```python
import torch

def _softmax(x, axis=-1):
    return torch.softmax(x, dim=axis)
def _gelu(x):
    return torch.nn.functional.gelu(x, approximate="tanh")
def _silu(x):
    return torch.nn.functional.silu(x)
def _sigmoid(x):
    return torch.sigmoid(x)
def _layernorm(x, axis=-1, eps=1e-5):
    m = x.mean(dim=axis, keepdim=True)
    v = x.var(dim=axis, keepdim=True, unbiased=False)
    return (x - m) / torch.sqrt(v + eps)
def _scatter_add(tgt, idx, src, axis=0):
    return tgt.clone().index_add_(axis, idx, src)
def _segment_sum(src, seg, n):
    out = torch.zeros((n,) + src.shape[1:], dtype=src.dtype)
    return out.index_add_(0, seg, src)
def _pad(x, pw):
    flat = tuple(v for pair in reversed(pw) for v in pair)
    return torch.nn.functional.pad(x, flat)

kernel_name = 'recurrent_scan__sliding_block_cached__dense_activation_gelu__prompt'

def setup_inputs():

    _w = (lambda a: (lambda t: t.to(torch.bfloat16) if t.is_floating_point() else t)(torch.as_tensor(a)))
    def _A_setup():
        B, Sq, D = 1, 2048, 1024
        Hq, Hkv, Sk, Dh = 32, 4, 2048, 128
        assert Hq % Hkv == 0, (Hq, Hkv)
        return {
            "x": _w((lambda *s: torch.randn(*s, dtype=torch.bfloat16) * 0.05)(B, Sq, D)),
            "k_cache": _w((lambda *s: torch.randn(*s, dtype=torch.bfloat16) * 1.6)(B, Hkv, Sk, Dh)),
            "v_cache": _w((lambda *s: torch.randn(*s, dtype=torch.bfloat16) * 0.8)(B, Hkv, Sk, Dh)),
            "wq": _w((lambda *s: torch.randn(*s, dtype=torch.bfloat16) * 1.6)(D, Hq * Dh) * (D ** -0.5)),
            "wo": _w((lambda *s: torch.randn(*s, dtype=torch.bfloat16) * 0.8)(Hq * Dh, D) * ((Hq * Dh) ** -0.5)),
        }
    _A_in = _A_setup()

    def _B_setup():
        B, S, D, F = 1, 2048, 1024, 3584
        return {
            "x": _w((lambda *s: torch.randn(*s, dtype=torch.bfloat16) * 0.05)(B, S, D)),
            "w1": _w((lambda *s: torch.randn(*s, dtype=torch.bfloat16) * 1.6)(D, F) * (D ** -0.5)),
            "b1": _w((lambda *s: torch.randn(*s, dtype=torch.bfloat16) * 1.6)(F) * 0.01),
            "w2": _w((lambda *s: torch.randn(*s, dtype=torch.bfloat16) * 0.2)(F, D) * (F ** -0.5)),
            "b2": _w((lambda *s: torch.randn(*s, dtype=torch.bfloat16) * 0.2)(D) * 0.01),
        }
    _B_in = _B_setup()

    return {
        "A_x": _A_in["x"],
        "A_k_cache": _A_in["k_cache"],
        "A_v_cache": _A_in["v_cache"],
        "A_wq": _A_in["wq"],
        "A_wo": _A_in["wo"],
        "B_x": _B_in["x"],
        "B_w1": _B_in["w1"],
        "B_b1": _B_in["b1"],
        "B_w2": _B_in["w2"],
        "B_b2": _B_in["b2"],
    }

def reference(A_x, A_k_cache, A_v_cache, A_wq, A_wo, B_x, B_w1, B_b1, B_w2, B_b2):
    def _A_ref(x, k_cache, v_cache, wq, wo):
        B, Sq, D = x.shape
        Hq, Dh = 32, 128
        Hkv, Sk = k_cache.shape[1], k_cache.shape[2]
        W = min(4096, max(256, Sk // 4))
        rep = Hq // Hkv
        q = (lambda x, *d: x.permute(*d))((x @ wq).reshape(B, Sq, Hq, Dh), 0, 2, 1, 3)
        k = (lambda x, n, axis: torch.repeat_interleave(x, n, dim=axis))(k_cache[:, :, Sk - W:, :], rep, axis=1)
        v = (lambda x, n, axis: torch.repeat_interleave(x, n, dim=axis))(v_cache[:, :, Sk - W:, :], rep, axis=1)
        scores = torch.einsum("bhqd,bhkd->bhqk", q, k) * (Dh ** -0.5)
        p = _softmax(scores, axis=-1)
        o = torch.einsum("bhqk,bhkd->bhqd", p, v)
        return (lambda x, *d: x.permute(*d))(o, 0, 2, 1, 3).reshape(B, Sq, Hq * Dh) @ wo

    def _B_ref(x, w1, b1, w2, b2):
        h = torch.einsum("bsd,df->bsf", x, w1) + b1
        h = _gelu(h)
        return torch.einsum("bsf,fd->bsd", h, w2) + b2

    x = A_x
    xn = _layernorm(x, axis=-1)
    s = _A_ref(xn, A_k_cache, A_v_cache, A_wq, A_wo)
    g = _silu(_B_ref(xn, B_w1, B_b1, B_w2, B_b2))
    return x + s * g
```

```asm
; @launch grid=(256,1,1) block=(256,1,1) lds=163840
.amdgcn_target "amdgcn-amd-amdhsa--gfx950"
.text
.macro M d,a,b
v_mfma_f32_16x16x32_bf16 \d,\a,\b,\d
.endm
.macro N d,a,b,c
v_mfma_f32_16x16x32_bf16 \d,\a,\b,\c
.endm
.macro T d,a,o
ds_read_b64_tr_b16 \d,\a offset:\o
.endm
.p2align 12
L_pad0:
s_cbranch_execz L_pb0
L_forkA:
s_mov_b64 exec, 0
s_cmp_eq_u32 s52, 0
s_cbranch_scc1 L_pad4
s_cmp_eq_u32 s52, 1
s_cbranch_scc1 L_pad5
s_cmp_eq_u32 s52, 2
s_cbranch_scc1 L_pad6
s_branch L_pad7
L_pb1A:
s_mov_b64 exec, -1
s_mul_i32 s62, s55, 1835008
v_lshrrev_b32 v40, 3, v0
v_cmp_eq_u32 vcc, 3, v40
s_mov_b32 s73, 100662912
s_cmp_eq_u32 s75, 0
s_cselect_b32 s73, s73, 100663552
s_sub_u32 s71, 201326464, s73
v_mov_b32 v40, s73
v_mov_b32 v41, s71
v_mov_b32 v42, 100663680
v_cndmask_b32 v40, 0, v40, vcc
v_cndmask_b32 v41, 0, v41, vcc
v_cndmask_b32 v42, 0, v42, vcc
v_add_u32 v58, v58, v40
v_add_u32 v59, v59, v41
v_add_u32 v13, v13, v42
v_lshlrev_b32 v99, 2, v63
v_add_u32 v99, 131072, v99
v_pk_mul_f32 v[40:41], v[128:129], v[128:129]
v_pk_mul_f32 v[42:43], v[130:131], v[130:131]
v_pk_mul_f32 v[44:45], v[144:145], v[144:145]
v_pk_mul_f32 v[46:47], v[146:147], v[146:147]
v_pk_fma_f32 v[40:41], v[40:41], v[112:113], v[108:109] op_sel:[0,0,0] op_sel_hi:[1,0,0]
v_pk_fma_f32 v[42:43], v[42:43], v[112:113], v[108:109] op_sel:[0,0,0] op_sel_hi:[1,0,0]
v_pk_fma_f32 v[44:45], v[44:45], v[112:113], v[108:109] op_sel:[0,0,0] op_sel_hi:[1,0,0]
v_pk_fma_f32 v[46:47], v[46:47], v[112:113], v[108:109] op_sel:[0,0,0] op_sel_hi:[1,0,0]
v_pk_mul_f32 v[40:41], v[40:41], v[128:129]
v_pk_mul_f32 v[42:43], v[42:43], v[130:131]
v_pk_mul_f32 v[44:45], v[44:45], v[144:145]
v_pk_mul_f32 v[46:47], v[46:47], v[146:147]
s_waitcnt lgkmcnt(8)
M a[0:3],a[128:131],a[192:195]
T a[152:153],v73,32776
T a[154:155],v73,33800
M a[0:3],a[132:135],a[208:211]
v_exp_f32 v40, v40
M a[4:7],a[132:135],a[212:215]
v_exp_f32 v41, v41
M a[4:7],a[128:131],a[196:199]
v_exp_f32 v42, v42
M a[8:11],a[128:131],a[200:203]
T a[156:157],v73,40968
T a[158:159],v73,41992
M a[8:11],a[132:135],a[216:219]
v_exp_f32 v43, v43
M a[12:15],a[132:135],a[220:223]
v_exp_f32 v44, v44
M a[12:15],a[128:131],a[204:207]
s_waitcnt lgkmcnt(8)
v_exp_f32 v45, v45
v_exp_f32 v46, v46
v_exp_f32 v47, v47
v_pk_fma_f32 v[40:41], v[40:41], v[104:105], v[104:105] op_sel:[0,0,0] op_sel_hi:[1,0,0]
v_pk_fma_f32 v[42:43], v[42:43], v[104:105], v[104:105] op_sel:[0,0,0] op_sel_hi:[1,0,0]
v_pk_fma_f32 v[44:45], v[44:45], v[104:105], v[104:105] op_sel:[0,0,0] op_sel_hi:[1,0,0]
v_pk_fma_f32 v[46:47], v[46:47], v[104:105], v[104:105] op_sel:[0,0,0] op_sel_hi:[1,0,0]
M a[28:31],a[140:143],a[220:223]
T a[128:129],v74,32768
T a[130:131],v74,33792
M a[28:31],a[136:139],a[204:207]
v_rcp_f32 v40, v40
M a[24:27],a[136:139],a[200:203]
v_rcp_f32 v41, v41
M a[24:27],a[140:143],a[216:219]
v_rcp_f32 v42, v42
M a[20:23],a[140:143],a[212:215]
T a[132:133],v74,40960
T a[134:135],v74,41984
M a[20:23],a[136:139],a[196:199]
v_rcp_f32 v43, v43
M a[16:19],a[136:139],a[192:195]
v_rcp_f32 v44, v44
M a[16:19],a[140:143],a[208:211]
v_rcp_f32 v45, v45
v_rcp_f32 v46, v46
v_rcp_f32 v47, v47
v_pk_mul_f32 v[128:129], v[40:41], v[128:129]
v_pk_mul_f32 v[130:131], v[42:43], v[130:131]
v_pk_mul_f32 v[144:145], v[44:45], v[144:145]
v_pk_mul_f32 v[146:147], v[46:47], v[146:147]
v_pk_mul_f32 v[40:41], v[132:133], v[132:133]
v_pk_mul_f32 v[42:43], v[134:135], v[134:135]
v_pk_mul_f32 v[44:45], v[148:149], v[148:149]
v_pk_mul_f32 v[46:47], v[150:151], v[150:151]
v_pk_fma_f32 v[40:41], v[40:41], v[112:113], v[108:109] op_sel:[0,1,1] op_sel_hi:[1,1,1]
v_pk_fma_f32 v[42:43], v[42:43], v[112:113], v[108:109] op_sel:[0,1,1] op_sel_hi:[1,1,1]
v_pk_fma_f32 v[44:45], v[44:45], v[112:113], v[108:109] op_sel:[0,1,1] op_sel_hi:[1,1,1]
v_pk_fma_f32 v[46:47], v[46:47], v[112:113], v[108:109] op_sel:[0,1,1] op_sel_hi:[1,1,1]
v_pk_mul_f32 v[40:41], v[40:41], v[132:133]
v_pk_mul_f32 v[42:43], v[42:43], v[134:135]
v_pk_mul_f32 v[44:45], v[44:45], v[148:149]
v_pk_mul_f32 v[46:47], v[46:47], v[150:151]
s_waitcnt lgkmcnt(8)
M a[32:35],a[144:147],a[192:195]
T a[136:137],v74,32776
T a[138:139],v74,33800
M a[32:35],a[148:151],a[208:211]
v_exp_f32 v40, v40
M a[36:39],a[148:151],a[212:215]
v_exp_f32 v41, v41
M a[36:39],a[144:147],a[196:199]
v_exp_f32 v42, v42
M a[40:43],a[144:147],a[200:203]
T a[140:141],v74,40968
T a[142:143],v74,41992
M a[40:43],a[148:151],a[216:219]
v_exp_f32 v43, v43
M a[44:47],a[148:151],a[220:223]
v_exp_f32 v44, v44
M a[44:47],a[144:147],a[204:207]
v_exp_f32 v45, v45
v_cvt_pk_bf16_f32 v240, v128, v129
v_cvt_pk_bf16_f32 v241, v130, v131
v_cvt_pk_bf16_f32 v242, v144, v145
v_cvt_pk_bf16_f32 v243, v146, v147
buffer_store_dwordx4 v[240:243], v58, s[12:15], s70 offen offset:0 sc1
v_exp_f32 v46, v46
v_exp_f32 v47, v47
v_pk_fma_f32 v[40:41], v[40:41], v[104:105], v[104:105] op_sel:[0,1,1] op_sel_hi:[1,1,1]
v_pk_fma_f32 v[42:43], v[42:43], v[104:105], v[104:105] op_sel:[0,1,1] op_sel_hi:[1,1,1]
v_pk_fma_f32 v[44:45], v[44:45], v[104:105], v[104:105] op_sel:[0,1,1] op_sel_hi:[1,1,1]
v_pk_fma_f32 v[46:47], v[46:47], v[104:105], v[104:105] op_sel:[0,1,1] op_sel_hi:[1,1,1]
s_waitcnt lgkmcnt(8)
M a[60:63],a[156:159],a[220:223]
T a[144:145],v75,32768
T a[146:147],v75,33792
M a[60:63],a[152:155],a[204:207]
v_rcp_f32 v40, v40
M a[56:59],a[152:155],a[200:203]
v_rcp_f32 v41, v41
M a[56:59],a[156:159],a[216:219]
v_rcp_f32 v42, v42
M a[52:55],a[156:159],a[212:215]
T a[148:149],v75,40960
T a[150:151],v75,41984
M a[52:55],a[152:155],a[196:199]
v_rcp_f32 v43, v43
M a[48:51],a[152:155],a[192:195]
v_rcp_f32 v44, v44
M a[48:51],a[156:159],a[208:211]
v_rcp_f32 v45, v45
v_rcp_f32 v46, v46
v_rcp_f32 v47, v47
v_pk_mul_f32 v[132:133], v[40:41], v[132:133]
v_pk_mul_f32 v[134:135], v[42:43], v[134:135]
v_pk_mul_f32 v[148:149], v[44:45], v[148:149]
v_pk_mul_f32 v[150:151], v[46:47], v[150:151]
v_pk_mul_f32 v[40:41], v[136:137], v[136:137]
v_pk_mul_f32 v[42:43], v[138:139], v[138:139]
v_pk_mul_f32 v[44:45], v[152:153], v[152:153]
v_pk_mul_f32 v[46:47], v[154:155], v[154:155]
v_pk_fma_f32 v[40:41], v[40:41], v[114:115], v[110:111] op_sel:[0,0,0] op_sel_hi:[1,0,0]
v_pk_fma_f32 v[42:43], v[42:43], v[114:115], v[110:111] op_sel:[0,0,0] op_sel_hi:[1,0,0]
v_pk_fma_f32 v[44:45], v[44:45], v[114:115], v[110:111] op_sel:[0,0,0] op_sel_hi:[1,0,0]
v_pk_fma_f32 v[46:47], v[46:47], v[114:115], v[110:111] op_sel:[0,0,0] op_sel_hi:[1,0,0]
v_pk_mul_f32 v[40:41], v[40:41], v[136:137]
v_pk_mul_f32 v[42:43], v[42:43], v[138:139]
v_pk_mul_f32 v[44:45], v[44:45], v[152:153]
v_pk_mul_f32 v[46:47], v[46:47], v[154:155]
s_waitcnt lgkmcnt(8)
M a[64:67],a[128:131],a[192:195]
T a[152:153],v75,32776
T a[154:155],v75,33800
M a[64:67],a[132:135],a[208:211]
v_exp_f32 v40, v40
M a[68:71],a[132:135],a[212:215]
v_exp_f32 v41, v41
M a[68:71],a[128:131],a[196:199]
v_exp_f32 v42, v42
M a[72:75],a[128:131],a[200:203]
T a[156:157],v75,40968
T a[158:159],v75,41992
M a[72:75],a[132:135],a[216:219]
v_exp_f32 v43, v43
M a[76:79],a[132:135],a[220:223]
v_exp_f32 v44, v44
M a[76:79],a[128:131],a[204:207]
v_exp_f32 v45, v45
v_cvt_pk_bf16_f32 v244, v132, v133
v_cvt_pk_bf16_f32 v245, v134, v135
v_cvt_pk_bf16_f32 v246, v148, v149
v_cvt_pk_bf16_f32 v247, v150, v151
buffer_store_dwordx4 v[244:247], v58, s[12:15], s70 offen offset:1024 sc1
v_exp_f32 v46, v46
v_exp_f32 v47, v47
v_pk_fma_f32 v[40:41], v[40:41], v[106:107], v[106:107] op_sel:[0,0,0] op_sel_hi:[1,0,0]
v_pk_fma_f32 v[42:43], v[42:43], v[106:107], v[106:107] op_sel:[0,0,0] op_sel_hi:[1,0,0]
v_pk_fma_f32 v[44:45], v[44:45], v[106:107], v[106:107] op_sel:[0,0,0] op_sel_hi:[1,0,0]
v_pk_fma_f32 v[46:47], v[46:47], v[106:107], v[106:107] op_sel:[0,0,0] op_sel_hi:[1,0,0]
s_waitcnt lgkmcnt(8)
M a[92:95],a[140:143],a[220:223]
T a[128:129],v76,0
T a[130:131],v76,1024
M a[92:95],a[136:139],a[204:207]
v_rcp_f32 v40, v40
M a[88:91],a[136:139],a[200:203]
v_rcp_f32 v41, v41
M a[88:91],a[140:143],a[216:219]
v_rcp_f32 v42, v42
M a[84:87],a[140:143],a[212:215]
T a[132:133],v76,8192
T a[134:135],v76,9216
M a[84:87],a[136:139],a[196:199]
v_rcp_f32 v43, v43
M a[80:83],a[136:139],a[192:195]
v_rcp_f32 v44, v44
M a[80:83],a[140:143],a[208:211]
v_rcp_f32 v45, v45
v_rcp_f32 v46, v46
v_rcp_f32 v47, v47
v_pk_mul_f32 v[136:137], v[40:41], v[136:137]
v_pk_mul_f32 v[138:139], v[42:43], v[138:139]
v_pk_mul_f32 v[152:153], v[44:45], v[152:153]
v_pk_mul_f32 v[154:155], v[46:47], v[154:155]
v_pk_mul_f32 v[40:41], v[140:141], v[140:141]
v_pk_mul_f32 v[42:43], v[142:143], v[142:143]
v_pk_mul_f32 v[44:45], v[156:157], v[156:157]
v_pk_mul_f32 v[46:47], v[158:159], v[158:159]
v_pk_fma_f32 v[40:41], v[40:41], v[114:115], v[110:111] op_sel:[0,1,1] op_sel_hi:[1,1,1]
v_pk_fma_f32 v[42:43], v[42:43], v[114:115], v[110:111] op_sel:[0,1,1] op_sel_hi:[1,1,1]
v_pk_fma_f32 v[44:45], v[44:45], v[114:115], v[110:111] op_sel:[0,1,1] op_sel_hi:[1,1,1]
v_pk_fma_f32 v[46:47], v[46:47], v[114:115], v[110:111] op_sel:[0,1,1] op_sel_hi:[1,1,1]
v_pk_mul_f32 v[40:41], v[40:41], v[140:141]
v_pk_mul_f32 v[42:43], v[42:43], v[142:143]
v_pk_mul_f32 v[44:45], v[44:45], v[156:157]
v_pk_mul_f32 v[46:47], v[46:47], v[158:159]
s_waitcnt lgkmcnt(8)
M a[96:99],a[144:147],a[192:195]
T a[136:137],v76,8
T a[138:139],v76,1032
M a[96:99],a[148:151],a[208:211]
v_exp_f32 v40, v40
M a[100:103],a[148:151],a[212:215]
v_exp_f32 v41, v41
M a[100:103],a[144:147],a[196:199]
v_exp_f32 v42, v42
M a[104:107],a[144:147],a[200:203]
T a[140:141],v76,8200
T a[142:143],v76,9224
M a[104:107],a[148:151],a[216:219]
v_exp_f32 v43, v43
M a[108:111],a[148:151],a[220:223]
v_exp_f32 v44, v44
M a[108:111],a[144:147],a[204:207]
v_exp_f32 v45, v45
v_cvt_pk_bf16_f32 v248, v136, v137
v_cvt_pk_bf16_f32 v249, v138, v139
v_cvt_pk_bf16_f32 v250, v152, v153
v_cvt_pk_bf16_f32 v251, v154, v155
buffer_store_dwordx4 v[248:251], v59, s[12:15], s70 offen offset:0 sc1
v_exp_f32 v46, v46
v_exp_f32 v47, v47
v_pk_fma_f32 v[40:41], v[40:41], v[106:107], v[106:107] op_sel:[0,1,1] op_sel_hi:[1,1,1]
v_pk_fma_f32 v[42:43], v[42:43], v[106:107], v[106:107] op_sel:[0,1,1] op_sel_hi:[1,1,1]
v_pk_fma_f32 v[44:45], v[44:45], v[106:107], v[106:107] op_sel:[0,1,1] op_sel_hi:[1,1,1]
v_pk_fma_f32 v[46:47], v[46:47], v[106:107], v[106:107] op_sel:[0,1,1] op_sel_hi:[1,1,1]
s_waitcnt lgkmcnt(8)
M a[124:127],a[156:159],a[220:223]
T a[144:145],v77,0
T a[146:147],v77,1024
M a[124:127],a[152:155],a[204:207]
v_rcp_f32 v40, v40
M a[120:123],a[152:155],a[200:203]
v_rcp_f32 v41, v41
M a[120:123],a[156:159],a[216:219]
v_rcp_f32 v42, v42
M a[116:119],a[156:159],a[212:215]
T a[148:149],v77,8192
T a[150:151],v77,9216
M a[116:119],a[152:155],a[196:199]
v_rcp_f32 v43, v43
M a[112:115],a[152:155],a[192:195]
v_rcp_f32 v44, v44
M a[112:115],a[156:159],a[208:211]
v_rcp_f32 v45, v45
v_rcp_f32 v46, v46
v_rcp_f32 v47, v47
v_pk_mul_f32 v[140:141], v[40:41], v[140:141]
v_pk_mul_f32 v[142:143], v[42:43], v[142:143]
v_pk_mul_f32 v[156:157], v[44:45], v[156:157]
v_pk_mul_f32 v[158:159], v[46:47], v[158:159]
v_pk_mul_f32 v[40:41], v[160:161], v[160:161]
v_pk_mul_f32 v[42:43], v[162:163], v[162:163]
v_pk_mul_f32 v[44:45], v[176:177], v[176:177]
v_pk_mul_f32 v[46:47], v[178:179], v[178:179]
v_pk_fma_f32 v[40:41], v[40:41], v[112:113], v[108:109] op_sel:[0,0,0] op_sel_hi:[1,0,0]
v_pk_fma_f32 v[42:43], v[42:43], v[112:113], v[108:109] op_sel:[0,0,0] op_sel_hi:[1,0,0]
v_pk_fma_f32 v[44:45], v[44:45], v[112:113], v[108:109] op_sel:[0,0,0] op_sel_hi:[1,0,0]
v_pk_fma_f32 v[46:47], v[46:47], v[112:113], v[108:109] op_sel:[0,0,0] op_sel_hi:[1,0,0]
v_pk_mul_f32 v[40:41], v[40:41], v[160:161]
v_pk_mul_f32 v[42:43], v[42:43], v[162:163]
v_pk_mul_f32 v[44:45], v[44:45], v[176:177]
v_pk_mul_f32 v[46:47], v[46:47], v[178:179]
s_waitcnt lgkmcnt(8)
M a[0:3],a[128:131],a[224:227]
T a[152:153],v77,8
T a[154:155],v77,1032
M a[0:3],a[132:135],a[240:243]
v_exp_f32 v40, v40
M a[4:7],a[132:135],a[244:247]
v_exp_f32 v41, v41
M a[4:7],a[128:131],a[228:231]
v_exp_f32 v42, v42
M a[8:11],a[128:131],a[232:235]
T a[156:157],v77,8200
T a[158:159],v77,9224
M a[8:11],a[132:135],a[248:251]
v_exp_f32 v43, v43
M a[12:15],a[132:135],a[252:255]
v_exp_f32 v44, v44
M a[12:15],a[128:131],a[236:239]
v_exp_f32 v45, v45
v_cvt_pk_bf16_f32 v252, v140, v141
v_cvt_pk_bf16_f32 v253, v142, v143
v_cvt_pk_bf16_f32 v254, v156, v157
v_cvt_pk_bf16_f32 v255, v158, v159
buffer_store_dwordx4 v[252:255], v59, s[12:15], s70 offen offset:1024 sc1
s_add_u32 s70, s70, 4096
v_exp_f32 v46, v46
v_exp_f32 v47, v47
v_pk_fma_f32 v[40:41], v[40:41], v[104:105], v[104:105] op_sel:[0,0,0] op_sel_hi:[1,0,0]
v_pk_fma_f32 v[42:43], v[42:43], v[104:105], v[104:105] op_sel:[0,0,0] op_sel_hi:[1,0,0]
v_pk_fma_f32 v[44:45], v[44:45], v[104:105], v[104:105] op_sel:[0,0,0] op_sel_hi:[1,0,0]
v_pk_fma_f32 v[46:47], v[46:47], v[104:105], v[104:105] op_sel:[0,0,0] op_sel_hi:[1,0,0]
s_waitcnt lgkmcnt(8)
M a[28:31],a[140:143],a[252:255]
T a[128:129],v78,0
T a[130:131],v78,1024
M a[28:31],a[136:139],a[236:239]
v_rcp_f32 v40, v40
M a[24:27],a[136:139],a[232:235]
v_rcp_f32 v41, v41
M a[24:27],a[140:143],a[248:251]
v_rcp_f32 v42, v42
M a[20:23],a[140:143],a[244:247]
T a[132:133],v78,8192
T a[134:135],v78,9216
M a[20:23],a[136:139],a[228:231]
v_rcp_f32 v43, v43
M a[16:19],a[136:139],a[224:227]
v_rcp_f32 v44, v44
M a[16:19],a[140:143],a[240:243]
v_rcp_f32 v45, v45
v_rcp_f32 v46, v46
v_rcp_f32 v47, v47
v_pk_mul_f32 v[160:161], v[40:41], v[160:161]
v_pk_mul_f32 v[162:163], v[42:43], v[162:163]
v_pk_mul_f32 v[176:177], v[44:45], v[176:177]
v_pk_mul_f32 v[178:179], v[46:47], v[178:179]
v_pk_mul_f32 v[40:41], v[164:165], v[164:165]
v_pk_mul_f32 v[42:43], v[166:167], v[166:167]
v_pk_mul_f32 v[44:45], v[180:181], v[180:181]
v_pk_mul_f32 v[46:47], v[182:183], v[182:183]
v_pk_fma_f32 v[40:41], v[40:41], v[112:113], v[108:109] op_sel:[0,1,1] op_sel_hi:[1,1,1]
v_pk_fma_f32 v[42:43], v[42:43], v[112:113], v[108:109] op_sel:[0,1,1] op_sel_hi:[1,1,1]
v_pk_fma_f32 v[44:45], v[44:45], v[112:113], v[108:109] op_sel:[0,1,1] op_sel_hi:[1,1,1]
v_pk_fma_f32 v[46:47], v[46:47], v[112:113], v[108:109] op_sel:[0,1,1] op_sel_hi:[1,1,1]
v_pk_mul_f32 v[40:41], v[40:41], v[164:165]
v_pk_mul_f32 v[42:43], v[42:43], v[166:167]
v_pk_mul_f32 v[44:45], v[44:45], v[180:181]
v_pk_mul_f32 v[46:47], v[46:47], v[182:183]
s_waitcnt lgkmcnt(8)
M a[32:35],a[144:147],a[224:227]
T a[136:137],v78,8
T a[138:139],v78,1032
M a[32:35],a[148:151],a[240:243]
v_exp_f32 v40, v40
M a[36:39],a[148:151],a[244:247]
v_exp_f32 v41, v41
M a[36:39],a[144:147],a[228:231]
v_exp_f32 v42, v42
M a[40:43],a[144:147],a[232:235]
T a[140:141],v78,8200
T a[142:143],v78,9224
M a[40:43],a[148:151],a[248:251]
v_exp_f32 v43, v43
M a[44:47],a[148:151],a[252:255]
v_exp_f32 v44, v44
M a[44:47],a[144:147],a[236:239]
v_exp_f32 v45, v45
v_cvt_pk_bf16_f32 v240, v160, v161
v_cvt_pk_bf16_f32 v241, v162, v163
v_cvt_pk_bf16_f32 v242, v176, v177
v_cvt_pk_bf16_f32 v243, v178, v179
buffer_store_dwordx4 v[240:243], v58, s[12:15], s70 offen offset:0 sc1
ds_read_b128 v[128:131], v99 offset:0
ds_read_b128 v[132:135], v99 offset:16
v_exp_f32 v46, v46
v_exp_f32 v47, v47
v_pk_fma_f32 v[40:41], v[40:41], v[104:105], v[104:105] op_sel:[0,1,1] op_sel_hi:[1,1,1]
v_pk_fma_f32 v[42:43], v[42:43], v[104:105], v[104:105] op_sel:[0,1,1] op_sel_hi:[1,1,1]
v_pk_fma_f32 v[44:45], v[44:45], v[104:105], v[104:105] op_sel:[0,1,1] op_sel_hi:[1,1,1]
v_pk_fma_f32 v[46:47], v[46:47], v[104:105], v[104:105] op_sel:[0,1,1] op_sel_hi:[1,1,1]
s_waitcnt lgkmcnt(10)
M a[60:63],a[156:159],a[252:255]
T a[144:145],v79,0
T a[146:147],v79,1024
M a[60:63],a[152:155],a[236:239]
v_rcp_f32 v40, v40
M a[56:59],a[152:155],a[232:235]
v_rcp_f32 v41, v41
M a[56:59],a[156:159],a[248:251]
v_rcp_f32 v42, v42
M a[52:55],a[156:159],a[244:247]
T a[148:149],v79,8192
T a[150:151],v79,9216
M a[52:55],a[152:155],a[228:231]
v_rcp_f32 v43, v43
M a[48:51],a[152:155],a[224:227]
v_rcp_f32 v44, v44
M a[48:51],a[156:159],a[240:243]
v_rcp_f32 v45, v45
v_rcp_f32 v46, v46
v_rcp_f32 v47, v47
v_pk_mul_f32 v[164:165], v[40:41], v[164:165]
v_pk_mul_f32 v[166:167], v[42:43], v[166:167]
v_pk_mul_f32 v[180:181], v[44:45], v[180:181]
v_pk_mul_f32 v[182:183], v[46:47], v[182:183]
v_pk_mul_f32 v[40:41], v[168:169], v[168:169]
v_pk_mul_f32 v[42:43], v[170:171], v[170:171]
v_pk_mul_f32 v[44:45], v[184:185], v[184:185]
v_pk_mul_f32 v[46:47], v[186:187], v[186:187]
v_pk_fma_f32 v[40:41], v[40:41], v[114:115], v[110:111] op_sel:[0,0,0] op_sel_hi:[1,0,0]
v_pk_fma_f32 v[42:43], v[42:43], v[114:115], v[110:111] op_sel:[0,0,0] op_sel_hi:[1,0,0]
v_pk_fma_f32 v[44:45], v[44:45], v[114:115], v[110:111] op_sel:[0,0,0] op_sel_hi:[1,0,0]
v_pk_fma_f32 v[46:47], v[46:47], v[114:115], v[110:111] op_sel:[0,0,0] op_sel_hi:[1,0,0]
v_pk_mul_f32 v[40:41], v[40:41], v[168:169]
v_pk_mul_f32 v[42:43], v[42:43], v[170:171]
v_pk_mul_f32 v[44:45], v[44:45], v[184:185]
v_pk_mul_f32 v[46:47], v[46:47], v[186:187]
s_waitcnt lgkmcnt(10)
M a[64:67],a[128:131],a[224:227]
T a[152:153],v79,8
T a[154:155],v79,1032
M a[64:67],a[132:135],a[240:243]
v_exp_f32 v40, v40
M a[68:71],a[132:135],a[244:247]
v_exp_f32 v41, v41
M a[68:71],a[128:131],a[228:231]
v_exp_f32 v42, v42
M a[72:75],a[128:131],a[232:235]
T a[156:157],v79,8200
T a[158:159],v79,9224
M a[72:75],a[132:135],a[248:251]
v_exp_f32 v43, v43
M a[76:79],a[132:135],a[252:255]
v_exp_f32 v44, v44
M a[76:79],a[128:131],a[236:239]
v_exp_f32 v45, v45
v_cvt_pk_bf16_f32 v244, v164, v165
v_cvt_pk_bf16_f32 v245, v166, v167
v_cvt_pk_bf16_f32 v246, v180, v181
v_cvt_pk_bf16_f32 v247, v182, v183
buffer_store_dwordx4 v[244:247], v58, s[12:15], s70 offen offset:1024 sc1
ds_read_b128 v[136:139], v99 offset:128
ds_read_b128 v[140:143], v99 offset:144
v_exp_f32 v46, v46
v_exp_f32 v47, v47
v_pk_fma_f32 v[40:41], v[40:41], v[106:107], v[106:107] op_sel:[0,0,0] op_sel_hi:[1,0,0]
v_pk_fma_f32 v[42:43], v[42:43], v[106:107], v[106:107] op_sel:[0,0,0] op_sel_hi:[1,0,0]
v_pk_fma_f32 v[44:45], v[44:45], v[106:107], v[106:107] op_sel:[0,0,0] op_sel_hi:[1,0,0]
v_pk_fma_f32 v[46:47], v[46:47], v[106:107], v[106:107] op_sel:[0,0,0] op_sel_hi:[1,0,0]
s_waitcnt lgkmcnt(12)
M a[92:95],a[140:143],a[252:255]
T a[128:129],v76,32768
T a[130:131],v76,33792
M a[92:95],a[136:139],a[236:239]
v_rcp_f32 v40, v40
M a[88:91],a[136:139],a[232:235]
v_rcp_f32 v41, v41
M a[88:91],a[140:143],a[248:251]
v_rcp_f32 v42, v42
M a[84:87],a[140:143],a[244:247]
T a[132:133],v76,40960
T a[134:135],v76,41984
M a[84:87],a[136:139],a[228:231]
v_rcp_f32 v43, v43
M a[80:83],a[136:139],a[224:227]
v_rcp_f32 v44, v44
M a[80:83],a[140:143],a[240:243]
v_rcp_f32 v45, v45
v_rcp_f32 v46, v46
v_rcp_f32 v47, v47
v_pk_mul_f32 v[168:169], v[40:41], v[168:169]
v_pk_mul_f32 v[170:171], v[42:43], v[170:171]
v_pk_mul_f32 v[184:185], v[44:45], v[184:185]
v_pk_mul_f32 v[186:187], v[46:47], v[186:187]
v_pk_mul_f32 v[40:41], v[172:173], v[172:173]
v_pk_mul_f32 v[42:43], v[174:175], v[174:175]
v_pk_mul_f32 v[44:45], v[188:189], v[188:189]
v_pk_mul_f32 v[46:47], v[190:191], v[190:191]
v_pk_fma_f32 v[40:41], v[40:41], v[114:115], v[110:111] op_sel:[0,1,1] op_sel_hi:[1,1,1]
v_pk_fma_f32 v[42:43], v[42:43], v[114:115], v[110:111] op_sel:[0,1,1] op_sel_hi:[1,1,1]
v_pk_fma_f32 v[44:45], v[44:45], v[114:115], v[110:111] op_sel:[0,1,1] op_sel_hi:[1,1,1]
v_pk_fma_f32 v[46:47], v[46:47], v[114:115], v[110:111] op_sel:[0,1,1] op_sel_hi:[1,1,1]
v_pk_mul_f32 v[40:41], v[40:41], v[172:173]
v_pk_mul_f32 v[42:43], v[42:43], v[174:175]
v_pk_mul_f32 v[44:45], v[44:45], v[188:189]
v_pk_mul_f32 v[46:47], v[46:47], v[190:191]
s_waitcnt lgkmcnt(10)
M a[96:99],a[144:147],a[224:227]
T a[136:137],v76,32776
T a[138:139],v76,33800
M a[96:99],a[148:151],a[240:243]
v_exp_f32 v40, v40
M a[100:103],a[148:151],a[244:247]
v_exp_f32 v41, v41
M a[100:103],a[144:147],a[228:231]
v_exp_f32 v42, v42
M a[104:107],a[144:147],a[232:235]
T a[140:141],v76,40968
T a[142:143],v76,41992
M a[104:107],a[148:151],a[248:251]
v_exp_f32 v43, v43
M a[108:111],a[148:151],a[252:255]
v_exp_f32 v44, v44
M a[108:111],a[144:147],a[236:239]
v_exp_f32 v45, v45
v_cvt_pk_bf16_f32 v248, v168, v169
v_cvt_pk_bf16_f32 v249, v170, v171
v_cvt_pk_bf16_f32 v250, v184, v185
v_cvt_pk_bf16_f32 v251, v186, v187
buffer_store_dwordx4 v[248:251], v59, s[12:15], s70 offen offset:0 sc1
ds_read_b128 v[144:147], v99 offset:256
ds_read_b128 v[148:151], v99 offset:272
v_exp_f32 v46, v46
v_exp_f32 v47, v47
v_pk_fma_f32 v[40:41], v[40:41], v[106:107], v[106:107] op_sel:[0,1,1] op_sel_hi:[1,1,1]
v_pk_fma_f32 v[42:43], v[42:43], v[106:107], v[106:107] op_sel:[0,1,1] op_sel_hi:[1,1,1]
v_pk_fma_f32 v[44:45], v[44:45], v[106:107], v[106:107] op_sel:[0,1,1] op_sel_hi:[1,1,1]
v_pk_fma_f32 v[46:47], v[46:47], v[106:107], v[106:107] op_sel:[0,1,1] op_sel_hi:[1,1,1]
s_waitcnt lgkmcnt(12)
M a[124:127],a[156:159],a[252:255]
T a[144:145],v77,32768
T a[146:147],v77,33792
M a[124:127],a[152:155],a[236:239]
v_rcp_f32 v40, v40
M a[120:123],a[152:155],a[232:235]
v_rcp_f32 v41, v41
M a[120:123],a[156:159],a[248:251]
v_rcp_f32 v42, v42
M a[116:119],a[156:159],a[244:247]
T a[148:149],v77,40960
T a[150:151],v77,41984
M a[116:119],a[152:155],a[228:231]
v_rcp_f32 v43, v43
M a[112:115],a[152:155],a[224:227]
v_rcp_f32 v44, v44
M a[112:115],a[156:159],a[240:243]
v_rcp_f32 v45, v45
v_rcp_f32 v46, v46
v_rcp_f32 v47, v47
v_pk_mul_f32 v[172:173], v[40:41], v[172:173]
v_pk_mul_f32 v[174:175], v[42:43], v[174:175]
v_pk_mul_f32 v[188:189], v[44:45], v[188:189]
v_pk_mul_f32 v[190:191], v[46:47], v[190:191]
v_pk_mul_f32 v[40:41], v[192:193], v[192:193]
v_pk_mul_f32 v[42:43], v[194:195], v[194:195]
v_pk_mul_f32 v[44:45], v[208:209], v[208:209]
v_pk_mul_f32 v[46:47], v[210:211], v[210:211]
v_pk_fma_f32 v[40:41], v[40:41], v[112:113], v[108:109] op_sel:[0,0,0] op_sel_hi:[1,0,0]
v_pk_fma_f32 v[42:43], v[42:43], v[112:113], v[108:109] op_sel:[0,0,0] op_sel_hi:[1,0,0]
v_pk_fma_f32 v[44:45], v[44:45], v[112:113], v[108:109] op_sel:[0,0,0] op_sel_hi:[1,0,0]
v_pk_fma_f32 v[46:47], v[46:47], v[112:113], v[108:109] op_sel:[0,0,0] op_sel_hi:[1,0,0]
v_pk_mul_f32 v[40:41], v[40:41], v[192:193]
v_pk_mul_f32 v[42:43], v[42:43], v[194:195]
v_pk_mul_f32 v[44:45], v[44:45], v[208:209]
v_pk_mul_f32 v[46:47], v[46:47], v[210:211]
s_waitcnt lgkmcnt(10)
M a[0:3],a[128:131],a[160:163]
T a[152:153],v77,32776
T a[154:155],v77,33800
M a[0:3],a[132:135],a[176:179]
v_exp_f32 v40, v40
M a[4:7],a[132:135],a[180:183]
v_exp_f32 v41, v41
M a[4:7],a[128:131],a[164:167]
v_exp_f32 v42, v42
M a[8:11],a[128:131],a[168:171]
T a[156:157],v77,40968
T a[158:159],v77,41992
M a[8:11],a[132:135],a[184:187]
v_exp_f32 v43, v43
M a[12:15],a[132:135],a[188:191]
v_exp_f32 v44, v44
M a[12:15],a[128:131],a[172:175]
v_exp_f32 v45, v45
v_cvt_pk_bf16_f32 v252, v172, v173
v_cvt_pk_bf16_f32 v253, v174, v175
L_pad1:
s_cbranch_execz L_pb0
v_cvt_pk_bf16_f32 v254, v188, v189
v_cvt_pk_bf16_f32 v255, v190, v191
buffer_store_dwordx4 v[252:255], v59, s[12:15], s70 offen offset:1024 sc1
s_add_u32 s70, s70, 4096
ds_read_b128 v[152:155], v99 offset:384
ds_read_b128 v[156:159], v99 offset:400
v_exp_f32 v46, v46
v_exp_f32 v47, v47
v_pk_fma_f32 v[40:41], v[40:41], v[104:105], v[104:105] op_sel:[0,0,0] op_sel_hi:[1,0,0]
v_pk_fma_f32 v[42:43], v[42:43], v[104:105], v[104:105] op_sel:[0,0,0] op_sel_hi:[1,0,0]
v_pk_fma_f32 v[44:45], v[44:45], v[104:105], v[104:105] op_sel:[0,0,0] op_sel_hi:[1,0,0]
v_pk_fma_f32 v[46:47], v[46:47], v[104:105], v[104:105] op_sel:[0,0,0] op_sel_hi:[1,0,0]
s_waitcnt lgkmcnt(12)
M a[28:31],a[140:143],a[188:191]
T a[128:129],v78,32768
T a[130:131],v78,33792
M a[28:31],a[136:139],a[172:175]
v_rcp_f32 v40, v40
M a[24:27],a[136:139],a[168:171]
v_rcp_f32 v41, v41
M a[24:27],a[140:143],a[184:187]
v_rcp_f32 v42, v42
M a[20:23],a[140:143],a[180:183]
T a[132:133],v78,40960
T a[134:135],v78,41984
M a[20:23],a[136:139],a[164:167]
v_rcp_f32 v43, v43
M a[16:19],a[136:139],a[160:163]
v_rcp_f32 v44, v44
M a[16:19],a[140:143],a[176:179]
v_rcp_f32 v45, v45
v_rcp_f32 v46, v46
v_rcp_f32 v47, v47
v_pk_mul_f32 v[192:193], v[40:41], v[192:193]
v_pk_mul_f32 v[194:195], v[42:43], v[194:195]
v_pk_mul_f32 v[208:209], v[44:45], v[208:209]
v_pk_mul_f32 v[210:211], v[46:47], v[210:211]
v_pk_mul_f32 v[40:41], v[196:197], v[196:197]
v_pk_mul_f32 v[42:43], v[198:199], v[198:199]
v_pk_mul_f32 v[44:45], v[212:213], v[212:213]
v_pk_mul_f32 v[46:47], v[214:215], v[214:215]
v_pk_fma_f32 v[40:41], v[40:41], v[112:113], v[108:109] op_sel:[0,1,1] op_sel_hi:[1,1,1]
v_pk_fma_f32 v[42:43], v[42:43], v[112:113], v[108:109] op_sel:[0,1,1] op_sel_hi:[1,1,1]
v_pk_fma_f32 v[44:45], v[44:45], v[112:113], v[108:109] op_sel:[0,1,1] op_sel_hi:[1,1,1]
v_pk_fma_f32 v[46:47], v[46:47], v[112:113], v[108:109] op_sel:[0,1,1] op_sel_hi:[1,1,1]
v_pk_mul_f32 v[40:41], v[40:41], v[196:197]
v_pk_mul_f32 v[42:43], v[42:43], v[198:199]
v_pk_mul_f32 v[44:45], v[44:45], v[212:213]
v_pk_mul_f32 v[46:47], v[46:47], v[214:215]
s_waitcnt lgkmcnt(10)
M a[32:35],a[144:147],a[160:163]
T a[136:137],v78,32776
T a[138:139],v78,33800
M a[32:35],a[148:151],a[176:179]
v_exp_f32 v40, v40
M a[36:39],a[148:151],a[180:183]
v_exp_f32 v41, v41
M a[36:39],a[144:147],a[164:167]
v_exp_f32 v42, v42
M a[40:43],a[144:147],a[168:171]
T a[140:141],v78,40968
T a[142:143],v78,41992
M a[40:43],a[148:151],a[184:187]
v_exp_f32 v43, v43
M a[44:47],a[148:151],a[188:191]
v_exp_f32 v44, v44
M a[44:47],a[144:147],a[172:175]
v_exp_f32 v45, v45
v_cvt_pk_bf16_f32 v240, v192, v193
v_cvt_pk_bf16_f32 v241, v194, v195
v_cvt_pk_bf16_f32 v242, v208, v209
v_cvt_pk_bf16_f32 v243, v210, v211
buffer_store_dwordx4 v[240:243], v58, s[12:15], s70 offen offset:0 sc1
v_exp_f32 v46, v46
v_exp_f32 v47, v47
v_pk_fma_f32 v[40:41], v[40:41], v[104:105], v[104:105] op_sel:[0,1,1] op_sel_hi:[1,1,1]
v_pk_fma_f32 v[42:43], v[42:43], v[104:105], v[104:105] op_sel:[0,1,1] op_sel_hi:[1,1,1]
v_pk_fma_f32 v[44:45], v[44:45], v[104:105], v[104:105] op_sel:[0,1,1] op_sel_hi:[1,1,1]
v_pk_fma_f32 v[46:47], v[46:47], v[104:105], v[104:105] op_sel:[0,1,1] op_sel_hi:[1,1,1]
s_waitcnt lgkmcnt(10)
M a[60:63],a[156:159],a[188:191]
T a[144:145],v79,32768
T a[146:147],v79,33792
M a[60:63],a[152:155],a[172:175]
v_rcp_f32 v40, v40
M a[56:59],a[152:155],a[168:171]
v_rcp_f32 v41, v41
M a[56:59],a[156:159],a[184:187]
v_rcp_f32 v42, v42
M a[52:55],a[156:159],a[180:183]
T a[148:149],v79,40960
T a[150:151],v79,41984
M a[52:55],a[152:155],a[164:167]
v_rcp_f32 v43, v43
M a[48:51],a[152:155],a[160:163]
v_rcp_f32 v44, v44
M a[48:51],a[156:159],a[176:179]
v_rcp_f32 v45, v45
v_rcp_f32 v46, v46
v_rcp_f32 v47, v47
v_pk_mul_f32 v[196:197], v[40:41], v[196:197]
v_pk_mul_f32 v[198:199], v[42:43], v[198:199]
v_pk_mul_f32 v[212:213], v[44:45], v[212:213]
v_pk_mul_f32 v[214:215], v[46:47], v[214:215]
v_pk_mul_f32 v[40:41], v[200:201], v[200:201]
v_pk_mul_f32 v[42:43], v[202:203], v[202:203]
v_pk_mul_f32 v[44:45], v[216:217], v[216:217]
v_pk_mul_f32 v[46:47], v[218:219], v[218:219]
v_pk_fma_f32 v[40:41], v[40:41], v[114:115], v[110:111] op_sel:[0,0,0] op_sel_hi:[1,0,0]
v_pk_fma_f32 v[42:43], v[42:43], v[114:115], v[110:111] op_sel:[0,0,0] op_sel_hi:[1,0,0]
v_pk_fma_f32 v[44:45], v[44:45], v[114:115], v[110:111] op_sel:[0,0,0] op_sel_hi:[1,0,0]
v_pk_fma_f32 v[46:47], v[46:47], v[114:115], v[110:111] op_sel:[0,0,0] op_sel_hi:[1,0,0]
v_pk_mul_f32 v[40:41], v[40:41], v[200:201]
v_pk_mul_f32 v[42:43], v[42:43], v[202:203]
v_pk_mul_f32 v[44:45], v[44:45], v[216:217]
v_pk_mul_f32 v[46:47], v[46:47], v[218:219]
s_waitcnt lgkmcnt(8)
M a[64:67],a[128:131],a[160:163]
T a[152:153],v79,32776
T a[154:155],v79,33800
M a[64:67],a[132:135],a[176:179]
v_exp_f32 v40, v40
M a[68:71],a[132:135],a[180:183]
v_exp_f32 v41, v41
M a[68:71],a[128:131],a[164:167]
v_exp_f32 v42, v42
M a[72:75],a[128:131],a[168:171]
T a[156:157],v79,40968
T a[158:159],v79,41992
M a[72:75],a[132:135],a[184:187]
v_exp_f32 v43, v43
M a[76:79],a[132:135],a[188:191]
v_exp_f32 v44, v44
M a[76:79],a[128:131],a[172:175]
v_cvt_pk_bf16_f32 v244, v196, v197
v_cvt_pk_bf16_f32 v245, v198, v199
v_cvt_pk_bf16_f32 v246, v212, v213
v_cvt_pk_bf16_f32 v247, v214, v215
buffer_store_dwordx4 v[244:247], v58, s[12:15], s70 offen offset:1024 sc1
v_exp_f32 v45, v45
v_exp_f32 v46, v46
v_exp_f32 v47, v47
v_pk_fma_f32 v[40:41], v[40:41], v[106:107], v[106:107] op_sel:[0,0,0] op_sel_hi:[1,0,0]
v_pk_fma_f32 v[42:43], v[42:43], v[106:107], v[106:107] op_sel:[0,0,0] op_sel_hi:[1,0,0]
v_pk_fma_f32 v[44:45], v[44:45], v[106:107], v[106:107] op_sel:[0,0,0] op_sel_hi:[1,0,0]
v_pk_fma_f32 v[46:47], v[46:47], v[106:107], v[106:107] op_sel:[0,0,0] op_sel_hi:[1,0,0]
s_waitcnt vmcnt(11)
s_barrier
s_waitcnt lgkmcnt(8)
M a[92:95],a[140:143],a[188:191]
ds_read_b128 a[128:131], v32 offset:0
v_rcp_f32 v40, v40
M a[92:95],a[136:139],a[172:175]
v_rcp_f32 v41, v41
M a[88:91],a[136:139],a[168:171]
v_rcp_f32 v42, v42
M a[88:91],a[140:143],a[184:187]
v_rcp_f32 v43, v43
M a[84:87],a[140:143],a[180:183]
ds_read_b128 a[132:135], v33 offset:0
v_rcp_f32 v44, v44
M a[84:87],a[136:139],a[164:167]
v_rcp_f32 v45, v45
M a[80:83],a[136:139],a[160:163]
v_rcp_f32 v46, v46
M a[80:83],a[140:143],a[176:179]
v_rcp_f32 v47, v47
v_pk_mul_f32 v[200:201], v[40:41], v[200:201]
v_pk_mul_f32 v[202:203], v[42:43], v[202:203]
v_pk_mul_f32 v[216:217], v[44:45], v[216:217]
v_pk_mul_f32 v[218:219], v[46:47], v[218:219]
v_pk_mul_f32 v[40:41], v[204:205], v[204:205]
v_pk_mul_f32 v[42:43], v[206:207], v[206:207]
v_pk_mul_f32 v[44:45], v[220:221], v[220:221]
v_pk_mul_f32 v[46:47], v[222:223], v[222:223]
v_pk_fma_f32 v[40:41], v[40:41], v[114:115], v[110:111] op_sel:[0,1,1] op_sel_hi:[1,1,1]
v_pk_fma_f32 v[42:43], v[42:43], v[114:115], v[110:111] op_sel:[0,1,1] op_sel_hi:[1,1,1]
v_pk_fma_f32 v[44:45], v[44:45], v[114:115], v[110:111] op_sel:[0,1,1] op_sel_hi:[1,1,1]
v_pk_fma_f32 v[46:47], v[46:47], v[114:115], v[110:111] op_sel:[0,1,1] op_sel_hi:[1,1,1]
v_pk_mul_f32 v[40:41], v[40:41], v[204:205]
v_pk_mul_f32 v[42:43], v[42:43], v[206:207]
v_pk_mul_f32 v[44:45], v[44:45], v[220:221]
v_pk_mul_f32 v[46:47], v[46:47], v[222:223]
s_waitcnt lgkmcnt(6)
M a[96:99],a[144:147],a[160:163]
ds_read_b128 a[136:139], v34 offset:0
v_cvt_pk_bf16_f32 v248, v200, v201
M a[96:99],a[148:151],a[176:179]
v_exp_f32 v40, v40
M a[100:103],a[148:151],a[180:183]
v_exp_f32 v41, v41
M a[100:103],a[144:147],a[164:167]
v_exp_f32 v42, v42
M a[104:107],a[144:147],a[168:171]
ds_read_b128 a[140:143], v35 offset:0
v_cvt_pk_bf16_f32 v249, v202, v203
M a[104:107],a[148:151],a[184:187]
v_exp_f32 v43, v43
M a[108:111],a[148:151],a[188:191]
v_exp_f32 v44, v44
M a[108:111],a[144:147],a[172:175]
v_exp_f32 v45, v45
v_cvt_pk_bf16_f32 v250, v216, v217
v_cvt_pk_bf16_f32 v251, v218, v219
buffer_store_dwordx4 v[248:251], v59, s[12:15], s70 offen offset:0 sc1
v_exp_f32 v46, v46
v_exp_f32 v47, v47
v_pk_fma_f32 v[40:41], v[40:41], v[106:107], v[106:107] op_sel:[0,1,1] op_sel_hi:[1,1,1]
v_pk_fma_f32 v[42:43], v[42:43], v[106:107], v[106:107] op_sel:[0,1,1] op_sel_hi:[1,1,1]
v_pk_fma_f32 v[44:45], v[44:45], v[106:107], v[106:107] op_sel:[0,1,1] op_sel_hi:[1,1,1]
v_pk_fma_f32 v[46:47], v[46:47], v[106:107], v[106:107] op_sel:[0,1,1] op_sel_hi:[1,1,1]
s_waitcnt lgkmcnt(4)
M a[124:127],a[156:159],a[188:191]
ds_read_b128 a[144:147], v32 offset:4096
v_rcp_f32 v40, v40
M a[124:127],a[152:155],a[172:175]
v_rcp_f32 v41, v41
M a[120:123],a[152:155],a[168:171]
v_rcp_f32 v42, v42
M a[120:123],a[156:159],a[184:187]
v_rcp_f32 v43, v43
M a[116:119],a[156:159],a[180:183]
ds_read_b128 a[148:151], v33 offset:4096
v_rcp_f32 v44, v44
M a[116:119],a[152:155],a[164:167]
v_rcp_f32 v45, v45
M a[112:115],a[152:155],a[160:163]
v_rcp_f32 v46, v46
M a[112:115],a[156:159],a[176:179]
v_rcp_f32 v47, v47
v_pk_mul_f32 v[204:205], v[40:41], v[204:205]
v_pk_mul_f32 v[206:207], v[42:43], v[206:207]
v_pk_mul_f32 v[220:221], v[44:45], v[220:221]
v_pk_mul_f32 v[222:223], v[46:47], v[222:223]
v_cvt_pk_bf16_f32 v252, v204, v205
v_cvt_pk_bf16_f32 v253, v206, v207
v_cvt_pk_bf16_f32 v254, v220, v221
v_cvt_pk_bf16_f32 v255, v222, v223
buffer_store_dwordx4 v[252:255], v59, s[12:15], s70 offen offset:1024 sc1
v_mov_b64 v[244:245], v[104:105]
v_mov_b64 v[246:247], v[108:109]
v_mov_b64 v[248:249], v[112:113]
s_waitcnt lgkmcnt(15)
s_waitcnt vmcnt(12)
v_accvgpr_read_b32 v40, a0
v_accvgpr_read_b32 v41, a1
v_accvgpr_read_b32 v42, a2
v_accvgpr_read_b32 v43, a3
v_accvgpr_read_b32 v44, a16
v_accvgpr_read_b32 v45, a17
v_accvgpr_read_b32 v46, a18
v_accvgpr_read_b32 v47, a19
v_pk_fma_f32 v[40:41], v[128:129], v[48:49], v[40:41] op_sel:[0,0,0] op_sel_hi:[1,0,1]
v_pk_fma_f32 v[42:43], v[130:131], v[48:49], v[42:43] op_sel:[0,0,0] op_sel_hi:[1,0,1]
v_pk_fma_f32 v[44:45], v[132:133], v[48:49], v[44:45] op_sel:[0,0,0] op_sel_hi:[1,0,1]
v_pk_fma_f32 v[46:47], v[134:135], v[48:49], v[46:47] op_sel:[0,0,0] op_sel_hi:[1,0,1]
v_pk_mul_f32 v[40:41], v[40:41], v[52:53] op_sel:[0,0] op_sel_hi:[1,0]
v_pk_mul_f32 v[42:43], v[42:43], v[52:53] op_sel:[0,0] op_sel_hi:[1,0]
v_pk_mul_f32 v[44:45], v[44:45], v[52:53] op_sel:[0,0] op_sel_hi:[1,0]
v_pk_mul_f32 v[46:47], v[46:47], v[52:53] op_sel:[0,0] op_sel_hi:[1,0]
v_cvt_pk_bf16_f32 v64, v40, v41
v_cvt_pk_bf16_f32 v65, v42, v43
v_cvt_pk_bf16_f32 v66, v44, v45
v_cvt_pk_bf16_f32 v67, v46, v47
s_add_u32 m0, s59, 32768
s_nop 0
buffer_load_dwordx4 v11, s[24:27], s61 offen offset:0 lds
v_accvgpr_read_b32 v40, a32
v_accvgpr_read_b32 v41, a33
v_accvgpr_read_b32 v42, a34
v_accvgpr_read_b32 v43, a35
v_accvgpr_read_b32 v44, a48
v_accvgpr_read_b32 v45, a49
v_accvgpr_read_b32 v46, a50
v_accvgpr_read_b32 v47, a51
v_pk_fma_f32 v[40:41], v[136:137], v[48:49], v[40:41] op_sel:[0,0,0] op_sel_hi:[1,0,1]
v_pk_fma_f32 v[42:43], v[138:139], v[48:49], v[42:43] op_sel:[0,0,0] op_sel_hi:[1,0,1]
v_pk_fma_f32 v[44:45], v[140:141], v[48:49], v[44:45] op_sel:[0,0,0] op_sel_hi:[1,0,1]
v_pk_fma_f32 v[46:47], v[142:143], v[48:49], v[46:47] op_sel:[0,0,0] op_sel_hi:[1,0,1]
v_pk_mul_f32 v[40:41], v[40:41], v[52:53] op_sel:[0,0] op_sel_hi:[1,0]
v_pk_mul_f32 v[42:43], v[42:43], v[52:53] op_sel:[0,0] op_sel_hi:[1,0]
v_pk_mul_f32 v[44:45], v[44:45], v[52:53] op_sel:[0,0] op_sel_hi:[1,0]
v_pk_mul_f32 v[46:47], v[46:47], v[52:53] op_sel:[0,0] op_sel_hi:[1,0]
v_cvt_pk_bf16_f32 v68, v40, v41
v_cvt_pk_bf16_f32 v69, v42, v43
v_cvt_pk_bf16_f32 v70, v44, v45
v_cvt_pk_bf16_f32 v71, v46, v47
buffer_load_dwordx4 v12, s[24:27], s61 offen offset:1024 lds
v_accvgpr_read_b32 v40, a64
v_accvgpr_read_b32 v41, a65
v_accvgpr_read_b32 v42, a66
v_accvgpr_read_b32 v43, a67
v_accvgpr_read_b32 v44, a80
v_accvgpr_read_b32 v45, a81
v_accvgpr_read_b32 v46, a82
v_accvgpr_read_b32 v47, a83
v_pk_fma_f32 v[40:41], v[144:145], v[48:49], v[40:41] op_sel:[0,0,0] op_sel_hi:[1,0,1]
v_pk_fma_f32 v[42:43], v[146:147], v[48:49], v[42:43] op_sel:[0,0,0] op_sel_hi:[1,0,1]
v_pk_fma_f32 v[44:45], v[148:149], v[48:49], v[44:45] op_sel:[0,0,0] op_sel_hi:[1,0,1]
v_pk_fma_f32 v[46:47], v[150:151], v[48:49], v[46:47] op_sel:[0,0,0] op_sel_hi:[1,0,1]
v_pk_mul_f32 v[40:41], v[40:41], v[52:53] op_sel:[0,0] op_sel_hi:[1,0]
v_pk_mul_f32 v[42:43], v[42:43], v[52:53] op_sel:[0,0] op_sel_hi:[1,0]
v_pk_mul_f32 v[44:45], v[44:45], v[52:53] op_sel:[0,0] op_sel_hi:[1,0]
v_pk_mul_f32 v[46:47], v[46:47], v[52:53] op_sel:[0,0] op_sel_hi:[1,0]
v_cvt_pk_bf16_f32 v72, v40, v41
v_cvt_pk_bf16_f32 v73, v42, v43
v_cvt_pk_bf16_f32 v74, v44, v45
v_cvt_pk_bf16_f32 v75, v46, v47
s_add_u32 m0, s59, 40960
s_nop 0
buffer_load_dwordx4 v9, s[20:23], s61 offen offset:0 lds
v_accvgpr_read_b32 v40, a96
v_accvgpr_read_b32 v41, a97
v_accvgpr_read_b32 v42, a98
v_accvgpr_read_b32 v43, a99
v_accvgpr_read_b32 v44, a112
v_accvgpr_read_b32 v45, a113
v_accvgpr_read_b32 v46, a114
v_accvgpr_read_b32 v47, a115
v_pk_fma_f32 v[40:41], v[152:153], v[48:49], v[40:41] op_sel:[0,0,0] op_sel_hi:[1,0,1]
v_pk_fma_f32 v[42:43], v[154:155], v[48:49], v[42:43] op_sel:[0,0,0] op_sel_hi:[1,0,1]
v_pk_fma_f32 v[44:45], v[156:157], v[48:49], v[44:45] op_sel:[0,0,0] op_sel_hi:[1,0,1]
v_pk_fma_f32 v[46:47], v[158:159], v[48:49], v[46:47] op_sel:[0,0,0] op_sel_hi:[1,0,1]
v_pk_mul_f32 v[40:41], v[40:41], v[52:53] op_sel:[0,0] op_sel_hi:[1,0]
v_pk_mul_f32 v[42:43], v[42:43], v[52:53] op_sel:[0,0] op_sel_hi:[1,0]
v_pk_mul_f32 v[44:45], v[44:45], v[52:53] op_sel:[0,0] op_sel_hi:[1,0]
v_pk_mul_f32 v[46:47], v[46:47], v[52:53] op_sel:[0,0] op_sel_hi:[1,0]
v_cvt_pk_bf16_f32 v76, v40, v41
v_cvt_pk_bf16_f32 v77, v42, v43
v_cvt_pk_bf16_f32 v78, v44, v45
v_cvt_pk_bf16_f32 v79, v46, v47
buffer_load_dwordx4 v10, s[20:23], s61 offen offset:1024 lds
s_add_u32 s61, s61, 8192
v_accvgpr_read_b32 v40, a4
v_accvgpr_read_b32 v41, a5
v_accvgpr_read_b32 v42, a6
v_accvgpr_read_b32 v43, a7
v_accvgpr_read_b32 v44, a20
v_accvgpr_read_b32 v45, a21
v_accvgpr_read_b32 v46, a22
v_accvgpr_read_b32 v47, a23
v_pk_fma_f32 v[40:41], v[128:129], v[48:49], v[40:41] op_sel:[0,1,0] op_sel_hi:[1,1,1]
v_pk_fma_f32 v[42:43], v[130:131], v[48:49], v[42:43] op_sel:[0,1,0] op_sel_hi:[1,1,1]
v_pk_fma_f32 v[44:45], v[132:133], v[48:49], v[44:45] op_sel:[0,1,0] op_sel_hi:[1,1,1]
v_pk_fma_f32 v[46:47], v[134:135], v[48:49], v[46:47] op_sel:[0,1,0] op_sel_hi:[1,1,1]
v_pk_mul_f32 v[40:41], v[40:41], v[52:53] op_sel:[0,1] op_sel_hi:[1,1]
v_pk_mul_f32 v[42:43], v[42:43], v[52:53] op_sel:[0,1] op_sel_hi:[1,1]
v_pk_mul_f32 v[44:45], v[44:45], v[52:53] op_sel:[0,1] op_sel_hi:[1,1]
v_pk_mul_f32 v[46:47], v[46:47], v[52:53] op_sel:[0,1] op_sel_hi:[1,1]
v_cvt_pk_bf16_f32 v80, v40, v41
v_cvt_pk_bf16_f32 v81, v42, v43
v_cvt_pk_bf16_f32 v82, v44, v45
v_cvt_pk_bf16_f32 v83, v46, v47
s_add_u32 m0, s59, 49152
s_nop 0
buffer_load_dwordx4 v11, s[24:27], s61 offen offset:0 lds
v_accvgpr_read_b32 v40, a36
v_accvgpr_read_b32 v41, a37
v_accvgpr_read_b32 v42, a38
v_accvgpr_read_b32 v43, a39
v_accvgpr_read_b32 v44, a52
v_accvgpr_read_b32 v45, a53
v_accvgpr_read_b32 v46, a54
v_accvgpr_read_b32 v47, a55
v_pk_fma_f32 v[40:41], v[136:137], v[48:49], v[40:41] op_sel:[0,1,0] op_sel_hi:[1,1,1]
v_pk_fma_f32 v[42:43], v[138:139], v[48:49], v[42:43] op_sel:[0,1,0] op_sel_hi:[1,1,1]
v_pk_fma_f32 v[44:45], v[140:141], v[48:49], v[44:45] op_sel:[0,1,0] op_sel_hi:[1,1,1]
v_pk_fma_f32 v[46:47], v[142:143], v[48:49], v[46:47] op_sel:[0,1,0] op_sel_hi:[1,1,1]
v_pk_mul_f32 v[40:41], v[40:41], v[52:53] op_sel:[0,1] op_sel_hi:[1,1]
v_pk_mul_f32 v[42:43], v[42:43], v[52:53] op_sel:[0,1] op_sel_hi:[1,1]
v_pk_mul_f32 v[44:45], v[44:45], v[52:53] op_sel:[0,1] op_sel_hi:[1,1]
v_pk_mul_f32 v[46:47], v[46:47], v[52:53] op_sel:[0,1] op_sel_hi:[1,1]
v_cvt_pk_bf16_f32 v84, v40, v41
v_cvt_pk_bf16_f32 v85, v42, v43
v_cvt_pk_bf16_f32 v86, v44, v45
v_cvt_pk_bf16_f32 v87, v46, v47
buffer_load_dwordx4 v12, s[24:27], s61 offen offset:1024 lds
v_accvgpr_read_b32 v40, a68
v_accvgpr_read_b32 v41, a69
v_accvgpr_read_b32 v42, a70
v_accvgpr_read_b32 v43, a71
v_accvgpr_read_b32 v44, a84
v_accvgpr_read_b32 v45, a85
v_accvgpr_read_b32 v46, a86
v_accvgpr_read_b32 v47, a87
v_pk_fma_f32 v[40:41], v[144:145], v[48:49], v[40:41] op_sel:[0,1,0] op_sel_hi:[1,1,1]
v_pk_fma_f32 v[42:43], v[146:147], v[48:49], v[42:43] op_sel:[0,1,0] op_sel_hi:[1,1,1]
v_pk_fma_f32 v[44:45], v[148:149], v[48:49], v[44:45] op_sel:[0,1,0] op_sel_hi:[1,1,1]
v_pk_fma_f32 v[46:47], v[150:151], v[48:49], v[46:47] op_sel:[0,1,0] op_sel_hi:[1,1,1]
v_pk_mul_f32 v[40:41], v[40:41], v[52:53] op_sel:[0,1] op_sel_hi:[1,1]
v_pk_mul_f32 v[42:43], v[42:43], v[52:53] op_sel:[0,1] op_sel_hi:[1,1]
v_pk_mul_f32 v[44:45], v[44:45], v[52:53] op_sel:[0,1] op_sel_hi:[1,1]
v_pk_mul_f32 v[46:47], v[46:47], v[52:53] op_sel:[0,1] op_sel_hi:[1,1]
v_cvt_pk_bf16_f32 v88, v40, v41
v_cvt_pk_bf16_f32 v89, v42, v43
v_cvt_pk_bf16_f32 v90, v44, v45
v_cvt_pk_bf16_f32 v91, v46, v47
s_add_u32 m0, s59, 57344
s_nop 0
buffer_load_dwordx4 v9, s[20:23], s61 offen offset:0 lds
v_accvgpr_read_b32 v40, a100
v_accvgpr_read_b32 v41, a101
v_accvgpr_read_b32 v42, a102
v_accvgpr_read_b32 v43, a103
v_accvgpr_read_b32 v44, a116
v_accvgpr_read_b32 v45, a117
v_accvgpr_read_b32 v46, a118
v_accvgpr_read_b32 v47, a119
v_pk_fma_f32 v[40:41], v[152:153], v[48:49], v[40:41] op_sel:[0,1,0] op_sel_hi:[1,1,1]
v_pk_fma_f32 v[42:43], v[154:155], v[48:49], v[42:43] op_sel:[0,1,0] op_sel_hi:[1,1,1]
v_pk_fma_f32 v[44:45], v[156:157], v[48:49], v[44:45] op_sel:[0,1,0] op_sel_hi:[1,1,1]
v_pk_fma_f32 v[46:47], v[158:159], v[48:49], v[46:47] op_sel:[0,1,0] op_sel_hi:[1,1,1]
v_pk_mul_f32 v[40:41], v[40:41], v[52:53] op_sel:[0,1] op_sel_hi:[1,1]
v_pk_mul_f32 v[42:43], v[42:43], v[52:53] op_sel:[0,1] op_sel_hi:[1,1]
v_pk_mul_f32 v[44:45], v[44:45], v[52:53] op_sel:[0,1] op_sel_hi:[1,1]
v_pk_mul_f32 v[46:47], v[46:47], v[52:53] op_sel:[0,1] op_sel_hi:[1,1]
v_cvt_pk_bf16_f32 v92, v40, v41
v_cvt_pk_bf16_f32 v93, v42, v43
v_cvt_pk_bf16_f32 v94, v44, v45
v_cvt_pk_bf16_f32 v95, v46, v47
buffer_load_dwordx4 v10, s[20:23], s61 offen offset:1024 lds
s_add_u32 s61, s61, 8192
v_accvgpr_read_b32 v40, a8
v_accvgpr_read_b32 v41, a9
v_accvgpr_read_b32 v42, a10
v_accvgpr_read_b32 v43, a11
v_accvgpr_read_b32 v44, a24
v_accvgpr_read_b32 v45, a25
v_accvgpr_read_b32 v46, a26
v_accvgpr_read_b32 v47, a27
v_pk_fma_f32 v[40:41], v[128:129], v[50:51], v[40:41] op_sel:[0,0,0] op_sel_hi:[1,0,1]
v_pk_fma_f32 v[42:43], v[130:131], v[50:51], v[42:43] op_sel:[0,0,0] op_sel_hi:[1,0,1]
v_pk_fma_f32 v[44:45], v[132:133], v[50:51], v[44:45] op_sel:[0,0,0] op_sel_hi:[1,0,1]
v_pk_fma_f32 v[46:47], v[134:135], v[50:51], v[46:47] op_sel:[0,0,0] op_sel_hi:[1,0,1]
v_pk_mul_f32 v[40:41], v[40:41], v[54:55] op_sel:[0,0] op_sel_hi:[1,0]
v_pk_mul_f32 v[42:43], v[42:43], v[54:55] op_sel:[0,0] op_sel_hi:[1,0]
v_pk_mul_f32 v[44:45], v[44:45], v[54:55] op_sel:[0,0] op_sel_hi:[1,0]
v_pk_mul_f32 v[46:47], v[46:47], v[54:55] op_sel:[0,0] op_sel_hi:[1,0]
v_cvt_pk_bf16_f32 v96, v40, v41
v_cvt_pk_bf16_f32 v97, v42, v43
v_cvt_pk_bf16_f32 v98, v44, v45
v_cvt_pk_bf16_f32 v99, v46, v47
v_accvgpr_read_b32 v40, a40
v_accvgpr_read_b32 v41, a41
v_accvgpr_read_b32 v42, a42
v_accvgpr_read_b32 v43, a43
v_accvgpr_read_b32 v44, a56
v_accvgpr_read_b32 v45, a57
v_accvgpr_read_b32 v46, a58
v_accvgpr_read_b32 v47, a59
v_pk_fma_f32 v[40:41], v[136:137], v[50:51], v[40:41] op_sel:[0,0,0] op_sel_hi:[1,0,1]
v_pk_fma_f32 v[42:43], v[138:139], v[50:51], v[42:43] op_sel:[0,0,0] op_sel_hi:[1,0,1]
v_pk_fma_f32 v[44:45], v[140:141], v[50:51], v[44:45] op_sel:[0,0,0] op_sel_hi:[1,0,1]
v_pk_fma_f32 v[46:47], v[142:143], v[50:51], v[46:47] op_sel:[0,0,0] op_sel_hi:[1,0,1]
v_pk_mul_f32 v[40:41], v[40:41], v[54:55] op_sel:[0,0] op_sel_hi:[1,0]
v_pk_mul_f32 v[42:43], v[42:43], v[54:55] op_sel:[0,0] op_sel_hi:[1,0]
v_pk_mul_f32 v[44:45], v[44:45], v[54:55] op_sel:[0,0] op_sel_hi:[1,0]
v_pk_mul_f32 v[46:47], v[46:47], v[54:55] op_sel:[0,0] op_sel_hi:[1,0]
v_cvt_pk_bf16_f32 v100, v40, v41
v_cvt_pk_bf16_f32 v101, v42, v43
v_cvt_pk_bf16_f32 v102, v44, v45
v_cvt_pk_bf16_f32 v103, v46, v47
v_accvgpr_read_b32 v40, a72
v_accvgpr_read_b32 v41, a73
v_accvgpr_read_b32 v42, a74
v_accvgpr_read_b32 v43, a75
v_accvgpr_read_b32 v44, a88
v_accvgpr_read_b32 v45, a89
v_accvgpr_read_b32 v46, a90
v_accvgpr_read_b32 v47, a91
v_pk_fma_f32 v[40:41], v[144:145], v[50:51], v[40:41] op_sel:[0,0,0] op_sel_hi:[1,0,1]
v_pk_fma_f32 v[42:43], v[146:147], v[50:51], v[42:43] op_sel:[0,0,0] op_sel_hi:[1,0,1]
v_pk_fma_f32 v[44:45], v[148:149], v[50:51], v[44:45] op_sel:[0,0,0] op_sel_hi:[1,0,1]
v_pk_fma_f32 v[46:47], v[150:151], v[50:51], v[46:47] op_sel:[0,0,0] op_sel_hi:[1,0,1]
v_pk_mul_f32 v[40:41], v[40:41], v[54:55] op_sel:[0,0] op_sel_hi:[1,0]
v_pk_mul_f32 v[42:43], v[42:43], v[54:55] op_sel:[0,0] op_sel_hi:[1,0]
v_pk_mul_f32 v[44:45], v[44:45], v[54:55] op_sel:[0,0] op_sel_hi:[1,0]
v_pk_mul_f32 v[46:47], v[46:47], v[54:55] op_sel:[0,0] op_sel_hi:[1,0]
v_cvt_pk_bf16_f32 v104, v40, v41
v_cvt_pk_bf16_f32 v105, v42, v43
v_cvt_pk_bf16_f32 v106, v44, v45
v_cvt_pk_bf16_f32 v107, v46, v47
v_accvgpr_read_b32 v40, a104
v_accvgpr_read_b32 v41, a105
v_accvgpr_read_b32 v42, a106
v_accvgpr_read_b32 v43, a107
v_accvgpr_read_b32 v44, a120
v_accvgpr_read_b32 v45, a121
v_accvgpr_read_b32 v46, a122
v_accvgpr_read_b32 v47, a123
v_pk_fma_f32 v[40:41], v[152:153], v[50:51], v[40:41] op_sel:[0,0,0] op_sel_hi:[1,0,1]
v_pk_fma_f32 v[42:43], v[154:155], v[50:51], v[42:43] op_sel:[0,0,0] op_sel_hi:[1,0,1]
v_pk_fma_f32 v[44:45], v[156:157], v[50:51], v[44:45] op_sel:[0,0,0] op_sel_hi:[1,0,1]
v_pk_fma_f32 v[46:47], v[158:159], v[50:51], v[46:47] op_sel:[0,0,0] op_sel_hi:[1,0,1]
v_pk_mul_f32 v[40:41], v[40:41], v[54:55] op_sel:[0,0] op_sel_hi:[1,0]
v_pk_mul_f32 v[42:43], v[42:43], v[54:55] op_sel:[0,0] op_sel_hi:[1,0]
v_pk_mul_f32 v[44:45], v[44:45], v[54:55] op_sel:[0,0] op_sel_hi:[1,0]
v_pk_mul_f32 v[46:47], v[46:47], v[54:55] op_sel:[0,0] op_sel_hi:[1,0]
v_cvt_pk_bf16_f32 v108, v40, v41
v_cvt_pk_bf16_f32 v109, v42, v43
v_cvt_pk_bf16_f32 v110, v44, v45
v_cvt_pk_bf16_f32 v111, v46, v47
v_accvgpr_read_b32 v40, a12
v_accvgpr_read_b32 v41, a13
v_accvgpr_read_b32 v42, a14
v_accvgpr_read_b32 v43, a15
v_accvgpr_read_b32 v44, a28
v_accvgpr_read_b32 v45, a29
v_accvgpr_read_b32 v46, a30
v_accvgpr_read_b32 v47, a31
v_pk_fma_f32 v[40:41], v[128:129], v[50:51], v[40:41] op_sel:[0,1,0] op_sel_hi:[1,1,1]
v_pk_fma_f32 v[42:43], v[130:131], v[50:51], v[42:43] op_sel:[0,1,0] op_sel_hi:[1,1,1]
v_pk_fma_f32 v[44:45], v[132:133], v[50:51], v[44:45] op_sel:[0,1,0] op_sel_hi:[1,1,1]
v_pk_fma_f32 v[46:47], v[134:135], v[50:51], v[46:47] op_sel:[0,1,0] op_sel_hi:[1,1,1]
v_pk_mul_f32 v[40:41], v[40:41], v[54:55] op_sel:[0,1] op_sel_hi:[1,1]
v_pk_mul_f32 v[42:43], v[42:43], v[54:55] op_sel:[0,1] op_sel_hi:[1,1]
v_pk_mul_f32 v[44:45], v[44:45], v[54:55] op_sel:[0,1] op_sel_hi:[1,1]
v_pk_mul_f32 v[46:47], v[46:47], v[54:55] op_sel:[0,1] op_sel_hi:[1,1]
v_cvt_pk_bf16_f32 v112, v40, v41
v_cvt_pk_bf16_f32 v113, v42, v43
v_cvt_pk_bf16_f32 v114, v44, v45
v_cvt_pk_bf16_f32 v115, v46, v47
v_accvgpr_read_b32 v40, a44
v_accvgpr_read_b32 v41, a45
v_accvgpr_read_b32 v42, a46
v_accvgpr_read_b32 v43, a47
v_accvgpr_read_b32 v44, a60
v_accvgpr_read_b32 v45, a61
v_accvgpr_read_b32 v46, a62
v_accvgpr_read_b32 v47, a63
v_pk_fma_f32 v[40:41], v[136:137], v[50:51], v[40:41] op_sel:[0,1,0] op_sel_hi:[1,1,1]
v_pk_fma_f32 v[42:43], v[138:139], v[50:51], v[42:43] op_sel:[0,1,0] op_sel_hi:[1,1,1]
v_pk_fma_f32 v[44:45], v[140:141], v[50:51], v[44:45] op_sel:[0,1,0] op_sel_hi:[1,1,1]
v_pk_fma_f32 v[46:47], v[142:143], v[50:51], v[46:47] op_sel:[0,1,0] op_sel_hi:[1,1,1]
v_pk_mul_f32 v[40:41], v[40:41], v[54:55] op_sel:[0,1] op_sel_hi:[1,1]
v_pk_mul_f32 v[42:43], v[42:43], v[54:55] op_sel:[0,1] op_sel_hi:[1,1]
v_pk_mul_f32 v[44:45], v[44:45], v[54:55] op_sel:[0,1] op_sel_hi:[1,1]
v_pk_mul_f32 v[46:47], v[46:47], v[54:55] op_sel:[0,1] op_sel_hi:[1,1]
v_cvt_pk_bf16_f32 v116, v40, v41
v_cvt_pk_bf16_f32 v117, v42, v43
v_cvt_pk_bf16_f32 v118, v44, v45
v_cvt_pk_bf16_f32 v119, v46, v47
v_accvgpr_read_b32 v40, a76
v_accvgpr_read_b32 v41, a77
v_accvgpr_read_b32 v42, a78
v_accvgpr_read_b32 v43, a79
v_accvgpr_read_b32 v44, a92
v_accvgpr_read_b32 v45, a93
v_accvgpr_read_b32 v46, a94
L_pad2:
s_cbranch_execz L_pb0
v_accvgpr_read_b32 v47, a95
v_pk_fma_f32 v[40:41], v[144:145], v[50:51], v[40:41] op_sel:[0,1,0] op_sel_hi:[1,1,1]
v_pk_fma_f32 v[42:43], v[146:147], v[50:51], v[42:43] op_sel:[0,1,0] op_sel_hi:[1,1,1]
v_pk_fma_f32 v[44:45], v[148:149], v[50:51], v[44:45] op_sel:[0,1,0] op_sel_hi:[1,1,1]
v_pk_fma_f32 v[46:47], v[150:151], v[50:51], v[46:47] op_sel:[0,1,0] op_sel_hi:[1,1,1]
v_pk_mul_f32 v[40:41], v[40:41], v[54:55] op_sel:[0,1] op_sel_hi:[1,1]
v_pk_mul_f32 v[42:43], v[42:43], v[54:55] op_sel:[0,1] op_sel_hi:[1,1]
v_pk_mul_f32 v[44:45], v[44:45], v[54:55] op_sel:[0,1] op_sel_hi:[1,1]
v_pk_mul_f32 v[46:47], v[46:47], v[54:55] op_sel:[0,1] op_sel_hi:[1,1]
v_cvt_pk_bf16_f32 v120, v40, v41
v_cvt_pk_bf16_f32 v121, v42, v43
v_cvt_pk_bf16_f32 v122, v44, v45
v_cvt_pk_bf16_f32 v123, v46, v47
v_accvgpr_read_b32 v40, a108
v_accvgpr_read_b32 v41, a109
v_accvgpr_read_b32 v42, a110
v_accvgpr_read_b32 v43, a111
v_accvgpr_read_b32 v44, a124
v_accvgpr_read_b32 v45, a125
v_accvgpr_read_b32 v46, a126
v_accvgpr_read_b32 v47, a127
v_pk_fma_f32 v[40:41], v[152:153], v[50:51], v[40:41] op_sel:[0,1,0] op_sel_hi:[1,1,1]
v_pk_fma_f32 v[42:43], v[154:155], v[50:51], v[42:43] op_sel:[0,1,0] op_sel_hi:[1,1,1]
v_pk_fma_f32 v[44:45], v[156:157], v[50:51], v[44:45] op_sel:[0,1,0] op_sel_hi:[1,1,1]
v_pk_fma_f32 v[46:47], v[158:159], v[50:51], v[46:47] op_sel:[0,1,0] op_sel_hi:[1,1,1]
v_pk_mul_f32 v[40:41], v[40:41], v[54:55] op_sel:[0,1] op_sel_hi:[1,1]
v_pk_mul_f32 v[42:43], v[42:43], v[54:55] op_sel:[0,1] op_sel_hi:[1,1]
v_pk_mul_f32 v[44:45], v[44:45], v[54:55] op_sel:[0,1] op_sel_hi:[1,1]
v_pk_mul_f32 v[46:47], v[46:47], v[54:55] op_sel:[0,1] op_sel_hi:[1,1]
v_cvt_pk_bf16_f32 v124, v40, v41
v_cvt_pk_bf16_f32 v125, v42, v43
v_cvt_pk_bf16_f32 v126, v44, v45
v_cvt_pk_bf16_f32 v127, v46, v47
s_barrier
s_waitcnt lgkmcnt(4)
N v[128:131],a[128:131],v[64:67],0
ds_read_b128 a[152:155], v34 offset:4096
v_lshlrev_b32 v55, 5, v0
M v[128:131],a[132:135],v[68:71]
v_mov_b32 v240, 0x3f803f80
v_mov_b32 v241, 0x3f803f80
N v[136:139],a[132:135],v[84:87],0
v_mov_b32 v242, 0x3f803f80
v_mov_b32 v243, 0x3f803f80
M v[136:139],a[128:131],v[80:83]
v_and_b32 v57, 15, v0
v_lshlrev_b32 v57, 11, v57
N v[144:147],a[128:131],v[96:99],0
ds_read_b128 a[156:159], v35 offset:4096
v_lshl_add_u32 v57, v63, 1, v57
M v[144:147],a[132:135],v[100:103]
v_mul_f32 v40, v224, v224
v_mul_f32 v41, v225, v225
N v[152:155],a[132:135],v[116:119],0
v_mul_f32 v42, v226, v226
v_mul_f32 v43, v227, v227
M v[152:155],a[128:131],v[112:115]
s_waitcnt lgkmcnt(4)
v_mul_f32 v44, v232, v232
v_mul_f32 v45, v233, v233
M v[152:155],a[140:143],v[124:127]
ds_read_b128 a[128:131], v32 offset:8192
v_mul_f32 v46, v234, v234
M v[152:155],a[136:139],v[120:123]
v_mul_f32 v47, v235, v235
v_fma_f32 v40, v40, v248, v246
M v[144:147],a[136:139],v[104:107]
v_fma_f32 v41, v41, v248, v246
v_fma_f32 v42, v42, v248, v246
M v[144:147],a[140:143],v[108:111]
v_fma_f32 v43, v43, v248, v246
v_fma_f32 v44, v44, v248, v246
M v[136:139],a[140:143],v[92:95]
ds_read_b128 a[132:135], v33 offset:8192
v_fma_f32 v45, v45, v248, v246
M v[136:139],a[136:139],v[88:91]
v_fma_f32 v46, v46, v248, v246
v_fma_f32 v47, v47, v248, v246
M v[128:131],a[136:139],v[72:75]
v_mul_f32 v40, v40, v224
v_mul_f32 v41, v41, v225
M v[128:131],a[140:143],v[76:79]
s_waitcnt lgkmcnt(4)
v_exp_f32 v40, v40
N v[132:135],a[144:147],v[64:67],0
ds_read_b128 a[136:139], v34 offset:8192
v_mul_f32 v42, v42, v226
M v[132:135],a[148:151],v[68:71]
v_exp_f32 v41, v41
N v[140:143],a[148:151],v[84:87],0
v_exp_f32 v42, v42
M v[140:143],a[144:147],v[80:83]
v_mul_f32 v43, v43, v227
v_mul_f32 v44, v44, v232
N v[148:151],a[144:147],v[96:99],0
ds_read_b128 a[140:143], v35 offset:8192
v_mul_f32 v45, v45, v233
M v[148:151],a[148:151],v[100:103]
v_exp_f32 v43, v43
N v[156:159],a[148:151],v[116:119],0
v_exp_f32 v44, v44
M v[156:159],a[144:147],v[112:115]
s_waitcnt lgkmcnt(4)
v_exp_f32 v45, v45
M v[156:159],a[156:159],v[124:127]
ds_read_b128 a[144:147], v32 offset:12288
v_mul_f32 v46, v46, v234
M v[156:159],a[152:155],v[120:123]
v_exp_f32 v46, v46
M v[148:151],a[152:155],v[104:107]
v_mul_f32 v47, v47, v235
v_fma_f32 v40, v40, v244, v244
M v[148:151],a[156:159],v[108:111]
v_exp_f32 v47, v47
M v[140:143],a[156:159],v[92:95]
ds_read_b128 a[148:151], v33 offset:12288
v_fma_f32 v41, v41, v244, v244
M v[140:143],a[152:155],v[88:91]
v_rcp_f32 v40, v40
M v[132:135],a[152:155],v[72:75]
v_rcp_f32 v41, v41
M v[132:135],a[156:159],v[76:79]
s_waitcnt lgkmcnt(4)
v_fma_f32 v42, v42, v244, v244
v_fma_f32 v43, v43, v244, v244
N v[160:163],a[128:131],v[64:67],0
ds_read_b128 a[152:155], v34 offset:12288
v_max3_f32 v192, v128, v129, v130
M v[160:163],a[132:135],v[68:71]
v_max3_f32 v196, v136, v137, v138
v_max3_f32 v192, v192, v131, v132
N v[168:171],a[132:135],v[84:87],0
v_max3_f32 v192, v192, v133, v134
v_max_f32 v192, v192, v135
M v[168:171],a[128:131],v[80:83]
v_max3_f32 v196, v196, v139, v140
v_max3_f32 v196, v196, v141, v142
N v[176:179],a[128:131],v[96:99],0
ds_read_b128 a[156:159], v35 offset:12288
v_max_f32 v196, v196, v143
M v[176:179],a[132:135],v[100:103]
v_max3_f32 v200, v144, v145, v146
v_max3_f32 v200, v200, v147, v148
N v[184:187],a[132:135],v[116:119],0
v_max3_f32 v200, v200, v149, v150
v_max_f32 v200, v200, v151
M v[184:187],a[128:131],v[112:115]
s_waitcnt lgkmcnt(4)
v_max3_f32 v204, v152, v153, v154
v_max3_f32 v204, v204, v155, v156
M v[184:187],a[140:143],v[124:127]
T a[128:129],v16,16384
T a[130:131],v16,20480
M v[184:187],a[136:139],v[120:123]
v_max3_f32 v204, v204, v157, v158
v_max_f32 v204, v204, v159
M v[176:179],a[136:139],v[104:107]
v_mov_b32 v193, v192
v_mov_b32 v197, v196
M v[176:179],a[140:143],v[108:111]
v_mov_b32 v201, v200
v_mov_b32 v205, v204
M v[168:171],a[140:143],v[92:95]
T a[132:133],v17,16384
T a[134:135],v17,20480
M v[168:171],a[136:139],v[88:91]
v_permlane32_swap_b32 v192, v193
v_permlane32_swap_b32 v196, v197
M v[160:163],a[136:139],v[72:75]
v_permlane32_swap_b32 v200, v201
v_permlane32_swap_b32 v204, v205
M v[160:163],a[140:143],v[76:79]
s_waitcnt lgkmcnt(6)
v_max_f32 v192, v192, v193
v_max_f32 v196, v196, v197
N v[164:167],a[144:147],v[64:67],0
T a[136:137],v18,16384
T a[138:139],v18,20480
M v[164:167],a[148:151],v[68:71]
v_max_f32 v200, v200, v201
v_max_f32 v204, v204, v205
N v[172:175],a[148:151],v[84:87],0
v_mov_b32 v193, v192
v_mov_b32 v197, v196
M v[172:175],a[144:147],v[80:83]
v_mov_b32 v201, v200
v_mov_b32 v205, v204
N v[180:183],a[144:147],v[96:99],0
T a[140:141],v19,16384
T a[142:143],v19,20480
M v[180:183],a[148:151],v[100:103]
v_permlane16_swap_b32 v192, v193
v_permlane16_swap_b32 v196, v197
N v[188:191],a[148:151],v[116:119],0
v_permlane16_swap_b32 v200, v201
v_permlane16_swap_b32 v204, v205
M v[188:191],a[144:147],v[112:115]
s_waitcnt lgkmcnt(8)
v_max_f32 v192, v192, v193
v_max_f32 v196, v196, v197
M v[188:191],a[156:159],v[124:127]
T a[144:145],v20,16384
T a[146:147],v20,20480
M v[188:191],a[152:155],v[120:123]
v_max_f32 v200, v200, v201
v_max_f32 v204, v204, v205
M v[180:183],a[152:155],v[104:107]
v_sub_f32 v195, 0, v192
v_sub_f32 v194, 0, v192
M v[180:183],a[156:159],v[108:111]
v_sub_f32 v193, 0, v192
v_sub_f32 v192, 0, v192
M v[172:175],a[156:159],v[92:95]
T a[148:149],v21,16384
T a[150:151],v21,20480
M v[172:175],a[152:155],v[88:91]
s_add_u32 m0, s59, 65536
v_sub_f32 v199, 0, v196
v_sub_f32 v198, 0, v196
M v[164:167],a[152:155],v[72:75]
buffer_load_dwordx4 v11, s[24:27], s61 offen offset:0 lds
v_sub_f32 v197, 0, v196
M v[164:167],a[156:159],v[76:79]
v_sub_f32 v196, 0, v196
v_sub_f32 v203, 0, v200
v_sub_f32 v202, 0, v200
v_sub_f32 v201, 0, v200
v_sub_f32 v200, 0, v200
v_sub_f32 v207, 0, v204
v_sub_f32 v206, 0, v204
v_sub_f32 v205, 0, v204
v_sub_f32 v204, 0, v204
v_add_f32 v128, v128, v192
v_exp_f32 v128, v128
v_add_f32 v129, v129, v192
v_exp_f32 v129, v129
v_add_f32 v130, v130, v192
v_cvt_pk_bf16_f32 v128, v128, v129
v_exp_f32 v130, v130
v_add_f32 v131, v131, v192
v_exp_f32 v131, v131
v_add_f32 v132, v132, v192
v_cvt_pk_bf16_f32 v129, v130, v131
v_exp_f32 v132, v132
v_add_f32 v133, v133, v192
v_exp_f32 v133, v133
v_add_f32 v134, v134, v192
v_cvt_pk_bf16_f32 v130, v132, v133
v_exp_f32 v134, v134
v_add_f32 v135, v135, v192
v_exp_f32 v135, v135
v_add_f32 v136, v136, v196
v_cvt_pk_bf16_f32 v131, v134, v135
v_exp_f32 v136, v136
v_add_f32 v137, v137, v196
v_exp_f32 v137, v137
v_add_f32 v138, v138, v196
v_cvt_pk_bf16_f32 v136, v136, v137
v_exp_f32 v138, v138
v_add_f32 v139, v139, v196
v_exp_f32 v139, v139
v_add_f32 v140, v140, v196
v_cvt_pk_bf16_f32 v137, v138, v139
v_exp_f32 v140, v140
v_add_f32 v141, v141, v196
v_exp_f32 v141, v141
v_add_f32 v142, v142, v196
v_cvt_pk_bf16_f32 v138, v140, v141
v_exp_f32 v142, v142
v_add_f32 v143, v143, v196
v_exp_f32 v143, v143
v_add_f32 v144, v144, v200
v_cvt_pk_bf16_f32 v139, v142, v143
v_exp_f32 v144, v144
v_add_f32 v145, v145, v200
v_exp_f32 v145, v145
v_add_f32 v146, v146, v200
v_cvt_pk_bf16_f32 v144, v144, v145
v_exp_f32 v146, v146
v_add_f32 v147, v147, v200
v_exp_f32 v147, v147
v_add_f32 v148, v148, v200
v_cvt_pk_bf16_f32 v145, v146, v147
v_exp_f32 v148, v148
v_add_f32 v149, v149, v200
v_exp_f32 v149, v149
v_add_f32 v150, v150, v200
v_cvt_pk_bf16_f32 v146, v148, v149
v_exp_f32 v150, v150
v_add_f32 v151, v151, v200
v_exp_f32 v151, v151
v_add_f32 v152, v152, v204
v_cvt_pk_bf16_f32 v147, v150, v151
v_exp_f32 v152, v152
v_add_f32 v153, v153, v204
v_exp_f32 v153, v153
v_add_f32 v154, v154, v204
v_cvt_pk_bf16_f32 v152, v152, v153
v_exp_f32 v154, v154
v_add_f32 v155, v155, v204
v_exp_f32 v155, v155
v_add_f32 v156, v156, v204
v_cvt_pk_bf16_f32 v153, v154, v155
v_exp_f32 v156, v156
v_add_f32 v157, v157, v204
v_exp_f32 v157, v157
v_add_f32 v158, v158, v204
v_cvt_pk_bf16_f32 v154, v156, v157
v_exp_f32 v158, v158
v_add_f32 v159, v159, v204
v_exp_f32 v159, v159
s_nop 0
v_cvt_pk_bf16_f32 v155, v158, v159
s_waitcnt lgkmcnt(8)
N a[0:3],a[128:131],v[128:131],0
T a[152:153],v22,16384
T a[154:155],v22,20480
N a[4:7],a[128:131],v[136:139],0
v_add_f32 v160, v160, v192
v_add_f32 v161, v161, v192
N a[8:11],a[128:131],v[144:147],0
v_exp_f32 v160, v160
N a[12:15],a[128:131],v[152:155],0
buffer_load_dwordx4 v12, s[24:27], s61 offen offset:1024 lds
v_add_f32 v162, v162, v192
N a[28:31],a[132:135],v[152:155],0
T a[156:157],v23,16384
T a[158:159],v23,20480
N a[24:27],a[132:135],v[144:147],0
s_add_u32 m0, s59, 73728
v_exp_f32 v161, v161
N a[20:23],a[132:135],v[136:139],0
buffer_load_dwordx4 v9, s[20:23], s61 offen offset:0 lds
v_cvt_pk_bf16_f32 v160, v160, v161
N a[16:19],a[132:135],v[128:131],0
s_waitcnt lgkmcnt(8)
v_exp_f32 v162, v162
N a[32:35],a[136:139],v[128:131],0
ds_read_b128 a[128:131], v32 offset:24576
v_add_f32 v163, v163, v192
N a[36:39],a[136:139],v[136:139],0
v_exp_f32 v163, v163
N a[40:43],a[136:139],v[144:147],0
v_cvt_pk_bf16_f32 v161, v162, v163
v_add_f32 v164, v164, v192
N a[44:47],a[136:139],v[152:155],0
buffer_load_dwordx4 v10, s[20:23], s61 offen offset:1024 lds
v_add_f32 v165, v165, v192
N a[60:63],a[140:143],v[152:155],0
s_add_u32 s61, s61, 8192
ds_read_b128 a[132:135], v33 offset:24576
v_add_f32 v166, v166, v192
N a[56:59],a[140:143],v[144:147],0
s_add_u32 m0, s59, 81920
v_exp_f32 v164, v164
N a[52:55],a[140:143],v[136:139],0
buffer_load_dwordx4 v11, s[24:27], s61 offen offset:0 lds
v_add_f32 v167, v167, v192
N a[48:51],a[140:143],v[128:131],0
s_waitcnt lgkmcnt(6)
v_exp_f32 v165, v165
N a[64:67],a[144:147],v[128:131],0
ds_read_b128 a[136:139], v34 offset:24576
v_cvt_pk_bf16_f32 v162, v164, v165
N a[68:71],a[144:147],v[136:139],0
v_exp_f32 v166, v166
N a[72:75],a[144:147],v[144:147],0
v_exp_f32 v167, v167
N a[76:79],a[144:147],v[152:155],0
buffer_load_dwordx4 v12, s[24:27], s61 offen offset:1024 lds
v_cvt_pk_bf16_f32 v163, v166, v167
N a[92:95],a[148:151],v[152:155],0
ds_read_b128 a[140:143], v35 offset:24576
v_add_f32 v168, v168, v196
N a[88:91],a[148:151],v[144:147],0
s_add_u32 m0, s59, 90112
v_exp_f32 v168, v168
N a[84:87],a[148:151],v[136:139],0
buffer_load_dwordx4 v9, s[20:23], s61 offen offset:0 lds
v_add_f32 v169, v169, v196
N a[80:83],a[148:151],v[128:131],0
s_waitcnt lgkmcnt(4)
v_exp_f32 v169, v169
N a[96:99],a[152:155],v[128:131],0
ds_read_b128 a[144:147], v32 offset:28672
v_cvt_pk_bf16_f32 v168, v168, v169
N a[100:103],a[152:155],v[136:139],0
v_add_f32 v170, v170, v196
v_add_f32 v171, v171, v196
N a[104:107],a[152:155],v[144:147],0
v_exp_f32 v170, v170
N a[108:111],a[152:155],v[152:155],0
buffer_load_dwordx4 v10, s[20:23], s61 offen offset:1024 lds
v_add_f32 v172, v172, v196
N a[124:127],a[156:159],v[152:155],0
s_add_u32 s61, s61, 8192
ds_read_b128 a[148:151], v33 offset:28672
v_add_f32 v173, v173, v196
N a[120:123],a[156:159],v[144:147],0
s_add_u32 m0, s59, 98304
v_exp_f32 v171, v171
N a[116:119],a[156:159],v[136:139],0
buffer_load_dwordx4 v11, s[24:27], s61 offen offset:0 lds
v_cvt_pk_bf16_f32 v169, v170, v171
N a[112:115],a[156:159],v[128:131],0
v_exp_f32 v172, v172
N v[208:211],v[240:243],v[128:131],0
v_exp_f32 v173, v173
N v[212:215],v[240:243],v[136:139],0
v_cvt_pk_bf16_f32 v170, v172, v173
v_add_f32 v174, v174, v196
N v[216:219],v[240:243],v[144:147],0
v_exp_f32 v174, v174
N v[220:223],v[240:243],v[152:155],0
s_waitcnt lgkmcnt(4)
v_add_f32 v175, v175, v196
v_add_f32 v176, v176, v200
N v[128:131],a[128:131],v[64:67],v[192:195]
ds_read_b128 a[152:155], v34 offset:28672
v_add_f32 v177, v177, v200
M v[128:131],a[132:135],v[68:71]
v_exp_f32 v175, v175
N v[136:139],a[132:135],v[84:87],v[196:199]
v_exp_f32 v176, v176
M v[136:139],a[128:131],v[80:83]
v_exp_f32 v177, v177
N v[144:147],a[128:131],v[96:99],v[200:203]
ds_read_b128 a[156:159], v35 offset:28672
v_cvt_pk_bf16_f32 v171, v174, v175
M v[144:147],a[132:135],v[100:103]
v_cvt_pk_bf16_f32 v176, v176, v177
v_add_f32 v178, v178, v200
N v[152:155],a[132:135],v[116:119],v[204:207]
buffer_load_dwordx4 v12, s[24:27], s61 offen offset:1024 lds
v_add_f32 v179, v179, v200
M v[152:155],a[128:131],v[112:115]
s_waitcnt vmcnt(10)
s_barrier
s_waitcnt lgkmcnt(4)
M v[152:155],a[140:143],v[124:127]
T a[128:129],v16,32768
T a[130:131],v16,36864
M v[152:155],a[136:139],v[120:123]
v_exp_f32 v178, v178
M v[144:147],a[136:139],v[104:107]
v_exp_f32 v179, v179
M v[144:147],a[140:143],v[108:111]
v_cvt_pk_bf16_f32 v177, v178, v179
v_add_f32 v180, v180, v200
M v[136:139],a[140:143],v[92:95]
T a[132:133],v17,32768
T a[134:135],v17,36864
M v[136:139],a[136:139],v[88:91]
s_add_u32 m0, s59, 106496
v_exp_f32 v180, v180
M v[128:131],a[136:139],v[72:75]
buffer_load_dwordx4 v9, s[20:23], s61 offen offset:0 lds
v_add_f32 v181, v181, v200
M v[128:131],a[140:143],v[76:79]
s_waitcnt lgkmcnt(6)
v_exp_f32 v181, v181
N v[132:135],a[144:147],v[64:67],v[192:195]
T a[136:137],v18,32768
T a[138:139],v18,36864
M v[132:135],a[148:151],v[68:71]
v_cvt_pk_bf16_f32 v178, v180, v181
v_add_f32 v182, v182, v200
N v[140:143],a[148:151],v[84:87],v[196:199]
v_exp_f32 v182, v182
M v[140:143],a[144:147],v[80:83]
v_add_f32 v183, v183, v200
v_add_f32 v184, v184, v204
N v[148:151],a[144:147],v[96:99],v[200:203]
T a[140:141],v19,32768
T a[142:143],v19,36864
M v[148:151],a[148:151],v[100:103]
v_exp_f32 v183, v183
N v[156:159],a[148:151],v[116:119],v[204:207]
buffer_load_dwordx4 v10, s[20:23], s61 offen offset:1024 lds
v_cvt_pk_bf16_f32 v179, v182, v183
M v[156:159],a[144:147],v[112:115]
s_waitcnt lgkmcnt(8)
v_exp_f32 v184, v184
M v[156:159],a[156:159],v[124:127]
s_add_u32 s61, s61, 8192
T a[144:145],v20,32768
T a[146:147],v20,36864
M v[156:159],a[152:155],v[120:123]
v_add_f32 v185, v185, v204
v_add_f32 v186, v186, v204
M v[148:151],a[152:155],v[104:107]
v_exp_f32 v185, v185
M v[148:151],a[156:159],v[108:111]
v_exp_f32 v186, v186
M v[140:143],a[156:159],v[92:95]
T a[148:149],v21,32768
T a[150:151],v21,36864
M v[140:143],a[152:155],v[88:91]
s_add_u32 m0, s59, 114688
v_cvt_pk_bf16_f32 v184, v184, v185
v_add_f32 v187, v187, v204
M v[132:135],a[152:155],v[72:75]
buffer_load_dwordx4 v11, s[24:27], s61 offen offset:0 lds
v_add_f32 v188, v188, v204
M v[132:135],a[156:159],v[76:79]
v_exp_f32 v187, v187
v_exp_f32 v188, v188
v_cvt_pk_bf16_f32 v185, v186, v187
v_add_f32 v189, v189, v204
v_exp_f32 v189, v189
v_add_f32 v190, v190, v204
v_cvt_pk_bf16_f32 v186, v188, v189
v_exp_f32 v190, v190
v_add_f32 v191, v191, v204
v_exp_f32 v191, v191
s_nop 0
v_cvt_pk_bf16_f32 v187, v190, v191
s_barrier
s_waitcnt lgkmcnt(8)
M a[0:3],a[128:131],v[160:163]
T a[152:153],v22,32768
T a[154:155],v22,36864
M a[4:7],a[128:131],v[168:171]
v_exp_f32 v128, v128
M a[8:11],a[128:131],v[176:179]
v_exp_f32 v129, v129
M a[12:15],a[128:131],v[184:187]
buffer_load_dwordx4 v12, s[24:27], s61 offen offset:1024 lds
v_cvt_pk_bf16_f32 v128, v128, v129
M a[28:31],a[132:135],v[184:187]
T a[156:157],v23,32768
T a[158:159],v23,36864
M a[24:27],a[132:135],v[176:179]
s_add_u32 m0, s59, 122880
v_exp_f32 v130, v130
M a[20:23],a[132:135],v[168:171]
buffer_load_dwordx4 v9, s[20:23], s61 offen offset:0 lds
v_fma_f32 v44, v44, v244, v244
M a[16:19],a[132:135],v[160:163]
s_waitcnt lgkmcnt(8)
v_exp_f32 v131, v131
M a[32:35],a[136:139],v[160:163]
ds_read_b128 a[128:131], v32 offset:40960
v_cvt_pk_bf16_f32 v129, v130, v131
M a[36:39],a[136:139],v[168:171]
v_exp_f32 v132, v132
M a[40:43],a[136:139],v[176:179]
v_exp_f32 v133, v133
M a[44:47],a[136:139],v[184:187]
buffer_load_dwordx4 v10, s[20:23], s61 offen offset:1024 lds
v_cvt_pk_bf16_f32 v130, v132, v133
M a[60:63],a[140:143],v[184:187]
s_add_u32 s61, s61, 8192
ds_read_b128 a[132:135], v33 offset:40960
v_fma_f32 v45, v45, v244, v244
M a[56:59],a[140:143],v[176:179]
s_add_u32 m0, s59, 0
v_exp_f32 v134, v134
M a[52:55],a[140:143],v[168:171]
buffer_load_dwordx4 v11, s[24:27], s61 offen offset:0 lds
v_fma_f32 v46, v46, v244, v244
M a[48:51],a[140:143],v[160:163]
s_waitcnt lgkmcnt(6)
v_exp_f32 v135, v135
M a[64:67],a[144:147],v[160:163]
ds_read_b128 a[136:139], v34 offset:40960
v_cvt_pk_bf16_f32 v131, v134, v135
M a[68:71],a[144:147],v[168:171]
v_exp_f32 v136, v136
M a[72:75],a[144:147],v[176:179]
v_exp_f32 v137, v137
M a[76:79],a[144:147],v[184:187]
v_exp_f32 v138, v138
M a[92:95],a[148:151],v[184:187]
ds_read_b128 a[140:143], v35 offset:40960
v_cvt_pk_bf16_f32 v136, v136, v137
M a[88:91],a[148:151],v[176:179]
v_exp_f32 v139, v139
M a[84:87],a[148:151],v[168:171]
buffer_load_dwordx4 v12, s[24:27], s61 offen offset:1024 lds
v_cvt_pk_bf16_f32 v137, v138, v139
M a[80:83],a[148:151],v[160:163]
s_waitcnt lgkmcnt(4)
v_exp_f32 v140, v140
M a[96:99],a[152:155],v[160:163]
ds_read_b128 a[144:147], v32 offset:45056
v_fma_f32 v47, v47, v244, v244
M a[100:103],a[152:155],v[168:171]
v_exp_f32 v141, v141
M a[104:107],a[152:155],v[176:179]
v_exp_f32 v142, v142
M a[108:111],a[152:155],v[184:187]
v_exp_f32 v143, v143
M a[124:127],a[156:159],v[184:187]
ds_read_b128 a[148:151], v33 offset:45056
v_cvt_pk_bf16_f32 v138, v140, v141
M a[120:123],a[156:159],v[176:179]
s_add_u32 m0, s59, 8192
v_exp_f32 v144, v144
M a[116:119],a[156:159],v[168:171]
buffer_load_dwordx4 v9, s[20:23], s61 offen offset:0 lds
v_cvt_pk_bf16_f32 v139, v142, v143
M a[112:115],a[156:159],v[160:163]
v_exp_f32 v145, v145
M v[208:211],v[240:243],v[160:163]
v_exp_f32 v146, v146
M v[212:215],v[240:243],v[168:171]
v_exp_f32 v147, v147
M v[216:219],v[240:243],v[176:179]
v_exp_f32 v148, v148
M v[220:223],v[240:243],v[184:187]
s_waitcnt lgkmcnt(4)
v_exp_f32 v149, v149
N v[160:163],a[128:131],v[64:67],v[192:195]
ds_read_b128 a[152:155], v34 offset:45056
v_cvt_pk_bf16_f32 v144, v144, v145
M v[160:163],a[132:135],v[68:71]
v_exp_f32 v150, v150
N v[168:171],a[132:135],v[84:87],v[196:199]
v_exp_f32 v151, v151
M v[168:171],a[128:131],v[80:83]
v_exp_f32 v152, v152
N v[176:179],a[128:131],v[96:99],v[200:203]
ds_read_b128 a[156:159], v35 offset:45056
v_cvt_pk_bf16_f32 v145, v146, v147
M v[176:179],a[132:135],v[100:103]
v_exp_f32 v153, v153
N v[184:187],a[132:135],v[116:119],v[204:207]
buffer_load_dwordx4 v10, s[20:23], s61 offen offset:1024 lds
v_cvt_pk_bf16_f32 v146, v148, v149
M v[184:187],a[128:131],v[112:115]
s_waitcnt lgkmcnt(4)
v_exp_f32 v154, v154
M v[184:187],a[140:143],v[124:127]
s_add_u32 s61, s61, 8192
T a[128:129],v16,49152
T a[130:131],v16,53248
M v[184:187],a[136:139],v[120:123]
v_exp_f32 v155, v155
M v[176:179],a[136:139],v[104:107]
v_exp_f32 v156, v156
M v[176:179],a[140:143],v[108:111]
L_pad3:
s_cbranch_execz L_pb0
v_exp_f32 v157, v157
M v[168:171],a[140:143],v[92:95]
T a[132:133],v17,49152
T a[134:135],v17,53248
M v[168:171],a[136:139],v[88:91]
s_add_u32 m0, s59, 16384
v_exp_f32 v158, v158
M v[160:163],a[136:139],v[72:75]
buffer_load_dwordx4 v11, s[24:27], s61 offen offset:0 lds
v_cvt_pk_bf16_f32 v147, v150, v151
M v[160:163],a[140:143],v[76:79]
s_waitcnt lgkmcnt(6)
v_exp_f32 v159, v159
N v[164:167],a[144:147],v[64:67],v[192:195]
T a[136:137],v18,49152
T a[138:139],v18,53248
M v[164:167],a[148:151],v[68:71]
v_cvt_pk_bf16_f32 v152, v152, v153
v_cvt_pk_bf16_f32 v153, v154, v155
N v[172:175],a[148:151],v[84:87],v[196:199]
v_cvt_pk_bf16_f32 v154, v156, v157
v_cvt_pk_bf16_f32 v155, v158, v159
M v[172:175],a[144:147],v[80:83]
v_rcp_f32 v42, v42
N v[180:183],a[144:147],v[96:99],v[200:203]
T a[140:141],v19,49152
T a[142:143],v19,53248
M v[180:183],a[148:151],v[100:103]
v_rcp_f32 v43, v43
N v[188:191],a[148:151],v[116:119],v[204:207]
buffer_load_dwordx4 v12, s[24:27], s61 offen offset:1024 lds
v_mul_f32 v224, v40, v224
M v[188:191],a[144:147],v[112:115]
s_waitcnt lgkmcnt(8)
v_rcp_f32 v44, v44
M v[188:191],a[156:159],v[124:127]
T a[144:145],v20,49152
T a[146:147],v20,53248
M v[188:191],a[152:155],v[120:123]
v_rcp_f32 v45, v45
M v[180:183],a[152:155],v[104:107]
v_rcp_f32 v46, v46
M v[180:183],a[156:159],v[108:111]
v_rcp_f32 v47, v47
M v[172:175],a[156:159],v[92:95]
T a[148:149],v21,49152
T a[150:151],v21,53248
M v[172:175],a[152:155],v[88:91]
s_add_u32 m0, s59, 24576
v_mul_f32 v225, v41, v225
v_mul_f32 v226, v42, v226
M v[164:167],a[152:155],v[72:75]
buffer_load_dwordx4 v9, s[20:23], s61 offen offset:0 lds
v_mul_f32 v227, v43, v227
M v[164:167],a[156:159],v[76:79]
s_waitcnt lgkmcnt(8)
v_mul_f32 v232, v44, v232
v_mul_f32 v233, v45, v233
M a[0:3],a[128:131],v[128:131]
T a[152:153],v22,49152
T a[154:155],v22,53248
M a[4:7],a[128:131],v[136:139]
v_exp_f32 v160, v160
M a[8:11],a[128:131],v[144:147]
v_exp_f32 v161, v161
M a[12:15],a[128:131],v[152:155]
v_exp_f32 v162, v162
M a[28:31],a[132:135],v[152:155]
T a[156:157],v23,49152
T a[158:159],v23,53248
M a[24:27],a[132:135],v[144:147]
v_exp_f32 v163, v163
M a[20:23],a[132:135],v[136:139]
buffer_load_dwordx4 v10, s[20:23], s61 offen offset:1024 lds
v_cvt_pk_bf16_f32 v160, v160, v161
M a[16:19],a[132:135],v[128:131]
s_waitcnt lgkmcnt(8)
v_exp_f32 v164, v164
M a[32:35],a[136:139],v[128:131]
s_add_u32 s61, s61, 8192
ds_read_b128 a[128:131], v32 offset:57344
v_cvt_pk_bf16_f32 v161, v162, v163
M a[36:39],a[136:139],v[136:139]
v_exp_f32 v165, v165
M a[40:43],a[136:139],v[144:147]
v_exp_f32 v166, v166
M a[44:47],a[136:139],v[152:155]
v_exp_f32 v167, v167
M a[60:63],a[140:143],v[152:155]
ds_read_b128 a[132:135], v33 offset:57344
v_cvt_pk_bf16_f32 v162, v164, v165
M a[56:59],a[140:143],v[144:147]
v_exp_f32 v168, v168
M a[52:55],a[140:143],v[136:139]
buffer_load_dword v56, v55, s[32:35], s78 offen
v_cvt_pk_bf16_f32 v163, v166, v167
M a[48:51],a[140:143],v[128:131]
s_waitcnt lgkmcnt(6)
v_exp_f32 v169, v169
M a[64:67],a[144:147],v[128:131]
s_add_u32 s78, s78, 2048
ds_read_b128 a[136:139], v34 offset:57344
v_cvt_pk_bf16_f32 v168, v168, v169
M a[68:71],a[144:147],v[136:139]
v_exp_f32 v170, v170
M a[72:75],a[144:147],v[144:147]
v_exp_f32 v171, v171
M a[76:79],a[144:147],v[152:155]
v_exp_f32 v172, v172
M a[92:95],a[148:151],v[152:155]
ds_read_b128 a[140:143], v35 offset:57344
v_cvt_pk_bf16_f32 v169, v170, v171
M a[88:91],a[148:151],v[144:147]
v_exp_f32 v173, v173
M a[84:87],a[148:151],v[136:139]
buffer_load_dword v56, v55, s[32:35], s78 offen
v_cvt_pk_bf16_f32 v170, v172, v173
M a[80:83],a[148:151],v[128:131]
s_waitcnt lgkmcnt(4)
v_exp_f32 v174, v174
M a[96:99],a[152:155],v[128:131]
s_add_u32 s78, s78, 2048
ds_read_b128 a[144:147], v32 offset:61440
v_mul_f32 v234, v46, v234
M a[100:103],a[152:155],v[136:139]
v_exp_f32 v175, v175
M a[104:107],a[152:155],v[144:147]
v_exp_f32 v176, v176
M a[108:111],a[152:155],v[152:155]
v_exp_f32 v177, v177
M a[124:127],a[156:159],v[152:155]
ds_read_b128 a[148:151], v33 offset:61440
v_cvt_pk_bf16_f32 v171, v174, v175
M a[120:123],a[156:159],v[144:147]
v_exp_f32 v178, v178
M a[116:119],a[156:159],v[136:139]
buffer_load_dword v56, v55, s[32:35], s78 offen
v_cvt_pk_bf16_f32 v176, v176, v177
M a[112:115],a[156:159],v[128:131]
v_exp_f32 v179, v179
M v[208:211],v[240:243],v[128:131]
s_add_u32 s78, s78, 2048
v_exp_f32 v180, v180
M v[212:215],v[240:243],v[136:139]
v_exp_f32 v181, v181
M v[216:219],v[240:243],v[144:147]
v_exp_f32 v182, v182
M v[220:223],v[240:243],v[152:155]
s_waitcnt lgkmcnt(4)
v_exp_f32 v183, v183
N v[128:131],a[128:131],v[64:67],v[192:195]
ds_read_b128 a[152:155], v34 offset:61440
v_cvt_pk_bf16_f32 v177, v178, v179
M v[128:131],a[132:135],v[68:71]
v_exp_f32 v184, v184
N v[136:139],a[132:135],v[84:87],v[196:199]
v_exp_f32 v185, v185
M v[136:139],a[128:131],v[80:83]
v_exp_f32 v186, v186
N v[144:147],a[128:131],v[96:99],v[200:203]
ds_read_b128 a[156:159], v35 offset:61440
v_cvt_pk_bf16_f32 v178, v180, v181
M v[144:147],a[132:135],v[100:103]
v_exp_f32 v187, v187
N v[152:155],a[132:135],v[116:119],v[204:207]
buffer_load_dword v56, v55, s[32:35], s78 offen
v_cvt_pk_bf16_f32 v179, v182, v183
M v[152:155],a[128:131],v[112:115]
s_waitcnt vmcnt(20)
s_barrier
s_waitcnt lgkmcnt(4)
M v[152:155],a[140:143],v[124:127]
s_add_u32 s78, s78, 2048
T a[128:129],v24,0
T a[130:131],v24,4096
M v[152:155],a[136:139],v[120:123]
v_exp_f32 v188, v188
M v[144:147],a[136:139],v[104:107]
v_exp_f32 v189, v189
M v[144:147],a[140:143],v[108:111]
v_exp_f32 v190, v190
M v[136:139],a[140:143],v[92:95]
T a[132:133],v25,0
T a[134:135],v25,4096
M v[136:139],a[136:139],v[88:91]
v_exp_f32 v191, v191
M v[128:131],a[136:139],v[72:75]
v_cvt_pk_bf16_f32 v184, v184, v185
v_cvt_pk_bf16_f32 v185, v186, v187
M v[128:131],a[140:143],v[76:79]
s_waitcnt lgkmcnt(6)
v_cvt_pk_bf16_f32 v186, v188, v189
v_cvt_pk_bf16_f32 v187, v190, v191
N v[132:135],a[144:147],v[64:67],v[192:195]
T a[136:137],v26,0
T a[138:139],v26,4096
M v[132:135],a[148:151],v[68:71]
v_mul_f32 v235, v47, v235
v_cvt_pk_bf16_f32 v224, v224, v225
N v[140:143],a[148:151],v[84:87],v[196:199]
v_cvt_pk_bf16_f32 v225, v226, v227
v_cvt_pk_bf16_f32 v226, v232, v233
M v[140:143],a[144:147],v[80:83]
v_cvt_pk_bf16_f32 v227, v234, v235
v_mul_f32 v40, v228, v228
N v[148:151],a[144:147],v[96:99],v[200:203]
T a[140:141],v27,0
T a[142:143],v27,4096
M v[148:151],a[148:151],v[100:103]
v_mul_f32 v41, v229, v229
v_mul_f32 v42, v230, v230
N v[156:159],a[148:151],v[116:119],v[204:207]
buffer_store_dwordx4 v[224:227], v58, s[12:15], s72 offen offset:0 sc1
v_mul_f32 v43, v231, v231
M v[156:159],a[144:147],v[112:115]
s_waitcnt lgkmcnt(8)
v_mul_f32 v44, v236, v236
v_mul_f32 v45, v237, v237
M v[156:159],a[156:159],v[124:127]
T a[144:145],v28,0
T a[146:147],v28,4096
M v[156:159],a[152:155],v[120:123]
v_mul_f32 v46, v238, v238
v_mul_f32 v47, v239, v239
M v[148:151],a[152:155],v[104:107]
v_fma_f32 v40, v40, v249, v247
v_fma_f32 v41, v41, v249, v247
M v[148:151],a[156:159],v[108:111]
v_fma_f32 v42, v42, v249, v247
v_fma_f32 v43, v43, v249, v247
M v[140:143],a[156:159],v[92:95]
T a[148:149],v29,0
T a[150:151],v29,4096
M v[140:143],a[152:155],v[88:91]
v_fma_f32 v44, v44, v249, v247
v_fma_f32 v45, v45, v249, v247
M v[132:135],a[152:155],v[72:75]
v_fma_f32 v46, v46, v249, v247
v_fma_f32 v47, v47, v249, v247
M v[132:135],a[156:159],v[76:79]
v_mul_f32 v40, v40, v228
v_mul_f32 v41, v41, v229
s_barrier
s_waitcnt lgkmcnt(8)
M a[0:3],a[128:131],v[160:163]
T a[152:153],v30,0
T a[154:155],v30,4096
M a[4:7],a[128:131],v[168:171]
v_exp_f32 v128, v128
M a[8:11],a[128:131],v[176:179]
v_exp_f32 v129, v129
M a[12:15],a[128:131],v[184:187]
v_exp_f32 v130, v130
M a[28:31],a[132:135],v[184:187]
T a[156:157],v31,0
T a[158:159],v31,4096
M a[24:27],a[132:135],v[176:179]
s_add_u32 m0, s59, 32768
v_exp_f32 v131, v131
M a[20:23],a[132:135],v[168:171]
buffer_load_dwordx4 v11, s[24:27], s61 offen offset:0 lds
v_cvt_pk_bf16_f32 v128, v128, v129
M a[16:19],a[132:135],v[160:163]
s_waitcnt lgkmcnt(8)
v_exp_f32 v132, v132
M a[32:35],a[136:139],v[160:163]
ds_read_b128 a[128:131], v36 offset:8192
v_cvt_pk_bf16_f32 v129, v130, v131
M a[36:39],a[136:139],v[168:171]
v_exp_f32 v133, v133
M a[40:43],a[136:139],v[176:179]
v_exp_f32 v134, v134
M a[44:47],a[136:139],v[184:187]
v_exp_f32 v135, v135
M a[60:63],a[140:143],v[184:187]
ds_read_b128 a[132:135], v37 offset:8192
v_cvt_pk_bf16_f32 v130, v132, v133
M a[56:59],a[140:143],v[176:179]
v_exp_f32 v136, v136
M a[52:55],a[140:143],v[168:171]
buffer_load_dwordx4 v12, s[24:27], s61 offen offset:1024 lds
v_cvt_pk_bf16_f32 v131, v134, v135
M a[48:51],a[140:143],v[160:163]
s_waitcnt lgkmcnt(6)
v_exp_f32 v137, v137
M a[64:67],a[144:147],v[160:163]
ds_read_b128 a[136:139], v38 offset:8192
v_cvt_pk_bf16_f32 v136, v136, v137
M a[68:71],a[144:147],v[168:171]
v_exp_f32 v138, v138
M a[72:75],a[144:147],v[176:179]
v_exp_f32 v139, v139
M a[76:79],a[144:147],v[184:187]
v_exp_f32 v140, v140
M a[92:95],a[148:151],v[184:187]
ds_read_b128 a[140:143], v39 offset:8192
v_cvt_pk_bf16_f32 v137, v138, v139
M a[88:91],a[148:151],v[176:179]
s_add_u32 m0, s59, 40960
v_exp_f32 v141, v141
M a[84:87],a[148:151],v[168:171]
buffer_load_dwordx4 v9, s[20:23], s61 offen offset:0 lds
v_cvt_pk_bf16_f32 v138, v140, v141
M a[80:83],a[148:151],v[160:163]
s_waitcnt lgkmcnt(4)
v_exp_f32 v142, v142
M a[96:99],a[152:155],v[160:163]
ds_read_b128 a[144:147], v36 offset:12288
v_mul_f32 v42, v42, v230
M a[100:103],a[152:155],v[168:171]
v_exp_f32 v143, v143
M a[104:107],a[152:155],v[176:179]
v_exp_f32 v144, v144
M a[108:111],a[152:155],v[184:187]
v_exp_f32 v145, v145
M a[124:127],a[156:159],v[184:187]
ds_read_b128 a[148:151], v37 offset:12288
v_cvt_pk_bf16_f32 v139, v142, v143
M a[120:123],a[156:159],v[176:179]
v_exp_f32 v146, v146
M a[116:119],a[156:159],v[168:171]
buffer_load_dwordx4 v10, s[20:23], s61 offen offset:1024 lds
v_cvt_pk_bf16_f32 v144, v144, v145
M a[112:115],a[156:159],v[160:163]
v_exp_f32 v147, v147
M v[208:211],v[240:243],v[160:163]
s_add_u32 s61, s61, 8192
v_exp_f32 v148, v148
M v[212:215],v[240:243],v[168:171]
v_exp_f32 v149, v149
M v[216:219],v[240:243],v[176:179]
v_exp_f32 v150, v150
M v[220:223],v[240:243],v[184:187]
s_waitcnt lgkmcnt(4)
v_exp_f32 v151, v151
N v[160:163],a[128:131],v[64:67],v[192:195]
ds_read_b128 a[152:155], v38 offset:12288
v_cvt_pk_bf16_f32 v145, v146, v147
M v[160:163],a[132:135],v[68:71]
v_exp_f32 v152, v152
N v[168:171],a[132:135],v[84:87],v[196:199]
v_exp_f32 v153, v153
M v[168:171],a[128:131],v[80:83]
v_exp_f32 v154, v154
N v[176:179],a[128:131],v[96:99],v[200:203]
ds_read_b128 a[156:159], v39 offset:12288
v_cvt_pk_bf16_f32 v146, v148, v149
M v[176:179],a[132:135],v[100:103]
s_add_u32 m0, s59, 49152
v_exp_f32 v155, v155
N v[184:187],a[132:135],v[116:119],v[204:207]
buffer_load_dwordx4 v11, s[24:27], s61 offen offset:0 lds
v_cvt_pk_bf16_f32 v147, v150, v151
M v[184:187],a[128:131],v[112:115]
s_waitcnt lgkmcnt(4)
v_exp_f32 v156, v156
M v[184:187],a[140:143],v[124:127]
T a[128:129],v24,16384
T a[130:131],v24,20480
M v[184:187],a[136:139],v[120:123]
v_exp_f32 v157, v157
M v[176:179],a[136:139],v[104:107]
v_exp_f32 v158, v158
M v[176:179],a[140:143],v[108:111]
v_exp_f32 v159, v159
M v[168:171],a[140:143],v[92:95]
T a[132:133],v25,16384
T a[134:135],v25,20480
M v[168:171],a[136:139],v[88:91]
v_cvt_pk_bf16_f32 v152, v152, v153
v_cvt_pk_bf16_f32 v153, v154, v155
M v[160:163],a[136:139],v[72:75]
buffer_load_dwordx4 v12, s[24:27], s61 offen offset:1024 lds
v_cvt_pk_bf16_f32 v154, v156, v157
M v[160:163],a[140:143],v[76:79]
s_waitcnt lgkmcnt(6)
v_cvt_pk_bf16_f32 v155, v158, v159
v_mul_f32 v43, v43, v231
N v[164:167],a[144:147],v[64:67],v[192:195]
T a[136:137],v26,16384
T a[138:139],v26,20480
M v[164:167],a[148:151],v[68:71]
v_exp_f32 v40, v40
N v[172:175],a[148:151],v[84:87],v[196:199]
v_exp_f32 v41, v41
M v[172:175],a[144:147],v[80:83]
v_exp_f32 v42, v42
N v[180:183],a[144:147],v[96:99],v[200:203]
T a[140:141],v27,16384
T a[142:143],v27,20480
M v[180:183],a[148:151],v[100:103]
s_add_u32 m0, s59, 57344
v_exp_f32 v43, v43
N v[188:191],a[148:151],v[116:119],v[204:207]
buffer_load_dwordx4 v9, s[20:23], s61 offen offset:0 lds
v_mul_f32 v44, v44, v236
M v[188:191],a[144:147],v[112:115]
s_waitcnt lgkmcnt(8)
v_exp_f32 v44, v44
M v[188:191],a[156:159],v[124:127]
T a[144:145],v28,16384
T a[146:147],v28,20480
M v[188:191],a[152:155],v[120:123]
v_mul_f32 v45, v45, v237
v_mul_f32 v46, v46, v238
M v[180:183],a[152:155],v[104:107]
v_exp_f32 v45, v45
M v[180:183],a[156:159],v[108:111]
v_exp_f32 v46, v46
M v[172:175],a[156:159],v[92:95]
T a[148:149],v29,16384
T a[150:151],v29,20480
M v[172:175],a[152:155],v[88:91]
v_mul_f32 v47, v47, v239
v_fma_f32 v40, v40, v245, v245
M v[164:167],a[152:155],v[72:75]
buffer_load_dwordx4 v10, s[20:23], s61 offen offset:1024 lds
s_add_u32 s61, s61, 8192
M v[164:167],a[156:159],v[76:79]
s_waitcnt lgkmcnt(8)
v_exp_f32 v47, v47
M a[0:3],a[128:131],v[128:131]
T a[152:153],v30,16384
T a[154:155],v30,20480
M a[4:7],a[128:131],v[136:139]
v_exp_f32 v160, v160
M a[8:11],a[128:131],v[144:147]
v_exp_f32 v161, v161
M a[12:15],a[128:131],v[152:155]
v_exp_f32 v162, v162
M a[28:31],a[132:135],v[152:155]
T a[156:157],v31,16384
T a[158:159],v31,20480
M a[24:27],a[132:135],v[144:147]
v_exp_f32 v163, v163
M a[20:23],a[132:135],v[136:139]
buffer_load_dword v56, v55, s[28:31], s79 offen
v_cvt_pk_bf16_f32 v160, v160, v161
M a[16:19],a[132:135],v[128:131]
s_waitcnt lgkmcnt(8)
v_exp_f32 v164, v164
M a[32:35],a[136:139],v[128:131]
s_add_u32 s79, s79, 2048
ds_read_b128 a[128:131], v36 offset:24576
v_cvt_pk_bf16_f32 v161, v162, v163
M a[36:39],a[136:139],v[136:139]
v_exp_f32 v165, v165
M a[40:43],a[136:139],v[144:147]
v_exp_f32 v166, v166
M a[44:47],a[136:139],v[152:155]
v_exp_f32 v167, v167
M a[60:63],a[140:143],v[152:155]
ds_read_b128 a[132:135], v37 offset:24576
v_cvt_pk_bf16_f32 v162, v164, v165
M a[56:59],a[140:143],v[144:147]
v_exp_f32 v168, v168
M a[52:55],a[140:143],v[136:139]
v_exp_f32 v169, v169
M a[48:51],a[140:143],v[128:131]
s_waitcnt lgkmcnt(6)
v_exp_f32 v170, v170
M a[64:67],a[144:147],v[128:131]
ds_read_b128 a[136:139], v38 offset:24576
v_cvt_pk_bf16_f32 v163, v166, v167
M a[68:71],a[144:147],v[136:139]
v_exp_f32 v171, v171
M a[72:75],a[144:147],v[144:147]
v_exp_f32 v172, v172
M a[76:79],a[144:147],v[152:155]
v_exp_f32 v173, v173
M a[92:95],a[148:151],v[152:155]
ds_read_b128 a[140:143], v39 offset:24576
v_cvt_pk_bf16_f32 v168, v168, v169
M a[88:91],a[148:151],v[144:147]
v_exp_f32 v174, v174
M a[84:87],a[148:151],v[136:139]
v_exp_f32 v175, v175
M a[80:83],a[148:151],v[128:131]
s_waitcnt lgkmcnt(4)
v_exp_f32 v176, v176
M a[96:99],a[152:155],v[128:131]
ds_read_b128 a[144:147], v36 offset:28672
v_cvt_pk_bf16_f32 v169, v170, v171
M a[100:103],a[152:155],v[136:139]
v_exp_f32 v177, v177
M a[104:107],a[152:155],v[144:147]
v_exp_f32 v178, v178
M a[108:111],a[152:155],v[152:155]
v_exp_f32 v179, v179
M a[124:127],a[156:159],v[152:155]
ds_read_b128 a[148:151], v37 offset:28672
v_cvt_pk_bf16_f32 v170, v172, v173
M a[120:123],a[156:159],v[144:147]
v_exp_f32 v180, v180
M a[116:119],a[156:159],v[136:139]
v_exp_f32 v181, v181
M a[112:115],a[156:159],v[128:131]
v_exp_f32 v182, v182
M v[208:211],v[240:243],v[128:131]
v_exp_f32 v183, v183
M v[212:215],v[240:243],v[136:139]
v_exp_f32 v184, v184
M v[216:219],v[240:243],v[144:147]
v_exp_f32 v185, v185
M v[220:223],v[240:243],v[152:155]
s_waitcnt lgkmcnt(4)
v_exp_f32 v186, v186
N v[128:131],a[128:131],v[64:67],v[192:195]
ds_read_b128 a[152:155], v38 offset:28672
v_cvt_pk_bf16_f32 v171, v174, v175
M v[128:131],a[132:135],v[68:71]
v_exp_f32 v187, v187
N v[136:139],a[132:135],v[84:87],v[196:199]
v_exp_f32 v188, v188
M v[136:139],a[128:131],v[80:83]
v_exp_f32 v189, v189
N v[144:147],a[128:131],v[96:99],v[200:203]
ds_read_b128 a[156:159], v39 offset:28672
v_cvt_pk_bf16_f32 v176, v176, v177
M v[144:147],a[132:135],v[100:103]
v_exp_f32 v190, v190
N v[152:155],a[132:135],v[116:119],v[204:207]
buffer_load_dword v56, v55, s[28:31], s79 offen
v_cvt_pk_bf16_f32 v177, v178, v179
M v[152:155],a[128:131],v[112:115]
s_waitcnt vmcnt(23)
s_barrier
s_waitcnt lgkmcnt(4)
M v[152:155],a[140:143],v[124:127]
s_add_u32 s79, s79, 2048
T a[128:129],v24,32768
T a[130:131],v24,36864
M v[152:155],a[136:139],v[120:123]
v_exp_f32 v191, v191
M v[144:147],a[136:139],v[104:107]
v_cvt_pk_bf16_f32 v178, v180, v181
v_cvt_pk_bf16_f32 v179, v182, v183
M v[144:147],a[140:143],v[108:111]
v_cvt_pk_bf16_f32 v184, v184, v185
v_cvt_pk_bf16_f32 v185, v186, v187
M v[136:139],a[140:143],v[92:95]
T a[132:133],v25,32768
T a[134:135],v25,36864
M v[136:139],a[136:139],v[88:91]
v_cvt_pk_bf16_f32 v186, v188, v189
v_cvt_pk_bf16_f32 v187, v190, v191
M v[128:131],a[136:139],v[72:75]
v_rcp_f32 v40, v40
M v[128:131],a[140:143],v[76:79]
s_waitcnt lgkmcnt(6)
v_fma_f32 v41, v41, v245, v245
v_fma_f32 v42, v42, v245, v245
N v[132:135],a[144:147],v[64:67],v[192:195]
T a[136:137],v26,32768
T a[138:139],v26,36864
M v[132:135],a[148:151],v[68:71]
v_rcp_f32 v41, v41
N v[140:143],a[148:151],v[84:87],v[196:199]
v_rcp_f32 v42, v42
M v[140:143],a[144:147],v[80:83]
v_fma_f32 v43, v43, v245, v245
v_fma_f32 v44, v44, v245, v245
N v[148:151],a[144:147],v[96:99],v[200:203]
T a[140:141],v27,32768
T a[142:143],v27,36864
M v[148:151],a[148:151],v[100:103]
v_rcp_f32 v43, v43
N v[156:159],a[148:151],v[116:119],v[204:207]
v_rcp_f32 v44, v44
M v[156:159],a[144:147],v[112:115]
s_waitcnt lgkmcnt(8)
v_fma_f32 v45, v45, v245, v245
v_fma_f32 v46, v46, v245, v245
M v[156:159],a[156:159],v[124:127]
T a[144:145],v28,32768
T a[146:147],v28,36864
M v[156:159],a[152:155],v[120:123]
v_rcp_f32 v45, v45
M v[148:151],a[152:155],v[104:107]
v_rcp_f32 v46, v46
M v[148:151],a[156:159],v[108:111]
v_fma_f32 v47, v47, v245, v245
v_mul_f32 v228, v40, v228
M v[140:143],a[156:159],v[92:95]
T a[148:149],v29,32768
T a[150:151],v29,36864
M v[140:143],a[152:155],v[88:91]
v_rcp_f32 v47, v47
M v[132:135],a[152:155],v[72:75]
v_mul_f32 v229, v41, v229
v_mul_f32 v230, v42, v230
M v[132:135],a[156:159],v[76:79]
v_mul_f32 v231, v43, v231
v_mul_f32 v236, v44, v236
s_barrier
s_waitcnt lgkmcnt(8)
M a[0:3],a[128:131],v[160:163]
T a[152:153],v30,32768
T a[154:155],v30,36864
M a[4:7],a[128:131],v[168:171]
v_exp_f32 v128, v128
M a[8:11],a[128:131],v[176:179]
s_add_u32 m0, s59, 65536
v_exp_f32 v129, v129
M a[12:15],a[128:131],v[184:187]
L_pad4:
s_cbranch_execz L_pad8
buffer_load_dwordx4 v11, s[24:27], s61 offen offset:0 lds
v_cvt_pk_bf16_f32 v128, v128, v129
M a[28:31],a[132:135],v[184:187]
T a[156:157],v31,32768
T a[158:159],v31,36864
M a[24:27],a[132:135],v[176:179]
v_exp_f32 v130, v130
M a[20:23],a[132:135],v[168:171]
buffer_load_dwordx4 v12, s[24:27], s61 offen offset:1024 lds
v_mul_f32 v237, v45, v237
M a[16:19],a[132:135],v[160:163]
s_waitcnt lgkmcnt(8)
v_exp_f32 v131, v131
M a[32:35],a[136:139],v[160:163]
ds_read_b128 a[128:131], v36 offset:40960
v_cvt_pk_bf16_f32 v129, v130, v131
M a[36:39],a[136:139],v[168:171]
v_exp_f32 v132, v132
M a[40:43],a[136:139],v[176:179]
s_add_u32 m0, s59, 73728
v_exp_f32 v133, v133
M a[44:47],a[136:139],v[184:187]
buffer_load_dwordx4 v9, s[20:23], s61 offen offset:0 lds
v_cvt_pk_bf16_f32 v130, v132, v133
M a[60:63],a[140:143],v[184:187]
ds_read_b128 a[132:135], v37 offset:40960
v_mul_f32 v238, v46, v238
M a[56:59],a[140:143],v[176:179]
v_exp_f32 v134, v134
M a[52:55],a[140:143],v[168:171]
buffer_load_dwordx4 v10, s[20:23], s61 offen offset:1024 lds
s_add_u32 s61, s61, 8192
M a[48:51],a[140:143],v[160:163]
s_waitcnt lgkmcnt(6)
v_exp_f32 v135, v135
M a[64:67],a[144:147],v[160:163]
ds_read_b128 a[136:139], v38 offset:40960
v_cvt_pk_bf16_f32 v131, v134, v135
M a[68:71],a[144:147],v[168:171]
v_exp_f32 v136, v136
M a[72:75],a[144:147],v[176:179]
s_add_u32 m0, s59, 81920
v_exp_f32 v137, v137
M a[76:79],a[144:147],v[184:187]
buffer_load_dwordx4 v11, s[24:27], s61 offen offset:0 lds
v_cvt_pk_bf16_f32 v136, v136, v137
M a[92:95],a[148:151],v[184:187]
ds_read_b128 a[140:143], v39 offset:40960
v_mul_f32 v239, v47, v239
M a[88:91],a[148:151],v[176:179]
v_exp_f32 v138, v138
M a[84:87],a[148:151],v[168:171]
buffer_load_dwordx4 v12, s[24:27], s61 offen offset:1024 lds
v_cvt_pk_bf16_f32 v228, v228, v229
M a[80:83],a[148:151],v[160:163]
s_waitcnt lgkmcnt(4)
v_exp_f32 v139, v139
M a[96:99],a[152:155],v[160:163]
ds_read_b128 a[144:147], v36 offset:45056
v_cvt_pk_bf16_f32 v137, v138, v139
M a[100:103],a[152:155],v[168:171]
v_exp_f32 v140, v140
M a[104:107],a[152:155],v[176:179]
s_add_u32 m0, s59, 90112
v_exp_f32 v141, v141
M a[108:111],a[152:155],v[184:187]
buffer_load_dwordx4 v9, s[20:23], s61 offen offset:0 lds
v_cvt_pk_bf16_f32 v138, v140, v141
M a[124:127],a[156:159],v[184:187]
ds_read_b128 a[148:151], v37 offset:45056
v_cvt_pk_bf16_f32 v229, v230, v231
M a[120:123],a[156:159],v[176:179]
v_exp_f32 v142, v142
M a[116:119],a[156:159],v[168:171]
buffer_load_dwordx4 v10, s[20:23], s61 offen offset:1024 lds
s_add_u32 s61, s61, 8192
M a[112:115],a[156:159],v[160:163]
v_exp_f32 v143, v143
M v[208:211],v[240:243],v[160:163]
v_exp_f32 v144, v144
M v[212:215],v[240:243],v[168:171]
v_exp_f32 v145, v145
M v[216:219],v[240:243],v[176:179]
v_exp_f32 v146, v146
M v[220:223],v[240:243],v[184:187]
s_waitcnt lgkmcnt(4)
v_exp_f32 v147, v147
N v[160:163],a[128:131],v[64:67],v[192:195]
ds_read_b128 a[152:155], v38 offset:45056
v_cvt_pk_bf16_f32 v139, v142, v143
M v[160:163],a[132:135],v[68:71]
v_exp_f32 v148, v148
N v[168:171],a[132:135],v[84:87],v[196:199]
v_exp_f32 v149, v149
M v[168:171],a[128:131],v[80:83]
v_exp_f32 v150, v150
N v[176:179],a[128:131],v[96:99],v[200:203]
ds_read_b128 a[156:159], v39 offset:45056
v_cvt_pk_bf16_f32 v144, v144, v145
M v[176:179],a[132:135],v[100:103]
s_add_u32 m0, s60, 131072
v_exp_f32 v151, v151
N v[184:187],a[132:135],v[116:119],v[204:207]
buffer_load_dwordx4 v1, s[32:35], s62 offen offset:0 lds
v_cvt_pk_bf16_f32 v145, v146, v147
M v[184:187],a[128:131],v[112:115]
s_waitcnt lgkmcnt(4)
v_exp_f32 v152, v152
M v[184:187],a[140:143],v[124:127]
T a[128:129],v24,49152
T a[130:131],v24,53248
M v[184:187],a[136:139],v[120:123]
v_exp_f32 v153, v153
M v[176:179],a[136:139],v[104:107]
v_exp_f32 v154, v154
M v[176:179],a[140:143],v[108:111]
v_exp_f32 v155, v155
M v[168:171],a[140:143],v[92:95]
T a[132:133],v25,49152
T a[134:135],v25,53248
M v[168:171],a[136:139],v[88:91]
v_exp_f32 v156, v156
M v[160:163],a[136:139],v[72:75]
buffer_load_dwordx4 v2, s[32:35], s62 offen offset:1024 lds
v_cvt_pk_bf16_f32 v146, v148, v149
M v[160:163],a[140:143],v[76:79]
s_waitcnt lgkmcnt(6)
v_exp_f32 v157, v157
N v[164:167],a[144:147],v[64:67],v[192:195]
T a[136:137],v26,49152
T a[138:139],v26,53248
M v[164:167],a[148:151],v[68:71]
v_exp_f32 v158, v158
N v[172:175],a[148:151],v[84:87],v[196:199]
v_exp_f32 v159, v159
M v[172:175],a[144:147],v[80:83]
v_cvt_pk_bf16_f32 v147, v150, v151
v_cvt_pk_bf16_f32 v152, v152, v153
N v[180:183],a[144:147],v[96:99],v[200:203]
T a[140:141],v27,49152
T a[142:143],v27,53248
M v[180:183],a[148:151],v[100:103]
v_cvt_pk_bf16_f32 v153, v154, v155
v_cvt_pk_bf16_f32 v154, v156, v157
N v[188:191],a[148:151],v[116:119],v[204:207]
buffer_load_dwordx4 v3, s[32:35], s62 offen offset:2048 lds
v_cvt_pk_bf16_f32 v155, v158, v159
M v[188:191],a[144:147],v[112:115]
s_waitcnt lgkmcnt(8)
v_cvt_pk_bf16_f32 v230, v236, v237
v_cvt_pk_bf16_f32 v231, v238, v239
M v[188:191],a[156:159],v[124:127]
T a[144:145],v28,49152
T a[146:147],v28,53248
M v[188:191],a[152:155],v[120:123]
M v[180:183],a[152:155],v[104:107]
M v[180:183],a[156:159],v[108:111]
M v[172:175],a[156:159],v[92:95]
T a[148:149],v29,49152
T a[150:151],v29,53248
M v[172:175],a[152:155],v[88:91]
M v[164:167],a[152:155],v[72:75]
buffer_store_dwordx4 v[228:231], v58, s[12:15], s72 offen offset:1024 sc1
M v[164:167],a[156:159],v[76:79]
s_waitcnt lgkmcnt(8)
M a[0:3],a[128:131],v[128:131]
T a[152:153],v30,49152
T a[154:155],v30,53248
M a[4:7],a[128:131],v[136:139]
v_exp_f32 v160, v160
M a[8:11],a[128:131],v[144:147]
v_exp_f32 v161, v161
M a[12:15],a[128:131],v[152:155]
v_exp_f32 v162, v162
M a[28:31],a[132:135],v[152:155]
T a[156:157],v31,49152
T a[158:159],v31,53248
M a[24:27],a[132:135],v[144:147]
v_exp_f32 v163, v163
M a[20:23],a[132:135],v[136:139]
buffer_load_dwordx4 v4, s[32:35], s62 offen offset:3072 lds
v_cvt_pk_bf16_f32 v160, v160, v161
M a[16:19],a[132:135],v[128:131]
s_waitcnt lgkmcnt(8)
v_exp_f32 v164, v164
M a[32:35],a[136:139],v[128:131]
ds_read_b128 a[128:131], v36 offset:57344
v_cvt_pk_bf16_f32 v161, v162, v163
M a[36:39],a[136:139],v[136:139]
v_exp_f32 v165, v165
M a[40:43],a[136:139],v[144:147]
v_exp_f32 v166, v166
M a[44:47],a[136:139],v[152:155]
v_exp_f32 v167, v167
M a[60:63],a[140:143],v[152:155]
ds_read_b128 a[132:135], v37 offset:57344
v_cvt_pk_bf16_f32 v162, v164, v165
M a[56:59],a[140:143],v[144:147]
s_add_u32 m0, s60, 135168
v_exp_f32 v168, v168
M a[52:55],a[140:143],v[136:139]
buffer_load_dwordx4 v5, s[32:35], s62 offen offset:0 lds
v_cvt_pk_bf16_f32 v163, v166, v167
M a[48:51],a[140:143],v[128:131]
s_waitcnt lgkmcnt(6)
v_exp_f32 v169, v169
M a[64:67],a[144:147],v[128:131]
ds_read_b128 a[136:139], v38 offset:57344
v_cvt_pk_bf16_f32 v168, v168, v169
M a[68:71],a[144:147],v[136:139]
v_exp_f32 v170, v170
M a[72:75],a[144:147],v[144:147]
v_exp_f32 v171, v171
M a[76:79],a[144:147],v[152:155]
v_exp_f32 v172, v172
M a[92:95],a[148:151],v[152:155]
ds_read_b128 a[140:143], v39 offset:57344
v_cvt_pk_bf16_f32 v169, v170, v171
M a[88:91],a[148:151],v[144:147]
v_exp_f32 v173, v173
M a[84:87],a[148:151],v[136:139]
buffer_load_dwordx4 v6, s[32:35], s62 offen offset:1024 lds
v_cvt_pk_bf16_f32 v170, v172, v173
M a[80:83],a[148:151],v[128:131]
s_waitcnt lgkmcnt(4)
v_exp_f32 v174, v174
M a[96:99],a[152:155],v[128:131]
ds_read_b128 a[144:147], v36 offset:61440
M a[100:103],a[152:155],v[136:139]
v_exp_f32 v175, v175
M a[104:107],a[152:155],v[144:147]
v_exp_f32 v176, v176
M a[108:111],a[152:155],v[152:155]
v_exp_f32 v177, v177
M a[124:127],a[156:159],v[152:155]
ds_read_b128 a[148:151], v37 offset:61440
v_cvt_pk_bf16_f32 v171, v174, v175
M a[120:123],a[156:159],v[144:147]
v_exp_f32 v178, v178
M a[116:119],a[156:159],v[136:139]
buffer_load_dwordx4 v7, s[32:35], s62 offen offset:2048 lds
v_cvt_pk_bf16_f32 v176, v176, v177
M a[112:115],a[156:159],v[128:131]
v_exp_f32 v179, v179
M v[208:211],v[240:243],v[128:131]
v_exp_f32 v180, v180
M v[212:215],v[240:243],v[136:139]
v_exp_f32 v181, v181
M v[216:219],v[240:243],v[144:147]
v_exp_f32 v182, v182
M v[220:223],v[240:243],v[152:155]
s_waitcnt lgkmcnt(4)
v_exp_f32 v183, v183
N v[128:131],a[128:131],v[64:67],v[192:195]
ds_read_b128 a[152:155], v38 offset:61440
v_cvt_pk_bf16_f32 v177, v178, v179
M v[128:131],a[132:135],v[68:71]
v_exp_f32 v184, v184
N v[136:139],a[132:135],v[84:87],v[196:199]
v_exp_f32 v185, v185
M v[136:139],a[128:131],v[80:83]
v_exp_f32 v186, v186
N v[144:147],a[128:131],v[96:99],v[200:203]
ds_read_b128 a[156:159], v39 offset:61440
v_cvt_pk_bf16_f32 v178, v180, v181
M v[144:147],a[132:135],v[100:103]
v_exp_f32 v187, v187
N v[152:155],a[132:135],v[116:119],v[204:207]
buffer_load_dwordx4 v8, s[32:35], s62 offen offset:3072 lds
v_cvt_pk_bf16_f32 v179, v182, v183
M v[152:155],a[128:131],v[112:115]
s_waitcnt vmcnt(5)
s_barrier
s_waitcnt lgkmcnt(4)
M v[152:155],a[140:143],v[124:127]
s_add_u32 s62, s62, 262144
T a[128:129],v16,0
T a[130:131],v16,4096
M v[152:155],a[136:139],v[120:123]
s_add_u32 s74, s64, 2
v_exp_f32 v188, v188
M v[144:147],a[136:139],v[104:107]
v_exp_f32 v189, v189
M v[144:147],a[140:143],v[108:111]
v_exp_f32 v190, v190
M v[136:139],a[140:143],v[92:95]
T a[132:133],v17,0
T a[134:135],v17,4096
M v[136:139],a[136:139],v[88:91]
v_exp_f32 v191, v191
M v[128:131],a[136:139],v[72:75]
buffer_load_dword v56, v55, s[28:31], s79 offen
v_cvt_pk_bf16_f32 v184, v184, v185
M v[128:131],a[140:143],v[76:79]
s_waitcnt lgkmcnt(6)
v_cvt_pk_bf16_f32 v185, v186, v187
v_cvt_pk_bf16_f32 v186, v188, v189
N v[132:135],a[144:147],v[64:67],v[192:195]
s_add_u32 s79, s79, 2048
T a[136:137],v18,0
T a[138:139],v18,4096
M v[132:135],a[148:151],v[68:71]
v_cvt_pk_bf16_f32 v187, v190, v191
v_mov_b32 v61, s74
N v[140:143],a[148:151],v[84:87],v[196:199]
buffer_store_dword v61, v60, s[12:15], s65 offen sc1
M v[140:143],a[144:147],v[80:83]
N v[148:151],a[144:147],v[96:99],v[200:203]
T a[140:141],v19,0
T a[142:143],v19,4096
M v[148:151],a[148:151],v[100:103]
N v[156:159],a[148:151],v[116:119],v[204:207]
buffer_load_dword v56, v55, s[28:31], s79 offen
s_add_u32 s79, s79, 2048
M v[156:159],a[144:147],v[112:115]
s_waitcnt lgkmcnt(8)
M v[156:159],a[156:159],v[124:127]
T a[144:145],v20,0
T a[146:147],v20,4096
M v[156:159],a[152:155],v[120:123]
M v[148:151],a[152:155],v[104:107]
M v[148:151],a[156:159],v[108:111]
M v[140:143],a[156:159],v[92:95]
T a[148:149],v21,0
T a[150:151],v21,4096
M v[140:143],a[152:155],v[88:91]
M v[132:135],a[152:155],v[72:75]
M v[132:135],a[156:159],v[76:79]
s_barrier
s_waitcnt lgkmcnt(8)
M a[0:3],a[128:131],v[160:163]
T a[152:153],v22,0
T a[154:155],v22,4096
M a[4:7],a[128:131],v[168:171]
v_exp_f32 v128, v128
M a[8:11],a[128:131],v[176:179]
v_exp_f32 v129, v129
M a[12:15],a[128:131],v[184:187]
v_exp_f32 v130, v130
M a[28:31],a[132:135],v[184:187]
T a[156:157],v23,0
T a[158:159],v23,4096
M a[24:27],a[132:135],v[176:179]
s_add_u32 m0, s59, 98304
v_exp_f32 v131, v131
M a[20:23],a[132:135],v[168:171]
buffer_load_dwordx4 v11, s[24:27], s61 offen offset:0 lds
v_cvt_pk_bf16_f32 v128, v128, v129
M a[16:19],a[132:135],v[160:163]
s_waitcnt lgkmcnt(8)
v_exp_f32 v132, v132
M a[32:35],a[136:139],v[160:163]
ds_read_b128 a[128:131], v32 offset:8192
v_cvt_pk_bf16_f32 v129, v130, v131
M a[36:39],a[136:139],v[168:171]
v_exp_f32 v133, v133
M a[40:43],a[136:139],v[176:179]
v_exp_f32 v134, v134
M a[44:47],a[136:139],v[184:187]
v_exp_f32 v135, v135
M a[60:63],a[140:143],v[184:187]
ds_read_b128 a[132:135], v33 offset:8192
v_cvt_pk_bf16_f32 v130, v132, v133
M a[56:59],a[140:143],v[176:179]
v_exp_f32 v136, v136
M a[52:55],a[140:143],v[168:171]
buffer_load_dwordx4 v12, s[24:27], s61 offen offset:1024 lds
v_cvt_pk_bf16_f32 v131, v134, v135
M a[48:51],a[140:143],v[160:163]
s_waitcnt lgkmcnt(6)
v_exp_f32 v137, v137
M a[64:67],a[144:147],v[160:163]
ds_read_b128 a[136:139], v34 offset:8192
v_cvt_pk_bf16_f32 v136, v136, v137
M a[68:71],a[144:147],v[168:171]
v_exp_f32 v138, v138
M a[72:75],a[144:147],v[176:179]
v_exp_f32 v139, v139
M a[76:79],a[144:147],v[184:187]
v_exp_f32 v140, v140
M a[92:95],a[148:151],v[184:187]
ds_read_b128 a[140:143], v35 offset:8192
v_cvt_pk_bf16_f32 v137, v138, v139
M a[88:91],a[148:151],v[176:179]
s_add_u32 m0, s59, 106496
v_exp_f32 v141, v141
M a[84:87],a[148:151],v[168:171]
buffer_load_dwordx4 v9, s[20:23], s61 offen offset:0 lds
v_cvt_pk_bf16_f32 v138, v140, v141
M a[80:83],a[148:151],v[160:163]
s_waitcnt lgkmcnt(4)
v_exp_f32 v142, v142
M a[96:99],a[152:155],v[160:163]
ds_read_b128 a[144:147], v32 offset:12288
M a[100:103],a[152:155],v[168:171]
v_exp_f32 v143, v143
M a[104:107],a[152:155],v[176:179]
v_exp_f32 v144, v144
M a[108:111],a[152:155],v[184:187]
v_exp_f32 v145, v145
M a[124:127],a[156:159],v[184:187]
ds_read_b128 a[148:151], v33 offset:12288
v_cvt_pk_bf16_f32 v139, v142, v143
M a[120:123],a[156:159],v[176:179]
v_exp_f32 v146, v146
M a[116:119],a[156:159],v[168:171]
buffer_load_dwordx4 v10, s[20:23], s61 offen offset:1024 lds
v_cvt_pk_bf16_f32 v144, v144, v145
M a[112:115],a[156:159],v[160:163]
v_exp_f32 v147, v147
M v[208:211],v[240:243],v[160:163]
s_add_u32 s61, s61, 8192
v_exp_f32 v148, v148
M v[212:215],v[240:243],v[168:171]
v_exp_f32 v149, v149
M v[216:219],v[240:243],v[176:179]
v_exp_f32 v150, v150
M v[220:223],v[240:243],v[184:187]
s_waitcnt lgkmcnt(4)
v_exp_f32 v151, v151
N v[160:163],a[128:131],v[64:67],v[192:195]
ds_read_b128 a[152:155], v34 offset:12288
v_cvt_pk_bf16_f32 v145, v146, v147
M v[160:163],a[132:135],v[68:71]
v_exp_f32 v152, v152
N v[168:171],a[132:135],v[84:87],v[196:199]
v_exp_f32 v153, v153
M v[168:171],a[128:131],v[80:83]
v_exp_f32 v154, v154
N v[176:179],a[128:131],v[96:99],v[200:203]
ds_read_b128 a[156:159], v35 offset:12288
v_cvt_pk_bf16_f32 v146, v148, v149
M v[176:179],a[132:135],v[100:103]
s_add_u32 m0, s59, 114688
v_exp_f32 v155, v155
N v[184:187],a[132:135],v[116:119],v[204:207]
buffer_load_dwordx4 v11, s[24:27], s61 offen offset:0 lds
v_cvt_pk_bf16_f32 v147, v150, v151
M v[184:187],a[128:131],v[112:115]
s_waitcnt lgkmcnt(4)
v_exp_f32 v156, v156
M v[184:187],a[140:143],v[124:127]
T a[128:129],v16,16384
T a[130:131],v16,20480
M v[184:187],a[136:139],v[120:123]
v_exp_f32 v157, v157
M v[176:179],a[136:139],v[104:107]
v_exp_f32 v158, v158
M v[176:179],a[140:143],v[108:111]
v_exp_f32 v159, v159
M v[168:171],a[140:143],v[92:95]
T a[132:133],v17,16384
T a[134:135],v17,20480
M v[168:171],a[136:139],v[88:91]
v_cvt_pk_bf16_f32 v152, v152, v153
v_cvt_pk_bf16_f32 v153, v154, v155
M v[160:163],a[136:139],v[72:75]
buffer_load_dwordx4 v12, s[24:27], s61 offen offset:1024 lds
v_cvt_pk_bf16_f32 v154, v156, v157
M v[160:163],a[140:143],v[76:79]
s_add_u32 s61, s61, 8192
v_cvt_pk_bf16_f32 v155, v158, v159
s_waitcnt lgkmcnt(6)
N v[164:167],a[144:147],v[64:67],v[192:195]
T a[136:137],v18,16384
T a[138:139],v18,20480
M v[164:167],a[148:151],v[68:71]
N v[172:175],a[148:151],v[84:87],v[196:199]
M v[172:175],a[144:147],v[80:83]
N v[180:183],a[144:147],v[96:99],v[200:203]
T a[140:141],v19,16384
T a[142:143],v19,20480
M v[180:183],a[148:151],v[100:103]
s_add_u32 m0, s59, 122880
N v[188:191],a[148:151],v[116:119],v[204:207]
buffer_load_dwordx4 v11, s[24:27], s61 offen offset:0 lds
M v[188:191],a[144:147],v[112:115]
s_waitcnt lgkmcnt(8)
M v[188:191],a[156:159],v[124:127]
T a[144:145],v20,16384
T a[146:147],v20,20480
M v[188:191],a[152:155],v[120:123]
M v[180:183],a[152:155],v[104:107]
M v[180:183],a[156:159],v[108:111]
M v[172:175],a[156:159],v[92:95]
T a[148:149],v21,16384
T a[150:151],v21,20480
M v[172:175],a[152:155],v[88:91]
M v[164:167],a[152:155],v[72:75]
buffer_load_dwordx4 v12, s[24:27], s61 offen offset:1024 lds
M v[164:167],a[156:159],v[76:79]
s_waitcnt lgkmcnt(8)
M a[0:3],a[128:131],v[128:131]
T a[152:153],v22,16384
T a[154:155],v22,20480
M a[4:7],a[128:131],v[136:139]
v_exp_f32 v160, v160
M a[8:11],a[128:131],v[144:147]
v_exp_f32 v161, v161
M a[12:15],a[128:131],v[152:155]
v_exp_f32 v162, v162
M a[28:31],a[132:135],v[152:155]
T a[156:157],v23,16384
T a[158:159],v23,20480
M a[24:27],a[132:135],v[144:147]
v_exp_f32 v163, v163
M a[20:23],a[132:135],v[136:139]
buffer_load_dwordx4 v[224:227], v57, s[36:39], s44 offen
v_cvt_pk_bf16_f32 v160, v160, v161
M a[16:19],a[132:135],v[128:131]
s_waitcnt lgkmcnt(8)
v_exp_f32 v164, v164
M a[32:35],a[136:139],v[128:131]
ds_read_b128 a[128:131], v32 offset:24576
v_cvt_pk_bf16_f32 v161, v162, v163
M a[36:39],a[136:139],v[136:139]
v_exp_f32 v165, v165
M a[40:43],a[136:139],v[144:147]
v_exp_f32 v166, v166
M a[44:47],a[136:139],v[152:155]
v_exp_f32 v167, v167
M a[60:63],a[140:143],v[152:155]
ds_read_b128 a[132:135], v33 offset:24576
v_cvt_pk_bf16_f32 v162, v164, v165
M a[56:59],a[140:143],v[144:147]
v_exp_f32 v168, v168
M a[52:55],a[140:143],v[136:139]
buffer_load_dwordx4 v[228:231], v57, s[36:39], s45 offen
v_cvt_pk_bf16_f32 v163, v166, v167
M a[48:51],a[140:143],v[128:131]
s_waitcnt lgkmcnt(6)
v_exp_f32 v169, v169
M a[64:67],a[144:147],v[128:131]
ds_read_b128 a[136:139], v34 offset:24576
v_cvt_pk_bf16_f32 v168, v168, v169
M a[68:71],a[144:147],v[136:139]
v_exp_f32 v170, v170
M a[72:75],a[144:147],v[144:147]
v_exp_f32 v171, v171
M a[76:79],a[144:147],v[152:155]
v_exp_f32 v172, v172
M a[92:95],a[148:151],v[152:155]
ds_read_b128 a[140:143], v35 offset:24576
v_cvt_pk_bf16_f32 v169, v170, v171
M a[88:91],a[148:151],v[144:147]
v_exp_f32 v173, v173
M a[84:87],a[148:151],v[136:139]
v_exp_f32 v174, v174
M a[80:83],a[148:151],v[128:131]
s_waitcnt lgkmcnt(4)
v_exp_f32 v175, v175
M a[96:99],a[152:155],v[128:131]
ds_read_b128 a[144:147], v32 offset:28672
v_cvt_pk_bf16_f32 v170, v172, v173
M a[100:103],a[152:155],v[136:139]
v_exp_f32 v176, v176
M a[104:107],a[152:155],v[144:147]
v_exp_f32 v177, v177
M a[108:111],a[152:155],v[152:155]
v_exp_f32 v178, v178
M a[124:127],a[156:159],v[152:155]
ds_read_b128 a[148:151], v33 offset:28672
v_cvt_pk_bf16_f32 v171, v174, v175
M a[120:123],a[156:159],v[144:147]
v_exp_f32 v179, v179
M a[116:119],a[156:159],v[136:139]
v_exp_f32 v180, v180
M a[112:115],a[156:159],v[128:131]
v_exp_f32 v181, v181
M v[208:211],v[240:243],v[128:131]
v_exp_f32 v182, v182
M v[212:215],v[240:243],v[136:139]
v_exp_f32 v183, v183
M v[216:219],v[240:243],v[144:147]
v_exp_f32 v184, v184
M v[220:223],v[240:243],v[152:155]
s_waitcnt lgkmcnt(4)
v_exp_f32 v185, v185
N v[128:131],a[128:131],v[64:67],v[192:195]
ds_read_b128 a[152:155], v34 offset:28672
v_cvt_pk_bf16_f32 v176, v176, v177
M v[128:131],a[132:135],v[68:71]
v_exp_f32 v186, v186
N v[136:139],a[132:135],v[84:87],v[196:199]
v_exp_f32 v187, v187
M v[136:139],a[128:131],v[80:83]
v_exp_f32 v188, v188
N v[144:147],a[128:131],v[96:99],v[200:203]
ds_read_b128 a[156:159], v35 offset:28672
v_cvt_pk_bf16_f32 v177, v178, v179
M v[144:147],a[132:135],v[100:103]
L_pad5:
s_cbranch_execz L_pad9
v_exp_f32 v189, v189
N v[152:155],a[132:135],v[116:119],v[204:207]
buffer_load_dwordx4 v[232:235], v57, s[36:39], s46 offen
v_cvt_pk_bf16_f32 v178, v180, v181
M v[152:155],a[128:131],v[112:115]
s_waitcnt vmcnt(33)
s_barrier
s_waitcnt lgkmcnt(4)
M v[152:155],a[140:143],v[124:127]
T a[128:129],v16,32768
T a[130:131],v16,36864
M v[152:155],a[136:139],v[120:123]
v_exp_f32 v190, v190
M v[144:147],a[136:139],v[104:107]
v_exp_f32 v191, v191
M v[144:147],a[140:143],v[108:111]
v_cvt_pk_bf16_f32 v179, v182, v183
v_cvt_pk_bf16_f32 v184, v184, v185
M v[136:139],a[140:143],v[92:95]
T a[132:133],v17,32768
T a[134:135],v17,36864
M v[136:139],a[136:139],v[88:91]
v_cvt_pk_bf16_f32 v185, v186, v187
v_cvt_pk_bf16_f32 v186, v188, v189
M v[128:131],a[136:139],v[72:75]
buffer_load_dwordx4 v[236:239], v57, s[36:39], s47 offen
v_cvt_pk_bf16_f32 v187, v190, v191
M v[128:131],a[140:143],v[76:79]
s_waitcnt lgkmcnt(6)
N v[132:135],a[144:147],v[64:67],v[192:195]
T a[136:137],v18,32768
T a[138:139],v18,36864
M v[132:135],a[148:151],v[68:71]
N v[140:143],a[148:151],v[84:87],v[196:199]
M v[140:143],a[144:147],v[80:83]
N v[148:151],a[144:147],v[96:99],v[200:203]
T a[140:141],v19,32768
T a[142:143],v19,36864
M v[148:151],a[148:151],v[100:103]
N v[156:159],a[148:151],v[116:119],v[204:207]
buffer_load_dword v62, v14, s[12:15], s6 offen sc1
M v[156:159],a[144:147],v[112:115]
s_waitcnt lgkmcnt(8)
M v[156:159],a[156:159],v[124:127]
T a[144:145],v20,32768
T a[146:147],v20,36864
M v[156:159],a[152:155],v[120:123]
M v[148:151],a[152:155],v[104:107]
M v[148:151],a[156:159],v[108:111]
M v[140:143],a[156:159],v[92:95]
T a[148:149],v21,32768
T a[150:151],v21,36864
M v[140:143],a[152:155],v[88:91]
M v[132:135],a[152:155],v[72:75]
M v[132:135],a[156:159],v[76:79]
s_barrier
s_waitcnt lgkmcnt(8)
M a[0:3],a[128:131],v[160:163]
T a[152:153],v22,32768
T a[154:155],v22,36864
M a[4:7],a[128:131],v[168:171]
v_exp_f32 v128, v128
M a[8:11],a[128:131],v[176:179]
v_exp_f32 v129, v129
M a[12:15],a[128:131],v[184:187]
v_exp_f32 v130, v130
M a[28:31],a[132:135],v[184:187]
T a[156:157],v23,32768
T a[158:159],v23,36864
M a[24:27],a[132:135],v[176:179]
s_add_u32 m0, s60, 0
v_exp_f32 v131, v131
M a[20:23],a[132:135],v[168:171]
buffer_load_dwordx4 v1, s[32:35], s62 offen offset:0 lds
v_cvt_pk_bf16_f32 v128, v128, v129
M a[16:19],a[132:135],v[160:163]
s_waitcnt lgkmcnt(8)
v_exp_f32 v132, v132
M a[32:35],a[136:139],v[160:163]
ds_read_b128 a[128:131], v32 offset:40960
v_cvt_pk_bf16_f32 v129, v130, v131
M a[36:39],a[136:139],v[168:171]
v_exp_f32 v133, v133
M a[40:43],a[136:139],v[176:179]
v_exp_f32 v134, v134
M a[44:47],a[136:139],v[184:187]
v_exp_f32 v135, v135
M a[60:63],a[140:143],v[184:187]
ds_read_b128 a[132:135], v33 offset:40960
v_cvt_pk_bf16_f32 v130, v132, v133
M a[56:59],a[140:143],v[176:179]
v_exp_f32 v136, v136
M a[52:55],a[140:143],v[168:171]
buffer_load_dwordx4 v2, s[32:35], s62 offen offset:1024 lds
v_cvt_pk_bf16_f32 v131, v134, v135
M a[48:51],a[140:143],v[160:163]
s_waitcnt lgkmcnt(6)
v_exp_f32 v137, v137
M a[64:67],a[144:147],v[160:163]
ds_read_b128 a[136:139], v34 offset:40960
v_cvt_pk_bf16_f32 v136, v136, v137
M a[68:71],a[144:147],v[168:171]
v_exp_f32 v138, v138
M a[72:75],a[144:147],v[176:179]
v_exp_f32 v139, v139
M a[76:79],a[144:147],v[184:187]
v_exp_f32 v140, v140
M a[92:95],a[148:151],v[184:187]
ds_read_b128 a[140:143], v35 offset:40960
v_cvt_pk_bf16_f32 v137, v138, v139
M a[88:91],a[148:151],v[176:179]
v_exp_f32 v141, v141
M a[84:87],a[148:151],v[168:171]
buffer_load_dwordx4 v3, s[32:35], s62 offen offset:2048 lds
v_cvt_pk_bf16_f32 v138, v140, v141
M a[80:83],a[148:151],v[160:163]
s_waitcnt lgkmcnt(4)
v_exp_f32 v142, v142
M a[96:99],a[152:155],v[160:163]
ds_read_b128 a[144:147], v32 offset:45056
M a[100:103],a[152:155],v[168:171]
v_exp_f32 v143, v143
M a[104:107],a[152:155],v[176:179]
v_exp_f32 v144, v144
M a[108:111],a[152:155],v[184:187]
v_exp_f32 v145, v145
M a[124:127],a[156:159],v[184:187]
ds_read_b128 a[148:151], v33 offset:45056
v_cvt_pk_bf16_f32 v139, v142, v143
M a[120:123],a[156:159],v[176:179]
v_exp_f32 v146, v146
M a[116:119],a[156:159],v[168:171]
buffer_load_dwordx4 v4, s[32:35], s62 offen offset:3072 lds
v_cvt_pk_bf16_f32 v144, v144, v145
M a[112:115],a[156:159],v[160:163]
v_exp_f32 v147, v147
M v[208:211],v[240:243],v[160:163]
v_exp_f32 v148, v148
M v[212:215],v[240:243],v[168:171]
v_exp_f32 v149, v149
M v[216:219],v[240:243],v[176:179]
v_exp_f32 v150, v150
M v[220:223],v[240:243],v[184:187]
s_waitcnt lgkmcnt(4)
v_exp_f32 v151, v151
N v[160:163],a[128:131],v[64:67],v[192:195]
ds_read_b128 a[152:155], v34 offset:45056
v_cvt_pk_bf16_f32 v145, v146, v147
M v[160:163],a[132:135],v[68:71]
v_exp_f32 v152, v152
N v[168:171],a[132:135],v[84:87],v[196:199]
v_exp_f32 v153, v153
M v[168:171],a[128:131],v[80:83]
v_exp_f32 v154, v154
N v[176:179],a[128:131],v[96:99],v[200:203]
ds_read_b128 a[156:159], v35 offset:45056
v_cvt_pk_bf16_f32 v146, v148, v149
M v[176:179],a[132:135],v[100:103]
s_add_u32 m0, s60, 4096
v_exp_f32 v155, v155
N v[184:187],a[132:135],v[116:119],v[204:207]
buffer_load_dwordx4 v5, s[32:35], s62 offen offset:0 lds
v_cvt_pk_bf16_f32 v147, v150, v151
M v[184:187],a[128:131],v[112:115]
s_waitcnt lgkmcnt(4)
v_exp_f32 v156, v156
M v[184:187],a[140:143],v[124:127]
T a[128:129],v16,49152
T a[130:131],v16,53248
M v[184:187],a[136:139],v[120:123]
v_exp_f32 v157, v157
M v[176:179],a[136:139],v[104:107]
v_exp_f32 v158, v158
M v[176:179],a[140:143],v[108:111]
v_exp_f32 v159, v159
M v[168:171],a[140:143],v[92:95]
T a[132:133],v17,49152
T a[134:135],v17,53248
M v[168:171],a[136:139],v[88:91]
v_cvt_pk_bf16_f32 v152, v152, v153
v_cvt_pk_bf16_f32 v153, v154, v155
M v[160:163],a[136:139],v[72:75]
buffer_load_dwordx4 v6, s[32:35], s62 offen offset:1024 lds
v_cvt_pk_bf16_f32 v154, v156, v157
M v[160:163],a[140:143],v[76:79]
v_cvt_pk_bf16_f32 v155, v158, v159
s_waitcnt lgkmcnt(6)
N v[164:167],a[144:147],v[64:67],v[192:195]
T a[136:137],v18,49152
T a[138:139],v18,53248
M v[164:167],a[148:151],v[68:71]
N v[172:175],a[148:151],v[84:87],v[196:199]
M v[172:175],a[144:147],v[80:83]
N v[180:183],a[144:147],v[96:99],v[200:203]
T a[140:141],v19,49152
T a[142:143],v19,53248
M v[180:183],a[148:151],v[100:103]
N v[188:191],a[148:151],v[116:119],v[204:207]
buffer_load_dwordx4 v7, s[32:35], s62 offen offset:2048 lds
M v[188:191],a[144:147],v[112:115]
s_waitcnt lgkmcnt(8)
M v[188:191],a[156:159],v[124:127]
T a[144:145],v20,49152
T a[146:147],v20,53248
M v[188:191],a[152:155],v[120:123]
M v[180:183],a[152:155],v[104:107]
M v[180:183],a[156:159],v[108:111]
M v[172:175],a[156:159],v[92:95]
T a[148:149],v21,49152
T a[150:151],v21,53248
M v[172:175],a[152:155],v[88:91]
M v[164:167],a[152:155],v[72:75]
buffer_load_dwordx4 v8, s[32:35], s62 offen offset:3072 lds
s_add_u32 s62, s62, 262144
M v[164:167],a[156:159],v[76:79]
s_waitcnt lgkmcnt(8)
M a[0:3],a[128:131],v[128:131]
s_waitcnt vmcnt(8)
T a[152:153],v22,49152
T a[154:155],v22,53248
M a[4:7],a[128:131],v[136:139]
v_subrev_u32 v62, s74, v62
v_cmp_le_u32 vcc, 14, v62
M a[8:11],a[128:131],v[144:147]
s_cbranch_vccnz SPIN_hA
BACK_hA:
v_exp_f32 v160, v160
M a[12:15],a[128:131],v[152:155]
v_exp_f32 v161, v161
M a[28:31],a[132:135],v[152:155]
T a[156:157],v23,49152
T a[158:159],v23,53248
M a[24:27],a[132:135],v[144:147]
v_exp_f32 v162, v162
M a[20:23],a[132:135],v[136:139]
buffer_load_dwordx4 a[160:163], v58, s[12:15], s63 offen offset:0 sc1
v_cvt_pk_bf16_f32 v160, v160, v161
M a[16:19],a[132:135],v[128:131]
s_waitcnt lgkmcnt(8)
v_exp_f32 v163, v163
M a[32:35],a[136:139],v[128:131]
ds_read_b128 a[128:131], v32 offset:57344
v_cvt_pk_bf16_f32 v161, v162, v163
M a[36:39],a[136:139],v[136:139]
v_exp_f32 v164, v164
M a[40:43],a[136:139],v[144:147]
v_exp_f32 v165, v165
M a[44:47],a[136:139],v[152:155]
buffer_load_dwordx4 a[164:167], v58, s[12:15], s63 offen offset:1024 sc1
v_cvt_pk_bf16_f32 v162, v164, v165
M a[60:63],a[140:143],v[152:155]
ds_read_b128 a[132:135], v33 offset:57344
M a[56:59],a[140:143],v[144:147]
v_exp_f32 v166, v166
M a[52:55],a[140:143],v[136:139]
buffer_load_dwordx4 a[168:171], v59, s[12:15], s63 offen offset:0 sc1
M a[48:51],a[140:143],v[128:131]
s_waitcnt lgkmcnt(6)
v_exp_f32 v167, v167
M a[64:67],a[144:147],v[128:131]
ds_read_b128 a[136:139], v34 offset:57344
v_cvt_pk_bf16_f32 v163, v166, v167
M a[68:71],a[144:147],v[136:139]
v_exp_f32 v168, v168
M a[72:75],a[144:147],v[144:147]
v_exp_f32 v169, v169
M a[76:79],a[144:147],v[152:155]
buffer_load_dwordx4 a[172:175], v59, s[12:15], s63 offen offset:1024 sc1
v_cvt_pk_bf16_f32 v168, v168, v169
M a[92:95],a[148:151],v[152:155]
s_add_u32 s63, s63, 4096
ds_read_b128 a[140:143], v35 offset:57344
M a[88:91],a[148:151],v[144:147]
v_exp_f32 v170, v170
M a[84:87],a[148:151],v[136:139]
buffer_load_dwordx4 a[176:179], v58, s[12:15], s63 offen offset:0 sc1
M a[80:83],a[148:151],v[128:131]
s_waitcnt lgkmcnt(4)
v_exp_f32 v171, v171
M a[96:99],a[152:155],v[128:131]
ds_read_b128 a[144:147], v32 offset:61440
v_cvt_pk_bf16_f32 v169, v170, v171
M a[100:103],a[152:155],v[136:139]
v_exp_f32 v172, v172
M a[104:107],a[152:155],v[144:147]
v_exp_f32 v173, v173
M a[108:111],a[152:155],v[152:155]
buffer_load_dwordx4 a[180:183], v58, s[12:15], s63 offen offset:1024 sc1
v_cvt_pk_bf16_f32 v170, v172, v173
M a[124:127],a[156:159],v[152:155]
ds_read_b128 a[148:151], v33 offset:61440
M a[120:123],a[156:159],v[144:147]
v_exp_f32 v174, v174
M a[116:119],a[156:159],v[136:139]
buffer_load_dwordx4 a[184:187], v59, s[12:15], s63 offen offset:0 sc1
M a[112:115],a[156:159],v[128:131]
v_exp_f32 v175, v175
M v[208:211],v[240:243],v[128:131]
v_exp_f32 v176, v176
M v[212:215],v[240:243],v[136:139]
v_exp_f32 v177, v177
M v[216:219],v[240:243],v[144:147]
v_exp_f32 v178, v178
M v[220:223],v[240:243],v[152:155]
s_waitcnt lgkmcnt(4)
v_exp_f32 v179, v179
N v[128:131],a[128:131],v[64:67],v[192:195]
ds_read_b128 a[152:155], v34 offset:61440
v_cvt_pk_bf16_f32 v171, v174, v175
M v[128:131],a[132:135],v[68:71]
v_exp_f32 v180, v180
N v[136:139],a[132:135],v[84:87],v[196:199]
v_exp_f32 v181, v181
M v[136:139],a[128:131],v[80:83]
buffer_load_dwordx4 a[188:191], v59, s[12:15], s63 offen offset:1024 sc1
v_cvt_pk_bf16_f32 v176, v176, v177
N v[144:147],a[128:131],v[96:99],v[200:203]
s_add_u32 s63, s63, 4096
ds_read_b128 a[156:159], v35 offset:61440
v_cvt_pk_bf16_f32 v177, v178, v179
M v[144:147],a[132:135],v[100:103]
v_exp_f32 v182, v182
N v[152:155],a[132:135],v[116:119],v[204:207]
buffer_load_dwordx4 a[192:195], v58, s[12:15], s63 offen offset:0 sc1
v_cvt_pk_bf16_f32 v178, v180, v181
M v[152:155],a[128:131],v[112:115]
s_waitcnt vmcnt(42)
s_barrier
s_waitcnt lgkmcnt(4)
M v[152:155],a[140:143],v[124:127]
T a[128:129],v24,0
T a[130:131],v24,4096
M v[152:155],a[136:139],v[120:123]
v_exp_f32 v183, v183
M v[144:147],a[136:139],v[104:107]
v_exp_f32 v184, v184
M v[144:147],a[140:143],v[108:111]
buffer_load_dwordx4 a[196:199], v58, s[12:15], s63 offen offset:1024 sc1
v_add_u32 v16, 131072, v16
M v[136:139],a[140:143],v[92:95]
T a[132:133],v25,0
T a[134:135],v25,4096
M v[136:139],a[136:139],v[88:91]
v_exp_f32 v185, v185
M v[128:131],a[136:139],v[72:75]
buffer_load_dwordx4 a[200:203], v59, s[12:15], s63 offen offset:0 sc1
v_add_u32 v17, 131072, v17
M v[128:131],a[140:143],v[76:79]
s_waitcnt lgkmcnt(6)
v_exp_f32 v186, v186
N v[132:135],a[144:147],v[64:67],v[192:195]
T a[136:137],v26,0
T a[138:139],v26,4096
M v[132:135],a[148:151],v[68:71]
v_exp_f32 v187, v187
N v[140:143],a[148:151],v[84:87],v[196:199]
v_exp_f32 v188, v188
M v[140:143],a[144:147],v[80:83]
v_exp_f32 v189, v189
N v[148:151],a[144:147],v[96:99],v[200:203]
T a[140:141],v27,0
T a[142:143],v27,4096
M v[148:151],a[148:151],v[100:103]
v_exp_f32 v190, v190
N v[156:159],a[148:151],v[116:119],v[204:207]
buffer_load_dwordx4 a[204:207], v59, s[12:15], s63 offen offset:1024 sc1
v_add_u32 v18, 131072, v18
M v[156:159],a[144:147],v[112:115]
s_waitcnt lgkmcnt(8)
v_exp_f32 v191, v191
M v[156:159],a[156:159],v[124:127]
s_add_u32 s63, s63, 4096
T a[144:145],v28,0
T a[146:147],v28,4096
M v[156:159],a[152:155],v[120:123]
v_add_u32 v19, 131072, v19
v_add_u32 v20, 131072, v20
M v[148:151],a[152:155],v[104:107]
v_add_u32 v21, 131072, v21
v_add_u32 v22, 131072, v22
M v[148:151],a[156:159],v[108:111]
v_add_u32 v23, 131072, v23
v_cvt_pk_bf16_f32 v179, v182, v183
M v[140:143],a[156:159],v[92:95]
T a[148:149],v29,0
T a[150:151],v29,4096
M v[140:143],a[152:155],v[88:91]
v_cvt_pk_bf16_f32 v184, v184, v185
v_cvt_pk_bf16_f32 v185, v186, v187
M v[132:135],a[152:155],v[72:75]
buffer_load_dwordx4 a[208:211], v58, s[12:15], s63 offen offset:0 sc1
v_cvt_pk_bf16_f32 v186, v188, v189
M v[132:135],a[156:159],v[76:79]
v_cvt_pk_bf16_f32 v187, v190, v191
s_barrier
s_waitcnt lgkmcnt(8)
M a[0:3],a[128:131],v[160:163]
T a[152:153],v30,0
T a[154:155],v30,4096
M a[4:7],a[128:131],v[168:171]
v_exp_f32 v128, v128
M a[8:11],a[128:131],v[176:179]
v_exp_f32 v129, v129
M a[12:15],a[128:131],v[184:187]
v_exp_f32 v130, v130
M a[28:31],a[132:135],v[184:187]
T a[156:157],v31,0
T a[158:159],v31,4096
M a[24:27],a[132:135],v[176:179]
s_add_u32 m0, s60, 32768
v_exp_f32 v131, v131
M a[20:23],a[132:135],v[168:171]
buffer_load_dwordx4 v1, s[32:35], s62 offen offset:0 lds
v_cvt_pk_bf16_f32 v128, v128, v129
M a[16:19],a[132:135],v[160:163]
s_waitcnt lgkmcnt(8)
v_exp_f32 v132, v132
M a[32:35],a[136:139],v[160:163]
ds_read_b128 a[128:131], v36 offset:8192
v_cvt_pk_bf16_f32 v129, v130, v131
M a[36:39],a[136:139],v[168:171]
v_exp_f32 v133, v133
M a[40:43],a[136:139],v[176:179]
v_exp_f32 v134, v134
M a[44:47],a[136:139],v[184:187]
v_exp_f32 v135, v135
M a[60:63],a[140:143],v[184:187]
ds_read_b128 a[132:135], v37 offset:8192
v_cvt_pk_bf16_f32 v130, v132, v133
M a[56:59],a[140:143],v[176:179]
v_exp_f32 v136, v136
M a[52:55],a[140:143],v[168:171]
buffer_load_dwordx4 v2, s[32:35], s62 offen offset:1024 lds
v_cvt_pk_bf16_f32 v131, v134, v135
M a[48:51],a[140:143],v[160:163]
s_waitcnt lgkmcnt(6)
v_exp_f32 v137, v137
M a[64:67],a[144:147],v[160:163]
ds_read_b128 a[136:139], v38 offset:8192
v_cvt_pk_bf16_f32 v136, v136, v137
M a[68:71],a[144:147],v[168:171]
v_exp_f32 v138, v138
M a[72:75],a[144:147],v[176:179]
v_exp_f32 v139, v139
M a[76:79],a[144:147],v[184:187]
v_exp_f32 v140, v140
M a[92:95],a[148:151],v[184:187]
ds_read_b128 a[140:143], v39 offset:8192
v_cvt_pk_bf16_f32 v137, v138, v139
M a[88:91],a[148:151],v[176:179]
v_exp_f32 v141, v141
M a[84:87],a[148:151],v[168:171]
buffer_load_dwordx4 v3, s[32:35], s62 offen offset:2048 lds
v_cvt_pk_bf16_f32 v138, v140, v141
M a[80:83],a[148:151],v[160:163]
s_waitcnt lgkmcnt(4)
v_exp_f32 v142, v142
M a[96:99],a[152:155],v[160:163]
ds_read_b128 a[144:147], v36 offset:12288
M a[100:103],a[152:155],v[168:171]
v_exp_f32 v143, v143
M a[104:107],a[152:155],v[176:179]
v_exp_f32 v144, v144
M a[108:111],a[152:155],v[184:187]
v_exp_f32 v145, v145
M a[124:127],a[156:159],v[184:187]
ds_read_b128 a[148:151], v37 offset:12288
v_cvt_pk_bf16_f32 v139, v142, v143
M a[120:123],a[156:159],v[176:179]
v_exp_f32 v146, v146
M a[116:119],a[156:159],v[168:171]
buffer_load_dwordx4 v4, s[32:35], s62 offen offset:3072 lds
v_cvt_pk_bf16_f32 v144, v144, v145
M a[112:115],a[156:159],v[160:163]
v_exp_f32 v147, v147
M v[208:211],v[240:243],v[160:163]
v_exp_f32 v148, v148
M v[212:215],v[240:243],v[168:171]
v_exp_f32 v149, v149
M v[216:219],v[240:243],v[176:179]
v_exp_f32 v150, v150
M v[220:223],v[240:243],v[184:187]
s_waitcnt lgkmcnt(4)
v_exp_f32 v151, v151
N v[160:163],a[128:131],v[64:67],v[192:195]
ds_read_b128 a[152:155], v38 offset:12288
v_cvt_pk_bf16_f32 v145, v146, v147
M v[160:163],a[132:135],v[68:71]
v_exp_f32 v152, v152
N v[168:171],a[132:135],v[84:87],v[196:199]
v_exp_f32 v153, v153
M v[168:171],a[128:131],v[80:83]
v_exp_f32 v154, v154
N v[176:179],a[128:131],v[96:99],v[200:203]
ds_read_b128 a[156:159], v39 offset:12288
v_cvt_pk_bf16_f32 v146, v148, v149
M v[176:179],a[132:135],v[100:103]
s_add_u32 m0, s60, 36864
v_exp_f32 v155, v155
N v[184:187],a[132:135],v[116:119],v[204:207]
buffer_load_dwordx4 v5, s[32:35], s62 offen offset:0 lds
v_cvt_pk_bf16_f32 v147, v150, v151
M v[184:187],a[128:131],v[112:115]
s_waitcnt lgkmcnt(4)
v_exp_f32 v156, v156
M v[184:187],a[140:143],v[124:127]
T a[128:129],v24,16384
T a[130:131],v24,20480
M v[184:187],a[136:139],v[120:123]
v_exp_f32 v157, v157
M v[176:179],a[136:139],v[104:107]
v_exp_f32 v158, v158
M v[176:179],a[140:143],v[108:111]
buffer_load_dwordx4 a[212:215], v58, s[12:15], s63 offen offset:1024 sc1
v_cvt_pk_bf16_f32 v152, v152, v153
M v[168:171],a[140:143],v[92:95]
T a[132:133],v25,16384
T a[134:135],v25,20480
M v[168:171],a[136:139],v[88:91]
v_exp_f32 v159, v159
M v[160:163],a[136:139],v[72:75]
buffer_load_dwordx4 v6, s[32:35], s62 offen offset:1024 lds
v_cvt_pk_bf16_f32 v153, v154, v155
M v[160:163],a[140:143],v[76:79]
s_waitcnt lgkmcnt(6)
v_cvt_pk_bf16_f32 v154, v156, v157
v_cvt_pk_bf16_f32 v155, v158, v159
N v[164:167],a[144:147],v[64:67],v[192:195]
T a[136:137],v26,16384
T a[138:139],v26,20480
M v[164:167],a[148:151],v[68:71]
N v[172:175],a[148:151],v[84:87],v[196:199]
M v[172:175],a[144:147],v[80:83]
N v[180:183],a[144:147],v[96:99],v[200:203]
T a[140:141],v27,16384
T a[142:143],v27,20480
M v[180:183],a[148:151],v[100:103]
N v[188:191],a[148:151],v[116:119],v[204:207]
buffer_load_dwordx4 v7, s[32:35], s62 offen offset:2048 lds
M v[188:191],a[144:147],v[112:115]
s_waitcnt lgkmcnt(8)
M v[188:191],a[156:159],v[124:127]
T a[144:145],v28,16384
T a[146:147],v28,20480
M v[188:191],a[152:155],v[120:123]
M v[180:183],a[152:155],v[104:107]
M v[180:183],a[156:159],v[108:111]
buffer_load_dwordx4 a[216:219], v59, s[12:15], s63 offen offset:0 sc1
M v[172:175],a[156:159],v[92:95]
T a[148:149],v29,16384
T a[150:151],v29,20480
M v[172:175],a[152:155],v[88:91]
M v[164:167],a[152:155],v[72:75]
buffer_load_dwordx4 v8, s[32:35], s62 offen offset:3072 lds
s_add_u32 s62, s62, 262144
M v[164:167],a[156:159],v[76:79]
s_waitcnt lgkmcnt(8)
M a[0:3],a[128:131],v[128:131]
T a[152:153],v30,16384
T a[154:155],v30,20480
M a[4:7],a[128:131],v[136:139]
v_exp_f32 v160, v160
M a[8:11],a[128:131],v[144:147]
v_exp_f32 v161, v161
M a[12:15],a[128:131],v[152:155]
v_exp_f32 v162, v162
M a[28:31],a[132:135],v[152:155]
T a[156:157],v31,16384
T a[158:159],v31,20480
M a[24:27],a[132:135],v[144:147]
v_exp_f32 v163, v163
M a[20:23],a[132:135],v[136:139]
buffer_load_dwordx4 a[220:223], v59, s[12:15], s63 offen offset:1024 sc1
v_cvt_pk_bf16_f32 v160, v160, v161
M a[16:19],a[132:135],v[128:131]
s_waitcnt lgkmcnt(8)
v_exp_f32 v164, v164
M a[32:35],a[136:139],v[128:131]
s_add_u32 s63, s63, 4096
ds_read_b128 a[128:131], v36 offset:24576
v_cvt_pk_bf16_f32 v161, v162, v163
M a[36:39],a[136:139],v[136:139]
v_exp_f32 v165, v165
M a[40:43],a[136:139],v[144:147]
L_pad6:
s_cbranch_execz L_pad10
v_exp_f32 v166, v166
M a[44:47],a[136:139],v[152:155]
v_exp_f32 v167, v167
M a[60:63],a[140:143],v[152:155]
ds_read_b128 a[132:135], v37 offset:24576
v_cvt_pk_bf16_f32 v162, v164, v165
M a[56:59],a[140:143],v[144:147]
v_exp_f32 v168, v168
M a[52:55],a[140:143],v[136:139]
buffer_load_dwordx4 a[224:227], v58, s[12:15], s63 offen offset:0 sc1
v_cvt_pk_bf16_f32 v163, v166, v167
M a[48:51],a[140:143],v[128:131]
s_waitcnt lgkmcnt(6)
v_exp_f32 v169, v169
M a[64:67],a[144:147],v[128:131]
ds_read_b128 a[136:139], v38 offset:24576
v_cvt_pk_bf16_f32 v168, v168, v169
M a[68:71],a[144:147],v[136:139]
v_exp_f32 v170, v170
M a[72:75],a[144:147],v[144:147]
v_exp_f32 v171, v171
M a[76:79],a[144:147],v[152:155]
v_exp_f32 v172, v172
M a[92:95],a[148:151],v[152:155]
ds_read_b128 a[140:143], v39 offset:24576
v_cvt_pk_bf16_f32 v169, v170, v171
M a[88:91],a[148:151],v[144:147]
v_exp_f32 v173, v173
M a[84:87],a[148:151],v[136:139]
buffer_load_dwordx4 a[228:231], v58, s[12:15], s63 offen offset:1024 sc1
v_cvt_pk_bf16_f32 v170, v172, v173
M a[80:83],a[148:151],v[128:131]
s_waitcnt lgkmcnt(4)
v_exp_f32 v174, v174
M a[96:99],a[152:155],v[128:131]
ds_read_b128 a[144:147], v36 offset:28672
M a[100:103],a[152:155],v[136:139]
v_exp_f32 v175, v175
M a[104:107],a[152:155],v[144:147]
v_exp_f32 v176, v176
M a[108:111],a[152:155],v[152:155]
v_exp_f32 v177, v177
M a[124:127],a[156:159],v[152:155]
ds_read_b128 a[148:151], v37 offset:28672
v_cvt_pk_bf16_f32 v171, v174, v175
M a[120:123],a[156:159],v[144:147]
v_exp_f32 v178, v178
M a[116:119],a[156:159],v[136:139]
buffer_load_dwordx4 a[232:235], v59, s[12:15], s63 offen offset:0 sc1
v_cvt_pk_bf16_f32 v176, v176, v177
M a[112:115],a[156:159],v[128:131]
v_exp_f32 v179, v179
M v[208:211],v[240:243],v[128:131]
v_exp_f32 v180, v180
M v[212:215],v[240:243],v[136:139]
v_exp_f32 v181, v181
M v[216:219],v[240:243],v[144:147]
v_exp_f32 v182, v182
M v[220:223],v[240:243],v[152:155]
s_waitcnt lgkmcnt(4)
v_exp_f32 v183, v183
N v[128:131],a[128:131],v[64:67],v[192:195]
ds_read_b128 a[152:155], v38 offset:28672
v_cvt_pk_bf16_f32 v177, v178, v179
M v[128:131],a[132:135],v[68:71]
v_exp_f32 v184, v184
N v[136:139],a[132:135],v[84:87],v[196:199]
v_exp_f32 v185, v185
M v[136:139],a[128:131],v[80:83]
v_exp_f32 v186, v186
N v[144:147],a[128:131],v[96:99],v[200:203]
ds_read_b128 a[156:159], v39 offset:28672
v_cvt_pk_bf16_f32 v178, v180, v181
M v[144:147],a[132:135],v[100:103]
v_exp_f32 v187, v187
N v[152:155],a[132:135],v[116:119],v[204:207]
buffer_load_dwordx4 a[236:239], v59, s[12:15], s63 offen offset:1024 sc1
v_cvt_pk_bf16_f32 v179, v182, v183
M v[152:155],a[128:131],v[112:115]
s_waitcnt vmcnt(41)
s_barrier
s_waitcnt lgkmcnt(4)
M v[152:155],a[140:143],v[124:127]
s_add_u32 s63, s63, 4096
T a[128:129],v24,32768
T a[130:131],v24,36864
M v[152:155],a[136:139],v[120:123]
v_exp_f32 v188, v188
M v[144:147],a[136:139],v[104:107]
v_exp_f32 v189, v189
M v[144:147],a[140:143],v[108:111]
v_exp_f32 v190, v190
M v[136:139],a[140:143],v[92:95]
T a[132:133],v25,32768
T a[134:135],v25,36864
M v[136:139],a[136:139],v[88:91]
v_exp_f32 v191, v191
M v[128:131],a[136:139],v[72:75]
buffer_load_dwordx4 a[240:243], v58, s[12:15], s63 offen offset:0 sc1
v_cvt_pk_bf16_f32 v184, v184, v185
M v[128:131],a[140:143],v[76:79]
s_waitcnt lgkmcnt(6)
v_cvt_pk_bf16_f32 v185, v186, v187
v_cvt_pk_bf16_f32 v186, v188, v189
N v[132:135],a[144:147],v[64:67],v[192:195]
T a[136:137],v26,32768
T a[138:139],v26,36864
M v[132:135],a[148:151],v[68:71]
v_cvt_pk_bf16_f32 v187, v190, v191
N v[140:143],a[148:151],v[84:87],v[196:199]
M v[140:143],a[144:147],v[80:83]
N v[148:151],a[144:147],v[96:99],v[200:203]
T a[140:141],v27,32768
T a[142:143],v27,36864
M v[148:151],a[148:151],v[100:103]
N v[156:159],a[148:151],v[116:119],v[204:207]
buffer_load_dwordx4 a[244:247], v58, s[12:15], s63 offen offset:1024 sc1
M v[156:159],a[144:147],v[112:115]
s_waitcnt lgkmcnt(8)
M v[156:159],a[156:159],v[124:127]
T a[144:145],v28,32768
T a[146:147],v28,36864
M v[156:159],a[152:155],v[120:123]
M v[148:151],a[152:155],v[104:107]
M v[148:151],a[156:159],v[108:111]
M v[140:143],a[156:159],v[92:95]
T a[148:149],v29,32768
T a[150:151],v29,36864
M v[140:143],a[152:155],v[88:91]
M v[132:135],a[152:155],v[72:75]
buffer_load_dwordx4 a[248:251], v59, s[12:15], s63 offen offset:0 sc1
M v[132:135],a[156:159],v[76:79]
s_barrier
s_waitcnt lgkmcnt(8)
M a[0:3],a[128:131],v[160:163]
T a[152:153],v30,32768
T a[154:155],v30,36864
M a[4:7],a[128:131],v[168:171]
v_exp_f32 v128, v128
M a[8:11],a[128:131],v[176:179]
v_exp_f32 v129, v129
M a[12:15],a[128:131],v[184:187]
v_exp_f32 v130, v130
M a[28:31],a[132:135],v[184:187]
T a[156:157],v31,32768
T a[158:159],v31,36864
M a[24:27],a[132:135],v[176:179]
s_add_u32 m0, s60, 65536
v_exp_f32 v131, v131
M a[20:23],a[132:135],v[168:171]
buffer_load_dwordx4 v1, s[32:35], s62 offen offset:0 lds
v_cvt_pk_bf16_f32 v128, v128, v129
M a[16:19],a[132:135],v[160:163]
s_waitcnt lgkmcnt(8)
v_exp_f32 v132, v132
M a[32:35],a[136:139],v[160:163]
ds_read_b128 a[128:131], v36 offset:40960
v_cvt_pk_bf16_f32 v129, v130, v131
M a[36:39],a[136:139],v[168:171]
v_exp_f32 v133, v133
M a[40:43],a[136:139],v[176:179]
v_exp_f32 v134, v134
M a[44:47],a[136:139],v[184:187]
v_exp_f32 v135, v135
M a[60:63],a[140:143],v[184:187]
ds_read_b128 a[132:135], v37 offset:40960
v_cvt_pk_bf16_f32 v130, v132, v133
M a[56:59],a[140:143],v[176:179]
v_exp_f32 v136, v136
M a[52:55],a[140:143],v[168:171]
buffer_load_dwordx4 v2, s[32:35], s62 offen offset:1024 lds
v_cvt_pk_bf16_f32 v131, v134, v135
M a[48:51],a[140:143],v[160:163]
s_waitcnt lgkmcnt(6)
v_exp_f32 v137, v137
M a[64:67],a[144:147],v[160:163]
ds_read_b128 a[136:139], v38 offset:40960
v_cvt_pk_bf16_f32 v136, v136, v137
M a[68:71],a[144:147],v[168:171]
v_exp_f32 v138, v138
M a[72:75],a[144:147],v[176:179]
v_exp_f32 v139, v139
M a[76:79],a[144:147],v[184:187]
v_exp_f32 v140, v140
M a[92:95],a[148:151],v[184:187]
ds_read_b128 a[140:143], v39 offset:40960
v_cvt_pk_bf16_f32 v137, v138, v139
M a[88:91],a[148:151],v[176:179]
v_exp_f32 v141, v141
M a[84:87],a[148:151],v[168:171]
buffer_load_dwordx4 v3, s[32:35], s62 offen offset:2048 lds
v_cvt_pk_bf16_f32 v138, v140, v141
M a[80:83],a[148:151],v[160:163]
s_waitcnt lgkmcnt(4)
v_exp_f32 v142, v142
M a[96:99],a[152:155],v[160:163]
ds_read_b128 a[144:147], v36 offset:45056
M a[100:103],a[152:155],v[168:171]
v_exp_f32 v143, v143
M a[104:107],a[152:155],v[176:179]
v_exp_f32 v144, v144
M a[108:111],a[152:155],v[184:187]
v_exp_f32 v145, v145
M a[124:127],a[156:159],v[184:187]
ds_read_b128 a[148:151], v37 offset:45056
v_cvt_pk_bf16_f32 v139, v142, v143
M a[120:123],a[156:159],v[176:179]
v_exp_f32 v146, v146
M a[116:119],a[156:159],v[168:171]
buffer_load_dwordx4 v4, s[32:35], s62 offen offset:3072 lds
v_cvt_pk_bf16_f32 v144, v144, v145
M a[112:115],a[156:159],v[160:163]
v_exp_f32 v147, v147
M v[208:211],v[240:243],v[160:163]
v_exp_f32 v148, v148
M v[212:215],v[240:243],v[168:171]
v_exp_f32 v149, v149
M v[216:219],v[240:243],v[176:179]
v_exp_f32 v150, v150
M v[220:223],v[240:243],v[184:187]
s_waitcnt lgkmcnt(4)
v_exp_f32 v151, v151
N v[160:163],a[128:131],v[64:67],v[192:195]
ds_read_b128 a[152:155], v38 offset:45056
v_cvt_pk_bf16_f32 v145, v146, v147
M v[160:163],a[132:135],v[68:71]
v_exp_f32 v152, v152
N v[168:171],a[132:135],v[84:87],v[196:199]
v_exp_f32 v153, v153
M v[168:171],a[128:131],v[80:83]
v_exp_f32 v154, v154
N v[176:179],a[128:131],v[96:99],v[200:203]
ds_read_b128 a[156:159], v39 offset:45056
v_cvt_pk_bf16_f32 v146, v148, v149
M v[176:179],a[132:135],v[100:103]
s_add_u32 m0, s60, 69632
v_exp_f32 v155, v155
N v[184:187],a[132:135],v[116:119],v[204:207]
buffer_load_dwordx4 v5, s[32:35], s62 offen offset:0 lds
v_cvt_pk_bf16_f32 v147, v150, v151
M v[184:187],a[128:131],v[112:115]
s_waitcnt lgkmcnt(4)
v_exp_f32 v156, v156
M v[184:187],a[140:143],v[124:127]
T a[128:129],v24,49152
T a[130:131],v24,53248
M v[184:187],a[136:139],v[120:123]
v_exp_f32 v157, v157
M v[176:179],a[136:139],v[104:107]
v_exp_f32 v158, v158
M v[176:179],a[140:143],v[108:111]
v_exp_f32 v159, v159
M v[168:171],a[140:143],v[92:95]
T a[132:133],v25,49152
T a[134:135],v25,53248
M v[168:171],a[136:139],v[88:91]
v_cvt_pk_bf16_f32 v152, v152, v153
v_cvt_pk_bf16_f32 v153, v154, v155
M v[160:163],a[136:139],v[72:75]
buffer_load_dwordx4 v6, s[32:35], s62 offen offset:1024 lds
v_cvt_pk_bf16_f32 v154, v156, v157
M v[160:163],a[140:143],v[76:79]
v_cvt_pk_bf16_f32 v155, v158, v159
s_waitcnt lgkmcnt(6)
N v[164:167],a[144:147],v[64:67],v[192:195]
T a[136:137],v26,49152
T a[138:139],v26,53248
M v[164:167],a[148:151],v[68:71]
v_exp_f32 v168, v168
N v[172:175],a[148:151],v[84:87],v[196:199]
v_exp_f32 v160, v160
M v[172:175],a[144:147],v[80:83]
v_exp_f32 v161, v161
N v[180:183],a[144:147],v[96:99],v[200:203]
T a[140:141],v27,49152
T a[142:143],v27,53248
M v[180:183],a[148:151],v[100:103]
v_exp_f32 v162, v162
N v[188:191],a[148:151],v[116:119],v[204:207]
buffer_load_dwordx4 v7, s[32:35], s62 offen offset:2048 lds
v_cvt_pk_bf16_f32 v160, v160, v161
M v[188:191],a[144:147],v[112:115]
s_waitcnt lgkmcnt(8)
v_exp_f32 v163, v163
M v[188:191],a[156:159],v[124:127]
T a[144:145],v28,49152
T a[146:147],v28,53248
M v[188:191],a[152:155],v[120:123]
v_exp_f32 v169, v169
M v[180:183],a[152:155],v[104:107]
v_exp_f32 v170, v170
M v[180:183],a[156:159],v[108:111]
v_exp_f32 v171, v171
M v[172:175],a[156:159],v[92:95]
T a[148:149],v29,49152
T a[150:151],v29,53248
M v[172:175],a[152:155],v[88:91]
v_exp_f32 v176, v176
M v[164:167],a[152:155],v[72:75]
buffer_load_dwordx4 v8, s[32:35], s62 offen offset:3072 lds
v_cvt_pk_bf16_f32 v161, v162, v163
M v[164:167],a[156:159],v[76:79]
s_waitcnt lgkmcnt(8)
v_exp_f32 v177, v177
M a[0:3],a[128:131],v[128:131]
s_add_u32 s62, s62, 262144
T a[152:153],v30,49152
T a[154:155],v30,53248
M a[4:7],a[128:131],v[136:139]
v_exp_f32 v178, v178
M a[8:11],a[128:131],v[144:147]
v_exp_f32 v179, v179
M a[12:15],a[128:131],v[152:155]
v_exp_f32 v184, v184
M a[28:31],a[132:135],v[152:155]
T a[156:157],v31,49152
T a[158:159],v31,53248
M a[24:27],a[132:135],v[144:147]
v_exp_f32 v185, v185
M a[20:23],a[132:135],v[136:139]
buffer_load_dwordx4 a[252:255], v59, s[12:15], s63 offen offset:1024 sc1
v_cvt_pk_bf16_f32 v168, v168, v169
M a[16:19],a[132:135],v[128:131]
s_waitcnt lgkmcnt(8)
v_exp_f32 v186, v186
M a[32:35],a[136:139],v[128:131]
s_add_u32 s63, s63, 4096
T a[128:129],v30,57344
T a[130:131],v30,61440
M a[36:39],a[136:139],v[136:139]
v_exp_f32 v187, v187
M a[40:43],a[136:139],v[144:147]
v_exp_f32 v164, v164
M a[44:47],a[136:139],v[152:155]
v_exp_f32 v165, v165
M a[60:63],a[140:143],v[152:155]
T a[132:133],v31,57344
T a[134:135],v31,61440
M a[56:59],a[140:143],v[144:147]
v_exp_f32 v166, v166
M a[52:55],a[140:143],v[136:139]
v_exp_f32 v167, v167
M a[48:51],a[140:143],v[128:131]
s_waitcnt lgkmcnt(8)
v_exp_f32 v172, v172
M a[64:67],a[144:147],v[128:131]
T a[136:137],v24,57344
T a[138:139],v24,61440
M a[68:71],a[144:147],v[136:139]
v_exp_f32 v173, v173
M a[72:75],a[144:147],v[144:147]
v_exp_f32 v174, v174
M a[76:79],a[144:147],v[152:155]
v_exp_f32 v175, v175
M a[92:95],a[148:151],v[152:155]
T a[140:141],v25,57344
T a[142:143],v25,61440
M a[88:91],a[148:151],v[144:147]
v_exp_f32 v180, v180
M a[84:87],a[148:151],v[136:139]
v_exp_f32 v181, v181
M a[80:83],a[148:151],v[128:131]
s_waitcnt lgkmcnt(8)
v_exp_f32 v182, v182
M a[96:99],a[152:155],v[128:131]
T a[144:145],v26,57344
T a[146:147],v26,61440
M a[100:103],a[152:155],v[136:139]
v_exp_f32 v183, v183
M a[104:107],a[152:155],v[144:147]
v_exp_f32 v188, v188
M a[108:111],a[152:155],v[152:155]
v_exp_f32 v189, v189
M a[124:127],a[156:159],v[152:155]
T a[148:149],v27,57344
T a[150:151],v27,61440
M a[120:123],a[156:159],v[144:147]
v_exp_f32 v190, v190
M a[116:119],a[156:159],v[136:139]
v_exp_f32 v191, v191
M a[112:115],a[156:159],v[128:131]
v_cvt_pk_bf16_f32 v169, v170, v171
v_cvt_pk_bf16_f32 v176, v176, v177
M v[208:211],v[240:243],v[128:131]
v_cvt_pk_bf16_f32 v177, v178, v179
v_cvt_pk_bf16_f32 v184, v184, v185
M v[212:215],v[240:243],v[136:139]
v_cvt_pk_bf16_f32 v185, v186, v187
v_cvt_pk_bf16_f32 v162, v164, v165
M v[216:219],v[240:243],v[144:147]
v_cvt_pk_bf16_f32 v163, v166, v167
v_cvt_pk_bf16_f32 v170, v172, v173
M v[220:223],v[240:243],v[152:155]
v_cvt_pk_bf16_f32 v171, v174, v175
v_cvt_pk_bf16_f32 v178, v180, v181
v_cvt_pk_bf16_f32 v179, v182, v183
v_cvt_pk_bf16_f32 v186, v188, v189
v_cvt_pk_bf16_f32 v187, v190, v191
M v[208:211],v[240:243],v[160:163]
M v[212:215],v[240:243],v[168:171]
M v[216:219],v[240:243],v[176:179]
M v[220:223],v[240:243],v[184:187]
s_waitcnt lgkmcnt(8)
M a[96:99],a[128:131],v[160:163]
s_mov_b32 s70, 0x4e800000
T a[152:153],v28,57344
T a[154:155],v28,61440
M a[100:103],a[128:131],v[168:171]
v_rcp_f32 v9, v208
M a[104:107],a[128:131],v[176:179]
v_rcp_f32 v10, v212
M a[108:111],a[128:131],v[184:187]
buffer_load_dwordx2 v[36:37], v63, s[48:51], s58 offen offset:0
v_add_f32 v40, v208, v212
M a[124:127],a[132:135],v[184:187]
T a[156:157],v29,57344
T a[158:159],v29,61440
M a[120:123],a[132:135],v[176:179]
v_rcp_f32 v11, v216
M a[116:119],a[132:135],v[168:171]
buffer_load_dwordx2 v[38:39], v63, s[48:51], s58 offen offset:32
v_add_f32 v41, v216, v220
M a[112:115],a[132:135],v[160:163]
v_add_f32 v40, v40, v41
v_cmp_nge_f32 vcc, s70, v40
v_rcp_f32 v12, v220
s_cbranch_vccnz L_slowA
L_normA:
s_waitcnt vmcnt(63)
s_barrier
s_waitcnt lgkmcnt(8)
M a[0:3],a[136:139],v[160:163]
T a[128:129],v16,0
T a[130:131],v16,4096
M a[4:7],a[136:139],v[168:171]
v_accvgpr_read_b32 v40, a96
v_accvgpr_read_b32 v41, a97
M a[8:11],a[136:139],v[176:179]
v_accvgpr_read_b32 v42, a98
v_accvgpr_read_b32 v43, a99
M a[12:15],a[136:139],v[184:187]
v_accvgpr_read_b32 v44, a112
v_accvgpr_read_b32 v45, a113
M a[28:31],a[140:143],v[184:187]
T a[132:133],v16,8192
T a[134:135],v16,12288
M a[24:27],a[140:143],v[176:179]
v_accvgpr_read_b32 v46, a114
v_accvgpr_read_b32 v47, a115
M a[20:23],a[140:143],v[168:171]
v_accvgpr_read_b32 v48, a100
v_accvgpr_read_b32 v49, a101
M a[16:19],a[140:143],v[160:163]
v_accvgpr_read_b32 v50, a102
v_accvgpr_read_b32 v51, a103
v_accvgpr_read_b32 v52, a116
v_accvgpr_read_b32 v53, a117
v_accvgpr_read_b32 v54, a118
v_accvgpr_read_b32 v55, a119
v_pk_mul_f32 v[40:41], v[40:41], v[8:9] op_sel:[0,1] op_sel_hi:[1,1]
v_pk_mul_f32 v[42:43], v[42:43], v[8:9] op_sel:[0,1] op_sel_hi:[1,1]
v_pk_mul_f32 v[44:45], v[44:45], v[8:9] op_sel:[0,1] op_sel_hi:[1,1]
v_pk_mul_f32 v[46:47], v[46:47], v[8:9] op_sel:[0,1] op_sel_hi:[1,1]
v_pk_mul_f32 v[48:49], v[48:49], v[10:11] op_sel:[0,0] op_sel_hi:[1,0]
v_pk_mul_f32 v[50:51], v[50:51], v[10:11] op_sel:[0,0] op_sel_hi:[1,0]
v_pk_mul_f32 v[52:53], v[52:53], v[10:11] op_sel:[0,0] op_sel_hi:[1,0]
v_pk_mul_f32 v[54:55], v[54:55], v[10:11] op_sel:[0,0] op_sel_hi:[1,0]
s_waitcnt lgkmcnt(8)
M a[32:35],a[144:147],v[160:163]
T a[136:137],v17,0
T a[138:139],v17,4096
M a[36:39],a[144:147],v[168:171]
v_cvt_pk_bf16_f32 v192, v40, v41
v_cvt_pk_bf16_f32 v193, v42, v43
M a[40:43],a[144:147],v[176:179]
v_cvt_pk_bf16_f32 v194, v44, v45
v_cvt_pk_bf16_f32 v195, v46, v47
M a[44:47],a[144:147],v[184:187]
v_cvt_pk_bf16_f32 v196, v48, v49
v_cvt_pk_bf16_f32 v197, v50, v51
M a[60:63],a[148:151],v[184:187]
T a[140:141],v17,8192
T a[142:143],v17,12288
M a[56:59],a[148:151],v[176:179]
v_cvt_pk_bf16_f32 v198, v52, v53
v_cvt_pk_bf16_f32 v199, v54, v55
M a[52:55],a[148:151],v[168:171]
v_accvgpr_read_b32 v40, a104
v_accvgpr_read_b32 v41, a105
M a[48:51],a[148:151],v[160:163]
s_waitcnt lgkmcnt(8)
v_accvgpr_read_b32 v42, a106
v_accvgpr_read_b32 v43, a107
M a[64:67],a[152:155],v[160:163]
T a[144:145],v18,0
T a[146:147],v18,4096
M a[68:71],a[152:155],v[168:171]
v_accvgpr_read_b32 v44, a120
v_accvgpr_read_b32 v45, a121
M a[72:75],a[152:155],v[176:179]
v_accvgpr_read_b32 v46, a122
v_accvgpr_read_b32 v47, a123
M a[76:79],a[152:155],v[184:187]
v_accvgpr_read_b32 v48, a108
v_accvgpr_read_b32 v49, a109
M a[92:95],a[156:159],v[184:187]
T a[148:149],v18,8192
T a[150:151],v18,12288
M a[88:91],a[156:159],v[176:179]
v_accvgpr_read_b32 v50, a110
v_accvgpr_read_b32 v51, a111
M a[84:87],a[156:159],v[168:171]
v_accvgpr_read_b32 v52, a124
v_accvgpr_read_b32 v53, a125
M a[80:83],a[156:159],v[160:163]
v_accvgpr_read_b32 v54, a126
v_accvgpr_read_b32 v55, a127
v_pk_mul_f32 v[40:41], v[40:41], v[10:11] op_sel:[0,1] op_sel_hi:[1,1]
v_pk_mul_f32 v[42:43], v[42:43], v[10:11] op_sel:[0,1] op_sel_hi:[1,1]
v_pk_mul_f32 v[44:45], v[44:45], v[10:11] op_sel:[0,1] op_sel_hi:[1,1]
v_pk_mul_f32 v[46:47], v[46:47], v[10:11] op_sel:[0,1] op_sel_hi:[1,1]
v_pk_mul_f32 v[48:49], v[48:49], v[12:13] op_sel:[0,0] op_sel_hi:[1,0]
v_pk_mul_f32 v[50:51], v[50:51], v[12:13] op_sel:[0,0] op_sel_hi:[1,0]
v_pk_mul_f32 v[52:53], v[52:53], v[12:13] op_sel:[0,0] op_sel_hi:[1,0]
v_pk_mul_f32 v[54:55], v[54:55], v[12:13] op_sel:[0,0] op_sel_hi:[1,0]
s_mov_b64 exec, 0
s_cmp_eq_u32 s52, 0
s_cbranch_scc1 L_pad12
s_cmp_eq_u32 s52, 1
s_cbranch_scc1 L_pad13
s_cmp_eq_u32 s52, 2
s_cbranch_scc1 L_pad14
s_branch L_pad15
L_pb2A:
s_mov_b64 exec, -1
s_barrier
s_xor_b32 s6, s6, 1024
s_waitcnt vmcnt(34)
s_waitcnt lgkmcnt(8)
N v[64:67],a[128:131],a[160:163],0
T a[152:153],v19,0
v_permlane16_swap_b32 v224, v226
M v[64:67],a[132:135],a[176:179]
T a[154:155],v19,4096
v_permlane16_swap_b32 v225, v227
N v[68:71],a[132:135],a[180:183],0
buffer_load_dwordx4 a[96:99], v58, s[12:15], s63 offen offset:0 sc1
v_permlane16_swap_b32 v228, v230
M v[68:71],a[128:131],a[164:167]
v_permlane16_swap_b32 v229, v231
v_permlane16_swap_b32 v232, v234
N v[72:75],a[128:131],a[168:171],0
T a[156:157],v19,8192
v_permlane16_swap_b32 v233, v235
M v[72:75],a[132:135],a[184:187]
T a[158:159],v19,12288
v_permlane16_swap_b32 v236, v238
N v[76:79],a[132:135],a[188:191],0
buffer_load_dwordx4 a[100:103], v58, s[12:15], s63 offen offset:1024 sc1
v_permlane16_swap_b32 v237, v239
M v[76:79],a[128:131],a[172:175]
v_permlane32_swap_b32 v224, v226
v_permlane32_swap_b32 v225, v227
v_permlane32_swap_b32 v228, v230
v_permlane32_swap_b32 v229, v231
v_permlane32_swap_b32 v232, v234
v_permlane32_swap_b32 v233, v235
v_permlane32_swap_b32 v236, v238
v_permlane32_swap_b32 v237, v239
v_accvgpr_write_b32 a112, v224
v_accvgpr_write_b32 a113, v225
v_accvgpr_write_b32 a114, v226
v_accvgpr_write_b32 a115, v227
v_accvgpr_write_b32 a116, v228
v_accvgpr_write_b32 a117, v229
v_accvgpr_write_b32 a118, v230
v_accvgpr_write_b32 a119, v231
v_accvgpr_write_b32 a120, v232
v_accvgpr_write_b32 a121, v233
v_accvgpr_write_b32 a122, v234
v_accvgpr_write_b32 a123, v235
v_accvgpr_write_b32 a124, v236
v_accvgpr_write_b32 a125, v237
v_accvgpr_write_b32 a126, v238
v_accvgpr_write_b32 a127, v239
v_cvt_pk_bf16_f32 v200, v40, v41
v_cvt_pk_bf16_f32 v201, v42, v43
v_cvt_pk_bf16_f32 v202, v44, v45
v_cvt_pk_bf16_f32 v203, v46, v47
v_cvt_pk_bf16_f32 v204, v48, v49
L_pad7:
s_cbranch_execz L_pad11
v_cvt_pk_bf16_f32 v205, v50, v51
v_cvt_pk_bf16_f32 v206, v52, v53
v_cvt_pk_bf16_f32 v207, v54, v55
v_accvgpr_read_b32 v40, a0
v_accvgpr_read_b32 v41, a1
v_accvgpr_read_b32 v42, a2
v_accvgpr_read_b32 v43, a3
v_accvgpr_read_b32 v44, a16
v_accvgpr_read_b32 v45, a17
v_accvgpr_read_b32 v46, a18
v_accvgpr_read_b32 v47, a19
v_accvgpr_read_b32 v48, a4
v_accvgpr_read_b32 v49, a5
v_accvgpr_read_b32 v50, a6
v_accvgpr_read_b32 v51, a7
v_accvgpr_read_b32 v52, a20
v_accvgpr_read_b32 v53, a21
v_accvgpr_read_b32 v54, a22
v_accvgpr_read_b32 v55, a23
v_pk_mul_f32 v[40:41], v[40:41], v[8:9] op_sel:[0,1] op_sel_hi:[1,1]
v_pk_mul_f32 v[42:43], v[42:43], v[8:9] op_sel:[0,1] op_sel_hi:[1,1]
v_pk_mul_f32 v[44:45], v[44:45], v[8:9] op_sel:[0,1] op_sel_hi:[1,1]
v_pk_mul_f32 v[46:47], v[46:47], v[8:9] op_sel:[0,1] op_sel_hi:[1,1]
v_pk_mul_f32 v[48:49], v[48:49], v[10:11] op_sel:[0,0] op_sel_hi:[1,0]
v_pk_mul_f32 v[50:51], v[50:51], v[10:11] op_sel:[0,0] op_sel_hi:[1,0]
v_pk_mul_f32 v[52:53], v[52:53], v[10:11] op_sel:[0,0] op_sel_hi:[1,0]
v_pk_mul_f32 v[54:55], v[54:55], v[10:11] op_sel:[0,0] op_sel_hi:[1,0]
s_waitcnt lgkmcnt(8)
N v[92:95],a[140:143],a[188:191],0
T a[128:129],v20,0
v_cvt_pk_bf16_f32 v208, v40, v41
M v[92:95],a[136:139],a[172:175]
T a[130:131],v20,4096
v_cvt_pk_bf16_f32 v209, v42, v43
N v[88:91],a[136:139],a[168:171],0
buffer_load_dwordx4 a[104:107], v59, s[12:15], s63 offen offset:0 sc1
v_cvt_pk_bf16_f32 v210, v44, v45
M v[88:91],a[140:143],a[184:187]
v_cvt_pk_bf16_f32 v211, v46, v47
v_cvt_pk_bf16_f32 v212, v48, v49
N v[84:87],a[140:143],a[180:183],0
T a[132:133],v20,8192
v_cvt_pk_bf16_f32 v213, v50, v51
M v[84:87],a[136:139],a[164:167]
T a[134:135],v20,12288
v_cvt_pk_bf16_f32 v214, v52, v53
N v[80:83],a[136:139],a[160:163],0
buffer_load_dwordx4 a[108:111], v59, s[12:15], s63 offen offset:1024 sc1
v_cvt_pk_bf16_f32 v215, v54, v55
M v[80:83],a[140:143],a[176:179]
s_waitcnt vmcnt(4)
v_accvgpr_read_b32 v40, a8
v_accvgpr_read_b32 v41, a9
s_waitcnt lgkmcnt(8)
N v[96:99],a[144:147],a[160:163],0
s_add_u32 s63, s63, 4096
T a[136:137],v21,0
v_lshlrev_b32 v32, 16, v36
M v[96:99],a[148:151],a[176:179]
T a[138:139],v21,4096
v_and_b32 v33, 0xffff0000, v36
N v[100:103],a[148:151],a[180:183],0
v_lshlrev_b32 v34, 16, v37
v_and_b32 v35, 0xffff0000, v37
M v[100:103],a[144:147],a[164:167]
v_lshlrev_b32 v36, 16, v38
v_and_b32 v37, 0xffff0000, v38
N v[104:107],a[144:147],a[168:171],0
T a[140:141],v21,8192
v_lshlrev_b32 v38, 16, v39
M v[104:107],a[148:151],a[184:187]
s_add_u32 m0, s60, 98304
T a[142:143],v21,12288
v_and_b32 v39, 0xffff0000, v39
N v[108:111],a[148:151],a[188:191],0
buffer_load_dwordx4 v1, s[32:35], s62 offen offset:0 lds
v_accvgpr_read_b32 v42, a10
M v[108:111],a[144:147],a[172:175]
v_accvgpr_read_b32 v43, a11
v_accvgpr_read_b32 v44, a24
v_accvgpr_read_b32 v45, a25
v_accvgpr_read_b32 v46, a26
v_accvgpr_read_b32 v47, a27
v_accvgpr_read_b32 v48, a12
v_accvgpr_read_b32 v49, a13
v_accvgpr_read_b32 v50, a14
v_accvgpr_read_b32 v51, a15
v_accvgpr_read_b32 v52, a28
v_accvgpr_read_b32 v53, a29
v_accvgpr_read_b32 v54, a30
v_accvgpr_read_b32 v55, a31
v_pk_mul_f32 v[40:41], v[40:41], v[10:11] op_sel:[0,1] op_sel_hi:[1,1]
v_pk_mul_f32 v[42:43], v[42:43], v[10:11] op_sel:[0,1] op_sel_hi:[1,1]
v_pk_mul_f32 v[44:45], v[44:45], v[10:11] op_sel:[0,1] op_sel_hi:[1,1]
v_pk_mul_f32 v[46:47], v[46:47], v[10:11] op_sel:[0,1] op_sel_hi:[1,1]
v_pk_mul_f32 v[48:49], v[48:49], v[12:13] op_sel:[0,0] op_sel_hi:[1,0]
v_pk_mul_f32 v[50:51], v[50:51], v[12:13] op_sel:[0,0] op_sel_hi:[1,0]
v_pk_mul_f32 v[52:53], v[52:53], v[12:13] op_sel:[0,0] op_sel_hi:[1,0]
v_pk_mul_f32 v[54:55], v[54:55], v[12:13] op_sel:[0,0] op_sel_hi:[1,0]
s_waitcnt lgkmcnt(8)
N v[124:127],a[156:159],a[188:191],0
T a[144:145],v22,0
v_cvt_pk_bf16_f32 v216, v40, v41
M v[124:127],a[152:155],a[172:175]
T a[146:147],v22,4096
v_cvt_pk_bf16_f32 v217, v42, v43
N v[120:123],a[152:155],a[168:171],0
buffer_load_dwordx4 a[0:3], v58, s[12:15], s63 offen offset:0 sc1
v_cvt_pk_bf16_f32 v218, v44, v45
M v[120:123],a[156:159],a[184:187]
v_cvt_pk_bf16_f32 v219, v46, v47
v_cvt_pk_bf16_f32 v220, v48, v49
N v[116:119],a[156:159],a[180:183],0
T a[148:149],v22,8192
v_cvt_pk_bf16_f32 v221, v50, v51
M v[116:119],a[152:155],a[164:167]
T a[150:151],v22,12288
v_cvt_pk_bf16_f32 v222, v52, v53
N v[112:115],a[152:155],a[160:163],0
buffer_load_dwordx4 a[4:7], v58, s[12:15], s63 offen offset:1024 sc1
v_cvt_pk_bf16_f32 v223, v54, v55
M v[112:115],a[156:159],a[176:179]
s_waitcnt lgkmcnt(8)
N v[128:131],a[128:131],a[160:163],0
T a[152:153],v23,0
v_accvgpr_read_b32 v40, a32
M v[128:131],a[132:135],a[176:179]
T a[154:155],v23,4096
v_accvgpr_read_b32 v41, a33
N v[132:135],a[132:135],a[180:183],0
buffer_load_dwordx4 a[8:11], v59, s[12:15], s63 offen offset:0 sc1
v_accvgpr_read_b32 v42, a34
M v[132:135],a[128:131],a[164:167]
v_accvgpr_read_b32 v43, a35
v_accvgpr_read_b32 v44, a48
N v[136:139],a[128:131],a[168:171],0
T a[156:157],v23,8192
v_accvgpr_read_b32 v45, a49
M v[136:139],a[132:135],a[184:187]
T a[158:159],v23,12288
v_accvgpr_read_b32 v46, a50
N v[140:143],a[132:135],a[188:191],0
buffer_load_dwordx4 a[12:15], v59, s[12:15], s63 offen offset:1024 sc1
v_accvgpr_read_b32 v47, a51
M v[140:143],a[128:131],a[172:175]
v_accvgpr_read_b32 v48, a36
v_accvgpr_read_b32 v49, a37
v_accvgpr_read_b32 v50, a38
v_accvgpr_read_b32 v51, a39
v_accvgpr_read_b32 v52, a52
v_accvgpr_read_b32 v53, a53
v_accvgpr_read_b32 v54, a54
v_accvgpr_read_b32 v55, a55
v_pk_mul_f32 v[40:41], v[40:41], v[8:9] op_sel:[0,1] op_sel_hi:[1,1]
v_pk_mul_f32 v[42:43], v[42:43], v[8:9] op_sel:[0,1] op_sel_hi:[1,1]
v_pk_mul_f32 v[44:45], v[44:45], v[8:9] op_sel:[0,1] op_sel_hi:[1,1]
v_pk_mul_f32 v[46:47], v[46:47], v[8:9] op_sel:[0,1] op_sel_hi:[1,1]
v_pk_mul_f32 v[48:49], v[48:49], v[10:11] op_sel:[0,0] op_sel_hi:[1,0]
v_pk_mul_f32 v[50:51], v[50:51], v[10:11] op_sel:[0,0] op_sel_hi:[1,0]
v_pk_mul_f32 v[52:53], v[52:53], v[10:11] op_sel:[0,0] op_sel_hi:[1,0]
v_pk_mul_f32 v[54:55], v[54:55], v[10:11] op_sel:[0,0] op_sel_hi:[1,0]
s_waitcnt lgkmcnt(8)
N v[156:159],a[140:143],a[188:191],0
s_add_u32 s63, s63, 4096
T a[128:129],v16,16384
v_cvt_pk_bf16_f32 v224, v40, v41
M v[156:159],a[136:139],a[172:175]
T a[130:131],v16,20480
v_cvt_pk_bf16_f32 v225, v42, v43
N v[152:155],a[136:139],a[168:171],0
v_cvt_pk_bf16_f32 v226, v44, v45
v_cvt_pk_bf16_f32 v227, v46, v47
M v[152:155],a[140:143],a[184:187]
v_cvt_pk_bf16_f32 v228, v48, v49
v_cvt_pk_bf16_f32 v229, v50, v51
N v[148:151],a[140:143],a[180:183],0
T a[132:133],v16,24576
v_cvt_pk_bf16_f32 v230, v52, v53
M v[148:151],a[136:139],a[164:167]
T a[134:135],v16,28672
v_cvt_pk_bf16_f32 v231, v54, v55
N v[144:147],a[136:139],a[160:163],0
buffer_load_dwordx4 a[16:19], v58, s[12:15], s63 offen offset:0 sc1
v_accvgpr_read_b32 v40, a40
M v[144:147],a[140:143],a[176:179]
s_waitcnt lgkmcnt(8)
v_accvgpr_read_b32 v41, a41
v_accvgpr_read_b32 v42, a42
N v[160:163],a[144:147],a[160:163],v[32:35]
T a[136:137],v17,16384
v_accvgpr_read_b32 v43, a43
M v[160:163],a[148:151],a[176:179]
T a[138:139],v17,20480
v_accvgpr_read_b32 v44, a56
N v[164:167],a[148:151],a[180:183],v[32:35]
buffer_load_dwordx4 a[20:23], v58, s[12:15], s63 offen offset:1024 sc1
v_accvgpr_read_b32 v45, a57
M v[164:167],a[144:147],a[164:167]
v_accvgpr_read_b32 v46, a58
v_accvgpr_read_b32 v47, a59
N v[168:171],a[144:147],a[168:171],v[32:35]
T a[140:141],v17,24576
v_accvgpr_read_b32 v48, a44
M v[168:171],a[148:151],a[184:187]
T a[142:143],v17,28672
v_accvgpr_read_b32 v49, a45
N v[172:175],a[148:151],a[188:191],v[32:35]
buffer_load_dwordx4 a[24:27], v59, s[12:15], s63 offen offset:0 sc1
v_accvgpr_read_b32 v50, a46
M v[172:175],a[144:147],a[172:175]
v_accvgpr_read_b32 v51, a47
v_accvgpr_read_b32 v52, a60
v_accvgpr_read_b32 v53, a61
v_accvgpr_read_b32 v54, a62
v_accvgpr_read_b32 v55, a63
v_pk_mul_f32 v[40:41], v[40:41], v[10:11] op_sel:[0,1] op_sel_hi:[1,1]
v_pk_mul_f32 v[42:43], v[42:43], v[10:11] op_sel:[0,1] op_sel_hi:[1,1]
v_pk_mul_f32 v[44:45], v[44:45], v[10:11] op_sel:[0,1] op_sel_hi:[1,1]
v_pk_mul_f32 v[46:47], v[46:47], v[10:11] op_sel:[0,1] op_sel_hi:[1,1]
v_pk_mul_f32 v[48:49], v[48:49], v[12:13] op_sel:[0,0] op_sel_hi:[1,0]
v_pk_mul_f32 v[50:51], v[50:51], v[12:13] op_sel:[0,0] op_sel_hi:[1,0]
v_pk_mul_f32 v[52:53], v[52:53], v[12:13] op_sel:[0,0] op_sel_hi:[1,0]
v_pk_mul_f32 v[54:55], v[54:55], v[12:13] op_sel:[0,0] op_sel_hi:[1,0]
s_waitcnt lgkmcnt(8)
N v[188:191],a[156:159],a[188:191],v[36:39]
T a[144:145],v18,16384
v_cvt_pk_bf16_f32 v232, v40, v41
M v[188:191],a[152:155],a[172:175]
T a[146:147],v18,20480
v_cvt_pk_bf16_f32 v233, v42, v43
N v[184:187],a[152:155],a[168:171],v[36:39]
buffer_load_dwordx4 a[28:31], v59, s[12:15], s63 offen offset:1024 sc1
v_cvt_pk_bf16_f32 v234, v44, v45
M v[184:187],a[156:159],a[184:187]
s_add_u32 s63, s63, 4096
v_cvt_pk_bf16_f32 v235, v46, v47
v_cvt_pk_bf16_f32 v236, v48, v49
N v[180:183],a[156:159],a[180:183],v[36:39]
T a[148:149],v18,24576
v_cvt_pk_bf16_f32 v237, v50, v51
M v[180:183],a[152:155],a[164:167]
T a[150:151],v18,28672
v_cvt_pk_bf16_f32 v238, v52, v53
N v[176:179],a[152:155],a[160:163],v[36:39]
buffer_load_dwordx4 a[32:35], v58, s[12:15], s63 offen offset:0 sc1
v_cvt_pk_bf16_f32 v239, v54, v55
M v[176:179],a[156:159],a[176:179]
s_waitcnt vmcnt(32)
s_waitcnt lgkmcnt(8)
M v[64:67],a[128:131],a[192:195]
T a[152:153],v19,16384
v_subrev_u32 v24, 65536, v24
M v[64:67],a[132:135],a[208:211]
T a[154:155],v19,20480
v_subrev_u32 v25, 65536, v25
M v[68:71],a[132:135],a[212:215]
v_subrev_u32 v26, 65536, v26
v_subrev_u32 v27, 65536, v27
M v[68:71],a[128:131],a[196:199]
v_subrev_u32 v28, 65536, v28
v_subrev_u32 v29, 65536, v29
M v[72:75],a[128:131],a[200:203]
T a[156:157],v19,24576
v_subrev_u32 v30, 65536, v30
M v[72:75],a[132:135],a[216:219]
T a[158:159],v19,28672
v_subrev_u32 v31, 65536, v31
M v[76:79],a[132:135],a[220:223]
buffer_load_dwordx4 a[36:39], v58, s[12:15], s63 offen offset:1024 sc1
v_accvgpr_read_b32 v40, a64
M v[76:79],a[128:131],a[204:207]
v_accvgpr_read_b32 v41, a65
v_accvgpr_read_b32 v42, a66
v_accvgpr_read_b32 v43, a67
v_accvgpr_read_b32 v44, a80
v_accvgpr_read_b32 v45, a81
v_accvgpr_read_b32 v46, a82
v_accvgpr_read_b32 v47, a83
v_accvgpr_read_b32 v48, a68
v_accvgpr_read_b32 v49, a69
v_accvgpr_read_b32 v50, a70
v_accvgpr_read_b32 v51, a71
v_accvgpr_read_b32 v52, a84
v_accvgpr_read_b32 v53, a85
v_accvgpr_read_b32 v54, a86
v_accvgpr_read_b32 v55, a87
v_pk_mul_f32 v[40:41], v[40:41], v[8:9] op_sel:[0,1] op_sel_hi:[1,1]
v_pk_mul_f32 v[42:43], v[42:43], v[8:9] op_sel:[0,1] op_sel_hi:[1,1]
v_pk_mul_f32 v[44:45], v[44:45], v[8:9] op_sel:[0,1] op_sel_hi:[1,1]
v_pk_mul_f32 v[46:47], v[46:47], v[8:9] op_sel:[0,1] op_sel_hi:[1,1]
v_pk_mul_f32 v[48:49], v[48:49], v[10:11] op_sel:[0,0] op_sel_hi:[1,0]
v_pk_mul_f32 v[50:51], v[50:51], v[10:11] op_sel:[0,0] op_sel_hi:[1,0]
v_pk_mul_f32 v[52:53], v[52:53], v[10:11] op_sel:[0,0] op_sel_hi:[1,0]
v_pk_mul_f32 v[54:55], v[54:55], v[10:11] op_sel:[0,0] op_sel_hi:[1,0]
s_waitcnt lgkmcnt(8)
M v[92:95],a[140:143],a[220:223]
T a[128:129],v20,16384
v_cvt_pk_bf16_f32 v240, v40, v41
M v[92:95],a[136:139],a[204:207]
T a[130:131],v20,20480
v_cvt_pk_bf16_f32 v241, v42, v43
M v[88:91],a[136:139],a[200:203]
buffer_load_dwordx4 a[40:43], v59, s[12:15], s63 offen offset:0 sc1
v_cvt_pk_bf16_f32 v242, v44, v45
M v[88:91],a[140:143],a[216:219]
v_cvt_pk_bf16_f32 v243, v46, v47
v_cvt_pk_bf16_f32 v244, v48, v49
M v[84:87],a[140:143],a[212:215]
T a[132:133],v20,24576
v_cvt_pk_bf16_f32 v245, v50, v51
M v[84:87],a[136:139],a[196:199]
T a[134:135],v20,28672
v_cvt_pk_bf16_f32 v246, v52, v53
M v[80:83],a[136:139],a[192:195]
buffer_load_dwordx4 a[44:47], v59, s[12:15], s63 offen offset:1024 sc1
v_cvt_pk_bf16_f32 v247, v54, v55
M v[80:83],a[140:143],a[208:211]
s_waitcnt lgkmcnt(8)
v_accvgpr_read_b32 v40, a72
v_accvgpr_read_b32 v41, a73
M v[96:99],a[144:147],a[192:195]
s_add_u32 s63, s63, 4096
T a[136:137],v21,16384
v_accvgpr_read_b32 v42, a74
M v[96:99],a[148:151],a[208:211]
T a[138:139],v21,20480
v_accvgpr_read_b32 v43, a75
M v[100:103],a[148:151],a[212:215]
buffer_load_dwordx4 a[48:51], v58, s[12:15], s63 offen offset:0 sc1
v_accvgpr_read_b32 v44, a88
M v[100:103],a[144:147],a[196:199]
v_accvgpr_read_b32 v45, a89
v_accvgpr_read_b32 v46, a90
M v[104:107],a[144:147],a[200:203]
T a[140:141],v21,24576
v_accvgpr_read_b32 v47, a91
M v[104:107],a[148:151],a[216:219]
T a[142:143],v21,28672
v_accvgpr_read_b32 v48, a76
M v[108:111],a[148:151],a[220:223]
buffer_load_dwordx4 a[52:55], v58, s[12:15], s63 offen offset:1024 sc1
v_accvgpr_read_b32 v49, a77
M v[108:111],a[144:147],a[204:207]
v_accvgpr_read_b32 v50, a78
v_accvgpr_read_b32 v51, a79
v_accvgpr_read_b32 v52, a92
v_accvgpr_read_b32 v53, a93
v_accvgpr_read_b32 v54, a94
v_accvgpr_read_b32 v55, a95
v_pk_mul_f32 v[40:41], v[40:41], v[10:11] op_sel:[0,1] op_sel_hi:[1,1]
v_pk_mul_f32 v[42:43], v[42:43], v[10:11] op_sel:[0,1] op_sel_hi:[1,1]
v_pk_mul_f32 v[44:45], v[44:45], v[10:11] op_sel:[0,1] op_sel_hi:[1,1]
v_pk_mul_f32 v[46:47], v[46:47], v[10:11] op_sel:[0,1] op_sel_hi:[1,1]
v_pk_mul_f32 v[48:49], v[48:49], v[12:13] op_sel:[0,0] op_sel_hi:[1,0]
v_pk_mul_f32 v[50:51], v[50:51], v[12:13] op_sel:[0,0] op_sel_hi:[1,0]
v_pk_mul_f32 v[52:53], v[52:53], v[12:13] op_sel:[0,0] op_sel_hi:[1,0]
v_pk_mul_f32 v[54:55], v[54:55], v[12:13] op_sel:[0,0] op_sel_hi:[1,0]
s_waitcnt lgkmcnt(8)
M v[124:127],a[156:159],a[220:223]
T a[144:145],v22,16384
v_cvt_pk_bf16_f32 v248, v40, v41
M v[124:127],a[152:155],a[204:207]
T a[146:147],v22,20480
v_cvt_pk_bf16_f32 v249, v42, v43
M v[120:123],a[152:155],a[200:203]
v_cvt_pk_bf16_f32 v250, v44, v45
v_cvt_pk_bf16_f32 v251, v46, v47
M v[120:123],a[156:159],a[216:219]
v_cvt_pk_bf16_f32 v252, v48, v49
v_cvt_pk_bf16_f32 v253, v50, v51
M v[116:119],a[156:159],a[212:215]
T a[148:149],v22,24576
v_cvt_pk_bf16_f32 v254, v52, v53
M v[116:119],a[152:155],a[196:199]
T a[150:151],v22,28672
v_cvt_pk_bf16_f32 v255, v54, v55
M v[112:115],a[152:155],a[192:195]
buffer_load_dwordx4 a[56:59], v59, s[12:15], s63 offen offset:0 sc1
M v[112:115],a[156:159],a[208:211]
s_waitcnt lgkmcnt(8)
M v[128:131],a[128:131],a[192:195]
T a[152:153],v23,16384
M v[128:131],a[132:135],a[208:211]
T a[154:155],v23,20480
M v[132:135],a[132:135],a[212:215]
buffer_load_dwordx4 a[60:63], v59, s[12:15], s63 offen offset:1024 sc1
s_add_u32 s63, s63, 4096
M v[132:135],a[128:131],a[196:199]
M v[136:139],a[128:131],a[200:203]
T a[156:157],v23,24576
M v[136:139],a[132:135],a[216:219]
T a[158:159],v23,28672
M v[140:143],a[132:135],a[220:223]
buffer_load_dwordx4 a[160:163], v58, s[12:15], s63 offen offset:0 sc1
M v[140:143],a[128:131],a[204:207]
s_waitcnt vmcnt(63)
s_barrier
s_waitcnt lgkmcnt(8)
M v[156:159],a[140:143],a[220:223]
T a[128:129],v24,0
v_subrev_u32 v16, 65536, v16
M v[156:159],a[136:139],a[204:207]
T a[130:131],v24,4096
v_subrev_u32 v17, 65536, v17
M v[152:155],a[136:139],a[200:203]
buffer_load_dwordx4 a[164:167], v58, s[12:15], s63 offen offset:1024 sc1
v_subrev_u32 v18, 65536, v18
M v[152:155],a[140:143],a[216:219]
v_subrev_u32 v19, 65536, v19
v_subrev_u32 v20, 65536, v20
M v[148:151],a[140:143],a[212:215]
T a[132:133],v24,8192
v_subrev_u32 v21, 65536, v21
M v[148:151],a[136:139],a[196:199]
T a[134:135],v24,12288
v_subrev_u32 v22, 65536, v22
M v[144:147],a[136:139],a[192:195]
buffer_load_dwordx4 a[168:171], v59, s[12:15], s63 offen offset:0 sc1
v_subrev_u32 v23, 65536, v23
M v[144:147],a[140:143],a[208:211]
s_waitcnt lgkmcnt(8)
M v[160:163],a[144:147],a[192:195]
T a[136:137],v25,0
M v[160:163],a[148:151],a[208:211]
T a[138:139],v25,4096
M v[164:167],a[148:151],a[212:215]
M v[164:167],a[144:147],a[196:199]
M v[168:171],a[144:147],a[200:203]
T a[140:141],v25,8192
M v[168:171],a[148:151],a[216:219]
T a[142:143],v25,12288
M v[172:175],a[148:151],a[220:223]
buffer_load_dwordx4 a[172:175], v59, s[12:15], s63 offen offset:1024 sc1
s_add_u32 s63, s63, 4096
M v[172:175],a[144:147],a[204:207]
s_waitcnt lgkmcnt(8)
M v[188:191],a[156:159],a[220:223]
T a[144:145],v26,0
M v[188:191],a[152:155],a[204:207]
T a[146:147],v26,4096
M v[184:187],a[152:155],a[200:203]
buffer_load_dwordx4 a[176:179], v58, s[12:15], s63 offen offset:0 sc1
M v[184:187],a[156:159],a[216:219]
M v[180:183],a[156:159],a[212:215]
T a[148:149],v26,8192
M v[180:183],a[152:155],a[196:199]
T a[150:151],v26,12288
M v[176:179],a[152:155],a[192:195]
buffer_load_dwordx4 a[180:183], v58, s[12:15], s63 offen offset:1024 sc1
M v[176:179],a[156:159],a[208:211]
s_barrier
s_waitcnt vmcnt(29)
s_waitcnt lgkmcnt(8)
M v[64:67],a[128:131],a[224:227]
T a[152:153],v27,0
M v[64:67],a[132:135],a[240:243]
T a[154:155],v27,4096
M v[68:71],a[132:135],a[244:247]
buffer_load_dwordx4 a[184:187], v59, s[12:15], s63 offen offset:0 sc1
M v[68:71],a[128:131],a[228:231]
M v[72:75],a[128:131],a[232:235]
T a[156:157],v27,8192
M v[72:75],a[132:135],a[248:251]
T a[158:159],v27,12288
M v[76:79],a[132:135],a[252:255]
buffer_load_dwordx4 a[188:191], v59, s[12:15], s63 offen offset:1024 sc1
s_add_u32 s63, s63, 4096
M v[76:79],a[128:131],a[236:239]
s_waitcnt lgkmcnt(8)
M v[92:95],a[140:143],a[252:255]
T a[128:129],v28,0
M v[92:95],a[136:139],a[236:239]
T a[130:131],v28,4096
M v[88:91],a[136:139],a[232:235]
M v[88:91],a[140:143],a[248:251]
M v[84:87],a[140:143],a[244:247]
T a[132:133],v28,8192
M v[84:87],a[136:139],a[228:231]
T a[134:135],v28,12288
M v[80:83],a[136:139],a[224:227]
buffer_load_dwordx4 a[64:67], v58, s[12:15], s63 offen offset:0 sc1
M v[80:83],a[140:143],a[240:243]
s_waitcnt lgkmcnt(8)
M v[96:99],a[144:147],a[224:227]
T a[136:137],v29,0
M v[96:99],a[148:151],a[240:243]
T a[138:139],v29,4096
M v[100:103],a[148:151],a[244:247]
buffer_load_dwordx4 a[68:71], v58, s[12:15], s63 offen offset:1024 sc1
M v[100:103],a[144:147],a[228:231]
M v[104:107],a[144:147],a[232:235]
T a[140:141],v29,8192
M v[104:107],a[148:151],a[248:251]
T a[142:143],v29,12288
M v[108:111],a[148:151],a[252:255]
buffer_load_dwordx4 a[72:75], v59, s[12:15], s63 offen offset:0 sc1
M v[108:111],a[144:147],a[236:239]
s_waitcnt lgkmcnt(8)
M v[124:127],a[156:159],a[252:255]
T a[144:145],v30,0
M v[124:127],a[152:155],a[236:239]
T a[146:147],v30,4096
M v[120:123],a[152:155],a[232:235]
buffer_load_dwordx4 a[76:79], v59, s[12:15], s63 offen offset:1024 sc1
s_add_u32 s63, s63, 4096
M v[120:123],a[156:159],a[248:251]
M v[116:119],a[156:159],a[244:247]
T a[148:149],v30,8192
M v[116:119],a[152:155],a[228:231]
T a[150:151],v30,12288
M v[112:115],a[152:155],a[224:227]
buffer_load_dwordx4 v2, s[32:35], s62 offen offset:1024 lds
M v[112:115],a[156:159],a[240:243]
s_waitcnt lgkmcnt(8)
M v[128:131],a[128:131],a[224:227]
T a[152:153],v31,0
M v[128:131],a[132:135],a[240:243]
T a[154:155],v31,4096
M v[132:135],a[132:135],a[244:247]
M v[132:135],a[128:131],a[228:231]
M v[136:139],a[128:131],a[232:235]
T a[156:157],v31,8192
M v[136:139],a[132:135],a[248:251]
T a[158:159],v31,12288
M v[140:143],a[132:135],a[252:255]
buffer_load_dwordx4 v3, s[32:35], s62 offen offset:2048 lds
M v[140:143],a[128:131],a[236:239]
L_pad8:
s_cbranch_execz L_pb1A
s_waitcnt lgkmcnt(8)
M v[156:159],a[140:143],a[252:255]
T a[128:129],v24,16384
M v[156:159],a[136:139],a[236:239]
T a[130:131],v24,20480
M v[152:155],a[136:139],a[232:235]
buffer_load_dwordx4 v4, s[32:35], s62 offen offset:3072 lds
M v[152:155],a[140:143],a[248:251]
M v[148:151],a[140:143],a[244:247]
T a[132:133],v24,24576
M v[148:151],a[136:139],a[228:231]
s_add_u32 m0, s60, 102400
T a[134:135],v24,28672
M v[144:147],a[136:139],a[224:227]
buffer_load_dwordx4 v5, s[32:35], s62 offen offset:0 lds
M v[144:147],a[140:143],a[240:243]
s_waitcnt lgkmcnt(8)
M v[160:163],a[144:147],a[224:227]
T a[136:137],v25,16384
M v[160:163],a[148:151],a[240:243]
T a[138:139],v25,20480
M v[164:167],a[148:151],a[244:247]
buffer_load_dwordx4 v6, s[32:35], s62 offen offset:1024 lds
M v[164:167],a[144:147],a[228:231]
M v[168:171],a[144:147],a[232:235]
T a[140:141],v25,24576
M v[168:171],a[148:151],a[248:251]
T a[142:143],v25,28672
M v[172:175],a[148:151],a[252:255]
buffer_load_dwordx4 v7, s[32:35], s62 offen offset:2048 lds
M v[172:175],a[144:147],a[236:239]
s_waitcnt lgkmcnt(8)
M v[188:191],a[156:159],a[252:255]
T a[144:145],v26,16384
M v[188:191],a[152:155],a[236:239]
T a[146:147],v26,20480
M v[184:187],a[152:155],a[232:235]
M v[184:187],a[156:159],a[248:251]
M v[180:183],a[156:159],a[244:247]
T a[148:149],v26,24576
M v[180:183],a[152:155],a[228:231]
T a[150:151],v26,28672
M v[176:179],a[152:155],a[224:227]
buffer_load_dwordx4 v8, s[32:35], s62 offen offset:3072 lds
s_add_u32 s62, s62, 262144
M v[176:179],a[156:159],a[240:243]
s_waitcnt vmcnt(31)
s_waitcnt lgkmcnt(8)
M v[64:67],a[128:131],a[96:99]
T a[152:153],v27,16384
M v[64:67],a[132:135],a[0:3]
T a[154:155],v27,20480
M v[68:71],a[132:135],a[4:7]
buffer_load_dwordx4 a[80:83], v58, s[12:15], s63 offen offset:0 sc1
M v[68:71],a[128:131],a[100:103]
M v[72:75],a[128:131],a[104:107]
T a[156:157],v27,24576
M v[72:75],a[132:135],a[8:11]
T a[158:159],v27,28672
M v[76:79],a[132:135],a[12:15]
buffer_load_dwordx4 a[84:87], v58, s[12:15], s63 offen offset:1024 sc1
M v[76:79],a[128:131],a[108:111]
s_waitcnt lgkmcnt(8)
M v[92:95],a[140:143],a[12:15]
T a[128:129],v28,16384
M v[92:95],a[136:139],a[108:111]
T a[130:131],v28,20480
M v[88:91],a[136:139],a[104:107]
buffer_load_dwordx4 a[88:91], v59, s[12:15], s63 offen offset:0 sc1
M v[88:91],a[140:143],a[8:11]
M v[84:87],a[140:143],a[4:7]
T a[132:133],v28,24576
M v[84:87],a[136:139],a[100:103]
T a[134:135],v28,28672
M v[80:83],a[136:139],a[96:99]
buffer_load_dwordx4 a[92:95], v59, s[12:15], s63 offen offset:1024 sc1
s_add_u32 s63, s63, 4096
M v[80:83],a[140:143],a[0:3]
s_waitcnt lgkmcnt(8)
M v[96:99],a[144:147],a[96:99]
T a[136:137],v29,16384
M v[96:99],a[148:151],a[0:3]
T a[138:139],v29,20480
M v[100:103],a[148:151],a[4:7]
M v[100:103],a[144:147],a[100:103]
M v[104:107],a[144:147],a[104:107]
T a[140:141],v29,24576
M v[104:107],a[148:151],a[8:11]
T a[142:143],v29,28672
M v[108:111],a[148:151],a[12:15]
buffer_load_dwordx4 a[192:195], v58, s[12:15], s63 offen offset:0 sc1
M v[108:111],a[144:147],a[108:111]
s_waitcnt lgkmcnt(8)
M v[124:127],a[156:159],a[12:15]
T a[144:145],v30,16384
M v[124:127],a[152:155],a[108:111]
T a[146:147],v30,20480
M v[120:123],a[152:155],a[104:107]
buffer_load_dwordx4 a[196:199], v58, s[12:15], s63 offen offset:1024 sc1
M v[120:123],a[156:159],a[8:11]
M v[116:119],a[156:159],a[4:7]
T a[148:149],v30,24576
M v[116:119],a[152:155],a[100:103]
T a[150:151],v30,28672
M v[112:115],a[152:155],a[96:99]
buffer_load_dwordx4 a[200:203], v59, s[12:15], s63 offen offset:0 sc1
M v[112:115],a[156:159],a[0:3]
s_waitcnt lgkmcnt(8)
M v[128:131],a[128:131],a[96:99]
T a[152:153],v31,16384
M v[128:131],a[132:135],a[0:3]
T a[154:155],v31,20480
M v[132:135],a[132:135],a[4:7]
buffer_load_dwordx4 a[204:207], v59, s[12:15], s63 offen offset:1024 sc1
s_add_u32 s63, s63, 4096
M v[132:135],a[128:131],a[100:103]
M v[136:139],a[128:131],a[104:107]
T a[156:157],v31,24576
M v[136:139],a[132:135],a[8:11]
T a[158:159],v31,28672
M v[140:143],a[132:135],a[12:15]
buffer_load_dwordx4 a[208:211], v58, s[12:15], s63 offen offset:0 sc1
M v[140:143],a[128:131],a[108:111]
s_waitcnt vmcnt(63)
s_barrier
s_waitcnt lgkmcnt(8)
M v[156:159],a[140:143],a[12:15]
T a[128:129],v24,32768
M v[156:159],a[136:139],a[108:111]
T a[130:131],v24,36864
M v[152:155],a[136:139],a[104:107]
M v[152:155],a[140:143],a[8:11]
M v[148:151],a[140:143],a[4:7]
T a[132:133],v24,40960
M v[148:151],a[136:139],a[100:103]
T a[134:135],v24,45056
M v[144:147],a[136:139],a[96:99]
buffer_load_dwordx4 a[212:215], v58, s[12:15], s63 offen offset:1024 sc1
M v[144:147],a[140:143],a[0:3]
s_waitcnt lgkmcnt(8)
M v[160:163],a[144:147],a[96:99]
T a[136:137],v25,32768
M v[160:163],a[148:151],a[0:3]
T a[138:139],v25,36864
M v[164:167],a[148:151],a[4:7]
buffer_load_dwordx4 a[216:219], v59, s[12:15], s63 offen offset:0 sc1
M v[164:167],a[144:147],a[100:103]
M v[168:171],a[144:147],a[104:107]
T a[140:141],v25,40960
M v[168:171],a[148:151],a[8:11]
T a[142:143],v25,45056
M v[172:175],a[148:151],a[12:15]
buffer_load_dwordx4 a[220:223], v59, s[12:15], s63 offen offset:1024 sc1
s_add_u32 s63, s63, 4096
M v[172:175],a[144:147],a[108:111]
s_waitcnt lgkmcnt(8)
M v[188:191],a[156:159],a[12:15]
T a[144:145],v26,32768
M v[188:191],a[152:155],a[108:111]
T a[146:147],v26,36864
M v[184:187],a[152:155],a[104:107]
buffer_load_dwordx4 a[224:227], v58, s[12:15], s63 offen offset:0 sc1
M v[184:187],a[156:159],a[8:11]
M v[180:183],a[156:159],a[4:7]
T a[148:149],v26,40960
M v[180:183],a[152:155],a[100:103]
T a[150:151],v26,45056
M v[176:179],a[152:155],a[96:99]
buffer_load_dwordx4 a[228:231], v58, s[12:15], s63 offen offset:1024 sc1
M v[176:179],a[156:159],a[0:3]
s_barrier
s_waitcnt vmcnt(37)
s_waitcnt lgkmcnt(8)
M v[64:67],a[128:131],a[16:19]
T a[152:153],v27,32768
M v[64:67],a[132:135],a[32:35]
T a[154:155],v27,36864
M v[68:71],a[132:135],a[36:39]
M v[68:71],a[128:131],a[20:23]
buffer_store_dwordx4 v[192:195], v58, s[12:15], s11 offen offset:0 sc1
M v[72:75],a[128:131],a[24:27]
T a[156:157],v27,40960
M v[72:75],a[132:135],a[40:43]
T a[158:159],v27,45056
M v[76:79],a[132:135],a[44:47]
M v[76:79],a[128:131],a[28:31]
s_waitcnt lgkmcnt(8)
M v[92:95],a[140:143],a[44:47]
T a[128:129],v28,32768
M v[92:95],a[136:139],a[28:31]
T a[130:131],v28,36864
M v[88:91],a[136:139],a[24:27]
M v[88:91],a[140:143],a[40:43]
M v[84:87],a[140:143],a[36:39]
T a[132:133],v28,40960
buffer_store_dwordx4 v[196:199], v58, s[12:15], s11 offen offset:1024 sc1
M v[84:87],a[136:139],a[20:23]
T a[134:135],v28,45056
M v[80:83],a[136:139],a[16:19]
M v[80:83],a[140:143],a[32:35]
s_waitcnt lgkmcnt(8)
M v[96:99],a[144:147],a[16:19]
T a[136:137],v29,32768
M v[96:99],a[148:151],a[32:35]
T a[138:139],v29,36864
M v[100:103],a[148:151],a[36:39]
M v[100:103],a[144:147],a[20:23]
M v[104:107],a[144:147],a[24:27]
T a[140:141],v29,40960
M v[104:107],a[148:151],a[40:43]
T a[142:143],v29,45056
buffer_store_dwordx4 v[200:203], v59, s[12:15], s11 offen offset:0 sc1
M v[108:111],a[148:151],a[44:47]
M v[108:111],a[144:147],a[28:31]
s_waitcnt lgkmcnt(8)
M v[124:127],a[156:159],a[44:47]
T a[144:145],v30,32768
M v[124:127],a[152:155],a[28:31]
T a[146:147],v30,36864
M v[120:123],a[152:155],a[24:27]
M v[120:123],a[156:159],a[40:43]
M v[116:119],a[156:159],a[36:39]
T a[148:149],v30,40960
M v[116:119],a[152:155],a[20:23]
T a[150:151],v30,45056
M v[112:115],a[152:155],a[16:19]
buffer_store_dwordx4 v[204:207], v59, s[12:15], s11 offen offset:1024 sc1
M v[112:115],a[156:159],a[32:35]
s_waitcnt lgkmcnt(8)
M v[128:131],a[128:131],a[16:19]
T a[152:153],v31,32768
M v[128:131],a[132:135],a[32:35]
T a[154:155],v31,36864
M v[132:135],a[132:135],a[36:39]
M v[132:135],a[128:131],a[20:23]
M v[136:139],a[128:131],a[24:27]
T a[156:157],v31,40960
M v[136:139],a[132:135],a[40:43]
T a[158:159],v31,45056
M v[140:143],a[132:135],a[44:47]
M v[140:143],a[128:131],a[28:31]
buffer_store_dwordx4 v[208:211], v58, s[12:15], s8 offen offset:0 sc1
s_waitcnt lgkmcnt(8)
M v[156:159],a[140:143],a[44:47]
T a[128:129],v24,49152
M v[156:159],a[136:139],a[28:31]
T a[130:131],v24,53248
M v[152:155],a[136:139],a[24:27]
M v[152:155],a[140:143],a[40:43]
M v[148:151],a[140:143],a[36:39]
T a[132:133],v24,57344
M v[148:151],a[136:139],a[20:23]
T a[134:135],v24,61440
M v[144:147],a[136:139],a[16:19]
M v[144:147],a[140:143],a[32:35]
s_waitcnt lgkmcnt(8)
M v[160:163],a[144:147],a[16:19]
T a[136:137],v25,49152
buffer_store_dwordx4 v[212:215], v58, s[12:15], s8 offen offset:1024 sc1
M v[160:163],a[148:151],a[32:35]
T a[138:139],v25,53248
M v[164:167],a[148:151],a[36:39]
M v[164:167],a[144:147],a[20:23]
M v[168:171],a[144:147],a[24:27]
T a[140:141],v25,57344
M v[168:171],a[148:151],a[40:43]
T a[142:143],v25,61440
M v[172:175],a[148:151],a[44:47]
M v[172:175],a[144:147],a[28:31]
s_waitcnt lgkmcnt(8)
M v[188:191],a[156:159],a[44:47]
T a[144:145],v26,49152
M v[188:191],a[152:155],a[28:31]
T a[146:147],v26,53248
buffer_store_dwordx4 v[216:219], v59, s[12:15], s8 offen offset:0 sc1
M v[184:187],a[152:155],a[24:27]
M v[184:187],a[156:159],a[40:43]
M v[180:183],a[156:159],a[36:39]
T a[148:149],v26,57344
M v[180:183],a[152:155],a[20:23]
T a[150:151],v26,61440
M v[176:179],a[152:155],a[16:19]
M v[176:179],a[156:159],a[32:35]
s_waitcnt vmcnt(36)
s_waitcnt lgkmcnt(8)
M v[64:67],a[128:131],a[48:51]
T a[152:153],v27,49152
M v[64:67],a[132:135],a[160:163]
T a[154:155],v27,53248
M v[68:71],a[132:135],a[164:167]
buffer_store_dwordx4 v[220:223], v59, s[12:15], s8 offen offset:1024 sc1
M v[68:71],a[128:131],a[52:55]
M v[72:75],a[128:131],a[56:59]
T a[156:157],v27,57344
M v[72:75],a[132:135],a[168:171]
T a[158:159],v27,61440
M v[76:79],a[132:135],a[172:175]
M v[76:79],a[128:131],a[60:63]
s_waitcnt lgkmcnt(8)
M v[92:95],a[140:143],a[172:175]
T a[128:129],v28,49152
M v[92:95],a[136:139],a[60:63]
T a[130:131],v28,53248
M v[88:91],a[136:139],a[56:59]
M v[88:91],a[140:143],a[168:171]
buffer_store_dwordx4 v[224:227], v58, s[12:15], s9 offen offset:0 sc1
M v[84:87],a[140:143],a[164:167]
T a[132:133],v28,57344
M v[84:87],a[136:139],a[52:55]
T a[134:135],v28,61440
M v[80:83],a[136:139],a[48:51]
M v[80:83],a[140:143],a[160:163]
s_waitcnt lgkmcnt(8)
M v[96:99],a[144:147],a[48:51]
T a[136:137],v29,49152
M v[96:99],a[148:151],a[160:163]
T a[138:139],v29,53248
M v[100:103],a[148:151],a[164:167]
M v[100:103],a[144:147],a[52:55]
M v[104:107],a[144:147],a[56:59]
T a[140:141],v29,57344
buffer_store_dwordx4 v[228:231], v58, s[12:15], s9 offen offset:1024 sc1
M v[104:107],a[148:151],a[168:171]
T a[142:143],v29,61440
M v[108:111],a[148:151],a[172:175]
M v[108:111],a[144:147],a[60:63]
s_waitcnt lgkmcnt(8)
M v[124:127],a[156:159],a[172:175]
T a[144:145],v30,49152
M v[124:127],a[152:155],a[60:63]
T a[146:147],v30,53248
M v[120:123],a[152:155],a[56:59]
M v[120:123],a[156:159],a[168:171]
M v[116:119],a[156:159],a[164:167]
T a[148:149],v30,57344
M v[116:119],a[152:155],a[52:55]
T a[150:151],v30,61440
buffer_store_dwordx4 v[232:235], v59, s[12:15], s9 offen offset:0 sc1
M v[112:115],a[152:155],a[48:51]
M v[112:115],a[156:159],a[160:163]
s_waitcnt lgkmcnt(8)
M v[128:131],a[128:131],a[48:51]
T a[152:153],v31,49152
M v[128:131],a[132:135],a[160:163]
T a[154:155],v31,53248
M v[132:135],a[132:135],a[164:167]
M v[132:135],a[128:131],a[52:55]
M v[136:139],a[128:131],a[56:59]
T a[156:157],v31,57344
M v[136:139],a[132:135],a[168:171]
T a[158:159],v31,61440
M v[140:143],a[132:135],a[172:175]
buffer_store_dwordx4 v[236:239], v59, s[12:15], s9 offen offset:1024 sc1
M v[140:143],a[128:131],a[60:63]
s_waitcnt vmcnt(63)
s_barrier
s_waitcnt lgkmcnt(8)
M v[156:159],a[140:143],a[172:175]
T a[128:129],v16,0
v_add_u32 v24, 131072, v24
M v[156:159],a[136:139],a[60:63]
T a[130:131],v16,4096
v_add_u32 v25, 131072, v25
M v[152:155],a[136:139],a[56:59]
v_add_u32 v26, 131072, v26
v_add_u32 v27, 131072, v27
M v[152:155],a[140:143],a[168:171]
v_add_u32 v28, 131072, v28
v_add_u32 v29, 131072, v29
M v[148:151],a[140:143],a[164:167]
T a[132:133],v16,8192
v_add_u32 v30, 131072, v30
M v[148:151],a[136:139],a[52:55]
T a[134:135],v16,12288
v_add_u32 v31, 131072, v31
M v[144:147],a[136:139],a[48:51]
M v[144:147],a[140:143],a[160:163]
buffer_store_dwordx4 v[240:243], v58, s[12:15], s10 offen offset:0 sc1
s_waitcnt lgkmcnt(8)
M v[160:163],a[144:147],a[48:51]
T a[136:137],v17,0
M v[160:163],a[148:151],a[160:163]
T a[138:139],v17,4096
M v[164:167],a[148:151],a[164:167]
M v[164:167],a[144:147],a[52:55]
M v[168:171],a[144:147],a[56:59]
T a[140:141],v17,8192
M v[168:171],a[148:151],a[168:171]
T a[142:143],v17,12288
M v[172:175],a[148:151],a[172:175]
M v[172:175],a[144:147],a[60:63]
s_waitcnt lgkmcnt(8)
M v[188:191],a[156:159],a[172:175]
T a[144:145],v18,0
buffer_store_dwordx4 v[244:247], v58, s[12:15], s10 offen offset:1024 sc1
M v[188:191],a[152:155],a[60:63]
T a[146:147],v18,4096
M v[184:187],a[152:155],a[56:59]
M v[184:187],a[156:159],a[168:171]
M v[180:183],a[156:159],a[164:167]
T a[148:149],v18,8192
M v[180:183],a[152:155],a[52:55]
T a[150:151],v18,12288
M v[176:179],a[152:155],a[48:51]
M v[176:179],a[156:159],a[160:163]
s_barrier
s_waitcnt vmcnt(35)
s_waitcnt lgkmcnt(8)
M v[64:67],a[128:131],a[176:179]
T a[152:153],v19,0
M v[64:67],a[132:135],a[64:67]
T a[154:155],v19,4096
buffer_store_dwordx4 v[248:251], v59, s[12:15], s10 offen offset:0 sc1
M v[68:71],a[132:135],a[68:71]
M v[68:71],a[128:131],a[180:183]
M v[72:75],a[128:131],a[184:187]
T a[156:157],v19,8192
M v[72:75],a[132:135],a[72:75]
T a[158:159],v19,12288
M v[76:79],a[132:135],a[76:79]
M v[76:79],a[128:131],a[188:191]
s_waitcnt lgkmcnt(8)
M v[92:95],a[140:143],a[76:79]
T a[128:129],v20,0
M v[92:95],a[136:139],a[188:191]
T a[130:131],v20,4096
M v[88:91],a[136:139],a[184:187]
buffer_store_dwordx4 v[252:255], v59, s[12:15], s10 offen offset:1024 sc1
M v[88:91],a[140:143],a[72:75]
M v[84:87],a[140:143],a[68:71]
T a[132:133],v20,8192
M v[84:87],a[136:139],a[180:183]
T a[134:135],v20,12288
M v[80:83],a[136:139],a[176:179]
M v[80:83],a[140:143],a[64:67]
s_waitcnt lgkmcnt(8)
M v[96:99],a[144:147],a[176:179]
T a[136:137],v21,0
M v[96:99],a[148:151],a[64:67]
T a[138:139],v21,4096
M v[100:103],a[148:151],a[68:71]
M v[100:103],a[144:147],a[180:183]
M v[104:107],a[144:147],a[184:187]
T a[140:141],v21,8192
M v[104:107],a[148:151],a[72:75]
T a[142:143],v21,12288
M v[108:111],a[148:151],a[76:79]
buffer_load_dwordx4 a[232:235], v59, s[12:15], s63 offen offset:0 sc1
M v[108:111],a[144:147],a[188:191]
s_waitcnt lgkmcnt(8)
M v[124:127],a[156:159],a[76:79]
T a[144:145],v22,0
M v[124:127],a[152:155],a[188:191]
T a[146:147],v22,4096
M v[120:123],a[152:155],a[184:187]
buffer_load_dwordx4 a[236:239], v59, s[12:15], s63 offen offset:1024 sc1
s_add_u32 s63, s63, 4096
M v[120:123],a[156:159],a[72:75]
M v[116:119],a[156:159],a[68:71]
T a[148:149],v22,8192
M v[116:119],a[152:155],a[180:183]
s_add_u32 m0, s60, 131072
T a[150:151],v22,12288
M v[112:115],a[152:155],a[176:179]
buffer_load_dwordx4 v1, s[32:35], s62 offen offset:0 lds
M v[112:115],a[156:159],a[64:67]
s_waitcnt lgkmcnt(8)
M v[128:131],a[128:131],a[176:179]
T a[152:153],v23,0
M v[128:131],a[132:135],a[64:67]
T a[154:155],v23,4096
M v[132:135],a[132:135],a[68:71]
buffer_load_dwordx4 v2, s[32:35], s62 offen offset:1024 lds
M v[132:135],a[128:131],a[180:183]
M v[136:139],a[128:131],a[184:187]
T a[156:157],v23,8192
M v[136:139],a[132:135],a[72:75]
T a[158:159],v23,12288
M v[140:143],a[132:135],a[76:79]
buffer_load_dwordx4 v3, s[32:35], s62 offen offset:2048 lds
M v[140:143],a[128:131],a[188:191]
s_waitcnt lgkmcnt(8)
M v[156:159],a[140:143],a[76:79]
T a[128:129],v16,16384
M v[156:159],a[136:139],a[188:191]
T a[130:131],v16,20480
M v[152:155],a[136:139],a[184:187]
M v[152:155],a[140:143],a[72:75]
M v[148:151],a[140:143],a[68:71]
T a[132:133],v16,24576
M v[148:151],a[136:139],a[180:183]
T a[134:135],v16,28672
M v[144:147],a[136:139],a[176:179]
buffer_load_dwordx4 v4, s[32:35], s62 offen offset:3072 lds
M v[144:147],a[140:143],a[64:67]
s_waitcnt lgkmcnt(8)
M v[160:163],a[144:147],a[176:179]
T a[136:137],v17,16384
M v[160:163],a[148:151],a[64:67]
s_add_u32 m0, s60, 135168
T a[138:139],v17,20480
M v[164:167],a[148:151],a[68:71]
buffer_load_dwordx4 v5, s[32:35], s62 offen offset:0 lds
M v[164:167],a[144:147],a[180:183]
M v[168:171],a[144:147],a[184:187]
T a[140:141],v17,24576
M v[168:171],a[148:151],a[72:75]
T a[142:143],v17,28672
M v[172:175],a[148:151],a[76:79]
buffer_load_dwordx4 v6, s[32:35], s62 offen offset:1024 lds
M v[172:175],a[144:147],a[188:191]
s_waitcnt lgkmcnt(8)
M v[188:191],a[156:159],a[76:79]
T a[144:145],v18,16384
M v[188:191],a[152:155],a[188:191]
T a[146:147],v18,20480
M v[184:187],a[152:155],a[184:187]
buffer_load_dwordx4 v7, s[32:35], s62 offen offset:2048 lds
M v[184:187],a[156:159],a[72:75]
M v[180:183],a[156:159],a[68:71]
T a[148:149],v18,24576
M v[180:183],a[152:155],a[180:183]
T a[150:151],v18,28672
M v[176:179],a[152:155],a[176:179]
M v[176:179],a[156:159],a[64:67]
s_waitcnt vmcnt(31)
s_waitcnt lgkmcnt(8)
M v[64:67],a[128:131],a[80:83]
T a[152:153],v19,16384
v_accvgpr_read_b32 v225, a112
M v[64:67],a[132:135],a[192:195]
T a[154:155],v19,20480
v_accvgpr_read_b32 v227, a113
M v[68:71],a[132:135],a[196:199]
L_pad9:
s_cbranch_execz L_pb1A
v_accvgpr_read_b32 v229, a114
v_accvgpr_read_b32 v231, a115
M v[68:71],a[128:131],a[84:87]
v_accvgpr_read_b32 v233, a116
v_accvgpr_read_b32 v235, a117
M v[72:75],a[128:131],a[88:91]
T a[156:157],v19,24576
v_accvgpr_read_b32 v237, a118
M v[72:75],a[132:135],a[200:203]
T a[158:159],v19,28672
v_accvgpr_read_b32 v239, a119
M v[76:79],a[132:135],a[204:207]
v_accvgpr_read_b32 v241, a120
v_accvgpr_read_b32 v243, a121
M v[76:79],a[128:131],a[92:95]
s_waitcnt lgkmcnt(8)
v_accvgpr_read_b32 v245, a122
v_accvgpr_read_b32 v247, a123
M v[92:95],a[140:143],a[204:207]
T a[128:129],v20,16384
v_accvgpr_read_b32 v249, a124
M v[92:95],a[136:139],a[92:95]
T a[130:131],v20,20480
v_accvgpr_read_b32 v251, a125
M v[88:91],a[136:139],a[88:91]
v_accvgpr_read_b32 v253, a126
v_accvgpr_read_b32 v255, a127
M v[88:91],a[140:143],a[200:203]
v_lshlrev_b32 v224, 16, v225
v_and_b32 v225, 0xffff0000, v225
M v[84:87],a[140:143],a[196:199]
T a[132:133],v20,24576
v_lshlrev_b32 v226, 16, v227
M v[84:87],a[136:139],a[84:87]
T a[134:135],v20,28672
v_and_b32 v227, 0xffff0000, v227
M v[80:83],a[136:139],a[80:83]
v_lshlrev_b32 v228, 16, v229
v_and_b32 v229, 0xffff0000, v229
M v[80:83],a[140:143],a[192:195]
s_waitcnt lgkmcnt(8)
v_lshlrev_b32 v230, 16, v231
v_and_b32 v231, 0xffff0000, v231
M v[96:99],a[144:147],a[80:83]
T a[136:137],v21,16384
v_lshlrev_b32 v232, 16, v233
M v[96:99],a[148:151],a[192:195]
T a[138:139],v21,20480
v_and_b32 v233, 0xffff0000, v233
M v[100:103],a[148:151],a[196:199]
v_lshlrev_b32 v234, 16, v235
v_and_b32 v235, 0xffff0000, v235
M v[100:103],a[144:147],a[84:87]
v_lshlrev_b32 v236, 16, v237
v_and_b32 v237, 0xffff0000, v237
M v[104:107],a[144:147],a[88:91]
T a[140:141],v21,24576
v_lshlrev_b32 v238, 16, v239
M v[104:107],a[148:151],a[200:203]
T a[142:143],v21,28672
v_and_b32 v239, 0xffff0000, v239
M v[108:111],a[148:151],a[204:207]
v_lshlrev_b32 v240, 16, v241
v_and_b32 v241, 0xffff0000, v241
M v[108:111],a[144:147],a[92:95]
s_waitcnt lgkmcnt(8)
v_lshlrev_b32 v242, 16, v243
v_and_b32 v243, 0xffff0000, v243
M v[124:127],a[156:159],a[204:207]
T a[144:145],v22,16384
v_lshlrev_b32 v244, 16, v245
M v[124:127],a[152:155],a[92:95]
T a[146:147],v22,20480
v_and_b32 v245, 0xffff0000, v245
M v[120:123],a[152:155],a[88:91]
v_lshlrev_b32 v246, 16, v247
v_and_b32 v247, 0xffff0000, v247
M v[120:123],a[156:159],a[200:203]
v_lshlrev_b32 v248, 16, v249
v_and_b32 v249, 0xffff0000, v249
M v[116:119],a[156:159],a[196:199]
T a[148:149],v22,24576
v_lshlrev_b32 v250, 16, v251
M v[116:119],a[152:155],a[84:87]
T a[150:151],v22,28672
v_and_b32 v251, 0xffff0000, v251
M v[112:115],a[152:155],a[80:83]
v_lshlrev_b32 v252, 16, v253
v_and_b32 v253, 0xffff0000, v253
M v[112:115],a[156:159],a[192:195]
s_waitcnt lgkmcnt(8)
v_lshlrev_b32 v254, 16, v255
v_and_b32 v255, 0xffff0000, v255
M v[128:131],a[128:131],a[80:83]
T a[152:153],v23,16384
M v[128:131],a[132:135],a[192:195]
T a[154:155],v23,20480
M v[132:135],a[132:135],a[196:199]
M v[132:135],a[128:131],a[84:87]
M v[136:139],a[128:131],a[88:91]
T a[156:157],v23,24576
M v[136:139],a[132:135],a[200:203]
T a[158:159],v23,28672
M v[140:143],a[132:135],a[204:207]
M v[140:143],a[128:131],a[92:95]
s_waitcnt vmcnt(9)
s_barrier
s_waitcnt lgkmcnt(8)
M v[156:159],a[140:143],a[204:207]
s_add_u32 s74, s64, 3
T a[128:129],v16,32768
v_mov_b32 v61, s74
M v[156:159],a[136:139],a[92:95]
T a[130:131],v16,36864
buffer_store_dword v61, v60, s[12:15], s65 offen sc1
M v[152:155],a[136:139],a[88:91]
M v[152:155],a[140:143],a[200:203]
M v[148:151],a[140:143],a[196:199]
T a[132:133],v16,40960
M v[148:151],a[136:139],a[84:87]
T a[134:135],v16,45056
M v[144:147],a[136:139],a[80:83]
M v[144:147],a[140:143],a[192:195]
buffer_load_dwordx4 v8, s[32:35], s62 offen offset:3072 lds
s_add_u32 s62, s62, 262144
s_waitcnt lgkmcnt(8)
M v[160:163],a[144:147],a[80:83]
T a[136:137],v17,32768
M v[160:163],a[148:151],a[192:195]
T a[138:139],v17,36864
M v[164:167],a[148:151],a[196:199]
buffer_load_dwordx4 a[240:243], v58, s[12:15], s63 offen offset:0 sc1
M v[164:167],a[144:147],a[84:87]
M v[168:171],a[144:147],a[88:91]
T a[140:141],v17,40960
M v[168:171],a[148:151],a[200:203]
T a[142:143],v17,45056
M v[172:175],a[148:151],a[204:207]
buffer_load_dwordx4 a[244:247], v58, s[12:15], s63 offen offset:1024 sc1
M v[172:175],a[144:147],a[92:95]
s_waitcnt lgkmcnt(8)
M v[188:191],a[156:159],a[204:207]
T a[144:145],v18,32768
M v[188:191],a[152:155],a[92:95]
T a[146:147],v18,36864
M v[184:187],a[152:155],a[88:91]
buffer_load_dwordx4 a[248:251], v59, s[12:15], s63 offen offset:0 sc1
M v[184:187],a[156:159],a[200:203]
M v[180:183],a[156:159],a[196:199]
T a[148:149],v18,40960
M v[180:183],a[152:155],a[84:87]
T a[150:151],v18,45056
M v[176:179],a[152:155],a[80:83]
buffer_load_dwordx4 a[252:255], v59, s[12:15], s63 offen offset:1024 sc1
s_add_u32 s63, s63, 4096
M v[176:179],a[156:159],a[192:195]
s_barrier
buffer_load_dwordx4 a[96:99], v58, s[12:15], s63 offen offset:0 sc1
s_waitcnt vmcnt(14)
s_waitcnt lgkmcnt(8)
M v[64:67],a[128:131],a[208:211]
T a[152:153],v19,32768
M v[64:67],a[132:135],a[224:227]
T a[154:155],v19,36864
M v[68:71],a[132:135],a[228:231]
buffer_load_dwordx4 a[100:103], v58, s[12:15], s63 offen offset:1024 sc1
M v[68:71],a[128:131],a[212:215]
buffer_load_dwordx4 a[104:107], v59, s[12:15], s63 offen offset:0 sc1
M v[72:75],a[128:131],a[216:219]
T a[156:157],v19,40960
M v[72:75],a[132:135],a[232:235]
T a[158:159],v19,45056
M v[76:79],a[132:135],a[236:239]
buffer_load_dwordx4 a[108:111], v59, s[12:15], s63 offen offset:1024 sc1
s_add_u32 s63, s63, 4096
M v[76:79],a[128:131],a[220:223]
s_waitcnt lgkmcnt(8)
M v[92:95],a[140:143],a[236:239]
T a[128:129],v20,32768
M v[92:95],a[136:139],a[220:223]
T a[130:131],v20,36864
M v[88:91],a[136:139],a[216:219]
M v[88:91],a[140:143],a[232:235]
M v[84:87],a[140:143],a[228:231]
T a[132:133],v20,40960
M v[84:87],a[136:139],a[212:215]
T a[134:135],v20,45056
M v[80:83],a[136:139],a[208:211]
buffer_load_dwordx4 a[0:3], v58, s[12:15], s63 offen offset:0 sc1
M v[80:83],a[140:143],a[224:227]
s_waitcnt lgkmcnt(8)
M v[96:99],a[144:147],a[208:211]
T a[136:137],v21,32768
M v[96:99],a[148:151],a[224:227]
T a[138:139],v21,36864
M v[100:103],a[148:151],a[228:231]
buffer_load_dwordx4 a[4:7], v58, s[12:15], s63 offen offset:1024 sc1
M v[100:103],a[144:147],a[212:215]
M v[104:107],a[144:147],a[216:219]
T a[140:141],v21,40960
M v[104:107],a[148:151],a[232:235]
T a[142:143],v21,45056
M v[108:111],a[148:151],a[236:239]
buffer_load_dwordx4 a[8:11], v59, s[12:15], s63 offen offset:0 sc1
M v[108:111],a[144:147],a[220:223]
s_waitcnt lgkmcnt(8)
M v[124:127],a[156:159],a[236:239]
T a[144:145],v22,32768
M v[124:127],a[152:155],a[220:223]
T a[146:147],v22,36864
M v[120:123],a[152:155],a[216:219]
buffer_load_dwordx4 a[12:15], v59, s[12:15], s63 offen offset:1024 sc1
s_add_u32 s63, s63, 4096
M v[120:123],a[156:159],a[232:235]
M v[116:119],a[156:159],a[228:231]
T a[148:149],v22,40960
M v[116:119],a[152:155],a[212:215]
T a[150:151],v22,45056
M v[112:115],a[152:155],a[208:211]
buffer_load_dwordx4 v[192:195], v58, s[12:15], s63 offen offset:0 sc1
M v[112:115],a[156:159],a[224:227]
s_waitcnt lgkmcnt(8)
M v[128:131],a[128:131],a[208:211]
T a[152:153],v23,32768
M v[128:131],a[132:135],a[224:227]
T a[154:155],v23,36864
M v[132:135],a[132:135],a[228:231]
buffer_load_dwordx4 v[196:199], v58, s[12:15], s63 offen offset:1024 sc1
M v[132:135],a[128:131],a[212:215]
M v[136:139],a[128:131],a[216:219]
T a[156:157],v23,40960
M v[136:139],a[132:135],a[232:235]
T a[158:159],v23,45056
M v[140:143],a[132:135],a[236:239]
buffer_load_dwordx4 v[200:203], v59, s[12:15], s63 offen offset:0 sc1
M v[140:143],a[128:131],a[220:223]
s_waitcnt lgkmcnt(8)
M v[156:159],a[140:143],a[236:239]
T a[128:129],v16,49152
M v[156:159],a[136:139],a[220:223]
T a[130:131],v16,53248
M v[152:155],a[136:139],a[216:219]
buffer_load_dwordx4 v[204:207], v59, s[12:15], s63 offen offset:1024 sc1
s_add_u32 s63, s63, 4096
M v[152:155],a[140:143],a[232:235]
M v[148:151],a[140:143],a[228:231]
T a[132:133],v16,57344
M v[148:151],a[136:139],a[212:215]
s_add_u32 m0, s60, 0
T a[134:135],v16,61440
M v[144:147],a[136:139],a[208:211]
buffer_load_dwordx4 v1, s[32:35], s62 offen offset:0 lds
M v[144:147],a[140:143],a[224:227]
s_waitcnt lgkmcnt(8)
M v[160:163],a[144:147],a[208:211]
T a[136:137],v17,49152
M v[160:163],a[148:151],a[224:227]
T a[138:139],v17,53248
M v[164:167],a[148:151],a[228:231]
buffer_load_dwordx4 v2, s[32:35], s62 offen offset:1024 lds
M v[164:167],a[144:147],a[212:215]
M v[168:171],a[144:147],a[216:219]
T a[140:141],v17,57344
M v[168:171],a[148:151],a[232:235]
T a[142:143],v17,61440
M v[172:175],a[148:151],a[236:239]
buffer_load_dwordx4 v3, s[32:35], s62 offen offset:2048 lds
M v[172:175],a[144:147],a[220:223]
s_waitcnt lgkmcnt(8)
M v[188:191],a[156:159],a[236:239]
T a[144:145],v18,49152
M v[188:191],a[152:155],a[220:223]
T a[146:147],v18,53248
M v[184:187],a[152:155],a[216:219]
M v[184:187],a[156:159],a[232:235]
M v[180:183],a[156:159],a[228:231]
T a[148:149],v18,57344
M v[180:183],a[152:155],a[212:215]
T a[150:151],v18,61440
M v[176:179],a[152:155],a[208:211]
buffer_load_dwordx4 v4, s[32:35], s62 offen offset:3072 lds
M v[176:179],a[156:159],a[224:227]
s_waitcnt vmcnt(12)
s_waitcnt lgkmcnt(8)
M v[64:67],a[128:131],a[240:243]
T a[152:153],v19,49152
M v[64:67],a[132:135],a[96:99]
s_add_u32 m0, s60, 4096
T a[154:155],v19,53248
M v[68:71],a[132:135],a[100:103]
buffer_load_dwordx4 v5, s[32:35], s62 offen offset:0 lds
M v[68:71],a[128:131],a[244:247]
M v[72:75],a[128:131],a[248:251]
T a[156:157],v19,57344
M v[72:75],a[132:135],a[104:107]
T a[158:159],v19,61440
M v[76:79],a[132:135],a[108:111]
buffer_load_dwordx4 v6, s[32:35], s62 offen offset:1024 lds
M v[76:79],a[128:131],a[252:255]
s_waitcnt lgkmcnt(8)
M v[92:95],a[140:143],a[108:111]
T a[128:129],v20,49152
M v[92:95],a[136:139],a[252:255]
T a[130:131],v20,53248
M v[88:91],a[136:139],a[248:251]
buffer_load_dwordx4 v7, s[32:35], s62 offen offset:2048 lds
M v[88:91],a[140:143],a[104:107]
M v[84:87],a[140:143],a[100:103]
T a[132:133],v20,57344
M v[84:87],a[136:139],a[244:247]
T a[134:135],v20,61440
M v[80:83],a[136:139],a[240:243]
buffer_load_dwordx4 v8, s[32:35], s62 offen offset:3072 lds
s_sub_u32 s62, s62, 3407872
M v[80:83],a[140:143],a[96:99]
s_waitcnt lgkmcnt(8)
M v[96:99],a[144:147],a[240:243]
T a[136:137],v21,49152
M v[96:99],a[148:151],a[96:99]
T a[138:139],v21,53248
M v[100:103],a[148:151],a[100:103]
M v[100:103],a[144:147],a[244:247]
M v[104:107],a[144:147],a[248:251]
T a[140:141],v21,57344
M v[104:107],a[148:151],a[104:107]
T a[142:143],v21,61440
M v[108:111],a[148:151],a[108:111]
buffer_load_dwordx4 a[16:19], v58, s[12:15], s63 offen offset:0 sc1
M v[108:111],a[144:147],a[252:255]
s_waitcnt lgkmcnt(8)
M v[124:127],a[156:159],a[108:111]
T a[144:145],v22,49152
M v[124:127],a[152:155],a[252:255]
T a[146:147],v22,53248
M v[120:123],a[152:155],a[248:251]
buffer_load_dwordx4 a[20:23], v58, s[12:15], s63 offen offset:1024 sc1
M v[120:123],a[156:159],a[104:107]
M v[116:119],a[156:159],a[100:103]
T a[148:149],v22,57344
M v[116:119],a[152:155],a[244:247]
T a[150:151],v22,61440
M v[112:115],a[152:155],a[240:243]
buffer_load_dwordx4 a[24:27], v59, s[12:15], s63 offen offset:0 sc1
M v[112:115],a[156:159],a[96:99]
s_waitcnt lgkmcnt(8)
M v[128:131],a[128:131],a[240:243]
T a[152:153],v23,49152
M v[128:131],a[132:135],a[96:99]
T a[154:155],v23,53248
M v[132:135],a[132:135],a[100:103]
buffer_load_dwordx4 a[28:31], v59, s[12:15], s63 offen offset:1024 sc1
s_add_u32 s63, s63, 4096
M v[132:135],a[128:131],a[244:247]
M v[136:139],a[128:131],a[248:251]
T a[156:157],v23,57344
M v[136:139],a[132:135],a[104:107]
T a[158:159],v23,61440
M v[140:143],a[132:135],a[108:111]
buffer_load_dwordx4 a[32:35], v58, s[12:15], s63 offen offset:0 sc1
M v[140:143],a[128:131],a[252:255]
s_waitcnt vmcnt(29)
s_barrier
s_waitcnt lgkmcnt(8)
M v[156:159],a[140:143],a[108:111]
T a[128:129],v24,0
v_subrev_u32 v16, 65536, v16
M v[156:159],a[136:139],a[252:255]
T a[130:131],v24,4096
v_subrev_u32 v17, 65536, v17
M v[152:155],a[136:139],a[248:251]
buffer_load_dwordx4 a[36:39], v58, s[12:15], s63 offen offset:1024 sc1
v_subrev_u32 v18, 65536, v18
M v[152:155],a[140:143],a[104:107]
v_subrev_u32 v19, 65536, v19
v_subrev_u32 v20, 65536, v20
M v[148:151],a[140:143],a[100:103]
T a[132:133],v24,8192
v_subrev_u32 v21, 65536, v21
M v[148:151],a[136:139],a[244:247]
T a[134:135],v24,12288
v_subrev_u32 v22, 65536, v22
M v[144:147],a[136:139],a[240:243]
buffer_load_dwordx4 a[40:43], v59, s[12:15], s63 offen offset:0 sc1
v_subrev_u32 v23, 65536, v23
M v[144:147],a[140:143],a[96:99]
s_waitcnt lgkmcnt(8)
M v[160:163],a[144:147],a[240:243]
T a[136:137],v25,0
M v[160:163],a[148:151],a[96:99]
T a[138:139],v25,4096
M v[164:167],a[148:151],a[100:103]
buffer_load_dwordx4 a[44:47], v59, s[12:15], s63 offen offset:1024 sc1
s_add_u32 s63, s63, 4096
M v[164:167],a[144:147],a[244:247]
M v[168:171],a[144:147],a[248:251]
T a[140:141],v25,8192
M v[168:171],a[148:151],a[104:107]
T a[142:143],v25,12288
M v[172:175],a[148:151],a[108:111]
buffer_load_dwordx4 v[208:211], v58, s[12:15], s63 offen offset:0 sc1
M v[172:175],a[144:147],a[252:255]
s_waitcnt lgkmcnt(8)
M v[188:191],a[156:159],a[108:111]
T a[144:145],v26,0
M v[188:191],a[152:155],a[252:255]
T a[146:147],v26,4096
M v[184:187],a[152:155],a[248:251]
buffer_load_dwordx4 v[212:215], v58, s[12:15], s63 offen offset:1024 sc1
M v[184:187],a[156:159],a[104:107]
M v[180:183],a[156:159],a[100:103]
T a[148:149],v26,8192
M v[180:183],a[152:155],a[244:247]
T a[150:151],v26,12288
M v[176:179],a[152:155],a[240:243]
buffer_load_dwordx4 v[216:219], v59, s[12:15], s63 offen offset:0 sc1
M v[176:179],a[156:159],a[96:99]
s_barrier
s_waitcnt vmcnt(19)
s_waitcnt lgkmcnt(8)
M v[64:67],a[128:131],a[0:3]
T a[152:153],v27,0
M v[64:67],a[132:135],v[192:195]
T a[154:155],v27,4096
M v[68:71],a[132:135],v[196:199]
M v[68:71],a[128:131],a[4:7]
M v[72:75],a[128:131],a[8:11]
T a[156:157],v27,8192
M v[72:75],a[132:135],v[200:203]
T a[158:159],v27,12288
M v[76:79],a[132:135],v[204:207]
buffer_load_dwordx4 v[220:223], v59, s[12:15], s63 offen offset:1024 sc1
s_add_u32 s63, s63, 4096
M v[76:79],a[128:131],a[12:15]
s_waitcnt lgkmcnt(8)
M v[92:95],a[140:143],v[204:207]
T a[128:129],v28,0
M v[92:95],a[136:139],a[12:15]
T a[130:131],v28,4096
M v[88:91],a[136:139],a[8:11]
buffer_load_dwordx4 a[48:51], v58, s[12:15], s63 offen offset:0 sc1
M v[88:91],a[140:143],v[200:203]
M v[84:87],a[140:143],v[196:199]
T a[132:133],v28,8192
M v[84:87],a[136:139],a[4:7]
T a[134:135],v28,12288
M v[80:83],a[136:139],a[0:3]
buffer_load_dwordx4 a[52:55], v58, s[12:15], s63 offen offset:1024 sc1
M v[80:83],a[140:143],v[192:195]
s_waitcnt lgkmcnt(8)
M v[96:99],a[144:147],a[0:3]
T a[136:137],v29,0
M v[96:99],a[148:151],v[192:195]
T a[138:139],v29,4096
M v[100:103],a[148:151],v[196:199]
buffer_load_dwordx4 a[56:59], v59, s[12:15], s63 offen offset:0 sc1
M v[100:103],a[144:147],a[4:7]
M v[104:107],a[144:147],a[8:11]
T a[140:141],v29,8192
M v[104:107],a[148:151],v[200:203]
T a[142:143],v29,12288
M v[108:111],a[148:151],v[204:207]
buffer_load_dwordx4 a[60:63], v59, s[12:15], s63 offen offset:1024 sc1
s_add_u32 s63, s63, 4096
M v[108:111],a[144:147],a[12:15]
s_waitcnt lgkmcnt(8)
M v[124:127],a[156:159],v[204:207]
T a[144:145],v30,0
M v[124:127],a[152:155],a[12:15]
T a[146:147],v30,4096
M v[120:123],a[152:155],a[8:11]
M v[120:123],a[156:159],v[200:203]
M v[116:119],a[156:159],v[196:199]
T a[148:149],v30,8192
M v[116:119],a[152:155],a[4:7]
s_add_u32 m0, s60, 32768
T a[150:151],v30,12288
M v[112:115],a[152:155],a[0:3]
buffer_load_dwordx4 v1, s[32:35], s62 offen offset:0 lds
M v[112:115],a[156:159],v[192:195]
s_waitcnt lgkmcnt(8)
M v[128:131],a[128:131],a[0:3]
T a[152:153],v31,0
M v[128:131],a[132:135],v[192:195]
T a[154:155],v31,4096
M v[132:135],a[132:135],v[196:199]
buffer_load_dwordx4 v2, s[32:35], s62 offen offset:1024 lds
M v[132:135],a[128:131],a[4:7]
M v[136:139],a[128:131],a[8:11]
T a[156:157],v31,8192
M v[136:139],a[132:135],v[200:203]
T a[158:159],v31,12288
M v[140:143],a[132:135],v[204:207]
buffer_load_dwordx4 v3, s[32:35], s62 offen offset:2048 lds
M v[140:143],a[128:131],a[12:15]
s_waitcnt lgkmcnt(8)
M v[156:159],a[140:143],v[204:207]
T a[128:129],v24,16384
M v[156:159],a[136:139],a[12:15]
T a[130:131],v24,20480
M v[152:155],a[136:139],a[8:11]
buffer_load_dwordx4 v4, s[32:35], s62 offen offset:3072 lds
M v[152:155],a[140:143],v[200:203]
M v[148:151],a[140:143],v[196:199]
T a[132:133],v24,24576
M v[148:151],a[136:139],a[4:7]
s_add_u32 m0, s60, 36864
T a[134:135],v24,28672
M v[144:147],a[136:139],a[0:3]
buffer_load_dwordx4 v5, s[32:35], s62 offen offset:0 lds
M v[144:147],a[140:143],v[192:195]
s_waitcnt lgkmcnt(8)
M v[160:163],a[144:147],a[0:3]
T a[136:137],v25,16384
M v[160:163],a[148:151],v[192:195]
T a[138:139],v25,20480
M v[164:167],a[148:151],v[196:199]
M v[164:167],a[144:147],a[4:7]
M v[168:171],a[144:147],a[8:11]
T a[140:141],v25,24576
M v[168:171],a[148:151],v[200:203]
T a[142:143],v25,28672
M v[172:175],a[148:151],v[204:207]
buffer_load_dwordx4 v6, s[32:35], s62 offen offset:1024 lds
M v[172:175],a[144:147],a[12:15]
s_waitcnt lgkmcnt(8)
M v[188:191],a[156:159],v[204:207]
T a[144:145],v26,16384
M v[188:191],a[152:155],a[12:15]
T a[146:147],v26,20480
M v[184:187],a[152:155],a[8:11]
buffer_load_dwordx4 v7, s[32:35], s62 offen offset:2048 lds
M v[184:187],a[156:159],v[200:203]
M v[180:183],a[156:159],v[196:199]
T a[148:149],v26,24576
M v[180:183],a[152:155],a[4:7]
T a[150:151],v26,28672
M v[176:179],a[152:155],a[0:3]
buffer_load_dwordx4 v8, s[32:35], s62 offen offset:3072 lds
s_add_u32 s62, s62, 262144
M v[176:179],a[156:159],v[192:195]
s_waitcnt vmcnt(16)
s_waitcnt lgkmcnt(8)
M v[64:67],a[128:131],a[16:19]
T a[152:153],v27,16384
M v[64:67],a[132:135],a[32:35]
T a[154:155],v27,20480
M v[68:71],a[132:135],a[36:39]
buffer_load_dwordx4 a[160:163], v58, s[12:15], s63 offen offset:0 sc1
M v[68:71],a[128:131],a[20:23]
L_pad10:
s_cbranch_execz L_pb1A
M v[72:75],a[128:131],a[24:27]
T a[156:157],v27,24576
M v[72:75],a[132:135],a[40:43]
T a[158:159],v27,28672
M v[76:79],a[132:135],a[44:47]
buffer_load_dwordx4 a[164:167], v58, s[12:15], s63 offen offset:1024 sc1
M v[76:79],a[128:131],a[28:31]
s_waitcnt lgkmcnt(8)
M v[92:95],a[140:143],a[44:47]
T a[128:129],v28,16384
M v[92:95],a[136:139],a[28:31]
T a[130:131],v28,20480
M v[88:91],a[136:139],a[24:27]
M v[88:91],a[140:143],a[40:43]
M v[84:87],a[140:143],a[36:39]
T a[132:133],v28,24576
M v[84:87],a[136:139],a[20:23]
T a[134:135],v28,28672
M v[80:83],a[136:139],a[16:19]
buffer_load_dwordx4 a[168:171], v59, s[12:15], s63 offen offset:0 sc1
M v[80:83],a[140:143],a[32:35]
s_waitcnt lgkmcnt(8)
M v[96:99],a[144:147],a[16:19]
T a[136:137],v29,16384
M v[96:99],a[148:151],a[32:35]
T a[138:139],v29,20480
M v[100:103],a[148:151],a[36:39]
buffer_load_dwordx4 a[172:175], v59, s[12:15], s63 offen offset:1024 sc1
s_add_u32 s63, s63, 4096
M v[100:103],a[144:147],a[20:23]
M v[104:107],a[144:147],a[24:27]
T a[140:141],v29,24576
M v[104:107],a[148:151],a[40:43]
T a[142:143],v29,28672
M v[108:111],a[148:151],a[44:47]
buffer_load_dwordx4 a[176:179], v58, s[12:15], s63 offen offset:0 sc1
M v[108:111],a[144:147],a[28:31]
s_waitcnt lgkmcnt(8)
M v[124:127],a[156:159],a[44:47]
T a[144:145],v30,16384
M v[124:127],a[152:155],a[28:31]
T a[146:147],v30,20480
M v[120:123],a[152:155],a[24:27]
buffer_load_dwordx4 a[180:183], v58, s[12:15], s63 offen offset:1024 sc1
M v[120:123],a[156:159],a[40:43]
M v[116:119],a[156:159],a[36:39]
T a[148:149],v30,24576
M v[116:119],a[152:155],a[20:23]
T a[150:151],v30,28672
M v[112:115],a[152:155],a[16:19]
buffer_load_dwordx4 a[184:187], v59, s[12:15], s63 offen offset:0 sc1
M v[112:115],a[156:159],a[32:35]
s_waitcnt lgkmcnt(8)
M v[128:131],a[128:131],a[16:19]
T a[152:153],v31,16384
M v[128:131],a[132:135],a[32:35]
T a[154:155],v31,20480
M v[132:135],a[132:135],a[36:39]
buffer_load_dwordx4 a[188:191], v59, s[12:15], s63 offen offset:1024 sc1
s_sub_u32 s63, s63, 225280
M v[132:135],a[128:131],a[20:23]
M v[136:139],a[128:131],a[24:27]
T a[156:157],v31,24576
M v[136:139],a[132:135],a[40:43]
s_add_u32 m0, s60, 65536
T a[158:159],v31,28672
M v[140:143],a[132:135],a[44:47]
buffer_load_dwordx4 v1, s[32:35], s62 offen offset:0 lds
M v[140:143],a[128:131],a[28:31]
s_waitcnt vmcnt(33)
s_barrier
s_waitcnt lgkmcnt(8)
M v[156:159],a[140:143],a[44:47]
T a[128:129],v16,0
v_subrev_u32 v24, 65536, v24
M v[156:159],a[136:139],a[28:31]
T a[130:131],v16,4096
v_subrev_u32 v25, 65536, v25
M v[152:155],a[136:139],a[24:27]
buffer_load_dwordx4 v2, s[32:35], s62 offen offset:1024 lds
v_subrev_u32 v26, 65536, v26
M v[152:155],a[140:143],a[40:43]
v_subrev_u32 v27, 65536, v27
v_subrev_u32 v28, 65536, v28
M v[148:151],a[140:143],a[36:39]
T a[132:133],v16,8192
v_subrev_u32 v29, 65536, v29
M v[148:151],a[136:139],a[20:23]
T a[134:135],v16,12288
v_subrev_u32 v30, 65536, v30
M v[144:147],a[136:139],a[16:19]
buffer_load_dwordx4 v3, s[32:35], s62 offen offset:2048 lds
v_subrev_u32 v31, 65536, v31
M v[144:147],a[140:143],a[32:35]
s_waitcnt lgkmcnt(8)
M v[160:163],a[144:147],a[16:19]
T a[136:137],v17,0
M v[160:163],a[148:151],a[32:35]
T a[138:139],v17,4096
M v[164:167],a[148:151],a[36:39]
buffer_load_dwordx4 v4, s[32:35], s62 offen offset:3072 lds
M v[164:167],a[144:147],a[20:23]
M v[168:171],a[144:147],a[24:27]
T a[140:141],v17,8192
M v[168:171],a[148:151],a[40:43]
s_add_u32 m0, s60, 69632
T a[142:143],v17,12288
M v[172:175],a[148:151],a[44:47]
buffer_load_dwordx4 v5, s[32:35], s62 offen offset:0 lds
M v[172:175],a[144:147],a[28:31]
s_waitcnt lgkmcnt(8)
M v[188:191],a[156:159],a[44:47]
T a[144:145],v18,0
M v[188:191],a[152:155],a[28:31]
T a[146:147],v18,4096
M v[184:187],a[152:155],a[24:27]
M v[184:187],a[156:159],a[40:43]
M v[180:183],a[156:159],a[36:39]
T a[148:149],v18,8192
M v[180:183],a[152:155],a[20:23]
T a[150:151],v18,12288
M v[176:179],a[152:155],a[16:19]
buffer_load_dwordx4 v6, s[32:35], s62 offen offset:1024 lds
M v[176:179],a[156:159],a[32:35]
s_waitcnt vmcnt(22)
s_waitcnt lgkmcnt(8)
M v[64:67],a[128:131],v[208:211]
T a[152:153],v19,0
M v[64:67],a[132:135],a[48:51]
s_add_u32 s73, s64, 4
T a[154:155],v19,4096
M v[68:71],a[132:135],a[52:55]
buffer_load_dword v62, v14, s[12:15], s6 offen sc1
M v[68:71],a[128:131],v[212:215]
M v[72:75],a[128:131],v[216:219]
T a[156:157],v19,8192
M v[72:75],a[132:135],a[56:59]
T a[158:159],v19,12288
M v[76:79],a[132:135],a[60:63]
buffer_load_dwordx4 v7, s[32:35], s62 offen offset:2048 lds
M v[76:79],a[128:131],v[220:223]
s_waitcnt lgkmcnt(8)
M v[92:95],a[140:143],a[60:63]
T a[128:129],v20,0
M v[92:95],a[136:139],v[220:223]
T a[130:131],v20,4096
M v[88:91],a[136:139],v[216:219]
buffer_load_dwordx4 v8, s[32:35], s62 offen offset:3072 lds
s_add_u32 s62, s62, 262144
M v[88:91],a[140:143],a[56:59]
M v[84:87],a[140:143],a[52:55]
T a[132:133],v20,8192
M v[84:87],a[136:139],v[212:215]
s_add_u32 m0, s60, 98304
T a[134:135],v20,12288
M v[80:83],a[136:139],v[208:211]
buffer_load_dwordx4 v1, s[32:35], s62 offen offset:0 lds
M v[80:83],a[140:143],a[48:51]
s_waitcnt lgkmcnt(8)
M v[96:99],a[144:147],v[208:211]
T a[136:137],v21,0
M v[96:99],a[148:151],a[48:51]
T a[138:139],v21,4096
M v[100:103],a[148:151],a[52:55]
M v[100:103],a[144:147],v[212:215]
M v[104:107],a[144:147],v[216:219]
T a[140:141],v21,8192
M v[104:107],a[148:151],a[56:59]
T a[142:143],v21,12288
M v[108:111],a[148:151],a[60:63]
buffer_load_dwordx4 v2, s[32:35], s62 offen offset:1024 lds
M v[108:111],a[144:147],v[220:223]
s_waitcnt lgkmcnt(8)
M v[124:127],a[156:159],a[60:63]
T a[144:145],v22,0
M v[124:127],a[152:155],v[220:223]
T a[146:147],v22,4096
M v[120:123],a[152:155],v[216:219]
buffer_load_dwordx4 v3, s[32:35], s62 offen offset:2048 lds
M v[120:123],a[156:159],a[56:59]
M v[116:119],a[156:159],a[52:55]
T a[148:149],v22,8192
M v[116:119],a[152:155],v[212:215]
T a[150:151],v22,12288
M v[112:115],a[152:155],v[208:211]
buffer_load_dwordx4 v4, s[32:35], s62 offen offset:3072 lds
M v[112:115],a[156:159],a[48:51]
s_waitcnt lgkmcnt(8)
M v[128:131],a[128:131],v[208:211]
T a[152:153],v23,0
M v[128:131],a[132:135],a[48:51]
s_add_u32 m0, s60, 102400
T a[154:155],v23,4096
M v[132:135],a[132:135],a[52:55]
buffer_load_dwordx4 v5, s[32:35], s62 offen offset:0 lds
M v[132:135],a[128:131],v[212:215]
M v[136:139],a[128:131],v[216:219]
T a[156:157],v23,8192
M v[136:139],a[132:135],a[56:59]
T a[158:159],v23,12288
M v[140:143],a[132:135],a[60:63]
buffer_load_dwordx4 v6, s[32:35], s62 offen offset:1024 lds
M v[140:143],a[128:131],v[220:223]
s_waitcnt lgkmcnt(8)
M v[156:159],a[140:143],a[60:63]
T a[128:129],v16,16384
M v[156:159],a[136:139],v[220:223]
T a[130:131],v16,20480
M v[152:155],a[136:139],v[216:219]
M v[152:155],a[140:143],a[56:59]
M v[148:151],a[140:143],a[52:55]
T a[132:133],v16,24576
M v[148:151],a[136:139],v[212:215]
T a[134:135],v16,28672
M v[144:147],a[136:139],v[208:211]
buffer_load_dwordx4 v7, s[32:35], s62 offen offset:2048 lds
M v[144:147],a[140:143],a[48:51]
s_waitcnt lgkmcnt(8)
M v[160:163],a[144:147],v[208:211]
T a[136:137],v17,16384
M v[160:163],a[148:151],a[48:51]
T a[138:139],v17,20480
M v[164:167],a[148:151],a[52:55]
buffer_load_dwordx4 v8, s[32:35], s62 offen offset:3072 lds
s_add_u32 s62, s62, 262144
M v[164:167],a[144:147],v[212:215]
M v[168:171],a[144:147],v[216:219]
T a[140:141],v17,24576
M v[168:171],a[148:151],a[56:59]
T a[142:143],v17,28672
M v[172:175],a[148:151],a[60:63]
M v[172:175],a[144:147],v[220:223]
s_waitcnt lgkmcnt(8)
M v[188:191],a[156:159],a[60:63]
T a[144:145],v18,16384
M v[188:191],a[152:155],v[220:223]
T a[146:147],v18,20480
M v[184:187],a[152:155],v[216:219]
M v[184:187],a[156:159],a[56:59]
M v[180:183],a[156:159],a[52:55]
T a[148:149],v18,24576
M v[180:183],a[152:155],v[212:215]
T a[150:151],v18,28672
M v[176:179],a[152:155],v[208:211]
M v[176:179],a[156:159],a[48:51]
s_waitcnt vmcnt(17)
s_waitcnt lgkmcnt(8)
M v[64:67],a[128:131],a[160:163]
s_lshl_b32 s70, s55, 21
T a[152:153],v19,16384
v_lshrrev_b32 v52, 2, v0
M v[64:67],a[132:135],a[176:179]
s_lshl_b32 s71, s52, 16
T a[154:155],v19,20480
v_and_b32 v53, 3, v0
M v[68:71],a[132:135],a[180:183]
s_add_u32 s70, s70, s71
v_lshlrev_b32 v52, 11, v52
v_lshl_add_u32 v52, v53, 4, v52
M v[68:71],a[128:131],a[164:167]
s_add_u32 s70, s70, s58
s_add_u32 s69, s70, 1835008
s_lshl_b32 s72, s52, 11
M v[72:75],a[128:131],a[168:171]
s_waitcnt vmcnt(10)
T a[156:157],v19,24576
v_subrev_u32 v62, s73, v62
M v[72:75],a[132:135],a[184:187]
T a[158:159],v19,28672
v_cmp_le_u32 vcc, 12, v62
M v[76:79],a[132:135],a[188:191]
s_cbranch_vccnz SPIN_nA
BACK_nA:
M v[76:79],a[128:131],a[172:175]
buffer_load_dwordx4 a[112:115], v58, s[12:15], s63 offen offset:0 sc1
s_waitcnt lgkmcnt(8)
M v[92:95],a[140:143],a[188:191]
T a[128:129],v20,16384
M v[92:95],a[136:139],a[172:175]
T a[130:131],v20,20480
M v[88:91],a[136:139],a[168:171]
buffer_load_dwordx4 a[116:119], v58, s[12:15], s63 offen offset:1024 sc1
M v[88:91],a[140:143],a[184:187]
buffer_load_dwordx4 a[120:123], v59, s[12:15], s63 offen offset:0 sc1
M v[84:87],a[140:143],a[180:183]
T a[132:133],v20,24576
M v[84:87],a[136:139],a[164:167]
T a[134:135],v20,28672
M v[80:83],a[136:139],a[160:163]
buffer_load_dwordx4 a[124:127], v59, s[12:15], s63 offen offset:1024 sc1
s_add_u32 s63, s63, 4096
M v[80:83],a[140:143],a[176:179]
buffer_load_dwordx4 a[64:67], v58, s[12:15], s63 offen offset:0 sc1
s_waitcnt lgkmcnt(8)
M v[96:99],a[144:147],a[160:163]
T a[136:137],v21,16384
M v[96:99],a[148:151],a[176:179]
T a[138:139],v21,20480
M v[100:103],a[148:151],a[180:183]
buffer_load_dwordx4 a[68:71], v58, s[12:15], s63 offen offset:1024 sc1
M v[100:103],a[144:147],a[164:167]
buffer_load_dwordx4 a[72:75], v59, s[12:15], s63 offen offset:0 sc1
M v[104:107],a[144:147],a[168:171]
T a[140:141],v21,24576
M v[104:107],a[148:151],a[184:187]
T a[142:143],v21,28672
M v[108:111],a[148:151],a[188:191]
buffer_load_dwordx4 a[76:79], v59, s[12:15], s63 offen offset:1024 sc1
s_add_u32 s63, s63, 4096
M v[108:111],a[144:147],a[172:175]
s_waitcnt lgkmcnt(8)
M v[124:127],a[156:159],a[188:191]
T a[144:145],v22,16384
M v[124:127],a[152:155],a[172:175]
T a[146:147],v22,20480
M v[120:123],a[152:155],a[168:171]
M v[120:123],a[156:159],a[184:187]
M v[116:119],a[156:159],a[180:183]
T a[148:149],v22,24576
M v[116:119],a[152:155],a[164:167]
T a[150:151],v22,28672
M v[112:115],a[152:155],a[160:163]
buffer_load_dwordx4 a[80:83], v58, s[12:15], s63 offen offset:0 sc1
M v[112:115],a[156:159],a[176:179]
s_waitcnt lgkmcnt(8)
M v[128:131],a[128:131],a[160:163]
T a[152:153],v23,16384
M v[128:131],a[132:135],a[176:179]
T a[154:155],v23,20480
M v[132:135],a[132:135],a[180:183]
buffer_load_dwordx4 a[84:87], v58, s[12:15], s63 offen offset:1024 sc1
M v[132:135],a[128:131],a[164:167]
M v[136:139],a[128:131],a[168:171]
T a[156:157],v23,24576
M v[136:139],a[132:135],a[184:187]
T a[158:159],v23,28672
M v[140:143],a[132:135],a[188:191]
buffer_load_dwordx4 a[88:91], v59, s[12:15], s63 offen offset:0 sc1
M v[140:143],a[128:131],a[172:175]
s_waitcnt vmcnt(36)
s_barrier
s_waitcnt lgkmcnt(8)
M v[156:159],a[140:143],a[188:191]
T a[128:129],v16,32768
M v[156:159],a[136:139],a[172:175]
T a[130:131],v16,36864
M v[152:155],a[136:139],a[168:171]
buffer_load_dwordx4 a[92:95], v59, s[12:15], s63 offen offset:1024 sc1
s_add_u32 s63, s63, 4096
M v[152:155],a[140:143],a[184:187]
M v[148:151],a[140:143],a[180:183]
T a[132:133],v16,40960
M v[148:151],a[136:139],a[164:167]
T a[134:135],v16,45056
M v[144:147],a[136:139],a[160:163]
buffer_load_dwordx4 a[192:195], v58, s[12:15], s63 offen offset:0 sc1
M v[144:147],a[140:143],a[176:179]
s_waitcnt lgkmcnt(8)
M v[160:163],a[144:147],a[160:163]
T a[136:137],v17,32768
M v[160:163],a[148:151],a[176:179]
T a[138:139],v17,36864
M v[164:167],a[148:151],a[180:183]
buffer_load_dwordx4 a[196:199], v58, s[12:15], s63 offen offset:1024 sc1
M v[164:167],a[144:147],a[164:167]
M v[168:171],a[144:147],a[168:171]
T a[140:141],v17,40960
M v[168:171],a[148:151],a[184:187]
T a[142:143],v17,45056
M v[172:175],a[148:151],a[188:191]
buffer_load_dwordx4 a[200:203], v59, s[12:15], s63 offen offset:0 sc1
M v[172:175],a[144:147],a[172:175]
s_waitcnt lgkmcnt(8)
M v[188:191],a[156:159],a[188:191]
T a[144:145],v18,32768
M v[188:191],a[152:155],a[172:175]
T a[146:147],v18,36864
M v[184:187],a[152:155],a[168:171]
buffer_load_dwordx4 a[204:207], v59, s[12:15], s63 offen offset:1024 sc1
s_add_u32 s63, s63, 4096
M v[184:187],a[156:159],a[184:187]
M v[180:183],a[156:159],a[180:183]
T a[148:149],v18,40960
M v[180:183],a[152:155],a[164:167]
T a[150:151],v18,45056
M v[176:179],a[152:155],a[160:163]
buffer_load_dwordx4 a[208:211], v58, s[12:15], s63 offen offset:0 sc1
M v[176:179],a[156:159],a[176:179]
s_barrier
s_waitcnt vmcnt(9)
s_waitcnt lgkmcnt(8)
M v[64:67],a[128:131],a[112:115]
T a[152:153],v19,32768
M v[64:67],a[132:135],a[64:67]
T a[154:155],v19,36864
M v[68:71],a[132:135],a[68:71]
buffer_load_dwordx4 a[212:215], v58, s[12:15], s63 offen offset:1024 sc1
M v[68:71],a[128:131],a[116:119]
M v[72:75],a[128:131],a[120:123]
T a[156:157],v19,40960
M v[72:75],a[132:135],a[72:75]
T a[158:159],v19,45056
M v[76:79],a[132:135],a[76:79]
buffer_load_dwordx4 a[216:219], v59, s[12:15], s63 offen offset:0 sc1
M v[76:79],a[128:131],a[124:127]
s_waitcnt lgkmcnt(8)
M v[92:95],a[140:143],a[76:79]
T a[128:129],v20,32768
M v[92:95],a[136:139],a[124:127]
T a[130:131],v20,36864
M v[88:91],a[136:139],a[120:123]
buffer_load_dwordx4 a[220:223], v59, s[12:15], s63 offen offset:1024 sc1
s_add_u32 s63, s63, 4096
M v[88:91],a[140:143],a[72:75]
M v[84:87],a[140:143],a[68:71]
T a[132:133],v20,40960
M v[84:87],a[136:139],a[116:119]
T a[134:135],v20,45056
M v[80:83],a[136:139],a[112:115]
buffer_load_dwordx4 a[224:227], v58, s[12:15], s63 offen offset:0 sc1
M v[80:83],a[140:143],a[64:67]
s_waitcnt lgkmcnt(8)
M v[96:99],a[144:147],a[112:115]
T a[136:137],v21,32768
M v[96:99],a[148:151],a[64:67]
T a[138:139],v21,36864
M v[100:103],a[148:151],a[68:71]
buffer_load_dwordx4 a[228:231], v58, s[12:15], s63 offen offset:1024 sc1
M v[100:103],a[144:147],a[116:119]
M v[104:107],a[144:147],a[120:123]
T a[140:141],v21,40960
M v[104:107],a[148:151],a[72:75]
T a[142:143],v21,45056
M v[108:111],a[148:151],a[76:79]
M v[108:111],a[144:147],a[124:127]
s_waitcnt lgkmcnt(8)
M v[124:127],a[156:159],a[76:79]
T a[144:145],v22,32768
M v[124:127],a[152:155],a[124:127]
T a[146:147],v22,36864
M v[120:123],a[152:155],a[120:123]
buffer_load_dwordx4 a[232:235], v59, s[12:15], s63 offen offset:0 sc1
M v[120:123],a[156:159],a[72:75]
M v[116:119],a[156:159],a[68:71]
T a[148:149],v22,40960
M v[116:119],a[152:155],a[116:119]
T a[150:151],v22,45056
M v[112:115],a[152:155],a[112:115]
buffer_load_dwordx4 a[236:239], v59, s[12:15], s63 offen offset:1024 sc1
s_add_u32 s63, s63, 4096
M v[112:115],a[156:159],a[64:67]
s_waitcnt lgkmcnt(8)
M v[128:131],a[128:131],a[112:115]
T a[152:153],v23,32768
M v[128:131],a[132:135],a[64:67]
T a[154:155],v23,36864
M v[132:135],a[132:135],a[68:71]
buffer_load_dwordx4 a[240:243], v58, s[12:15], s63 offen offset:0 sc1
M v[132:135],a[128:131],a[116:119]
M v[136:139],a[128:131],a[120:123]
T a[156:157],v23,40960
M v[136:139],a[132:135],a[72:75]
T a[158:159],v23,45056
M v[140:143],a[132:135],a[76:79]
buffer_load_dwordx4 a[244:247], v58, s[12:15], s63 offen offset:1024 sc1
M v[140:143],a[128:131],a[124:127]
s_waitcnt lgkmcnt(8)
M v[156:159],a[140:143],a[76:79]
T a[128:129],v16,49152
M v[156:159],a[136:139],a[124:127]
T a[130:131],v16,53248
M v[152:155],a[136:139],a[120:123]
buffer_load_dwordx4 a[248:251], v59, s[12:15], s63 offen offset:0 sc1
M v[152:155],a[140:143],a[72:75]
M v[148:151],a[140:143],a[68:71]
T a[132:133],v16,57344
M v[148:151],a[136:139],a[116:119]
T a[134:135],v16,61440
M v[144:147],a[136:139],a[112:115]
buffer_load_dwordx4 a[252:255], v59, s[12:15], s63 offen offset:1024 sc1
s_add_u32 s63, s63, 4096
M v[144:147],a[140:143],a[64:67]
s_waitcnt lgkmcnt(8)
M v[160:163],a[144:147],a[112:115]
T a[136:137],v17,49152
M v[160:163],a[148:151],a[64:67]
T a[138:139],v17,53248
M v[164:167],a[148:151],a[68:71]
M v[164:167],a[144:147],a[116:119]
M v[168:171],a[144:147],a[120:123]
T a[140:141],v17,57344
M v[168:171],a[148:151],a[72:75]
T a[142:143],v17,61440
M v[172:175],a[148:151],a[76:79]
buffer_load_dwordx4 a[96:99], v58, s[12:15], s63 offen offset:0 sc1
M v[172:175],a[144:147],a[124:127]
s_waitcnt lgkmcnt(8)
M v[188:191],a[156:159],a[76:79]
T a[144:145],v18,49152
M v[188:191],a[152:155],a[124:127]
T a[146:147],v18,53248
M v[184:187],a[152:155],a[120:123]
buffer_load_dwordx4 a[100:103], v58, s[12:15], s63 offen offset:1024 sc1
M v[184:187],a[156:159],a[72:75]
M v[180:183],a[156:159],a[68:71]
T a[148:149],v18,57344
M v[180:183],a[152:155],a[116:119]
T a[150:151],v18,61440
M v[176:179],a[152:155],a[112:115]
buffer_load_dwordx4 a[104:107], v59, s[12:15], s63 offen offset:0 sc1
M v[176:179],a[156:159],a[64:67]
s_waitcnt vmcnt(15)
s_waitcnt lgkmcnt(8)
M v[64:67],a[128:131],a[80:83]
T a[152:153],v19,49152
M v[64:67],a[132:135],a[192:195]
T a[154:155],v19,53248
M v[68:71],a[132:135],a[196:199]
buffer_load_dwordx4 a[108:111], v59, s[12:15], s63 offen offset:1024 sc1
s_add_u32 s63, s63, 4096
M v[68:71],a[128:131],a[84:87]
M v[72:75],a[128:131],a[88:91]
T a[156:157],v19,57344
M v[72:75],a[132:135],a[200:203]
T a[158:159],v19,61440
M v[76:79],a[132:135],a[204:207]
buffer_load_dwordx4 a[0:3], v58, s[12:15], s63 offen offset:0 sc1
M v[76:79],a[128:131],a[92:95]
s_waitcnt lgkmcnt(8)
M v[92:95],a[140:143],a[204:207]
T a[128:129],v20,49152
M v[92:95],a[136:139],a[92:95]
T a[130:131],v20,53248
M v[88:91],a[136:139],a[88:91]
buffer_load_dwordx4 a[4:7], v58, s[12:15], s63 offen offset:1024 sc1
M v[88:91],a[140:143],a[200:203]
L_pad11:
s_cbranch_execz L_pb1A
M v[84:87],a[140:143],a[196:199]
T a[132:133],v20,57344
M v[84:87],a[136:139],a[84:87]
T a[134:135],v20,61440
M v[80:83],a[136:139],a[80:83]
M v[80:83],a[140:143],a[192:195]
s_waitcnt lgkmcnt(8)
M v[96:99],a[144:147],a[80:83]
T a[136:137],v21,49152
M v[96:99],a[148:151],a[192:195]
T a[138:139],v21,53248
M v[100:103],a[148:151],a[196:199]
buffer_load_dwordx4 a[8:11], v59, s[12:15], s63 offen offset:0 sc1
M v[100:103],a[144:147],a[84:87]
M v[104:107],a[144:147],a[88:91]
T a[140:141],v21,57344
M v[104:107],a[148:151],a[200:203]
T a[142:143],v21,61440
M v[108:111],a[148:151],a[204:207]
buffer_load_dwordx4 a[12:15], v59, s[12:15], s63 offen offset:1024 sc1
s_add_u32 s63, s63, 4096
M v[108:111],a[144:147],a[92:95]
s_waitcnt lgkmcnt(8)
M v[124:127],a[156:159],a[204:207]
T a[144:145],v22,49152
M v[124:127],a[152:155],a[92:95]
T a[146:147],v22,53248
M v[120:123],a[152:155],a[88:91]
buffer_load_dwordx4 v[192:195], v58, s[12:15], s63 offen offset:0 sc1
M v[120:123],a[156:159],a[200:203]
M v[116:119],a[156:159],a[196:199]
T a[148:149],v22,57344
M v[116:119],a[152:155],a[84:87]
T a[150:151],v22,61440
M v[112:115],a[152:155],a[80:83]
buffer_load_dwordx4 v[196:199], v58, s[12:15], s63 offen offset:1024 sc1
M v[112:115],a[156:159],a[192:195]
s_waitcnt lgkmcnt(8)
M v[128:131],a[128:131],a[80:83]
T a[152:153],v23,49152
M v[128:131],a[132:135],a[192:195]
T a[154:155],v23,53248
M v[132:135],a[132:135],a[196:199]
buffer_load_dwordx4 v[200:203], v59, s[12:15], s63 offen offset:0 sc1
M v[132:135],a[128:131],a[84:87]
M v[136:139],a[128:131],a[88:91]
T a[156:157],v23,57344
M v[136:139],a[132:135],a[200:203]
T a[158:159],v23,61440
M v[140:143],a[132:135],a[204:207]
buffer_load_dwordx4 v[204:207], v59, s[12:15], s63 offen offset:1024 sc1
s_add_u32 s63, s63, 4096
M v[140:143],a[128:131],a[92:95]
s_waitcnt vmcnt(48)
s_barrier
s_waitcnt lgkmcnt(8)
M v[156:159],a[140:143],a[204:207]
T a[128:129],v24,0
M v[156:159],a[136:139],a[92:95]
T a[130:131],v24,4096
M v[152:155],a[136:139],a[88:91]
M v[152:155],a[140:143],a[200:203]
M v[148:151],a[140:143],a[196:199]
T a[132:133],v24,8192
M v[148:151],a[136:139],a[84:87]
s_add_u32 m0, s60, 0
T a[134:135],v24,12288
M v[144:147],a[136:139],a[80:83]
buffer_load_dwordx4 v1, s[32:35], s62 offen offset:0 lds
M v[144:147],a[140:143],a[192:195]
s_waitcnt lgkmcnt(8)
M v[160:163],a[144:147],a[80:83]
T a[136:137],v25,0
M v[160:163],a[148:151],a[192:195]
T a[138:139],v25,4096
M v[164:167],a[148:151],a[196:199]
buffer_load_dwordx4 v2, s[32:35], s62 offen offset:1024 lds
M v[164:167],a[144:147],a[84:87]
M v[168:171],a[144:147],a[88:91]
T a[140:141],v25,8192
M v[168:171],a[148:151],a[200:203]
T a[142:143],v25,12288
M v[172:175],a[148:151],a[204:207]
buffer_load_dwordx4 v3, s[32:35], s62 offen offset:2048 lds
M v[172:175],a[144:147],a[92:95]
s_waitcnt lgkmcnt(8)
M v[188:191],a[156:159],a[204:207]
T a[144:145],v26,0
M v[188:191],a[152:155],a[92:95]
T a[146:147],v26,4096
M v[184:187],a[152:155],a[88:91]
buffer_load_dwordx4 v4, s[32:35], s62 offen offset:3072 lds
M v[184:187],a[156:159],a[200:203]
M v[180:183],a[156:159],a[196:199]
T a[148:149],v26,8192
M v[180:183],a[152:155],a[84:87]
s_add_u32 m0, s60, 4096
T a[150:151],v26,12288
M v[176:179],a[152:155],a[80:83]
buffer_load_dwordx4 v5, s[32:35], s62 offen offset:0 lds
M v[176:179],a[156:159],a[192:195]
s_barrier
s_waitcnt vmcnt(21)
s_waitcnt lgkmcnt(8)
M v[64:67],a[128:131],a[208:211]
T a[152:153],v27,0
M v[64:67],a[132:135],a[224:227]
T a[154:155],v27,4096
M v[68:71],a[132:135],a[228:231]
buffer_load_dwordx4 v6, s[32:35], s62 offen offset:1024 lds
M v[68:71],a[128:131],a[212:215]
M v[72:75],a[128:131],a[216:219]
T a[156:157],v27,8192
M v[72:75],a[132:135],a[232:235]
T a[158:159],v27,12288
M v[76:79],a[132:135],a[236:239]
M v[76:79],a[128:131],a[220:223]
s_waitcnt lgkmcnt(8)
M v[92:95],a[140:143],a[236:239]
T a[128:129],v28,0
M v[92:95],a[136:139],a[220:223]
T a[130:131],v28,4096
M v[88:91],a[136:139],a[216:219]
buffer_load_dwordx4 v7, s[32:35], s62 offen offset:2048 lds
M v[88:91],a[140:143],a[232:235]
M v[84:87],a[140:143],a[228:231]
T a[132:133],v28,8192
M v[84:87],a[136:139],a[212:215]
T a[134:135],v28,12288
M v[80:83],a[136:139],a[208:211]
buffer_load_dwordx4 v8, s[32:35], s62 offen offset:3072 lds
s_add_u32 s62, s62, 262144
M v[80:83],a[140:143],a[224:227]
s_waitcnt lgkmcnt(8)
M v[96:99],a[144:147],a[208:211]
T a[136:137],v29,0
M v[96:99],a[148:151],a[224:227]
T a[138:139],v29,4096
M v[100:103],a[148:151],a[228:231]
buffer_load_dwordx4 a[16:19], v58, s[12:15], s63 offen offset:0 sc1
M v[100:103],a[144:147],a[212:215]
M v[104:107],a[144:147],a[216:219]
T a[140:141],v29,8192
M v[104:107],a[148:151],a[232:235]
T a[142:143],v29,12288
M v[108:111],a[148:151],a[236:239]
buffer_load_dwordx4 a[20:23], v58, s[12:15], s63 offen offset:1024 sc1
M v[108:111],a[144:147],a[220:223]
s_waitcnt lgkmcnt(8)
M v[124:127],a[156:159],a[236:239]
T a[144:145],v30,0
M v[124:127],a[152:155],a[220:223]
T a[146:147],v30,4096
M v[120:123],a[152:155],a[216:219]
buffer_load_dwordx4 a[24:27], v59, s[12:15], s63 offen offset:0 sc1
M v[120:123],a[156:159],a[232:235]
M v[116:119],a[156:159],a[228:231]
T a[148:149],v30,8192
M v[116:119],a[152:155],a[212:215]
T a[150:151],v30,12288
M v[112:115],a[152:155],a[208:211]
buffer_load_dwordx4 a[28:31], v59, s[12:15], s63 offen offset:1024 sc1
s_add_u32 s63, s63, 4096
M v[112:115],a[156:159],a[224:227]
s_waitcnt lgkmcnt(8)
M v[128:131],a[128:131],a[208:211]
T a[152:153],v31,0
M v[128:131],a[132:135],a[224:227]
T a[154:155],v31,4096
M v[132:135],a[132:135],a[228:231]
M v[132:135],a[128:131],a[212:215]
M v[136:139],a[128:131],a[216:219]
T a[156:157],v31,8192
M v[136:139],a[132:135],a[232:235]
T a[158:159],v31,12288
M v[140:143],a[132:135],a[236:239]
buffer_load_dwordx4 a[32:35], v58, s[12:15], s63 offen offset:0 sc1
M v[140:143],a[128:131],a[220:223]
s_waitcnt lgkmcnt(8)
M v[156:159],a[140:143],a[236:239]
T a[128:129],v24,16384
M v[156:159],a[136:139],a[220:223]
T a[130:131],v24,20480
M v[152:155],a[136:139],a[216:219]
buffer_load_dwordx4 a[36:39], v58, s[12:15], s63 offen offset:1024 sc1
M v[152:155],a[140:143],a[232:235]
M v[148:151],a[140:143],a[228:231]
T a[132:133],v24,24576
M v[148:151],a[136:139],a[212:215]
T a[134:135],v24,28672
M v[144:147],a[136:139],a[208:211]
buffer_load_dwordx4 a[40:43], v59, s[12:15], s63 offen offset:0 sc1
M v[144:147],a[140:143],a[224:227]
s_waitcnt lgkmcnt(8)
M v[160:163],a[144:147],a[208:211]
T a[136:137],v25,16384
M v[160:163],a[148:151],a[224:227]
T a[138:139],v25,20480
M v[164:167],a[148:151],a[228:231]
buffer_load_dwordx4 a[44:47], v59, s[12:15], s63 offen offset:1024 sc1
s_add_u32 s63, s63, 4096
M v[164:167],a[144:147],a[212:215]
M v[168:171],a[144:147],a[216:219]
T a[140:141],v25,24576
M v[168:171],a[148:151],a[232:235]
s_add_u32 m0, s72, 131072
T a[142:143],v25,28672
M v[172:175],a[148:151],a[236:239]
buffer_load_dwordx4 v52, s[28:31], s69 offen offset:0 lds
s_add_u32 s69, s69, 31744
M v[172:175],a[144:147],a[220:223]
s_waitcnt lgkmcnt(8)
M v[188:191],a[156:159],a[236:239]
T a[144:145],v26,16384
M v[188:191],a[152:155],a[220:223]
T a[146:147],v26,20480
M v[184:187],a[152:155],a[216:219]
buffer_load_dwordx4 v52, s[28:31], s69 offen offset:1024 lds
M v[184:187],a[156:159],a[232:235]
M v[180:183],a[156:159],a[228:231]
T a[148:149],v26,24576
M v[180:183],a[152:155],a[212:215]
T a[150:151],v26,28672
M v[176:179],a[152:155],a[208:211]
M v[176:179],a[156:159],a[224:227]
s_waitcnt vmcnt(26)
s_waitcnt lgkmcnt(8)
M v[64:67],a[128:131],a[240:243]
T a[152:153],v27,16384
M v[64:67],a[132:135],a[96:99]
T a[154:155],v27,20480
M v[68:71],a[132:135],a[100:103]
buffer_load_dwordx4 v[208:211], v58, s[12:15], s63 offen offset:0 sc1
M v[68:71],a[128:131],a[244:247]
M v[72:75],a[128:131],a[248:251]
T a[156:157],v27,24576
M v[72:75],a[132:135],a[104:107]
T a[158:159],v27,28672
M v[76:79],a[132:135],a[108:111]
buffer_load_dwordx4 v[212:215], v58, s[12:15], s63 offen offset:1024 sc1
M v[76:79],a[128:131],a[252:255]
s_waitcnt lgkmcnt(8)
M v[92:95],a[140:143],a[108:111]
T a[128:129],v28,16384
M v[92:95],a[136:139],a[252:255]
T a[130:131],v28,20480
M v[88:91],a[136:139],a[248:251]
buffer_load_dwordx4 v[216:219], v59, s[12:15], s63 offen offset:0 sc1
M v[88:91],a[140:143],a[104:107]
M v[84:87],a[140:143],a[100:103]
T a[132:133],v28,24576
M v[84:87],a[136:139],a[244:247]
T a[134:135],v28,28672
M v[80:83],a[136:139],a[240:243]
buffer_load_dwordx4 v[220:223], v59, s[12:15], s63 offen offset:1024 sc1
s_add_u32 s63, s63, 4096
M v[80:83],a[140:143],a[96:99]
s_waitcnt lgkmcnt(8)
M v[96:99],a[144:147],a[240:243]
T a[136:137],v29,16384
M v[96:99],a[148:151],a[96:99]
T a[138:139],v29,20480
M v[100:103],a[148:151],a[100:103]
buffer_load_dwordx4 a[48:51], v58, s[12:15], s63 offen offset:0 sc1
M v[100:103],a[144:147],a[244:247]
M v[104:107],a[144:147],a[248:251]
T a[140:141],v29,24576
M v[104:107],a[148:151],a[104:107]
T a[142:143],v29,28672
M v[108:111],a[148:151],a[108:111]
buffer_load_dwordx4 a[52:55], v58, s[12:15], s63 offen offset:1024 sc1
M v[108:111],a[144:147],a[252:255]
s_waitcnt lgkmcnt(8)
M v[124:127],a[156:159],a[108:111]
T a[144:145],v30,16384
M v[124:127],a[152:155],a[252:255]
T a[146:147],v30,20480
M v[120:123],a[152:155],a[248:251]
M v[120:123],a[156:159],a[104:107]
M v[116:119],a[156:159],a[100:103]
T a[148:149],v30,24576
M v[116:119],a[152:155],a[244:247]
T a[150:151],v30,28672
M v[112:115],a[152:155],a[240:243]
buffer_load_dwordx4 a[56:59], v59, s[12:15], s63 offen offset:0 sc1
M v[112:115],a[156:159],a[96:99]
s_waitcnt lgkmcnt(8)
M v[128:131],a[128:131],a[240:243]
T a[152:153],v31,16384
M v[128:131],a[132:135],a[96:99]
T a[154:155],v31,20480
M v[132:135],a[132:135],a[100:103]
buffer_load_dwordx4 a[60:63], v59, s[12:15], s63 offen offset:1024 sc1
s_add_u32 s63, s63, 4096
M v[132:135],a[128:131],a[244:247]
M v[136:139],a[128:131],a[248:251]
T a[156:157],v31,24576
M v[136:139],a[132:135],a[104:107]
s_add_u32 m0, s60, 32768
T a[158:159],v31,28672
M v[140:143],a[132:135],a[108:111]
buffer_load_dwordx4 v1, s[32:35], s62 offen offset:0 lds
M v[140:143],a[128:131],a[252:255]
s_waitcnt vmcnt(63)
s_barrier
s_waitcnt lgkmcnt(8)
M v[156:159],a[140:143],a[108:111]
T a[128:129],v24,32768
M v[156:159],a[136:139],a[252:255]
T a[130:131],v24,36864
M v[152:155],a[136:139],a[248:251]
buffer_load_dwordx4 v2, s[32:35], s62 offen offset:1024 lds
M v[152:155],a[140:143],a[104:107]
M v[148:151],a[140:143],a[100:103]
T a[132:133],v24,40960
M v[148:151],a[136:139],a[244:247]
T a[134:135],v24,45056
M v[144:147],a[136:139],a[240:243]
buffer_load_dwordx4 v3, s[32:35], s62 offen offset:2048 lds
M v[144:147],a[140:143],a[96:99]
s_waitcnt lgkmcnt(8)
M v[160:163],a[144:147],a[240:243]
T a[136:137],v25,32768
M v[160:163],a[148:151],a[96:99]
T a[138:139],v25,36864
M v[164:167],a[148:151],a[100:103]
buffer_load_dwordx4 v4, s[32:35], s62 offen offset:3072 lds
M v[164:167],a[144:147],a[244:247]
M v[168:171],a[144:147],a[248:251]
T a[140:141],v25,40960
M v[168:171],a[148:151],a[104:107]
T a[142:143],v25,45056
M v[172:175],a[148:151],a[108:111]
M v[172:175],a[144:147],a[252:255]
s_waitcnt lgkmcnt(8)
M v[188:191],a[156:159],a[108:111]
T a[144:145],v26,32768
M v[188:191],a[152:155],a[252:255]
s_add_u32 m0, s60, 36864
T a[146:147],v26,36864
M v[184:187],a[152:155],a[248:251]
buffer_load_dwordx4 v5, s[32:35], s62 offen offset:0 lds
M v[184:187],a[156:159],a[104:107]
M v[180:183],a[156:159],a[100:103]
T a[148:149],v26,40960
M v[180:183],a[152:155],a[244:247]
T a[150:151],v26,45056
M v[176:179],a[152:155],a[240:243]
buffer_load_dwordx4 v6, s[32:35], s62 offen offset:1024 lds
M v[176:179],a[156:159],a[96:99]
s_barrier
s_waitcnt vmcnt(32)
s_waitcnt lgkmcnt(8)
M v[64:67],a[128:131],a[0:3]
s_xor_b32 s70, s55, 2
T a[152:153],v27,32768
v_and_b32 v48, 15, v0
M v[64:67],a[132:135],v[192:195]
s_lshl_b32 s70, s70, 10
T a[154:155],v27,36864
v_lshrrev_b32 v49, 1, v63
M v[68:71],a[132:135],v[196:199]
s_add_u32 s73, s64, 5
buffer_load_dwordx4 v7, s[32:35], s62 offen offset:2048 lds
v_sub_u32 v48, v48, v49
M v[68:71],a[128:131],a[4:7]
v_mov_b32 v32, 0
v_mov_b32 v33, 0
M v[72:75],a[128:131],a[8:11]
T a[156:157],v27,40960
v_mov_b32 v36, 0
M v[72:75],a[132:135],v[200:203]
T a[158:159],v27,45056
v_mov_b32 v37, 0
M v[76:79],a[132:135],v[204:207]
buffer_load_dwordx4 v8, s[32:35], s62 offen offset:3072 lds
v_mov_b32 v49, 0x3f80
M v[76:79],a[128:131],a[12:15]
s_waitcnt lgkmcnt(8)
v_mov_b32 v50, 0x3f800000
v_cmp_eq_u32 vcc, 0, v48
M v[92:95],a[140:143],v[204:207]
s_add_u32 s62, s62, 262144
T a[128:129],v28,32768
v_cndmask_b32 v34, 0, v49, vcc
M v[92:95],a[136:139],a[12:15]
T a[130:131],v28,36864
v_cmp_eq_u32 vcc, 1, v48
M v[88:91],a[136:139],a[8:11]
buffer_load_dwordx4 a[160:163], v58, s[12:15], s63 offen offset:0 sc1
v_cndmask_b32 v34, v34, v50, vcc
M v[88:91],a[140:143],v[200:203]
v_cmp_eq_u32 vcc, 2, v48
v_mov_b32 v14, s70
M v[84:87],a[140:143],v[196:199]
T a[132:133],v28,40960
v_cndmask_b32 v35, 0, v49, vcc
M v[84:87],a[136:139],a[4:7]
T a[134:135],v28,45056
v_cmp_eq_u32 vcc, 3, v48
M v[80:83],a[136:139],a[0:3]
buffer_load_dwordx4 a[164:167], v58, s[12:15], s63 offen offset:1024 sc1
v_cndmask_b32 v35, v35, v50, vcc
M v[80:83],a[140:143],v[192:195]
v_and_b32 v15, 2048, v15
s_waitcnt lgkmcnt(8)
M v[96:99],a[144:147],a[0:3]
T a[136:137],v29,32768
M v[96:99],a[148:151],v[192:195]
T a[138:139],v29,36864
M v[100:103],a[148:151],v[196:199]
M v[100:103],a[144:147],a[4:7]
M v[104:107],a[144:147],a[8:11]
T a[140:141],v29,40960
M v[104:107],a[148:151],v[200:203]
T a[142:143],v29,45056
M v[108:111],a[148:151],v[204:207]
buffer_load_dwordx4 a[168:171], v59, s[12:15], s63 offen offset:0 sc1
M v[108:111],a[144:147],a[12:15]
s_waitcnt lgkmcnt(8)
M v[124:127],a[156:159],v[204:207]
T a[144:145],v30,32768
M v[124:127],a[152:155],a[12:15]
T a[146:147],v30,36864
M v[120:123],a[152:155],a[8:11]
buffer_load_dwordx4 a[172:175], v59, s[12:15], s63 offen offset:1024 sc1
s_add_u32 s63, s63, 4096
M v[120:123],a[156:159],v[200:203]
M v[116:119],a[156:159],v[196:199]
T a[148:149],v30,40960
M v[116:119],a[152:155],a[4:7]
T a[150:151],v30,45056
M v[112:115],a[152:155],a[0:3]
buffer_load_dwordx4 a[176:179], v58, s[12:15], s63 offen offset:0 sc1
M v[112:115],a[156:159],v[192:195]
s_waitcnt lgkmcnt(8)
M v[128:131],a[128:131],a[0:3]
T a[152:153],v31,32768
M v[128:131],a[132:135],v[192:195]
T a[154:155],v31,36864
M v[132:135],a[132:135],v[196:199]
buffer_load_dwordx4 a[180:183], v58, s[12:15], s63 offen offset:1024 sc1
M v[132:135],a[128:131],a[4:7]
M v[136:139],a[128:131],a[8:11]
T a[156:157],v31,40960
M v[136:139],a[132:135],v[200:203]
T a[158:159],v31,45056
M v[140:143],a[132:135],v[204:207]
buffer_load_dwordx4 a[184:187], v59, s[12:15], s63 offen offset:0 sc1
M v[140:143],a[128:131],a[12:15]
s_waitcnt lgkmcnt(8)
M v[156:159],a[140:143],v[204:207]
T a[128:129],v24,49152
M v[156:159],a[136:139],a[12:15]
T a[130:131],v24,53248
M v[152:155],a[136:139],a[8:11]
buffer_load_dwordx4 a[188:191], v59, s[12:15], s63 offen offset:1024 sc1
s_add_u32 s63, s63, 4096
M v[152:155],a[140:143],v[200:203]
M v[148:151],a[140:143],v[196:199]
T a[132:133],v24,57344
M v[148:151],a[136:139],a[4:7]
T a[134:135],v24,61440
M v[144:147],a[136:139],a[0:3]
M v[144:147],a[140:143],v[192:195]
s_waitcnt lgkmcnt(8)
M v[160:163],a[144:147],a[0:3]
T a[136:137],v25,49152
M v[160:163],a[148:151],v[192:195]
T a[138:139],v25,53248
M v[164:167],a[148:151],v[196:199]
buffer_load_dwordx4 a[112:115], v58, s[12:15], s63 offen offset:0 sc1
M v[164:167],a[144:147],a[4:7]
M v[168:171],a[144:147],a[8:11]
T a[140:141],v25,57344
M v[168:171],a[148:151],v[200:203]
T a[142:143],v25,61440
M v[172:175],a[148:151],v[204:207]
buffer_load_dwordx4 a[116:119], v58, s[12:15], s63 offen offset:1024 sc1
M v[172:175],a[144:147],a[12:15]
s_waitcnt lgkmcnt(8)
M v[188:191],a[156:159],v[204:207]
T a[144:145],v26,49152
M v[188:191],a[152:155],a[12:15]
T a[146:147],v26,53248
M v[184:187],a[152:155],a[8:11]
buffer_load_dwordx4 a[120:123], v59, s[12:15], s63 offen offset:0 sc1
M v[184:187],a[156:159],v[200:203]
M v[180:183],a[156:159],v[196:199]
T a[148:149],v26,57344
M v[180:183],a[152:155],a[4:7]
T a[150:151],v26,61440
M v[176:179],a[152:155],a[0:3]
buffer_load_dwordx4 a[124:127], v59, s[12:15], s63 offen offset:1024 sc1
s_add_u32 s63, s63, 4096
M v[176:179],a[156:159],v[192:195]
s_waitcnt vmcnt(30)
s_waitcnt lgkmcnt(8)
M v[64:67],a[128:131],a[16:19]
T a[152:153],v27,49152
M v[64:67],a[132:135],a[32:35]
s_lshl_b32 s72, s56, 7
s_sub_u32 s72, s7, s72
s_add_u32 s72, s72, 1920
s_add_u32 s75, s64, 3
T a[154:155],v27,53248
M v[68:71],a[132:135],a[36:39]
buffer_load_dword v62, v15, s[12:15], s72 offen sc1
M v[68:71],a[128:131],a[20:23]
M v[72:75],a[128:131],a[24:27]
T a[156:157],v27,57344
M v[72:75],a[132:135],a[40:43]
T a[158:159],v27,61440
M v[76:79],a[132:135],a[44:47]
buffer_load_dwordx4 a[64:67], v58, s[12:15], s63 offen offset:0 sc1
M v[76:79],a[128:131],a[28:31]
s_waitcnt lgkmcnt(8)
M v[92:95],a[140:143],a[44:47]
T a[128:129],v28,49152
M v[92:95],a[136:139],a[28:31]
T a[130:131],v28,53248
M v[88:91],a[136:139],a[24:27]
M v[88:91],a[140:143],a[40:43]
M v[84:87],a[140:143],a[36:39]
T a[132:133],v28,57344
M v[84:87],a[136:139],a[20:23]
T a[134:135],v28,61440
M v[80:83],a[136:139],a[16:19]
buffer_load_dwordx4 a[68:71], v58, s[12:15], s63 offen offset:1024 sc1
M v[80:83],a[140:143],a[32:35]
s_waitcnt lgkmcnt(8)
M v[96:99],a[144:147],a[16:19]
T a[136:137],v29,49152
M v[96:99],a[148:151],a[32:35]
T a[138:139],v29,53248
M v[100:103],a[148:151],a[36:39]
buffer_load_dwordx4 a[72:75], v59, s[12:15], s63 offen offset:0 sc1
M v[100:103],a[144:147],a[20:23]
M v[104:107],a[144:147],a[24:27]
T a[140:141],v29,57344
M v[104:107],a[148:151],a[40:43]
T a[142:143],v29,61440
M v[108:111],a[148:151],a[44:47]
buffer_load_dwordx4 a[76:79], v59, s[12:15], s63 offen offset:1024 sc1
s_add_u32 s63, s63, 4096
M v[108:111],a[144:147],a[28:31]
L_pad12:
s_cbranch_execz L_pb2A
s_waitcnt lgkmcnt(8)
M v[124:127],a[156:159],a[44:47]
T a[144:145],v30,49152
M v[124:127],a[152:155],a[28:31]
s_add_u32 m0, s60, 65536
T a[146:147],v30,53248
M v[120:123],a[152:155],a[24:27]
buffer_load_dwordx4 v1, s[32:35], s62 offen offset:0 lds
M v[120:123],a[156:159],a[40:43]
M v[116:119],a[156:159],a[36:39]
T a[148:149],v30,57344
M v[116:119],a[152:155],a[20:23]
T a[150:151],v30,61440
M v[112:115],a[152:155],a[16:19]
buffer_load_dwordx4 v2, s[32:35], s62 offen offset:1024 lds
M v[112:115],a[156:159],a[32:35]
s_waitcnt lgkmcnt(8)
M v[128:131],a[128:131],a[16:19]
T a[152:153],v31,49152
M v[128:131],a[132:135],a[32:35]
T a[154:155],v31,53248
M v[132:135],a[132:135],a[36:39]
buffer_load_dwordx4 v3, s[32:35], s62 offen offset:2048 lds
M v[132:135],a[128:131],a[20:23]
M v[136:139],a[128:131],a[24:27]
T a[156:157],v31,57344
M v[136:139],a[132:135],a[40:43]
T a[158:159],v31,61440
M v[140:143],a[132:135],a[44:47]
M v[140:143],a[128:131],a[28:31]
s_waitcnt vmcnt(46)
s_barrier
s_waitcnt lgkmcnt(8)
M v[156:159],a[140:143],a[44:47]
T a[128:129],v16,0
M v[156:159],a[136:139],a[28:31]
T a[130:131],v16,4096
M v[152:155],a[136:139],a[24:27]
buffer_load_dwordx4 v4, s[32:35], s62 offen offset:3072 lds
M v[152:155],a[140:143],a[40:43]
M v[148:151],a[140:143],a[36:39]
T a[132:133],v16,8192
M v[148:151],a[136:139],a[20:23]
s_add_u32 m0, s60, 69632
T a[134:135],v16,12288
M v[144:147],a[136:139],a[16:19]
buffer_load_dwordx4 v5, s[32:35], s62 offen offset:0 lds
M v[144:147],a[140:143],a[32:35]
s_waitcnt lgkmcnt(8)
M v[160:163],a[144:147],a[16:19]
T a[136:137],v17,0
M v[160:163],a[148:151],a[32:35]
T a[138:139],v17,4096
M v[164:167],a[148:151],a[36:39]
buffer_load_dwordx4 v6, s[32:35], s62 offen offset:1024 lds
M v[164:167],a[144:147],a[20:23]
M v[168:171],a[144:147],a[24:27]
T a[140:141],v17,8192
M v[168:171],a[148:151],a[40:43]
T a[142:143],v17,12288
M v[172:175],a[148:151],a[44:47]
buffer_load_dwordx4 v7, s[32:35], s62 offen offset:2048 lds
M v[172:175],a[144:147],a[28:31]
s_waitcnt lgkmcnt(8)
M v[188:191],a[156:159],a[44:47]
T a[144:145],v18,0
M v[188:191],a[152:155],a[28:31]
T a[146:147],v18,4096
M v[184:187],a[152:155],a[24:27]
buffer_load_dwordx4 v8, s[32:35], s62 offen offset:3072 lds
s_add_u32 s62, s62, 262144
M v[184:187],a[156:159],a[40:43]
M v[180:183],a[156:159],a[36:39]
T a[148:149],v18,8192
M v[180:183],a[152:155],a[20:23]
T a[150:151],v18,12288
M v[176:179],a[152:155],a[16:19]
buffer_load_dwordx4 a[80:83], v58, s[12:15], s63 offen offset:0 sc1
M v[176:179],a[156:159],a[32:35]
s_barrier
s_waitcnt vmcnt(34)
s_waitcnt lgkmcnt(8)
M v[64:67],a[128:131],v[208:211]
s_waitcnt vmcnt(13)
T a[152:153],v19,0
v_subrev_u32 v62, s75, v62
M v[64:67],a[132:135],a[48:51]
T a[154:155],v19,4096
v_cmp_le_u32 vcc, 13, v62
M v[68:71],a[132:135],a[52:55]
s_cbranch_vccnz SPIN_xA
BACK_xA:
M v[68:71],a[128:131],v[212:215]
M v[72:75],a[128:131],v[216:219]
T a[156:157],v19,8192
M v[72:75],a[132:135],a[56:59]
T a[158:159],v19,12288
M v[76:79],a[132:135],a[60:63]
buffer_load_dwordx4 a[84:87], v58, s[12:15], s63 offen offset:1024 sc1
M v[76:79],a[128:131],v[220:223]
s_waitcnt lgkmcnt(8)
M v[92:95],a[140:143],a[60:63]
T a[128:129],v20,0
M v[92:95],a[136:139],v[220:223]
T a[130:131],v20,4096
M v[88:91],a[136:139],v[216:219]
buffer_load_dwordx4 a[88:91], v59, s[12:15], s63 offen offset:0 sc1
M v[88:91],a[140:143],a[56:59]
M v[84:87],a[140:143],a[52:55]
T a[132:133],v20,8192
M v[84:87],a[136:139],v[212:215]
T a[134:135],v20,12288
M v[80:83],a[136:139],v[208:211]
buffer_load_dwordx4 a[92:95], v59, s[12:15], s63 offen offset:1024 sc1
s_add_u32 s63, s63, 4096
M v[80:83],a[140:143],a[48:51]
s_waitcnt lgkmcnt(8)
M v[96:99],a[144:147],v[208:211]
T a[136:137],v21,0
M v[96:99],a[148:151],a[48:51]
T a[138:139],v21,4096
M v[100:103],a[148:151],a[52:55]
buffer_load_dwordx4 a[192:195], v58, s[12:15], s63 offen offset:0 sc1
M v[100:103],a[144:147],v[212:215]
M v[104:107],a[144:147],v[216:219]
T a[140:141],v21,8192
M v[104:107],a[148:151],a[56:59]
T a[142:143],v21,12288
M v[108:111],a[148:151],a[60:63]
buffer_load_dwordx4 a[196:199], v58, s[12:15], s63 offen offset:1024 sc1
M v[108:111],a[144:147],v[220:223]
s_waitcnt lgkmcnt(8)
M v[124:127],a[156:159],a[60:63]
T a[144:145],v16,16384
M v[124:127],a[152:155],v[220:223]
T a[146:147],v16,20480
M v[120:123],a[152:155],v[216:219]
buffer_load_dwordx4 a[200:203], v59, s[12:15], s63 offen offset:0 sc1
M v[120:123],a[156:159],a[56:59]
M v[116:119],a[156:159],a[52:55]
T a[148:149],v16,24576
M v[116:119],a[152:155],v[212:215]
T a[150:151],v16,28672
M v[112:115],a[152:155],v[208:211]
M v[112:115],a[156:159],a[48:51]
s_waitcnt lgkmcnt(8)
M v[128:131],a[128:131],v[208:211]
T a[152:153],v17,16384
M v[128:131],a[132:135],a[48:51]
T a[154:155],v17,20480
M v[132:135],a[132:135],a[52:55]
buffer_load_dwordx4 a[204:207], v59, s[12:15], s63 offen offset:1024 sc1
s_add_u32 s63, s63, 4096
M v[132:135],a[128:131],v[212:215]
M v[136:139],a[128:131],v[216:219]
T a[156:157],v17,24576
M v[136:139],a[132:135],a[56:59]
T a[158:159],v17,28672
M v[140:143],a[132:135],a[60:63]
buffer_load_dwordx4 a[208:211], v58, s[12:15], s63 offen offset:0 sc1
M v[140:143],a[128:131],v[220:223]
s_waitcnt lgkmcnt(8)
M v[156:159],a[140:143],a[60:63]
T a[128:129],v18,16384
M v[156:159],a[136:139],v[220:223]
T a[130:131],v18,20480
M v[152:155],a[136:139],v[216:219]
buffer_load_dwordx4 a[212:215], v58, s[12:15], s63 offen offset:1024 sc1
M v[152:155],a[140:143],a[56:59]
M v[148:151],a[140:143],a[52:55]
T a[132:133],v18,24576
M v[148:151],a[136:139],v[212:215]
T a[134:135],v18,28672
M v[144:147],a[136:139],v[208:211]
buffer_load_dwordx4 a[216:219], v59, s[12:15], s63 offen offset:0 sc1
M v[144:147],a[140:143],a[48:51]
s_waitcnt vmcnt(28)
s_waitcnt lgkmcnt(8)
M v[64:67],a[144:147],a[160:163]
T a[136:137],v19,16384
M v[64:67],a[148:151],a[176:179]
T a[138:139],v19,20480
M v[68:71],a[148:151],a[180:183]
buffer_load_dwordx4 a[220:223], v59, s[12:15], s63 offen offset:1024 sc1
s_add_u32 s63, s63, 4096
M v[68:71],a[144:147],a[164:167]
M v[72:75],a[144:147],a[168:171]
T a[140:141],v19,24576
M v[72:75],a[148:151],a[184:187]
T a[142:143],v19,28672
M v[76:79],a[148:151],a[188:191]
buffer_load_dwordx4 a[224:227], v58, s[12:15], s63 offen offset:0 sc1
M v[76:79],a[144:147],a[172:175]
s_waitcnt lgkmcnt(8)
M v[92:95],a[156:159],a[188:191]
T a[144:145],v20,16384
M v[92:95],a[152:155],a[172:175]
T a[146:147],v20,20480
M v[88:91],a[152:155],a[168:171]
M v[88:91],a[156:159],a[184:187]
M v[84:87],a[156:159],a[180:183]
T a[148:149],v20,24576
M v[84:87],a[152:155],a[164:167]
T a[150:151],v20,28672
M v[80:83],a[152:155],a[160:163]
buffer_load_dwordx4 a[228:231], v58, s[12:15], s63 offen offset:1024 sc1
M v[80:83],a[156:159],a[176:179]
s_waitcnt lgkmcnt(8)
M v[96:99],a[128:131],a[160:163]
T a[152:153],v21,16384
M v[96:99],a[132:135],a[176:179]
T a[154:155],v21,20480
M v[100:103],a[132:135],a[180:183]
buffer_load_dwordx4 a[232:235], v59, s[12:15], s63 offen offset:0 sc1
M v[100:103],a[128:131],a[164:167]
M v[104:107],a[128:131],a[168:171]
T a[156:157],v21,24576
M v[104:107],a[132:135],a[184:187]
T a[158:159],v21,28672
M v[108:111],a[132:135],a[188:191]
buffer_load_dwordx4 a[236:239], v59, s[12:15], s63 offen offset:1024 sc1
s_add_u32 s63, s63, 4096
M v[108:111],a[128:131],a[172:175]
s_waitcnt vmcnt(41)
s_barrier
s_waitcnt lgkmcnt(8)
M v[124:127],a[140:143],a[188:191]
T a[128:129],v16,32768
M v[124:127],a[136:139],a[172:175]
s_add_u32 m0, s60, 98304
T a[130:131],v16,36864
M v[120:123],a[136:139],a[168:171]
buffer_load_dwordx4 v1, s[32:35], s62 offen offset:0 lds
M v[120:123],a[140:143],a[184:187]
M v[116:119],a[140:143],a[180:183]
T a[132:133],v16,40960
M v[116:119],a[136:139],a[164:167]
T a[134:135],v16,45056
M v[112:115],a[136:139],a[160:163]
buffer_load_dwordx4 v2, s[32:35], s62 offen offset:1024 lds
M v[112:115],a[140:143],a[176:179]
s_waitcnt lgkmcnt(8)
M v[128:131],a[144:147],a[160:163]
T a[136:137],v17,32768
M v[128:131],a[148:151],a[176:179]
T a[138:139],v17,36864
M v[132:135],a[148:151],a[180:183]
buffer_load_dwordx4 v3, s[32:35], s62 offen offset:2048 lds
M v[132:135],a[144:147],a[164:167]
M v[136:139],a[144:147],a[168:171]
T a[140:141],v17,40960
M v[136:139],a[148:151],a[184:187]
T a[142:143],v17,45056
M v[140:143],a[148:151],a[188:191]
M v[140:143],a[144:147],a[172:175]
s_waitcnt lgkmcnt(8)
M v[156:159],a[156:159],a[188:191]
T a[144:145],v18,32768
M v[156:159],a[152:155],a[172:175]
T a[146:147],v18,36864
M v[152:155],a[152:155],a[168:171]
buffer_load_dwordx4 v4, s[32:35], s62 offen offset:3072 lds
M v[152:155],a[156:159],a[184:187]
M v[148:151],a[156:159],a[180:183]
T a[148:149],v18,40960
M v[148:151],a[152:155],a[164:167]
s_add_u32 m0, s60, 102400
T a[150:151],v18,45056
M v[144:147],a[152:155],a[160:163]
buffer_load_dwordx4 v5, s[32:35], s62 offen offset:0 lds
M v[144:147],a[156:159],a[176:179]
s_waitcnt vmcnt(29)
s_waitcnt lgkmcnt(8)
M v[64:67],a[128:131],a[112:115]
T a[152:153],v19,32768
M v[64:67],a[132:135],a[64:67]
T a[154:155],v19,36864
M v[68:71],a[132:135],a[68:71]
buffer_load_dwordx4 v6, s[32:35], s62 offen offset:1024 lds
M v[68:71],a[128:131],a[116:119]
M v[72:75],a[128:131],a[120:123]
T a[156:157],v19,40960
M v[72:75],a[132:135],a[72:75]
T a[158:159],v19,45056
M v[76:79],a[132:135],a[76:79]
buffer_load_dwordx4 v7, s[32:35], s62 offen offset:2048 lds
M v[76:79],a[128:131],a[124:127]
s_waitcnt lgkmcnt(8)
M v[92:95],a[140:143],a[76:79]
T a[128:129],v20,32768
M v[92:95],a[136:139],a[124:127]
T a[130:131],v20,36864
M v[88:91],a[136:139],a[120:123]
buffer_load_dwordx4 v8, s[32:35], s62 offen offset:3072 lds
M v[88:91],a[140:143],a[72:75]
M v[84:87],a[140:143],a[68:71]
T a[132:133],v20,40960
M v[84:87],a[136:139],a[116:119]
T a[134:135],v20,45056
M v[80:83],a[136:139],a[112:115]
buffer_load_dwordx4 a[240:243], v58, s[12:15], s63 offen offset:0 sc1
M v[80:83],a[140:143],a[64:67]
s_waitcnt lgkmcnt(8)
M v[96:99],a[144:147],a[112:115]
T a[136:137],v21,32768
M v[96:99],a[148:151],a[64:67]
T a[138:139],v21,36864
M v[100:103],a[148:151],a[68:71]
M v[100:103],a[144:147],a[116:119]
M v[104:107],a[144:147],a[120:123]
T a[140:141],v21,40960
M v[104:107],a[148:151],a[72:75]
T a[142:143],v21,45056
M v[108:111],a[148:151],a[76:79]
buffer_load_dwordx4 a[244:247], v58, s[12:15], s63 offen offset:1024 sc1
M v[108:111],a[144:147],a[124:127]
s_waitcnt lgkmcnt(8)
M v[124:127],a[156:159],a[76:79]
T a[144:145],v16,49152
M v[124:127],a[152:155],a[124:127]
T a[146:147],v16,53248
M v[120:123],a[152:155],a[120:123]
buffer_load_dwordx4 a[248:251], v59, s[12:15], s63 offen offset:0 sc1
M v[120:123],a[156:159],a[72:75]
M v[116:119],a[156:159],a[68:71]
T a[148:149],v16,57344
M v[116:119],a[152:155],a[116:119]
T a[150:151],v16,61440
M v[112:115],a[152:155],a[112:115]
buffer_load_dwordx4 a[252:255], v59, s[12:15], s63 offen offset:1024 sc1
s_add_u32 s63, s63, 4096
M v[112:115],a[156:159],a[64:67]
s_waitcnt lgkmcnt(8)
M v[128:131],a[128:131],a[112:115]
T a[152:153],v17,49152
M v[128:131],a[132:135],a[64:67]
T a[154:155],v17,53248
M v[132:135],a[132:135],a[68:71]
buffer_load_dwordx4 a[96:99], v58, s[12:15], s63 offen offset:0 sc1
M v[132:135],a[128:131],a[116:119]
M v[136:139],a[128:131],a[120:123]
T a[156:157],v17,57344
M v[136:139],a[132:135],a[72:75]
T a[158:159],v17,61440
M v[140:143],a[132:135],a[76:79]
buffer_load_dwordx4 a[100:103], v58, s[12:15], s63 offen offset:1024 sc1
M v[140:143],a[128:131],a[124:127]
s_waitcnt lgkmcnt(8)
M v[156:159],a[140:143],a[76:79]
T a[128:129],v18,49152
M v[156:159],a[136:139],a[124:127]
T a[130:131],v18,53248
M v[152:155],a[136:139],a[120:123]
buffer_load_dwordx4 a[104:107], v59, s[12:15], s63 offen offset:0 sc1
M v[152:155],a[140:143],a[72:75]
M v[148:151],a[140:143],a[68:71]
T a[132:133],v18,57344
M v[148:151],a[136:139],a[116:119]
T a[134:135],v18,61440
M v[144:147],a[136:139],a[112:115]
M v[144:147],a[140:143],a[64:67]
s_waitcnt vmcnt(23)
s_waitcnt lgkmcnt(8)
M v[64:67],a[144:147],a[80:83]
T a[136:137],v19,49152
M v[64:67],a[148:151],a[192:195]
T a[138:139],v19,53248
M v[68:71],a[148:151],a[196:199]
buffer_load_dwordx4 a[108:111], v59, s[12:15], s63 offen offset:1024 sc1
s_add_u32 s63, s63, 4096
M v[68:71],a[144:147],a[84:87]
M v[72:75],a[144:147],a[88:91]
T a[140:141],v19,57344
M v[72:75],a[148:151],a[200:203]
T a[142:143],v19,61440
M v[76:79],a[148:151],a[204:207]
buffer_load_dwordx4 a[0:3], v58, s[12:15], s63 offen offset:0 sc1
M v[76:79],a[144:147],a[92:95]
s_waitcnt lgkmcnt(8)
M v[92:95],a[156:159],a[204:207]
T a[144:145],v20,49152
M v[92:95],a[152:155],a[92:95]
T a[146:147],v20,53248
M v[88:91],a[152:155],a[88:91]
buffer_load_dwordx4 a[4:7], v58, s[12:15], s63 offen offset:1024 sc1
M v[88:91],a[156:159],a[200:203]
M v[84:87],a[156:159],a[196:199]
T a[148:149],v20,57344
M v[84:87],a[152:155],a[84:87]
T a[150:151],v20,61440
M v[80:83],a[152:155],a[80:83]
buffer_load_dwordx4 a[8:11], v59, s[12:15], s63 offen offset:0 sc1
M v[80:83],a[156:159],a[192:195]
s_waitcnt lgkmcnt(8)
M v[96:99],a[128:131],a[80:83]
T a[152:153],v21,49152
M v[96:99],a[132:135],a[192:195]
T a[154:155],v21,53248
M v[100:103],a[132:135],a[196:199]
buffer_load_dwordx4 a[12:15], v59, s[12:15], s63 offen offset:1024 sc1
s_add_u32 s63, s63, 4096
M v[100:103],a[128:131],a[84:87]
M v[104:107],a[128:131],a[88:91]
T a[156:157],v21,57344
M v[104:107],a[132:135],a[200:203]
T a[158:159],v21,61440
M v[108:111],a[132:135],a[204:207]
buffer_load_dwordx4 v[192:195], v58, s[12:15], s63 offen offset:0 sc1
M v[108:111],a[128:131],a[92:95]
s_waitcnt vmcnt(37)
s_barrier
s_waitcnt lgkmcnt(8)
M v[124:127],a[140:143],a[204:207]
T a[128:129],v24,0
M v[124:127],a[136:139],a[92:95]
T a[130:131],v24,4096
M v[120:123],a[136:139],a[88:91]
M v[120:123],a[140:143],a[200:203]
M v[116:119],a[140:143],a[196:199]
T a[132:133],v24,8192
M v[116:119],a[136:139],a[84:87]
T a[134:135],v24,12288
M v[112:115],a[136:139],a[80:83]
buffer_load_dwordx4 v[196:199], v58, s[12:15], s63 offen offset:1024 sc1
M v[112:115],a[140:143],a[192:195]
s_waitcnt lgkmcnt(8)
M v[128:131],a[144:147],a[80:83]
T a[136:137],v25,0
M v[128:131],a[148:151],a[192:195]
T a[138:139],v25,4096
M v[132:135],a[148:151],a[196:199]
buffer_load_dwordx4 v[200:203], v59, s[12:15], s63 offen offset:0 sc1
M v[132:135],a[144:147],a[84:87]
M v[136:139],a[144:147],a[88:91]
T a[140:141],v25,8192
M v[136:139],a[148:151],a[200:203]
T a[142:143],v25,12288
M v[140:143],a[148:151],a[204:207]
buffer_load_dwordx4 v[204:207], v59, s[12:15], s63 offen offset:1024 sc1
s_add_u32 s63, s63, 4096
M v[140:143],a[144:147],a[92:95]
s_waitcnt lgkmcnt(8)
M v[156:159],a[156:159],a[204:207]
T a[144:145],v24,16384
M v[156:159],a[152:155],a[92:95]
T a[146:147],v24,20480
M v[152:155],a[152:155],a[88:91]
buffer_load_dwordx4 a[16:19], v58, s[12:15], s63 offen offset:0 sc1
M v[152:155],a[156:159],a[200:203]
M v[148:151],a[156:159],a[196:199]
T a[148:149],v24,24576
M v[148:151],a[152:155],a[84:87]
T a[150:151],v24,28672
M v[144:147],a[152:155],a[80:83]
buffer_load_dwordx4 a[20:23], v58, s[12:15], s63 offen offset:1024 sc1
M v[144:147],a[156:159],a[192:195]
s_waitcnt vmcnt(26)
s_waitcnt lgkmcnt(8)
M v[64:67],a[128:131],a[208:211]
T a[152:153],v25,16384
M v[64:67],a[132:135],a[224:227]
T a[154:155],v25,20480
M v[68:71],a[132:135],a[228:231]
buffer_load_dwordx4 a[24:27], v59, s[12:15], s63 offen offset:0 sc1
M v[68:71],a[128:131],a[212:215]
M v[72:75],a[128:131],a[216:219]
T a[156:157],v25,24576
M v[72:75],a[132:135],a[232:235]
T a[158:159],v25,28672
M v[76:79],a[132:135],a[236:239]
M v[76:79],a[128:131],a[220:223]
s_waitcnt vmcnt(19)
s_barrier
s_waitcnt lgkmcnt(8)
M v[92:95],a[140:143],a[236:239]
T a[128:129],v24,32768
M v[92:95],a[136:139],a[220:223]
T a[130:131],v24,36864
M v[88:91],a[136:139],a[216:219]
buffer_load_dwordx4 a[28:31], v59, s[12:15], s63 offen offset:1024 sc1
s_add_u32 s63, s63, 4096
M v[88:91],a[140:143],a[232:235]
M v[84:87],a[140:143],a[228:231]
T a[132:133],v24,40960
M v[84:87],a[136:139],a[212:215]
T a[134:135],v24,45056
M v[80:83],a[136:139],a[208:211]
buffer_load_dwordx4 a[32:35], v58, s[12:15], s63 offen offset:0 sc1
M v[80:83],a[140:143],a[224:227]
s_waitcnt vmcnt(13)
s_waitcnt lgkmcnt(8)
M v[64:67],a[144:147],a[240:243]
T a[136:137],v25,32768
M v[64:67],a[148:151],a[96:99]
T a[138:139],v25,36864
M v[68:71],a[148:151],a[100:103]
buffer_load_dwordx4 a[36:39], v58, s[12:15], s63 offen offset:1024 sc1
M v[68:71],a[144:147],a[244:247]
M v[72:75],a[144:147],a[248:251]
T a[140:141],v25,40960
M v[72:75],a[148:151],a[104:107]
T a[142:143],v25,45056
M v[76:79],a[148:151],a[108:111]
buffer_load_dwordx4 a[40:43], v59, s[12:15], s63 offen offset:0 sc1
M v[76:79],a[144:147],a[252:255]
s_waitcnt lgkmcnt(8)
M v[92:95],a[156:159],a[108:111]
T a[144:145],v24,49152
M v[92:95],a[152:155],a[252:255]
T a[146:147],v24,53248
M v[88:91],a[152:155],a[248:251]
buffer_load_dwordx4 a[44:47], v59, s[12:15], s63 offen offset:1024 sc1
s_add_u32 s63, s63, 4096
M v[88:91],a[156:159],a[104:107]
M v[84:87],a[156:159],a[100:103]
T a[148:149],v24,57344
M v[84:87],a[152:155],a[244:247]
T a[150:151],v24,61440
M v[80:83],a[152:155],a[240:243]
M v[80:83],a[156:159],a[96:99]
s_waitcnt vmcnt(8)
s_waitcnt lgkmcnt(8)
M v[64:67],a[128:131],a[0:3]
T a[152:153],v25,49152
M v[64:67],a[132:135],v[192:195]
T a[154:155],v25,53248
M v[68:71],a[132:135],v[196:199]
M v[68:71],a[128:131],a[4:7]
M v[72:75],a[128:131],a[8:11]
T a[156:157],v25,57344
M v[72:75],a[132:135],v[200:203]
T a[158:159],v25,61440
M v[76:79],a[132:135],v[204:207]
M v[76:79],a[128:131],a[12:15]
s_waitcnt lgkmcnt(8)
M v[92:95],a[140:143],v[204:207]
T a[128:129],v26,0
M v[92:95],a[136:139],a[12:15]
T a[130:131],v26,4096
M v[88:91],a[136:139],a[8:11]
L_pad13:
s_cbranch_execz L_pb2A
M v[88:91],a[140:143],v[200:203]
M v[84:87],a[140:143],v[196:199]
T a[132:133],v26,8192
M v[84:87],a[136:139],a[4:7]
T a[134:135],v26,12288
M v[80:83],a[136:139],a[0:3]
M v[80:83],a[140:143],v[192:195]
s_waitcnt vmcnt(0)
s_waitcnt lgkmcnt(8)
M v[64:67],a[144:147],a[16:19]
T a[136:137],v27,0
M v[64:67],a[148:151],a[32:35]
T a[138:139],v27,4096
M v[68:71],a[148:151],a[36:39]
M v[68:71],a[144:147],a[20:23]
M v[72:75],a[144:147],a[24:27]
T a[140:141],v27,8192
M v[72:75],a[148:151],a[40:43]
T a[142:143],v27,12288
M v[76:79],a[148:151],a[44:47]
M v[76:79],a[144:147],a[28:31]
s_waitcnt lgkmcnt(8)
M v[92:95],a[156:159],a[44:47]
T a[144:145],v26,16384
M v[92:95],a[152:155],a[28:31]
T a[146:147],v26,20480
M v[88:91],a[152:155],a[24:27]
M v[88:91],a[156:159],a[40:43]
M v[84:87],a[156:159],a[36:39]
T a[148:149],v26,24576
M v[84:87],a[152:155],a[20:23]
T a[150:151],v26,28672
M v[80:83],a[152:155],a[16:19]
M v[80:83],a[156:159],a[32:35]
s_waitcnt lgkmcnt(8)
M v[96:99],a[128:131],a[208:211]
T a[152:153],v27,16384
v_cvt_pk_bf16_f32 v64, v64, v65
M v[96:99],a[132:135],a[224:227]
T a[154:155],v27,20480
v_cvt_pk_bf16_f32 v65, v66, v67
M v[100:103],a[132:135],a[228:231]
v_cvt_pk_bf16_f32 v66, v80, v81
v_cvt_pk_bf16_f32 v67, v82, v83
M v[100:103],a[128:131],a[212:215]
buffer_store_dwordx4 v[64:67], v13, s[12:15], s66 offen offset:0 sc1
v_cvt_pk_bf16_f32 v68, v68, v69
M v[104:107],a[128:131],a[216:219]
T a[156:157],v27,24576
v_cvt_pk_bf16_f32 v69, v70, v71
M v[104:107],a[132:135],a[232:235]
T a[158:159],v27,28672
v_cvt_pk_bf16_f32 v70, v84, v85
M v[108:111],a[132:135],a[236:239]
v_cvt_pk_bf16_f32 v71, v86, v87
buffer_store_dwordx4 v[68:71], v13, s[12:15], s66 offen offset:1024 sc1
M v[108:111],a[128:131],a[220:223]
s_waitcnt lgkmcnt(8)
v_cvt_pk_bf16_f32 v72, v72, v73
v_cvt_pk_bf16_f32 v73, v74, v75
M v[124:127],a[140:143],a[236:239]
T a[128:129],v26,32768
v_cvt_pk_bf16_f32 v74, v88, v89
M v[124:127],a[136:139],a[220:223]
T a[130:131],v26,36864
v_cvt_pk_bf16_f32 v75, v90, v91
M v[120:123],a[136:139],a[216:219]
buffer_store_dwordx4 v[72:75], v13, s[12:15], s66 offen offset:2048 sc1
v_cvt_pk_bf16_f32 v76, v76, v77
M v[120:123],a[140:143],a[232:235]
v_cvt_pk_bf16_f32 v77, v78, v79
v_cvt_pk_bf16_f32 v78, v92, v93
M v[116:119],a[140:143],a[228:231]
T a[132:133],v26,40960
v_cvt_pk_bf16_f32 v79, v94, v95
M v[116:119],a[136:139],a[212:215]
T a[134:135],v26,45056
buffer_store_dwordx4 v[76:79], v13, s[12:15], s66 offen offset:3072 sc1
M v[112:115],a[136:139],a[208:211]
M v[112:115],a[140:143],a[224:227]
s_waitcnt lgkmcnt(8)
M v[96:99],a[144:147],a[240:243]
T a[136:137],v27,32768
M v[96:99],a[148:151],a[96:99]
T a[138:139],v27,36864
M v[100:103],a[148:151],a[100:103]
M v[100:103],a[144:147],a[244:247]
M v[104:107],a[144:147],a[248:251]
T a[140:141],v27,40960
M v[104:107],a[148:151],a[104:107]
T a[142:143],v27,45056
M v[108:111],a[148:151],a[108:111]
M v[108:111],a[144:147],a[252:255]
s_waitcnt lgkmcnt(8)
M v[124:127],a[156:159],a[108:111]
T a[144:145],v26,49152
M v[124:127],a[152:155],a[252:255]
T a[146:147],v26,53248
M v[120:123],a[152:155],a[248:251]
M v[120:123],a[156:159],a[104:107]
M v[116:119],a[156:159],a[100:103]
T a[148:149],v26,57344
M v[116:119],a[152:155],a[244:247]
T a[150:151],v26,61440
M v[112:115],a[152:155],a[240:243]
M v[112:115],a[156:159],a[96:99]
s_waitcnt lgkmcnt(8)
M v[96:99],a[128:131],a[0:3]
T a[152:153],v27,49152
M v[96:99],a[132:135],v[192:195]
T a[154:155],v27,53248
M v[100:103],a[132:135],v[196:199]
M v[100:103],a[128:131],a[4:7]
M v[104:107],a[128:131],a[8:11]
T a[156:157],v27,57344
M v[104:107],a[132:135],v[200:203]
T a[158:159],v27,61440
M v[108:111],a[132:135],v[204:207]
M v[108:111],a[128:131],a[12:15]
s_waitcnt lgkmcnt(8)
M v[124:127],a[140:143],v[204:207]
T a[128:129],v28,0
M v[124:127],a[136:139],a[12:15]
T a[130:131],v28,4096
M v[120:123],a[136:139],a[8:11]
M v[120:123],a[140:143],v[200:203]
M v[116:119],a[140:143],v[196:199]
T a[132:133],v28,8192
M v[116:119],a[136:139],a[4:7]
T a[134:135],v28,12288
M v[112:115],a[136:139],a[0:3]
M v[112:115],a[140:143],v[192:195]
s_waitcnt lgkmcnt(8)
M v[96:99],a[144:147],a[16:19]
T a[136:137],v29,0
M v[96:99],a[148:151],a[32:35]
T a[138:139],v29,4096
M v[100:103],a[148:151],a[36:39]
M v[100:103],a[144:147],a[20:23]
M v[104:107],a[144:147],a[24:27]
T a[140:141],v29,8192
M v[104:107],a[148:151],a[40:43]
T a[142:143],v29,12288
M v[108:111],a[148:151],a[44:47]
M v[108:111],a[144:147],a[28:31]
s_waitcnt lgkmcnt(8)
M v[124:127],a[156:159],a[44:47]
T a[144:145],v28,16384
M v[124:127],a[152:155],a[28:31]
T a[146:147],v28,20480
M v[120:123],a[152:155],a[24:27]
M v[120:123],a[156:159],a[40:43]
M v[116:119],a[156:159],a[36:39]
T a[148:149],v28,24576
M v[116:119],a[152:155],a[20:23]
T a[150:151],v28,28672
M v[112:115],a[152:155],a[16:19]
M v[112:115],a[156:159],a[32:35]
s_waitcnt lgkmcnt(8)
M v[128:131],a[128:131],a[208:211]
T a[152:153],v29,16384
v_cvt_pk_bf16_f32 v96, v96, v97
M v[128:131],a[132:135],a[224:227]
T a[154:155],v29,20480
v_cvt_pk_bf16_f32 v97, v98, v99
M v[132:135],a[132:135],a[228:231]
v_cvt_pk_bf16_f32 v98, v112, v113
v_cvt_pk_bf16_f32 v99, v114, v115
M v[132:135],a[128:131],a[212:215]
buffer_store_dwordx4 v[96:99], v13, s[12:15], s67 offen offset:0 sc1
v_cvt_pk_bf16_f32 v100, v100, v101
M v[136:139],a[128:131],a[216:219]
T a[156:157],v29,24576
v_cvt_pk_bf16_f32 v101, v102, v103
M v[136:139],a[132:135],a[232:235]
T a[158:159],v29,28672
v_cvt_pk_bf16_f32 v102, v116, v117
M v[140:143],a[132:135],a[236:239]
v_cvt_pk_bf16_f32 v103, v118, v119
buffer_store_dwordx4 v[100:103], v13, s[12:15], s67 offen offset:1024 sc1
M v[140:143],a[128:131],a[220:223]
s_waitcnt lgkmcnt(8)
v_cvt_pk_bf16_f32 v104, v104, v105
v_cvt_pk_bf16_f32 v105, v106, v107
M v[156:159],a[140:143],a[236:239]
T a[128:129],v28,32768
v_cvt_pk_bf16_f32 v106, v120, v121
M v[156:159],a[136:139],a[220:223]
T a[130:131],v28,36864
v_cvt_pk_bf16_f32 v107, v122, v123
M v[152:155],a[136:139],a[216:219]
buffer_store_dwordx4 v[104:107], v13, s[12:15], s67 offen offset:2048 sc1
v_cvt_pk_bf16_f32 v108, v108, v109
M v[152:155],a[140:143],a[232:235]
v_cvt_pk_bf16_f32 v109, v110, v111
v_cvt_pk_bf16_f32 v110, v124, v125
M v[148:151],a[140:143],a[228:231]
T a[132:133],v28,40960
v_cvt_pk_bf16_f32 v111, v126, v127
M v[148:151],a[136:139],a[212:215]
T a[134:135],v28,45056
buffer_store_dwordx4 v[108:111], v13, s[12:15], s67 offen offset:3072 sc1
M v[144:147],a[136:139],a[208:211]
M v[144:147],a[140:143],a[224:227]
s_waitcnt lgkmcnt(8)
M v[128:131],a[144:147],a[240:243]
T a[136:137],v29,32768
M v[128:131],a[148:151],a[96:99]
T a[138:139],v29,36864
M v[132:135],a[148:151],a[100:103]
M v[132:135],a[144:147],a[244:247]
M v[136:139],a[144:147],a[248:251]
T a[140:141],v29,40960
M v[136:139],a[148:151],a[104:107]
T a[142:143],v29,45056
M v[140:143],a[148:151],a[108:111]
M v[140:143],a[144:147],a[252:255]
s_waitcnt lgkmcnt(8)
M v[156:159],a[156:159],a[108:111]
T a[144:145],v28,49152
M v[156:159],a[152:155],a[252:255]
T a[146:147],v28,53248
M v[152:155],a[152:155],a[248:251]
M v[152:155],a[156:159],a[104:107]
M v[148:151],a[156:159],a[100:103]
T a[148:149],v28,57344
M v[148:151],a[152:155],a[244:247]
T a[150:151],v28,61440
M v[144:147],a[152:155],a[240:243]
M v[144:147],a[156:159],a[96:99]
s_waitcnt lgkmcnt(8)
M v[128:131],a[128:131],a[0:3]
T a[152:153],v29,49152
M v[128:131],a[132:135],v[192:195]
T a[154:155],v29,53248
M v[132:135],a[132:135],v[196:199]
M v[132:135],a[128:131],a[4:7]
M v[136:139],a[128:131],a[8:11]
T a[156:157],v29,57344
M v[136:139],a[132:135],v[200:203]
T a[158:159],v29,61440
M v[140:143],a[132:135],v[204:207]
M v[140:143],a[128:131],a[12:15]
s_waitcnt lgkmcnt(8)
M v[156:159],a[140:143],v[204:207]
T a[128:129],v22,0
M v[156:159],a[136:139],a[12:15]
T a[130:131],v22,4096
M v[152:155],a[136:139],a[8:11]
M v[152:155],a[140:143],v[200:203]
M v[148:151],a[140:143],v[196:199]
T a[132:133],v22,8192
M v[148:151],a[136:139],a[4:7]
T a[134:135],v22,12288
M v[144:147],a[136:139],a[0:3]
M v[144:147],a[140:143],v[192:195]
s_waitcnt lgkmcnt(8)
M v[128:131],a[144:147],a[16:19]
T a[136:137],v23,0
M v[128:131],a[148:151],a[32:35]
T a[138:139],v23,4096
M v[132:135],a[148:151],a[36:39]
M v[132:135],a[144:147],a[20:23]
M v[136:139],a[144:147],a[24:27]
T a[140:141],v23,8192
M v[136:139],a[148:151],a[40:43]
T a[142:143],v23,12288
M v[140:143],a[148:151],a[44:47]
M v[140:143],a[144:147],a[28:31]
s_waitcnt lgkmcnt(8)
M v[156:159],a[156:159],a[44:47]
T a[144:145],v22,16384
M v[156:159],a[152:155],a[28:31]
T a[146:147],v22,20480
M v[152:155],a[152:155],a[24:27]
M v[152:155],a[156:159],a[40:43]
M v[148:151],a[156:159],a[36:39]
T a[148:149],v22,24576
M v[148:151],a[152:155],a[20:23]
T a[150:151],v22,28672
M v[144:147],a[152:155],a[16:19]
M v[144:147],a[156:159],a[32:35]
s_waitcnt lgkmcnt(8)
M v[160:163],a[128:131],v[208:211]
T a[152:153],v23,16384
v_cvt_pk_bf16_f32 v128, v128, v129
M v[160:163],a[132:135],a[48:51]
T a[154:155],v23,20480
v_cvt_pk_bf16_f32 v129, v130, v131
M v[164:167],a[132:135],a[52:55]
v_cvt_pk_bf16_f32 v130, v144, v145
v_cvt_pk_bf16_f32 v131, v146, v147
M v[164:167],a[128:131],v[212:215]
buffer_store_dwordx4 v[128:131], v13, s[12:15], s68 offen offset:0 sc1
v_cvt_pk_bf16_f32 v132, v132, v133
M v[168:171],a[128:131],v[216:219]
T a[156:157],v23,24576
v_cvt_pk_bf16_f32 v133, v134, v135
M v[168:171],a[132:135],a[56:59]
T a[158:159],v23,28672
v_cvt_pk_bf16_f32 v134, v148, v149
M v[172:175],a[132:135],a[60:63]
v_cvt_pk_bf16_f32 v135, v150, v151
buffer_store_dwordx4 v[132:135], v13, s[12:15], s68 offen offset:1024 sc1
M v[172:175],a[128:131],v[220:223]
s_waitcnt lgkmcnt(8)
v_cvt_pk_bf16_f32 v136, v136, v137
v_cvt_pk_bf16_f32 v137, v138, v139
M v[188:191],a[140:143],a[60:63]
T a[128:129],v22,32768
v_cvt_pk_bf16_f32 v138, v152, v153
M v[188:191],a[136:139],v[220:223]
T a[130:131],v22,36864
v_cvt_pk_bf16_f32 v139, v154, v155
M v[184:187],a[136:139],v[216:219]
buffer_store_dwordx4 v[136:139], v13, s[12:15], s68 offen offset:2048 sc1
v_cvt_pk_bf16_f32 v140, v140, v141
M v[184:187],a[140:143],a[56:59]
v_cvt_pk_bf16_f32 v141, v142, v143
v_cvt_pk_bf16_f32 v142, v156, v157
M v[180:183],a[140:143],a[52:55]
T a[132:133],v22,40960
v_cvt_pk_bf16_f32 v143, v158, v159
M v[180:183],a[136:139],v[212:215]
T a[134:135],v22,45056
buffer_store_dwordx4 v[140:143], v13, s[12:15], s68 offen offset:3072 sc1
M v[176:179],a[136:139],v[208:211]
M v[176:179],a[140:143],a[48:51]
s_waitcnt lgkmcnt(8)
M v[160:163],a[144:147],a[160:163]
T a[136:137],v23,32768
M v[160:163],a[148:151],a[176:179]
T a[138:139],v23,36864
M v[164:167],a[148:151],a[180:183]
M v[164:167],a[144:147],a[164:167]
M v[168:171],a[144:147],a[168:171]
T a[140:141],v23,40960
M v[168:171],a[148:151],a[184:187]
T a[142:143],v23,45056
M v[172:175],a[148:151],a[188:191]
M v[172:175],a[144:147],a[172:175]
s_waitcnt lgkmcnt(8)
M v[188:191],a[156:159],a[188:191]
T a[144:145],v22,49152
M v[188:191],a[152:155],a[172:175]
T a[146:147],v22,53248
M v[184:187],a[152:155],a[168:171]
M v[184:187],a[156:159],a[184:187]
M v[180:183],a[156:159],a[180:183]
T a[148:149],v22,57344
M v[180:183],a[152:155],a[164:167]
T a[150:151],v22,61440
M v[176:179],a[152:155],a[160:163]
M v[176:179],a[156:159],a[176:179]
s_waitcnt lgkmcnt(8)
M v[160:163],a[128:131],a[112:115]
T a[152:153],v23,49152
M v[160:163],a[132:135],a[64:67]
T a[154:155],v23,53248
M v[164:167],a[132:135],a[68:71]
M v[164:167],a[128:131],a[116:119]
M v[168:171],a[128:131],a[120:123]
T a[156:157],v23,57344
M v[168:171],a[132:135],a[72:75]
T a[158:159],v23,61440
M v[172:175],a[132:135],a[76:79]
M v[172:175],a[128:131],a[124:127]
s_waitcnt lgkmcnt(8)
M v[188:191],a[140:143],a[76:79]
T a[128:129],v30,0
M v[188:191],a[136:139],a[124:127]
T a[130:131],v30,4096
M v[184:187],a[136:139],a[120:123]
M v[184:187],a[140:143],a[72:75]
M v[180:183],a[140:143],a[68:71]
T a[132:133],v30,8192
M v[180:183],a[136:139],a[116:119]
T a[134:135],v30,12288
M v[176:179],a[136:139],a[112:115]
M v[176:179],a[140:143],a[64:67]
s_waitcnt lgkmcnt(8)
M v[160:163],a[144:147],a[80:83]
T a[136:137],v31,0
M v[160:163],a[148:151],a[192:195]
T a[138:139],v31,4096
M v[164:167],a[148:151],a[196:199]
buffer_load_dword v62, v14, s[12:15], s7 offen sc1
M v[164:167],a[144:147],a[84:87]
M v[168:171],a[144:147],a[88:91]
T a[140:141],v31,8192
M v[168:171],a[148:151],a[200:203]
T a[142:143],v31,12288
M v[172:175],a[148:151],a[204:207]
buffer_load_dword v56, v15, s[12:15], s7 offen sc1
M v[172:175],a[144:147],a[92:95]
s_waitcnt lgkmcnt(8)
M v[188:191],a[156:159],a[204:207]
T a[144:145],v30,16384
M v[188:191],a[152:155],a[92:95]
T a[146:147],v30,20480
M v[184:187],a[152:155],a[88:91]
M v[184:187],a[156:159],a[200:203]
M v[180:183],a[156:159],a[196:199]
T a[148:149],v30,24576
M v[180:183],a[152:155],a[84:87]
T a[150:151],v30,28672
M v[176:179],a[152:155],a[80:83]
M v[176:179],a[156:159],a[192:195]
s_waitcnt lgkmcnt(8)
M v[160:163],a[128:131],a[208:211]
T a[152:153],v31,16384
M v[160:163],a[132:135],a[224:227]
T a[154:155],v31,20480
M v[164:167],a[132:135],a[228:231]
M v[164:167],a[128:131],a[212:215]
M v[168:171],a[128:131],a[216:219]
T a[156:157],v31,24576
M v[168:171],a[132:135],a[232:235]
T a[158:159],v31,28672
M v[172:175],a[132:135],a[236:239]
M v[172:175],a[128:131],a[220:223]
s_waitcnt lgkmcnt(8)
M v[188:191],a[140:143],a[236:239]
T a[128:129],v30,32768
M v[188:191],a[136:139],a[220:223]
T a[130:131],v30,36864
M v[184:187],a[136:139],a[216:219]
M v[184:187],a[140:143],a[232:235]
M v[180:183],a[140:143],a[228:231]
s_waitcnt vmcnt(2)
T a[132:133],v30,40960
s_barrier
M v[180:183],a[136:139],a[212:215]
s_add_u32 s74, s64, 5
T a[134:135],v30,45056
v_mov_b32 v61, s74
M v[176:179],a[136:139],a[208:211]
buffer_store_dword v61, v60, s[12:15], s65 offen sc1
s_waitcnt vmcnt(1)
M v[176:179],a[140:143],a[224:227]
s_waitcnt lgkmcnt(8)
v_subrev_u32 v62, s73, v62
v_subrev_u32 v56, s73, v56
M v[160:163],a[144:147],a[240:243]
T a[136:137],v31,32768
v_cmp_le_u32 vcc, 11, v62
M v[160:163],a[148:151],a[96:99]
T a[138:139],v31,36864
v_max_u32 v56, v56, v62
M v[164:167],a[148:151],a[100:103]
v_cmp_le_u32 s[78:79], 11, v56
M v[164:167],a[144:147],a[244:247]
s_cbranch_vccnz L_g0A
buffer_load_dwordx4 v[208:211], v13, s[12:15], s17 offen offset:0 sc1
L_g0A:
M v[168:171],a[144:147],a[248:251]
T a[140:141],v31,40960
M v[168:171],a[148:151],a[104:107]
T a[142:143],v31,45056
M v[172:175],a[148:151],a[108:111]
s_cbranch_vccnz L_g1A
buffer_load_dwordx4 v[212:215], v13, s[12:15], s17 offen offset:1024 sc1
L_g1A:
M v[172:175],a[144:147],a[252:255]
s_cbranch_vccnz L_g2A
buffer_load_dwordx4 v[216:219], v13, s[12:15], s17 offen offset:2048 sc1
L_g2A:
s_waitcnt lgkmcnt(8)
M v[188:191],a[156:159],a[108:111]
T a[144:145],v30,49152
M v[188:191],a[152:155],a[252:255]
T a[146:147],v30,53248
M v[184:187],a[152:155],a[248:251]
s_cbranch_vccnz L_g3A
buffer_load_dwordx4 v[220:223], v13, s[12:15], s17 offen offset:3072 sc1
L_g3A:
M v[184:187],a[156:159],a[104:107]
s_add_u32 s63, s4, 114688
buffer_load_dwordx4 a[176:179], v58, s[12:15], s63 offen offset:0 sc1
M v[180:183],a[156:159],a[100:103]
T a[148:149],v30,57344
M v[180:183],a[152:155],a[244:247]
T a[150:151],v30,61440
M v[176:179],a[152:155],a[240:243]
buffer_load_dwordx4 a[180:183], v58, s[12:15], s63 offen offset:1024 sc1
M v[176:179],a[156:159],a[96:99]
buffer_load_dwordx4 a[184:187], v59, s[12:15], s63 offen offset:0 sc1
s_waitcnt lgkmcnt(8)
M v[160:163],a[128:131],a[0:3]
T a[152:153],v31,49152
M v[160:163],a[132:135],v[192:195]
T a[154:155],v31,53248
M v[164:167],a[132:135],v[196:199]
M v[164:167],a[128:131],a[4:7]
buffer_load_dwordx4 a[188:191], v59, s[12:15], s63 offen offset:1024 sc1
s_add_u32 s63, s63, 4096
M v[168:171],a[128:131],a[8:11]
T a[156:157],v31,57344
M v[168:171],a[132:135],v[200:203]
T a[158:159],v31,61440
M v[172:175],a[132:135],v[204:207]
M v[172:175],a[128:131],a[12:15]
buffer_load_dwordx4 a[112:115], v58, s[12:15], s63 offen offset:0 sc1
s_waitcnt lgkmcnt(8)
M v[188:191],a[140:143],v[204:207]
M v[188:191],a[136:139],a[12:15]
M v[184:187],a[136:139],a[8:11]
M v[184:187],a[140:143],v[200:203]
buffer_load_dwordx4 a[116:119], v58, s[12:15], s63 offen offset:1024 sc1
M v[180:183],a[140:143],v[196:199]
M v[180:183],a[136:139],a[4:7]
M v[176:179],a[136:139],a[0:3]
M v[176:179],a[140:143],v[192:195]
buffer_load_dwordx4 a[120:123], v59, s[12:15], s63 offen offset:0 sc1
s_waitcnt lgkmcnt(4)
M v[160:163],a[144:147],a[16:19]
M v[160:163],a[148:151],a[32:35]
M v[164:167],a[148:151],a[36:39]
M v[164:167],a[144:147],a[20:23]
buffer_load_dwordx4 a[124:127], v59, s[12:15], s63 offen offset:1024 sc1
s_add_u32 s63, s63, 4096
M v[168:171],a[144:147],a[24:27]
M v[168:171],a[148:151],a[40:43]
M v[172:175],a[148:151],a[44:47]
M v[172:175],a[144:147],a[28:31]
buffer_load_dwordx4 a[64:67], v58, s[12:15], s63 offen offset:0 sc1
s_waitcnt lgkmcnt(0)
M v[188:191],a[156:159],a[44:47]
M v[188:191],a[152:155],a[28:31]
M v[184:187],a[152:155],a[24:27]
M v[184:187],a[156:159],a[40:43]
M v[180:183],a[156:159],a[36:39]
M v[180:183],a[152:155],a[20:23]
M v[176:179],a[152:155],a[16:19]
M v[176:179],a[156:159],a[32:35]
s_mov_b32 s70, 0xbfb8aa3b
L_pad14:
s_cbranch_execz L_pb2A
s_mov_b32 s71, s70
s_mov_b32 s3, 262144
v_lshrrev_b32 v52, 2, v0
v_lshlrev_b32 v52, 6, v52
v_lshl_add_u32 v52, v53, 3, v52
v_add_u32 v52, 131072, v52
T a[96:97],v52,0
T a[98:99],v52,1024
T a[100:101],v52,32
T a[102:103],v52,1056
T a[104:105],v52,2048
T a[106:107],v52,3072
T a[108:109],v52,2080
T a[110:111],v52,3104
T a[0:1],v52,4096
T a[2:3],v52,5120
T a[4:5],v52,4128
T a[6:7],v52,5152
T a[8:9],v52,6144
T a[10:11],v52,7168
T a[12:13],v52,6176
T a[14:15],v52,7200
s_cbranch_vccz L_xeA
buffer_load_dwordx4 a[68:71], v58, s[12:15], s63 offen offset:1024 sc1
buffer_load_dwordx4 a[72:75], v59, s[12:15], s63 offen offset:0 sc1
buffer_load_dwordx4 a[76:79], v59, s[12:15], s63 offen offset:1024 sc1
s_add_u32 s63, s63, 4096
buffer_load_dwordx4 a[80:83], v58, s[12:15], s63 offen offset:0 sc1
buffer_load_dwordx4 a[84:87], v58, s[12:15], s63 offen offset:1024 sc1
buffer_load_dwordx4 a[88:91], v59, s[12:15], s63 offen offset:0 sc1
buffer_load_dwordx4 a[92:95], v59, s[12:15], s63 offen offset:1024 sc1
buffer_load_dword v62, v14, s[12:15], s7 offen sc1
buffer_load_dword v56, v15, s[12:15], s7 offen sc1
s_waitcnt lgkmcnt(0)
s_waitcnt vmcnt(10)
N v[80:83],a[96:99],a[176:179],0
M v[80:83],a[104:107],a[112:115]
N v[84:87],a[96:99],a[180:183],0
M v[84:87],a[104:107],a[116:119]
N v[88:91],a[96:99],a[184:187],0
M v[88:91],a[104:107],a[120:123]
N v[92:95],a[96:99],a[188:191],0
M v[92:95],a[104:107],a[124:127]
N v[112:115],a[100:103],a[176:179],0
M v[112:115],a[108:111],a[112:115]
N v[116:119],a[100:103],a[180:183],0
M v[116:119],a[108:111],a[116:119]
N v[120:123],a[100:103],a[184:187],0
M v[120:123],a[108:111],a[120:123]
N v[124:127],a[100:103],a[188:191],0
M v[124:127],a[108:111],a[124:127]
s_waitcnt vmcnt(2)
M v[80:83],a[0:3],a[64:67]
M v[80:83],a[8:11],a[80:83]
M v[84:87],a[0:3],a[68:71]
M v[84:87],a[8:11],a[84:87]
M v[88:91],a[0:3],a[72:75]
M v[88:91],a[8:11],a[88:91]
M v[92:95],a[0:3],a[76:79]
M v[92:95],a[8:11],a[92:95]
M v[112:115],a[4:7],a[64:67]
M v[112:115],a[12:15],a[80:83]
M v[116:119],a[4:7],a[68:71]
M v[116:119],a[12:15],a[84:87]
M v[120:123],a[4:7],a[72:75]
M v[120:123],a[12:15],a[88:91]
M v[124:127],a[4:7],a[76:79]
M v[124:127],a[12:15],a[92:95]
s_branch L_lateA
L_xeA:
buffer_load_dword v61, v15, s[12:15], s7 offen sc1
buffer_load_dwordx4 a[68:71], v58, s[12:15], s63 offen offset:1024 sc1
s_waitcnt vmcnt(14)
M v[160:163],v[34:37],v[208:211]
M v[176:179],v[32:35],v[208:211]
s_waitcnt vmcnt(13)
M v[164:167],v[34:37],v[212:215]
M v[180:183],v[32:35],v[212:215]
buffer_load_dwordx4 a[72:75], v59, s[12:15], s63 offen offset:0 sc1
s_waitcnt lgkmcnt(0)
s_nop 1
v_pk_mul_f32 v[48:49], v[160:161], s[70:71]
v_pk_mul_f32 v[50:51], v[162:163], s[70:71]
v_pk_mul_f32 v[52:53], v[176:177], s[70:71]
v_pk_mul_f32 v[54:55], v[178:179], s[70:71]
v_exp_f32 v48, v48
v_exp_f32 v49, v49
v_exp_f32 v50, v50
v_exp_f32 v51, v51
v_exp_f32 v52, v52
buffer_load_dwordx4 a[76:79], v59, s[12:15], s63 offen offset:1024 sc1
s_add_u32 s63, s63, 4096
v_exp_f32 v53, v53
v_exp_f32 v54, v54
v_exp_f32 v55, v55
s_waitcnt vmcnt(13)
M v[168:171],v[34:37],v[216:219]
M v[184:187],v[32:35],v[216:219]
M v[172:175],v[34:37],v[220:223]
buffer_load_dwordx4 a[80:83], v58, s[12:15], s63 offen offset:0 sc1
M v[188:191],v[32:35],v[220:223]
v_pk_add_f32 v[48:49], v[48:49], 1.0 op_sel_hi:[1,0]
v_pk_add_f32 v[50:51], v[50:51], 1.0 op_sel_hi:[1,0]
v_pk_add_f32 v[52:53], v[52:53], 1.0 op_sel_hi:[1,0]
v_pk_add_f32 v[54:55], v[54:55], 1.0 op_sel_hi:[1,0]
v_rcp_f32 v48, v48
v_rcp_f32 v49, v49
v_rcp_f32 v50, v50
v_rcp_f32 v51, v51
buffer_load_dwordx4 a[84:87], v58, s[12:15], s63 offen offset:1024 sc1
v_rcp_f32 v52, v52
v_rcp_f32 v53, v53
v_rcp_f32 v54, v54
v_rcp_f32 v55, v55
v_pk_mul_f32 v[160:161], v[160:161], v[48:49]
v_pk_mul_f32 v[162:163], v[162:163], v[50:51]
v_pk_mul_f32 v[176:177], v[176:177], v[52:53]
v_pk_mul_f32 v[178:179], v[178:179], v[54:55]
v_pk_mul_f32 v[48:49], v[164:165], s[70:71]
v_pk_mul_f32 v[50:51], v[166:167], s[70:71]
v_pk_mul_f32 v[52:53], v[180:181], s[70:71]
buffer_load_dwordx4 a[88:91], v59, s[12:15], s63 offen offset:0 sc1
v_pk_mul_f32 v[54:55], v[182:183], s[70:71]
v_exp_f32 v48, v48
v_exp_f32 v49, v49
v_exp_f32 v50, v50
v_exp_f32 v51, v51
v_exp_f32 v52, v52
v_exp_f32 v53, v53
v_exp_f32 v54, v54
v_exp_f32 v55, v55
buffer_load_dwordx4 a[92:95], v59, s[12:15], s63 offen offset:1024 sc1
v_pk_add_f32 v[48:49], v[48:49], 1.0 op_sel_hi:[1,0]
v_pk_add_f32 v[50:51], v[50:51], 1.0 op_sel_hi:[1,0]
v_pk_add_f32 v[52:53], v[52:53], 1.0 op_sel_hi:[1,0]
v_pk_add_f32 v[54:55], v[54:55], 1.0 op_sel_hi:[1,0]
v_rcp_f32 v48, v48
v_rcp_f32 v49, v49
v_rcp_f32 v50, v50
v_rcp_f32 v51, v51
v_rcp_f32 v52, v52
v_rcp_f32 v53, v53
v_rcp_f32 v54, v54
v_rcp_f32 v55, v55
v_pk_mul_f32 v[164:165], v[164:165], v[48:49]
v_pk_mul_f32 v[166:167], v[166:167], v[50:51]
v_pk_mul_f32 v[180:181], v[180:181], v[52:53]
v_pk_mul_f32 v[182:183], v[182:183], v[54:55]
s_waitcnt vmcnt(9)
N v[80:83],a[96:99],a[176:179],0
M v[80:83],a[104:107],a[112:115]
N v[84:87],a[96:99],a[180:183],0
M v[84:87],a[104:107],a[116:119]
N v[88:91],a[96:99],a[184:187],0
M v[88:91],a[104:107],a[120:123]
N v[92:95],a[96:99],a[188:191],0
M v[92:95],a[104:107],a[124:127]
N v[112:115],a[100:103],a[176:179],0
M v[112:115],a[108:111],a[112:115]
N v[116:119],a[100:103],a[180:183],0
M v[116:119],a[108:111],a[116:119]
N v[120:123],a[100:103],a[184:187],0
M v[120:123],a[108:111],a[120:123]
N v[124:127],a[100:103],a[188:191],0
M v[124:127],a[108:111],a[124:127]
s_waitcnt vmcnt(7)
v_subrev_u32 v61, s73, v61
v_cmp_le_u32 vcc, 11, v61
s_cbranch_vccnz L_xnA
buffer_load_dwordx4 a[48:51], v13, s[12:15], s16 offen offset:0 sc1
buffer_load_dwordx4 a[52:55], v13, s[12:15], s16 offen offset:1024 sc1
buffer_load_dwordx4 a[56:59], v13, s[12:15], s16 offen offset:2048 sc1
buffer_load_dwordx4 a[60:63], v13, s[12:15], s16 offen offset:3072 sc1
buffer_load_dwordx4 a[160:163], v13, s[12:15], s18 offen offset:0 sc1
buffer_load_dwordx4 a[164:167], v13, s[12:15], s18 offen offset:1024 sc1
buffer_load_dwordx4 a[168:171], v13, s[12:15], s18 offen offset:2048 sc1
buffer_load_dwordx4 a[172:175], v13, s[12:15], s18 offen offset:3072 sc1
s_branch L_xyA
L_xnA:
buffer_load_dword v61, v15, s[12:15], s7 offen sc1
L_xyA:
v_pk_mul_f32 v[48:49], v[168:169], s[70:71]
v_pk_mul_f32 v[50:51], v[170:171], s[70:71]
v_pk_mul_f32 v[52:53], v[184:185], s[70:71]
v_pk_mul_f32 v[54:55], v[186:187], s[70:71]
v_exp_f32 v48, v48
v_exp_f32 v49, v49
v_exp_f32 v50, v50
v_exp_f32 v51, v51
v_exp_f32 v52, v52
v_exp_f32 v53, v53
v_exp_f32 v54, v54
v_exp_f32 v55, v55
v_pk_add_f32 v[48:49], v[48:49], 1.0 op_sel_hi:[1,0]
v_pk_add_f32 v[50:51], v[50:51], 1.0 op_sel_hi:[1,0]
v_pk_add_f32 v[52:53], v[52:53], 1.0 op_sel_hi:[1,0]
v_pk_add_f32 v[54:55], v[54:55], 1.0 op_sel_hi:[1,0]
v_rcp_f32 v48, v48
v_rcp_f32 v49, v49
v_rcp_f32 v50, v50
v_rcp_f32 v51, v51
v_rcp_f32 v52, v52
v_rcp_f32 v53, v53
v_rcp_f32 v54, v54
v_rcp_f32 v55, v55
v_pk_mul_f32 v[168:169], v[168:169], v[48:49]
v_pk_mul_f32 v[170:171], v[170:171], v[50:51]
v_pk_mul_f32 v[184:185], v[184:185], v[52:53]
v_pk_mul_f32 v[186:187], v[186:187], v[54:55]
v_pk_mul_f32 v[48:49], v[172:173], s[70:71]
v_pk_mul_f32 v[50:51], v[174:175], s[70:71]
v_pk_mul_f32 v[52:53], v[188:189], s[70:71]
v_pk_mul_f32 v[54:55], v[190:191], s[70:71]
v_exp_f32 v48, v48
v_exp_f32 v49, v49
v_exp_f32 v50, v50
v_exp_f32 v51, v51
v_exp_f32 v52, v52
v_exp_f32 v53, v53
v_exp_f32 v54, v54
v_exp_f32 v55, v55
v_pk_add_f32 v[48:49], v[48:49], 1.0 op_sel_hi:[1,0]
v_pk_add_f32 v[50:51], v[50:51], 1.0 op_sel_hi:[1,0]
v_pk_add_f32 v[52:53], v[52:53], 1.0 op_sel_hi:[1,0]
v_pk_add_f32 v[54:55], v[54:55], 1.0 op_sel_hi:[1,0]
v_rcp_f32 v48, v48
v_rcp_f32 v49, v49
v_rcp_f32 v50, v50
v_rcp_f32 v51, v51
v_rcp_f32 v52, v52
v_rcp_f32 v53, v53
v_rcp_f32 v54, v54
v_rcp_f32 v55, v55
v_pk_mul_f32 v[172:173], v[172:173], v[48:49]
v_pk_mul_f32 v[174:175], v[174:175], v[50:51]
v_pk_mul_f32 v[188:189], v[188:189], v[52:53]
v_pk_mul_f32 v[190:191], v[190:191], v[54:55]
s_waitcnt vmcnt(8)
s_cbranch_vccz L_xwA
buffer_load_dword v56, v15, s[12:15], s7 offen sc1
s_waitcnt vmcnt(2)
L_xwA:
M v[80:83],a[0:3],a[64:67]
M v[80:83],a[8:11],a[80:83]
M v[84:87],a[0:3],a[68:71]
M v[84:87],a[8:11],a[84:87]
M v[88:91],a[0:3],a[72:75]
M v[88:91],a[8:11],a[88:91]
M v[92:95],a[0:3],a[76:79]
M v[92:95],a[8:11],a[92:95]
M v[112:115],a[4:7],a[64:67]
M v[112:115],a[12:15],a[80:83]
M v[116:119],a[4:7],a[68:71]
M v[116:119],a[12:15],a[84:87]
M v[120:123],a[4:7],a[72:75]
M v[120:123],a[12:15],a[88:91]
M v[124:127],a[4:7],a[76:79]
M v[124:127],a[12:15],a[92:95]
s_branch L_sxA
L_allA:
s_waitcnt vmcnt(13)
M v[160:163],v[34:37],v[208:211]
M v[176:179],v[32:35],v[208:211]
s_nop 6
v_pk_mul_f32 v[48:49], v[160:161], s[70:71]
v_pk_mul_f32 v[50:51], v[162:163], s[70:71]
v_pk_mul_f32 v[52:53], v[176:177], s[70:71]
v_pk_mul_f32 v[54:55], v[178:179], s[70:71]
v_exp_f32 v48, v48
v_exp_f32 v49, v49
v_exp_f32 v50, v50
v_exp_f32 v51, v51
v_exp_f32 v52, v52
v_exp_f32 v53, v53
v_exp_f32 v54, v54
v_exp_f32 v55, v55
s_waitcnt vmcnt(11)
M v[80:83],v[34:37],a[48:51]
M v[112:115],v[32:35],a[48:51]
M v[80:83],v[34:37],a[160:163]
M v[112:115],v[32:35],a[160:163]
s_waitcnt vmcnt(10)
M v[164:167],v[34:37],v[212:215]
M v[180:183],v[32:35],v[212:215]
v_pk_add_f32 v[48:49], v[48:49], 1.0 op_sel_hi:[1,0]
v_pk_add_f32 v[50:51], v[50:51], 1.0 op_sel_hi:[1,0]
v_pk_add_f32 v[52:53], v[52:53], 1.0 op_sel_hi:[1,0]
v_pk_add_f32 v[54:55], v[54:55], 1.0 op_sel_hi:[1,0]
v_rcp_f32 v48, v48
v_rcp_f32 v49, v49
v_rcp_f32 v50, v50
v_rcp_f32 v51, v51
v_rcp_f32 v52, v52
v_rcp_f32 v53, v53
v_rcp_f32 v54, v54
v_rcp_f32 v55, v55
v_pk_mul_f32 v[160:161], v[160:161], v[48:49]
v_pk_mul_f32 v[162:163], v[162:163], v[50:51]
v_pk_mul_f32 v[176:177], v[176:177], v[52:53]
v_pk_mul_f32 v[178:179], v[178:179], v[54:55]
v_pk_fma_f32 v[80:81], v[80:81], v[160:161], v[224:225]
v_pk_fma_f32 v[82:83], v[82:83], v[162:163], v[226:227]
v_pk_fma_f32 v[112:113], v[112:113], v[176:177], v[228:229]
v_pk_fma_f32 v[114:115], v[114:115], v[178:179], v[230:231]
v_cvt_pk_bf16_f32 v64, v80, v81
v_cvt_pk_bf16_f32 v65, v82, v83
v_cvt_pk_bf16_f32 v66, v112, v113
v_cvt_pk_bf16_f32 v67, v114, v115
s_nop 0
v_permlane32_swap_b32 v64, v66
v_permlane32_swap_b32 v65, v67
s_nop 0
v_permlane16_swap_b32 v64, v66
v_permlane16_swap_b32 v65, v67
buffer_store_dwordx4 v[64:67], v57, s[40:43], s44 offen
v_pk_mul_f32 v[48:49], v[164:165], s[70:71]
v_pk_mul_f32 v[50:51], v[166:167], s[70:71]
v_pk_mul_f32 v[52:53], v[180:181], s[70:71]
v_pk_mul_f32 v[54:55], v[182:183], s[70:71]
v_exp_f32 v48, v48
v_exp_f32 v49, v49
v_exp_f32 v50, v50
v_exp_f32 v51, v51
v_exp_f32 v52, v52
v_exp_f32 v53, v53
v_exp_f32 v54, v54
v_exp_f32 v55, v55
s_waitcnt vmcnt(9)
M v[84:87],v[34:37],a[52:55]
M v[116:119],v[32:35],a[52:55]
M v[84:87],v[34:37],a[164:167]
M v[116:119],v[32:35],a[164:167]
s_waitcnt vmcnt(8)
M v[168:171],v[34:37],v[216:219]
M v[184:187],v[32:35],v[216:219]
v_pk_add_f32 v[48:49], v[48:49], 1.0 op_sel_hi:[1,0]
v_pk_add_f32 v[50:51], v[50:51], 1.0 op_sel_hi:[1,0]
v_pk_add_f32 v[52:53], v[52:53], 1.0 op_sel_hi:[1,0]
v_pk_add_f32 v[54:55], v[54:55], 1.0 op_sel_hi:[1,0]
v_rcp_f32 v48, v48
v_rcp_f32 v49, v49
v_rcp_f32 v50, v50
v_rcp_f32 v51, v51
v_rcp_f32 v52, v52
v_rcp_f32 v53, v53
v_rcp_f32 v54, v54
v_rcp_f32 v55, v55
v_pk_mul_f32 v[164:165], v[164:165], v[48:49]
v_pk_mul_f32 v[166:167], v[166:167], v[50:51]
v_pk_mul_f32 v[180:181], v[180:181], v[52:53]
v_pk_mul_f32 v[182:183], v[182:183], v[54:55]
v_pk_fma_f32 v[84:85], v[84:85], v[164:165], v[232:233]
v_pk_fma_f32 v[86:87], v[86:87], v[166:167], v[234:235]
v_pk_fma_f32 v[116:117], v[116:117], v[180:181], v[236:237]
v_pk_fma_f32 v[118:119], v[118:119], v[182:183], v[238:239]
v_cvt_pk_bf16_f32 v68, v84, v85
v_cvt_pk_bf16_f32 v69, v86, v87
v_cvt_pk_bf16_f32 v70, v116, v117
v_cvt_pk_bf16_f32 v71, v118, v119
s_nop 0
v_permlane32_swap_b32 v68, v70
v_permlane32_swap_b32 v69, v71
s_nop 0
v_permlane16_swap_b32 v68, v70
v_permlane16_swap_b32 v69, v71
buffer_store_dwordx4 v[68:71], v57, s[40:43], s45 offen
v_pk_mul_f32 v[48:49], v[168:169], s[70:71]
v_pk_mul_f32 v[50:51], v[170:171], s[70:71]
v_pk_mul_f32 v[52:53], v[184:185], s[70:71]
v_pk_mul_f32 v[54:55], v[186:187], s[70:71]
v_exp_f32 v48, v48
v_exp_f32 v49, v49
v_exp_f32 v50, v50
v_exp_f32 v51, v51
v_exp_f32 v52, v52
v_exp_f32 v53, v53
v_exp_f32 v54, v54
v_exp_f32 v55, v55
s_waitcnt vmcnt(7)
M v[88:91],v[34:37],a[56:59]
M v[120:123],v[32:35],a[56:59]
M v[88:91],v[34:37],a[168:171]
M v[120:123],v[32:35],a[168:171]
s_waitcnt vmcnt(6)
M v[172:175],v[34:37],v[220:223]
M v[188:191],v[32:35],v[220:223]
v_pk_add_f32 v[48:49], v[48:49], 1.0 op_sel_hi:[1,0]
v_pk_add_f32 v[50:51], v[50:51], 1.0 op_sel_hi:[1,0]
v_pk_add_f32 v[52:53], v[52:53], 1.0 op_sel_hi:[1,0]
v_pk_add_f32 v[54:55], v[54:55], 1.0 op_sel_hi:[1,0]
v_rcp_f32 v48, v48
v_rcp_f32 v49, v49
v_rcp_f32 v50, v50
v_rcp_f32 v51, v51
v_rcp_f32 v52, v52
v_rcp_f32 v53, v53
v_rcp_f32 v54, v54
v_rcp_f32 v55, v55
v_pk_mul_f32 v[168:169], v[168:169], v[48:49]
v_pk_mul_f32 v[170:171], v[170:171], v[50:51]
v_pk_mul_f32 v[184:185], v[184:185], v[52:53]
v_pk_mul_f32 v[186:187], v[186:187], v[54:55]
v_pk_fma_f32 v[88:89], v[88:89], v[168:169], v[240:241]
v_pk_fma_f32 v[90:91], v[90:91], v[170:171], v[242:243]
v_pk_fma_f32 v[120:121], v[120:121], v[184:185], v[244:245]
v_pk_fma_f32 v[122:123], v[122:123], v[186:187], v[246:247]
v_cvt_pk_bf16_f32 v72, v88, v89
v_cvt_pk_bf16_f32 v73, v90, v91
v_cvt_pk_bf16_f32 v74, v120, v121
v_cvt_pk_bf16_f32 v75, v122, v123
s_nop 0
v_permlane32_swap_b32 v72, v74
v_permlane32_swap_b32 v73, v75
s_nop 0
v_permlane16_swap_b32 v72, v74
v_permlane16_swap_b32 v73, v75
buffer_store_dwordx4 v[72:75], v57, s[40:43], s46 offen
v_pk_mul_f32 v[48:49], v[172:173], s[70:71]
v_pk_mul_f32 v[50:51], v[174:175], s[70:71]
v_pk_mul_f32 v[52:53], v[188:189], s[70:71]
v_pk_mul_f32 v[54:55], v[190:191], s[70:71]
v_exp_f32 v48, v48
v_exp_f32 v49, v49
v_exp_f32 v50, v50
v_exp_f32 v51, v51
v_exp_f32 v52, v52
v_exp_f32 v53, v53
v_exp_f32 v54, v54
v_exp_f32 v55, v55
s_waitcnt vmcnt(5)
M v[92:95],v[34:37],a[60:63]
M v[124:127],v[32:35],a[60:63]
M v[92:95],v[34:37],a[172:175]
M v[124:127],v[32:35],a[172:175]
v_pk_add_f32 v[48:49], v[48:49], 1.0 op_sel_hi:[1,0]
v_pk_add_f32 v[50:51], v[50:51], 1.0 op_sel_hi:[1,0]
v_pk_add_f32 v[52:53], v[52:53], 1.0 op_sel_hi:[1,0]
v_pk_add_f32 v[54:55], v[54:55], 1.0 op_sel_hi:[1,0]
v_rcp_f32 v48, v48
v_rcp_f32 v49, v49
v_rcp_f32 v50, v50
v_rcp_f32 v51, v51
v_rcp_f32 v52, v52
v_rcp_f32 v53, v53
v_rcp_f32 v54, v54
v_rcp_f32 v55, v55
v_pk_mul_f32 v[172:173], v[172:173], v[48:49]
v_pk_mul_f32 v[174:175], v[174:175], v[50:51]
v_pk_mul_f32 v[188:189], v[188:189], v[52:53]
v_pk_mul_f32 v[190:191], v[190:191], v[54:55]
v_pk_fma_f32 v[92:93], v[92:93], v[172:173], v[248:249]
v_pk_fma_f32 v[94:95], v[94:95], v[174:175], v[250:251]
v_pk_fma_f32 v[124:125], v[124:125], v[188:189], v[252:253]
v_pk_fma_f32 v[126:127], v[126:127], v[190:191], v[254:255]
v_cvt_pk_bf16_f32 v76, v92, v93
v_cvt_pk_bf16_f32 v77, v94, v95
v_cvt_pk_bf16_f32 v78, v124, v125
v_cvt_pk_bf16_f32 v79, v126, v127
s_nop 0
v_permlane32_swap_b32 v76, v78
v_permlane32_swap_b32 v77, v79
s_nop 0
v_permlane16_swap_b32 v76, v78
v_permlane16_swap_b32 v77, v79
buffer_store_dwordx4 v[76:79], v57, s[40:43], s47 offen
L_finA:
L_endA:
s_endpgm
L_lateA:
s_cbranch_vccz L_late2A
L_spfA:
buffer_load_dword v60, v14, s[12:15], s7 offen sc1
buffer_load_dword v61, v15, s[12:15], s7 offen sc1
s_waitcnt vmcnt(2)
v_subrev_u32 v62, s73, v62
v_cmp_le_u32 vcc, 11, v62
v_mov_b32 v48, v56
s_cbranch_vccz L_fokA
buffer_load_dword v62, v14, s[12:15], s7 offen sc1
buffer_load_dword v56, v15, s[12:15], s7 offen sc1
s_waitcnt vmcnt(2)
v_subrev_u32 v60, s73, v60
v_cmp_le_u32 vcc, 11, v60
v_mov_b32 v48, v61
s_cbranch_vccz L_fokA
s_sub_u32 s3, s3, 1
s_cmp_gt_i32 s3, 0
s_cbranch_scc1 L_spfA
L_fokA:
v_subrev_u32 v48, s73, v48
v_cmp_le_u32 vcc, 11, v48
s_cbranch_vccnz L_fonlyA
buffer_load_dwordx4 v[208:211], v13, s[12:15], s17 offen offset:0 sc1
buffer_load_dwordx4 a[48:51], v13, s[12:15], s16 offen offset:0 sc1
buffer_load_dwordx4 a[160:163], v13, s[12:15], s18 offen offset:0 sc1
buffer_load_dwordx4 v[212:215], v13, s[12:15], s17 offen offset:1024 sc1
buffer_load_dwordx4 a[52:55], v13, s[12:15], s16 offen offset:1024 sc1
buffer_load_dwordx4 a[164:167], v13, s[12:15], s18 offen offset:1024 sc1
buffer_load_dwordx4 v[216:219], v13, s[12:15], s17 offen offset:2048 sc1
buffer_load_dwordx4 a[56:59], v13, s[12:15], s16 offen offset:2048 sc1
buffer_load_dwordx4 a[168:171], v13, s[12:15], s18 offen offset:2048 sc1
buffer_load_dwordx4 v[220:223], v13, s[12:15], s17 offen offset:3072 sc1
buffer_load_dwordx4 a[60:63], v13, s[12:15], s16 offen offset:3072 sc1
buffer_load_dwordx4 a[172:175], v13, s[12:15], s18 offen offset:3072 sc1
buffer_load_dword v62, v14, s[12:15], s7 offen sc1
buffer_load_dword v56, v15, s[12:15], s7 offen sc1
s_branch L_allA
L_fonlyA:
buffer_load_dwordx4 v[208:211], v13, s[12:15], s17 offen offset:0 sc1
buffer_load_dwordx4 v[212:215], v13, s[12:15], s17 offen offset:1024 sc1
buffer_load_dwordx4 v[216:219], v13, s[12:15], s17 offen offset:2048 sc1
buffer_load_dwordx4 v[220:223], v13, s[12:15], s17 offen offset:3072 sc1
buffer_load_dword v62, v14, s[12:15], s7 offen sc1
buffer_load_dword v56, v15, s[12:15], s7 offen sc1
L_late2A:
buffer_load_dword v61, v15, s[12:15], s7 offen sc1
s_waitcnt vmcnt(6)
M v[160:163],v[34:37],v[208:211]
M v[176:179],v[32:35],v[208:211]
s_nop 6
v_pk_mul_f32 v[48:49], v[160:161], s[70:71]
v_pk_mul_f32 v[50:51], v[162:163], s[70:71]
v_pk_mul_f32 v[52:53], v[176:177], s[70:71]
v_pk_mul_f32 v[54:55], v[178:179], s[70:71]
v_exp_f32 v48, v48
v_exp_f32 v49, v49
v_exp_f32 v50, v50
v_exp_f32 v51, v51
v_exp_f32 v52, v52
v_exp_f32 v53, v53
v_exp_f32 v54, v54
v_exp_f32 v55, v55
s_waitcnt vmcnt(5)
M v[164:167],v[34:37],v[212:215]
M v[180:183],v[32:35],v[212:215]
v_pk_add_f32 v[48:49], v[48:49], 1.0 op_sel_hi:[1,0]
v_pk_add_f32 v[50:51], v[50:51], 1.0 op_sel_hi:[1,0]
v_pk_add_f32 v[52:53], v[52:53], 1.0 op_sel_hi:[1,0]
v_pk_add_f32 v[54:55], v[54:55], 1.0 op_sel_hi:[1,0]
v_rcp_f32 v48, v48
v_rcp_f32 v49, v49
v_rcp_f32 v50, v50
v_rcp_f32 v51, v51
v_rcp_f32 v52, v52
v_rcp_f32 v53, v53
v_rcp_f32 v54, v54
v_rcp_f32 v55, v55
v_pk_mul_f32 v[160:161], v[160:161], v[48:49]
v_pk_mul_f32 v[162:163], v[162:163], v[50:51]
v_pk_mul_f32 v[176:177], v[176:177], v[52:53]
v_pk_mul_f32 v[178:179], v[178:179], v[54:55]
v_pk_mul_f32 v[48:49], v[164:165], s[70:71]
v_pk_mul_f32 v[50:51], v[166:167], s[70:71]
v_pk_mul_f32 v[52:53], v[180:181], s[70:71]
v_pk_mul_f32 v[54:55], v[182:183], s[70:71]
v_exp_f32 v48, v48
v_exp_f32 v49, v49
v_exp_f32 v50, v50
v_exp_f32 v51, v51
v_exp_f32 v52, v52
v_exp_f32 v53, v53
v_exp_f32 v54, v54
v_exp_f32 v55, v55
v_pk_add_f32 v[48:49], v[48:49], 1.0 op_sel_hi:[1,0]
v_pk_add_f32 v[50:51], v[50:51], 1.0 op_sel_hi:[1,0]
v_pk_add_f32 v[52:53], v[52:53], 1.0 op_sel_hi:[1,0]
v_pk_add_f32 v[54:55], v[54:55], 1.0 op_sel_hi:[1,0]
v_rcp_f32 v48, v48
v_rcp_f32 v49, v49
v_rcp_f32 v50, v50
v_rcp_f32 v51, v51
v_rcp_f32 v52, v52
v_rcp_f32 v53, v53
v_rcp_f32 v54, v54
v_rcp_f32 v55, v55
v_pk_mul_f32 v[164:165], v[164:165], v[48:49]
v_pk_mul_f32 v[166:167], v[166:167], v[50:51]
v_pk_mul_f32 v[180:181], v[180:181], v[52:53]
v_pk_mul_f32 v[182:183], v[182:183], v[54:55]
s_waitcnt vmcnt(1)
M v[168:171],v[34:37],v[216:219]
M v[184:187],v[32:35],v[216:219]
M v[172:175],v[34:37],v[220:223]
M v[188:191],v[32:35],v[220:223]
v_subrev_u32 v56, s73, v56
v_cmp_le_u32 vcc, 11, v56
s_cbranch_vccnz L_noA
buffer_load_dwordx4 a[48:51], v13, s[12:15], s16 offen offset:0 sc1
buffer_load_dwordx4 a[52:55], v13, s[12:15], s16 offen offset:1024 sc1
buffer_load_dwordx4 a[56:59], v13, s[12:15], s16 offen offset:2048 sc1
buffer_load_dwordx4 a[60:63], v13, s[12:15], s16 offen offset:3072 sc1
buffer_load_dwordx4 a[160:163], v13, s[12:15], s18 offen offset:0 sc1
buffer_load_dwordx4 a[164:167], v13, s[12:15], s18 offen offset:1024 sc1
buffer_load_dwordx4 a[168:171], v13, s[12:15], s18 offen offset:2048 sc1
buffer_load_dwordx4 a[172:175], v13, s[12:15], s18 offen offset:3072 sc1
s_branch L_yesA
L_noA:
buffer_load_dword v56, v15, s[12:15], s7 offen sc1
L_yesA:
v_pk_mul_f32 v[48:49], v[168:169], s[70:71]
v_pk_mul_f32 v[50:51], v[170:171], s[70:71]
v_pk_mul_f32 v[52:53], v[184:185], s[70:71]
v_pk_mul_f32 v[54:55], v[186:187], s[70:71]
v_exp_f32 v48, v48
v_exp_f32 v49, v49
v_exp_f32 v50, v50
v_exp_f32 v51, v51
v_exp_f32 v52, v52
v_exp_f32 v53, v53
v_exp_f32 v54, v54
v_exp_f32 v55, v55
v_pk_add_f32 v[48:49], v[48:49], 1.0 op_sel_hi:[1,0]
v_pk_add_f32 v[50:51], v[50:51], 1.0 op_sel_hi:[1,0]
v_pk_add_f32 v[52:53], v[52:53], 1.0 op_sel_hi:[1,0]
v_pk_add_f32 v[54:55], v[54:55], 1.0 op_sel_hi:[1,0]
v_rcp_f32 v48, v48
v_rcp_f32 v49, v49
v_rcp_f32 v50, v50
v_rcp_f32 v51, v51
v_rcp_f32 v52, v52
v_rcp_f32 v53, v53
v_rcp_f32 v54, v54
v_rcp_f32 v55, v55
v_pk_mul_f32 v[168:169], v[168:169], v[48:49]
v_pk_mul_f32 v[170:171], v[170:171], v[50:51]
v_pk_mul_f32 v[184:185], v[184:185], v[52:53]
v_pk_mul_f32 v[186:187], v[186:187], v[54:55]
v_pk_mul_f32 v[48:49], v[172:173], s[70:71]
v_pk_mul_f32 v[50:51], v[174:175], s[70:71]
v_pk_mul_f32 v[52:53], v[188:189], s[70:71]
v_pk_mul_f32 v[54:55], v[190:191], s[70:71]
v_exp_f32 v48, v48
v_exp_f32 v49, v49
v_exp_f32 v50, v50
v_exp_f32 v51, v51
v_exp_f32 v52, v52
v_exp_f32 v53, v53
v_exp_f32 v54, v54
v_exp_f32 v55, v55
v_pk_add_f32 v[48:49], v[48:49], 1.0 op_sel_hi:[1,0]
v_pk_add_f32 v[50:51], v[50:51], 1.0 op_sel_hi:[1,0]
v_pk_add_f32 v[52:53], v[52:53], 1.0 op_sel_hi:[1,0]
v_pk_add_f32 v[54:55], v[54:55], 1.0 op_sel_hi:[1,0]
v_rcp_f32 v48, v48
v_rcp_f32 v49, v49
v_rcp_f32 v50, v50
v_rcp_f32 v51, v51
v_rcp_f32 v52, v52
v_rcp_f32 v53, v53
v_rcp_f32 v54, v54
v_rcp_f32 v55, v55
v_pk_mul_f32 v[172:173], v[172:173], v[48:49]
v_pk_mul_f32 v[174:175], v[174:175], v[50:51]
v_pk_mul_f32 v[188:189], v[188:189], v[52:53]
v_pk_mul_f32 v[190:191], v[190:191], v[54:55]
L_sxA:
s_cbranch_vccz L_got2A
s_add_u32 s74, s55, 1
s_and_b32 s74, s74, 3
L_spxA:
s_waitcnt vmcnt(1)
v_subrev_u32 v61, s73, v61
v_cmp_le_u32 vcc, 11, v61
s_cmp_lg_u64 vcc, -1
s_cbranch_scc1 L_hitbA
buffer_load_dword v61, v15, s[12:15], s7 offen sc1
s_waitcnt vmcnt(1)
v_subrev_u32 v56, s73, v56
v_cmp_le_u32 vcc, 11, v56
s_cmp_lg_u64 vcc, -1
s_cbranch_scc1 L_hitaA
L_pad15:
s_cbranch_execz L_pb2A
buffer_load_dword v56, v15, s[12:15], s7 offen sc1
s_sub_u32 s3, s3, 1
s_cmp_gt_i32 s3, 0
s_cbranch_scc1 L_spxA
L_hitbA:
s_bitcmp1_b32 vcc_lo, s74
s_cselect_b32 s75, 1, 0
s_cbranch_scc1 L_h2bA
buffer_load_dwordx4 a[48:51], v13, s[12:15], s16 offen offset:0 sc1
buffer_load_dwordx4 a[52:55], v13, s[12:15], s16 offen offset:1024 sc1
buffer_load_dwordx4 a[56:59], v13, s[12:15], s16 offen offset:2048 sc1
buffer_load_dwordx4 a[60:63], v13, s[12:15], s16 offen offset:3072 sc1
s_branch L_h3bA
L_h2bA:
buffer_load_dwordx4 a[160:163], v13, s[12:15], s18 offen offset:0 sc1
buffer_load_dwordx4 a[164:167], v13, s[12:15], s18 offen offset:1024 sc1
buffer_load_dwordx4 a[168:171], v13, s[12:15], s18 offen offset:2048 sc1
buffer_load_dwordx4 a[172:175], v13, s[12:15], s18 offen offset:3072 sc1
L_h3bA:
s_cbranch_vccz L_gotA
buffer_load_dword v61, v15, s[12:15], s7 offen sc1
s_waitcnt vmcnt(5)
v_subrev_u32 v56, s73, v56
v_cmp_le_u32 vcc, 11, v56
s_cbranch_vccz L_gotA
buffer_load_dword v56, v15, s[12:15], s7 offen sc1
s_branch L_spybA
L_hitaA:
s_bitcmp1_b32 vcc_lo, s74
s_cselect_b32 s75, 1, 0
s_cbranch_scc1 L_h2aA
buffer_load_dwordx4 a[48:51], v13, s[12:15], s16 offen offset:0 sc1
buffer_load_dwordx4 a[52:55], v13, s[12:15], s16 offen offset:1024 sc1
buffer_load_dwordx4 a[56:59], v13, s[12:15], s16 offen offset:2048 sc1
buffer_load_dwordx4 a[60:63], v13, s[12:15], s16 offen offset:3072 sc1
s_branch L_h3aA
L_h2aA:
buffer_load_dwordx4 a[160:163], v13, s[12:15], s18 offen offset:0 sc1
buffer_load_dwordx4 a[164:167], v13, s[12:15], s18 offen offset:1024 sc1
buffer_load_dwordx4 a[168:171], v13, s[12:15], s18 offen offset:2048 sc1
buffer_load_dwordx4 a[172:175], v13, s[12:15], s18 offen offset:3072 sc1
L_h3aA:
s_cbranch_vccz L_gotA
buffer_load_dword v56, v15, s[12:15], s7 offen sc1
s_waitcnt vmcnt(5)
v_subrev_u32 v61, s73, v61
v_cmp_le_u32 vcc, 11, v61
s_cbranch_vccz L_gotA
buffer_load_dword v61, v15, s[12:15], s7 offen sc1
s_branch L_spyaA
L_spybA:
s_waitcnt vmcnt(1)
v_subrev_u32 v61, s73, v61
v_cmp_le_u32 vcc, 11, v61
s_cbranch_vccz L_gotA
buffer_load_dword v61, v15, s[12:15], s7 offen sc1
L_spyaA:
s_waitcnt vmcnt(1)
v_subrev_u32 v56, s73, v56
v_cmp_le_u32 vcc, 11, v56
s_cbranch_vccz L_gotA
buffer_load_dword v56, v15, s[12:15], s7 offen sc1
s_sub_u32 s3, s3, 1
s_cmp_gt_i32 s3, 0
s_cbranch_scc1 L_spybA
L_gotA:
s_cmp_eq_u32 s75, 0
s_cbranch_scc1 L_h4A
buffer_load_dwordx4 a[48:51], v13, s[12:15], s16 offen offset:0 sc1
buffer_load_dwordx4 a[52:55], v13, s[12:15], s16 offen offset:1024 sc1
buffer_load_dwordx4 a[56:59], v13, s[12:15], s16 offen offset:2048 sc1
buffer_load_dwordx4 a[60:63], v13, s[12:15], s16 offen offset:3072 sc1
s_branch L_got2A
L_h4A:
buffer_load_dwordx4 a[160:163], v13, s[12:15], s18 offen offset:0 sc1
buffer_load_dwordx4 a[164:167], v13, s[12:15], s18 offen offset:1024 sc1
buffer_load_dwordx4 a[168:171], v13, s[12:15], s18 offen offset:2048 sc1
buffer_load_dwordx4 a[172:175], v13, s[12:15], s18 offen offset:3072 sc1
L_got2A:
s_waitcnt vmcnt(3)
M v[80:83],v[34:37],a[48:51]
M v[112:115],v[32:35],a[48:51]
M v[80:83],v[34:37],a[160:163]
M v[112:115],v[32:35],a[160:163]
s_waitcnt vmcnt(2)
M v[84:87],v[34:37],a[52:55]
M v[116:119],v[32:35],a[52:55]
M v[84:87],v[34:37],a[164:167]
M v[116:119],v[32:35],a[164:167]
s_nop 1
v_pk_fma_f32 v[80:81], v[80:81], v[160:161], v[224:225]
v_pk_fma_f32 v[82:83], v[82:83], v[162:163], v[226:227]
v_pk_fma_f32 v[112:113], v[112:113], v[176:177], v[228:229]
v_pk_fma_f32 v[114:115], v[114:115], v[178:179], v[230:231]
v_cvt_pk_bf16_f32 v64, v80, v81
v_cvt_pk_bf16_f32 v65, v82, v83
v_cvt_pk_bf16_f32 v66, v112, v113
v_cvt_pk_bf16_f32 v67, v114, v115
s_nop 0
v_permlane32_swap_b32 v64, v66
v_permlane32_swap_b32 v65, v67
s_nop 0
v_permlane16_swap_b32 v64, v66
v_permlane16_swap_b32 v65, v67
buffer_store_dwordx4 v[64:67], v57, s[40:43], s44 offen
s_waitcnt vmcnt(2)
M v[88:91],v[34:37],a[56:59]
M v[120:123],v[32:35],a[56:59]
M v[88:91],v[34:37],a[168:171]
M v[120:123],v[32:35],a[168:171]
v_pk_fma_f32 v[84:85], v[84:85], v[164:165], v[232:233]
v_pk_fma_f32 v[86:87], v[86:87], v[166:167], v[234:235]
v_pk_fma_f32 v[116:117], v[116:117], v[180:181], v[236:237]
v_pk_fma_f32 v[118:119], v[118:119], v[182:183], v[238:239]
v_cvt_pk_bf16_f32 v68, v84, v85
v_cvt_pk_bf16_f32 v69, v86, v87
v_cvt_pk_bf16_f32 v70, v116, v117
v_cvt_pk_bf16_f32 v71, v118, v119
s_nop 0
v_permlane32_swap_b32 v68, v70
v_permlane32_swap_b32 v69, v71
s_nop 0
v_permlane16_swap_b32 v68, v70
v_permlane16_swap_b32 v69, v71
buffer_store_dwordx4 v[68:71], v57, s[40:43], s45 offen
s_waitcnt vmcnt(2)
M v[92:95],v[34:37],a[60:63]
M v[124:127],v[32:35],a[60:63]
M v[92:95],v[34:37],a[172:175]
M v[124:127],v[32:35],a[172:175]
v_pk_fma_f32 v[88:89], v[88:89], v[168:169], v[240:241]
v_pk_fma_f32 v[90:91], v[90:91], v[170:171], v[242:243]
v_pk_fma_f32 v[120:121], v[120:121], v[184:185], v[244:245]
v_pk_fma_f32 v[122:123], v[122:123], v[186:187], v[246:247]
v_cvt_pk_bf16_f32 v72, v88, v89
v_cvt_pk_bf16_f32 v73, v90, v91
v_cvt_pk_bf16_f32 v74, v120, v121
v_cvt_pk_bf16_f32 v75, v122, v123
s_nop 0
v_permlane32_swap_b32 v72, v74
v_permlane32_swap_b32 v73, v75
s_nop 0
v_permlane16_swap_b32 v72, v74
v_permlane16_swap_b32 v73, v75
buffer_store_dwordx4 v[72:75], v57, s[40:43], s46 offen
v_pk_fma_f32 v[92:93], v[92:93], v[172:173], v[248:249]
v_pk_fma_f32 v[94:95], v[94:95], v[174:175], v[250:251]
v_pk_fma_f32 v[124:125], v[124:125], v[188:189], v[252:253]
v_pk_fma_f32 v[126:127], v[126:127], v[190:191], v[254:255]
v_cvt_pk_bf16_f32 v76, v92, v93
v_cvt_pk_bf16_f32 v77, v94, v95
v_cvt_pk_bf16_f32 v78, v124, v125
v_cvt_pk_bf16_f32 v79, v126, v127
s_nop 0
v_permlane32_swap_b32 v76, v78
v_permlane32_swap_b32 v77, v79
s_nop 0
v_permlane16_swap_b32 v76, v78
v_permlane16_swap_b32 v77, v79
buffer_store_dwordx4 v[76:79], v57, s[40:43], s47 offen
s_endpgm
L_slowA:
s_nop 7
s_lshl_b32 s70, s55, 19
s_add_u32 s70, s70, 393216
v_and_b32 v40, 15, v0
v_lshlrev_b32 v41, 8, v40
v_lshl_add_u32 v41, v63, 1, v41
v_lshlrev_b32 v42, 7, v63
v_lshl_add_u32 v42, v40, 1, v42
v_mov_b32 v192, 0xff800000
v_mov_b32 v196, 0xff800000
v_mov_b32 v200, 0xff800000
v_mov_b32 v204, 0xff800000
s_mov_b32 s71, 0
L_slow1A:
s_lshl_b32 s72, s71, 13
s_add_u32 s72, s72, s70
s_add_u32 s73, s72, 4096
buffer_load_dwordx4 v[160:163], v41, s[20:23], s72 offen offset:0
buffer_load_dwordx4 v[164:167], v41, s[20:23], s72 offen offset:64
buffer_load_dwordx4 v[168:171], v41, s[20:23], s72 offen offset:128
buffer_load_dwordx4 v[172:175], v41, s[20:23], s72 offen offset:192
buffer_load_dwordx4 v[176:179], v41, s[20:23], s73 offen offset:0
buffer_load_dwordx4 v[180:183], v41, s[20:23], s73 offen offset:64
buffer_load_dwordx4 v[184:187], v41, s[20:23], s73 offen offset:128
buffer_load_dwordx4 v[188:191], v41, s[20:23], s73 offen offset:192
s_waitcnt vmcnt(0)
N v[128:131],v[160:163],v[64:67],0
N v[136:139],v[160:163],v[80:83],0
N v[144:147],v[160:163],v[96:99],0
N v[152:155],v[160:163],v[112:115],0
M v[128:131],v[164:167],v[68:71]
M v[136:139],v[164:167],v[84:87]
M v[144:147],v[164:167],v[100:103]
M v[152:155],v[164:167],v[116:119]
M v[128:131],v[168:171],v[72:75]
M v[136:139],v[168:171],v[88:91]
M v[144:147],v[168:171],v[104:107]
M v[152:155],v[168:171],v[120:123]
M v[128:131],v[172:175],v[76:79]
M v[136:139],v[172:175],v[92:95]
M v[144:147],v[172:175],v[108:111]
M v[152:155],v[172:175],v[124:127]
N v[132:135],v[176:179],v[64:67],0
N v[140:143],v[176:179],v[80:83],0
N v[148:151],v[176:179],v[96:99],0
N v[156:159],v[176:179],v[112:115],0
M v[132:135],v[180:183],v[68:71]
M v[140:143],v[180:183],v[84:87]
M v[148:151],v[180:183],v[100:103]
M v[156:159],v[180:183],v[116:119]
M v[132:135],v[184:187],v[72:75]
M v[140:143],v[184:187],v[88:91]
M v[148:151],v[184:187],v[104:107]
M v[156:159],v[184:187],v[120:123]
M v[132:135],v[188:191],v[76:79]
M v[140:143],v[188:191],v[92:95]
M v[148:151],v[188:191],v[108:111]
M v[156:159],v[188:191],v[124:127]
v_max3_f32 v192, v192, v128, v129
v_max3_f32 v192, v192, v130, v131
s_nop 2
v_max3_f32 v192, v192, v132, v133
v_max3_f32 v192, v192, v134, v135
v_max3_f32 v196, v196, v136, v137
v_max3_f32 v196, v196, v138, v139
v_max3_f32 v196, v196, v140, v141
v_max3_f32 v196, v196, v142, v143
v_max3_f32 v200, v200, v144, v145
v_max3_f32 v200, v200, v146, v147
v_max3_f32 v200, v200, v148, v149
v_max3_f32 v200, v200, v150, v151
v_max3_f32 v204, v204, v152, v153
v_max3_f32 v204, v204, v154, v155
v_max3_f32 v204, v204, v156, v157
v_max3_f32 v204, v204, v158, v159
s_add_u32 s71, s71, 1
s_cmp_lt_u32 s71, 16
s_cbranch_scc1 L_slow1A
v_mov_b32 v193, v192
s_nop 1
v_permlane32_swap_b32 v192, v193
v_max_f32 v192, v192, v193
v_mov_b32 v193, v192
s_nop 1
v_permlane16_swap_b32 v192, v193
v_max_f32 v192, v192, v193
v_sub_f32 v195, 0, v192
v_sub_f32 v194, 0, v192
v_sub_f32 v193, 0, v192
v_sub_f32 v192, 0, v192
v_mov_b32 v197, v196
s_nop 1
v_permlane32_swap_b32 v196, v197
v_max_f32 v196, v196, v197
v_mov_b32 v197, v196
s_nop 1
v_permlane16_swap_b32 v196, v197
v_max_f32 v196, v196, v197
v_sub_f32 v199, 0, v196
v_sub_f32 v198, 0, v196
v_sub_f32 v197, 0, v196
v_sub_f32 v196, 0, v196
v_mov_b32 v201, v200
s_nop 1
v_permlane32_swap_b32 v200, v201
v_max_f32 v200, v200, v201
v_mov_b32 v201, v200
s_nop 1
v_permlane16_swap_b32 v200, v201
v_max_f32 v200, v200, v201
v_sub_f32 v203, 0, v200
v_sub_f32 v202, 0, v200
v_sub_f32 v201, 0, v200
v_sub_f32 v200, 0, v200
v_mov_b32 v205, v204
s_nop 1
v_permlane32_swap_b32 v204, v205
v_max_f32 v204, v204, v205
v_mov_b32 v205, v204
s_nop 1
v_permlane16_swap_b32 v204, v205
v_max_f32 v204, v204, v205
v_sub_f32 v207, 0, v204
v_sub_f32 v206, 0, v204
v_sub_f32 v205, 0, v204
v_sub_f32 v204, 0, v204
v_accvgpr_write_b32 a0, 0
v_accvgpr_write_b32 a1, 0
v_accvgpr_write_b32 a2, 0
v_accvgpr_write_b32 a3, 0
v_accvgpr_write_b32 a4, 0
v_accvgpr_write_b32 a5, 0
v_accvgpr_write_b32 a6, 0
v_accvgpr_write_b32 a7, 0
v_accvgpr_write_b32 a8, 0
v_accvgpr_write_b32 a9, 0
v_accvgpr_write_b32 a10, 0
v_accvgpr_write_b32 a11, 0
v_accvgpr_write_b32 a12, 0
v_accvgpr_write_b32 a13, 0
v_accvgpr_write_b32 a14, 0
v_accvgpr_write_b32 a15, 0
v_accvgpr_write_b32 a16, 0
v_accvgpr_write_b32 a17, 0
v_accvgpr_write_b32 a18, 0
v_accvgpr_write_b32 a19, 0
v_accvgpr_write_b32 a20, 0
v_accvgpr_write_b32 a21, 0
v_accvgpr_write_b32 a22, 0
v_accvgpr_write_b32 a23, 0
v_accvgpr_write_b32 a24, 0
v_accvgpr_write_b32 a25, 0
v_accvgpr_write_b32 a26, 0
v_accvgpr_write_b32 a27, 0
v_accvgpr_write_b32 a28, 0
v_accvgpr_write_b32 a29, 0
v_accvgpr_write_b32 a30, 0
v_accvgpr_write_b32 a31, 0
v_accvgpr_write_b32 a32, 0
v_accvgpr_write_b32 a33, 0
v_accvgpr_write_b32 a34, 0
v_accvgpr_write_b32 a35, 0
v_accvgpr_write_b32 a36, 0
v_accvgpr_write_b32 a37, 0
v_accvgpr_write_b32 a38, 0
v_accvgpr_write_b32 a39, 0
v_accvgpr_write_b32 a40, 0
v_accvgpr_write_b32 a41, 0
v_accvgpr_write_b32 a42, 0
v_accvgpr_write_b32 a43, 0
v_accvgpr_write_b32 a44, 0
v_accvgpr_write_b32 a45, 0
v_accvgpr_write_b32 a46, 0
v_accvgpr_write_b32 a47, 0
v_accvgpr_write_b32 a48, 0
v_accvgpr_write_b32 a49, 0
v_accvgpr_write_b32 a50, 0
v_accvgpr_write_b32 a51, 0
v_accvgpr_write_b32 a52, 0
v_accvgpr_write_b32 a53, 0
v_accvgpr_write_b32 a54, 0
v_accvgpr_write_b32 a55, 0
v_accvgpr_write_b32 a56, 0
v_accvgpr_write_b32 a57, 0
v_accvgpr_write_b32 a58, 0
v_accvgpr_write_b32 a59, 0
v_accvgpr_write_b32 a60, 0
v_accvgpr_write_b32 a61, 0
v_accvgpr_write_b32 a62, 0
v_accvgpr_write_b32 a63, 0
v_accvgpr_write_b32 a64, 0
v_accvgpr_write_b32 a65, 0
v_accvgpr_write_b32 a66, 0
v_accvgpr_write_b32 a67, 0
v_accvgpr_write_b32 a68, 0
v_accvgpr_write_b32 a69, 0
v_accvgpr_write_b32 a70, 0
v_accvgpr_write_b32 a71, 0
v_accvgpr_write_b32 a72, 0
v_accvgpr_write_b32 a73, 0
v_accvgpr_write_b32 a74, 0
v_accvgpr_write_b32 a75, 0
v_accvgpr_write_b32 a76, 0
v_accvgpr_write_b32 a77, 0
v_accvgpr_write_b32 a78, 0
v_accvgpr_write_b32 a79, 0
v_accvgpr_write_b32 a80, 0
v_accvgpr_write_b32 a81, 0
v_accvgpr_write_b32 a82, 0
v_accvgpr_write_b32 a83, 0
v_accvgpr_write_b32 a84, 0
v_accvgpr_write_b32 a85, 0
v_accvgpr_write_b32 a86, 0
v_accvgpr_write_b32 a87, 0
v_accvgpr_write_b32 a88, 0
v_accvgpr_write_b32 a89, 0
v_accvgpr_write_b32 a90, 0
v_accvgpr_write_b32 a91, 0
v_accvgpr_write_b32 a92, 0
v_accvgpr_write_b32 a93, 0
v_accvgpr_write_b32 a94, 0
v_accvgpr_write_b32 a95, 0
v_accvgpr_write_b32 a96, 0
v_accvgpr_write_b32 a97, 0
v_accvgpr_write_b32 a98, 0
v_accvgpr_write_b32 a99, 0
v_accvgpr_write_b32 a100, 0
v_accvgpr_write_b32 a101, 0
v_accvgpr_write_b32 a102, 0
v_accvgpr_write_b32 a103, 0
v_accvgpr_write_b32 a104, 0
v_accvgpr_write_b32 a105, 0
v_accvgpr_write_b32 a106, 0
v_accvgpr_write_b32 a107, 0
v_accvgpr_write_b32 a108, 0
v_accvgpr_write_b32 a109, 0
v_accvgpr_write_b32 a110, 0
v_accvgpr_write_b32 a111, 0
v_accvgpr_write_b32 a112, 0
v_accvgpr_write_b32 a113, 0
v_accvgpr_write_b32 a114, 0
v_accvgpr_write_b32 a115, 0
v_accvgpr_write_b32 a116, 0
v_accvgpr_write_b32 a117, 0
v_accvgpr_write_b32 a118, 0
v_accvgpr_write_b32 a119, 0
v_accvgpr_write_b32 a120, 0
v_accvgpr_write_b32 a121, 0
v_accvgpr_write_b32 a122, 0
v_accvgpr_write_b32 a123, 0
v_accvgpr_write_b32 a124, 0
v_accvgpr_write_b32 a125, 0
v_accvgpr_write_b32 a126, 0
v_accvgpr_write_b32 a127, 0
v_mov_b32 v208, 0
v_mov_b32 v209, 0
v_mov_b32 v210, 0
v_mov_b32 v211, 0
v_mov_b32 v212, 0
v_mov_b32 v213, 0
v_mov_b32 v214, 0
v_mov_b32 v215, 0
v_mov_b32 v216, 0
v_mov_b32 v217, 0
v_mov_b32 v218, 0
v_mov_b32 v219, 0
v_mov_b32 v220, 0
v_mov_b32 v221, 0
v_mov_b32 v222, 0
v_mov_b32 v223, 0
s_mov_b32 s71, 0
L_slow2A:
s_lshl_b32 s72, s71, 13
s_add_u32 s72, s72, s70
s_add_u32 s73, s72, 4096
buffer_load_dwordx4 v[160:163], v41, s[20:23], s72 offen offset:0
buffer_load_dwordx4 v[164:167], v41, s[20:23], s72 offen offset:64
buffer_load_dwordx4 v[168:171], v41, s[20:23], s72 offen offset:128
buffer_load_dwordx4 v[172:175], v41, s[20:23], s72 offen offset:192
buffer_load_dwordx4 v[176:179], v41, s[20:23], s73 offen offset:0
buffer_load_dwordx4 v[180:183], v41, s[20:23], s73 offen offset:64
buffer_load_dwordx4 v[184:187], v41, s[20:23], s73 offen offset:128
buffer_load_dwordx4 v[188:191], v41, s[20:23], s73 offen offset:192
s_waitcnt vmcnt(0)
N v[128:131],v[160:163],v[64:67],v[192:195]
N v[136:139],v[160:163],v[80:83],v[196:199]
N v[144:147],v[160:163],v[96:99],v[200:203]
N v[152:155],v[160:163],v[112:115],v[204:207]
M v[128:131],v[164:167],v[68:71]
M v[136:139],v[164:167],v[84:87]
M v[144:147],v[164:167],v[100:103]
M v[152:155],v[164:167],v[116:119]
M v[128:131],v[168:171],v[72:75]
M v[136:139],v[168:171],v[88:91]
M v[144:147],v[168:171],v[104:107]
M v[152:155],v[168:171],v[120:123]
M v[128:131],v[172:175],v[76:79]
M v[136:139],v[172:175],v[92:95]
M v[144:147],v[172:175],v[108:111]
M v[152:155],v[172:175],v[124:127]
N v[132:135],v[176:179],v[64:67],v[192:195]
N v[140:143],v[176:179],v[80:83],v[196:199]
N v[148:151],v[176:179],v[96:99],v[200:203]
N v[156:159],v[176:179],v[112:115],v[204:207]
M v[132:135],v[180:183],v[68:71]
M v[140:143],v[180:183],v[84:87]
M v[148:151],v[180:183],v[100:103]
M v[156:159],v[180:183],v[116:119]
M v[132:135],v[184:187],v[72:75]
M v[140:143],v[184:187],v[88:91]
M v[148:151],v[184:187],v[104:107]
M v[156:159],v[184:187],v[120:123]
M v[132:135],v[188:191],v[76:79]
M v[140:143],v[188:191],v[92:95]
M v[148:151],v[188:191],v[108:111]
M v[156:159],v[188:191],v[124:127]
v_exp_f32 v128, v128
v_exp_f32 v129, v129
v_exp_f32 v130, v130
v_exp_f32 v131, v131
s_nop 0
v_exp_f32 v132, v132
v_exp_f32 v133, v133
v_exp_f32 v134, v134
v_exp_f32 v135, v135
v_cvt_pk_bf16_f32 v128, v128, v129
v_cvt_pk_bf16_f32 v129, v130, v131
v_cvt_pk_bf16_f32 v130, v132, v133
v_cvt_pk_bf16_f32 v131, v134, v135
v_exp_f32 v136, v136
v_exp_f32 v137, v137
v_exp_f32 v138, v138
v_exp_f32 v139, v139
v_exp_f32 v140, v140
v_exp_f32 v141, v141
v_exp_f32 v142, v142
v_exp_f32 v143, v143
v_cvt_pk_bf16_f32 v136, v136, v137
v_cvt_pk_bf16_f32 v137, v138, v139
v_cvt_pk_bf16_f32 v138, v140, v141
v_cvt_pk_bf16_f32 v139, v142, v143
v_exp_f32 v144, v144
v_exp_f32 v145, v145
v_exp_f32 v146, v146
v_exp_f32 v147, v147
v_exp_f32 v148, v148
v_exp_f32 v149, v149
v_exp_f32 v150, v150
v_exp_f32 v151, v151
v_cvt_pk_bf16_f32 v144, v144, v145
v_cvt_pk_bf16_f32 v145, v146, v147
v_cvt_pk_bf16_f32 v146, v148, v149
v_cvt_pk_bf16_f32 v147, v150, v151
v_exp_f32 v152, v152
v_exp_f32 v153, v153
v_exp_f32 v154, v154
v_exp_f32 v155, v155
v_exp_f32 v156, v156
v_exp_f32 v157, v157
v_exp_f32 v158, v158
v_exp_f32 v159, v159
v_cvt_pk_bf16_f32 v152, v152, v153
v_cvt_pk_bf16_f32 v153, v154, v155
v_cvt_pk_bf16_f32 v154, v156, v157
v_cvt_pk_bf16_f32 v155, v158, v159
s_lshl_b32 s3, s55, 1
s_add_u32 s3, s3, 2
s_and_b32 s3, s3, 7
s_lshl_b32 s3, s3, 5
v_add_u32 v43, s3, v42
buffer_load_ushort v44, v43, s[24:27], s72 offen offset:0
buffer_load_ushort v45, v43, s[24:27], s72 offen offset:256
buffer_load_ushort v46, v43, s[24:27], s72 offen offset:512
buffer_load_ushort v47, v43, s[24:27], s72 offen offset:768
buffer_load_ushort v48, v43, s[24:27], s73 offen offset:0
buffer_load_ushort v49, v43, s[24:27], s73 offen offset:256
buffer_load_ushort v50, v43, s[24:27], s73 offen offset:512
buffer_load_ushort v51, v43, s[24:27], s73 offen offset:768
s_waitcnt vmcnt(0)
v_lshl_or_b32 v160, v45, 16, v44
v_lshl_or_b32 v161, v47, 16, v46
v_lshl_or_b32 v162, v49, 16, v48
v_lshl_or_b32 v163, v51, 16, v50
s_lshl_b32 s3, s55, 1
s_add_u32 s3, s3, 3
s_and_b32 s3, s3, 7
s_lshl_b32 s3, s3, 5
v_add_u32 v43, s3, v42
buffer_load_ushort v44, v43, s[24:27], s72 offen offset:0
buffer_load_ushort v45, v43, s[24:27], s72 offen offset:256
buffer_load_ushort v46, v43, s[24:27], s72 offen offset:512
buffer_load_ushort v47, v43, s[24:27], s72 offen offset:768
buffer_load_ushort v48, v43, s[24:27], s73 offen offset:0
buffer_load_ushort v49, v43, s[24:27], s73 offen offset:256
buffer_load_ushort v50, v43, s[24:27], s73 offen offset:512
buffer_load_ushort v51, v43, s[24:27], s73 offen offset:768
s_waitcnt vmcnt(0)
v_lshl_or_b32 v164, v45, 16, v44
v_lshl_or_b32 v165, v47, 16, v46
v_lshl_or_b32 v166, v49, 16, v48
v_lshl_or_b32 v167, v51, 16, v50
s_lshl_b32 s3, s55, 1
s_add_u32 s3, s3, 4
s_and_b32 s3, s3, 7
s_lshl_b32 s3, s3, 5
v_add_u32 v43, s3, v42
buffer_load_ushort v44, v43, s[24:27], s72 offen offset:0
buffer_load_ushort v45, v43, s[24:27], s72 offen offset:256
buffer_load_ushort v46, v43, s[24:27], s72 offen offset:512
buffer_load_ushort v47, v43, s[24:27], s72 offen offset:768
buffer_load_ushort v48, v43, s[24:27], s73 offen offset:0
buffer_load_ushort v49, v43, s[24:27], s73 offen offset:256
buffer_load_ushort v50, v43, s[24:27], s73 offen offset:512
buffer_load_ushort v51, v43, s[24:27], s73 offen offset:768
s_waitcnt vmcnt(0)
v_lshl_or_b32 v168, v45, 16, v44
v_lshl_or_b32 v169, v47, 16, v46
v_lshl_or_b32 v170, v49, 16, v48
v_lshl_or_b32 v171, v51, 16, v50
s_lshl_b32 s3, s55, 1
s_add_u32 s3, s3, 5
s_and_b32 s3, s3, 7
s_lshl_b32 s3, s3, 5
v_add_u32 v43, s3, v42
buffer_load_ushort v44, v43, s[24:27], s72 offen offset:0
buffer_load_ushort v45, v43, s[24:27], s72 offen offset:256
buffer_load_ushort v46, v43, s[24:27], s72 offen offset:512
buffer_load_ushort v47, v43, s[24:27], s72 offen offset:768
buffer_load_ushort v48, v43, s[24:27], s73 offen offset:0
buffer_load_ushort v49, v43, s[24:27], s73 offen offset:256
buffer_load_ushort v50, v43, s[24:27], s73 offen offset:512
buffer_load_ushort v51, v43, s[24:27], s73 offen offset:768
s_waitcnt vmcnt(0)
v_lshl_or_b32 v172, v45, 16, v44
v_lshl_or_b32 v173, v47, 16, v46
v_lshl_or_b32 v174, v49, 16, v48
v_lshl_or_b32 v175, v51, 16, v50
s_lshl_b32 s3, s55, 1
s_add_u32 s3, s3, 6
s_and_b32 s3, s3, 7
s_lshl_b32 s3, s3, 5
v_add_u32 v43, s3, v42
buffer_load_ushort v44, v43, s[24:27], s72 offen offset:0
buffer_load_ushort v45, v43, s[24:27], s72 offen offset:256
buffer_load_ushort v46, v43, s[24:27], s72 offen offset:512
buffer_load_ushort v47, v43, s[24:27], s72 offen offset:768
buffer_load_ushort v48, v43, s[24:27], s73 offen offset:0
buffer_load_ushort v49, v43, s[24:27], s73 offen offset:256
buffer_load_ushort v50, v43, s[24:27], s73 offen offset:512
buffer_load_ushort v51, v43, s[24:27], s73 offen offset:768
s_waitcnt vmcnt(0)
v_lshl_or_b32 v176, v45, 16, v44
v_lshl_or_b32 v177, v47, 16, v46
v_lshl_or_b32 v178, v49, 16, v48
v_lshl_or_b32 v179, v51, 16, v50
s_lshl_b32 s3, s55, 1
s_add_u32 s3, s3, 7
s_and_b32 s3, s3, 7
s_lshl_b32 s3, s3, 5
v_add_u32 v43, s3, v42
buffer_load_ushort v44, v43, s[24:27], s72 offen offset:0
buffer_load_ushort v45, v43, s[24:27], s72 offen offset:256
buffer_load_ushort v46, v43, s[24:27], s72 offen offset:512
buffer_load_ushort v47, v43, s[24:27], s72 offen offset:768
buffer_load_ushort v48, v43, s[24:27], s73 offen offset:0
buffer_load_ushort v49, v43, s[24:27], s73 offen offset:256
buffer_load_ushort v50, v43, s[24:27], s73 offen offset:512
buffer_load_ushort v51, v43, s[24:27], s73 offen offset:768
s_waitcnt vmcnt(0)
v_lshl_or_b32 v180, v45, 16, v44
v_lshl_or_b32 v181, v47, 16, v46
v_lshl_or_b32 v182, v49, 16, v48
v_lshl_or_b32 v183, v51, 16, v50
s_lshl_b32 s3, s55, 1
s_add_u32 s3, s3, 8
s_and_b32 s3, s3, 7
s_lshl_b32 s3, s3, 5
v_add_u32 v43, s3, v42
buffer_load_ushort v44, v43, s[24:27], s72 offen offset:0
buffer_load_ushort v45, v43, s[24:27], s72 offen offset:256
buffer_load_ushort v46, v43, s[24:27], s72 offen offset:512
buffer_load_ushort v47, v43, s[24:27], s72 offen offset:768
buffer_load_ushort v48, v43, s[24:27], s73 offen offset:0
buffer_load_ushort v49, v43, s[24:27], s73 offen offset:256
buffer_load_ushort v50, v43, s[24:27], s73 offen offset:512
buffer_load_ushort v51, v43, s[24:27], s73 offen offset:768
s_waitcnt vmcnt(0)
v_lshl_or_b32 v184, v45, 16, v44
v_lshl_or_b32 v185, v47, 16, v46
v_lshl_or_b32 v186, v49, 16, v48
v_lshl_or_b32 v187, v51, 16, v50
s_lshl_b32 s3, s55, 1
s_add_u32 s3, s3, 9
s_and_b32 s3, s3, 7
s_lshl_b32 s3, s3, 5
v_add_u32 v43, s3, v42
buffer_load_ushort v44, v43, s[24:27], s72 offen offset:0
buffer_load_ushort v45, v43, s[24:27], s72 offen offset:256
buffer_load_ushort v46, v43, s[24:27], s72 offen offset:512
buffer_load_ushort v47, v43, s[24:27], s72 offen offset:768
buffer_load_ushort v48, v43, s[24:27], s73 offen offset:0
buffer_load_ushort v49, v43, s[24:27], s73 offen offset:256
buffer_load_ushort v50, v43, s[24:27], s73 offen offset:512
buffer_load_ushort v51, v43, s[24:27], s73 offen offset:768
s_waitcnt vmcnt(0)
v_lshl_or_b32 v188, v45, 16, v44
v_lshl_or_b32 v189, v47, 16, v46
v_lshl_or_b32 v190, v49, 16, v48
v_lshl_or_b32 v191, v51, 16, v50
M a[0:3],v[160:163],v[128:131]
M a[4:7],v[160:163],v[136:139]
M a[8:11],v[160:163],v[144:147]
M a[12:15],v[160:163],v[152:155]
M a[16:19],v[164:167],v[128:131]
M a[20:23],v[164:167],v[136:139]
M a[24:27],v[164:167],v[144:147]
M a[28:31],v[164:167],v[152:155]
M a[32:35],v[168:171],v[128:131]
M a[36:39],v[168:171],v[136:139]
M a[40:43],v[168:171],v[144:147]
M a[44:47],v[168:171],v[152:155]
M a[48:51],v[172:175],v[128:131]
M a[52:55],v[172:175],v[136:139]
M a[56:59],v[172:175],v[144:147]
M a[60:63],v[172:175],v[152:155]
M a[64:67],v[176:179],v[128:131]
M a[68:71],v[176:179],v[136:139]
M a[72:75],v[176:179],v[144:147]
M a[76:79],v[176:179],v[152:155]
M a[80:83],v[180:183],v[128:131]
M a[84:87],v[180:183],v[136:139]
M a[88:91],v[180:183],v[144:147]
M a[92:95],v[180:183],v[152:155]
M a[96:99],v[184:187],v[128:131]
M a[100:103],v[184:187],v[136:139]
M a[104:107],v[184:187],v[144:147]
M a[108:111],v[184:187],v[152:155]
M a[112:115],v[188:191],v[128:131]
M a[116:119],v[188:191],v[136:139]
M a[120:123],v[188:191],v[144:147]
M a[124:127],v[188:191],v[152:155]
M v[208:211],v[240:243],v[128:131]
M v[212:215],v[240:243],v[136:139]
M v[216:219],v[240:243],v[144:147]
M v[220:223],v[240:243],v[152:155]
s_nop 7
s_add_u32 s71, s71, 1
s_cmp_lt_u32 s71, 16
s_cbranch_scc1 L_slow2A
v_rcp_f32 v9, v208
v_mov_b32 v160, 0
v_mov_b32 v161, 0
v_mov_b32 v162, 0
v_mov_b32 v163, 0
v_rcp_f32 v10, v212
v_mov_b32 v168, 0
v_mov_b32 v169, 0
v_mov_b32 v170, 0
v_mov_b32 v171, 0
v_rcp_f32 v11, v216
v_mov_b32 v176, 0
v_mov_b32 v177, 0
v_mov_b32 v178, 0
v_mov_b32 v179, 0
v_rcp_f32 v12, v220
v_mov_b32 v184, 0
v_mov_b32 v185, 0
v_mov_b32 v186, 0
v_mov_b32 v187, 0
s_nop 1
s_branch L_normA
SPIN_hA:
s_mov_b32 s3, 262144
SPINL_hA:
buffer_load_dword v62, v14, s[12:15], s6 offen sc1
s_waitcnt vmcnt(0)
v_subrev_u32 v62, s74, v62
v_cmp_le_u32 vcc, 14, v62
s_cbranch_vccz BACK_hA
s_sub_u32 s3, s3, 1
s_cmp_lg_u32 s3, 0
s_cbranch_scc1 SPINL_hA
s_branch BACK_hA
SPIN_nA:
s_mov_b32 s3, 262144
SPINL_nA:
buffer_load_dword v62, v14, s[12:15], s6 offen sc1
s_waitcnt vmcnt(0)
v_subrev_u32 v62, s73, v62
v_cmp_le_u32 vcc, 12, v62
s_cbranch_vccz BACK_nA
s_sub_u32 s3, s3, 1
s_cmp_lg_u32 s3, 0
s_cbranch_scc1 SPINL_nA
s_branch BACK_nA
SPIN_xA:
s_mov_b32 s3, 262144
SPINL_xA:
buffer_load_dword v62, v15, s[12:15], s72 offen sc1
s_waitcnt vmcnt(0)
v_subrev_u32 v62, s75, v62
v_cmp_le_u32 vcc, 13, v62
s_cbranch_vccz BACK_xA
s_sub_u32 s3, s3, 1
s_cmp_lg_u32 s3, 0
s_cbranch_scc1 SPINL_xA
s_branch BACK_xA
.globl recurrent_scan__sliding_block_cached__dense_activation_gelu__prompt_kernel
.p2align 12
.type recurrent_scan__sliding_block_cached__dense_activation_gelu__prompt_kernel,@function
recurrent_scan__sliding_block_cached__dense_activation_gelu__prompt_kernel:
s_cmp_lt_u32 s2, 256
s_cbranch_scc1 L_go
s_endpgm
L_go:
s_getpc_b64 s[76:77]
L_pc:
s_load_dwordx2 s[36:37], s[0:1], 0
s_load_dwordx2 s[12:13], s[0:1], 96
s_load_dwordx2 s[4:5], s[0:1], 24
s_load_dwordx2 s[8:9], s[0:1], 48
s_load_dwordx2 s[44:45], s[0:1], 88
s_load_dwordx2 s[16:17], s[0:1], 56
s_load_dwordx2 s[20:21], s[0:1], 8
s_load_dwordx2 s[24:25], s[0:1], 16
s_load_dwordx2 s[28:29], s[0:1], 32
s_load_dwordx2 s[32:33], s[0:1], 64
s_load_dwordx2 s[40:41], s[0:1], 80
s_load_dwordx2 s[48:49], s[0:1], 72
v_lshrrev_b32 v1, 6, v0
v_and_b32 v0, 63, v0
v_readfirstlane_b32 s52, v1
s_bitcmp1_b32 s2, 0
s_cselect_b32 s71, L_pc-L_forkA, 0
s_sub_u32 s76, s76, s71
s_subb_u32 s77, s77, 0
s_lshr_b32 s71, s2, 1
s_and_b32 s71, s71, 124
s_add_u32 s71, s71, s52
s_lshl_b32 s71, s71, 10
v_lshrrev_b32 v57, 3, v0
v_lshl_add_u32 v57, v57, 7, s71
v_min_u32 v57, L_code_end-L_pc-4, v57
global_load_dword v97, v57, s[76:77]
s_and_b32 s70, s2, 7
s_lshr_b32 s71, s2, 3
s_and_b32 s53, s70, 4
s_and_b32 s55, s70, 3
s_and_b32 s72, s71, 3
s_add_u32 s53, s53, s72
s_lshr_b32 s56, s71, 2
s_lshl_b32 s54, s55, 3
s_add_u32 s54, s54, s56
s_lshl_b32 s57, s53, 2
s_add_u32 s57, s57, s52
s_lshl_b32 s58, s52, 12
v_and_b32 v40, 7, v0
v_lshrrev_b32 v41, 3, v0
v_xor_b32 v43, v40, v41
v_lshlrev_b32 v43, 4, v43
v_lshl_add_u32 v42, v41, 11, v43
s_lshl_b32 s70, s53, 19
s_lshl_b32 s71, s54, 14
s_add_u32 s70, s70, s71
s_lshl_b32 s71, s52, 9
s_add_u32 s70, s70, s71
s_lshl_b32 s65, s53, 12
s_add_u32 s65, s65, 4194304
v_lshrrev_b32 v44, 4, v0
v_and_b32 v45, 15, v0
s_lshl_b32 s71, s52, 4
v_add_u32 v46, s71, v44
s_lshl_b32 s72, s54, 8
s_and_b32 s75, s54, 1
s_mul_i32 s73, s54, 224
s_lshl_b32 s74, s75, 5
s_sub_u32 s73, s73, s74
v_mul_u32_u24 v51, 7168, v46
v_or_b32 v47, 0, v44
v_lshlrev_b32 v47, 1, v47
v_xor_b32 v47, v45, v47
v_lshlrev_b32 v47, 4, v47
v_lshl_add_u32 v48, v46, 13, v47
v_add_u32 v48, s72, v48
v_add3_u32 v50, v47, v51, s73
v_add_u32 v64, 0, v48
v_add_u32 v68, 0, v50
v_add_u32 v65, 31744, v48
v_add_u32 v69, 27648, v50
v_or_b32 v47, 4, v44
v_lshlrev_b32 v47, 1, v47
v_xor_b32 v47, v45, v47
v_lshlrev_b32 v47, 4, v47
v_lshl_add_u32 v48, v46, 13, v47
v_add_u32 v48, s72, v48
v_add3_u32 v50, v47, v51, s73
v_add_u32 v66, 63488, v48
v_add_u32 v70, 55296, v50
v_add_u32 v67, 95232, v48
v_add_u32 v71, 82944, v50
s_mov_b32 s66, 0
s_mov_b32 s67, 0
v_xor_b32 v47, v40, v44
v_lshlrev_b32 v47, 4, v47
v_lshl_add_u32 v100, v41, 11, v47
v_xor_b32 v48, 64, v100
v_add_u32 v101, 15360, v48
v_add_u32 v102, 30720, v100
v_add_u32 v103, 46080, v48
s_lshl_b32 s63, s57, 17
s_lshl_b32 s71, s75, 16
s_add_u32 s78, s63, s71
s_xor_b32 s79, s78, 65536
s_add_u32 s63, s63, 24576
s_mov_b32 s38, 4194304
s_mov_b32 s39, 0x20000
s_mov_b32 s14, 268435456
s_mov_b32 s15, 0x20000
s_mov_b32 s6, 8388608
s_mov_b32 s7, 0x20000
s_mov_b32 s10, 7340032
s_mov_b32 s11, 0x20000
s_mov_b32 s46, 256
s_mov_b32 s47, 0x20000
s_mov_b32 s18, 7168
s_mov_b32 s19, 0x20000
s_or_b32 s71, s54, s52
s_add_u32 m0, s58, 131072
s_waitcnt lgkmcnt(0)
s_and_b32 s37, s37, 0xffff
s_and_b32 s13, s13, 0xffff
s_cmp_lg_u32 s71, 0
s_cbranch_scc1 L_nolead
v_and_b32 v52, 31, v0
v_lshlrev_b32 v52, 7, v52
buffer_load_dword v122, v52, s[12:15], s65 offen sc1
L_nolead:
buffer_load_dwordx4 v42, s[36:39], s70 offen offset:0 lds
s_add_u32 m0, s58, 131968
s_and_b32 s5, s5, 0xffff
buffer_load_dwordx4 v42, s[36:39], s70 offen offset:128 lds
s_add_u32 m0, s58, 132864
s_and_b32 s9, s9, 0xffff
buffer_load_dwordx4 v42, s[36:39], s70 offen offset:256 lds
s_add_u32 m0, s58, 133760
s_and_b32 s45, s45, 0xffff
buffer_load_dwordx4 v42, s[36:39], s70 offen offset:384 lds
s_and_b32 s17, s17, 0xffff
s_add_u32 m0, s58, 0
s_nop 0
buffer_load_dwordx4 v64, s[4:7], s66 offen offset:0 lds
buffer_load_dwordx4 v65, s[4:7], s66 offen offset:1024 lds
buffer_load_dwordx4 v66, s[4:7], s66 offen offset:2048 lds
buffer_load_dwordx4 v67, s[4:7], s66 offen offset:3072 lds
s_add_u32 s66, s66, 524288
s_add_u32 m0, s58, 16384
s_nop 0
buffer_load_dwordx4 v68, s[8:11], s67 offen offset:0 lds
buffer_load_dwordx4 v69, s[8:11], s67 offen offset:1024 lds
buffer_load_dwordx4 v70, s[8:11], s67 offen offset:2048 lds
buffer_load_dwordx4 v71, s[8:11], s67 offen offset:3072 lds
s_add_u32 s67, s67, 458752
v_lshlrev_b32 v14, 7, v40
v_lshlrev_b32 v63, 3, v44
v_bfe_u32 v47, v0, 1, 3
v_xor_b32 v47, v47, v44
v_lshlrev_b32 v47, 4, v47
v_lshl_add_u32 v47, v45, 7, v47
s_add_u32 s71, s58, 65536
v_add_u32 v126, s71, v47
v_xor_b32 v127, 64, v126
v_lshlrev_b32 v47, 1, v44
v_xor_b32 v47, v47, v0
v_lshlrev_b32 v47, 4, v47
v_add_u32 v120, s58, v47
v_xor_b32 v121, 128, v120
s_lshl_b32 s70, s52, 6
v_add_u32 v98, s70, v0
v_and_b32 v96, 127, v98
v_lshlrev_b32 v96, 1, v96
v_bfe_u32 v52, v0, 2, 2
v_lshl_add_u32 v46, v44, 3, v52
v_lshlrev_b32 v46, 8, v46
v_and_b32 v47, 3, v0
v_and_b32 v48, 1, v44
v_lshl_or_b32 v48, v48, 2, v52
v_lshl_add_u32 v49, v47, 3, v46
v_lshlrev_b32 v51, 1, v48
v_xor_b32 v51, v51, v47
s_lshl_b32 s70, s75, 1
s_add_u32 s71, s70, 0
v_xor_b32 v50, s71, v48
v_lshl_add_u32 v80, v50, 5, v49
s_add_u32 s71, s70, 1
v_xor_b32 v50, s71, v48
v_lshl_add_u32 v81, v50, 5, v49
s_add_u32 s71, s70, 2
v_xor_b32 v50, s71, v48
v_lshl_add_u32 v82, v50, 5, v49
s_add_u32 s71, s70, 3
v_xor_b32 v50, s71, v48
v_lshl_add_u32 v83, v50, 5, v49
s_add_u32 s71, s70, 4
v_xor_b32 v50, s71, v48
v_lshl_add_u32 v84, v50, 5, v49
s_add_u32 s71, s70, 5
v_xor_b32 v50, s71, v48
v_lshl_add_u32 v85, v50, 5, v49
s_add_u32 s71, s70, 6
s_and_b32 s71, s71, 7
v_xor_b32 v50, s71, v48
v_lshl_add_u32 v86, v50, 5, v49
s_add_u32 s71, s70, 7
s_and_b32 s71, s71, 7
v_xor_b32 v50, s71, v48
v_lshl_add_u32 v87, v50, 5, v49
v_xor_b32 v50, 0, v51
v_lshl_add_u32 v72, v50, 4, v46
v_xor_b32 v50, 4, v51
v_lshl_add_u32 v73, v50, 4, v46
v_xor_b32 v50, 8, v51
v_lshl_add_u32 v74, v50, 4, v46
v_xor_b32 v50, 12, v51
v_lshl_add_u32 v75, v50, 4, v46
v_or_b32 v47, s52, v0
v_min_u32 v47, 1, v47
v_lshlrev_b32 v60, 31, v47
s_lshl_b32 s71, s52, 10
s_add_u32 s71, s71, s65
s_lshl_b32 s72, s54, 7
s_add_u32 s65, s65, s72
s_add_u32 s70, s58, 131072
v_add3_u32 v43, v43, v14, s70
v_and_b32 v51, 3, v41
v_lshlrev_b32 v52, 5, v40
s_add_u32 s70, s70, 16384
v_add_u32 v53, s70, v52
s_lshl_b32 s70, s52, 3
s_add_u32 s70, s70, 147456
v_lshl_add_u32 v52, v51, 12, v52
v_add_u32 v52, s70, v52
s_lshl_b32 s70, s53, 2
s_add_u32 s70, s70, s55
s_lshl_b32 s70, s70, 17
s_lshl_b32 s74, s52, 15
s_add_u32 s70, s70, s74
s_bfe_u32 s74, s54, 0x20001
s_lshl_b32 s74, s74, 10
s_add_u32 s70, s70, s74
s_lshl_b32 s74, s75, 7
s_add_u32 s70, s70, s74
v_lshrrev_b32 v50, 2, v41
v_lshlrev_b32 v50, 12, v50
v_lshl_add_u32 v50, v51, 8, v50
v_lshl_add_u32 v50, v40, 4, v50
s_sub_u32 s74, s52, 1
s_and_b32 s74, s74, 0x80000000
v_or_b32 v49, s74, v50
s_lshl_b32 s74, s52, 30
v_lshl_add_u32 v51, v40, 2, s74
s_add_u32 s3, s65, 1048576
s_mov_b64 exec, 0
s_cmp_eq_u32 s52, 0
s_cbranch_scc1 L_pad18
s_cmp_eq_u32 s52, 1
s_cbranch_scc1 L_pad19
s_cmp_eq_u32 s52, 2
s_cbranch_scc1 L_pad20
s_branch L_pad21
L_px0:
s_bitcmp1_b32 s55, 0
s_cbranch_scc1 L_pad0
s_branch L_pad26
L_px1:
s_bitcmp1_b32 s55, 0
s_cbranch_scc1 L_pad1
s_branch L_pad27
L_px2:
s_bitcmp1_b32 s55, 0
s_cbranch_scc1 L_pad2
s_branch L_pad28
L_px3:
s_bitcmp1_b32 s55, 0
s_cbranch_scc1 L_pad3
s_branch L_pad29
L_pb0:
s_mov_b64 exec, -1
s_waitcnt vmcnt(8)
ds_read_b128 v[128:131], v43 offset:0
ds_read_b128 v[132:135], v43 offset:1024
ds_read_b128 v[136:139], v43 offset:2048
ds_read_b128 v[140:143], v43 offset:3072
s_or_b32 s74, s54, s52
s_cmp_eq_u32 s74, 0
s_cbranch_scc1 L_lead2
L_lead3:
s_add_u32 m0, s58, 65536
s_nop 0
buffer_load_dwordx4 v100, s[36:39], s78 offen offset:0 lds
buffer_load_dwordx4 v101, s[36:39], s78 offen offset:1024 lds
buffer_load_dwordx4 v102, s[36:39], s78 offen offset:2048 lds
s_waitcnt lgkmcnt(3)
v_lshlrev_b32 v144, 16, v128
v_and_b32 v145, 0xffff0000, v128
v_lshlrev_b32 v146, 16, v129
v_and_b32 v147, 0xffff0000, v129
buffer_load_dwordx4 v103, s[36:39], s78 offen offset:3072 lds
v_lshlrev_b32 v148, 16, v130
v_and_b32 v149, 0xffff0000, v130
v_lshlrev_b32 v150, 16, v131
v_and_b32 v151, 0xffff0000, v131
s_add_u32 m0, s58, 81920
s_nop 0
buffer_load_dwordx4 v100, s[36:39], s79 offen offset:0 lds
v_pk_add_f32 v[44:45], v[144:145], v[146:147]
v_pk_add_f32 v[46:47], v[148:149], v[150:151]
s_waitcnt lgkmcnt(2)
v_lshlrev_b32 v152, 16, v132
v_and_b32 v153, 0xffff0000, v132
buffer_load_dwordx4 v101, s[36:39], s79 offen offset:1024 lds
v_lshlrev_b32 v154, 16, v133
v_and_b32 v155, 0xffff0000, v133
v_lshlrev_b32 v156, 16, v134
v_and_b32 v157, 0xffff0000, v134
buffer_load_dwordx4 v102, s[36:39], s79 offen offset:2048 lds
v_lshlrev_b32 v158, 16, v135
v_and_b32 v159, 0xffff0000, v135
v_pk_add_f32 v[44:45], v[44:45], v[152:153]
v_pk_add_f32 v[44:45], v[44:45], v[154:155]
buffer_load_dwordx4 v103, s[36:39], s79 offen offset:3072 lds
v_pk_add_f32 v[46:47], v[46:47], v[156:157]
v_pk_add_f32 v[46:47], v[46:47], v[158:159]
s_waitcnt lgkmcnt(1)
v_lshlrev_b32 v160, 16, v136
v_and_b32 v161, 0xffff0000, v136
v_lshlrev_b32 v162, 16, v137
v_and_b32 v163, 0xffff0000, v137
v_lshlrev_b32 v164, 16, v138
v_and_b32 v165, 0xffff0000, v138
s_add_u32 m0, s58, 32768
s_nop 0
buffer_load_dwordx4 v64, s[4:7], s66 offen offset:0 lds
v_lshlrev_b32 v166, 16, v139
v_and_b32 v167, 0xffff0000, v139
v_pk_add_f32 v[44:45], v[44:45], v[160:161]
v_pk_add_f32 v[44:45], v[44:45], v[162:163]
v_pk_add_f32 v[46:47], v[46:47], v[164:165]
v_pk_add_f32 v[46:47], v[46:47], v[166:167]
s_waitcnt lgkmcnt(0)
v_lshlrev_b32 v168, 16, v140
v_and_b32 v169, 0xffff0000, v140
buffer_load_dwordx4 v65, s[4:7], s66 offen offset:1024 lds
v_lshlrev_b32 v170, 16, v141
v_and_b32 v171, 0xffff0000, v141
v_lshlrev_b32 v172, 16, v142
v_and_b32 v173, 0xffff0000, v142
v_lshlrev_b32 v174, 16, v143
v_and_b32 v175, 0xffff0000, v143
v_pk_add_f32 v[44:45], v[44:45], v[168:169]
v_pk_add_f32 v[44:45], v[44:45], v[170:171]
buffer_load_dwordx4 v66, s[4:7], s66 offen offset:2048 lds
v_pk_add_f32 v[46:47], v[46:47], v[172:173]
v_pk_add_f32 v[46:47], v[46:47], v[174:175]
v_pk_add_f32 v[44:45], v[44:45], v[46:47]
v_add_f32 v54, v44, v45
s_nop 1
v_add_f32_dpp v54, v54, v54 row_ror:8 row_mask:0xf bank_mask:0xf
v_mov_b32 v46, v54
s_nop 1
v_permlane32_swap_b32 v54, v46
v_add_f32 v54, v54, v46
buffer_load_dwordx4 v67, s[4:7], s66 offen offset:3072 lds
s_add_u32 s66, s66, 524288
v_mov_b32 v46, v54
s_nop 1
v_permlane16_swap_b32 v54, v46
v_add_f32 v54, v54, v46
v_mul_f32 v54, 0x3b800000, v54
v_pk_add_f32 v[128:129], v[144:145], v[54:55] op_sel:[0,0] op_sel_hi:[1,0] neg_lo:[0,1] neg_hi:[0,1]
v_pk_mul_f32 v[44:45], v[128:129], v[128:129]
v_pk_add_f32 v[130:131], v[146:147], v[54:55] op_sel:[0,0] op_sel_hi:[1,0] neg_lo:[0,1] neg_hi:[0,1]
v_pk_mul_f32 v[46:47], v[130:131], v[130:131]
s_add_u32 m0, s58, 49152
s_nop 0
buffer_load_dwordx4 v68, s[8:11], s67 offen offset:0 lds
v_pk_add_f32 v[132:133], v[148:149], v[54:55] op_sel:[0,0] op_sel_hi:[1,0] neg_lo:[0,1] neg_hi:[0,1]
v_pk_fma_f32 v[44:45], v[132:133], v[132:133], v[44:45]
v_pk_add_f32 v[134:135], v[150:151], v[54:55] op_sel:[0,0] op_sel_hi:[1,0] neg_lo:[0,1] neg_hi:[0,1]
v_pk_fma_f32 v[46:47], v[134:135], v[134:135], v[46:47]
v_pk_add_f32 v[128:129], v[152:153], v[54:55] op_sel:[0,0] op_sel_hi:[1,0] neg_lo:[0,1] neg_hi:[0,1]
v_pk_fma_f32 v[44:45], v[128:129], v[128:129], v[44:45]
v_pk_add_f32 v[130:131], v[154:155], v[54:55] op_sel:[0,0] op_sel_hi:[1,0] neg_lo:[0,1] neg_hi:[0,1]
v_pk_fma_f32 v[46:47], v[130:131], v[130:131], v[46:47]
buffer_load_dwordx4 v69, s[8:11], s67 offen offset:1024 lds
v_pk_add_f32 v[132:133], v[156:157], v[54:55] op_sel:[0,0] op_sel_hi:[1,0] neg_lo:[0,1] neg_hi:[0,1]
v_pk_fma_f32 v[44:45], v[132:133], v[132:133], v[44:45]
v_pk_add_f32 v[134:135], v[158:159], v[54:55] op_sel:[0,0] op_sel_hi:[1,0] neg_lo:[0,1] neg_hi:[0,1]
v_pk_fma_f32 v[46:47], v[134:135], v[134:135], v[46:47]
v_pk_add_f32 v[128:129], v[160:161], v[54:55] op_sel:[0,0] op_sel_hi:[1,0] neg_lo:[0,1] neg_hi:[0,1]
v_pk_fma_f32 v[44:45], v[128:129], v[128:129], v[44:45]
v_pk_add_f32 v[130:131], v[162:163], v[54:55] op_sel:[0,0] op_sel_hi:[1,0] neg_lo:[0,1] neg_hi:[0,1]
v_pk_fma_f32 v[46:47], v[130:131], v[130:131], v[46:47]
buffer_load_dwordx4 v70, s[8:11], s67 offen offset:2048 lds
v_pk_add_f32 v[132:133], v[164:165], v[54:55] op_sel:[0,0] op_sel_hi:[1,0] neg_lo:[0,1] neg_hi:[0,1]
v_pk_fma_f32 v[44:45], v[132:133], v[132:133], v[44:45]
v_pk_add_f32 v[134:135], v[166:167], v[54:55] op_sel:[0,0] op_sel_hi:[1,0] neg_lo:[0,1] neg_hi:[0,1]
v_pk_fma_f32 v[46:47], v[134:135], v[134:135], v[46:47]
v_pk_add_f32 v[128:129], v[168:169], v[54:55] op_sel:[0,0] op_sel_hi:[1,0] neg_lo:[0,1] neg_hi:[0,1]
v_pk_fma_f32 v[44:45], v[128:129], v[128:129], v[44:45]
v_pk_add_f32 v[130:131], v[170:171], v[54:55] op_sel:[0,0] op_sel_hi:[1,0] neg_lo:[0,1] neg_hi:[0,1]
v_pk_fma_f32 v[46:47], v[130:131], v[130:131], v[46:47]
buffer_load_dwordx4 v71, s[8:11], s67 offen offset:3072 lds
s_add_u32 s67, s67, 458752
v_pk_add_f32 v[132:133], v[172:173], v[54:55] op_sel:[0,0] op_sel_hi:[1,0] neg_lo:[0,1] neg_hi:[0,1]
v_pk_fma_f32 v[44:45], v[132:133], v[132:133], v[44:45]
v_pk_add_f32 v[134:135], v[174:175], v[54:55] op_sel:[0,0] op_sel_hi:[1,0] neg_lo:[0,1] neg_hi:[0,1]
v_pk_fma_f32 v[46:47], v[134:135], v[134:135], v[46:47]
v_pk_add_f32 v[44:45], v[44:45], v[46:47]
v_add_f32 v55, v44, v45
s_nop 1
v_add_f32_dpp v55, v55, v55 row_ror:8 row_mask:0xf bank_mask:0xf
v_mov_b32 v46, v55
s_nop 1
v_permlane32_swap_b32 v55, v46
v_add_f32 v55, v55, v46
v_mov_b32 v46, v55
s_nop 1
v_permlane16_swap_b32 v55, v46
v_add_f32 v55, v55, v46
ds_write_b64 v52, v[54:55]
s_waitcnt lgkmcnt(0)
s_barrier
ds_read_b128 v[176:179], v53
ds_read_b128 v[180:183], v53 offset:16
buffer_load_ushort v96, v96, s[16:19], s73 offen
s_waitcnt lgkmcnt(0)
v_pk_add_f32 v[44:45], v[176:177], v[178:179]
v_pk_add_f32 v[46:47], v[180:181], v[182:183]
v_pk_add_f32 v[44:45], v[44:45], v[46:47]
v_mul_f32 v44, 0x3e800000, v44
v_cvt_pk_bf16_f32 v54, v44, v44
v_and_b32 v54, 0xffff0000, v54
v_pk_add_f32 v[144:145], v[144:145], v[54:55] op_sel:[0,0] op_sel_hi:[1,0] neg_lo:[0,1] neg_hi:[0,1]
v_pk_add_f32 v[146:147], v[146:147], v[54:55] op_sel:[0,0] op_sel_hi:[1,0] neg_lo:[0,1] neg_hi:[0,1]
v_pk_add_f32 v[148:149], v[148:149], v[54:55] op_sel:[0,0] op_sel_hi:[1,0] neg_lo:[0,1] neg_hi:[0,1]
v_pk_add_f32 v[150:151], v[150:151], v[54:55] op_sel:[0,0] op_sel_hi:[1,0] neg_lo:[0,1] neg_hi:[0,1]
v_cvt_pk_bf16_f32 v128, v144, v145
v_cvt_pk_bf16_f32 v129, v146, v147
v_cvt_pk_bf16_f32 v130, v148, v149
v_cvt_pk_bf16_f32 v131, v150, v151
buffer_store_dwordx4 v[128:131], v49, s[12:15], s70 offen sc1
s_add_u32 s70, s70, 8192
v_pk_add_f32 v[152:153], v[152:153], v[54:55] op_sel:[0,0] op_sel_hi:[1,0] neg_lo:[0,1] neg_hi:[0,1]
v_pk_add_f32 v[154:155], v[154:155], v[54:55] op_sel:[0,0] op_sel_hi:[1,0] neg_lo:[0,1] neg_hi:[0,1]
v_pk_add_f32 v[156:157], v[156:157], v[54:55] op_sel:[0,0] op_sel_hi:[1,0] neg_lo:[0,1] neg_hi:[0,1]
v_pk_add_f32 v[158:159], v[158:159], v[54:55] op_sel:[0,0] op_sel_hi:[1,0] neg_lo:[0,1] neg_hi:[0,1]
v_cvt_pk_bf16_f32 v132, v152, v153
v_cvt_pk_bf16_f32 v133, v154, v155
v_cvt_pk_bf16_f32 v134, v156, v157
v_cvt_pk_bf16_f32 v135, v158, v159
buffer_store_dwordx4 v[132:135], v49, s[12:15], s70 offen sc1
s_add_u32 s70, s70, 8192
v_pk_add_f32 v[160:161], v[160:161], v[54:55] op_sel:[0,0] op_sel_hi:[1,0] neg_lo:[0,1] neg_hi:[0,1]
v_pk_add_f32 v[162:163], v[162:163], v[54:55] op_sel:[0,0] op_sel_hi:[1,0] neg_lo:[0,1] neg_hi:[0,1]
v_pk_add_f32 v[164:165], v[164:165], v[54:55] op_sel:[0,0] op_sel_hi:[1,0] neg_lo:[0,1] neg_hi:[0,1]
v_pk_add_f32 v[166:167], v[166:167], v[54:55] op_sel:[0,0] op_sel_hi:[1,0] neg_lo:[0,1] neg_hi:[0,1]
v_cvt_pk_bf16_f32 v136, v160, v161
v_cvt_pk_bf16_f32 v137, v162, v163
v_cvt_pk_bf16_f32 v138, v164, v165
v_cvt_pk_bf16_f32 v139, v166, v167
buffer_store_dwordx4 v[136:139], v49, s[12:15], s70 offen sc1
s_add_u32 s70, s70, 8192
v_pk_add_f32 v[168:169], v[168:169], v[54:55] op_sel:[0,0] op_sel_hi:[1,0] neg_lo:[0,1] neg_hi:[0,1]
v_pk_add_f32 v[170:171], v[170:171], v[54:55] op_sel:[0,0] op_sel_hi:[1,0] neg_lo:[0,1] neg_hi:[0,1]
v_pk_add_f32 v[172:173], v[172:173], v[54:55] op_sel:[0,0] op_sel_hi:[1,0] neg_lo:[0,1] neg_hi:[0,1]
v_pk_add_f32 v[174:175], v[174:175], v[54:55] op_sel:[0,0] op_sel_hi:[1,0] neg_lo:[0,1] neg_hi:[0,1]
v_cvt_pk_bf16_f32 v140, v168, v169
v_cvt_pk_bf16_f32 v141, v170, v171
v_cvt_pk_bf16_f32 v142, v172, v173
v_cvt_pk_bf16_f32 v143, v174, v175
buffer_store_dwordx4 v[140:143], v50, s[12:15], s70 offen sc1
v_mul_f32 v45, 0x3b800000, v45
v_sub_f32 v176, v176, v44
v_sub_f32 v178, v178, v44
v_sub_f32 v180, v180, v44
v_sub_f32 v182, v182, v44
v_fmac_f32 v45, v176, v176
v_fmac_f32 v45, v178, v178
v_fmac_f32 v45, v180, v180
v_fmac_f32 v45, v182, v182
v_mul_f32 v45, 0x3e800000, v45
v_cvt_pk_bf16_f32 v45, v45, v45
v_and_b32 v45, 0xffff0000, v45
v_add_f32 v45, 0x3727c5ac, v45
v_cvt_pk_bf16_f32 v45, v45, v45
v_and_b32 v45, 0xffff0000, v45
v_sqrt_f32 v45, v45
s_lshl_b32 s74, s53, 5
v_cvt_pk_bf16_f32 v44, -v44, v45
v_mov_b32 v123, s74
buffer_store_dword v44, v51, s[12:15], s3 offen sc1
buffer_load_dword v122, v123, s[44:47], 0 offen sc1
s_waitcnt vmcnt(15)
ds_read_b128 a[160:163], v126 offset:0
ds_read_b128 a[176:179], v127 offset:0
ds_read_b128 a[164:167], v126 offset:2048
ds_read_b128 a[180:183], v127 offset:2048
ds_read_b128 a[168:171], v126 offset:16384
ds_read_b128 a[184:187], v127 offset:16384
ds_read_b128 a[172:175], v126 offset:18432
ds_read_b128 a[188:191], v127 offset:18432
s_waitcnt vmcnt(23)
s_barrier
T a[128:129],v72,0
T a[130:131],v72,1024
T a[132:133],v72,8192
T a[134:135],v72,9216
T a[136:137],v72,8
T a[138:139],v72,1032
T a[140:141],v72,8200
T a[142:143],v72,9224
T a[144:145],v73,0
T a[146:147],v73,1024
T a[148:149],v73,8192
T a[150:151],v73,9216
s_waitcnt lgkmcnt(12)
s_waitcnt lgkmcnt(8)
N a[0:3],a[128:131],a[160:163],0
T a[152:153],v73,8
s_lshr_b32 s72, s2, 3
M a[0:3],a[132:135],a[176:179]
s_add_u32 m0, s58, 98176
T a[154:155],v73,1032
v_lshlrev_b32 v13, 4, v0
N a[4:7],a[132:135],a[180:183],0
s_lshl_b32 s72, s72, 2
buffer_load_dwordx4 v100, s[36:39], s78 offen offset:128 lds
s_add_u32 s72, s72, s52
M a[4:7],a[128:131],a[164:167]
s_lshl_b32 s70, s75, 11
s_lshl_b32 s72, s72, 4
s_add_u32 s72, s72, 4096
N a[8:11],a[128:131],a[168:171],0
T a[156:157],v73,8200
v_add_u32 v58, s70, v13
M a[8:11],a[132:135],a[184:187]
T a[158:159],v73,9224
v_lshrrev_b32 v125, 2, v0
N a[12:15],a[132:135],a[188:191],0
buffer_load_dwordx4 v101, s[36:39], s78 offen offset:1152 lds
v_add_u32 v125, s72, v125
M a[12:15],a[128:131],a[172:175]
s_waitcnt lgkmcnt(8)
v_xor_b32 v59, 2048, v58
v_and_b32 v97, 15, v125
N a[28:31],a[140:143],a[188:191],0
s_lshl_b32 s68, s55, 11
T a[128:129],v74,0
v_lshrrev_b32 v125, 4, v125
M a[28:31],a[136:139],a[172:175]
s_mul_i32 s69, s55, 1792
T a[130:131],v74,1024
v_add_u32 v88, 0x10000, v80
N a[24:27],a[136:139],a[168:171],0
v_mul_u32_u24 v56, 7168, v125
v_lshlrev_b32 v125, 13, v125
M a[24:27],a[140:143],a[184:187]
v_add_u32 v89, 0x10000, v81
v_lshl_add_u32 v125, v97, 7, v125
N a[20:23],a[140:143],a[180:183],0
T a[132:133],v74,8192
v_min_u32 v97, 13, v97
M a[20:23],a[136:139],a[164:167]
T a[134:135],v74,9216
v_add_u32 v90, 0x10000, v82
N a[16:19],a[136:139],a[160:163],0
buffer_load_dwordx4 v102, s[36:39], s78 offen offset:2176 lds
v_lshl_add_u32 v56, v97, 7, v56
M a[16:19],a[140:143],a[176:179]
s_waitcnt lgkmcnt(8)
v_add_u32 v91, 0x10000, v83
v_add_u32 v92, 0x10000, v84
N a[32:35],a[144:147],a[160:163],0
T a[136:137],v74,8
v_add_u32 v93, 0x10000, v85
M a[32:35],a[148:151],a[176:179]
T a[138:139],v74,1032
v_add_u32 v94, 0x10000, v86
N a[36:39],a[148:151],a[180:183],0
buffer_load_dwordx4 v103, s[36:39], s78 offen offset:3200 lds
v_add_u32 v95, 0x10000, v87
M a[36:39],a[144:147],a[164:167]
v_add_u32 v76, 0x10000, v72
v_add_u32 v77, 0x10000, v73
N a[40:43],a[144:147],a[168:171],0
T a[140:141],v74,8200
v_add_u32 v78, 0x10000, v74
M a[40:43],a[148:151],a[184:187]
T a[142:143],v74,9224
v_add_u32 v79, 0x10000, v75
N a[44:47],a[148:151],a[188:191],0
ds_read_b128 v[240:243], v120 offset:0
ds_read_b128 v[244:247], v120 offset:1024
M a[44:47],a[144:147],a[172:175]
s_waitcnt lgkmcnt(10)
N a[60:63],a[156:159],a[188:191],0
T a[144:145],v75,0
M a[60:63],a[152:155],a[172:175]
s_add_u32 m0, s58, 114560
T a[146:147],v75,1024
N a[56:59],a[152:155],a[168:171],0
buffer_load_dwordx4 v100, s[36:39], s79 offen offset:128 lds
M a[56:59],a[156:159],a[184:187]
N a[52:55],a[156:159],a[180:183],0
T a[148:149],v75,8192
M a[52:55],a[152:155],a[164:167]
T a[150:151],v75,9216
N a[48:51],a[152:155],a[160:163],0
buffer_load_dwordx4 v101, s[36:39], s79 offen offset:1152 lds
M a[48:51],a[156:159],a[176:179]
s_waitcnt lgkmcnt(10)
N a[64:67],a[128:131],a[160:163],0
T a[152:153],v75,8
M a[64:67],a[132:135],a[176:179]
T a[154:155],v75,1032
N a[68:71],a[132:135],a[180:183],0
s_waitcnt lgkmcnt(7)
v_lshlrev_b32 v104, 16, v240
v_and_b32 v105, 0xffff0000, v240
M a[68:71],a[128:131],a[164:167]
v_lshlrev_b32 v106, 16, v241
v_and_b32 v107, 0xffff0000, v241
N a[72:75],a[128:131],a[168:171],0
T a[156:157],v75,8200
v_lshlrev_b32 v108, 16, v242
M a[72:75],a[132:135],a[184:187]
T a[158:159],v75,9224
ds_read_b128 v[248:251], v121 offset:2048
N a[76:79],a[132:135],a[188:191],0
buffer_load_dwordx4 v102, s[36:39], s79 offen offset:2176 lds
v_and_b32 v109, 0xffff0000, v242
M a[76:79],a[128:131],a[172:175]
s_waitcnt lgkmcnt(11)
v_lshlrev_b32 v110, 16, v243
v_and_b32 v111, 0xffff0000, v243
N a[92:95],a[140:143],a[188:191],0
T a[128:129],v80,16384
M a[92:95],a[136:139],a[172:175]
T a[130:131],v80,17408
N a[88:91],a[136:139],a[168:171],0
buffer_load_dwordx4 v103, s[36:39], s79 offen offset:3200 lds
M a[88:91],a[140:143],a[184:187]
N a[84:87],a[140:143],a[180:183],0
T a[132:133],v80,24576
M a[84:87],a[136:139],a[164:167]
T a[134:135],v80,25600
N a[80:83],a[136:139],a[160:163],0
M a[80:83],a[140:143],a[176:179]
L_pad18:
s_cbranch_execz L_pad22
s_waitcnt lgkmcnt(9)
N a[96:99],a[144:147],a[160:163],0
T a[136:137],v81,16384
M a[96:99],a[148:151],a[176:179]
s_add_u32 m0, s58, 65536
T a[138:139],v81,17408
N a[100:103],a[148:151],a[180:183],0
buffer_load_dwordx4 v64, s[4:7], s66 offen offset:0 lds
M a[100:103],a[144:147],a[164:167]
v_lshlrev_b32 v99, 16, v244
v_and_b32 v244, 0xffff0000, v244
N a[104:107],a[144:147],a[168:171],0
T a[140:141],v81,24576
v_add_f32 v104, v104, v99
M a[104:107],a[148:151],a[184:187]
T a[142:143],v81,25600
v_add_f32 v105, v105, v244
N a[108:111],a[148:151],a[188:191],0
buffer_load_dwordx4 v65, s[4:7], s66 offen offset:1024 lds
ds_read_b128 v[252:255], v121 offset:3072
M a[108:111],a[144:147],a[172:175]
s_waitcnt lgkmcnt(10)
v_lshlrev_b32 v99, 16, v245
v_and_b32 v245, 0xffff0000, v245
N a[124:127],a[156:159],a[188:191],0
T a[144:145],v82,16384
v_add_f32 v106, v106, v99
M a[124:127],a[152:155],a[172:175]
T a[146:147],v82,17408
v_add_f32 v107, v107, v245
N a[120:123],a[152:155],a[168:171],0
v_lshlrev_b32 v99, 16, v246
v_and_b32 v246, 0xffff0000, v246
M a[120:123],a[156:159],a[184:187]
s_waitcnt vmcnt(10)
v_cmp_eq_u32 vcc, 0, v122
v_add_f32 v108, v108, v99
N a[116:119],a[156:159],a[180:183],0
s_cbranch_vccnz SPIN_nonce
BACK_nonce:
T a[148:149],v82,24576
v_readfirstlane_b32 s64, v122
M a[116:119],a[152:155],a[164:167]
s_barrier
T a[150:151],v82,25600
s_add_u32 s74, s64, 1
N a[112:115],a[152:155],a[160:163],0
buffer_load_dwordx4 v66, s[4:7], s66 offen offset:2048 lds
v_mov_b32 v61, s74
M a[112:115],a[156:159],a[176:179]
s_waitcnt lgkmcnt(9)
v_add_f32 v109, v109, v246
v_lshlrev_b32 v99, 16, v247
N v[128:131],a[128:131],a[160:163],0
T a[152:153],v83,16384
buffer_store_dword v61, v60, s[12:15], s65 offen sc1
M v[128:131],a[132:135],a[176:179]
T a[154:155],v83,17408
v_and_b32 v247, 0xffff0000, v247
N v[132:135],a[132:135],a[180:183],0
buffer_load_dwordx4 v67, s[4:7], s66 offen offset:3072 lds
s_add_u32 s66, s66, 524288
M v[132:135],a[128:131],a[164:167]
v_add_f32 v110, v110, v99
v_add_f32 v111, v111, v247
N v[136:139],a[128:131],a[168:171],0
T a[156:157],v83,24576
v_lshlrev_b32 v99, 16, v248
M v[136:139],a[132:135],a[184:187]
s_add_u32 m0, s58, 81920
T a[158:159],v83,25600
v_and_b32 v248, 0xffff0000, v248
N v[140:143],a[132:135],a[188:191],0
buffer_load_dwordx4 v68, s[8:11], s67 offen offset:0 lds
v_add_f32 v104, v104, v99
M v[140:143],a[128:131],a[172:175]
s_waitcnt lgkmcnt(9)
ds_read_b128 v[40:43], v120 offset:16384
v_add_f32 v105, v105, v248
N v[156:159],a[140:143],a[188:191],0
T a[128:129],v84,16384
v_lshlrev_b32 v99, 16, v249
M v[156:159],a[136:139],a[172:175]
T a[130:131],v84,17408
v_and_b32 v249, 0xffff0000, v249
N v[152:155],a[136:139],a[168:171],0
v_add_f32 v106, v106, v99
v_add_f32 v107, v107, v249
M v[152:155],a[140:143],a[184:187]
v_lshlrev_b32 v99, 16, v250
v_and_b32 v250, 0xffff0000, v250
N v[148:151],a[140:143],a[180:183],0
T a[132:133],v84,24576
v_add_f32 v108, v108, v99
M v[148:151],a[136:139],a[164:167]
T a[134:135],v84,25600
v_add_f32 v109, v109, v250
N v[144:147],a[136:139],a[160:163],0
buffer_load_dwordx4 v69, s[8:11], s67 offen offset:1024 lds
v_lshlrev_b32 v99, 16, v251
M v[144:147],a[140:143],a[176:179]
s_waitcnt lgkmcnt(9)
v_and_b32 v251, 0xffff0000, v251
v_add_f32 v110, v110, v99
N v[160:163],a[144:147],a[160:163],0
T a[136:137],v85,16384
v_add_f32 v111, v111, v251
M v[160:163],a[148:151],a[176:179]
T a[138:139],v85,17408
N v[164:167],a[148:151],a[180:183],0
buffer_load_dwordx4 v70, s[8:11], s67 offen offset:2048 lds
M v[164:167],a[144:147],a[164:167]
N v[168:171],a[144:147],a[168:171],0
T a[140:141],v85,24576
M v[168:171],a[148:151],a[184:187]
T a[142:143],v85,25600
v_lshlrev_b32 v99, 16, v252
N v[172:175],a[148:151],a[188:191],0
v_and_b32 v252, 0xffff0000, v252
v_add_f32 v104, v104, v99
M v[172:175],a[144:147],a[172:175]
s_waitcnt lgkmcnt(9)
v_add_f32 v105, v105, v252
v_lshlrev_b32 v99, 16, v253
N v[188:191],a[156:159],a[188:191],0
T a[144:145],v86,16384
ds_read_b128 v[44:47], v120 offset:17408
M v[188:191],a[152:155],a[172:175]
T a[146:147],v86,17408
v_and_b32 v253, 0xffff0000, v253
N v[184:187],a[152:155],a[168:171],0
buffer_load_dwordx4 v71, s[8:11], s67 offen offset:3072 lds
s_add_u32 s67, s67, 458752
M v[184:187],a[156:159],a[184:187]
v_add_f32 v106, v106, v99
v_add_f32 v107, v107, v253
N v[180:183],a[156:159],a[180:183],0
T a[148:149],v86,24576
v_lshlrev_b32 v99, 16, v254
M v[180:183],a[152:155],a[164:167]
s_add_u32 m0, s58, 130816
T a[150:151],v86,25600
v_and_b32 v254, 0xffff0000, v254
N v[176:179],a[152:155],a[160:163],0
buffer_load_dwordx4 v100, s[36:39], s78 offen offset:256 lds
v_add_f32 v108, v108, v99
M v[176:179],a[156:159],a[176:179]
s_waitcnt lgkmcnt(9)
v_add_f32 v109, v109, v254
v_lshlrev_b32 v99, 16, v255
N v[192:195],a[128:131],a[160:163],0
T a[152:153],v87,16384
v_and_b32 v255, 0xffff0000, v255
M v[192:195],a[132:135],a[176:179]
T a[154:155],v87,17408
v_add_f32 v110, v110, v99
N v[196:199],a[132:135],a[180:183],0
v_add_f32 v111, v111, v255
M v[196:199],a[128:131],a[164:167]
s_waitcnt vmcnt(10)
ds_read_b128 a[192:195], v126 offset:32768
N v[200:203],a[128:131],a[168:171],0
T a[156:157],v87,24576
ds_read_b128 a[208:211], v127 offset:32768
M v[200:203],a[132:135],a[184:187]
T a[158:159],v87,25600
ds_read_b128 a[196:199], v126 offset:34816
N v[204:207],a[132:135],a[188:191],0
buffer_load_dwordx4 v101, s[36:39], s78 offen offset:1280 lds
ds_read_b128 a[212:215], v127 offset:34816
M v[204:207],a[128:131],a[172:175]
s_waitcnt vmcnt(26)
s_barrier
s_waitcnt lgkmcnt(13)
N v[220:223],a[140:143],a[188:191],0
T a[128:129],v72,32768
ds_read_b128 a[200:203], v126 offset:49152
M v[220:223],a[136:139],a[172:175]
T a[130:131],v72,33792
ds_read_b128 a[216:219], v127 offset:49152
N v[216:219],a[136:139],a[168:171],0
buffer_load_dwordx4 v102, s[36:39], s78 offen offset:2304 lds
ds_read_b128 a[204:207], v126 offset:51200
M v[216:219],a[140:143],a[184:187]
ds_read_b128 a[220:223], v127 offset:51200
v_add_u32 v126, 65536, v126
N v[212:215],a[140:143],a[180:183],0
T a[132:133],v72,40960
v_add_u32 v127, 65536, v127
M v[212:215],a[136:139],a[164:167]
T a[134:135],v72,41984
v_lshlrev_b32 v112, 16, v40
N v[208:211],a[136:139],a[160:163],0
v_and_b32 v113, 0xffff0000, v40
v_lshlrev_b32 v114, 16, v41
M v[208:211],a[140:143],a[176:179]
s_waitcnt lgkmcnt(14)
ds_read_b128 v[240:243], v121 offset:18432
v_and_b32 v115, 0xffff0000, v41
N v[224:227],a[144:147],a[160:163],0
T a[136:137],v72,32776
v_lshlrev_b32 v116, 16, v42
M v[224:227],a[148:151],a[176:179]
T a[138:139],v72,33800
v_and_b32 v117, 0xffff0000, v42
N v[228:231],a[148:151],a[180:183],0
T a[140:141],v72,40968
v_lshlrev_b32 v118, 16, v43
M v[228:231],a[144:147],a[164:167]
s_waitcnt lgkmcnt(14)
T a[142:143],v72,41992
v_and_b32 v119, 0xffff0000, v43
N v[236:239],a[156:159],a[180:183],0
T a[144:145],v73,32768
M v[236:239],a[152:155],a[164:167]
T a[146:147],v73,33792
N v[232:235],a[152:155],a[160:163],0
T a[148:149],v73,40960
M v[232:235],a[156:159],a[176:179]
s_waitcnt lgkmcnt(10)
T a[150:151],v73,41984
s_waitcnt lgkmcnt(9)
M a[0:3],a[128:131],a[192:195]
T a[152:153],v73,32776
v_lshlrev_b32 v99, 16, v44
M a[0:3],a[132:135],a[208:211]
T a[154:155],v73,33800
v_lshrrev_b32 v122, 5, v14
M a[4:7],a[132:135],a[212:215]
buffer_load_dwordx4 v103, s[36:39], s78 offen offset:3328 lds
v_and_b32 v44, 0xffff0000, v44
M a[4:7],a[128:131],a[196:199]
v_add_f32 v112, v112, v99
ds_read_b128 v[244:247], v121 offset:19456
M a[8:11],a[128:131],a[200:203]
T a[156:157],v73,40968
v_add_f32 v113, v113, v44
M a[8:11],a[132:135],a[216:219]
s_add_u32 m0, s58, 147200
T a[158:159],v73,41992
v_lshlrev_b32 v99, 16, v45
M a[12:15],a[132:135],a[220:223]
buffer_load_dwordx4 v100, s[36:39], s79 offen offset:256 lds
v_and_b32 v45, 0xffff0000, v45
M a[12:15],a[128:131],a[204:207]
s_waitcnt lgkmcnt(9)
v_add_f32 v114, v114, v99
v_add_f32 v115, v115, v45
M a[28:31],a[140:143],a[220:223]
T a[128:129],v74,32768
v_lshlrev_b32 v99, 16, v46
M a[28:31],a[136:139],a[204:207]
T a[130:131],v74,33792
v_and_b32 v46, 0xffff0000, v46
M a[24:27],a[136:139],a[200:203]
buffer_load_dword v97, v125, s[4:7], s68 offen
v_add_u32 v125, 1048576, v125
M a[24:27],a[140:143],a[216:219]
v_add_f32 v116, v116, v99
v_add_f32 v117, v117, v46
M a[20:23],a[140:143],a[212:215]
T a[132:133],v74,40960
v_lshlrev_b32 v99, 16, v47
M a[20:23],a[136:139],a[196:199]
T a[134:135],v74,41984
v_and_b32 v47, 0xffff0000, v47
M a[16:19],a[136:139],a[192:195]
buffer_load_dwordx4 v101, s[36:39], s79 offen offset:1280 lds
v_add_f32 v118, v118, v99
M a[16:19],a[140:143],a[208:211]
v_add_f32 v119, v119, v47
s_waitcnt lgkmcnt(9)
M a[32:35],a[144:147],a[192:195]
T a[136:137],v74,32776
v_lshlrev_b32 v99, 16, v240
M a[32:35],a[148:151],a[208:211]
T a[138:139],v74,33800
v_and_b32 v240, 0xffff0000, v240
M a[36:39],a[148:151],a[212:215]
buffer_load_dwordx4 v102, s[36:39], s79 offen offset:2304 lds
v_add_f32 v112, v112, v99
M a[36:39],a[144:147],a[196:199]
ds_read_b128 v[248:251], v120 offset:32768
v_add_f32 v113, v113, v240
M a[40:43],a[144:147],a[200:203]
T a[140:141],v74,40968
v_lshlrev_b32 v99, 16, v241
M a[40:43],a[148:151],a[216:219]
s_lshl_b32 s70, s75, 5
T a[142:143],v74,41992
v_xor_b32 v123, s70, v0
M a[44:47],a[148:151],a[220:223]
buffer_load_dword v97, v56, s[8:11], s69 offen
v_add_u32 v56, 917504, v56
M a[44:47],a[144:147],a[204:207]
s_waitcnt lgkmcnt(9)
v_lshrrev_b32 v123, 3, v123
v_lshlrev_b32 v123, 7, v123
M a[60:63],a[156:159],a[220:223]
T a[144:145],v75,32768
v_add_u32 v123, v123, v122
M a[60:63],a[152:155],a[204:207]
T a[146:147],v75,33792
v_and_b32 v241, 0xffff0000, v241
M a[56:59],a[152:155],a[200:203]
buffer_load_dwordx4 v103, s[36:39], s79 offen offset:3328 lds
v_add_f32 v114, v114, v99
M a[56:59],a[156:159],a[216:219]
s_add_u32 s70, s71, 1048576
v_add_f32 v115, v115, v241
v_lshlrev_b32 v99, 16, v242
M a[52:55],a[156:159],a[212:215]
T a[148:149],v75,40960
v_and_b32 v242, 0xffff0000, v242
M a[52:55],a[152:155],a[196:199]
s_add_u32 m0, s58, 98304
T a[150:151],v75,41984
v_add_f32 v116, v116, v99
M a[48:51],a[152:155],a[192:195]
buffer_load_dwordx4 v64, s[4:7], s66 offen offset:0 lds
v_add_f32 v117, v117, v242
M a[48:51],a[156:159],a[208:211]
s_waitcnt lgkmcnt(9)
v_lshlrev_b32 v99, 16, v243
v_and_b32 v243, 0xffff0000, v243
M a[64:67],a[128:131],a[192:195]
T a[152:153],v75,32776
buffer_load_dword v62, v14, s[12:15], s71 offen sc1
M a[64:67],a[132:135],a[208:211]
T a[154:155],v75,33800
v_add_f32 v118, v118, v99
M a[68:71],a[132:135],a[212:215]
v_add_f32 v119, v119, v243
v_lshlrev_b32 v99, 16, v244
M a[68:71],a[128:131],a[196:199]
v_and_b32 v244, 0xffff0000, v244
v_add_f32 v112, v112, v99
M a[72:75],a[128:131],a[200:203]
T a[156:157],v75,40968
ds_read_b128 v[252:255], v120 offset:33792
M a[72:75],a[132:135],a[216:219]
T a[158:159],v75,41992
v_add_f32 v113, v113, v244
M a[76:79],a[132:135],a[220:223]
buffer_load_dwordx4 v65, s[4:7], s66 offen offset:1024 lds
v_lshlrev_b32 v99, 16, v245
M a[76:79],a[128:131],a[204:207]
s_waitcnt lgkmcnt(9)
v_and_b32 v245, 0xffff0000, v245
v_add_f32 v114, v114, v99
M a[92:95],a[140:143],a[220:223]
T a[128:129],v80,49152
v_add_f32 v115, v115, v245
M a[92:95],a[136:139],a[204:207]
T a[130:131],v80,50176
v_lshlrev_b32 v99, 16, v246
M a[88:91],a[136:139],a[200:203]
buffer_load_dwordx4 v66, s[4:7], s66 offen offset:2048 lds
v_and_b32 v246, 0xffff0000, v246
M a[88:91],a[140:143],a[216:219]
v_add_f32 v116, v116, v99
v_add_f32 v117, v117, v246
M a[84:87],a[140:143],a[212:215]
T a[132:133],v80,57344
v_lshlrev_b32 v99, 16, v247
M a[84:87],a[136:139],a[196:199]
T a[134:135],v80,58368
v_and_b32 v247, 0xffff0000, v247
M a[80:83],a[136:139],a[192:195]
v_add_f32 v118, v118, v99
v_add_f32 v119, v119, v247
M a[80:83],a[140:143],a[208:211]
s_waitcnt lgkmcnt(9)
M a[96:99],a[144:147],a[192:195]
T a[136:137],v81,49152
M a[96:99],a[148:151],a[208:211]
T a[138:139],v81,50176
M a[100:103],a[148:151],a[212:215]
buffer_load_dwordx4 v67, s[4:7], s66 offen offset:3072 lds
s_add_u32 s66, s66, 524288
M a[100:103],a[144:147],a[196:199]
v_lshlrev_b32 v99, 16, v248
v_and_b32 v248, 0xffff0000, v248
M a[104:107],a[144:147],a[200:203]
T a[140:141],v81,57344
v_add_f32 v104, v104, v99
M a[104:107],a[148:151],a[216:219]
s_add_u32 m0, s58, 114688
T a[142:143],v81,58368
ds_read_b128 v[40:43], v121 offset:34816
M a[108:111],a[148:151],a[220:223]
buffer_load_dwordx4 v68, s[8:11], s67 offen offset:0 lds
v_add_f32 v105, v105, v248
M a[108:111],a[144:147],a[204:207]
s_waitcnt lgkmcnt(9)
v_lshlrev_b32 v99, 16, v249
v_and_b32 v249, 0xffff0000, v249
M a[124:127],a[156:159],a[220:223]
T a[144:145],v82,49152
v_add_f32 v106, v106, v99
M a[124:127],a[152:155],a[204:207]
T a[146:147],v82,50176
v_add_f32 v107, v107, v249
M a[120:123],a[152:155],a[200:203]
v_lshlrev_b32 v99, 16, v250
v_and_b32 v250, 0xffff0000, v250
M a[120:123],a[156:159],a[216:219]
v_add_f32 v108, v108, v99
v_add_f32 v109, v109, v250
M a[116:119],a[156:159],a[212:215]
T a[148:149],v82,57344
v_lshlrev_b32 v99, 16, v251
M a[116:119],a[152:155],a[196:199]
T a[150:151],v82,58368
v_and_b32 v251, 0xffff0000, v251
M a[112:115],a[152:155],a[192:195]
buffer_load_dwordx4 v69, s[8:11], s67 offen offset:1024 lds
v_add_f32 v110, v110, v99
M a[112:115],a[156:159],a[208:211]
v_add_f32 v111, v111, v251
s_waitcnt lgkmcnt(9)
M v[128:131],a[128:131],a[192:195]
T a[152:153],v83,49152
M v[128:131],a[132:135],a[208:211]
T a[154:155],v83,50176
M v[132:135],a[132:135],a[212:215]
buffer_load_dwordx4 v70, s[8:11], s67 offen offset:2048 lds
M v[132:135],a[128:131],a[196:199]
v_lshlrev_b32 v99, 16, v252
v_and_b32 v252, 0xffff0000, v252
M v[136:139],a[128:131],a[200:203]
T a[156:157],v83,57344
v_add_f32 v104, v104, v99
M v[136:139],a[132:135],a[216:219]
T a[158:159],v83,58368
v_add_f32 v105, v105, v252
M v[140:143],a[132:135],a[220:223]
buffer_load_dwordx4 v71, s[8:11], s67 offen offset:3072 lds
s_add_u32 s67, s67, 458752
M v[140:143],a[128:131],a[204:207]
s_waitcnt lgkmcnt(9)
ds_read_b128 v[44:47], v121 offset:35840
v_lshlrev_b32 v99, 16, v253
M v[156:159],a[140:143],a[220:223]
T a[128:129],v84,49152
v_and_b32 v253, 0xffff0000, v253
M v[156:159],a[136:139],a[204:207]
T a[130:131],v84,50176
v_add_f32 v106, v106, v99
M v[152:155],a[136:139],a[200:203]
v_add_f32 v107, v107, v253
v_lshlrev_b32 v99, 16, v254
M v[152:155],a[140:143],a[216:219]
v_and_b32 v254, 0xffff0000, v254
v_add_f32 v108, v108, v99
M v[148:151],a[140:143],a[212:215]
T a[132:133],v84,57344
v_add_f32 v109, v109, v254
M v[148:151],a[136:139],a[196:199]
T a[134:135],v84,58368
v_lshlrev_b32 v99, 16, v255
M v[144:147],a[136:139],a[192:195]
v_and_b32 v255, 0xffff0000, v255
v_add_f32 v110, v110, v99
M v[144:147],a[140:143],a[208:211]
v_add_f32 v111, v111, v255
s_waitcnt lgkmcnt(9)
M v[160:163],a[144:147],a[192:195]
T a[136:137],v85,49152
M v[160:163],a[148:151],a[208:211]
T a[138:139],v85,50176
M v[164:167],a[148:151],a[212:215]
M v[164:167],a[144:147],a[196:199]
M v[168:171],a[144:147],a[200:203]
T a[140:141],v85,57344
v_lshlrev_b32 v99, 16, v40
M v[168:171],a[148:151],a[216:219]
T a[142:143],v85,58368
v_and_b32 v40, 0xffff0000, v40
M v[172:175],a[148:151],a[220:223]
v_add_f32 v104, v104, v99
v_add_f32 v105, v105, v40
M v[172:175],a[144:147],a[204:207]
s_waitcnt lgkmcnt(9)
ds_read_b128 v[240:243], v120 offset:49152
v_lshlrev_b32 v99, 16, v41
M v[188:191],a[156:159],a[220:223]
T a[144:145],v86,49152
v_and_b32 v41, 0xffff0000, v41
M v[188:191],a[152:155],a[204:207]
T a[146:147],v86,50176
v_add_f32 v106, v106, v99
M v[184:187],a[152:155],a[200:203]
v_add_f32 v107, v107, v41
v_lshlrev_b32 v99, 16, v42
M v[184:187],a[156:159],a[216:219]
v_and_b32 v42, 0xffff0000, v42
v_add_f32 v108, v108, v99
M v[180:183],a[156:159],a[212:215]
T a[148:149],v86,57344
v_add_f32 v109, v109, v42
M v[180:183],a[152:155],a[196:199]
T a[150:151],v86,58368
v_lshlrev_b32 v99, 16, v43
M v[176:179],a[152:155],a[192:195]
s_waitcnt vmcnt(9)
ds_read_b128 a[224:227], v126 offset:0
v_and_b32 v43, 0xffff0000, v43
M v[176:179],a[156:159],a[208:211]
s_waitcnt lgkmcnt(10)
ds_read_b128 a[240:243], v127 offset:0
ds_read_b128 a[228:231], v126 offset:2048
M v[192:195],a[128:131],a[192:195]
T a[152:153],v87,49152
ds_read_b128 a[244:247], v127 offset:2048
M v[192:195],a[132:135],a[208:211]
T a[154:155],v87,50176
ds_read_b128 a[232:235], v126 offset:16384
M v[196:199],a[132:135],a[212:215]
ds_read_b128 a[248:251], v127 offset:16384
ds_read_b128 a[236:239], v126 offset:18432
M v[196:199],a[128:131],a[196:199]
ds_read_b128 a[252:255], v127 offset:18432
v_add_f32 v110, v110, v99
M v[200:203],a[128:131],a[200:203]
T a[156:157],v87,57344
v_add_f32 v111, v111, v43
M v[200:203],a[132:135],a[216:219]
T a[158:159],v87,58368
v_lshlrev_b32 v99, 16, v44
M v[204:207],a[132:135],a[220:223]
v_and_b32 v44, 0xffff0000, v44
v_add_f32 v104, v104, v99
M v[204:207],a[128:131],a[204:207]
s_waitcnt vmcnt(19)
s_barrier
s_waitcnt lgkmcnt(15)
M v[220:223],a[140:143],a[220:223]
T a[128:129],v76,0
ds_read_b128 v[244:247], v120 offset:50176
M v[220:223],a[136:139],a[204:207]
s_add_u32 m0, s58, 0
T a[130:131],v76,1024
v_add_f32 v105, v105, v44
M v[216:219],a[136:139],a[200:203]
buffer_load_dwordx4 v64, s[4:7], s66 offen offset:0 lds
v_lshlrev_b32 v99, 16, v45
M v[216:219],a[140:143],a[216:219]
v_and_b32 v45, 0xffff0000, v45
v_add_f32 v106, v106, v99
M v[212:215],a[140:143],a[212:215]
T a[132:133],v76,8192
v_add_f32 v107, v107, v45
M v[212:215],a[136:139],a[196:199]
T a[134:135],v76,9216
v_lshlrev_b32 v99, 16, v46
M v[208:211],a[136:139],a[192:195]
v_and_b32 v46, 0xffff0000, v46
v_add_f32 v108, v108, v99
M v[208:211],a[140:143],a[208:211]
s_waitcnt lgkmcnt(15)
v_add_f32 v109, v109, v46
v_lshlrev_b32 v99, 16, v47
M v[224:227],a[144:147],a[192:195]
T a[136:137],v76,8
v_and_b32 v47, 0xffff0000, v47
M v[224:227],a[148:151],a[208:211]
T a[138:139],v76,1032
v_add_f32 v110, v110, v99
M v[228:231],a[148:151],a[212:215]
s_waitcnt vmcnt(8)
T a[140:141],v76,8200
v_subrev_u32 v62, s74, v62
M v[228:231],a[144:147],a[196:199]
s_waitcnt lgkmcnt(8)
T a[142:143],v76,9224
v_cmp_le_u32 vcc, 15, v62
M v[236:239],a[156:159],a[212:215]
s_cbranch_vccnz SPIN_xc
BACK_xc:
T a[144:145],v77,0
buffer_load_dword v52, v123, s[12:15], s70 offen sc1
M v[236:239],a[152:155],a[196:199]
T a[146:147],v77,1024
v_add_f32 v111, v111, v47
M v[232:235],a[152:155],a[192:195]
T a[148:149],v77,8192
v_lshlrev_b32 v99, 16, v240
M v[232:235],a[156:159],a[208:211]
T a[150:151],v77,9216
s_waitcnt lgkmcnt(8)
M a[0:3],a[128:131],a[224:227]
T a[152:153],v77,8
v_and_b32 v240, 0xffff0000, v240
M a[0:3],a[132:135],a[240:243]
T a[154:155],v77,1032
v_add_f32 v112, v112, v99
M a[4:7],a[132:135],a[244:247]
buffer_load_dwordx4 a[160:163], v58, s[12:15], s63 offen offset:0 sc1
ds_read_b128 v[248:251], v121 offset:51200
M a[4:7],a[128:131],a[228:231]
v_add_f32 v113, v113, v240
v_lshlrev_b32 v99, 16, v241
M a[8:11],a[128:131],a[232:235]
L_pad19:
s_cbranch_execz L_pad23
T a[156:157],v77,8200
v_and_b32 v241, 0xffff0000, v241
M a[8:11],a[132:135],a[248:251]
T a[158:159],v77,9224
v_add_f32 v114, v114, v99
M a[12:15],a[132:135],a[252:255]
buffer_load_dwordx4 a[164:167], v58, s[12:15], s63 offen offset:1024 sc1
v_add_f32 v115, v115, v241
M a[12:15],a[128:131],a[236:239]
s_waitcnt lgkmcnt(9)
v_lshlrev_b32 v99, 16, v242
v_and_b32 v242, 0xffff0000, v242
M a[28:31],a[140:143],a[252:255]
T a[128:129],v78,0
v_add_f32 v116, v116, v99
M a[28:31],a[136:139],a[236:239]
T a[130:131],v78,1024
v_add_f32 v117, v117, v242
M a[24:27],a[136:139],a[232:235]
buffer_load_dwordx4 a[168:171], v59, s[12:15], s63 offen offset:0 sc1
v_lshlrev_b32 v99, 16, v243
M a[24:27],a[140:143],a[248:251]
v_and_b32 v243, 0xffff0000, v243
v_add_f32 v118, v118, v99
M a[20:23],a[140:143],a[244:247]
T a[132:133],v78,8192
v_add_f32 v119, v119, v243
M a[20:23],a[136:139],a[228:231]
T a[134:135],v78,9216
M a[16:19],a[136:139],a[224:227]
buffer_load_dwordx4 a[172:175], v59, s[12:15], s63 offen offset:1024 sc1
s_add_u32 s63, s63, 4096
M a[16:19],a[140:143],a[240:243]
s_waitcnt lgkmcnt(9)
v_lshlrev_b32 v99, 16, v244
v_and_b32 v244, 0xffff0000, v244
M a[32:35],a[144:147],a[224:227]
T a[136:137],v78,8
v_add_f32 v112, v112, v99
M a[32:35],a[148:151],a[240:243]
T a[138:139],v78,1032
v_add_f32 v113, v113, v244
M a[36:39],a[148:151],a[244:247]
buffer_load_dwordx4 a[176:179], v58, s[12:15], s63 offen offset:0 sc1
ds_read_b128 v[252:255], v121 offset:52224
M a[36:39],a[144:147],a[228:231]
v_lshlrev_b32 v99, 16, v245
v_and_b32 v245, 0xffff0000, v245
M a[40:43],a[144:147],a[232:235]
T a[140:141],v78,8200
v_add_f32 v114, v114, v99
M a[40:43],a[148:151],a[248:251]
T a[142:143],v78,9224
v_add_f32 v115, v115, v245
M a[44:47],a[148:151],a[252:255]
buffer_load_dwordx4 a[180:183], v58, s[12:15], s63 offen offset:1024 sc1
v_lshlrev_b32 v99, 16, v246
M a[44:47],a[144:147],a[236:239]
s_waitcnt lgkmcnt(9)
v_and_b32 v246, 0xffff0000, v246
v_add_f32 v116, v116, v99
M a[60:63],a[156:159],a[252:255]
T a[144:145],v79,0
v_add_f32 v117, v117, v246
M a[60:63],a[152:155],a[236:239]
T a[146:147],v79,1024
v_lshlrev_b32 v99, 16, v247
M a[56:59],a[152:155],a[232:235]
buffer_load_dwordx4 a[184:187], v59, s[12:15], s63 offen offset:0 sc1
v_and_b32 v247, 0xffff0000, v247
M a[56:59],a[156:159],a[248:251]
v_add_f32 v118, v118, v99
v_add_f32 v119, v119, v247
M a[52:55],a[156:159],a[244:247]
T a[148:149],v79,8192
M a[52:55],a[152:155],a[228:231]
T a[150:151],v79,9216
M a[48:51],a[152:155],a[224:227]
buffer_load_dwordx4 a[188:191], v59, s[12:15], s63 offen offset:1024 sc1
s_add_u32 s63, s63, 4096
M a[48:51],a[156:159],a[240:243]
s_waitcnt lgkmcnt(9)
M a[64:67],a[128:131],a[224:227]
T a[152:153],v79,8
v_lshlrev_b32 v99, 16, v248
M a[64:67],a[132:135],a[240:243]
T a[154:155],v79,1032
v_and_b32 v248, 0xffff0000, v248
M a[68:71],a[132:135],a[244:247]
v_add_f32 v112, v112, v99
v_add_u32 v120, 65536, v120
M a[68:71],a[128:131],a[228:231]
v_add_u32 v121, 65536, v121
ds_read_b128 v[40:43], v120 offset:0
M a[72:75],a[128:131],a[232:235]
T a[156:157],v79,8200
v_add_f32 v113, v113, v248
M a[72:75],a[132:135],a[248:251]
T a[158:159],v79,9224
v_lshlrev_b32 v99, 16, v249
M a[76:79],a[132:135],a[252:255]
v_and_b32 v249, 0xffff0000, v249
v_add_f32 v114, v114, v99
M a[76:79],a[128:131],a[236:239]
s_waitcnt lgkmcnt(9)
v_add_f32 v115, v115, v249
v_lshlrev_b32 v99, 16, v250
M a[92:95],a[140:143],a[252:255]
T a[128:129],v88,16384
v_and_b32 v250, 0xffff0000, v250
M a[92:95],a[136:139],a[236:239]
T a[130:131],v88,17408
v_add_f32 v116, v116, v99
M a[88:91],a[136:139],a[232:235]
v_add_f32 v117, v117, v250
v_lshlrev_b32 v99, 16, v251
M a[88:91],a[140:143],a[248:251]
v_and_b32 v251, 0xffff0000, v251
v_add_f32 v118, v118, v99
M a[84:87],a[140:143],a[244:247]
T a[132:133],v88,24576
v_add_f32 v119, v119, v251
M a[84:87],a[136:139],a[228:231]
T a[134:135],v88,25600
M a[80:83],a[136:139],a[224:227]
M a[80:83],a[140:143],a[240:243]
s_waitcnt lgkmcnt(9)
M a[96:99],a[144:147],a[224:227]
T a[136:137],v89,16384
M a[96:99],a[148:151],a[240:243]
T a[138:139],v89,17408
v_lshlrev_b32 v99, 16, v252
M a[100:103],a[148:151],a[244:247]
v_and_b32 v252, 0xffff0000, v252
v_add_f32 v112, v112, v99
M a[100:103],a[144:147],a[228:231]
v_add_f32 v113, v113, v252
v_lshlrev_b32 v99, 16, v253
M a[104:107],a[144:147],a[232:235]
T a[140:141],v89,24576
ds_read_b128 v[44:47], v120 offset:1024
M a[104:107],a[148:151],a[248:251]
T a[142:143],v89,25600
v_and_b32 v253, 0xffff0000, v253
M a[108:111],a[148:151],a[252:255]
v_add_f32 v114, v114, v99
v_add_f32 v115, v115, v253
M a[108:111],a[144:147],a[236:239]
s_waitcnt lgkmcnt(9)
v_lshlrev_b32 v99, 16, v254
v_and_b32 v254, 0xffff0000, v254
M a[124:127],a[156:159],a[252:255]
T a[144:145],v90,16384
v_add_f32 v116, v116, v99
M a[124:127],a[152:155],a[236:239]
T a[146:147],v90,17408
v_add_f32 v117, v117, v254
M a[120:123],a[152:155],a[232:235]
v_lshlrev_b32 v99, 16, v255
v_and_b32 v255, 0xffff0000, v255
M a[120:123],a[156:159],a[248:251]
v_add_f32 v118, v118, v99
v_add_f32 v119, v119, v255
M a[116:119],a[156:159],a[244:247]
T a[148:149],v90,24576
M a[116:119],a[152:155],a[228:231]
T a[150:151],v90,25600
M a[112:115],a[152:155],a[224:227]
M a[112:115],a[156:159],a[240:243]
s_waitcnt lgkmcnt(9)
M v[128:131],a[128:131],a[224:227]
T a[152:153],v91,16384
M v[128:131],a[132:135],a[240:243]
T a[154:155],v91,17408
M v[132:135],a[132:135],a[244:247]
v_lshlrev_b32 v99, 16, v40
v_and_b32 v40, 0xffff0000, v40
M v[132:135],a[128:131],a[228:231]
v_add_f32 v104, v104, v99
v_add_f32 v105, v105, v40
M v[136:139],a[128:131],a[232:235]
T a[156:157],v91,24576
v_lshlrev_b32 v99, 16, v41
M v[136:139],a[132:135],a[248:251]
T a[158:159],v91,25600
ds_read_b128 v[240:243], v121 offset:2048
M v[140:143],a[132:135],a[252:255]
buffer_load_dwordx4 a[192:195], v58, s[12:15], s63 offen offset:0 sc1
v_and_b32 v41, 0xffff0000, v41
M v[140:143],a[128:131],a[236:239]
s_waitcnt lgkmcnt(9)
v_add_f32 v106, v106, v99
v_add_f32 v107, v107, v41
M v[156:159],a[140:143],a[252:255]
T a[128:129],v92,16384
v_lshlrev_b32 v99, 16, v42
M v[156:159],a[136:139],a[236:239]
T a[130:131],v92,17408
v_and_b32 v42, 0xffff0000, v42
M v[152:155],a[136:139],a[232:235]
buffer_load_dwordx4 a[196:199], v58, s[12:15], s63 offen offset:1024 sc1
v_add_f32 v108, v108, v99
M v[152:155],a[140:143],a[248:251]
v_add_f32 v109, v109, v42
v_lshlrev_b32 v99, 16, v43
M v[148:151],a[140:143],a[244:247]
T a[132:133],v92,24576
v_and_b32 v43, 0xffff0000, v43
M v[148:151],a[136:139],a[228:231]
T a[134:135],v92,25600
v_add_f32 v110, v110, v99
M v[144:147],a[136:139],a[224:227]
buffer_load_dwordx4 a[200:203], v59, s[12:15], s63 offen offset:0 sc1
v_add_f32 v111, v111, v43
M v[144:147],a[140:143],a[240:243]
s_waitcnt lgkmcnt(9)
M v[160:163],a[144:147],a[224:227]
T a[136:137],v93,16384
M v[160:163],a[148:151],a[240:243]
T a[138:139],v93,17408
M v[164:167],a[148:151],a[244:247]
buffer_load_dwordx4 a[204:207], v59, s[12:15], s63 offen offset:1024 sc1
s_add_u32 s63, s63, 4096
M v[164:167],a[144:147],a[228:231]
v_lshlrev_b32 v99, 16, v44
v_and_b32 v44, 0xffff0000, v44
M v[168:171],a[144:147],a[232:235]
T a[140:141],v93,24576
v_add_f32 v104, v104, v99
M v[168:171],a[148:151],a[248:251]
T a[142:143],v93,25600
v_add_f32 v105, v105, v44
M v[172:175],a[148:151],a[252:255]
buffer_load_dwordx4 a[208:211], v58, s[12:15], s63 offen offset:0 sc1
ds_read_b128 v[244:247], v121 offset:3072
M v[172:175],a[144:147],a[236:239]
s_waitcnt lgkmcnt(10)
v_lshlrev_b32 v99, 16, v45
v_and_b32 v45, 0xffff0000, v45
M v[188:191],a[156:159],a[252:255]
T a[144:145],v94,16384
v_add_f32 v106, v106, v99
M v[188:191],a[152:155],a[236:239]
T a[146:147],v94,17408
v_add_f32 v107, v107, v45
M v[184:187],a[152:155],a[232:235]
buffer_load_dwordx4 a[212:215], v58, s[12:15], s63 offen offset:1024 sc1
v_lshlrev_b32 v99, 16, v46
M v[184:187],a[156:159],a[248:251]
v_and_b32 v46, 0xffff0000, v46
v_add_f32 v108, v108, v99
M v[180:183],a[156:159],a[244:247]
T a[148:149],v94,24576
v_add_f32 v109, v109, v46
M v[180:183],a[152:155],a[228:231]
T a[150:151],v94,25600
v_lshlrev_b32 v99, 16, v47
M v[176:179],a[152:155],a[224:227]
buffer_load_dwordx4 a[216:219], v59, s[12:15], s63 offen offset:0 sc1
v_and_b32 v47, 0xffff0000, v47
M v[176:179],a[156:159],a[240:243]
s_waitcnt lgkmcnt(9)
v_add_f32 v110, v110, v99
v_add_f32 v111, v111, v47
M v[192:195],a[128:131],a[224:227]
T a[152:153],v95,16384
M v[192:195],a[132:135],a[240:243]
T a[154:155],v95,17408
M v[196:199],a[132:135],a[244:247]
buffer_load_dwordx4 a[220:223], v59, s[12:15], s63 offen offset:1024 sc1
s_add_u32 s63, s63, 4096
M v[196:199],a[128:131],a[228:231]
M v[200:203],a[128:131],a[232:235]
T a[156:157],v95,24576
v_lshlrev_b32 v99, 16, v240
M v[200:203],a[132:135],a[248:251]
T a[158:159],v95,25600
v_and_b32 v240, 0xffff0000, v240
M v[204:207],a[132:135],a[252:255]
v_add_f32 v104, v104, v99
v_add_f32 v105, v105, v240
M v[204:207],a[128:131],a[236:239]
s_waitcnt vmcnt(18)
s_barrier
s_waitcnt lgkmcnt(9)
M v[220:223],a[140:143],a[252:255]
T a[128:129],v76,32768
ds_read_b128 v[248:251], v120 offset:16384
M v[220:223],a[136:139],a[236:239]
T a[130:131],v76,33792
v_lshlrev_b32 v99, 16, v241
M v[216:219],a[136:139],a[232:235]
buffer_load_dwordx4 v65, s[4:7], s66 offen offset:1024 lds
v_and_b32 v241, 0xffff0000, v241
M v[216:219],a[140:143],a[248:251]
v_add_f32 v106, v106, v99
v_add_f32 v107, v107, v241
M v[212:215],a[140:143],a[244:247]
T a[132:133],v76,40960
v_lshlrev_b32 v99, 16, v242
M v[212:215],a[136:139],a[228:231]
T a[134:135],v76,41984
v_and_b32 v242, 0xffff0000, v242
M v[208:211],a[136:139],a[224:227]
buffer_load_dwordx4 v66, s[4:7], s66 offen offset:2048 lds
v_add_f32 v108, v108, v99
M v[208:211],a[140:143],a[240:243]
s_waitcnt lgkmcnt(9)
v_add_f32 v109, v109, v242
v_lshlrev_b32 v99, 16, v243
M v[224:227],a[144:147],a[224:227]
T a[136:137],v76,32776
v_and_b32 v243, 0xffff0000, v243
M v[224:227],a[148:151],a[240:243]
T a[138:139],v76,33800
v_add_f32 v110, v110, v99
M v[228:231],a[148:151],a[244:247]
T a[140:141],v76,40968
v_add_f32 v111, v111, v243
M v[228:231],a[144:147],a[228:231]
T a[142:143],v76,41992
s_waitcnt lgkmcnt(9)
M v[236:239],a[156:159],a[244:247]
T a[144:145],v77,32768
M v[236:239],a[152:155],a[228:231]
T a[146:147],v77,33792
v_lshlrev_b32 v99, 16, v244
M v[232:235],a[152:155],a[224:227]
T a[148:149],v77,40960
v_and_b32 v244, 0xffff0000, v244
M v[232:235],a[156:159],a[240:243]
s_waitcnt vmcnt(10)
T a[150:151],v77,41984
s_waitcnt lgkmcnt(8)
M a[0:3],a[128:131],a[160:163]
T a[152:153],v77,32776
v_add_f32 v104, v104, v99
M a[0:3],a[132:135],a[176:179]
T a[154:155],v77,33800
ds_read_b128 v[252:255], v120 offset:17408
M a[4:7],a[132:135],a[180:183]
buffer_load_dwordx4 v67, s[4:7], s66 offen offset:3072 lds
s_add_u32 s66, s66, 524288
M a[4:7],a[128:131],a[164:167]
v_add_f32 v105, v105, v244
v_lshlrev_b32 v99, 16, v245
M a[8:11],a[128:131],a[168:171]
T a[156:157],v77,40968
v_and_b32 v245, 0xffff0000, v245
M a[8:11],a[132:135],a[184:187]
s_add_u32 m0, s58, 16384
T a[158:159],v77,41992
v_add_f32 v106, v106, v99
M a[12:15],a[132:135],a[188:191]
buffer_load_dwordx4 v68, s[8:11], s67 offen offset:0 lds
v_add_f32 v107, v107, v245
M a[12:15],a[128:131],a[172:175]
s_waitcnt lgkmcnt(9)
v_lshlrev_b32 v99, 16, v246
v_and_b32 v246, 0xffff0000, v246
M a[28:31],a[140:143],a[188:191]
T a[128:129],v78,32768
v_add_f32 v108, v108, v99
M a[28:31],a[136:139],a[172:175]
T a[130:131],v78,33792
v_add_f32 v109, v109, v246
M a[24:27],a[136:139],a[168:171]
buffer_load_dwordx4 v69, s[8:11], s67 offen offset:1024 lds
v_lshlrev_b32 v99, 16, v247
M a[24:27],a[140:143],a[184:187]
v_and_b32 v247, 0xffff0000, v247
v_add_f32 v110, v110, v99
M a[20:23],a[140:143],a[180:183]
T a[132:133],v78,40960
v_add_f32 v111, v111, v247
M a[20:23],a[136:139],a[164:167]
T a[134:135],v78,41984
M a[16:19],a[136:139],a[160:163]
buffer_load_dwordx4 v70, s[8:11], s67 offen offset:2048 lds
v_lshlrev_b32 v99, 16, v248
M a[16:19],a[140:143],a[176:179]
s_waitcnt lgkmcnt(9)
v_and_b32 v248, 0xffff0000, v248
v_add_f32 v112, v112, v99
M a[32:35],a[144:147],a[160:163]
T a[136:137],v78,32776
v_add_f32 v113, v113, v248
M a[32:35],a[148:151],a[176:179]
T a[138:139],v78,33800
ds_read_b128 v[40:43], v121 offset:18432
M a[36:39],a[148:151],a[180:183]
buffer_load_dwordx4 v71, s[8:11], s67 offen offset:3072 lds
s_add_u32 s67, s67, 458752
M a[36:39],a[144:147],a[164:167]
v_lshlrev_b32 v99, 16, v249
v_and_b32 v249, 0xffff0000, v249
M a[40:43],a[144:147],a[168:171]
T a[140:141],v78,40968
v_add_f32 v114, v114, v99
M a[40:43],a[148:151],a[184:187]
s_add_u32 m0, s58, 32768
T a[142:143],v78,41992
v_add_f32 v115, v115, v249
M a[44:47],a[148:151],a[188:191]
buffer_load_dwordx4 v64, s[4:7], s66 offen offset:0 lds
v_lshlrev_b32 v99, 16, v250
M a[44:47],a[144:147],a[172:175]
s_waitcnt lgkmcnt(9)
v_and_b32 v250, 0xffff0000, v250
v_add_f32 v116, v116, v99
M a[60:63],a[156:159],a[188:191]
T a[144:145],v79,32768
v_add_f32 v117, v117, v250
M a[60:63],a[152:155],a[172:175]
T a[146:147],v79,33792
v_lshlrev_b32 v99, 16, v251
M a[56:59],a[152:155],a[168:171]
buffer_load_dword v97, v125, s[4:7], s68 offen
v_add_u32 v125, 1048576, v125
M a[56:59],a[156:159],a[184:187]
v_and_b32 v251, 0xffff0000, v251
v_add_f32 v118, v118, v99
M a[52:55],a[156:159],a[180:183]
T a[148:149],v79,40960
v_add_f32 v119, v119, v251
M a[52:55],a[152:155],a[164:167]
T a[150:151],v79,41984
M a[48:51],a[152:155],a[160:163]
buffer_load_dword v97, v56, s[8:11], s69 offen
v_add_u32 v56, 917504, v56
M a[48:51],a[156:159],a[176:179]
s_waitcnt lgkmcnt(9)
v_lshlrev_b32 v99, 16, v252
v_and_b32 v252, 0xffff0000, v252
M a[64:67],a[128:131],a[160:163]
T a[152:153],v79,32776
v_add_f32 v112, v112, v99
M a[64:67],a[132:135],a[176:179]
T a[154:155],v79,33800
v_add_f32 v113, v113, v252
M a[68:71],a[132:135],a[180:183]
ds_read_b128 v[44:47], v121 offset:19456
v_lshlrev_b32 v99, 16, v253
M a[68:71],a[128:131],a[164:167]
v_and_b32 v253, 0xffff0000, v253
v_add_f32 v114, v114, v99
M a[72:75],a[128:131],a[168:171]
T a[156:157],v79,40968
v_add_f32 v115, v115, v253
M a[72:75],a[132:135],a[184:187]
T a[158:159],v79,41992
v_lshlrev_b32 v99, 16, v254
M a[76:79],a[132:135],a[188:191]
v_and_b32 v254, 0xffff0000, v254
v_add_f32 v116, v116, v99
M a[76:79],a[128:131],a[172:175]
s_waitcnt lgkmcnt(9)
v_add_f32 v117, v117, v254
v_lshlrev_b32 v99, 16, v255
M a[92:95],a[140:143],a[188:191]
T a[128:129],v88,49152
v_and_b32 v255, 0xffff0000, v255
M a[92:95],a[136:139],a[172:175]
T a[130:131],v88,50176
v_add_f32 v118, v118, v99
M a[88:91],a[136:139],a[168:171]
v_add_f32 v119, v119, v255
M a[88:91],a[140:143],a[184:187]
M a[84:87],a[140:143],a[180:183]
T a[132:133],v88,57344
M a[84:87],a[136:139],a[164:167]
T a[134:135],v88,58368
M a[80:83],a[136:139],a[160:163]
M a[80:83],a[140:143],a[176:179]
s_waitcnt lgkmcnt(9)
M a[96:99],a[144:147],a[160:163]
T a[136:137],v89,49152
v_lshlrev_b32 v99, 16, v40
M a[96:99],a[148:151],a[176:179]
T a[138:139],v89,50176
v_and_b32 v40, 0xffff0000, v40
M a[100:103],a[148:151],a[180:183]
v_add_f32 v112, v112, v99
v_add_f32 v113, v113, v40
M a[100:103],a[144:147],a[164:167]
v_lshlrev_b32 v99, 16, v41
v_and_b32 v41, 0xffff0000, v41
M a[104:107],a[144:147],a[168:171]
T a[140:141],v89,57344
v_add_f32 v114, v114, v99
M a[104:107],a[148:151],a[184:187]
T a[142:143],v89,58368
v_add_f32 v115, v115, v41
M a[108:111],a[148:151],a[188:191]
v_lshlrev_b32 v99, 16, v42
v_and_b32 v42, 0xffff0000, v42
M a[108:111],a[144:147],a[172:175]
s_waitcnt lgkmcnt(8)
v_add_f32 v116, v116, v99
v_add_f32 v117, v117, v42
M a[124:127],a[156:159],a[188:191]
T a[144:145],v90,49152
v_lshlrev_b32 v99, 16, v43
M a[124:127],a[152:155],a[172:175]
T a[146:147],v90,50176
v_and_b32 v43, 0xffff0000, v43
M a[120:123],a[152:155],a[168:171]
v_add_f32 v118, v118, v99
v_add_f32 v119, v119, v43
M a[120:123],a[156:159],a[184:187]
M a[116:119],a[156:159],a[180:183]
T a[148:149],v90,57344
M a[116:119],a[152:155],a[164:167]
T a[150:151],v90,58368
M a[112:115],a[152:155],a[160:163]
M a[112:115],a[156:159],a[176:179]
s_waitcnt lgkmcnt(8)
M v[128:131],a[128:131],a[160:163]
T a[152:153],v91,49152
M v[128:131],a[132:135],a[176:179]
T a[154:155],v91,50176
v_lshlrev_b32 v99, 16, v44
M v[132:135],a[132:135],a[180:183]
v_and_b32 v44, 0xffff0000, v44
v_add_f32 v112, v112, v99
M v[132:135],a[128:131],a[164:167]
v_add_f32 v113, v113, v44
v_lshlrev_b32 v99, 16, v45
M v[136:139],a[128:131],a[168:171]
T a[156:157],v91,57344
v_and_b32 v45, 0xffff0000, v45
M v[136:139],a[132:135],a[184:187]
T a[158:159],v91,58368
v_add_f32 v114, v114, v99
M v[140:143],a[132:135],a[188:191]
buffer_load_dwordx4 a[224:227], v58, s[12:15], s63 offen offset:0 sc1
v_add_f32 v115, v115, v45
M v[140:143],a[128:131],a[172:175]
s_waitcnt lgkmcnt(8)
v_lshlrev_b32 v99, 16, v46
v_and_b32 v46, 0xffff0000, v46
M v[156:159],a[140:143],a[188:191]
T a[128:129],v92,49152
v_add_f32 v116, v116, v99
M v[156:159],a[136:139],a[172:175]
T a[130:131],v92,50176
v_add_f32 v117, v117, v46
M v[152:155],a[136:139],a[168:171]
buffer_load_dwordx4 a[228:231], v58, s[12:15], s63 offen offset:1024 sc1
v_lshlrev_b32 v99, 16, v47
M v[152:155],a[140:143],a[184:187]
v_and_b32 v47, 0xffff0000, v47
v_add_f32 v118, v118, v99
M v[148:151],a[140:143],a[180:183]
T a[132:133],v92,57344
v_add_f32 v119, v119, v47
M v[148:151],a[136:139],a[164:167]
T a[134:135],v92,58368
v_and_b32 v120, 15, v0
M v[144:147],a[136:139],a[160:163]
buffer_load_dwordx4 a[232:235], v59, s[12:15], s63 offen offset:0 sc1
v_lshl_add_u32 v120, v120, 5, v63
M v[144:147],a[140:143],a[176:179]
s_waitcnt lgkmcnt(8)
v_permlane32_swap_b32 v104, v108
v_permlane32_swap_b32 v105, v109
M v[160:163],a[144:147],a[160:163]
T a[136:137],v93,49152
v_permlane32_swap_b32 v106, v110
M v[160:163],a[148:151],a[176:179]
T a[138:139],v93,50176
v_permlane32_swap_b32 v107, v111
M v[164:167],a[148:151],a[180:183]
buffer_load_dwordx4 a[236:239], v59, s[12:15], s63 offen offset:1024 sc1
s_add_u32 s63, s63, 4096
M v[164:167],a[144:147],a[164:167]
v_add_f32 v104, v104, v108
v_add_f32 v105, v105, v109
M v[168:171],a[144:147],a[168:171]
s_lshr_b32 s70, s58, 2
T a[140:141],v93,57344
v_add_f32 v106, v106, v110
M v[168:171],a[148:151],a[184:187]
s_add_u32 s70, s70, 135168
T a[142:143],v93,58368
v_add_u32 v120, s70, v120
M v[172:175],a[148:151],a[188:191]
buffer_load_dwordx4 a[240:243], v58, s[12:15], s63 offen offset:0 sc1
v_add_f32 v107, v107, v111
M v[172:175],a[144:147],a[172:175]
s_waitcnt lgkmcnt(8)
v_permlane16_swap_b32 v104, v106
v_permlane16_swap_b32 v105, v107
M v[188:191],a[156:159],a[188:191]
T a[144:145],v94,49152
v_add_f32 v104, v104, v106
M v[188:191],a[152:155],a[172:175]
T a[146:147],v94,50176
v_add_f32 v105, v105, v107
M v[184:187],a[152:155],a[168:171]
buffer_load_dwordx4 a[244:247], v58, s[12:15], s63 offen offset:1024 sc1
v_permlane32_swap_b32 v112, v116
M v[184:187],a[156:159],a[184:187]
v_permlane32_swap_b32 v113, v117
v_permlane32_swap_b32 v114, v118
M v[180:183],a[156:159],a[180:183]
L_pad20:
s_cbranch_execz L_pad24
T a[148:149],v94,57344
v_permlane32_swap_b32 v115, v119
M v[180:183],a[152:155],a[164:167]
T a[150:151],v94,58368
v_add_f32 v112, v112, v116
M v[176:179],a[152:155],a[160:163]
buffer_load_dwordx4 a[248:251], v59, s[12:15], s63 offen offset:0 sc1
v_add_f32 v113, v113, v117
M v[176:179],a[156:159],a[176:179]
s_waitcnt lgkmcnt(8)
v_add_f32 v114, v114, v118
v_add_f32 v115, v115, v119
M v[192:195],a[128:131],a[160:163]
T a[152:153],v95,49152
v_permlane16_swap_b32 v112, v114
M v[192:195],a[132:135],a[176:179]
T a[154:155],v95,50176
v_permlane16_swap_b32 v113, v115
M v[196:199],a[132:135],a[180:183]
buffer_load_dwordx4 a[252:255], v59, s[12:15], s63 offen offset:1024 sc1
s_add_u32 s63, s63, 4096
M v[196:199],a[128:131],a[164:167]
ds_write_b64 v120, v[104:105] offset:0
v_add_f32 v112, v112, v114
M v[200:203],a[128:131],a[168:171]
T a[156:157],v95,57344
v_add_f32 v113, v113, v115
M v[200:203],a[132:135],a[184:187]
T a[158:159],v95,58368
M v[204:207],a[132:135],a[188:191]
M v[204:207],a[128:131],a[172:175]
s_waitcnt vmcnt(11)
s_barrier
s_waitcnt lgkmcnt(9)
M v[220:223],a[140:143],a[188:191]
T a[128:129],v72,0
M v[220:223],a[136:139],a[172:175]
T a[130:131],v72,1024
M v[216:219],a[136:139],a[168:171]
buffer_load_dwordx4 v65, s[4:7], s66 offen offset:1024 lds
M v[216:219],a[140:143],a[184:187]
M v[212:215],a[140:143],a[180:183]
T a[132:133],v72,8192
M v[212:215],a[136:139],a[164:167]
T a[134:135],v72,9216
M v[208:211],a[136:139],a[160:163]
buffer_load_dwordx4 v66, s[4:7], s66 offen offset:2048 lds
M v[208:211],a[140:143],a[176:179]
s_waitcnt lgkmcnt(9)
M v[224:227],a[144:147],a[160:163]
T a[136:137],v72,8
ds_write_b64 v120, v[112:113] offset:512
M v[224:227],a[148:151],a[176:179]
T a[138:139],v72,1032
v_mov_b32 v54, v52
M v[228:231],a[148:151],a[180:183]
T a[140:141],v72,8200
v_permlane32_swap_b32 v52, v54
M v[228:231],a[144:147],a[164:167]
s_waitcnt lgkmcnt(8)
T a[142:143],v72,9224
v_mov_b32 v53, v52
M v[236:239],a[156:159],a[180:183]
T a[144:145],v73,0
v_mov_b32 v55, v54
M v[236:239],a[152:155],a[164:167]
T a[146:147],v73,1024
v_permlane16_swap_b32 v52, v53
M v[232:235],a[152:155],a[160:163]
T a[148:149],v73,8192
v_permlane16_swap_b32 v54, v55
M v[232:235],a[156:159],a[176:179]
s_waitcnt vmcnt(20)
T a[150:151],v73,9216
s_waitcnt lgkmcnt(9)
M a[0:3],a[128:131],a[192:195]
T a[152:153],v73,8
v_lshlrev_b32 v96, 16, v96
M a[0:3],a[132:135],a[208:211]
T a[154:155],v73,1032
v_and_b32 v104, 0xffff0000, v52
M a[4:7],a[132:135],a[212:215]
buffer_load_dwordx4 v67, s[4:7], s66 offen offset:3072 lds
s_add_u32 s66, s66, 524288
M a[4:7],a[128:131],a[196:199]
v_lshlrev_b32 v48, 16, v52
v_and_b32 v105, 0xffff0000, v53
M a[8:11],a[128:131],a[200:203]
T a[156:157],v73,8200
v_lshlrev_b32 v49, 16, v53
M a[8:11],a[132:135],a[216:219]
s_add_u32 m0, s58, 49152
T a[158:159],v73,9224
v_and_b32 v106, 0xffff0000, v54
M a[12:15],a[132:135],a[220:223]
buffer_load_dwordx4 v68, s[8:11], s67 offen offset:0 lds
v_lshlrev_b32 v50, 16, v54
M a[12:15],a[128:131],a[204:207]
s_waitcnt lgkmcnt(8)
v_rcp_f32 v52, v104
M a[28:31],a[140:143],a[220:223]
T a[128:129],v74,0
v_and_b32 v107, 0xffff0000, v55
M a[28:31],a[136:139],a[204:207]
T a[130:131],v74,1024
v_lshlrev_b32 v51, 16, v55
M a[24:27],a[136:139],a[200:203]
buffer_load_dwordx4 v69, s[8:11], s67 offen offset:1024 lds
v_mul_f32 v108, 0xc0135761, v52
M a[24:27],a[140:143],a[216:219]
v_rcp_f32 v53, v105
M a[20:23],a[140:143],a[212:215]
T a[132:133],v74,8192
v_mul_f32 v112, v52, v52
M a[20:23],a[136:139],a[196:199]
T a[134:135],v74,9216
v_mul_f32 v112, v112, v108
M a[16:19],a[136:139],a[192:195]
buffer_load_dwordx4 v70, s[8:11], s67 offen offset:2048 lds
v_mul_f32 v112, 0x3d372713, v112
M a[16:19],a[140:143],a[208:211]
s_waitcnt lgkmcnt(8)
v_rcp_f32 v54, v106
M a[32:35],a[144:147],a[192:195]
T a[136:137],v74,8
v_mul_f32 v52, 0x3e0293ee, v52
M a[32:35],a[148:151],a[208:211]
T a[138:139],v74,1032
v_mul_f32 v109, 0xc0135761, v53
M a[36:39],a[148:151],a[212:215]
buffer_load_dwordx4 v71, s[8:11], s67 offen offset:3072 lds
s_add_u32 s67, s67, 458752
M a[36:39],a[144:147],a[196:199]
v_rcp_f32 v55, v107
M a[40:43],a[144:147],a[200:203]
T a[140:141],v74,8200
v_mul_f32 v113, v53, v53
M a[40:43],a[148:151],a[216:219]
s_add_u32 m0, s58, 65536
T a[142:143],v74,9224
v_mul_f32 v113, v113, v109
M a[44:47],a[148:151],a[220:223]
buffer_load_dwordx4 v64, s[4:7], s66 offen offset:0 lds
v_mul_f32 v113, 0x3d372713, v113
M a[44:47],a[144:147],a[204:207]
s_waitcnt lgkmcnt(8)
v_mul_f32 v53, 0x3e0293ee, v53
v_mul_f32 v110, 0xc0135761, v54
M a[60:63],a[156:159],a[220:223]
T a[144:145],v75,0
v_mul_f32 v114, v54, v54
M a[60:63],a[152:155],a[204:207]
T a[146:147],v75,1024
v_mul_f32 v114, v114, v110
M a[56:59],a[152:155],a[200:203]
v_mul_f32 v114, 0x3d372713, v114
v_mul_f32 v54, 0x3e0293ee, v54
M a[56:59],a[156:159],a[216:219]
v_mul_f32 v111, 0xc0135761, v55
v_mul_f32 v115, v55, v55
M a[52:55],a[156:159],a[212:215]
T a[148:149],v75,8192
v_mul_f32 v115, v115, v111
M a[52:55],a[152:155],a[196:199]
T a[150:151],v75,9216
v_mul_f32 v115, 0x3d372713, v115
M a[48:51],a[152:155],a[192:195]
v_mul_f32 v55, 0x3e0293ee, v55
v_lshlrev_b32 v120, 2, v98
M a[48:51],a[156:159],a[208:211]
s_waitcnt lgkmcnt(8)
v_add_u32 v120, 135168, v120
v_lshlrev_b32 v99, 1, v63
M a[64:67],a[128:131],a[192:195]
T a[152:153],v75,8
v_add_u32 v99, 131072, v99
M a[64:67],a[132:135],a[208:211]
T a[154:155],v75,1032
M a[68:71],a[132:135],a[212:215]
M a[68:71],a[128:131],a[196:199]
s_lshr_b32 s70, s52, 1
M a[72:75],a[128:131],a[200:203]
s_and_b32 s72, s70, s75
T a[156:157],v75,8200
M a[72:75],a[132:135],a[216:219]
s_lshl_b32 s72, s72, 5
T a[158:159],v75,9224
v_subrev_u32 v98, s72, v98
M a[76:79],a[132:135],a[220:223]
v_and_b32 v98, 127, v98
M a[76:79],a[128:131],a[204:207]
s_waitcnt lgkmcnt(8)
M a[92:95],a[140:143],a[220:223]
s_lshl_b32 s70, s70, 9
T a[128:129],v80,16384
M a[92:95],a[136:139],a[204:207]
s_add_u32 s70, s70, 131072
T a[130:131],v80,17408
v_lshl_add_u32 v98, v98, 2, s70
M a[88:91],a[136:139],a[200:203]
M a[88:91],a[140:143],a[216:219]
M a[84:87],a[140:143],a[212:215]
T a[132:133],v80,24576
M a[84:87],a[136:139],a[196:199]
T a[134:135],v80,25600
M a[80:83],a[136:139],a[192:195]
M a[80:83],a[140:143],a[208:211]
s_waitcnt lgkmcnt(8)
M a[96:99],a[144:147],a[192:195]
T a[136:137],v81,16384
M a[96:99],a[148:151],a[208:211]
T a[138:139],v81,17408
M a[100:103],a[148:151],a[212:215]
M a[100:103],a[144:147],a[196:199]
M a[104:107],a[144:147],a[200:203]
T a[140:141],v81,24576
M a[104:107],a[148:151],a[216:219]
T a[142:143],v81,25600
M a[108:111],a[148:151],a[220:223]
M a[108:111],a[144:147],a[204:207]
s_waitcnt lgkmcnt(8)
M a[124:127],a[156:159],a[220:223]
T a[144:145],v82,16384
M a[124:127],a[152:155],a[204:207]
T a[146:147],v82,17408
M a[120:123],a[152:155],a[200:203]
M a[120:123],a[156:159],a[216:219]
M a[116:119],a[156:159],a[212:215]
T a[148:149],v82,24576
M a[116:119],a[152:155],a[196:199]
T a[150:151],v82,25600
M a[112:115],a[152:155],a[192:195]
M a[112:115],a[156:159],a[208:211]
s_waitcnt lgkmcnt(8)
M v[128:131],a[128:131],a[192:195]
T a[152:153],v83,16384
M v[128:131],a[132:135],a[208:211]
T a[154:155],v83,17408
M v[132:135],a[132:135],a[212:215]
M v[132:135],a[128:131],a[196:199]
M v[136:139],a[128:131],a[200:203]
T a[156:157],v83,24576
M v[136:139],a[132:135],a[216:219]
T a[158:159],v83,25600
M v[140:143],a[132:135],a[220:223]
buffer_load_dwordx4 a[160:163], v58, s[12:15], s63 offen offset:0 sc1
M v[140:143],a[128:131],a[204:207]
s_waitcnt lgkmcnt(8)
M v[156:159],a[140:143],a[220:223]
T a[128:129],v84,16384
M v[156:159],a[136:139],a[204:207]
T a[130:131],v84,17408
M v[152:155],a[136:139],a[200:203]
buffer_load_dwordx4 a[164:167], v58, s[12:15], s63 offen offset:1024 sc1
M v[152:155],a[140:143],a[216:219]
M v[148:151],a[140:143],a[212:215]
T a[132:133],v84,24576
M v[148:151],a[136:139],a[196:199]
T a[134:135],v84,25600
M v[144:147],a[136:139],a[192:195]
buffer_load_dwordx4 a[168:171], v59, s[12:15], s63 offen offset:0 sc1
M v[144:147],a[140:143],a[208:211]
s_waitcnt lgkmcnt(8)
M v[160:163],a[144:147],a[192:195]
T a[136:137],v85,16384
M v[160:163],a[148:151],a[208:211]
T a[138:139],v85,17408
M v[164:167],a[148:151],a[212:215]
buffer_load_dwordx4 a[172:175], v59, s[12:15], s63 offen offset:1024 sc1
s_add_u32 s63, s63, 4096
M v[164:167],a[144:147],a[196:199]
M v[168:171],a[144:147],a[200:203]
T a[140:141],v85,24576
M v[168:171],a[148:151],a[216:219]
T a[142:143],v85,25600
M v[172:175],a[148:151],a[220:223]
buffer_load_dwordx4 a[176:179], v58, s[12:15], s63 offen offset:0 sc1
M v[172:175],a[144:147],a[204:207]
s_waitcnt lgkmcnt(8)
M v[188:191],a[156:159],a[220:223]
T a[144:145],v86,16384
M v[188:191],a[152:155],a[204:207]
T a[146:147],v86,17408
M v[184:187],a[152:155],a[200:203]
buffer_load_dwordx4 a[180:183], v58, s[12:15], s63 offen offset:1024 sc1
M v[184:187],a[156:159],a[216:219]
M v[180:183],a[156:159],a[212:215]
T a[148:149],v86,24576
M v[180:183],a[152:155],a[196:199]
T a[150:151],v86,25600
M v[176:179],a[152:155],a[192:195]
buffer_load_dwordx4 a[184:187], v59, s[12:15], s63 offen offset:0 sc1
M v[176:179],a[156:159],a[208:211]
s_waitcnt lgkmcnt(8)
M v[192:195],a[128:131],a[192:195]
T a[152:153],v87,16384
M v[192:195],a[132:135],a[208:211]
T a[154:155],v87,17408
M v[196:199],a[132:135],a[212:215]
buffer_load_dwordx4 a[188:191], v59, s[12:15], s63 offen offset:1024 sc1
s_add_u32 s63, s63, 4096
M v[196:199],a[128:131],a[196:199]
M v[200:203],a[128:131],a[200:203]
T a[156:157],v87,24576
M v[200:203],a[132:135],a[216:219]
T a[158:159],v87,25600
M v[204:207],a[132:135],a[220:223]
M v[204:207],a[128:131],a[204:207]
s_waitcnt vmcnt(9)
s_barrier
s_waitcnt lgkmcnt(8)
M v[220:223],a[140:143],a[220:223]
T a[128:129],v72,32768
ds_read2st64_b32 v[40:41], v120 offset1:4
M v[220:223],a[136:139],a[204:207]
T a[130:131],v72,33792
ds_read2st64_b32 v[42:43], v120 offset0:8 offset1:12
M v[216:219],a[136:139],a[200:203]
buffer_load_dwordx4 v65, s[4:7], s66 offen offset:1024 lds
M v[216:219],a[140:143],a[216:219]
M v[212:215],a[140:143],a[212:215]
T a[132:133],v72,40960
M v[212:215],a[136:139],a[196:199]
T a[134:135],v72,41984
M v[208:211],a[136:139],a[192:195]
buffer_load_dwordx4 v66, s[4:7], s66 offen offset:2048 lds
M v[208:211],a[140:143],a[208:211]
s_waitcnt lgkmcnt(10)
M v[224:227],a[144:147],a[192:195]
T a[136:137],v72,32776
M v[224:227],a[148:151],a[208:211]
T a[138:139],v72,33800
M v[228:231],a[148:151],a[212:215]
T a[140:141],v72,40968
M v[228:231],a[144:147],a[196:199]
T a[142:143],v72,41992
s_waitcnt lgkmcnt(10)
M v[236:239],a[156:159],a[212:215]
T a[144:145],v73,32768
M v[236:239],a[152:155],a[196:199]
s_waitcnt lgkmcnt(7)
T a[146:147],v73,33792
v_add_f32 v40, v40, v41
M v[232:235],a[152:155],a[192:195]
T a[148:149],v73,40960
v_add_f32 v42, v42, v43
M v[232:235],a[156:159],a[208:211]
s_waitcnt vmcnt(18)
T a[150:151],v73,41984
s_waitcnt lgkmcnt(8)
M a[0:3],a[128:131],a[224:227]
T a[152:153],v73,32776
v_add_f32 v40, v40, v42
M a[0:3],a[132:135],a[240:243]
T a[154:155],v73,33800
ds_write_b32 v98, v40
M a[4:7],a[132:135],a[244:247]
buffer_load_dwordx4 v67, s[4:7], s66 offen offset:3072 lds
ds_write_b32 v98, v96 offset:1024
M a[4:7],a[128:131],a[228:231]
s_add_u32 s66, s66, 524288
M a[8:11],a[128:131],a[232:235]
T a[156:157],v73,40968
M a[8:11],a[132:135],a[248:251]
s_add_u32 m0, s58, 81920
T a[158:159],v73,41992
M a[12:15],a[132:135],a[252:255]
buffer_load_dwordx4 v68, s[8:11], s67 offen offset:0 lds
M a[12:15],a[128:131],a[236:239]
s_waitcnt lgkmcnt(10)
M a[28:31],a[140:143],a[252:255]
T a[128:129],v74,32768
M a[28:31],a[136:139],a[236:239]
T a[130:131],v74,33792
M a[24:27],a[136:139],a[232:235]
buffer_load_dwordx4 v69, s[8:11], s67 offen offset:1024 lds
M a[24:27],a[140:143],a[248:251]
M a[20:23],a[140:143],a[244:247]
T a[132:133],v74,40960
M a[20:23],a[136:139],a[228:231]
T a[134:135],v74,41984
M a[16:19],a[136:139],a[224:227]
buffer_load_dwordx4 v70, s[8:11], s67 offen offset:2048 lds
M a[16:19],a[140:143],a[240:243]
s_waitcnt lgkmcnt(10)
M a[32:35],a[144:147],a[224:227]
T a[136:137],v74,32776
M a[32:35],a[148:151],a[240:243]
T a[138:139],v74,33800
M a[36:39],a[148:151],a[244:247]
buffer_load_dwordx4 v71, s[8:11], s67 offen offset:3072 lds
s_add_u32 s67, s67, 458752
M a[36:39],a[144:147],a[228:231]
M a[40:43],a[144:147],a[232:235]
T a[140:141],v74,40968
M a[40:43],a[148:151],a[248:251]
s_add_u32 m0, s58, 98304
T a[142:143],v74,41992
M a[44:47],a[148:151],a[252:255]
buffer_load_dwordx4 v64, s[4:7], s66 offen offset:0 lds
M a[44:47],a[144:147],a[236:239]
s_waitcnt lgkmcnt(8)
M a[60:63],a[156:159],a[252:255]
T a[144:145],v75,32768
M a[60:63],a[152:155],a[236:239]
T a[146:147],v75,33792
M a[56:59],a[152:155],a[232:235]
buffer_load_dword v97, v125, s[4:7], s68 offen
v_add_u32 v125, 1048576, v125
M a[56:59],a[156:159],a[248:251]
M a[52:55],a[156:159],a[244:247]
T a[148:149],v75,40960
M a[52:55],a[152:155],a[228:231]
T a[150:151],v75,41984
M a[48:51],a[152:155],a[224:227]
buffer_load_dword v97, v56, s[8:11], s69 offen
v_add_u32 v56, 917504, v56
M a[48:51],a[156:159],a[240:243]
s_waitcnt lgkmcnt(8)
M a[64:67],a[128:131],a[224:227]
T a[152:153],v75,32776
M a[64:67],a[132:135],a[240:243]
T a[154:155],v75,33800
M a[68:71],a[132:135],a[244:247]
M a[68:71],a[128:131],a[228:231]
M a[72:75],a[128:131],a[232:235]
T a[156:157],v75,40968
M a[72:75],a[132:135],a[248:251]
T a[158:159],v75,41992
M a[76:79],a[132:135],a[252:255]
M a[76:79],a[128:131],a[236:239]
s_waitcnt lgkmcnt(8)
M a[92:95],a[140:143],a[252:255]
T a[128:129],v80,49152
M a[92:95],a[136:139],a[236:239]
T a[130:131],v80,50176
M a[88:91],a[136:139],a[232:235]
M a[88:91],a[140:143],a[248:251]
M a[84:87],a[140:143],a[244:247]
T a[132:133],v80,57344
M a[84:87],a[136:139],a[228:231]
T a[134:135],v80,58368
M a[80:83],a[136:139],a[224:227]
M a[80:83],a[140:143],a[240:243]
s_waitcnt lgkmcnt(8)
M a[96:99],a[144:147],a[224:227]
T a[136:137],v81,49152
M a[96:99],a[148:151],a[240:243]
T a[138:139],v81,50176
M a[100:103],a[148:151],a[244:247]
M a[100:103],a[144:147],a[228:231]
M a[104:107],a[144:147],a[232:235]
T a[140:141],v81,57344
M a[104:107],a[148:151],a[248:251]
T a[142:143],v81,58368
M a[108:111],a[148:151],a[252:255]
M a[108:111],a[144:147],a[236:239]
s_waitcnt lgkmcnt(8)
M a[124:127],a[156:159],a[252:255]
T a[144:145],v82,49152
M a[124:127],a[152:155],a[236:239]
T a[146:147],v82,50176
M a[120:123],a[152:155],a[232:235]
M a[120:123],a[156:159],a[248:251]
M a[116:119],a[156:159],a[244:247]
T a[148:149],v82,57344
M a[116:119],a[152:155],a[228:231]
T a[150:151],v82,58368
M a[112:115],a[152:155],a[224:227]
M a[112:115],a[156:159],a[240:243]
s_waitcnt lgkmcnt(8)
M v[128:131],a[128:131],a[224:227]
T a[152:153],v83,49152
M v[128:131],a[132:135],a[240:243]
T a[154:155],v83,50176
M v[132:135],a[132:135],a[244:247]
M v[132:135],a[128:131],a[228:231]
M v[136:139],a[128:131],a[232:235]
T a[156:157],v83,57344
M v[136:139],a[132:135],a[248:251]
T a[158:159],v83,58368
M v[140:143],a[132:135],a[252:255]
buffer_load_dwordx4 a[192:195], v58, s[12:15], s63 offen offset:0 sc1
M v[140:143],a[128:131],a[236:239]
s_waitcnt lgkmcnt(8)
M v[156:159],a[140:143],a[252:255]
T a[128:129],v84,49152
M v[156:159],a[136:139],a[236:239]
T a[130:131],v84,50176
M v[152:155],a[136:139],a[232:235]
buffer_load_dwordx4 a[196:199], v58, s[12:15], s63 offen offset:1024 sc1
M v[152:155],a[140:143],a[248:251]
M v[148:151],a[140:143],a[244:247]
T a[132:133],v84,57344
M v[148:151],a[136:139],a[228:231]
T a[134:135],v84,58368
M v[144:147],a[136:139],a[224:227]
buffer_load_dwordx4 a[200:203], v59, s[12:15], s63 offen offset:0 sc1
M v[144:147],a[140:143],a[240:243]
s_waitcnt lgkmcnt(8)
M v[160:163],a[144:147],a[224:227]
T a[136:137],v85,49152
M v[160:163],a[148:151],a[240:243]
T a[138:139],v85,50176
M v[164:167],a[148:151],a[244:247]
buffer_load_dwordx4 a[204:207], v59, s[12:15], s63 offen offset:1024 sc1
s_add_u32 s63, s63, 4096
M v[164:167],a[144:147],a[228:231]
M v[168:171],a[144:147],a[232:235]
T a[140:141],v85,57344
M v[168:171],a[148:151],a[248:251]
T a[142:143],v85,58368
M v[172:175],a[148:151],a[252:255]
buffer_load_dwordx4 a[208:211], v58, s[12:15], s63 offen offset:0 sc1
M v[172:175],a[144:147],a[236:239]
s_waitcnt lgkmcnt(8)
M v[188:191],a[156:159],a[252:255]
T a[144:145],v86,49152
M v[188:191],a[152:155],a[236:239]
T a[146:147],v86,50176
M v[184:187],a[152:155],a[232:235]
buffer_load_dwordx4 a[212:215], v58, s[12:15], s63 offen offset:1024 sc1
M v[184:187],a[156:159],a[248:251]
M v[180:183],a[156:159],a[244:247]
T a[148:149],v86,57344
M v[180:183],a[152:155],a[228:231]
T a[150:151],v86,58368
M v[176:179],a[152:155],a[224:227]
buffer_load_dwordx4 a[216:219], v59, s[12:15], s63 offen offset:0 sc1
M v[176:179],a[156:159],a[240:243]
s_waitcnt lgkmcnt(8)
M v[192:195],a[128:131],a[224:227]
T a[152:153],v87,49152
M v[192:195],a[132:135],a[240:243]
T a[154:155],v87,50176
M v[196:199],a[132:135],a[244:247]
buffer_load_dwordx4 a[220:223], v59, s[12:15], s63 offen offset:1024 sc1
s_add_u32 s63, s63, 4096
M v[196:199],a[128:131],a[228:231]
M v[200:203],a[128:131],a[232:235]
T a[156:157],v87,57344
M v[200:203],a[132:135],a[248:251]
T a[158:159],v87,58368
M v[204:207],a[132:135],a[252:255]
M v[204:207],a[128:131],a[236:239]
s_waitcnt vmcnt(11)
s_barrier
s_waitcnt lgkmcnt(8)
M v[220:223],a[140:143],a[252:255]
T a[128:129],v76,0
ds_read_b128 v[40:43], v99 offset:512
M v[220:223],a[136:139],a[236:239]
T a[130:131],v76,1024
ds_read_b128 v[44:47], v99 offset:1536
M v[216:219],a[136:139],a[232:235]
L_pad21:
s_cbranch_execz L_pad25
buffer_load_dwordx4 v65, s[4:7], s66 offen offset:1024 lds
ds_read_b128 v[240:243], v99 offset:576
M v[216:219],a[140:143],a[248:251]
ds_read_b128 v[244:247], v99 offset:1600
ds_read_b128 v[248:251], v99 offset:640
M v[212:215],a[140:143],a[244:247]
T a[132:133],v76,8192
ds_read_b128 v[252:255], v99 offset:1664
M v[212:215],a[136:139],a[228:231]
T a[134:135],v76,9216
M v[208:211],a[136:139],a[224:227]
buffer_load_dwordx4 v66, s[4:7], s66 offen offset:2048 lds
M v[208:211],a[140:143],a[240:243]
s_waitcnt lgkmcnt(14)
M v[224:227],a[144:147],a[224:227]
T a[136:137],v76,8
M v[224:227],a[148:151],a[240:243]
T a[138:139],v76,1032
M v[228:231],a[148:151],a[244:247]
T a[140:141],v76,8200
M v[228:231],a[144:147],a[228:231]
T a[142:143],v76,9224
s_waitcnt lgkmcnt(14)
M v[236:239],a[156:159],a[244:247]
T a[144:145],v77,0
M v[236:239],a[152:155],a[228:231]
s_waitcnt lgkmcnt(11)
T a[146:147],v77,1024
v_fmac_f32 v128, v48, v40
M v[232:235],a[152:155],a[224:227]
T a[148:149],v77,8192
v_fmac_f32 v129, v48, v41
M v[232:235],a[156:159],a[240:243]
s_waitcnt vmcnt(20)
T a[150:151],v77,9216
s_waitcnt lgkmcnt(8)
M a[0:3],a[128:131],a[160:163]
T a[152:153],v77,8
v_fmac_f32 v130, v48, v42
M a[0:3],a[132:135],a[176:179]
T a[154:155],v77,1032
v_fmac_f32 v131, v48, v43
M a[4:7],a[132:135],a[180:183]
buffer_load_dwordx4 v67, s[4:7], s66 offen offset:3072 lds
v_fmac_f32 v128, v104, v44
M a[4:7],a[128:131],a[164:167]
s_add_u32 s66, s66, 524288
v_fmac_f32 v129, v104, v45
v_fmac_f32 v130, v104, v46
M a[8:11],a[128:131],a[168:171]
T a[156:157],v77,8200
v_fmac_f32 v131, v104, v47
M a[8:11],a[132:135],a[184:187]
s_add_u32 m0, s58, 114688
T a[158:159],v77,9224
v_fmac_f32 v132, v49, v40
M a[12:15],a[132:135],a[188:191]
buffer_load_dwordx4 v68, s[8:11], s67 offen offset:0 lds
v_fmac_f32 v133, v49, v41
M a[12:15],a[128:131],a[172:175]
s_waitcnt lgkmcnt(8)
v_fmac_f32 v134, v49, v42
v_fmac_f32 v135, v49, v43
M a[28:31],a[140:143],a[188:191]
T a[128:129],v78,0
v_fmac_f32 v132, v105, v44
M a[28:31],a[136:139],a[172:175]
T a[130:131],v78,1024
v_fmac_f32 v133, v105, v45
M a[24:27],a[136:139],a[168:171]
buffer_load_dwordx4 v69, s[8:11], s67 offen offset:1024 lds
v_fmac_f32 v134, v105, v46
M a[24:27],a[140:143],a[184:187]
v_fmac_f32 v135, v105, v47
v_fmac_f32 v136, v50, v40
M a[20:23],a[140:143],a[180:183]
T a[132:133],v78,8192
v_fmac_f32 v137, v50, v41
M a[20:23],a[136:139],a[164:167]
T a[134:135],v78,9216
v_fmac_f32 v138, v50, v42
M a[16:19],a[136:139],a[160:163]
buffer_load_dwordx4 v70, s[8:11], s67 offen offset:2048 lds
v_fmac_f32 v139, v50, v43
M a[16:19],a[140:143],a[176:179]
s_waitcnt lgkmcnt(8)
v_fmac_f32 v136, v106, v44
v_fmac_f32 v137, v106, v45
M a[32:35],a[144:147],a[160:163]
T a[136:137],v78,8
v_fmac_f32 v138, v106, v46
M a[32:35],a[148:151],a[176:179]
T a[138:139],v78,1032
v_fmac_f32 v139, v106, v47
M a[36:39],a[148:151],a[180:183]
buffer_load_dwordx4 v71, s[8:11], s67 offen offset:3072 lds
v_fmac_f32 v140, v51, v40
M a[36:39],a[144:147],a[164:167]
s_add_u32 s67, s67, 458752
v_fmac_f32 v141, v51, v41
v_fmac_f32 v142, v51, v42
M a[40:43],a[144:147],a[168:171]
T a[140:141],v78,8200
v_fmac_f32 v143, v51, v43
M a[40:43],a[148:151],a[184:187]
s_add_u32 m0, s58, 0
T a[142:143],v78,9224
v_fmac_f32 v140, v107, v44
M a[44:47],a[148:151],a[188:191]
buffer_load_dwordx4 v64, s[4:7], s66 offen offset:0 lds
v_fmac_f32 v141, v107, v45
M a[44:47],a[144:147],a[172:175]
s_waitcnt lgkmcnt(8)
v_fmac_f32 v142, v107, v46
v_fmac_f32 v143, v107, v47
M a[60:63],a[156:159],a[188:191]
T a[144:145],v79,0
ds_read_b128 v[40:43], v99 offset:704
M a[60:63],a[152:155],a[172:175]
T a[146:147],v79,1024
ds_read_b128 v[44:47], v99 offset:1728
M a[56:59],a[152:155],a[168:171]
v_fmac_f32 v144, v48, v240
v_fmac_f32 v145, v48, v241
M a[56:59],a[156:159],a[184:187]
v_fmac_f32 v146, v48, v242
v_fmac_f32 v147, v48, v243
M a[52:55],a[156:159],a[180:183]
T a[148:149],v79,8192
v_fmac_f32 v144, v104, v244
M a[52:55],a[152:155],a[164:167]
T a[150:151],v79,9216
v_fmac_f32 v145, v104, v245
M a[48:51],a[152:155],a[160:163]
v_fmac_f32 v146, v104, v246
v_fmac_f32 v147, v104, v247
M a[48:51],a[156:159],a[176:179]
s_waitcnt lgkmcnt(10)
v_fmac_f32 v148, v49, v240
v_fmac_f32 v149, v49, v241
M a[64:67],a[128:131],a[160:163]
T a[152:153],v79,8
v_fmac_f32 v150, v49, v242
M a[64:67],a[132:135],a[176:179]
T a[154:155],v79,1032
v_fmac_f32 v151, v49, v243
M a[68:71],a[132:135],a[180:183]
v_fmac_f32 v148, v105, v244
v_fmac_f32 v149, v105, v245
M a[68:71],a[128:131],a[164:167]
v_fmac_f32 v150, v105, v246
v_fmac_f32 v151, v105, v247
M a[72:75],a[128:131],a[168:171]
T a[156:157],v79,8200
v_fmac_f32 v152, v50, v240
M a[72:75],a[132:135],a[184:187]
T a[158:159],v79,9224
v_fmac_f32 v153, v50, v241
M a[76:79],a[132:135],a[188:191]
v_fmac_f32 v154, v50, v242
v_fmac_f32 v155, v50, v243
M a[76:79],a[128:131],a[172:175]
s_waitcnt lgkmcnt(10)
v_fmac_f32 v152, v106, v244
v_fmac_f32 v153, v106, v245
M a[92:95],a[140:143],a[188:191]
T a[128:129],v88,16384
v_fmac_f32 v154, v106, v246
M a[92:95],a[136:139],a[172:175]
T a[130:131],v88,17408
v_fmac_f32 v155, v106, v247
M a[88:91],a[136:139],a[168:171]
v_fmac_f32 v156, v51, v240
v_fmac_f32 v157, v51, v241
M a[88:91],a[140:143],a[184:187]
v_fmac_f32 v158, v51, v242
v_fmac_f32 v159, v51, v243
M a[84:87],a[140:143],a[180:183]
T a[132:133],v88,24576
v_fmac_f32 v156, v107, v244
M a[84:87],a[136:139],a[164:167]
T a[134:135],v88,25600
v_fmac_f32 v157, v107, v245
M a[80:83],a[136:139],a[160:163]
v_fmac_f32 v158, v107, v246
v_fmac_f32 v159, v107, v247
M a[80:83],a[140:143],a[176:179]
s_waitcnt lgkmcnt(8)
ds_read_b128 v[240:243], v99 offset:768
ds_read_b128 v[244:247], v99 offset:1792
M a[96:99],a[144:147],a[160:163]
T a[136:137],v89,16384
v_fmac_f32 v160, v48, v248
M a[96:99],a[148:151],a[176:179]
T a[138:139],v89,17408
v_fmac_f32 v161, v48, v249
M a[100:103],a[148:151],a[180:183]
v_fmac_f32 v162, v48, v250
v_fmac_f32 v163, v48, v251
M a[100:103],a[144:147],a[164:167]
v_fmac_f32 v160, v104, v252
v_fmac_f32 v161, v104, v253
M a[104:107],a[144:147],a[168:171]
T a[140:141],v89,24576
v_fmac_f32 v162, v104, v254
M a[104:107],a[148:151],a[184:187]
T a[142:143],v89,25600
v_fmac_f32 v163, v104, v255
M a[108:111],a[148:151],a[188:191]
v_fmac_f32 v164, v49, v248
v_fmac_f32 v165, v49, v249
M a[108:111],a[144:147],a[172:175]
s_waitcnt lgkmcnt(10)
v_fmac_f32 v166, v49, v250
v_fmac_f32 v167, v49, v251
M a[124:127],a[156:159],a[188:191]
T a[144:145],v90,16384
v_fmac_f32 v164, v105, v252
M a[124:127],a[152:155],a[172:175]
T a[146:147],v90,17408
v_fmac_f32 v165, v105, v253
M a[120:123],a[152:155],a[168:171]
v_fmac_f32 v166, v105, v254
v_fmac_f32 v167, v105, v255
M a[120:123],a[156:159],a[184:187]
v_fmac_f32 v168, v50, v248
v_fmac_f32 v169, v50, v249
M a[116:119],a[156:159],a[180:183]
T a[148:149],v90,24576
v_fmac_f32 v170, v50, v250
M a[116:119],a[152:155],a[164:167]
T a[150:151],v90,25600
v_fmac_f32 v171, v50, v251
M a[112:115],a[152:155],a[160:163]
v_fmac_f32 v168, v106, v252
v_fmac_f32 v169, v106, v253
M a[112:115],a[156:159],a[176:179]
s_waitcnt lgkmcnt(10)
v_fmac_f32 v170, v106, v254
v_fmac_f32 v171, v106, v255
M v[128:131],a[128:131],a[160:163]
T a[152:153],v91,16384
v_fmac_f32 v172, v51, v248
M v[128:131],a[132:135],a[176:179]
T a[154:155],v91,17408
v_fmac_f32 v173, v51, v249
M v[132:135],a[132:135],a[180:183]
v_fmac_f32 v174, v51, v250
v_fmac_f32 v175, v51, v251
M v[132:135],a[128:131],a[164:167]
v_fmac_f32 v172, v107, v252
v_fmac_f32 v173, v107, v253
M v[136:139],a[128:131],a[168:171]
T a[156:157],v91,24576
v_fmac_f32 v174, v107, v254
M v[136:139],a[132:135],a[184:187]
T a[158:159],v91,25600
v_fmac_f32 v175, v107, v255
M v[140:143],a[132:135],a[188:191]
buffer_load_dwordx4 a[224:227], v58, s[12:15], s63 offen offset:0 sc1
ds_read_b128 v[248:251], v99 offset:832
M v[140:143],a[128:131],a[172:175]
ds_read_b128 v[252:255], v99 offset:1856
s_waitcnt lgkmcnt(10)
M v[156:159],a[140:143],a[188:191]
T a[128:129],v92,16384
v_fmac_f32 v176, v48, v40
M v[156:159],a[136:139],a[172:175]
T a[130:131],v92,17408
v_fmac_f32 v177, v48, v41
M v[152:155],a[136:139],a[168:171]
buffer_load_dwordx4 a[228:231], v58, s[12:15], s63 offen offset:1024 sc1
v_fmac_f32 v178, v48, v42
M v[152:155],a[140:143],a[184:187]
v_fmac_f32 v179, v48, v43
v_fmac_f32 v176, v104, v44
M v[148:151],a[140:143],a[180:183]
T a[132:133],v92,24576
v_fmac_f32 v177, v104, v45
M v[148:151],a[136:139],a[164:167]
T a[134:135],v92,25600
v_fmac_f32 v178, v104, v46
M v[144:147],a[136:139],a[160:163]
buffer_load_dwordx4 a[232:235], v59, s[12:15], s63 offen offset:0 sc1
v_fmac_f32 v179, v104, v47
M v[144:147],a[140:143],a[176:179]
s_waitcnt lgkmcnt(10)
v_fmac_f32 v180, v49, v40
v_fmac_f32 v181, v49, v41
M v[160:163],a[144:147],a[160:163]
T a[136:137],v93,16384
v_fmac_f32 v182, v49, v42
M v[160:163],a[148:151],a[176:179]
T a[138:139],v93,17408
v_fmac_f32 v183, v49, v43
M v[164:167],a[148:151],a[180:183]
buffer_load_dwordx4 a[236:239], v59, s[12:15], s63 offen offset:1024 sc1
v_fmac_f32 v180, v105, v44
M v[164:167],a[144:147],a[164:167]
s_add_u32 s63, s63, 4096
v_fmac_f32 v181, v105, v45
v_fmac_f32 v182, v105, v46
M v[168:171],a[144:147],a[168:171]
T a[140:141],v93,24576
v_fmac_f32 v183, v105, v47
M v[168:171],a[148:151],a[184:187]
T a[142:143],v93,25600
v_fmac_f32 v184, v50, v40
M v[172:175],a[148:151],a[188:191]
buffer_load_dwordx4 a[240:243], v58, s[12:15], s63 offen offset:0 sc1
v_fmac_f32 v185, v50, v41
M v[172:175],a[144:147],a[172:175]
s_waitcnt lgkmcnt(10)
v_fmac_f32 v186, v50, v42
v_fmac_f32 v187, v50, v43
M v[188:191],a[156:159],a[188:191]
T a[144:145],v94,16384
v_fmac_f32 v184, v106, v44
M v[188:191],a[152:155],a[172:175]
T a[146:147],v94,17408
v_fmac_f32 v185, v106, v45
s_nop 1
M v[184:187],a[152:155],a[168:171]
buffer_load_dwordx4 a[244:247], v58, s[12:15], s63 offen offset:1024 sc1
M v[184:187],a[156:159],a[184:187]
M v[180:183],a[156:159],a[180:183]
T a[148:149],v94,24576
v_fmac_f32 v188, v51, v40
M v[180:183],a[152:155],a[164:167]
T a[150:151],v94,25600
v_fmac_f32 v189, v51, v41
M v[176:179],a[152:155],a[160:163]
buffer_load_dwordx4 a[248:251], v59, s[12:15], s63 offen offset:0 sc1
v_fmac_f32 v186, v106, v46
M v[176:179],a[156:159],a[176:179]
s_waitcnt lgkmcnt(8)
v_fmac_f32 v187, v106, v47
v_fmac_f32 v190, v51, v42
M v[192:195],a[128:131],a[160:163]
T a[152:153],v95,16384
v_fmac_f32 v191, v51, v43
M v[192:195],a[132:135],a[176:179]
T a[154:155],v95,17408
v_fmac_f32 v188, v107, v44
M v[196:199],a[132:135],a[180:183]
buffer_load_dwordx4 a[252:255], v59, s[12:15], s63 offen offset:1024 sc1
v_fmac_f32 v189, v107, v45
M v[196:199],a[128:131],a[164:167]
s_add_u32 s63, s63, 4096
v_fmac_f32 v190, v107, v46
v_fmac_f32 v191, v107, v47
M v[200:203],a[128:131],a[168:171]
T a[156:157],v95,24576
ds_read_b128 v[40:43], v99 offset:896
M v[200:203],a[132:135],a[184:187]
T a[158:159],v95,25600
ds_read_b128 v[44:47], v99 offset:1920
M v[204:207],a[132:135],a[188:191]
v_fmac_f32 v192, v48, v240
v_fmac_f32 v193, v48, v241
M v[204:207],a[128:131],a[172:175]
s_waitcnt vmcnt(9)
s_barrier
s_waitcnt lgkmcnt(10)
M v[220:223],a[140:143],a[188:191]
T a[128:129],v76,32768
v_fmac_f32 v194, v48, v242
M v[220:223],a[136:139],a[172:175]
T a[130:131],v76,33792
v_fmac_f32 v195, v48, v243
M v[216:219],a[136:139],a[168:171]
buffer_load_dwordx4 v65, s[4:7], s66 offen offset:1024 lds
v_fmac_f32 v192, v104, v244
M v[216:219],a[140:143],a[184:187]
v_fmac_f32 v193, v104, v245
v_fmac_f32 v194, v104, v246
M v[212:215],a[140:143],a[180:183]
T a[132:133],v76,40960
v_fmac_f32 v195, v104, v247
M v[212:215],a[136:139],a[164:167]
T a[134:135],v76,41984
v_fmac_f32 v196, v49, v240
M v[208:211],a[136:139],a[160:163]
buffer_load_dwordx4 v66, s[4:7], s66 offen offset:2048 lds
v_fmac_f32 v197, v49, v241
M v[208:211],a[140:143],a[176:179]
s_waitcnt lgkmcnt(10)
v_fmac_f32 v198, v49, v242
v_fmac_f32 v199, v49, v243
M v[224:227],a[144:147],a[160:163]
T a[136:137],v76,32776
v_fmac_f32 v196, v105, v244
M v[224:227],a[148:151],a[176:179]
T a[138:139],v76,33800
v_fmac_f32 v197, v105, v245
M v[228:231],a[148:151],a[180:183]
T a[140:141],v76,40968
v_fmac_f32 v198, v105, v246
M v[228:231],a[144:147],a[164:167]
s_waitcnt lgkmcnt(8)
T a[142:143],v76,41992
v_fmac_f32 v199, v105, v247
M v[236:239],a[156:159],a[180:183]
T a[144:145],v77,32768
v_fmac_f32 v200, v50, v240
M v[236:239],a[152:155],a[164:167]
T a[146:147],v77,33792
v_fmac_f32 v201, v50, v241
M v[232:235],a[152:155],a[160:163]
T a[148:149],v77,40960
v_fmac_f32 v202, v50, v242
M v[232:235],a[156:159],a[176:179]
s_waitcnt vmcnt(18)
T a[150:151],v77,41984
s_waitcnt lgkmcnt(8)
M a[0:3],a[128:131],a[192:195]
T a[152:153],v77,32776
v_fmac_f32 v203, v50, v243
M a[0:3],a[132:135],a[208:211]
T a[154:155],v77,33800
v_fmac_f32 v200, v106, v244
M a[4:7],a[132:135],a[212:215]
buffer_load_dwordx4 v67, s[4:7], s66 offen offset:3072 lds
v_fmac_f32 v201, v106, v245
M a[4:7],a[128:131],a[196:199]
s_add_u32 s66, s66, 524288
v_fmac_f32 v202, v106, v246
v_fmac_f32 v203, v106, v247
M a[8:11],a[128:131],a[200:203]
T a[156:157],v77,40968
v_fmac_f32 v204, v51, v240
M a[8:11],a[132:135],a[216:219]
s_add_u32 m0, s58, 16384
T a[158:159],v77,41992
v_fmac_f32 v205, v51, v241
M a[12:15],a[132:135],a[220:223]
buffer_load_dwordx4 v68, s[8:11], s67 offen offset:0 lds
v_fmac_f32 v206, v51, v242
M a[12:15],a[128:131],a[204:207]
s_waitcnt lgkmcnt(8)
v_fmac_f32 v207, v51, v243
v_fmac_f32 v204, v107, v244
M a[28:31],a[140:143],a[220:223]
T a[128:129],v78,32768
v_fmac_f32 v205, v107, v245
M a[28:31],a[136:139],a[204:207]
T a[130:131],v78,33792
v_fmac_f32 v206, v107, v246
M a[24:27],a[136:139],a[200:203]
buffer_load_dwordx4 v69, s[8:11], s67 offen offset:1024 lds
v_fmac_f32 v207, v107, v247
M a[24:27],a[140:143],a[216:219]
ds_read_b128 v[240:243], v99 offset:960
ds_read_b128 v[244:247], v99 offset:1984
M a[20:23],a[140:143],a[212:215]
T a[132:133],v78,40960
v_fmac_f32 v208, v48, v248
M a[20:23],a[136:139],a[196:199]
T a[134:135],v78,41984
v_fmac_f32 v209, v48, v249
M a[16:19],a[136:139],a[192:195]
buffer_load_dwordx4 v70, s[8:11], s67 offen offset:2048 lds
v_fmac_f32 v210, v48, v250
M a[16:19],a[140:143],a[208:211]
s_waitcnt lgkmcnt(10)
v_fmac_f32 v211, v48, v251
v_fmac_f32 v208, v104, v252
M a[32:35],a[144:147],a[192:195]
T a[136:137],v78,32776
v_fmac_f32 v209, v104, v253
M a[32:35],a[148:151],a[208:211]
T a[138:139],v78,33800
v_fmac_f32 v210, v104, v254
M a[36:39],a[148:151],a[212:215]
buffer_load_dwordx4 v71, s[8:11], s67 offen offset:3072 lds
v_fmac_f32 v211, v104, v255
M a[36:39],a[144:147],a[196:199]
s_add_u32 s67, s67, 458752
v_fmac_f32 v212, v49, v248
v_fmac_f32 v213, v49, v249
M a[40:43],a[144:147],a[200:203]
T a[140:141],v78,40968
v_fmac_f32 v214, v49, v250
M a[40:43],a[148:151],a[216:219]
s_add_u32 m0, s58, 32768
T a[142:143],v78,41992
v_fmac_f32 v215, v49, v251
M a[44:47],a[148:151],a[220:223]
buffer_load_dwordx4 v64, s[4:7], s66 offen offset:0 lds
v_fmac_f32 v212, v105, v252
M a[44:47],a[144:147],a[204:207]
s_waitcnt lgkmcnt(10)
v_fmac_f32 v213, v105, v253
v_fmac_f32 v214, v105, v254
M a[60:63],a[156:159],a[220:223]
T a[144:145],v79,32768
v_fmac_f32 v215, v105, v255
M a[60:63],a[152:155],a[204:207]
T a[146:147],v79,33792
v_fmac_f32 v216, v50, v248
M a[56:59],a[152:155],a[200:203]
buffer_load_dword v97, v125, s[4:7], s68 offen
v_add_u32 v125, 1048576, v125
M a[56:59],a[156:159],a[216:219]
v_fmac_f32 v217, v50, v249
v_fmac_f32 v218, v50, v250
M a[52:55],a[156:159],a[212:215]
T a[148:149],v79,40960
v_fmac_f32 v219, v50, v251
M a[52:55],a[152:155],a[196:199]
T a[150:151],v79,41984
v_fmac_f32 v216, v106, v252
M a[48:51],a[152:155],a[192:195]
buffer_load_dword v97, v56, s[8:11], s69 offen
v_add_u32 v56, 917504, v56
M a[48:51],a[156:159],a[208:211]
s_waitcnt lgkmcnt(8)
v_fmac_f32 v217, v106, v253
v_fmac_f32 v218, v106, v254
M a[64:67],a[128:131],a[192:195]
T a[152:153],v79,32776
v_fmac_f32 v219, v106, v255
M a[64:67],a[132:135],a[208:211]
T a[154:155],v79,33800
v_fmac_f32 v220, v51, v248
M a[68:71],a[132:135],a[212:215]
v_fmac_f32 v221, v51, v249
v_fmac_f32 v222, v51, v250
M a[68:71],a[128:131],a[196:199]
v_fmac_f32 v223, v51, v251
v_fmac_f32 v220, v107, v252
M a[72:75],a[128:131],a[200:203]
T a[156:157],v79,40968
v_fmac_f32 v221, v107, v253
M a[72:75],a[132:135],a[216:219]
T a[158:159],v79,41992
v_fmac_f32 v222, v107, v254
M a[76:79],a[132:135],a[220:223]
v_fmac_f32 v223, v107, v255
M a[76:79],a[128:131],a[204:207]
s_waitcnt lgkmcnt(8)
v_fmac_f32 v224, v48, v40
v_fmac_f32 v225, v48, v41
M a[92:95],a[140:143],a[220:223]
T a[128:129],v88,49152
v_fmac_f32 v226, v48, v42
M a[92:95],a[136:139],a[204:207]
T a[130:131],v88,50176
v_fmac_f32 v227, v48, v43
M a[88:91],a[136:139],a[200:203]
v_fmac_f32 v224, v104, v44
v_fmac_f32 v225, v104, v45
M a[88:91],a[140:143],a[216:219]
v_fmac_f32 v226, v104, v46
v_fmac_f32 v227, v104, v47
M a[84:87],a[140:143],a[212:215]
T a[132:133],v88,57344
v_fmac_f32 v228, v49, v40
M a[84:87],a[136:139],a[196:199]
T a[134:135],v88,58368
v_fmac_f32 v229, v49, v41
M a[80:83],a[136:139],a[192:195]
v_fmac_f32 v230, v49, v42
v_fmac_f32 v231, v49, v43
M a[80:83],a[140:143],a[208:211]
s_waitcnt lgkmcnt(8)
v_fmac_f32 v228, v105, v44
v_fmac_f32 v229, v105, v45
M a[96:99],a[144:147],a[192:195]
T a[136:137],v89,49152
v_fmac_f32 v230, v105, v46
M a[96:99],a[148:151],a[208:211]
T a[138:139],v89,50176
v_fmac_f32 v231, v105, v47
M a[100:103],a[148:151],a[212:215]
v_fmac_f32 v232, v48, v240
v_fmac_f32 v233, v48, v241
M a[100:103],a[144:147],a[196:199]
s_and_b32 s21, s21, 0xffff
v_fmac_f32 v234, v48, v242
v_fmac_f32 v235, v48, v243
M a[104:107],a[144:147],a[200:203]
s_mov_b32 s22, 2097152
T a[140:141],v89,57344
v_fmac_f32 v232, v104, v244
M a[104:107],a[148:151],a[216:219]
s_mov_b32 s23, 0x20000
T a[142:143],v89,58368
v_fmac_f32 v233, v104, v245
M a[108:111],a[148:151],a[220:223]
s_and_b32 s25, s25, 0xffff
v_fmac_f32 v234, v104, v246
v_fmac_f32 v235, v104, v247
M a[108:111],a[144:147],a[204:207]
s_waitcnt lgkmcnt(8)
v_fmac_f32 v236, v49, v240
v_fmac_f32 v237, v49, v241
M a[124:127],a[156:159],a[220:223]
s_mov_b32 s26, 2097152
T a[144:145],v90,49152
v_fmac_f32 v238, v49, v242
M a[124:127],a[152:155],a[204:207]
s_mov_b32 s27, 0x20000
T a[146:147],v90,50176
v_fmac_f32 v239, v49, v243
M a[120:123],a[152:155],a[200:203]
s_and_b32 s29, s29, 0xffff
v_fmac_f32 v236, v105, v244
v_fmac_f32 v237, v105, v245
M a[120:123],a[156:159],a[216:219]
s_mov_b32 s30, 8388608
v_fmac_f32 v238, v105, v246
v_fmac_f32 v239, v105, v247
M a[116:119],a[156:159],a[212:215]
s_mov_b32 s31, 0x20000
T a[148:149],v90,57344
s_and_b32 s33, s33, 0xffff
M a[116:119],a[152:155],a[196:199]
s_mov_b32 s34, 7340032
T a[150:151],v90,58368
s_mov_b32 s35, 0x20000
M a[112:115],a[152:155],a[192:195]
s_and_b32 s41, s41, 0xffff
s_mov_b32 s42, 4194304
s_mov_b32 s43, 0x20000
M a[112:115],a[156:159],a[208:211]
s_and_b32 s49, s49, 0xffff
s_mov_b32 s50, 2048
s_waitcnt lgkmcnt(8)
M v[128:131],a[128:131],a[192:195]
s_mov_b32 s51, 0x20000
T a[152:153],v91,49152
s_lshl_b32 s59, s52, 11
M v[128:131],a[132:135],a[208:211]
s_lshl_b32 s60, s52, 13
T a[154:155],v91,50176
v_lshrrev_b32 v116, 4, v0
M v[132:135],a[132:135],a[212:215]
s_lshl_b32 s70, s55, 1
v_and_b32 v117, 15, v0
v_and_b32 v118, 3, v0
M v[132:135],a[128:131],a[196:199]
L_pad22:
s_cbranch_execz L_px0
s_add_u32 s70, s70, 2
v_lshlrev_b32 v15, 10, v118
v_lshlrev_b32 v119, 8, v117
M v[136:139],a[128:131],a[200:203]
s_add_u32 s71, s70, 0
T a[156:157],v91,57344
v_lshrrev_b32 v120, 6, v14
M v[136:139],a[132:135],a[216:219]
s_and_b32 s71, s71, 7
T a[158:159],v91,58368
v_xor_b32 v120, v120, v116
M v[140:143],a[132:135],a[220:223]
buffer_load_dwordx4 a[160:163], v58, s[12:15], s63 offen offset:0 sc1
v_xor_b32 v121, 0, v120
M v[140:143],a[128:131],a[204:207]
s_waitcnt lgkmcnt(8)
v_lshl_add_u32 v32, v121, 4, v119
v_add_u32 v36, 0x10000, v32
M v[156:159],a[140:143],a[220:223]
T a[128:129],v92,49152
v_xor_b32 v121, 4, v120
M v[156:159],a[136:139],a[204:207]
T a[130:131],v92,50176
v_lshl_add_u32 v33, v121, 4, v119
M v[152:155],a[136:139],a[200:203]
buffer_load_dwordx4 a[164:167], v58, s[12:15], s63 offen offset:1024 sc1
v_add_u32 v37, 0x10000, v33
M v[152:155],a[140:143],a[216:219]
v_xor_b32 v121, 8, v120
v_lshl_add_u32 v34, v121, 4, v119
M v[148:151],a[140:143],a[212:215]
T a[132:133],v92,57344
v_add_u32 v38, 0x10000, v34
M v[148:151],a[136:139],a[196:199]
T a[134:135],v92,58368
v_xor_b32 v121, 12, v120
M v[144:147],a[136:139],a[192:195]
buffer_load_dwordx4 a[168:171], v59, s[12:15], s63 offen offset:0 sc1
v_lshl_add_u32 v35, v121, 4, v119
M v[144:147],a[140:143],a[208:211]
s_waitcnt lgkmcnt(8)
v_add_u32 v39, 0x10000, v35
v_lshrrev_b32 v120, 2, v0
M v[160:163],a[144:147],a[192:195]
T a[136:137],v93,49152
v_lshlrev_b32 v119, 8, v120
M v[160:163],a[148:151],a[208:211]
T a[138:139],v93,50176
v_lshl_add_u32 v119, v118, 3, v119
M v[164:167],a[148:151],a[212:215]
buffer_load_dwordx4 a[172:175], v59, s[12:15], s63 offen offset:1024 sc1
v_and_b32 v120, 7, v120
M v[164:167],a[144:147],a[196:199]
s_add_u32 s63, s63, 4096
v_xor_b32 v121, s71, v120
v_lshl_add_u32 v16, v121, 5, v119
M v[168:171],a[144:147],a[200:203]
s_add_u32 s71, s70, 1
T a[140:141],v93,57344
v_add_u32 v24, 0x10000, v16
M v[168:171],a[148:151],a[216:219]
s_and_b32 s71, s71, 7
T a[142:143],v93,58368
v_xor_b32 v121, s71, v120
M v[172:175],a[148:151],a[220:223]
s_add_u32 s71, s70, 2
buffer_load_dwordx4 a[176:179], v58, s[12:15], s63 offen offset:0 sc1
v_lshl_add_u32 v17, v121, 5, v119
M v[172:175],a[144:147],a[204:207]
s_and_b32 s71, s71, 7
v_add_u32 v25, 0x10000, v17
s_waitcnt lgkmcnt(8)
M v[188:191],a[156:159],a[220:223]
s_xor_b32 s72, s56, 2
T a[144:145],v94,49152
v_xor_b32 v121, s71, v120
M v[188:191],a[152:155],a[204:207]
s_add_u32 s71, s70, 3
T a[146:147],v94,50176
v_lshl_add_u32 v18, v121, 5, v119
M v[184:187],a[152:155],a[200:203]
s_and_b32 s71, s71, 7
buffer_load_dwordx4 a[180:183], v58, s[12:15], s63 offen offset:1024 sc1
v_add_u32 v26, 0x10000, v18
M v[184:187],a[156:159],a[216:219]
s_lshl_b32 s72, s72, 8
v_xor_b32 v121, s71, v120
v_lshl_add_u32 v19, v121, 5, v119
M v[180:183],a[156:159],a[212:215]
s_add_u32 s71, s70, 4
T a[148:149],v94,57344
v_add_u32 v27, 0x10000, v19
M v[180:183],a[152:155],a[196:199]
s_and_b32 s71, s71, 7
T a[150:151],v94,58368
v_xor_b32 v121, s71, v120
M v[176:179],a[152:155],a[192:195]
s_add_u32 s71, s70, 5
buffer_load_dwordx4 a[184:187], v59, s[12:15], s63 offen offset:0 sc1
v_lshl_add_u32 v20, v121, 5, v119
M v[176:179],a[156:159],a[208:211]
s_and_b32 s71, s71, 7
v_add_u32 v28, 0x10000, v20
s_waitcnt lgkmcnt(8)
M v[192:195],a[128:131],a[192:195]
T a[152:153],v95,49152
v_xor_b32 v121, s71, v120
M v[192:195],a[132:135],a[208:211]
s_add_u32 s71, s70, 6
T a[154:155],v95,50176
v_lshl_add_u32 v21, v121, 5, v119
M v[196:199],a[132:135],a[212:215]
s_and_b32 s71, s71, 7
buffer_load_dwordx4 a[188:191], v59, s[12:15], s63 offen offset:1024 sc1
v_add_u32 v29, 0x10000, v21
M v[196:199],a[128:131],a[196:199]
s_add_u32 s63, s63, 4096
v_xor_b32 v121, s71, v120
v_lshl_add_u32 v22, v121, 5, v119
M v[200:203],a[128:131],a[200:203]
s_add_u32 s71, s70, 7
T a[156:157],v95,57344
v_add_u32 v30, 0x10000, v22
M v[200:203],a[132:135],a[216:219]
s_and_b32 s71, s71, 7
T a[158:159],v95,58368
v_xor_b32 v121, s71, v120
M v[204:207],a[132:135],a[220:223]
s_lshl_b32 s70, s55, 19
v_lshl_add_u32 v23, v121, 5, v119
v_add_u32 v31, 0x10000, v23
M v[204:207],a[128:131],a[204:207]
s_waitcnt vmcnt(11)
s_barrier
s_waitcnt lgkmcnt(8)
M v[220:223],a[140:143],a[220:223]
s_add_u32 s70, s70, s59
T a[128:129],v72,0
s_add_u32 s70, s70, 393216
M v[220:223],a[136:139],a[204:207]
s_lshr_b32 s71, s2, 3
T a[130:131],v72,1024
s_lshl_b32 s71, s71, 12
M v[216:219],a[136:139],a[200:203]
s_add_u32 s78, s70, s71
buffer_load_dwordx4 v65, s[4:7], s66 offen offset:1024 lds
s_lshl_b32 s71, s52, 10
M v[216:219],a[140:143],a[216:219]
s_sub_u32 s78, s78, s71
s_lshl_b32 s71, s52, 16
s_add_u32 s71, s71, s72
M v[212:215],a[140:143],a[212:215]
s_mov_b32 s61, 0
T a[132:133],v72,8192
v_or_b32 v118, 0, v116
M v[212:215],a[136:139],a[196:199]
s_lshl_b32 s62, s54, 18
T a[134:135],v72,9216
v_lshlrev_b32 v118, 1, v118
M v[208:211],a[136:139],a[192:195]
buffer_load_dwordx4 v66, s[4:7], s66 offen offset:2048 lds
v_xor_b32 v118, v117, v118
M v[208:211],a[140:143],a[208:211]
s_waitcnt lgkmcnt(8)
v_lshlrev_b32 v118, 4, v118
v_lshl_add_u32 v120, v116, 8, v118
M v[224:227],a[144:147],a[192:195]
T a[136:137],v72,8
v_add_u32 v9, s70, v120
M v[224:227],a[148:151],a[208:211]
T a[138:139],v72,1032
v_subrev_u32 v11, 16384, v9
M v[228:231],a[148:151],a[212:215]
T a[140:141],v72,8200
v_lshl_add_u32 v120, v116, 11, v118
M v[228:231],a[144:147],a[196:199]
s_waitcnt lgkmcnt(7)
T a[142:143],v72,9224
v_add_u32 v120, s71, v120
M v[236:239],a[156:159],a[212:215]
T a[144:145],v73,0
v_add_u32 v1, 0, v120
M v[236:239],a[152:155],a[196:199]
T a[146:147],v73,1024
v_add_u32 v3, 14336, v120
M v[232:235],a[152:155],a[192:195]
T a[148:149],v73,8192
v_add_u32 v5, 32768, v120
M v[232:235],a[156:159],a[208:211]
s_waitcnt vmcnt(20)
T a[150:151],v73,9216
s_waitcnt lgkmcnt(8)
M a[0:3],a[128:131],a[224:227]
T a[152:153],v73,8
v_add_u32 v7, 47104, v120
M a[0:3],a[132:135],a[240:243]
T a[154:155],v73,1032
v_or_b32 v118, 4, v116
M a[4:7],a[132:135],a[244:247]
buffer_load_dwordx4 v67, s[4:7], s66 offen offset:3072 lds
v_lshlrev_b32 v118, 1, v118
M a[4:7],a[128:131],a[228:231]
s_add_u32 s66, s66, 524288
v_xor_b32 v118, v117, v118
v_lshlrev_b32 v118, 4, v118
M a[8:11],a[128:131],a[232:235]
T a[156:157],v73,8200
v_lshl_add_u32 v120, v116, 8, v118
M a[8:11],a[132:135],a[248:251]
s_add_u32 m0, s58, 49152
T a[158:159],v73,9224
v_add_u32 v10, s70, v120
M a[12:15],a[132:135],a[252:255]
buffer_load_dwordx4 v68, s[8:11], s67 offen offset:0 lds
v_subrev_u32 v12, 16384, v10
M a[12:15],a[128:131],a[236:239]
s_waitcnt lgkmcnt(8)
v_lshl_add_u32 v120, v116, 11, v118
v_add_u32 v120, s71, v120
M a[28:31],a[140:143],a[252:255]
T a[128:129],v74,0
v_add_u32 v2, 7168, v120
M a[28:31],a[136:139],a[236:239]
T a[130:131],v74,1024
v_add_u32 v4, 21504, v120
M a[24:27],a[136:139],a[232:235]
buffer_load_dwordx4 v69, s[8:11], s67 offen offset:1024 lds
v_add_u32 v6, 39936, v120
M a[24:27],a[140:143],a[248:251]
v_add_u32 v8, 54272, v120
M a[20:23],a[140:143],a[244:247]
T a[132:133],v74,8192
M a[20:23],a[136:139],a[228:231]
T a[134:135],v74,9216
M a[16:19],a[136:139],a[224:227]
buffer_load_dwordx4 v70, s[8:11], s67 offen offset:2048 lds
M a[16:19],a[140:143],a[240:243]
s_waitcnt lgkmcnt(8)
M a[32:35],a[144:147],a[224:227]
T a[136:137],v74,8
M a[32:35],a[148:151],a[240:243]
T a[138:139],v74,1032
M a[36:39],a[148:151],a[244:247]
buffer_load_dwordx4 v71, s[8:11], s67 offen offset:3072 lds
s_add_u32 s67, s67, 458752
M a[36:39],a[144:147],a[228:231]
M a[40:43],a[144:147],a[232:235]
T a[140:141],v74,8200
M a[40:43],a[148:151],a[248:251]
s_add_u32 m0, s58, 65536
T a[142:143],v74,9224
M a[44:47],a[148:151],a[252:255]
buffer_load_dwordx4 v64, s[4:7], s66 offen offset:0 lds
M a[44:47],a[144:147],a[236:239]
s_waitcnt lgkmcnt(8)
M a[60:63],a[156:159],a[252:255]
T a[144:145],v75,0
M a[60:63],a[152:155],a[236:239]
T a[146:147],v75,1024
M a[56:59],a[152:155],a[232:235]
M a[56:59],a[156:159],a[248:251]
M a[52:55],a[156:159],a[244:247]
T a[148:149],v75,8192
M a[52:55],a[152:155],a[228:231]
T a[150:151],v75,9216
M a[48:51],a[152:155],a[224:227]
M a[48:51],a[156:159],a[240:243]
s_waitcnt lgkmcnt(8)
M a[64:67],a[128:131],a[224:227]
T a[152:153],v75,8
M a[64:67],a[132:135],a[240:243]
T a[154:155],v75,1032
M a[68:71],a[132:135],a[244:247]
M a[68:71],a[128:131],a[228:231]
M a[72:75],a[128:131],a[232:235]
T a[156:157],v75,8200
M a[72:75],a[132:135],a[248:251]
T a[158:159],v75,9224
M a[76:79],a[132:135],a[252:255]
M a[76:79],a[128:131],a[236:239]
s_waitcnt lgkmcnt(8)
M a[92:95],a[140:143],a[252:255]
T a[128:129],v80,16384
M a[92:95],a[136:139],a[236:239]
T a[130:131],v80,17408
M a[88:91],a[136:139],a[232:235]
M a[88:91],a[140:143],a[248:251]
M a[84:87],a[140:143],a[244:247]
T a[132:133],v80,24576
M a[84:87],a[136:139],a[228:231]
T a[134:135],v80,25600
M a[80:83],a[136:139],a[224:227]
M a[80:83],a[140:143],a[240:243]
s_waitcnt lgkmcnt(8)
M a[96:99],a[144:147],a[224:227]
T a[136:137],v81,16384
M a[96:99],a[148:151],a[240:243]
T a[138:139],v81,17408
M a[100:103],a[148:151],a[244:247]
M a[100:103],a[144:147],a[228:231]
M a[104:107],a[144:147],a[232:235]
T a[140:141],v81,24576
M a[104:107],a[148:151],a[248:251]
T a[142:143],v81,25600
M a[108:111],a[148:151],a[252:255]
M a[108:111],a[144:147],a[236:239]
s_waitcnt lgkmcnt(8)
M a[124:127],a[156:159],a[252:255]
T a[144:145],v82,16384
M a[124:127],a[152:155],a[236:239]
T a[146:147],v82,17408
M a[120:123],a[152:155],a[232:235]
M a[120:123],a[156:159],a[248:251]
M a[116:119],a[156:159],a[244:247]
T a[148:149],v82,24576
M a[116:119],a[152:155],a[228:231]
T a[150:151],v82,25600
M a[112:115],a[152:155],a[224:227]
M a[112:115],a[156:159],a[240:243]
s_waitcnt lgkmcnt(8)
M v[128:131],a[128:131],a[224:227]
T a[152:153],v83,16384
M v[128:131],a[132:135],a[240:243]
T a[154:155],v83,17408
M v[132:135],a[132:135],a[244:247]
M v[132:135],a[128:131],a[228:231]
M v[136:139],a[128:131],a[232:235]
T a[156:157],v83,24576
M v[136:139],a[132:135],a[248:251]
T a[158:159],v83,25600
M v[140:143],a[132:135],a[252:255]
buffer_load_dwordx4 a[192:195], v58, s[12:15], s63 offen offset:0 sc1
M v[140:143],a[128:131],a[236:239]
s_waitcnt lgkmcnt(8)
M v[156:159],a[140:143],a[252:255]
T a[128:129],v84,16384
M v[156:159],a[136:139],a[236:239]
T a[130:131],v84,17408
M v[152:155],a[136:139],a[232:235]
buffer_load_dwordx4 a[196:199], v58, s[12:15], s63 offen offset:1024 sc1
M v[152:155],a[140:143],a[248:251]
M v[148:151],a[140:143],a[244:247]
T a[132:133],v84,24576
M v[148:151],a[136:139],a[228:231]
T a[134:135],v84,25600
M v[144:147],a[136:139],a[224:227]
buffer_load_dwordx4 a[200:203], v59, s[12:15], s63 offen offset:0 sc1
M v[144:147],a[140:143],a[240:243]
s_waitcnt lgkmcnt(8)
M v[160:163],a[144:147],a[224:227]
T a[136:137],v85,16384
M v[160:163],a[148:151],a[240:243]
T a[138:139],v85,17408
M v[164:167],a[148:151],a[244:247]
buffer_load_dwordx4 a[204:207], v59, s[12:15], s63 offen offset:1024 sc1
s_add_u32 s63, s63, 4096
M v[164:167],a[144:147],a[228:231]
M v[168:171],a[144:147],a[232:235]
T a[140:141],v85,24576
M v[168:171],a[148:151],a[248:251]
T a[142:143],v85,25600
M v[172:175],a[148:151],a[252:255]
buffer_load_dwordx4 a[208:211], v58, s[12:15], s63 offen offset:0 sc1
M v[172:175],a[144:147],a[236:239]
s_waitcnt lgkmcnt(8)
M v[188:191],a[156:159],a[252:255]
T a[144:145],v86,16384
M v[188:191],a[152:155],a[236:239]
T a[146:147],v86,17408
M v[184:187],a[152:155],a[232:235]
buffer_load_dwordx4 a[212:215], v58, s[12:15], s63 offen offset:1024 sc1
M v[184:187],a[156:159],a[248:251]
M v[180:183],a[156:159],a[244:247]
T a[148:149],v86,24576
M v[180:183],a[152:155],a[228:231]
T a[150:151],v86,25600
M v[176:179],a[152:155],a[224:227]
buffer_load_dwordx4 a[216:219], v59, s[12:15], s63 offen offset:0 sc1
M v[176:179],a[156:159],a[240:243]
s_waitcnt lgkmcnt(8)
M v[192:195],a[128:131],a[224:227]
T a[152:153],v87,16384
M v[192:195],a[132:135],a[240:243]
T a[154:155],v87,17408
M v[196:199],a[132:135],a[244:247]
buffer_load_dwordx4 a[220:223], v59, s[12:15], s63 offen offset:1024 sc1
s_add_u32 s63, s63, 4096
M v[196:199],a[128:131],a[228:231]
M v[200:203],a[128:131],a[232:235]
T a[156:157],v87,24576
M v[200:203],a[132:135],a[248:251]
T a[158:159],v87,25600
M v[204:207],a[132:135],a[252:255]
M v[204:207],a[128:131],a[236:239]
s_waitcnt vmcnt(9)
s_barrier
s_waitcnt lgkmcnt(8)
M v[220:223],a[140:143],a[252:255]
T a[128:129],v72,32768
M v[220:223],a[136:139],a[236:239]
T a[130:131],v72,33792
M v[216:219],a[136:139],a[232:235]
buffer_load_dwordx4 v65, s[4:7], s66 offen offset:1024 lds
M v[216:219],a[140:143],a[248:251]
M v[212:215],a[140:143],a[244:247]
T a[132:133],v72,40960
M v[212:215],a[136:139],a[228:231]
T a[134:135],v72,41984
M v[208:211],a[136:139],a[224:227]
buffer_load_dwordx4 v66, s[4:7], s66 offen offset:2048 lds
M v[208:211],a[140:143],a[240:243]
s_waitcnt lgkmcnt(8)
M v[224:227],a[144:147],a[224:227]
T a[136:137],v72,32776
M v[224:227],a[148:151],a[240:243]
T a[138:139],v72,33800
M v[228:231],a[148:151],a[244:247]
T a[140:141],v72,40968
M v[228:231],a[144:147],a[228:231]
T a[142:143],v72,41992
s_waitcnt lgkmcnt(8)
M v[236:239],a[156:159],a[244:247]
T a[144:145],v73,32768
M v[236:239],a[152:155],a[228:231]
T a[146:147],v73,33792
M v[232:235],a[152:155],a[224:227]
T a[148:149],v73,40960
M v[232:235],a[156:159],a[240:243]
s_waitcnt vmcnt(18)
T a[150:151],v73,41984
s_waitcnt lgkmcnt(8)
M a[0:3],a[128:131],a[160:163]
T a[152:153],v73,32776
M a[0:3],a[132:135],a[176:179]
T a[154:155],v73,33800
M a[4:7],a[132:135],a[180:183]
buffer_load_dwordx4 v67, s[4:7], s66 offen offset:3072 lds
s_add_u32 s66, s66, 524288
M a[4:7],a[128:131],a[164:167]
M a[8:11],a[128:131],a[168:171]
T a[156:157],v73,40968
M a[8:11],a[132:135],a[184:187]
s_add_u32 m0, s58, 81920
T a[158:159],v73,41992
M a[12:15],a[132:135],a[188:191]
buffer_load_dwordx4 v68, s[8:11], s67 offen offset:0 lds
M a[12:15],a[128:131],a[172:175]
s_waitcnt lgkmcnt(8)
M a[28:31],a[140:143],a[188:191]
T a[128:129],v74,32768
M a[28:31],a[136:139],a[172:175]
T a[130:131],v74,33792
M a[24:27],a[136:139],a[168:171]
buffer_load_dwordx4 v69, s[8:11], s67 offen offset:1024 lds
M a[24:27],a[140:143],a[184:187]
M a[20:23],a[140:143],a[180:183]
T a[132:133],v74,40960
M a[20:23],a[136:139],a[164:167]
T a[134:135],v74,41984
M a[16:19],a[136:139],a[160:163]
buffer_load_dwordx4 v70, s[8:11], s67 offen offset:2048 lds
M a[16:19],a[140:143],a[176:179]
s_waitcnt lgkmcnt(8)
M a[32:35],a[144:147],a[160:163]
T a[136:137],v74,32776
M a[32:35],a[148:151],a[176:179]
T a[138:139],v74,33800
M a[36:39],a[148:151],a[180:183]
buffer_load_dwordx4 v71, s[8:11], s67 offen offset:3072 lds
s_add_u32 s67, s67, 458752
M a[36:39],a[144:147],a[164:167]
M a[40:43],a[144:147],a[168:171]
T a[140:141],v74,40968
M a[40:43],a[148:151],a[184:187]
s_add_u32 m0, s58, 98304
T a[142:143],v74,41992
M a[44:47],a[148:151],a[188:191]
buffer_load_dwordx4 v64, s[4:7], s66 offen offset:0 lds
M a[44:47],a[144:147],a[172:175]
s_waitcnt lgkmcnt(8)
M a[60:63],a[156:159],a[188:191]
T a[144:145],v75,32768
M a[60:63],a[152:155],a[172:175]
T a[146:147],v75,33792
M a[56:59],a[152:155],a[168:171]
buffer_load_dword v97, v125, s[4:7], s68 offen
v_add_u32 v125, 1048576, v125
M a[56:59],a[156:159],a[184:187]
M a[52:55],a[156:159],a[180:183]
T a[148:149],v75,40960
M a[52:55],a[152:155],a[164:167]
T a[150:151],v75,41984
M a[48:51],a[152:155],a[160:163]
buffer_load_dword v97, v56, s[8:11], s69 offen
v_add_u32 v56, 917504, v56
M a[48:51],a[156:159],a[176:179]
s_waitcnt lgkmcnt(8)
M a[64:67],a[128:131],a[160:163]
T a[152:153],v75,32776
M a[64:67],a[132:135],a[176:179]
T a[154:155],v75,33800
M a[68:71],a[132:135],a[180:183]
M a[68:71],a[128:131],a[164:167]
M a[72:75],a[128:131],a[168:171]
T a[156:157],v75,40968
M a[72:75],a[132:135],a[184:187]
T a[158:159],v75,41992
M a[76:79],a[132:135],a[188:191]
M a[76:79],a[128:131],a[172:175]
s_waitcnt lgkmcnt(8)
M a[92:95],a[140:143],a[188:191]
T a[128:129],v80,49152
M a[92:95],a[136:139],a[172:175]
T a[130:131],v80,50176
M a[88:91],a[136:139],a[168:171]
M a[88:91],a[140:143],a[184:187]
M a[84:87],a[140:143],a[180:183]
T a[132:133],v80,57344
M a[84:87],a[136:139],a[164:167]
T a[134:135],v80,58368
M a[80:83],a[136:139],a[160:163]
M a[80:83],a[140:143],a[176:179]
s_waitcnt lgkmcnt(8)
M a[96:99],a[144:147],a[160:163]
T a[136:137],v81,49152
M a[96:99],a[148:151],a[176:179]
T a[138:139],v81,50176
M a[100:103],a[148:151],a[180:183]
M a[100:103],a[144:147],a[164:167]
M a[104:107],a[144:147],a[168:171]
T a[140:141],v81,57344
M a[104:107],a[148:151],a[184:187]
T a[142:143],v81,58368
M a[108:111],a[148:151],a[188:191]
M a[108:111],a[144:147],a[172:175]
s_waitcnt lgkmcnt(8)
M a[124:127],a[156:159],a[188:191]
T a[144:145],v82,49152
M a[124:127],a[152:155],a[172:175]
T a[146:147],v82,50176
M a[120:123],a[152:155],a[168:171]
M a[120:123],a[156:159],a[184:187]
M a[116:119],a[156:159],a[180:183]
T a[148:149],v82,57344
M a[116:119],a[152:155],a[164:167]
T a[150:151],v82,58368
M a[112:115],a[152:155],a[160:163]
M a[112:115],a[156:159],a[176:179]
s_waitcnt lgkmcnt(8)
M v[128:131],a[128:131],a[160:163]
T a[152:153],v83,49152
M v[128:131],a[132:135],a[176:179]
T a[154:155],v83,50176
M v[132:135],a[132:135],a[180:183]
M v[132:135],a[128:131],a[164:167]
M v[136:139],a[128:131],a[168:171]
T a[156:157],v83,57344
M v[136:139],a[132:135],a[184:187]
T a[158:159],v83,58368
M v[140:143],a[132:135],a[188:191]
buffer_load_dwordx4 a[224:227], v58, s[12:15], s63 offen offset:0 sc1
M v[140:143],a[128:131],a[172:175]
L_pad23:
s_cbranch_execz L_px1
s_waitcnt lgkmcnt(8)
M v[156:159],a[140:143],a[188:191]
T a[128:129],v84,49152
M v[156:159],a[136:139],a[172:175]
T a[130:131],v84,50176
M v[152:155],a[136:139],a[168:171]
buffer_load_dwordx4 a[228:231], v58, s[12:15], s63 offen offset:1024 sc1
M v[152:155],a[140:143],a[184:187]
M v[148:151],a[140:143],a[180:183]
T a[132:133],v84,57344
M v[148:151],a[136:139],a[164:167]
T a[134:135],v84,58368
M v[144:147],a[136:139],a[160:163]
buffer_load_dwordx4 a[232:235], v59, s[12:15], s63 offen offset:0 sc1
M v[144:147],a[140:143],a[176:179]
s_waitcnt lgkmcnt(8)
M v[160:163],a[144:147],a[160:163]
T a[136:137],v85,49152
M v[160:163],a[148:151],a[176:179]
T a[138:139],v85,50176
M v[164:167],a[148:151],a[180:183]
buffer_load_dwordx4 a[236:239], v59, s[12:15], s63 offen offset:1024 sc1
s_add_u32 s63, s63, 4096
M v[164:167],a[144:147],a[164:167]
M v[168:171],a[144:147],a[168:171]
T a[140:141],v85,57344
M v[168:171],a[148:151],a[184:187]
T a[142:143],v85,58368
M v[172:175],a[148:151],a[188:191]
buffer_load_dwordx4 a[240:243], v58, s[12:15], s63 offen offset:0 sc1
M v[172:175],a[144:147],a[172:175]
s_waitcnt lgkmcnt(8)
M v[188:191],a[156:159],a[188:191]
T a[144:145],v86,49152
M v[188:191],a[152:155],a[172:175]
T a[146:147],v86,50176
M v[184:187],a[152:155],a[168:171]
buffer_load_dwordx4 a[244:247], v58, s[12:15], s63 offen offset:1024 sc1
M v[184:187],a[156:159],a[184:187]
M v[180:183],a[156:159],a[180:183]
T a[148:149],v86,57344
M v[180:183],a[152:155],a[164:167]
T a[150:151],v86,58368
M v[176:179],a[152:155],a[160:163]
buffer_load_dwordx4 a[248:251], v59, s[12:15], s63 offen offset:0 sc1
M v[176:179],a[156:159],a[176:179]
s_waitcnt lgkmcnt(8)
M v[192:195],a[128:131],a[160:163]
T a[152:153],v87,49152
M v[192:195],a[132:135],a[176:179]
T a[154:155],v87,50176
M v[196:199],a[132:135],a[180:183]
buffer_load_dwordx4 a[252:255], v59, s[12:15], s63 offen offset:1024 sc1
s_add_u32 s63, s63, 4096
M v[196:199],a[128:131],a[164:167]
M v[200:203],a[128:131],a[168:171]
T a[156:157],v87,57344
M v[200:203],a[132:135],a[184:187]
T a[158:159],v87,58368
M v[204:207],a[132:135],a[188:191]
M v[204:207],a[128:131],a[172:175]
s_waitcnt vmcnt(11)
s_barrier
s_waitcnt lgkmcnt(8)
M v[220:223],a[140:143],a[188:191]
T a[128:129],v76,0
M v[220:223],a[136:139],a[172:175]
T a[130:131],v76,1024
M v[216:219],a[136:139],a[168:171]
buffer_load_dwordx4 v65, s[4:7], s66 offen offset:1024 lds
M v[216:219],a[140:143],a[184:187]
M v[212:215],a[140:143],a[180:183]
T a[132:133],v76,8192
M v[212:215],a[136:139],a[164:167]
T a[134:135],v76,9216
M v[208:211],a[136:139],a[160:163]
buffer_load_dwordx4 v66, s[4:7], s66 offen offset:2048 lds
M v[208:211],a[140:143],a[176:179]
s_waitcnt lgkmcnt(8)
M v[224:227],a[144:147],a[160:163]
T a[136:137],v76,8
M v[224:227],a[148:151],a[176:179]
T a[138:139],v76,1032
M v[228:231],a[148:151],a[180:183]
T a[140:141],v76,8200
M v[228:231],a[144:147],a[164:167]
T a[142:143],v76,9224
s_waitcnt lgkmcnt(8)
M v[236:239],a[156:159],a[180:183]
T a[144:145],v77,0
M v[236:239],a[152:155],a[164:167]
T a[146:147],v77,1024
M v[232:235],a[152:155],a[160:163]
T a[148:149],v77,8192
M v[232:235],a[156:159],a[176:179]
s_waitcnt vmcnt(20)
T a[150:151],v77,9216
s_waitcnt lgkmcnt(8)
M a[0:3],a[128:131],a[192:195]
T a[152:153],v77,8
M a[0:3],a[132:135],a[208:211]
T a[154:155],v77,1032
M a[4:7],a[132:135],a[212:215]
buffer_load_dwordx4 v67, s[4:7], s66 offen offset:3072 lds
s_add_u32 s66, s66, 524288
M a[4:7],a[128:131],a[196:199]
M a[8:11],a[128:131],a[200:203]
T a[156:157],v77,8200
M a[8:11],a[132:135],a[216:219]
s_add_u32 m0, s58, 114688
T a[158:159],v77,9224
M a[12:15],a[132:135],a[220:223]
buffer_load_dwordx4 v68, s[8:11], s67 offen offset:0 lds
M a[12:15],a[128:131],a[204:207]
s_waitcnt lgkmcnt(8)
M a[28:31],a[140:143],a[220:223]
T a[128:129],v78,0
M a[28:31],a[136:139],a[204:207]
T a[130:131],v78,1024
M a[24:27],a[136:139],a[200:203]
buffer_load_dwordx4 v69, s[8:11], s67 offen offset:1024 lds
M a[24:27],a[140:143],a[216:219]
M a[20:23],a[140:143],a[212:215]
T a[132:133],v78,8192
M a[20:23],a[136:139],a[196:199]
T a[134:135],v78,9216
M a[16:19],a[136:139],a[192:195]
buffer_load_dwordx4 v70, s[8:11], s67 offen offset:2048 lds
M a[16:19],a[140:143],a[208:211]
s_waitcnt lgkmcnt(8)
M a[32:35],a[144:147],a[192:195]
T a[136:137],v78,8
M a[32:35],a[148:151],a[208:211]
T a[138:139],v78,1032
M a[36:39],a[148:151],a[212:215]
buffer_load_dwordx4 v71, s[8:11], s67 offen offset:3072 lds
s_add_u32 s67, s67, 458752
M a[36:39],a[144:147],a[196:199]
M a[40:43],a[144:147],a[200:203]
T a[140:141],v78,8200
M a[40:43],a[148:151],a[216:219]
s_add_u32 m0, s58, 0
T a[142:143],v78,9224
M a[44:47],a[148:151],a[220:223]
buffer_load_dwordx4 v64, s[4:7], s66 offen offset:0 lds
M a[44:47],a[144:147],a[204:207]
s_waitcnt lgkmcnt(8)
M a[60:63],a[156:159],a[220:223]
T a[144:145],v79,0
M a[60:63],a[152:155],a[204:207]
T a[146:147],v79,1024
M a[56:59],a[152:155],a[200:203]
buffer_load_dword v97, v13, s[20:23], s78 offen
M a[56:59],a[156:159],a[216:219]
M a[52:55],a[156:159],a[212:215]
T a[148:149],v79,8192
M a[52:55],a[152:155],a[196:199]
T a[150:151],v79,9216
M a[48:51],a[152:155],a[192:195]
buffer_load_dword v97, v13, s[24:27], s78 offen
M a[48:51],a[156:159],a[208:211]
s_waitcnt lgkmcnt(8)
M a[64:67],a[128:131],a[192:195]
T a[152:153],v79,8
M a[64:67],a[132:135],a[208:211]
T a[154:155],v79,1032
M a[68:71],a[132:135],a[212:215]
M a[68:71],a[128:131],a[196:199]
M a[72:75],a[128:131],a[200:203]
T a[156:157],v79,8200
M a[72:75],a[132:135],a[216:219]
T a[158:159],v79,9224
M a[76:79],a[132:135],a[220:223]
M a[76:79],a[128:131],a[204:207]
s_waitcnt lgkmcnt(8)
M a[92:95],a[140:143],a[220:223]
T a[128:129],v88,16384
M a[92:95],a[136:139],a[204:207]
T a[130:131],v88,17408
M a[88:91],a[136:139],a[200:203]
M a[88:91],a[140:143],a[216:219]
M a[84:87],a[140:143],a[212:215]
T a[132:133],v88,24576
M a[84:87],a[136:139],a[196:199]
T a[134:135],v88,25600
M a[80:83],a[136:139],a[192:195]
M a[80:83],a[140:143],a[208:211]
s_waitcnt lgkmcnt(8)
M a[96:99],a[144:147],a[192:195]
T a[136:137],v89,16384
M a[96:99],a[148:151],a[208:211]
T a[138:139],v89,17408
M a[100:103],a[148:151],a[212:215]
M a[100:103],a[144:147],a[196:199]
M a[104:107],a[144:147],a[200:203]
T a[140:141],v89,24576
M a[104:107],a[148:151],a[216:219]
T a[142:143],v89,25600
M a[108:111],a[148:151],a[220:223]
M a[108:111],a[144:147],a[204:207]
s_waitcnt lgkmcnt(8)
M a[124:127],a[156:159],a[220:223]
T a[144:145],v90,16384
M a[124:127],a[152:155],a[204:207]
T a[146:147],v90,17408
M a[120:123],a[152:155],a[200:203]
M a[120:123],a[156:159],a[216:219]
M a[116:119],a[156:159],a[212:215]
T a[148:149],v90,24576
M a[116:119],a[152:155],a[196:199]
T a[150:151],v90,25600
M a[112:115],a[152:155],a[192:195]
M a[112:115],a[156:159],a[208:211]
s_waitcnt lgkmcnt(8)
M v[128:131],a[128:131],a[192:195]
T a[152:153],v91,16384
M v[128:131],a[132:135],a[208:211]
T a[154:155],v91,17408
M v[132:135],a[132:135],a[212:215]
M v[132:135],a[128:131],a[196:199]
M v[136:139],a[128:131],a[200:203]
T a[156:157],v91,24576
M v[136:139],a[132:135],a[216:219]
T a[158:159],v91,25600
M v[140:143],a[132:135],a[220:223]
buffer_load_dwordx4 a[160:163], v58, s[12:15], s63 offen offset:0 sc1
M v[140:143],a[128:131],a[204:207]
s_waitcnt lgkmcnt(8)
M v[156:159],a[140:143],a[220:223]
T a[128:129],v92,16384
M v[156:159],a[136:139],a[204:207]
T a[130:131],v92,17408
M v[152:155],a[136:139],a[200:203]
buffer_load_dwordx4 a[164:167], v58, s[12:15], s63 offen offset:1024 sc1
M v[152:155],a[140:143],a[216:219]
M v[148:151],a[140:143],a[212:215]
T a[132:133],v92,24576
M v[148:151],a[136:139],a[196:199]
T a[134:135],v92,25600
M v[144:147],a[136:139],a[192:195]
buffer_load_dwordx4 a[168:171], v59, s[12:15], s63 offen offset:0 sc1
M v[144:147],a[140:143],a[208:211]
s_waitcnt lgkmcnt(8)
M v[160:163],a[144:147],a[192:195]
T a[136:137],v93,16384
M v[160:163],a[148:151],a[208:211]
T a[138:139],v93,17408
M v[164:167],a[148:151],a[212:215]
buffer_load_dwordx4 a[172:175], v59, s[12:15], s63 offen offset:1024 sc1
s_add_u32 s63, s63, 4096
M v[164:167],a[144:147],a[196:199]
M v[168:171],a[144:147],a[200:203]
T a[140:141],v93,24576
M v[168:171],a[148:151],a[216:219]
T a[142:143],v93,25600
M v[172:175],a[148:151],a[220:223]
buffer_load_dwordx4 a[176:179], v58, s[12:15], s63 offen offset:0 sc1
M v[172:175],a[144:147],a[204:207]
s_waitcnt lgkmcnt(8)
M v[188:191],a[156:159],a[220:223]
T a[144:145],v94,16384
M v[188:191],a[152:155],a[204:207]
T a[146:147],v94,17408
M v[184:187],a[152:155],a[200:203]
buffer_load_dwordx4 a[180:183], v58, s[12:15], s63 offen offset:1024 sc1
M v[184:187],a[156:159],a[216:219]
M v[180:183],a[156:159],a[212:215]
T a[148:149],v94,24576
M v[180:183],a[152:155],a[196:199]
T a[150:151],v94,25600
M v[176:179],a[152:155],a[192:195]
buffer_load_dwordx4 a[184:187], v59, s[12:15], s63 offen offset:0 sc1
M v[176:179],a[156:159],a[208:211]
s_waitcnt lgkmcnt(8)
M v[192:195],a[128:131],a[192:195]
T a[152:153],v95,16384
M v[192:195],a[132:135],a[208:211]
T a[154:155],v95,17408
M v[196:199],a[132:135],a[212:215]
buffer_load_dwordx4 a[188:191], v59, s[12:15], s63 offen offset:1024 sc1
s_add_u32 s63, s63, 4096
M v[196:199],a[128:131],a[196:199]
M v[200:203],a[128:131],a[200:203]
T a[156:157],v95,24576
M v[200:203],a[132:135],a[216:219]
T a[158:159],v95,25600
M v[204:207],a[132:135],a[220:223]
M v[204:207],a[128:131],a[204:207]
s_waitcnt vmcnt(11)
s_barrier
s_waitcnt lgkmcnt(8)
M v[220:223],a[140:143],a[220:223]
T a[128:129],v76,32768
M v[220:223],a[136:139],a[204:207]
T a[130:131],v76,33792
M v[216:219],a[136:139],a[200:203]
buffer_load_dwordx4 v65, s[4:7], s66 offen offset:1024 lds
M v[216:219],a[140:143],a[216:219]
M v[212:215],a[140:143],a[212:215]
T a[132:133],v76,40960
M v[212:215],a[136:139],a[196:199]
T a[134:135],v76,41984
M v[208:211],a[136:139],a[192:195]
buffer_load_dwordx4 v66, s[4:7], s66 offen offset:2048 lds
M v[208:211],a[140:143],a[208:211]
s_waitcnt lgkmcnt(8)
M v[224:227],a[144:147],a[192:195]
T a[136:137],v76,32776
M v[224:227],a[148:151],a[208:211]
T a[138:139],v76,33800
M v[228:231],a[148:151],a[212:215]
T a[140:141],v76,40968
M v[228:231],a[144:147],a[196:199]
T a[142:143],v76,41992
s_waitcnt lgkmcnt(8)
M v[236:239],a[156:159],a[212:215]
T a[144:145],v77,32768
M v[236:239],a[152:155],a[196:199]
T a[146:147],v77,33792
M v[232:235],a[152:155],a[192:195]
T a[148:149],v77,40960
M v[232:235],a[156:159],a[208:211]
s_waitcnt vmcnt(20)
T a[150:151],v77,41984
s_waitcnt lgkmcnt(8)
M a[0:3],a[128:131],a[224:227]
T a[152:153],v77,32776
M a[0:3],a[132:135],a[240:243]
T a[154:155],v77,33800
M a[4:7],a[132:135],a[244:247]
buffer_load_dwordx4 v67, s[4:7], s66 offen offset:3072 lds
s_add_u32 s66, s66, 524288
M a[4:7],a[128:131],a[228:231]
M a[8:11],a[128:131],a[232:235]
T a[156:157],v77,40968
M a[8:11],a[132:135],a[248:251]
s_add_u32 m0, s58, 16384
T a[158:159],v77,41992
M a[12:15],a[132:135],a[252:255]
buffer_load_dwordx4 v68, s[8:11], s67 offen offset:0 lds
M a[12:15],a[128:131],a[236:239]
s_waitcnt lgkmcnt(8)
M a[28:31],a[140:143],a[252:255]
T a[128:129],v78,32768
M a[28:31],a[136:139],a[236:239]
T a[130:131],v78,33792
M a[24:27],a[136:139],a[232:235]
buffer_load_dwordx4 v69, s[8:11], s67 offen offset:1024 lds
M a[24:27],a[140:143],a[248:251]
M a[20:23],a[140:143],a[244:247]
T a[132:133],v78,40960
M a[20:23],a[136:139],a[228:231]
T a[134:135],v78,41984
M a[16:19],a[136:139],a[224:227]
buffer_load_dwordx4 v70, s[8:11], s67 offen offset:2048 lds
M a[16:19],a[140:143],a[240:243]
s_waitcnt lgkmcnt(8)
M a[32:35],a[144:147],a[224:227]
T a[136:137],v78,32776
M a[32:35],a[148:151],a[240:243]
T a[138:139],v78,33800
M a[36:39],a[148:151],a[244:247]
buffer_load_dwordx4 v71, s[8:11], s67 offen offset:3072 lds
s_add_u32 s67, s67, 458752
M a[36:39],a[144:147],a[228:231]
M a[40:43],a[144:147],a[232:235]
T a[140:141],v78,40968
M a[40:43],a[148:151],a[248:251]
s_add_u32 m0, s58, 32768
T a[142:143],v78,41992
M a[44:47],a[148:151],a[252:255]
buffer_load_dwordx4 v64, s[4:7], s66 offen offset:0 lds
M a[44:47],a[144:147],a[236:239]
s_waitcnt lgkmcnt(8)
M a[60:63],a[156:159],a[252:255]
T a[144:145],v79,32768
M a[60:63],a[152:155],a[236:239]
T a[146:147],v79,33792
M a[56:59],a[152:155],a[232:235]
buffer_load_dword v97, v125, s[4:7], s68 offen
v_add_u32 v125, 1048576, v125
M a[56:59],a[156:159],a[248:251]
M a[52:55],a[156:159],a[244:247]
T a[148:149],v79,40960
M a[52:55],a[152:155],a[228:231]
T a[150:151],v79,41984
M a[48:51],a[152:155],a[224:227]
buffer_load_dword v97, v56, s[8:11], s69 offen
v_add_u32 v56, 917504, v56
M a[48:51],a[156:159],a[240:243]
s_waitcnt lgkmcnt(8)
M a[64:67],a[128:131],a[224:227]
T a[152:153],v79,32776
M a[64:67],a[132:135],a[240:243]
T a[154:155],v79,33800
M a[68:71],a[132:135],a[244:247]
M a[68:71],a[128:131],a[228:231]
M a[72:75],a[128:131],a[232:235]
T a[156:157],v79,40968
M a[72:75],a[132:135],a[248:251]
T a[158:159],v79,41992
M a[76:79],a[132:135],a[252:255]
M a[76:79],a[128:131],a[236:239]
s_waitcnt lgkmcnt(8)
M a[92:95],a[140:143],a[252:255]
T a[128:129],v88,49152
M a[92:95],a[136:139],a[236:239]
T a[130:131],v88,50176
M a[88:91],a[136:139],a[232:235]
M a[88:91],a[140:143],a[248:251]
M a[84:87],a[140:143],a[244:247]
T a[132:133],v88,57344
M a[84:87],a[136:139],a[228:231]
T a[134:135],v88,58368
M a[80:83],a[136:139],a[224:227]
M a[80:83],a[140:143],a[240:243]
s_waitcnt lgkmcnt(8)
M a[96:99],a[144:147],a[224:227]
T a[136:137],v89,49152
M a[96:99],a[148:151],a[240:243]
T a[138:139],v89,50176
M a[100:103],a[148:151],a[244:247]
M a[100:103],a[144:147],a[228:231]
M a[104:107],a[144:147],a[232:235]
T a[140:141],v89,57344
M a[104:107],a[148:151],a[248:251]
T a[142:143],v89,58368
M a[108:111],a[148:151],a[252:255]
M a[108:111],a[144:147],a[236:239]
s_waitcnt lgkmcnt(8)
M a[124:127],a[156:159],a[252:255]
T a[144:145],v90,49152
M a[124:127],a[152:155],a[236:239]
T a[146:147],v90,50176
M a[120:123],a[152:155],a[232:235]
M a[120:123],a[156:159],a[248:251]
M a[116:119],a[156:159],a[244:247]
T a[148:149],v90,57344
M a[116:119],a[152:155],a[228:231]
T a[150:151],v90,58368
M a[112:115],a[152:155],a[224:227]
M a[112:115],a[156:159],a[240:243]
s_waitcnt lgkmcnt(8)
M v[128:131],a[128:131],a[224:227]
T a[152:153],v91,49152
M v[128:131],a[132:135],a[240:243]
T a[154:155],v91,50176
M v[132:135],a[132:135],a[244:247]
M v[132:135],a[128:131],a[228:231]
M v[136:139],a[128:131],a[232:235]
T a[156:157],v91,57344
M v[136:139],a[132:135],a[248:251]
T a[158:159],v91,58368
M v[140:143],a[132:135],a[252:255]
buffer_load_dwordx4 a[192:195], v58, s[12:15], s63 offen offset:0 sc1
M v[140:143],a[128:131],a[236:239]
s_waitcnt lgkmcnt(8)
M v[156:159],a[140:143],a[252:255]
T a[128:129],v92,49152
M v[156:159],a[136:139],a[236:239]
T a[130:131],v92,50176
M v[152:155],a[136:139],a[232:235]
buffer_load_dwordx4 a[196:199], v58, s[12:15], s63 offen offset:1024 sc1
M v[152:155],a[140:143],a[248:251]
M v[148:151],a[140:143],a[244:247]
T a[132:133],v92,57344
M v[148:151],a[136:139],a[228:231]
T a[134:135],v92,58368
M v[144:147],a[136:139],a[224:227]
buffer_load_dwordx4 a[200:203], v59, s[12:15], s63 offen offset:0 sc1
M v[144:147],a[140:143],a[240:243]
s_waitcnt lgkmcnt(8)
M v[160:163],a[144:147],a[224:227]
T a[136:137],v93,49152
M v[160:163],a[148:151],a[240:243]
T a[138:139],v93,50176
M v[164:167],a[148:151],a[244:247]
buffer_load_dwordx4 a[204:207], v59, s[12:15], s63 offen offset:1024 sc1
s_add_u32 s63, s63, 4096
M v[164:167],a[144:147],a[228:231]
M v[168:171],a[144:147],a[232:235]
T a[140:141],v93,57344
M v[168:171],a[148:151],a[248:251]
T a[142:143],v93,58368
M v[172:175],a[148:151],a[252:255]
buffer_load_dwordx4 a[208:211], v58, s[12:15], s63 offen offset:0 sc1
M v[172:175],a[144:147],a[236:239]
s_waitcnt lgkmcnt(8)
M v[188:191],a[156:159],a[252:255]
T a[144:145],v94,49152
M v[188:191],a[152:155],a[236:239]
T a[146:147],v94,50176
M v[184:187],a[152:155],a[232:235]
buffer_load_dwordx4 a[212:215], v58, s[12:15], s63 offen offset:1024 sc1
M v[184:187],a[156:159],a[248:251]
M v[180:183],a[156:159],a[244:247]
T a[148:149],v94,57344
M v[180:183],a[152:155],a[228:231]
T a[150:151],v94,58368
M v[176:179],a[152:155],a[224:227]
buffer_load_dwordx4 a[216:219], v59, s[12:15], s63 offen offset:0 sc1
M v[176:179],a[156:159],a[240:243]
s_waitcnt lgkmcnt(8)
M v[192:195],a[128:131],a[224:227]
T a[152:153],v95,49152
M v[192:195],a[132:135],a[240:243]
T a[154:155],v95,50176
M v[196:199],a[132:135],a[244:247]
buffer_load_dwordx4 a[220:223], v59, s[12:15], s63 offen offset:1024 sc1
s_add_u32 s63, s63, 4096
M v[196:199],a[128:131],a[228:231]
M v[200:203],a[128:131],a[232:235]
T a[156:157],v95,57344
M v[200:203],a[132:135],a[248:251]
T a[158:159],v95,58368
M v[204:207],a[132:135],a[252:255]
M v[204:207],a[128:131],a[236:239]
s_waitcnt vmcnt(11)
s_barrier
s_waitcnt lgkmcnt(8)
M v[220:223],a[140:143],a[252:255]
T a[128:129],v72,0
M v[220:223],a[136:139],a[236:239]
T a[130:131],v72,1024
M v[216:219],a[136:139],a[232:235]
buffer_load_dwordx4 v65, s[4:7], s66 offen offset:1024 lds
M v[216:219],a[140:143],a[248:251]
M v[212:215],a[140:143],a[244:247]
T a[132:133],v72,8192
M v[212:215],a[136:139],a[228:231]
T a[134:135],v72,9216
M v[208:211],a[136:139],a[224:227]
buffer_load_dwordx4 v66, s[4:7], s66 offen offset:2048 lds
M v[208:211],a[140:143],a[240:243]
L_pad24:
s_cbranch_execz L_px2
s_waitcnt lgkmcnt(8)
M v[224:227],a[144:147],a[224:227]
T a[136:137],v72,8
M v[224:227],a[148:151],a[240:243]
T a[138:139],v72,1032
M v[228:231],a[148:151],a[244:247]
T a[140:141],v72,8200
M v[228:231],a[144:147],a[228:231]
T a[142:143],v72,9224
s_waitcnt lgkmcnt(8)
M v[236:239],a[156:159],a[244:247]
T a[144:145],v73,0
M v[236:239],a[152:155],a[228:231]
T a[146:147],v73,1024
M v[232:235],a[152:155],a[224:227]
T a[148:149],v73,8192
M v[232:235],a[156:159],a[240:243]
T a[150:151],v73,9216
s_barrier
s_waitcnt vmcnt(20)
s_waitcnt lgkmcnt(8)
M a[0:3],a[128:131],a[160:163]
T a[152:153],v73,8
M a[0:3],a[132:135],a[176:179]
T a[154:155],v73,1032
M a[4:7],a[132:135],a[180:183]
buffer_load_dwordx4 v67, s[4:7], s66 offen offset:3072 lds
s_add_u32 s66, s66, 524288
M a[4:7],a[128:131],a[164:167]
M a[8:11],a[128:131],a[168:171]
T a[156:157],v73,8200
M a[8:11],a[132:135],a[184:187]
s_add_u32 m0, s58, 49152
T a[158:159],v73,9224
M a[12:15],a[132:135],a[188:191]
buffer_load_dwordx4 v68, s[8:11], s67 offen offset:0 lds
M a[12:15],a[128:131],a[172:175]
s_waitcnt lgkmcnt(8)
M a[28:31],a[140:143],a[188:191]
T a[128:129],v74,0
M a[28:31],a[136:139],a[172:175]
T a[130:131],v74,1024
M a[24:27],a[136:139],a[168:171]
buffer_load_dwordx4 v69, s[8:11], s67 offen offset:1024 lds
M a[24:27],a[140:143],a[184:187]
M a[20:23],a[140:143],a[180:183]
T a[132:133],v74,8192
M a[20:23],a[136:139],a[164:167]
T a[134:135],v74,9216
M a[16:19],a[136:139],a[160:163]
buffer_load_dwordx4 v70, s[8:11], s67 offen offset:2048 lds
M a[16:19],a[140:143],a[176:179]
s_waitcnt lgkmcnt(8)
M a[32:35],a[144:147],a[160:163]
T a[136:137],v74,8
M a[32:35],a[148:151],a[176:179]
T a[138:139],v74,1032
M a[36:39],a[148:151],a[180:183]
buffer_load_dwordx4 v71, s[8:11], s67 offen offset:3072 lds
s_add_u32 s67, s67, 458752
M a[36:39],a[144:147],a[164:167]
M a[40:43],a[144:147],a[168:171]
T a[140:141],v74,8200
M a[40:43],a[148:151],a[184:187]
s_add_u32 m0, s58, 65536
T a[142:143],v74,9224
M a[44:47],a[148:151],a[188:191]
buffer_load_dwordx4 v64, s[4:7], s66 offen offset:0 lds
M a[44:47],a[144:147],a[172:175]
s_waitcnt lgkmcnt(8)
M a[60:63],a[156:159],a[188:191]
T a[144:145],v75,0
M a[60:63],a[152:155],a[172:175]
T a[146:147],v75,1024
M a[56:59],a[152:155],a[168:171]
buffer_load_dwordx4 v65, s[4:7], s66 offen offset:1024 lds
M a[56:59],a[156:159],a[184:187]
M a[52:55],a[156:159],a[180:183]
T a[148:149],v75,8192
M a[52:55],a[152:155],a[164:167]
T a[150:151],v75,9216
M a[48:51],a[152:155],a[160:163]
buffer_load_dwordx4 v66, s[4:7], s66 offen offset:2048 lds
M a[48:51],a[156:159],a[176:179]
s_waitcnt lgkmcnt(8)
M a[64:67],a[128:131],a[160:163]
T a[152:153],v75,8
M a[64:67],a[132:135],a[176:179]
T a[154:155],v75,1032
M a[68:71],a[132:135],a[180:183]
buffer_load_dwordx4 v67, s[4:7], s66 offen offset:3072 lds
s_add_u32 s66, s66, 524288
M a[68:71],a[128:131],a[164:167]
M a[72:75],a[128:131],a[168:171]
T a[156:157],v75,8200
M a[72:75],a[132:135],a[184:187]
s_add_u32 m0, s58, 81920
T a[158:159],v75,9224
M a[76:79],a[132:135],a[188:191]
buffer_load_dwordx4 v68, s[8:11], s67 offen offset:0 lds
M a[76:79],a[128:131],a[172:175]
s_waitcnt lgkmcnt(8)
M a[92:95],a[140:143],a[188:191]
T a[128:129],v80,16384
M a[92:95],a[136:139],a[172:175]
T a[130:131],v80,17408
M a[88:91],a[136:139],a[168:171]
buffer_load_dwordx4 v69, s[8:11], s67 offen offset:1024 lds
M a[88:91],a[140:143],a[184:187]
M a[84:87],a[140:143],a[180:183]
T a[132:133],v80,24576
M a[84:87],a[136:139],a[164:167]
T a[134:135],v80,25600
M a[80:83],a[136:139],a[160:163]
buffer_load_dwordx4 v70, s[8:11], s67 offen offset:2048 lds
M a[80:83],a[140:143],a[176:179]
s_waitcnt lgkmcnt(8)
M a[96:99],a[144:147],a[160:163]
T a[136:137],v81,16384
M a[96:99],a[148:151],a[176:179]
T a[138:139],v81,17408
M a[100:103],a[148:151],a[180:183]
buffer_load_dwordx4 v71, s[8:11], s67 offen offset:3072 lds
s_add_u32 s67, s67, 458752
M a[100:103],a[144:147],a[164:167]
M a[104:107],a[144:147],a[168:171]
T a[140:141],v81,24576
M a[104:107],a[148:151],a[184:187]
s_add_u32 m0, s58, 98304
T a[142:143],v81,25600
M a[108:111],a[148:151],a[188:191]
buffer_load_dwordx4 v64, s[4:7], s66 offen offset:0 lds
M a[108:111],a[144:147],a[172:175]
s_waitcnt lgkmcnt(8)
M a[124:127],a[156:159],a[188:191]
T a[144:145],v82,16384
M a[124:127],a[152:155],a[172:175]
T a[146:147],v82,17408
M a[120:123],a[152:155],a[168:171]
buffer_load_dwordx4 v65, s[4:7], s66 offen offset:1024 lds
M a[120:123],a[156:159],a[184:187]
M a[116:119],a[156:159],a[180:183]
T a[148:149],v82,24576
M a[116:119],a[152:155],a[164:167]
T a[150:151],v82,25600
M a[112:115],a[152:155],a[160:163]
buffer_load_dwordx4 v66, s[4:7], s66 offen offset:2048 lds
M a[112:115],a[156:159],a[176:179]
s_waitcnt lgkmcnt(8)
M v[128:131],a[128:131],a[160:163]
T a[152:153],v83,16384
M v[128:131],a[132:135],a[176:179]
T a[154:155],v83,17408
M v[132:135],a[132:135],a[180:183]
M v[132:135],a[128:131],a[164:167]
M v[136:139],a[128:131],a[168:171]
T a[156:157],v83,24576
M v[136:139],a[132:135],a[184:187]
T a[158:159],v83,25600
M v[140:143],a[132:135],a[188:191]
buffer_load_dwordx4 a[224:227], v58, s[12:15], s63 offen offset:0 sc1
M v[140:143],a[128:131],a[172:175]
s_waitcnt lgkmcnt(8)
M v[156:159],a[140:143],a[188:191]
T a[128:129],v84,16384
M v[156:159],a[136:139],a[172:175]
T a[130:131],v84,17408
M v[152:155],a[136:139],a[168:171]
buffer_load_dwordx4 a[228:231], v58, s[12:15], s63 offen offset:1024 sc1
M v[152:155],a[140:143],a[184:187]
M v[148:151],a[140:143],a[180:183]
T a[132:133],v84,24576
M v[148:151],a[136:139],a[164:167]
T a[134:135],v84,25600
M v[144:147],a[136:139],a[160:163]
buffer_load_dwordx4 a[232:235], v59, s[12:15], s63 offen offset:0 sc1
M v[144:147],a[140:143],a[176:179]
s_waitcnt lgkmcnt(8)
M v[160:163],a[144:147],a[160:163]
T a[136:137],v85,16384
M v[160:163],a[148:151],a[176:179]
T a[138:139],v85,17408
M v[164:167],a[148:151],a[180:183]
buffer_load_dwordx4 a[236:239], v59, s[12:15], s63 offen offset:1024 sc1
s_add_u32 s63, s63, 4096
M v[164:167],a[144:147],a[164:167]
M v[168:171],a[144:147],a[168:171]
T a[140:141],v85,24576
M v[168:171],a[148:151],a[184:187]
T a[142:143],v85,25600
M v[172:175],a[148:151],a[188:191]
buffer_load_dwordx4 a[240:243], v58, s[12:15], s63 offen offset:0 sc1
M v[172:175],a[144:147],a[172:175]
s_waitcnt lgkmcnt(8)
M v[188:191],a[156:159],a[188:191]
T a[144:145],v86,16384
M v[188:191],a[152:155],a[172:175]
T a[146:147],v86,17408
M v[184:187],a[152:155],a[168:171]
buffer_load_dwordx4 a[244:247], v58, s[12:15], s63 offen offset:1024 sc1
M v[184:187],a[156:159],a[184:187]
M v[180:183],a[156:159],a[180:183]
T a[148:149],v86,24576
M v[180:183],a[152:155],a[164:167]
T a[150:151],v86,25600
M v[176:179],a[152:155],a[160:163]
buffer_load_dwordx4 a[248:251], v59, s[12:15], s63 offen offset:0 sc1
M v[176:179],a[156:159],a[176:179]
s_waitcnt lgkmcnt(8)
M v[192:195],a[128:131],a[160:163]
T a[152:153],v87,16384
M v[192:195],a[132:135],a[176:179]
T a[154:155],v87,17408
M v[196:199],a[132:135],a[180:183]
buffer_load_dwordx4 a[252:255], v59, s[12:15], s63 offen offset:1024 sc1
s_add_u32 s63, s63, 4096
M v[196:199],a[128:131],a[164:167]
M v[200:203],a[128:131],a[168:171]
T a[156:157],v87,24576
M v[200:203],a[132:135],a[184:187]
T a[158:159],v87,25600
M v[204:207],a[132:135],a[188:191]
M v[204:207],a[128:131],a[172:175]
s_waitcnt vmcnt(19)
s_barrier
s_waitcnt lgkmcnt(8)
M v[220:223],a[140:143],a[188:191]
T a[128:129],v80,49152
M v[220:223],a[136:139],a[172:175]
T a[130:131],v80,50176
M v[216:219],a[136:139],a[168:171]
buffer_load_dwordx4 v67, s[4:7], s66 offen offset:3072 lds
s_add_u32 s66, s66, 524288
M v[216:219],a[140:143],a[184:187]
M v[212:215],a[140:143],a[180:183]
T a[132:133],v80,57344
M v[212:215],a[136:139],a[164:167]
s_add_u32 m0, s58, 114688
T a[134:135],v80,58368
M v[208:211],a[136:139],a[160:163]
buffer_load_dwordx4 v68, s[8:11], s67 offen offset:0 lds
M v[208:211],a[140:143],a[176:179]
s_waitcnt lgkmcnt(8)
M v[224:227],a[144:147],a[160:163]
T a[136:137],v81,49152
M v[224:227],a[148:151],a[176:179]
T a[138:139],v81,50176
M v[228:231],a[148:151],a[180:183]
T a[140:141],v81,57344
M v[228:231],a[144:147],a[164:167]
T a[142:143],v81,58368
s_waitcnt lgkmcnt(8)
M v[236:239],a[156:159],a[180:183]
T a[144:145],v82,49152
M v[236:239],a[152:155],a[164:167]
T a[146:147],v82,50176
M v[232:235],a[152:155],a[160:163]
T a[148:149],v82,57344
M v[232:235],a[156:159],a[176:179]
s_waitcnt vmcnt(28)
T a[150:151],v82,58368
s_waitcnt lgkmcnt(8)
M v[128:131],a[128:131],a[192:195]
T a[152:153],v83,49152
M v[128:131],a[132:135],a[208:211]
T a[154:155],v83,50176
M v[132:135],a[132:135],a[212:215]
buffer_load_dwordx4 a[160:163], v58, s[12:15], s63 offen offset:0 sc1
M v[132:135],a[128:131],a[196:199]
M v[136:139],a[128:131],a[200:203]
T a[156:157],v83,57344
M v[136:139],a[132:135],a[216:219]
T a[158:159],v83,58368
M v[140:143],a[132:135],a[220:223]
buffer_load_dwordx4 a[164:167], v58, s[12:15], s63 offen offset:1024 sc1
M v[140:143],a[128:131],a[204:207]
s_waitcnt lgkmcnt(8)
M v[156:159],a[140:143],a[220:223]
T a[128:129],v84,49152
M v[156:159],a[136:139],a[204:207]
T a[130:131],v84,50176
M v[152:155],a[136:139],a[200:203]
buffer_load_dwordx4 a[168:171], v59, s[12:15], s63 offen offset:0 sc1
M v[152:155],a[140:143],a[216:219]
M v[148:151],a[140:143],a[212:215]
T a[132:133],v84,57344
M v[148:151],a[136:139],a[196:199]
T a[134:135],v84,58368
M v[144:147],a[136:139],a[192:195]
buffer_load_dwordx4 a[172:175], v59, s[12:15], s63 offen offset:1024 sc1
s_add_u32 s63, s63, 4096
M v[144:147],a[140:143],a[208:211]
s_waitcnt lgkmcnt(8)
M v[160:163],a[144:147],a[192:195]
T a[136:137],v85,49152
M v[160:163],a[148:151],a[208:211]
T a[138:139],v85,50176
M v[164:167],a[148:151],a[212:215]
buffer_load_dwordx4 a[176:179], v58, s[12:15], s63 offen offset:0 sc1
M v[164:167],a[144:147],a[196:199]
M v[168:171],a[144:147],a[200:203]
T a[140:141],v85,57344
M v[168:171],a[148:151],a[216:219]
T a[142:143],v85,58368
M v[172:175],a[148:151],a[220:223]
buffer_load_dwordx4 a[180:183], v58, s[12:15], s63 offen offset:1024 sc1
M v[172:175],a[144:147],a[204:207]
s_waitcnt lgkmcnt(8)
M v[188:191],a[156:159],a[220:223]
T a[144:145],v86,49152
M v[188:191],a[152:155],a[204:207]
T a[146:147],v86,50176
M v[184:187],a[152:155],a[200:203]
buffer_load_dwordx4 a[184:187], v59, s[12:15], s63 offen offset:0 sc1
M v[184:187],a[156:159],a[216:219]
M v[180:183],a[156:159],a[212:215]
T a[148:149],v86,57344
M v[180:183],a[152:155],a[196:199]
T a[150:151],v86,58368
M v[176:179],a[152:155],a[192:195]
buffer_load_dwordx4 a[188:191], v59, s[12:15], s63 offen offset:1024 sc1
s_add_u32 s63, s63, 4096
M v[176:179],a[156:159],a[208:211]
s_waitcnt lgkmcnt(8)
M v[192:195],a[128:131],a[192:195]
T a[152:153],v87,49152
M v[192:195],a[132:135],a[208:211]
T a[154:155],v87,50176
M v[196:199],a[132:135],a[212:215]
buffer_load_dwordx4 v69, s[8:11], s67 offen offset:1024 lds
M v[196:199],a[128:131],a[196:199]
M v[200:203],a[128:131],a[200:203]
T a[156:157],v87,57344
M v[200:203],a[132:135],a[216:219]
T a[158:159],v87,58368
M v[204:207],a[132:135],a[220:223]
buffer_load_dwordx4 v70, s[8:11], s67 offen offset:2048 lds
M v[204:207],a[128:131],a[204:207]
s_waitcnt vmcnt(23)
s_barrier
s_waitcnt lgkmcnt(8)
M v[220:223],a[140:143],a[220:223]
T a[128:129],v88,16384
M v[220:223],a[136:139],a[204:207]
T a[130:131],v88,17408
M v[216:219],a[136:139],a[200:203]
buffer_load_dwordx4 v71, s[8:11], s67 offen offset:3072 lds
s_add_u32 s67, s67, 458752
M v[216:219],a[140:143],a[216:219]
M v[212:215],a[140:143],a[212:215]
T a[132:133],v88,24576
M v[212:215],a[136:139],a[196:199]
s_add_u32 m0, s59, 0
T a[134:135],v88,25600
M v[208:211],a[136:139],a[192:195]
buffer_load_dwordx4 v9, s[20:23], s61 offen offset:0 lds
M v[208:211],a[140:143],a[208:211]
s_waitcnt lgkmcnt(8)
M v[224:227],a[144:147],a[192:195]
T a[136:137],v89,16384
M v[224:227],a[148:151],a[208:211]
T a[138:139],v89,17408
M v[228:231],a[148:151],a[212:215]
T a[140:141],v89,24576
M v[228:231],a[144:147],a[196:199]
T a[142:143],v89,25600
s_waitcnt lgkmcnt(8)
M v[236:239],a[156:159],a[212:215]
T a[144:145],v90,16384
M v[236:239],a[152:155],a[196:199]
T a[146:147],v90,17408
M v[232:235],a[152:155],a[192:195]
T a[148:149],v90,24576
M v[232:235],a[156:159],a[208:211]
s_waitcnt vmcnt(14)
T a[150:151],v90,25600
s_waitcnt lgkmcnt(8)
M v[128:131],a[128:131],a[224:227]
T a[152:153],v91,16384
M v[128:131],a[132:135],a[240:243]
T a[154:155],v91,17408
M v[132:135],a[132:135],a[244:247]
buffer_load_dwordx4 v10, s[20:23], s61 offen offset:1024 lds
s_add_u32 s61, s61, 8192
M v[132:135],a[128:131],a[228:231]
M v[136:139],a[128:131],a[232:235]
T a[156:157],v91,24576
M v[136:139],a[132:135],a[248:251]
s_add_u32 m0, s59, 8192
T a[158:159],v91,25600
M v[140:143],a[132:135],a[252:255]
buffer_load_dwordx4 v9, s[20:23], s61 offen offset:0 lds
M v[140:143],a[128:131],a[236:239]
s_waitcnt lgkmcnt(8)
M v[156:159],a[140:143],a[252:255]
T a[128:129],v92,16384
M v[156:159],a[136:139],a[236:239]
T a[130:131],v92,17408
M v[152:155],a[136:139],a[232:235]
buffer_load_dwordx4 v10, s[20:23], s61 offen offset:1024 lds
s_add_u32 s61, s61, 8192
M v[152:155],a[140:143],a[248:251]
M v[148:151],a[140:143],a[244:247]
T a[132:133],v92,24576
M v[148:151],a[136:139],a[228:231]
s_add_u32 m0, s59, 16384
T a[134:135],v92,25600
M v[144:147],a[136:139],a[224:227]
buffer_load_dwordx4 v11, s[24:27], s61 offen offset:0 lds
M v[144:147],a[140:143],a[240:243]
s_waitcnt lgkmcnt(8)
M v[160:163],a[144:147],a[224:227]
T a[136:137],v93,16384
M v[160:163],a[148:151],a[240:243]
T a[138:139],v93,17408
M v[164:167],a[148:151],a[244:247]
buffer_load_dwordx4 v12, s[24:27], s61 offen offset:1024 lds
M v[164:167],a[144:147],a[228:231]
M v[168:171],a[144:147],a[232:235]
T a[140:141],v93,24576
M v[168:171],a[148:151],a[248:251]
s_add_u32 m0, s59, 24576
T a[142:143],v93,25600
M v[172:175],a[148:151],a[252:255]
buffer_load_dwordx4 v9, s[20:23], s61 offen offset:0 lds
M v[172:175],a[144:147],a[236:239]
s_waitcnt lgkmcnt(8)
M v[188:191],a[156:159],a[252:255]
T a[144:145],v94,16384
M v[188:191],a[152:155],a[236:239]
T a[146:147],v94,17408
M v[184:187],a[152:155],a[232:235]
buffer_load_dwordx4 v10, s[20:23], s61 offen offset:1024 lds
s_add_u32 s61, s61, 8192
M v[184:187],a[156:159],a[248:251]
M v[180:183],a[156:159],a[244:247]
T a[148:149],v94,24576
M v[180:183],a[152:155],a[228:231]
T a[150:151],v94,25600
M v[176:179],a[152:155],a[224:227]
M v[176:179],a[156:159],a[240:243]
s_waitcnt lgkmcnt(8)
M v[192:195],a[128:131],a[224:227]
T a[152:153],v95,16384
M v[192:195],a[132:135],a[240:243]
T a[154:155],v95,17408
M v[196:199],a[132:135],a[244:247]
M v[196:199],a[128:131],a[228:231]
M v[200:203],a[128:131],a[232:235]
T a[156:157],v95,24576
M v[200:203],a[132:135],a[248:251]
T a[158:159],v95,25600
M v[204:207],a[132:135],a[252:255]
M v[204:207],a[128:131],a[236:239]
s_waitcnt vmcnt(8)
s_barrier
s_waitcnt lgkmcnt(8)
M v[220:223],a[140:143],a[252:255]
s_lshl_b32 s4, s57, 19
T a[128:129],v88,49152
s_add_u32 s4, s4, 8388608
M v[220:223],a[136:139],a[236:239]
s_lshl_b32 s71, s54, 14
T a[130:131],v88,50176
s_add_u32 s5, s4, s71
M v[216:219],a[136:139],a[232:235]
s_lshl_b32 s71, s55, 17
s_add_u32 s4, s4, s71
s_lshl_b32 s70, s53, 12
M v[216:219],a[140:143],a[248:251]
s_add_u32 s70, s70, 4194304
s_lshl_b32 s71, s55, 10
s_add_u32 s6, s70, s71
M v[212:215],a[140:143],a[244:247]
s_lshl_b32 s71, s56, 7
T a[132:133],v88,57344
s_add_u32 s7, s70, s71
M v[212:215],a[136:139],a[228:231]
s_lshl_b32 s70, s53, 3
T a[134:135],v88,58368
s_add_u32 s70, s70, s56
M v[208:211],a[136:139],a[224:227]
s_lshl_b32 s70, s70, 18
s_add_u32 s70, s70, s58
s_add_u32 s70, s70, 41943040
M v[208:211],a[140:143],a[240:243]
s_add_u32 s71, s55, 1
s_and_b32 s71, s71, 3
s_waitcnt lgkmcnt(8)
M v[224:227],a[144:147],a[224:227]
s_lshl_b32 s72, s71, 12
T a[136:137],v89,49152
s_add_u32 s8, s5, s72
M v[224:227],a[148:151],a[240:243]
s_lshl_b32 s72, s71, 16
T a[138:139],v89,50176
s_lshl_b32 s73, s55, 14
M v[228:231],a[148:151],a[244:247]
s_add_u32 s72, s72, s73
T a[140:141],v89,57344
s_add_u32 s66, s70, s72
M v[228:231],a[144:147],a[228:231]
s_lshl_b32 s72, s55, 16
T a[142:143],v89,58368
s_waitcnt lgkmcnt(8)
M v[236:239],a[156:159],a[244:247]
s_lshl_b32 s73, s71, 14
T a[144:145],v90,49152
s_add_u32 s72, s72, s73
M v[236:239],a[152:155],a[228:231]
s_add_u32 s16, s70, s72
T a[146:147],v90,50176
s_add_u32 s71, s55, 2
M v[232:235],a[152:155],a[224:227]
s_and_b32 s71, s71, 3
T a[148:149],v90,57344
s_lshl_b32 s72, s71, 12
M v[232:235],a[156:159],a[240:243]
s_waitcnt vmcnt(11)
T a[150:151],v90,58368
s_waitcnt lgkmcnt(8)
M v[128:131],a[128:131],a[160:163]
s_add_u32 s9, s5, s72
T a[152:153],v91,49152
s_lshl_b32 s72, s71, 16
M v[128:131],a[132:135],a[176:179]
s_lshl_b32 s73, s55, 14
T a[154:155],v91,50176
s_add_u32 s72, s72, s73
M v[132:135],a[132:135],a[180:183]
s_add_u32 s67, s70, s72
global_load_dword v97, v57, s[76:77]
s_lshl_b32 s72, s55, 16
M v[132:135],a[128:131],a[164:167]
s_lshl_b32 s73, s71, 14
s_add_u32 s72, s72, s73
s_add_u32 s17, s70, s72
M v[136:139],a[128:131],a[168:171]
s_add_u32 s71, s55, 3
T a[156:157],v91,57344
s_and_b32 s71, s71, 3
M v[136:139],a[132:135],a[184:187]
s_lshl_b32 s72, s71, 12
T a[158:159],v91,58368
s_add_u32 s10, s5, s72
M v[140:143],a[132:135],a[188:191]
s_lshl_b32 s72, s71, 16
s_lshl_b32 s73, s55, 14
s_add_u32 s72, s72, s73
M v[140:143],a[128:131],a[172:175]
s_add_u32 s68, s70, s72
s_lshl_b32 s72, s55, 16
s_waitcnt lgkmcnt(8)
M v[156:159],a[140:143],a[188:191]
s_lshl_b32 s73, s71, 14
T a[128:129],v92,49152
s_add_u32 s72, s72, s73
M v[156:159],a[136:139],a[172:175]
s_add_u32 s18, s70, s72
T a[130:131],v92,50176
s_add_u32 s71, s55, 4
M v[152:155],a[136:139],a[168:171]
L_pad25:
s_cbranch_execz L_px3
s_and_b32 s71, s71, 3
s_lshl_b32 s72, s71, 12
s_add_u32 s11, s5, s72
M v[152:155],a[140:143],a[184:187]
s_lshl_b32 s69, s55, 21
s_sub_u32 s19, s52, s55
s_add_u32 s19, s19, 3
M v[148:151],a[140:143],a[180:183]
s_and_b32 s19, s19, 3
T a[132:133],v92,57344
s_lshl_b32 s19, s19, 13
M v[148:151],a[136:139],a[164:167]
s_xor_b32 s58, s56, 2
T a[134:135],v92,58368
s_lshl_b32 s58, s58, 8
M v[144:147],a[136:139],a[160:163]
s_lshl_b32 s70, s55, 6
s_add_u32 s58, s58, s70
s_lshl_b32 s70, s57, 17
M v[144:147],a[140:143],a[176:179]
s_add_u32 s70, s70, s58
s_lshl_b32 s71, s75, 16
s_waitcnt lgkmcnt(8)
M v[160:163],a[144:147],a[160:163]
s_add_u32 s44, s70, s71
T a[136:137],v93,49152
s_xor_b32 s45, s44, 32768
M v[160:163],a[148:151],a[176:179]
s_xor_b32 s46, s44, 65536
T a[138:139],v93,50176
s_xor_b32 s47, s44, 98304
M v[164:167],a[148:151],a[180:183]
s_lshl_b32 s79, s2, 2
s_add_u32 s79, s79, s52
s_mul_i32 s78, s79, 7168
M v[164:167],a[144:147],a[164:167]
s_lshl_b32 s79, s79, 13
s_mul_i32 s63, s57, 458752
s_add_u32 s63, s63, 25165824
M v[168:171],a[144:147],a[168:171]
s_lshr_b32 s71, s54, 1
T a[140:141],v93,57344
s_mul_i32 s71, s71, 28672
M v[168:171],a[148:151],a[184:187]
s_add_u32 s70, s63, s71
T a[142:143],v93,58368
s_add_u32 s72, s70, 12288
M v[172:175],a[148:151],a[188:191]
s_lshl_b32 s71, s75, 14
s_add_u32 s70, s70, s71
s_mul_i32 s71, s55, 114688
M v[172:175],a[144:147],a[172:175]
s_add_u32 s63, s63, s71
s_waitcnt lgkmcnt(8)
M v[188:191],a[156:159],a[188:191]
T a[144:145],v94,49152
M v[188:191],a[152:155],a[172:175]
T a[146:147],v94,50176
M v[184:187],a[152:155],a[168:171]
M v[184:187],a[156:159],a[184:187]
M v[180:183],a[156:159],a[180:183]
T a[148:149],v94,57344
M v[180:183],a[152:155],a[164:167]
T a[150:151],v94,58368
M v[176:179],a[152:155],a[160:163]
M v[176:179],a[156:159],a[176:179]
s_waitcnt lgkmcnt(8)
M v[192:195],a[128:131],a[160:163]
T a[152:153],v95,49152
M v[192:195],a[132:135],a[176:179]
T a[154:155],v95,50176
M v[196:199],a[132:135],a[180:183]
M v[196:199],a[128:131],a[164:167]
M v[200:203],a[128:131],a[168:171]
T a[156:157],v95,57344
M v[200:203],a[132:135],a[184:187]
T a[158:159],v95,58368
M v[204:207],a[132:135],a[188:191]
M v[204:207],a[128:131],a[172:175]
s_waitcnt lgkmcnt(8)
M v[220:223],a[140:143],a[188:191]
T a[128:129],v72,32768
M v[220:223],a[136:139],a[172:175]
T a[130:131],v72,33792
M v[216:219],a[136:139],a[168:171]
M v[216:219],a[140:143],a[184:187]
M v[212:215],a[140:143],a[180:183]
T a[132:133],v72,40960
M v[212:215],a[136:139],a[164:167]
T a[134:135],v72,41984
M v[208:211],a[136:139],a[160:163]
M v[208:211],a[140:143],a[176:179]
s_waitcnt lgkmcnt(8)
M v[224:227],a[144:147],a[160:163]
T a[136:137],v72,32776
M v[224:227],a[148:151],a[176:179]
T a[138:139],v72,33800
M v[228:231],a[148:151],a[180:183]
T a[140:141],v72,40968
M v[228:231],a[144:147],a[164:167]
T a[142:143],v72,41992
s_waitcnt lgkmcnt(8)
M v[236:239],a[156:159],a[180:183]
T a[144:145],v73,32768
M v[236:239],a[152:155],a[164:167]
T a[146:147],v73,33792
M v[232:235],a[152:155],a[160:163]
T a[148:149],v73,40960
M v[232:235],a[156:159],a[176:179]
T a[150:151],v73,41984
s_bitcmp1_b32 s55, 0
s_cbranch_scc1 L_forkA
L_fork:
s_mov_b64 exec, 0
s_cmp_eq_u32 s52, 0
s_cbranch_scc1 L_pad30
s_cmp_eq_u32 s52, 1
s_cbranch_scc1 L_pad31
s_cmp_eq_u32 s52, 2
s_cbranch_scc1 L_pad32
s_branch L_pad33
L_pb1:
s_mov_b64 exec, -1
s_cmp_eq_u32 s56, 0
s_cselect_b32 s63, 7, 0
s_lshl_b32 s63, s63, 14
s_add_u32 s63, s63, s4
s_mov_b32 s57, s70
s_mov_b32 s53, s72
v_lshrrev_b32 v40, 3, v0
v_cmp_eq_u32 vcc, 3, v40
s_mov_b32 s73, 100662912
s_cmp_eq_u32 s75, 0
s_cselect_b32 s73, s73, 100663552
s_sub_u32 s71, 201326464, s73
v_mov_b32 v40, s73
v_mov_b32 v41, s71
v_mov_b32 v42, 100663680
v_cndmask_b32 v40, 0, v40, vcc
v_cndmask_b32 v41, 0, v41, vcc
v_cndmask_b32 v42, 0, v42, vcc
v_add_u32 v58, v58, v40
v_add_u32 v59, v59, v41
v_add_u32 v13, v13, v42
v_lshlrev_b32 v99, 2, v63
v_add_u32 v99, 131072, v99
s_waitcnt lgkmcnt(8)
M a[0:3],a[128:131],a[192:195]
T a[152:153],v73,32776
T a[154:155],v73,33800
M a[0:3],a[132:135],a[208:211]
v_mul_f32 v40, v128, v128
v_mul_f32 v41, v129, v129
M a[4:7],a[132:135],a[212:215]
v_mul_f32 v42, v130, v130
v_mul_f32 v43, v131, v131
M a[4:7],a[128:131],a[196:199]
v_mul_f32 v44, v144, v144
v_mul_f32 v45, v145, v145
M a[8:11],a[128:131],a[200:203]
T a[156:157],v73,40968
T a[158:159],v73,41992
M a[8:11],a[132:135],a[216:219]
v_mul_f32 v46, v146, v146
v_mul_f32 v47, v147, v147
M a[12:15],a[132:135],a[220:223]
v_fma_f32 v40, v40, v112, v108
v_fma_f32 v41, v41, v112, v108
M a[12:15],a[128:131],a[204:207]
s_waitcnt lgkmcnt(8)
v_fma_f32 v42, v42, v112, v108
v_fma_f32 v43, v43, v112, v108
M a[28:31],a[140:143],a[220:223]
T a[128:129],v74,32768
T a[130:131],v74,33792
M a[28:31],a[136:139],a[204:207]
v_fma_f32 v44, v44, v112, v108
v_fma_f32 v45, v45, v112, v108
M a[24:27],a[136:139],a[200:203]
v_fma_f32 v46, v46, v112, v108
v_fma_f32 v47, v47, v112, v108
M a[24:27],a[140:143],a[216:219]
v_mul_f32 v40, v40, v128
v_mul_f32 v41, v41, v129
M a[20:23],a[140:143],a[212:215]
T a[132:133],v74,40960
T a[134:135],v74,41984
M a[20:23],a[136:139],a[196:199]
v_exp_f32 v40, v40
M a[16:19],a[136:139],a[192:195]
v_exp_f32 v41, v41
M a[16:19],a[140:143],a[208:211]
s_waitcnt lgkmcnt(8)
v_mul_f32 v42, v42, v130
v_mul_f32 v43, v43, v131
M a[32:35],a[144:147],a[192:195]
T a[136:137],v74,32776
T a[138:139],v74,33800
M a[32:35],a[148:151],a[208:211]
v_exp_f32 v42, v42
M a[36:39],a[148:151],a[212:215]
v_exp_f32 v43, v43
M a[36:39],a[144:147],a[196:199]
v_mul_f32 v44, v44, v144
v_mul_f32 v45, v45, v145
M a[40:43],a[144:147],a[200:203]
T a[140:141],v74,40968
T a[142:143],v74,41992
M a[40:43],a[148:151],a[216:219]
v_exp_f32 v44, v44
M a[44:47],a[148:151],a[220:223]
v_exp_f32 v45, v45
M a[44:47],a[144:147],a[204:207]
s_waitcnt lgkmcnt(8)
v_mul_f32 v46, v46, v146
v_mul_f32 v47, v47, v147
M a[60:63],a[156:159],a[220:223]
T a[144:145],v75,32768
T a[146:147],v75,33792
M a[60:63],a[152:155],a[204:207]
v_exp_f32 v46, v46
M a[56:59],a[152:155],a[200:203]
v_exp_f32 v47, v47
M a[56:59],a[156:159],a[216:219]
v_fma_f32 v40, v40, v104, v104
v_fma_f32 v41, v41, v104, v104
M a[52:55],a[156:159],a[212:215]
T a[148:149],v75,40960
T a[150:151],v75,41984
M a[52:55],a[152:155],a[196:199]
v_rcp_f32 v40, v40
M a[48:51],a[152:155],a[192:195]
v_rcp_f32 v41, v41
M a[48:51],a[156:159],a[208:211]
s_waitcnt lgkmcnt(8)
v_fma_f32 v42, v42, v104, v104
v_fma_f32 v43, v43, v104, v104
M a[64:67],a[128:131],a[192:195]
T a[152:153],v75,32776
T a[154:155],v75,33800
M a[64:67],a[132:135],a[208:211]
v_rcp_f32 v42, v42
M a[68:71],a[132:135],a[212:215]
v_rcp_f32 v43, v43
M a[68:71],a[128:131],a[196:199]
v_fma_f32 v44, v44, v104, v104
v_fma_f32 v45, v45, v104, v104
M a[72:75],a[128:131],a[200:203]
T a[156:157],v75,40968
T a[158:159],v75,41992
M a[72:75],a[132:135],a[216:219]
v_rcp_f32 v44, v44
M a[76:79],a[132:135],a[220:223]
v_rcp_f32 v45, v45
M a[76:79],a[128:131],a[204:207]
s_waitcnt lgkmcnt(8)
v_fma_f32 v46, v46, v104, v104
v_fma_f32 v47, v47, v104, v104
M a[92:95],a[140:143],a[220:223]
T a[128:129],v76,0
T a[130:131],v76,1024
M a[92:95],a[136:139],a[204:207]
v_rcp_f32 v46, v46
M a[88:91],a[136:139],a[200:203]
v_rcp_f32 v47, v47
M a[88:91],a[140:143],a[216:219]
v_mul_f32 v128, v40, v128
v_mul_f32 v129, v41, v129
M a[84:87],a[140:143],a[212:215]
T a[132:133],v76,8192
T a[134:135],v76,9216
M a[84:87],a[136:139],a[196:199]
v_mul_f32 v130, v42, v130
v_mul_f32 v131, v43, v131
M a[80:83],a[136:139],a[192:195]
v_mul_f32 v144, v44, v144
v_mul_f32 v145, v45, v145
M a[80:83],a[140:143],a[208:211]
s_waitcnt lgkmcnt(8)
v_mul_f32 v146, v46, v146
v_mul_f32 v147, v47, v147
M a[96:99],a[144:147],a[192:195]
T a[136:137],v76,8
T a[138:139],v76,1032
M a[96:99],a[148:151],a[208:211]
v_cvt_pk_bf16_f32 v240, v128, v129
v_cvt_pk_bf16_f32 v241, v130, v131
M a[100:103],a[148:151],a[212:215]
v_cvt_pk_bf16_f32 v242, v144, v145
v_cvt_pk_bf16_f32 v243, v146, v147
M a[100:103],a[144:147],a[196:199]
buffer_store_dwordx4 v[240:243], v58, s[12:15], s57 offen offset:0 sc1
v_mul_f32 v40, v132, v132
M a[104:107],a[144:147],a[200:203]
T a[140:141],v76,8200
T a[142:143],v76,9224
M a[104:107],a[148:151],a[216:219]
v_mul_f32 v41, v133, v133
v_mul_f32 v42, v134, v134
M a[108:111],a[148:151],a[220:223]
v_mul_f32 v43, v135, v135
v_mul_f32 v44, v148, v148
M a[108:111],a[144:147],a[204:207]
s_waitcnt lgkmcnt(8)
v_mul_f32 v45, v149, v149
v_mul_f32 v46, v150, v150
M a[124:127],a[156:159],a[220:223]
T a[144:145],v77,0
T a[146:147],v77,1024
M a[124:127],a[152:155],a[204:207]
v_mul_f32 v47, v151, v151
v_fma_f32 v40, v40, v113, v109
M a[120:123],a[152:155],a[200:203]
v_fma_f32 v41, v41, v113, v109
v_fma_f32 v42, v42, v113, v109
M a[120:123],a[156:159],a[216:219]
v_fma_f32 v43, v43, v113, v109
v_fma_f32 v44, v44, v113, v109
M a[116:119],a[156:159],a[212:215]
T a[148:149],v77,8192
T a[150:151],v77,9216
M a[116:119],a[152:155],a[196:199]
v_fma_f32 v45, v45, v113, v109
v_fma_f32 v46, v46, v113, v109
M a[112:115],a[152:155],a[192:195]
v_fma_f32 v47, v47, v113, v109
v_mul_f32 v40, v40, v132
M a[112:115],a[156:159],a[208:211]
s_waitcnt lgkmcnt(8)
v_exp_f32 v40, v40
M a[0:3],a[128:131],a[224:227]
T a[152:153],v77,8
T a[154:155],v77,1032
M a[0:3],a[132:135],a[240:243]
v_mul_f32 v41, v41, v133
v_mul_f32 v42, v42, v134
M a[4:7],a[132:135],a[244:247]
v_exp_f32 v41, v41
M a[4:7],a[128:131],a[228:231]
v_exp_f32 v42, v42
M a[8:11],a[128:131],a[232:235]
T a[156:157],v77,8200
T a[158:159],v77,9224
M a[8:11],a[132:135],a[248:251]
v_mul_f32 v43, v43, v135
v_mul_f32 v44, v44, v148
M a[12:15],a[132:135],a[252:255]
v_exp_f32 v43, v43
M a[12:15],a[128:131],a[236:239]
s_waitcnt lgkmcnt(8)
v_exp_f32 v44, v44
M a[28:31],a[140:143],a[252:255]
T a[128:129],v78,0
T a[130:131],v78,1024
M a[28:31],a[136:139],a[236:239]
v_mul_f32 v45, v45, v149
v_mul_f32 v46, v46, v150
M a[24:27],a[136:139],a[232:235]
v_exp_f32 v45, v45
M a[24:27],a[140:143],a[248:251]
v_exp_f32 v46, v46
M a[20:23],a[140:143],a[244:247]
T a[132:133],v78,8192
T a[134:135],v78,9216
M a[20:23],a[136:139],a[228:231]
v_mul_f32 v47, v47, v151
v_fma_f32 v40, v40, v105, v105
M a[16:19],a[136:139],a[224:227]
v_exp_f32 v47, v47
M a[16:19],a[140:143],a[240:243]
s_waitcnt lgkmcnt(8)
v_rcp_f32 v40, v40
M a[32:35],a[144:147],a[224:227]
T a[136:137],v78,8
T a[138:139],v78,1032
M a[32:35],a[148:151],a[240:243]
v_fma_f32 v41, v41, v105, v105
v_fma_f32 v42, v42, v105, v105
M a[36:39],a[148:151],a[244:247]
v_rcp_f32 v41, v41
M a[36:39],a[144:147],a[228:231]
v_rcp_f32 v42, v42
M a[40:43],a[144:147],a[232:235]
T a[140:141],v78,8200
T a[142:143],v78,9224
M a[40:43],a[148:151],a[248:251]
v_fma_f32 v43, v43, v105, v105
v_fma_f32 v44, v44, v105, v105
M a[44:47],a[148:151],a[252:255]
v_rcp_f32 v43, v43
M a[44:47],a[144:147],a[236:239]
s_waitcnt lgkmcnt(8)
v_rcp_f32 v44, v44
M a[60:63],a[156:159],a[252:255]
T a[144:145],v79,0
T a[146:147],v79,1024
M a[60:63],a[152:155],a[236:239]
v_fma_f32 v45, v45, v105, v105
v_fma_f32 v46, v46, v105, v105
M a[56:59],a[152:155],a[232:235]
v_rcp_f32 v45, v45
M a[56:59],a[156:159],a[248:251]
v_rcp_f32 v46, v46
M a[52:55],a[156:159],a[244:247]
T a[148:149],v79,8192
T a[150:151],v79,9216
M a[52:55],a[152:155],a[228:231]
v_fma_f32 v47, v47, v105, v105
v_mul_f32 v132, v40, v132
M a[48:51],a[152:155],a[224:227]
v_rcp_f32 v47, v47
M a[48:51],a[156:159],a[240:243]
s_waitcnt lgkmcnt(8)
v_mul_f32 v133, v41, v133
v_mul_f32 v134, v42, v134
M a[64:67],a[128:131],a[224:227]
T a[152:153],v79,8
T a[154:155],v79,1032
M a[64:67],a[132:135],a[240:243]
v_mul_f32 v135, v43, v135
v_mul_f32 v148, v44, v148
M a[68:71],a[132:135],a[244:247]
v_mul_f32 v149, v45, v149
v_mul_f32 v150, v46, v150
M a[68:71],a[128:131],a[228:231]
v_mul_f32 v151, v47, v151
v_cvt_pk_bf16_f32 v244, v132, v133
M a[72:75],a[128:131],a[232:235]
T a[156:157],v79,8200
T a[158:159],v79,9224
M a[72:75],a[132:135],a[248:251]
v_cvt_pk_bf16_f32 v245, v134, v135
v_cvt_pk_bf16_f32 v246, v148, v149
M a[76:79],a[132:135],a[252:255]
v_cvt_pk_bf16_f32 v247, v150, v151
buffer_store_dwordx4 v[244:247], v58, s[12:15], s57 offen offset:1024 sc1
M a[76:79],a[128:131],a[236:239]
s_waitcnt lgkmcnt(8)
v_accvgpr_write_b32 a192, v136
v_accvgpr_write_b32 a193, v137
M a[92:95],a[140:143],a[252:255]
T a[128:129],v76,32768
T a[130:131],v76,33792
M a[92:95],a[136:139],a[236:239]
v_accvgpr_write_b32 a194, v138
v_accvgpr_write_b32 a195, v139
M a[88:91],a[136:139],a[232:235]
v_accvgpr_write_b32 a196, v152
v_accvgpr_write_b32 a197, v153
M a[88:91],a[140:143],a[248:251]
v_accvgpr_write_b32 a198, v154
v_accvgpr_write_b32 a199, v155
M a[84:87],a[140:143],a[244:247]
T a[132:133],v76,40960
T a[134:135],v76,41984
M a[84:87],a[136:139],a[228:231]
v_accvgpr_write_b32 a200, v140
v_accvgpr_write_b32 a201, v141
M a[80:83],a[136:139],a[224:227]
v_accvgpr_write_b32 a202, v142
v_accvgpr_write_b32 a203, v143
M a[80:83],a[140:143],a[240:243]
s_waitcnt lgkmcnt(8)
v_accvgpr_write_b32 a204, v156
v_accvgpr_write_b32 a205, v157
M a[96:99],a[144:147],a[224:227]
T a[136:137],v76,32776
T a[138:139],v76,33800
M a[96:99],a[148:151],a[240:243]
v_accvgpr_write_b32 a206, v158
v_accvgpr_write_b32 a207, v159
M a[100:103],a[148:151],a[244:247]
v_accvgpr_write_b32 a208, v160
v_accvgpr_write_b32 a209, v161
M a[100:103],a[144:147],a[228:231]
v_accvgpr_write_b32 a210, v162
v_accvgpr_write_b32 a211, v163
M a[104:107],a[144:147],a[232:235]
T a[140:141],v76,40968
T a[142:143],v76,41992
M a[104:107],a[148:151],a[248:251]
v_accvgpr_write_b32 a212, v176
v_accvgpr_write_b32 a213, v177
M a[108:111],a[148:151],a[252:255]
v_accvgpr_write_b32 a214, v178
v_accvgpr_write_b32 a215, v179
M a[108:111],a[144:147],a[236:239]
s_waitcnt lgkmcnt(8)
v_accvgpr_write_b32 a216, v164
v_accvgpr_write_b32 a217, v165
M a[124:127],a[156:159],a[252:255]
T a[144:145],v77,32768
T a[146:147],v77,33792
M a[124:127],a[152:155],a[236:239]
v_accvgpr_write_b32 a218, v166
v_accvgpr_write_b32 a219, v167
M a[120:123],a[152:155],a[232:235]
v_accvgpr_write_b32 a220, v180
v_accvgpr_write_b32 a221, v181
M a[120:123],a[156:159],a[248:251]
v_accvgpr_write_b32 a222, v182
v_accvgpr_write_b32 a223, v183
M a[116:119],a[156:159],a[244:247]
T a[148:149],v77,40960
T a[150:151],v77,41984
M a[116:119],a[152:155],a[228:231]
M a[112:115],a[152:155],a[224:227]
M a[112:115],a[156:159],a[240:243]
s_waitcnt lgkmcnt(8)
M a[0:3],a[128:131],a[160:163]
T a[152:153],v77,32776
T a[154:155],v77,33800
M a[0:3],a[132:135],a[176:179]
v_accvgpr_write_b32 a224, v168
v_accvgpr_write_b32 a225, v169
M a[4:7],a[132:135],a[180:183]
v_accvgpr_write_b32 a226, v170
v_accvgpr_write_b32 a227, v171
M a[4:7],a[128:131],a[164:167]
v_accvgpr_write_b32 a228, v184
v_accvgpr_write_b32 a229, v185
M a[8:11],a[128:131],a[168:171]
T a[156:157],v77,40968
T a[158:159],v77,41992
M a[8:11],a[132:135],a[184:187]
v_accvgpr_write_b32 a230, v186
v_accvgpr_write_b32 a231, v187
M a[12:15],a[132:135],a[188:191]
v_accvgpr_write_b32 a232, v172
v_accvgpr_write_b32 a233, v173
M a[12:15],a[128:131],a[172:175]
s_waitcnt lgkmcnt(8)
v_accvgpr_write_b32 a234, v174
v_accvgpr_write_b32 a235, v175
M a[28:31],a[140:143],a[188:191]
T a[128:129],v78,32768
T a[130:131],v78,33792
M a[28:31],a[136:139],a[172:175]
v_accvgpr_write_b32 a236, v188
v_accvgpr_write_b32 a237, v189
M a[24:27],a[136:139],a[168:171]
v_accvgpr_write_b32 a238, v190
v_accvgpr_write_b32 a239, v191
M a[24:27],a[140:143],a[184:187]
v_accvgpr_write_b32 a240, v192
v_accvgpr_write_b32 a241, v193
M a[20:23],a[140:143],a[180:183]
T a[132:133],v78,40960
T a[134:135],v78,41984
M a[20:23],a[136:139],a[164:167]
v_accvgpr_write_b32 a242, v194
v_accvgpr_write_b32 a243, v195
M a[16:19],a[136:139],a[160:163]
v_accvgpr_write_b32 a244, v208
v_accvgpr_write_b32 a245, v209
M a[16:19],a[140:143],a[176:179]
s_waitcnt lgkmcnt(8)
v_accvgpr_write_b32 a246, v210
v_accvgpr_write_b32 a247, v211
M a[32:35],a[144:147],a[160:163]
T a[136:137],v78,32776
T a[138:139],v78,33800
M a[32:35],a[148:151],a[176:179]
v_accvgpr_write_b32 a248, v196
v_accvgpr_write_b32 a249, v197
M a[36:39],a[148:151],a[180:183]
v_accvgpr_write_b32 a250, v198
v_accvgpr_write_b32 a251, v199
M a[36:39],a[144:147],a[164:167]
v_accvgpr_write_b32 a252, v212
v_accvgpr_write_b32 a253, v213
M a[40:43],a[144:147],a[168:171]
T a[140:141],v78,40968
T a[142:143],v78,41992
M a[40:43],a[148:151],a[184:187]
ds_read_b128 v[128:131], v99 offset:0
ds_read_b128 v[132:135], v99 offset:16
M a[44:47],a[148:151],a[188:191]
ds_read_b128 v[136:139], v99 offset:128
ds_read_b128 v[140:143], v99 offset:144
M a[44:47],a[144:147],a[172:175]
s_waitcnt lgkmcnt(12)
ds_read_b128 v[144:147], v99 offset:256
ds_read_b128 v[148:151], v99 offset:272
M a[60:63],a[156:159],a[188:191]
T a[144:145],v79,32768
T a[146:147],v79,33792
M a[60:63],a[152:155],a[172:175]
ds_read_b128 v[152:155], v99 offset:384
ds_read_b128 v[156:159], v99 offset:400
M a[56:59],a[152:155],a[168:171]
v_accvgpr_write_b32 a254, v214
v_accvgpr_write_b32 a255, v215
M a[56:59],a[156:159],a[184:187]
L_pad26:
s_cbranch_execz L_pb0
M a[52:55],a[156:159],a[180:183]
T a[148:149],v79,40960
T a[150:151],v79,41984
M a[52:55],a[152:155],a[164:167]
M a[48:51],a[152:155],a[160:163]
M a[48:51],a[156:159],a[176:179]
s_waitcnt lgkmcnt(15)
M a[64:67],a[128:131],a[160:163]
T a[152:153],v79,32776
T a[154:155],v79,33800
M a[64:67],a[132:135],a[176:179]
M a[68:71],a[132:135],a[180:183]
M a[68:71],a[128:131],a[164:167]
M a[72:75],a[128:131],a[168:171]
T a[156:157],v79,40968
T a[158:159],v79,41992
M a[72:75],a[132:135],a[184:187]
M a[76:79],a[132:135],a[188:191]
M a[76:79],a[128:131],a[172:175]
s_waitcnt vmcnt(3)
s_barrier
s_waitcnt lgkmcnt(15)
M a[92:95],a[140:143],a[188:191]
ds_read_b128 a[128:131], v32 offset:0
M a[92:95],a[136:139],a[172:175]
M a[88:91],a[136:139],a[168:171]
M a[88:91],a[140:143],a[184:187]
M a[84:87],a[140:143],a[180:183]
ds_read_b128 a[132:135], v33 offset:0
M a[84:87],a[136:139],a[164:167]
M a[80:83],a[136:139],a[160:163]
M a[80:83],a[140:143],a[176:179]
s_waitcnt lgkmcnt(6)
M a[96:99],a[144:147],a[160:163]
ds_read_b128 a[136:139], v34 offset:0
M a[96:99],a[148:151],a[176:179]
M a[100:103],a[148:151],a[180:183]
M a[100:103],a[144:147],a[164:167]
M a[104:107],a[144:147],a[168:171]
ds_read_b128 a[140:143], v35 offset:0
M a[104:107],a[148:151],a[184:187]
M a[108:111],a[148:151],a[188:191]
M a[108:111],a[144:147],a[172:175]
s_waitcnt lgkmcnt(4)
M a[124:127],a[156:159],a[188:191]
ds_read_b128 a[144:147], v32 offset:4096
M a[124:127],a[152:155],a[172:175]
M a[120:123],a[152:155],a[168:171]
M a[120:123],a[156:159],a[184:187]
M a[116:119],a[156:159],a[180:183]
ds_read_b128 a[148:151], v33 offset:4096
M a[116:119],a[152:155],a[164:167]
M a[112:115],a[152:155],a[160:163]
M a[112:115],a[156:159],a[176:179]
s_nop 3
v_accvgpr_write_b32 a160, v200
v_accvgpr_write_b32 a161, v201
v_accvgpr_write_b32 a162, v202
v_accvgpr_write_b32 a163, v203
v_accvgpr_write_b32 a164, v216
v_accvgpr_write_b32 a165, v217
v_accvgpr_write_b32 a166, v218
v_accvgpr_write_b32 a167, v219
v_accvgpr_write_b32 a168, v204
v_accvgpr_write_b32 a169, v205
v_accvgpr_write_b32 a170, v206
v_accvgpr_write_b32 a171, v207
v_accvgpr_write_b32 a172, v220
v_accvgpr_write_b32 a173, v221
v_accvgpr_write_b32 a174, v222
v_accvgpr_write_b32 a175, v223
v_accvgpr_write_b32 a176, v224
v_accvgpr_write_b32 a177, v225
v_accvgpr_write_b32 a178, v226
v_accvgpr_write_b32 a179, v227
v_accvgpr_write_b32 a180, v232
v_accvgpr_write_b32 a181, v233
v_accvgpr_write_b32 a182, v234
v_accvgpr_write_b32 a183, v235
v_accvgpr_write_b32 a184, v228
v_accvgpr_write_b32 a185, v229
v_accvgpr_write_b32 a186, v230
v_accvgpr_write_b32 a187, v231
v_accvgpr_write_b32 a188, v236
v_accvgpr_write_b32 a189, v237
v_accvgpr_write_b32 a190, v238
v_accvgpr_write_b32 a191, v239
v_mov_b64 v[244:245], v[104:105]
v_mov_b64 v[246:247], v[108:109]
v_mov_b64 v[248:249], v[112:113]
v_mov_b64 v[250:251], v[106:107]
s_waitcnt lgkmcnt(12)
s_waitcnt vmcnt(2)
v_accvgpr_read_b32 v40, a0
v_accvgpr_read_b32 v41, a1
v_accvgpr_read_b32 v42, a2
v_accvgpr_read_b32 v43, a3
v_accvgpr_read_b32 v44, a16
v_accvgpr_read_b32 v45, a17
v_accvgpr_read_b32 v46, a18
v_accvgpr_read_b32 v47, a19
v_pk_fma_f32 v[40:41], v[128:129], v[48:49], v[40:41] op_sel:[0,0,0] op_sel_hi:[1,0,1]
v_pk_fma_f32 v[42:43], v[130:131], v[48:49], v[42:43] op_sel:[0,0,0] op_sel_hi:[1,0,1]
v_pk_fma_f32 v[44:45], v[132:133], v[48:49], v[44:45] op_sel:[0,0,0] op_sel_hi:[1,0,1]
v_pk_fma_f32 v[46:47], v[134:135], v[48:49], v[46:47] op_sel:[0,0,0] op_sel_hi:[1,0,1]
v_pk_mul_f32 v[40:41], v[40:41], v[52:53] op_sel:[0,0] op_sel_hi:[1,0]
v_pk_mul_f32 v[42:43], v[42:43], v[52:53] op_sel:[0,0] op_sel_hi:[1,0]
v_pk_mul_f32 v[44:45], v[44:45], v[52:53] op_sel:[0,0] op_sel_hi:[1,0]
v_pk_mul_f32 v[46:47], v[46:47], v[52:53] op_sel:[0,0] op_sel_hi:[1,0]
v_cvt_pk_bf16_f32 v64, v40, v41
v_cvt_pk_bf16_f32 v65, v42, v43
v_cvt_pk_bf16_f32 v66, v44, v45
v_cvt_pk_bf16_f32 v67, v46, v47
s_add_u32 m0, s59, 32768
s_nop 0
buffer_load_dwordx4 v11, s[24:27], s61 offen offset:0 lds
v_accvgpr_read_b32 v40, a32
v_accvgpr_read_b32 v41, a33
v_accvgpr_read_b32 v42, a34
v_accvgpr_read_b32 v43, a35
v_accvgpr_read_b32 v44, a48
v_accvgpr_read_b32 v45, a49
v_accvgpr_read_b32 v46, a50
v_accvgpr_read_b32 v47, a51
v_pk_fma_f32 v[40:41], v[136:137], v[48:49], v[40:41] op_sel:[0,0,0] op_sel_hi:[1,0,1]
v_pk_fma_f32 v[42:43], v[138:139], v[48:49], v[42:43] op_sel:[0,0,0] op_sel_hi:[1,0,1]
v_pk_fma_f32 v[44:45], v[140:141], v[48:49], v[44:45] op_sel:[0,0,0] op_sel_hi:[1,0,1]
v_pk_fma_f32 v[46:47], v[142:143], v[48:49], v[46:47] op_sel:[0,0,0] op_sel_hi:[1,0,1]
v_pk_mul_f32 v[40:41], v[40:41], v[52:53] op_sel:[0,0] op_sel_hi:[1,0]
v_pk_mul_f32 v[42:43], v[42:43], v[52:53] op_sel:[0,0] op_sel_hi:[1,0]
v_pk_mul_f32 v[44:45], v[44:45], v[52:53] op_sel:[0,0] op_sel_hi:[1,0]
v_pk_mul_f32 v[46:47], v[46:47], v[52:53] op_sel:[0,0] op_sel_hi:[1,0]
v_cvt_pk_bf16_f32 v68, v40, v41
v_cvt_pk_bf16_f32 v69, v42, v43
v_cvt_pk_bf16_f32 v70, v44, v45
v_cvt_pk_bf16_f32 v71, v46, v47
buffer_load_dwordx4 v12, s[24:27], s61 offen offset:1024 lds
v_accvgpr_read_b32 v40, a64
v_accvgpr_read_b32 v41, a65
v_accvgpr_read_b32 v42, a66
v_accvgpr_read_b32 v43, a67
v_accvgpr_read_b32 v44, a80
v_accvgpr_read_b32 v45, a81
v_accvgpr_read_b32 v46, a82
v_accvgpr_read_b32 v47, a83
v_pk_fma_f32 v[40:41], v[144:145], v[48:49], v[40:41] op_sel:[0,0,0] op_sel_hi:[1,0,1]
v_pk_fma_f32 v[42:43], v[146:147], v[48:49], v[42:43] op_sel:[0,0,0] op_sel_hi:[1,0,1]
v_pk_fma_f32 v[44:45], v[148:149], v[48:49], v[44:45] op_sel:[0,0,0] op_sel_hi:[1,0,1]
v_pk_fma_f32 v[46:47], v[150:151], v[48:49], v[46:47] op_sel:[0,0,0] op_sel_hi:[1,0,1]
v_pk_mul_f32 v[40:41], v[40:41], v[52:53] op_sel:[0,0] op_sel_hi:[1,0]
v_pk_mul_f32 v[42:43], v[42:43], v[52:53] op_sel:[0,0] op_sel_hi:[1,0]
v_pk_mul_f32 v[44:45], v[44:45], v[52:53] op_sel:[0,0] op_sel_hi:[1,0]
v_pk_mul_f32 v[46:47], v[46:47], v[52:53] op_sel:[0,0] op_sel_hi:[1,0]
v_cvt_pk_bf16_f32 v72, v40, v41
v_cvt_pk_bf16_f32 v73, v42, v43
v_cvt_pk_bf16_f32 v74, v44, v45
v_cvt_pk_bf16_f32 v75, v46, v47
s_add_u32 m0, s59, 40960
s_nop 0
buffer_load_dwordx4 v9, s[20:23], s61 offen offset:0 lds
v_accvgpr_read_b32 v40, a96
v_accvgpr_read_b32 v41, a97
v_accvgpr_read_b32 v42, a98
v_accvgpr_read_b32 v43, a99
v_accvgpr_read_b32 v44, a112
v_accvgpr_read_b32 v45, a113
v_accvgpr_read_b32 v46, a114
v_accvgpr_read_b32 v47, a115
v_pk_fma_f32 v[40:41], v[152:153], v[48:49], v[40:41] op_sel:[0,0,0] op_sel_hi:[1,0,1]
v_pk_fma_f32 v[42:43], v[154:155], v[48:49], v[42:43] op_sel:[0,0,0] op_sel_hi:[1,0,1]
v_pk_fma_f32 v[44:45], v[156:157], v[48:49], v[44:45] op_sel:[0,0,0] op_sel_hi:[1,0,1]
v_pk_fma_f32 v[46:47], v[158:159], v[48:49], v[46:47] op_sel:[0,0,0] op_sel_hi:[1,0,1]
v_pk_mul_f32 v[40:41], v[40:41], v[52:53] op_sel:[0,0] op_sel_hi:[1,0]
v_pk_mul_f32 v[42:43], v[42:43], v[52:53] op_sel:[0,0] op_sel_hi:[1,0]
v_pk_mul_f32 v[44:45], v[44:45], v[52:53] op_sel:[0,0] op_sel_hi:[1,0]
v_pk_mul_f32 v[46:47], v[46:47], v[52:53] op_sel:[0,0] op_sel_hi:[1,0]
v_cvt_pk_bf16_f32 v76, v40, v41
v_cvt_pk_bf16_f32 v77, v42, v43
v_cvt_pk_bf16_f32 v78, v44, v45
v_cvt_pk_bf16_f32 v79, v46, v47
buffer_load_dwordx4 v10, s[20:23], s61 offen offset:1024 lds
s_add_u32 s61, s61, 8192
v_accvgpr_read_b32 v40, a4
v_accvgpr_read_b32 v41, a5
v_accvgpr_read_b32 v42, a6
v_accvgpr_read_b32 v43, a7
v_accvgpr_read_b32 v44, a20
v_accvgpr_read_b32 v45, a21
v_accvgpr_read_b32 v46, a22
v_accvgpr_read_b32 v47, a23
v_pk_fma_f32 v[40:41], v[128:129], v[48:49], v[40:41] op_sel:[0,1,0] op_sel_hi:[1,1,1]
v_pk_fma_f32 v[42:43], v[130:131], v[48:49], v[42:43] op_sel:[0,1,0] op_sel_hi:[1,1,1]
v_pk_fma_f32 v[44:45], v[132:133], v[48:49], v[44:45] op_sel:[0,1,0] op_sel_hi:[1,1,1]
v_pk_fma_f32 v[46:47], v[134:135], v[48:49], v[46:47] op_sel:[0,1,0] op_sel_hi:[1,1,1]
v_pk_mul_f32 v[40:41], v[40:41], v[52:53] op_sel:[0,1] op_sel_hi:[1,1]
v_pk_mul_f32 v[42:43], v[42:43], v[52:53] op_sel:[0,1] op_sel_hi:[1,1]
v_pk_mul_f32 v[44:45], v[44:45], v[52:53] op_sel:[0,1] op_sel_hi:[1,1]
v_pk_mul_f32 v[46:47], v[46:47], v[52:53] op_sel:[0,1] op_sel_hi:[1,1]
v_cvt_pk_bf16_f32 v80, v40, v41
v_cvt_pk_bf16_f32 v81, v42, v43
v_cvt_pk_bf16_f32 v82, v44, v45
v_cvt_pk_bf16_f32 v83, v46, v47
s_add_u32 m0, s59, 49152
s_nop 0
buffer_load_dwordx4 v11, s[24:27], s61 offen offset:0 lds
v_accvgpr_read_b32 v40, a36
v_accvgpr_read_b32 v41, a37
v_accvgpr_read_b32 v42, a38
v_accvgpr_read_b32 v43, a39
v_accvgpr_read_b32 v44, a52
v_accvgpr_read_b32 v45, a53
v_accvgpr_read_b32 v46, a54
v_accvgpr_read_b32 v47, a55
v_pk_fma_f32 v[40:41], v[136:137], v[48:49], v[40:41] op_sel:[0,1,0] op_sel_hi:[1,1,1]
v_pk_fma_f32 v[42:43], v[138:139], v[48:49], v[42:43] op_sel:[0,1,0] op_sel_hi:[1,1,1]
v_pk_fma_f32 v[44:45], v[140:141], v[48:49], v[44:45] op_sel:[0,1,0] op_sel_hi:[1,1,1]
v_pk_fma_f32 v[46:47], v[142:143], v[48:49], v[46:47] op_sel:[0,1,0] op_sel_hi:[1,1,1]
v_pk_mul_f32 v[40:41], v[40:41], v[52:53] op_sel:[0,1] op_sel_hi:[1,1]
v_pk_mul_f32 v[42:43], v[42:43], v[52:53] op_sel:[0,1] op_sel_hi:[1,1]
v_pk_mul_f32 v[44:45], v[44:45], v[52:53] op_sel:[0,1] op_sel_hi:[1,1]
v_pk_mul_f32 v[46:47], v[46:47], v[52:53] op_sel:[0,1] op_sel_hi:[1,1]
v_cvt_pk_bf16_f32 v84, v40, v41
v_cvt_pk_bf16_f32 v85, v42, v43
v_cvt_pk_bf16_f32 v86, v44, v45
v_cvt_pk_bf16_f32 v87, v46, v47
buffer_load_dwordx4 v12, s[24:27], s61 offen offset:1024 lds
v_accvgpr_read_b32 v40, a68
v_accvgpr_read_b32 v41, a69
v_accvgpr_read_b32 v42, a70
v_accvgpr_read_b32 v43, a71
v_accvgpr_read_b32 v44, a84
v_accvgpr_read_b32 v45, a85
v_accvgpr_read_b32 v46, a86
v_accvgpr_read_b32 v47, a87
v_pk_fma_f32 v[40:41], v[144:145], v[48:49], v[40:41] op_sel:[0,1,0] op_sel_hi:[1,1,1]
v_pk_fma_f32 v[42:43], v[146:147], v[48:49], v[42:43] op_sel:[0,1,0] op_sel_hi:[1,1,1]
v_pk_fma_f32 v[44:45], v[148:149], v[48:49], v[44:45] op_sel:[0,1,0] op_sel_hi:[1,1,1]
v_pk_fma_f32 v[46:47], v[150:151], v[48:49], v[46:47] op_sel:[0,1,0] op_sel_hi:[1,1,1]
v_pk_mul_f32 v[40:41], v[40:41], v[52:53] op_sel:[0,1] op_sel_hi:[1,1]
v_pk_mul_f32 v[42:43], v[42:43], v[52:53] op_sel:[0,1] op_sel_hi:[1,1]
v_pk_mul_f32 v[44:45], v[44:45], v[52:53] op_sel:[0,1] op_sel_hi:[1,1]
v_pk_mul_f32 v[46:47], v[46:47], v[52:53] op_sel:[0,1] op_sel_hi:[1,1]
v_cvt_pk_bf16_f32 v88, v40, v41
v_cvt_pk_bf16_f32 v89, v42, v43
v_cvt_pk_bf16_f32 v90, v44, v45
v_cvt_pk_bf16_f32 v91, v46, v47
s_add_u32 m0, s59, 57344
s_nop 0
buffer_load_dwordx4 v9, s[20:23], s61 offen offset:0 lds
v_accvgpr_read_b32 v40, a100
v_accvgpr_read_b32 v41, a101
v_accvgpr_read_b32 v42, a102
v_accvgpr_read_b32 v43, a103
v_accvgpr_read_b32 v44, a116
v_accvgpr_read_b32 v45, a117
v_accvgpr_read_b32 v46, a118
v_accvgpr_read_b32 v47, a119
v_pk_fma_f32 v[40:41], v[152:153], v[48:49], v[40:41] op_sel:[0,1,0] op_sel_hi:[1,1,1]
v_pk_fma_f32 v[42:43], v[154:155], v[48:49], v[42:43] op_sel:[0,1,0] op_sel_hi:[1,1,1]
v_pk_fma_f32 v[44:45], v[156:157], v[48:49], v[44:45] op_sel:[0,1,0] op_sel_hi:[1,1,1]
v_pk_fma_f32 v[46:47], v[158:159], v[48:49], v[46:47] op_sel:[0,1,0] op_sel_hi:[1,1,1]
v_pk_mul_f32 v[40:41], v[40:41], v[52:53] op_sel:[0,1] op_sel_hi:[1,1]
v_pk_mul_f32 v[42:43], v[42:43], v[52:53] op_sel:[0,1] op_sel_hi:[1,1]
v_pk_mul_f32 v[44:45], v[44:45], v[52:53] op_sel:[0,1] op_sel_hi:[1,1]
v_pk_mul_f32 v[46:47], v[46:47], v[52:53] op_sel:[0,1] op_sel_hi:[1,1]
v_cvt_pk_bf16_f32 v92, v40, v41
v_cvt_pk_bf16_f32 v93, v42, v43
v_cvt_pk_bf16_f32 v94, v44, v45
v_cvt_pk_bf16_f32 v95, v46, v47
buffer_load_dwordx4 v10, s[20:23], s61 offen offset:1024 lds
s_add_u32 s61, s61, 8192
v_accvgpr_read_b32 v40, a8
v_accvgpr_read_b32 v41, a9
v_accvgpr_read_b32 v42, a10
v_accvgpr_read_b32 v43, a11
v_accvgpr_read_b32 v44, a24
v_accvgpr_read_b32 v45, a25
v_accvgpr_read_b32 v46, a26
v_accvgpr_read_b32 v47, a27
v_pk_fma_f32 v[40:41], v[128:129], v[50:51], v[40:41] op_sel:[0,0,0] op_sel_hi:[1,0,1]
v_pk_fma_f32 v[42:43], v[130:131], v[50:51], v[42:43] op_sel:[0,0,0] op_sel_hi:[1,0,1]
v_pk_fma_f32 v[44:45], v[132:133], v[50:51], v[44:45] op_sel:[0,0,0] op_sel_hi:[1,0,1]
v_pk_fma_f32 v[46:47], v[134:135], v[50:51], v[46:47] op_sel:[0,0,0] op_sel_hi:[1,0,1]
v_pk_mul_f32 v[40:41], v[40:41], v[54:55] op_sel:[0,0] op_sel_hi:[1,0]
v_pk_mul_f32 v[42:43], v[42:43], v[54:55] op_sel:[0,0] op_sel_hi:[1,0]
v_pk_mul_f32 v[44:45], v[44:45], v[54:55] op_sel:[0,0] op_sel_hi:[1,0]
v_pk_mul_f32 v[46:47], v[46:47], v[54:55] op_sel:[0,0] op_sel_hi:[1,0]
v_cvt_pk_bf16_f32 v96, v40, v41
v_cvt_pk_bf16_f32 v97, v42, v43
v_cvt_pk_bf16_f32 v98, v44, v45
v_cvt_pk_bf16_f32 v99, v46, v47
v_accvgpr_read_b32 v40, a40
v_accvgpr_read_b32 v41, a41
v_accvgpr_read_b32 v42, a42
v_accvgpr_read_b32 v43, a43
v_accvgpr_read_b32 v44, a56
v_accvgpr_read_b32 v45, a57
v_accvgpr_read_b32 v46, a58
v_accvgpr_read_b32 v47, a59
v_pk_fma_f32 v[40:41], v[136:137], v[50:51], v[40:41] op_sel:[0,0,0] op_sel_hi:[1,0,1]
v_pk_fma_f32 v[42:43], v[138:139], v[50:51], v[42:43] op_sel:[0,0,0] op_sel_hi:[1,0,1]
v_pk_fma_f32 v[44:45], v[140:141], v[50:51], v[44:45] op_sel:[0,0,0] op_sel_hi:[1,0,1]
v_pk_fma_f32 v[46:47], v[142:143], v[50:51], v[46:47] op_sel:[0,0,0] op_sel_hi:[1,0,1]
v_pk_mul_f32 v[40:41], v[40:41], v[54:55] op_sel:[0,0] op_sel_hi:[1,0]
v_pk_mul_f32 v[42:43], v[42:43], v[54:55] op_sel:[0,0] op_sel_hi:[1,0]
v_pk_mul_f32 v[44:45], v[44:45], v[54:55] op_sel:[0,0] op_sel_hi:[1,0]
v_pk_mul_f32 v[46:47], v[46:47], v[54:55] op_sel:[0,0] op_sel_hi:[1,0]
v_cvt_pk_bf16_f32 v100, v40, v41
v_cvt_pk_bf16_f32 v101, v42, v43
v_cvt_pk_bf16_f32 v102, v44, v45
v_cvt_pk_bf16_f32 v103, v46, v47
v_accvgpr_read_b32 v40, a72
v_accvgpr_read_b32 v41, a73
v_accvgpr_read_b32 v42, a74
v_accvgpr_read_b32 v43, a75
v_accvgpr_read_b32 v44, a88
v_accvgpr_read_b32 v45, a89
v_accvgpr_read_b32 v46, a90
v_accvgpr_read_b32 v47, a91
v_pk_fma_f32 v[40:41], v[144:145], v[50:51], v[40:41] op_sel:[0,0,0] op_sel_hi:[1,0,1]
v_pk_fma_f32 v[42:43], v[146:147], v[50:51], v[42:43] op_sel:[0,0,0] op_sel_hi:[1,0,1]
v_pk_fma_f32 v[44:45], v[148:149], v[50:51], v[44:45] op_sel:[0,0,0] op_sel_hi:[1,0,1]
v_pk_fma_f32 v[46:47], v[150:151], v[50:51], v[46:47] op_sel:[0,0,0] op_sel_hi:[1,0,1]
v_pk_mul_f32 v[40:41], v[40:41], v[54:55] op_sel:[0,0] op_sel_hi:[1,0]
v_pk_mul_f32 v[42:43], v[42:43], v[54:55] op_sel:[0,0] op_sel_hi:[1,0]
v_pk_mul_f32 v[44:45], v[44:45], v[54:55] op_sel:[0,0] op_sel_hi:[1,0]
v_pk_mul_f32 v[46:47], v[46:47], v[54:55] op_sel:[0,0] op_sel_hi:[1,0]
v_cvt_pk_bf16_f32 v104, v40, v41
v_cvt_pk_bf16_f32 v105, v42, v43
v_cvt_pk_bf16_f32 v106, v44, v45
v_cvt_pk_bf16_f32 v107, v46, v47
v_accvgpr_read_b32 v40, a104
v_accvgpr_read_b32 v41, a105
v_accvgpr_read_b32 v42, a106
v_accvgpr_read_b32 v43, a107
v_accvgpr_read_b32 v44, a120
v_accvgpr_read_b32 v45, a121
v_accvgpr_read_b32 v46, a122
v_accvgpr_read_b32 v47, a123
v_pk_fma_f32 v[40:41], v[152:153], v[50:51], v[40:41] op_sel:[0,0,0] op_sel_hi:[1,0,1]
v_pk_fma_f32 v[42:43], v[154:155], v[50:51], v[42:43] op_sel:[0,0,0] op_sel_hi:[1,0,1]
v_pk_fma_f32 v[44:45], v[156:157], v[50:51], v[44:45] op_sel:[0,0,0] op_sel_hi:[1,0,1]
v_pk_fma_f32 v[46:47], v[158:159], v[50:51], v[46:47] op_sel:[0,0,0] op_sel_hi:[1,0,1]
v_pk_mul_f32 v[40:41], v[40:41], v[54:55] op_sel:[0,0] op_sel_hi:[1,0]
v_pk_mul_f32 v[42:43], v[42:43], v[54:55] op_sel:[0,0] op_sel_hi:[1,0]
v_pk_mul_f32 v[44:45], v[44:45], v[54:55] op_sel:[0,0] op_sel_hi:[1,0]
v_pk_mul_f32 v[46:47], v[46:47], v[54:55] op_sel:[0,0] op_sel_hi:[1,0]
v_cvt_pk_bf16_f32 v108, v40, v41
v_cvt_pk_bf16_f32 v109, v42, v43
v_cvt_pk_bf16_f32 v110, v44, v45
v_cvt_pk_bf16_f32 v111, v46, v47
v_accvgpr_read_b32 v40, a12
v_accvgpr_read_b32 v41, a13
v_accvgpr_read_b32 v42, a14
v_accvgpr_read_b32 v43, a15
v_accvgpr_read_b32 v44, a28
v_accvgpr_read_b32 v45, a29
v_accvgpr_read_b32 v46, a30
v_accvgpr_read_b32 v47, a31
v_pk_fma_f32 v[40:41], v[128:129], v[50:51], v[40:41] op_sel:[0,1,0] op_sel_hi:[1,1,1]
v_pk_fma_f32 v[42:43], v[130:131], v[50:51], v[42:43] op_sel:[0,1,0] op_sel_hi:[1,1,1]
v_pk_fma_f32 v[44:45], v[132:133], v[50:51], v[44:45] op_sel:[0,1,0] op_sel_hi:[1,1,1]
v_pk_fma_f32 v[46:47], v[134:135], v[50:51], v[46:47] op_sel:[0,1,0] op_sel_hi:[1,1,1]
v_pk_mul_f32 v[40:41], v[40:41], v[54:55] op_sel:[0,1] op_sel_hi:[1,1]
v_pk_mul_f32 v[42:43], v[42:43], v[54:55] op_sel:[0,1] op_sel_hi:[1,1]
v_pk_mul_f32 v[44:45], v[44:45], v[54:55] op_sel:[0,1] op_sel_hi:[1,1]
v_pk_mul_f32 v[46:47], v[46:47], v[54:55] op_sel:[0,1] op_sel_hi:[1,1]
v_cvt_pk_bf16_f32 v112, v40, v41
v_cvt_pk_bf16_f32 v113, v42, v43
v_cvt_pk_bf16_f32 v114, v44, v45
v_cvt_pk_bf16_f32 v115, v46, v47
v_accvgpr_read_b32 v40, a44
v_accvgpr_read_b32 v41, a45
v_accvgpr_read_b32 v42, a46
v_accvgpr_read_b32 v43, a47
v_accvgpr_read_b32 v44, a60
v_accvgpr_read_b32 v45, a61
v_accvgpr_read_b32 v46, a62
v_accvgpr_read_b32 v47, a63
v_pk_fma_f32 v[40:41], v[136:137], v[50:51], v[40:41] op_sel:[0,1,0] op_sel_hi:[1,1,1]
v_pk_fma_f32 v[42:43], v[138:139], v[50:51], v[42:43] op_sel:[0,1,0] op_sel_hi:[1,1,1]
v_pk_fma_f32 v[44:45], v[140:141], v[50:51], v[44:45] op_sel:[0,1,0] op_sel_hi:[1,1,1]
v_pk_fma_f32 v[46:47], v[142:143], v[50:51], v[46:47] op_sel:[0,1,0] op_sel_hi:[1,1,1]
v_pk_mul_f32 v[40:41], v[40:41], v[54:55] op_sel:[0,1] op_sel_hi:[1,1]
v_pk_mul_f32 v[42:43], v[42:43], v[54:55] op_sel:[0,1] op_sel_hi:[1,1]
v_pk_mul_f32 v[44:45], v[44:45], v[54:55] op_sel:[0,1] op_sel_hi:[1,1]
v_pk_mul_f32 v[46:47], v[46:47], v[54:55] op_sel:[0,1] op_sel_hi:[1,1]
v_cvt_pk_bf16_f32 v116, v40, v41
v_cvt_pk_bf16_f32 v117, v42, v43
v_cvt_pk_bf16_f32 v118, v44, v45
v_cvt_pk_bf16_f32 v119, v46, v47
v_accvgpr_read_b32 v40, a76
v_accvgpr_read_b32 v41, a77
v_accvgpr_read_b32 v42, a78
v_accvgpr_read_b32 v43, a79
v_accvgpr_read_b32 v44, a92
v_accvgpr_read_b32 v45, a93
v_accvgpr_read_b32 v46, a94
v_accvgpr_read_b32 v47, a95
v_pk_fma_f32 v[40:41], v[144:145], v[50:51], v[40:41] op_sel:[0,1,0] op_sel_hi:[1,1,1]
v_pk_fma_f32 v[42:43], v[146:147], v[50:51], v[42:43] op_sel:[0,1,0] op_sel_hi:[1,1,1]
v_pk_fma_f32 v[44:45], v[148:149], v[50:51], v[44:45] op_sel:[0,1,0] op_sel_hi:[1,1,1]
v_pk_fma_f32 v[46:47], v[150:151], v[50:51], v[46:47] op_sel:[0,1,0] op_sel_hi:[1,1,1]
v_pk_mul_f32 v[40:41], v[40:41], v[54:55] op_sel:[0,1] op_sel_hi:[1,1]
v_pk_mul_f32 v[42:43], v[42:43], v[54:55] op_sel:[0,1] op_sel_hi:[1,1]
v_pk_mul_f32 v[44:45], v[44:45], v[54:55] op_sel:[0,1] op_sel_hi:[1,1]
v_pk_mul_f32 v[46:47], v[46:47], v[54:55] op_sel:[0,1] op_sel_hi:[1,1]
v_cvt_pk_bf16_f32 v120, v40, v41
v_cvt_pk_bf16_f32 v121, v42, v43
v_cvt_pk_bf16_f32 v122, v44, v45
v_cvt_pk_bf16_f32 v123, v46, v47
v_accvgpr_read_b32 v40, a108
v_accvgpr_read_b32 v41, a109
v_accvgpr_read_b32 v42, a110
v_accvgpr_read_b32 v43, a111
v_accvgpr_read_b32 v44, a124
v_accvgpr_read_b32 v45, a125
v_accvgpr_read_b32 v46, a126
v_accvgpr_read_b32 v47, a127
v_pk_fma_f32 v[40:41], v[152:153], v[50:51], v[40:41] op_sel:[0,1,0] op_sel_hi:[1,1,1]
v_pk_fma_f32 v[42:43], v[154:155], v[50:51], v[42:43] op_sel:[0,1,0] op_sel_hi:[1,1,1]
v_pk_fma_f32 v[44:45], v[156:157], v[50:51], v[44:45] op_sel:[0,1,0] op_sel_hi:[1,1,1]
v_pk_fma_f32 v[46:47], v[158:159], v[50:51], v[46:47] op_sel:[0,1,0] op_sel_hi:[1,1,1]
v_pk_mul_f32 v[40:41], v[40:41], v[54:55] op_sel:[0,1] op_sel_hi:[1,1]
v_pk_mul_f32 v[42:43], v[42:43], v[54:55] op_sel:[0,1] op_sel_hi:[1,1]
v_pk_mul_f32 v[44:45], v[44:45], v[54:55] op_sel:[0,1] op_sel_hi:[1,1]
v_pk_mul_f32 v[46:47], v[46:47], v[54:55] op_sel:[0,1] op_sel_hi:[1,1]
v_cvt_pk_bf16_f32 v124, v40, v41
v_cvt_pk_bf16_f32 v125, v42, v43
v_cvt_pk_bf16_f32 v126, v44, v45
v_cvt_pk_bf16_f32 v127, v46, v47
s_barrier
s_waitcnt lgkmcnt(4)
N v[128:131],a[128:131],v[64:67],0
ds_read_b128 a[152:155], v34 offset:4096
v_lshlrev_b32 v55, 5, v0
M v[128:131],a[132:135],v[68:71]
v_mov_b32 v240, 0x3f803f80
v_mov_b32 v241, 0x3f803f80
N v[136:139],a[132:135],v[84:87],0
v_mov_b32 v242, 0x3f803f80
v_mov_b32 v243, 0x3f803f80
M v[136:139],a[128:131],v[80:83]
v_and_b32 v57, 15, v0
v_lshlrev_b32 v57, 11, v57
N v[144:147],a[128:131],v[96:99],0
ds_read_b128 a[156:159], v35 offset:4096
v_lshl_add_u32 v57, v63, 1, v57
M v[144:147],a[132:135],v[100:103]
N v[152:155],a[132:135],v[116:119],0
M v[152:155],a[128:131],v[112:115]
s_waitcnt lgkmcnt(4)
M v[152:155],a[140:143],v[124:127]
ds_read_b128 a[128:131], v32 offset:8192
M v[152:155],a[136:139],v[120:123]
M v[144:147],a[136:139],v[104:107]
M v[144:147],a[140:143],v[108:111]
M v[136:139],a[140:143],v[92:95]
ds_read_b128 a[132:135], v33 offset:8192
M v[136:139],a[136:139],v[88:91]
M v[128:131],a[136:139],v[72:75]
M v[128:131],a[140:143],v[76:79]
s_waitcnt lgkmcnt(4)
N v[132:135],a[144:147],v[64:67],0
ds_read_b128 a[136:139], v34 offset:8192
M v[132:135],a[148:151],v[68:71]
N v[140:143],a[148:151],v[84:87],0
M v[140:143],a[144:147],v[80:83]
N v[148:151],a[144:147],v[96:99],0
ds_read_b128 a[140:143], v35 offset:8192
M v[148:151],a[148:151],v[100:103]
N v[156:159],a[148:151],v[116:119],0
M v[156:159],a[144:147],v[112:115]
s_waitcnt lgkmcnt(4)
M v[156:159],a[156:159],v[124:127]
ds_read_b128 a[144:147], v32 offset:12288
M v[156:159],a[152:155],v[120:123]
M v[148:151],a[152:155],v[104:107]
M v[148:151],a[156:159],v[108:111]
M v[140:143],a[156:159],v[92:95]
ds_read_b128 a[148:151], v33 offset:12288
M v[140:143],a[152:155],v[88:91]
M v[132:135],a[152:155],v[72:75]
M v[132:135],a[156:159],v[76:79]
s_waitcnt lgkmcnt(4)
N v[160:163],a[128:131],v[64:67],0
ds_read_b128 a[152:155], v34 offset:12288
v_max3_f32 v192, v128, v129, v130
M v[160:163],a[132:135],v[68:71]
v_max3_f32 v196, v136, v137, v138
v_max3_f32 v196, v196, v139, v140
N v[168:171],a[132:135],v[84:87],0
v_max3_f32 v192, v192, v131, v132
v_max3_f32 v192, v192, v133, v134
M v[168:171],a[128:131],v[80:83]
v_max_f32 v192, v192, v135
v_max3_f32 v196, v196, v141, v142
N v[176:179],a[128:131],v[96:99],0
ds_read_b128 a[156:159], v35 offset:12288
v_max_f32 v196, v196, v143
M v[176:179],a[132:135],v[100:103]
v_max3_f32 v200, v144, v145, v146
v_max3_f32 v200, v200, v147, v148
N v[184:187],a[132:135],v[116:119],0
v_max3_f32 v200, v200, v149, v150
v_max_f32 v200, v200, v151
M v[184:187],a[128:131],v[112:115]
s_waitcnt lgkmcnt(4)
v_max3_f32 v204, v152, v153, v154
v_max3_f32 v204, v204, v155, v156
M v[184:187],a[140:143],v[124:127]
T a[128:129],v16,16384
T a[130:131],v16,20480
M v[184:187],a[136:139],v[120:123]
v_max3_f32 v204, v204, v157, v158
v_max_f32 v204, v204, v159
M v[176:179],a[136:139],v[104:107]
v_mov_b32 v193, v192
v_mov_b32 v197, v196
M v[176:179],a[140:143],v[108:111]
v_mov_b32 v201, v200
v_mov_b32 v205, v204
M v[168:171],a[140:143],v[92:95]
T a[132:133],v17,16384
T a[134:135],v17,20480
M v[168:171],a[136:139],v[88:91]
L_pad27:
s_cbranch_execz L_pb0
v_permlane32_swap_b32 v192, v193
v_permlane32_swap_b32 v196, v197
M v[160:163],a[136:139],v[72:75]
v_permlane32_swap_b32 v200, v201
v_permlane32_swap_b32 v204, v205
M v[160:163],a[140:143],v[76:79]
s_waitcnt lgkmcnt(6)
v_max_f32 v192, v192, v193
v_max_f32 v196, v196, v197
N v[164:167],a[144:147],v[64:67],0
T a[136:137],v18,16384
T a[138:139],v18,20480
M v[164:167],a[148:151],v[68:71]
v_max_f32 v200, v200, v201
v_max_f32 v204, v204, v205
N v[172:175],a[148:151],v[84:87],0
v_mov_b32 v193, v192
v_mov_b32 v197, v196
M v[172:175],a[144:147],v[80:83]
v_mov_b32 v201, v200
v_mov_b32 v205, v204
N v[180:183],a[144:147],v[96:99],0
T a[140:141],v19,16384
T a[142:143],v19,20480
M v[180:183],a[148:151],v[100:103]
v_permlane16_swap_b32 v192, v193
v_permlane16_swap_b32 v196, v197
N v[188:191],a[148:151],v[116:119],0
v_permlane16_swap_b32 v200, v201
v_permlane16_swap_b32 v204, v205
M v[188:191],a[144:147],v[112:115]
s_waitcnt lgkmcnt(8)
v_max_f32 v192, v192, v193
v_max_f32 v196, v196, v197
M v[188:191],a[156:159],v[124:127]
T a[144:145],v20,16384
T a[146:147],v20,20480
M v[188:191],a[152:155],v[120:123]
v_max_f32 v200, v200, v201
v_max_f32 v204, v204, v205
M v[180:183],a[152:155],v[104:107]
v_sub_f32 v195, 0, v192
v_sub_f32 v194, 0, v192
M v[180:183],a[156:159],v[108:111]
v_sub_f32 v193, 0, v192
v_sub_f32 v192, 0, v192
M v[172:175],a[156:159],v[92:95]
T a[148:149],v21,16384
T a[150:151],v21,20480
M v[172:175],a[152:155],v[88:91]
s_add_u32 m0, s59, 65536
v_sub_f32 v199, 0, v196
v_sub_f32 v198, 0, v196
M v[164:167],a[152:155],v[72:75]
buffer_load_dwordx4 v11, s[24:27], s61 offen offset:0 lds
v_sub_f32 v197, 0, v196
M v[164:167],a[156:159],v[76:79]
v_sub_f32 v196, 0, v196
v_sub_f32 v203, 0, v200
v_sub_f32 v202, 0, v200
v_sub_f32 v201, 0, v200
v_sub_f32 v200, 0, v200
v_sub_f32 v207, 0, v204
v_sub_f32 v206, 0, v204
v_sub_f32 v205, 0, v204
v_sub_f32 v204, 0, v204
v_add_f32 v128, v128, v192
v_exp_f32 v128, v128
v_add_f32 v129, v129, v192
v_exp_f32 v129, v129
v_add_f32 v130, v130, v192
v_cvt_pk_bf16_f32 v128, v128, v129
v_exp_f32 v130, v130
v_add_f32 v131, v131, v192
v_exp_f32 v131, v131
v_add_f32 v132, v132, v192
v_cvt_pk_bf16_f32 v129, v130, v131
v_exp_f32 v132, v132
v_add_f32 v133, v133, v192
v_exp_f32 v133, v133
v_add_f32 v134, v134, v192
v_cvt_pk_bf16_f32 v130, v132, v133
v_exp_f32 v134, v134
v_add_f32 v135, v135, v192
v_exp_f32 v135, v135
v_add_f32 v136, v136, v196
v_cvt_pk_bf16_f32 v131, v134, v135
v_exp_f32 v136, v136
v_add_f32 v137, v137, v196
v_exp_f32 v137, v137
v_add_f32 v138, v138, v196
v_cvt_pk_bf16_f32 v136, v136, v137
v_exp_f32 v138, v138
v_add_f32 v139, v139, v196
v_exp_f32 v139, v139
v_add_f32 v140, v140, v196
v_cvt_pk_bf16_f32 v137, v138, v139
v_exp_f32 v140, v140
v_add_f32 v141, v141, v196
v_exp_f32 v141, v141
v_add_f32 v142, v142, v196
v_cvt_pk_bf16_f32 v138, v140, v141
v_exp_f32 v142, v142
v_add_f32 v143, v143, v196
v_exp_f32 v143, v143
v_add_f32 v144, v144, v200
v_cvt_pk_bf16_f32 v139, v142, v143
v_exp_f32 v144, v144
v_add_f32 v145, v145, v200
v_exp_f32 v145, v145
v_add_f32 v146, v146, v200
v_cvt_pk_bf16_f32 v144, v144, v145
v_exp_f32 v146, v146
v_add_f32 v147, v147, v200
v_exp_f32 v147, v147
v_add_f32 v148, v148, v200
v_cvt_pk_bf16_f32 v145, v146, v147
v_exp_f32 v148, v148
v_add_f32 v149, v149, v200
v_exp_f32 v149, v149
v_add_f32 v150, v150, v200
v_cvt_pk_bf16_f32 v146, v148, v149
v_exp_f32 v150, v150
v_add_f32 v151, v151, v200
v_exp_f32 v151, v151
v_add_f32 v152, v152, v204
v_cvt_pk_bf16_f32 v147, v150, v151
v_exp_f32 v152, v152
v_add_f32 v153, v153, v204
v_exp_f32 v153, v153
v_add_f32 v154, v154, v204
v_cvt_pk_bf16_f32 v152, v152, v153
v_exp_f32 v154, v154
v_add_f32 v155, v155, v204
v_exp_f32 v155, v155
v_add_f32 v156, v156, v204
v_cvt_pk_bf16_f32 v153, v154, v155
v_exp_f32 v156, v156
v_add_f32 v157, v157, v204
v_exp_f32 v157, v157
v_add_f32 v158, v158, v204
v_cvt_pk_bf16_f32 v154, v156, v157
v_exp_f32 v158, v158
v_add_f32 v159, v159, v204
v_exp_f32 v159, v159
s_nop 0
v_cvt_pk_bf16_f32 v155, v158, v159
s_waitcnt lgkmcnt(8)
N a[0:3],a[128:131],v[128:131],0
T a[152:153],v22,16384
T a[154:155],v22,20480
N a[4:7],a[128:131],v[136:139],0
v_add_f32 v160, v160, v192
v_add_f32 v161, v161, v192
N a[8:11],a[128:131],v[144:147],0
v_exp_f32 v160, v160
N a[12:15],a[128:131],v[152:155],0
buffer_load_dwordx4 v12, s[24:27], s61 offen offset:1024 lds
v_add_f32 v162, v162, v192
N a[28:31],a[132:135],v[152:155],0
T a[156:157],v23,16384
T a[158:159],v23,20480
N a[24:27],a[132:135],v[144:147],0
s_add_u32 m0, s59, 73728
v_exp_f32 v161, v161
N a[20:23],a[132:135],v[136:139],0
buffer_load_dwordx4 v9, s[20:23], s61 offen offset:0 lds
v_cvt_pk_bf16_f32 v160, v160, v161
N a[16:19],a[132:135],v[128:131],0
s_waitcnt lgkmcnt(8)
v_exp_f32 v162, v162
N a[32:35],a[136:139],v[128:131],0
ds_read_b128 a[128:131], v32 offset:24576
v_add_f32 v163, v163, v192
N a[36:39],a[136:139],v[136:139],0
v_exp_f32 v163, v163
N a[40:43],a[136:139],v[144:147],0
v_cvt_pk_bf16_f32 v161, v162, v163
v_add_f32 v164, v164, v192
N a[44:47],a[136:139],v[152:155],0
buffer_load_dwordx4 v10, s[20:23], s61 offen offset:1024 lds
v_add_f32 v165, v165, v192
N a[60:63],a[140:143],v[152:155],0
s_add_u32 s61, s61, 8192
ds_read_b128 a[132:135], v33 offset:24576
v_add_f32 v166, v166, v192
N a[56:59],a[140:143],v[144:147],0
s_add_u32 m0, s59, 81920
v_exp_f32 v164, v164
N a[52:55],a[140:143],v[136:139],0
buffer_load_dwordx4 v11, s[24:27], s61 offen offset:0 lds
v_add_f32 v167, v167, v192
N a[48:51],a[140:143],v[128:131],0
s_waitcnt lgkmcnt(6)
v_exp_f32 v165, v165
N a[64:67],a[144:147],v[128:131],0
ds_read_b128 a[136:139], v34 offset:24576
v_cvt_pk_bf16_f32 v162, v164, v165
N a[68:71],a[144:147],v[136:139],0
v_exp_f32 v166, v166
N a[72:75],a[144:147],v[144:147],0
v_exp_f32 v167, v167
N a[76:79],a[144:147],v[152:155],0
buffer_load_dwordx4 v12, s[24:27], s61 offen offset:1024 lds
v_cvt_pk_bf16_f32 v163, v166, v167
N a[92:95],a[148:151],v[152:155],0
ds_read_b128 a[140:143], v35 offset:24576
v_add_f32 v168, v168, v196
N a[88:91],a[148:151],v[144:147],0
s_add_u32 m0, s59, 90112
v_exp_f32 v168, v168
N a[84:87],a[148:151],v[136:139],0
buffer_load_dwordx4 v9, s[20:23], s61 offen offset:0 lds
v_add_f32 v169, v169, v196
N a[80:83],a[148:151],v[128:131],0
s_waitcnt lgkmcnt(4)
v_exp_f32 v169, v169
N a[96:99],a[152:155],v[128:131],0
ds_read_b128 a[144:147], v32 offset:28672
v_cvt_pk_bf16_f32 v168, v168, v169
N a[100:103],a[152:155],v[136:139],0
v_add_f32 v170, v170, v196
v_add_f32 v171, v171, v196
N a[104:107],a[152:155],v[144:147],0
v_exp_f32 v170, v170
N a[108:111],a[152:155],v[152:155],0
buffer_load_dwordx4 v10, s[20:23], s61 offen offset:1024 lds
v_add_f32 v172, v172, v196
N a[124:127],a[156:159],v[152:155],0
s_add_u32 s61, s61, 8192
ds_read_b128 a[148:151], v33 offset:28672
v_add_f32 v173, v173, v196
N a[120:123],a[156:159],v[144:147],0
s_add_u32 m0, s59, 98304
v_exp_f32 v171, v171
N a[116:119],a[156:159],v[136:139],0
buffer_load_dwordx4 v11, s[24:27], s61 offen offset:0 lds
v_cvt_pk_bf16_f32 v169, v170, v171
N a[112:115],a[156:159],v[128:131],0
v_exp_f32 v172, v172
N v[208:211],v[240:243],v[128:131],0
v_exp_f32 v173, v173
N v[212:215],v[240:243],v[136:139],0
v_cvt_pk_bf16_f32 v170, v172, v173
v_add_f32 v174, v174, v196
N v[216:219],v[240:243],v[144:147],0
v_exp_f32 v174, v174
N v[220:223],v[240:243],v[152:155],0
s_waitcnt lgkmcnt(4)
v_add_f32 v175, v175, v196
v_add_f32 v176, v176, v200
N v[128:131],a[128:131],v[64:67],v[192:195]
ds_read_b128 a[152:155], v34 offset:28672
v_add_f32 v177, v177, v200
M v[128:131],a[132:135],v[68:71]
v_exp_f32 v175, v175
N v[136:139],a[132:135],v[84:87],v[196:199]
v_exp_f32 v176, v176
M v[136:139],a[128:131],v[80:83]
v_exp_f32 v177, v177
N v[144:147],a[128:131],v[96:99],v[200:203]
ds_read_b128 a[156:159], v35 offset:28672
v_cvt_pk_bf16_f32 v171, v174, v175
M v[144:147],a[132:135],v[100:103]
v_cvt_pk_bf16_f32 v176, v176, v177
v_add_f32 v178, v178, v200
N v[152:155],a[132:135],v[116:119],v[204:207]
buffer_load_dwordx4 v12, s[24:27], s61 offen offset:1024 lds
v_add_f32 v179, v179, v200
M v[152:155],a[128:131],v[112:115]
s_waitcnt vmcnt(10)
s_barrier
s_waitcnt lgkmcnt(4)
M v[152:155],a[140:143],v[124:127]
T a[128:129],v16,32768
T a[130:131],v16,36864
M v[152:155],a[136:139],v[120:123]
v_exp_f32 v178, v178
M v[144:147],a[136:139],v[104:107]
v_exp_f32 v179, v179
M v[144:147],a[140:143],v[108:111]
v_cvt_pk_bf16_f32 v177, v178, v179
v_add_f32 v180, v180, v200
M v[136:139],a[140:143],v[92:95]
T a[132:133],v17,32768
T a[134:135],v17,36864
M v[136:139],a[136:139],v[88:91]
s_add_u32 m0, s59, 106496
v_exp_f32 v180, v180
M v[128:131],a[136:139],v[72:75]
buffer_load_dwordx4 v9, s[20:23], s61 offen offset:0 lds
v_add_f32 v181, v181, v200
M v[128:131],a[140:143],v[76:79]
s_waitcnt lgkmcnt(6)
v_exp_f32 v181, v181
N v[132:135],a[144:147],v[64:67],v[192:195]
T a[136:137],v18,32768
T a[138:139],v18,36864
M v[132:135],a[148:151],v[68:71]
v_cvt_pk_bf16_f32 v178, v180, v181
v_add_f32 v182, v182, v200
N v[140:143],a[148:151],v[84:87],v[196:199]
v_exp_f32 v182, v182
M v[140:143],a[144:147],v[80:83]
v_add_f32 v183, v183, v200
v_add_f32 v184, v184, v204
N v[148:151],a[144:147],v[96:99],v[200:203]
T a[140:141],v19,32768
T a[142:143],v19,36864
M v[148:151],a[148:151],v[100:103]
v_exp_f32 v183, v183
N v[156:159],a[148:151],v[116:119],v[204:207]
buffer_load_dwordx4 v10, s[20:23], s61 offen offset:1024 lds
v_cvt_pk_bf16_f32 v179, v182, v183
M v[156:159],a[144:147],v[112:115]
s_waitcnt lgkmcnt(8)
v_exp_f32 v184, v184
M v[156:159],a[156:159],v[124:127]
s_add_u32 s61, s61, 8192
T a[144:145],v20,32768
T a[146:147],v20,36864
M v[156:159],a[152:155],v[120:123]
v_add_f32 v185, v185, v204
v_add_f32 v186, v186, v204
M v[148:151],a[152:155],v[104:107]
v_exp_f32 v185, v185
M v[148:151],a[156:159],v[108:111]
v_exp_f32 v186, v186
M v[140:143],a[156:159],v[92:95]
T a[148:149],v21,32768
T a[150:151],v21,36864
M v[140:143],a[152:155],v[88:91]
s_add_u32 m0, s59, 114688
v_cvt_pk_bf16_f32 v184, v184, v185
v_add_f32 v187, v187, v204
M v[132:135],a[152:155],v[72:75]
buffer_load_dwordx4 v11, s[24:27], s61 offen offset:0 lds
v_add_f32 v188, v188, v204
M v[132:135],a[156:159],v[76:79]
v_exp_f32 v187, v187
v_exp_f32 v188, v188
v_cvt_pk_bf16_f32 v185, v186, v187
v_add_f32 v189, v189, v204
v_exp_f32 v189, v189
v_add_f32 v190, v190, v204
v_cvt_pk_bf16_f32 v186, v188, v189
v_exp_f32 v190, v190
v_add_f32 v191, v191, v204
v_exp_f32 v191, v191
s_nop 0
v_cvt_pk_bf16_f32 v187, v190, v191
s_barrier
s_waitcnt lgkmcnt(8)
M a[0:3],a[128:131],v[160:163]
T a[152:153],v22,32768
T a[154:155],v22,36864
M a[4:7],a[128:131],v[168:171]
v_exp_f32 v128, v128
M a[8:11],a[128:131],v[176:179]
v_exp_f32 v129, v129
M a[12:15],a[128:131],v[184:187]
buffer_load_dwordx4 v12, s[24:27], s61 offen offset:1024 lds
v_cvt_pk_bf16_f32 v128, v128, v129
M a[28:31],a[132:135],v[184:187]
T a[156:157],v23,32768
T a[158:159],v23,36864
M a[24:27],a[132:135],v[176:179]
s_add_u32 m0, s59, 122880
v_exp_f32 v130, v130
M a[20:23],a[132:135],v[168:171]
buffer_load_dwordx4 v9, s[20:23], s61 offen offset:0 lds
M a[16:19],a[132:135],v[160:163]
s_waitcnt lgkmcnt(8)
v_exp_f32 v131, v131
M a[32:35],a[136:139],v[160:163]
ds_read_b128 a[128:131], v32 offset:40960
v_cvt_pk_bf16_f32 v129, v130, v131
M a[36:39],a[136:139],v[168:171]
v_exp_f32 v132, v132
M a[40:43],a[136:139],v[176:179]
v_exp_f32 v133, v133
M a[44:47],a[136:139],v[184:187]
buffer_load_dwordx4 v10, s[20:23], s61 offen offset:1024 lds
v_cvt_pk_bf16_f32 v130, v132, v133
M a[60:63],a[140:143],v[184:187]
s_add_u32 s61, s61, 8192
ds_read_b128 a[132:135], v33 offset:40960
M a[56:59],a[140:143],v[176:179]
s_add_u32 m0, s59, 0
v_exp_f32 v134, v134
M a[52:55],a[140:143],v[168:171]
buffer_load_dwordx4 v11, s[24:27], s61 offen offset:0 lds
M a[48:51],a[140:143],v[160:163]
s_waitcnt lgkmcnt(6)
v_exp_f32 v135, v135
M a[64:67],a[144:147],v[160:163]
ds_read_b128 a[136:139], v34 offset:40960
v_cvt_pk_bf16_f32 v131, v134, v135
M a[68:71],a[144:147],v[168:171]
v_exp_f32 v136, v136
M a[72:75],a[144:147],v[176:179]
v_exp_f32 v137, v137
M a[76:79],a[144:147],v[184:187]
v_exp_f32 v138, v138
M a[92:95],a[148:151],v[184:187]
ds_read_b128 a[140:143], v35 offset:40960
v_cvt_pk_bf16_f32 v136, v136, v137
M a[88:91],a[148:151],v[176:179]
v_exp_f32 v139, v139
M a[84:87],a[148:151],v[168:171]
buffer_load_dwordx4 v12, s[24:27], s61 offen offset:1024 lds
v_cvt_pk_bf16_f32 v137, v138, v139
M a[80:83],a[148:151],v[160:163]
s_waitcnt lgkmcnt(4)
v_exp_f32 v140, v140
M a[96:99],a[152:155],v[160:163]
ds_read_b128 a[144:147], v32 offset:45056
M a[100:103],a[152:155],v[168:171]
v_exp_f32 v141, v141
M a[104:107],a[152:155],v[176:179]
v_exp_f32 v142, v142
M a[108:111],a[152:155],v[184:187]
v_exp_f32 v143, v143
M a[124:127],a[156:159],v[184:187]
ds_read_b128 a[148:151], v33 offset:45056
v_cvt_pk_bf16_f32 v138, v140, v141
M a[120:123],a[156:159],v[176:179]
s_add_u32 m0, s59, 8192
v_exp_f32 v144, v144
M a[116:119],a[156:159],v[168:171]
buffer_load_dwordx4 v9, s[20:23], s61 offen offset:0 lds
v_cvt_pk_bf16_f32 v139, v142, v143
M a[112:115],a[156:159],v[160:163]
v_exp_f32 v145, v145
M v[208:211],v[240:243],v[160:163]
v_exp_f32 v146, v146
M v[212:215],v[240:243],v[168:171]
v_exp_f32 v147, v147
M v[216:219],v[240:243],v[176:179]
v_exp_f32 v148, v148
M v[220:223],v[240:243],v[184:187]
s_waitcnt lgkmcnt(4)
v_exp_f32 v149, v149
N v[160:163],a[128:131],v[64:67],v[192:195]
ds_read_b128 a[152:155], v34 offset:45056
v_cvt_pk_bf16_f32 v144, v144, v145
M v[160:163],a[132:135],v[68:71]
v_exp_f32 v150, v150
N v[168:171],a[132:135],v[84:87],v[196:199]
v_exp_f32 v151, v151
M v[168:171],a[128:131],v[80:83]
v_exp_f32 v152, v152
N v[176:179],a[128:131],v[96:99],v[200:203]
ds_read_b128 a[156:159], v35 offset:45056
v_cvt_pk_bf16_f32 v145, v146, v147
M v[176:179],a[132:135],v[100:103]
v_exp_f32 v153, v153
N v[184:187],a[132:135],v[116:119],v[204:207]
buffer_load_dwordx4 v10, s[20:23], s61 offen offset:1024 lds
v_cvt_pk_bf16_f32 v146, v148, v149
M v[184:187],a[128:131],v[112:115]
s_waitcnt lgkmcnt(4)
v_exp_f32 v154, v154
M v[184:187],a[140:143],v[124:127]
s_add_u32 s61, s61, 8192
T a[128:129],v16,49152
T a[130:131],v16,53248
M v[184:187],a[136:139],v[120:123]
v_exp_f32 v155, v155
M v[176:179],a[136:139],v[104:107]
v_exp_f32 v156, v156
M v[176:179],a[140:143],v[108:111]
v_exp_f32 v157, v157
M v[168:171],a[140:143],v[92:95]
T a[132:133],v17,49152
T a[134:135],v17,53248
M v[168:171],a[136:139],v[88:91]
s_add_u32 m0, s59, 16384
v_exp_f32 v158, v158
M v[160:163],a[136:139],v[72:75]
buffer_load_dwordx4 v11, s[24:27], s61 offen offset:0 lds
v_cvt_pk_bf16_f32 v147, v150, v151
M v[160:163],a[140:143],v[76:79]
s_waitcnt lgkmcnt(6)
v_exp_f32 v159, v159
N v[164:167],a[144:147],v[64:67],v[192:195]
T a[136:137],v18,49152
T a[138:139],v18,53248
M v[164:167],a[148:151],v[68:71]
v_cvt_pk_bf16_f32 v152, v152, v153
v_cvt_pk_bf16_f32 v153, v154, v155
N v[172:175],a[148:151],v[84:87],v[196:199]
v_cvt_pk_bf16_f32 v154, v156, v157
v_cvt_pk_bf16_f32 v155, v158, v159
M v[172:175],a[144:147],v[80:83]
N v[180:183],a[144:147],v[96:99],v[200:203]
T a[140:141],v19,49152
T a[142:143],v19,53248
M v[180:183],a[148:151],v[100:103]
N v[188:191],a[148:151],v[116:119],v[204:207]
buffer_load_dwordx4 v12, s[24:27], s61 offen offset:1024 lds
M v[188:191],a[144:147],v[112:115]
s_waitcnt lgkmcnt(8)
M v[188:191],a[156:159],v[124:127]
T a[144:145],v20,49152
T a[146:147],v20,53248
M v[188:191],a[152:155],v[120:123]
M v[180:183],a[152:155],v[104:107]
M v[180:183],a[156:159],v[108:111]
M v[172:175],a[156:159],v[92:95]
T a[148:149],v21,49152
T a[150:151],v21,53248
M v[172:175],a[152:155],v[88:91]
s_add_u32 m0, s59, 24576
M v[164:167],a[152:155],v[72:75]
buffer_load_dwordx4 v9, s[20:23], s61 offen offset:0 lds
M v[164:167],a[156:159],v[76:79]
s_waitcnt lgkmcnt(8)
M a[0:3],a[128:131],v[128:131]
T a[152:153],v22,49152
T a[154:155],v22,53248
M a[4:7],a[128:131],v[136:139]
v_exp_f32 v160, v160
M a[8:11],a[128:131],v[144:147]
v_exp_f32 v161, v161
M a[12:15],a[128:131],v[152:155]
v_exp_f32 v162, v162
M a[28:31],a[132:135],v[152:155]
T a[156:157],v23,49152
T a[158:159],v23,53248
M a[24:27],a[132:135],v[144:147]
v_exp_f32 v163, v163
M a[20:23],a[132:135],v[136:139]
buffer_load_dwordx4 v10, s[20:23], s61 offen offset:1024 lds
v_cvt_pk_bf16_f32 v160, v160, v161
M a[16:19],a[132:135],v[128:131]
s_waitcnt lgkmcnt(8)
v_exp_f32 v164, v164
M a[32:35],a[136:139],v[128:131]
s_add_u32 s61, s61, 8192
ds_read_b128 a[128:131], v32 offset:57344
v_cvt_pk_bf16_f32 v161, v162, v163
M a[36:39],a[136:139],v[136:139]
v_exp_f32 v165, v165
M a[40:43],a[136:139],v[144:147]
v_exp_f32 v166, v166
M a[44:47],a[136:139],v[152:155]
v_exp_f32 v167, v167
M a[60:63],a[140:143],v[152:155]
ds_read_b128 a[132:135], v33 offset:57344
v_cvt_pk_bf16_f32 v162, v164, v165
M a[56:59],a[140:143],v[144:147]
v_exp_f32 v168, v168
M a[52:55],a[140:143],v[136:139]
buffer_load_dword v56, v55, s[32:35], s78 offen
v_cvt_pk_bf16_f32 v163, v166, v167
M a[48:51],a[140:143],v[128:131]
s_waitcnt lgkmcnt(6)
v_exp_f32 v169, v169
M a[64:67],a[144:147],v[128:131]
s_add_u32 s78, s78, 2048
ds_read_b128 a[136:139], v34 offset:57344
v_cvt_pk_bf16_f32 v168, v168, v169
M a[68:71],a[144:147],v[136:139]
v_exp_f32 v170, v170
M a[72:75],a[144:147],v[144:147]
v_exp_f32 v171, v171
M a[76:79],a[144:147],v[152:155]
v_exp_f32 v172, v172
M a[92:95],a[148:151],v[152:155]
ds_read_b128 a[140:143], v35 offset:57344
v_cvt_pk_bf16_f32 v169, v170, v171
M a[88:91],a[148:151],v[144:147]
v_exp_f32 v173, v173
M a[84:87],a[148:151],v[136:139]
buffer_load_dword v56, v55, s[32:35], s78 offen
v_cvt_pk_bf16_f32 v170, v172, v173
M a[80:83],a[148:151],v[128:131]
s_waitcnt lgkmcnt(4)
v_exp_f32 v174, v174
M a[96:99],a[152:155],v[128:131]
s_add_u32 s78, s78, 2048
ds_read_b128 a[144:147], v32 offset:61440
M a[100:103],a[152:155],v[136:139]
v_exp_f32 v175, v175
M a[104:107],a[152:155],v[144:147]
v_exp_f32 v176, v176
M a[108:111],a[152:155],v[152:155]
v_exp_f32 v177, v177
M a[124:127],a[156:159],v[152:155]
ds_read_b128 a[148:151], v33 offset:61440
v_cvt_pk_bf16_f32 v171, v174, v175
M a[120:123],a[156:159],v[144:147]
v_exp_f32 v178, v178
M a[116:119],a[156:159],v[136:139]
buffer_load_dword v56, v55, s[32:35], s78 offen
v_cvt_pk_bf16_f32 v176, v176, v177
M a[112:115],a[156:159],v[128:131]
v_exp_f32 v179, v179
M v[208:211],v[240:243],v[128:131]
s_add_u32 s78, s78, 2048
v_exp_f32 v180, v180
M v[212:215],v[240:243],v[136:139]
v_exp_f32 v181, v181
M v[216:219],v[240:243],v[144:147]
v_exp_f32 v182, v182
M v[220:223],v[240:243],v[152:155]
s_waitcnt lgkmcnt(4)
v_exp_f32 v183, v183
N v[128:131],a[128:131],v[64:67],v[192:195]
ds_read_b128 a[152:155], v34 offset:61440
v_cvt_pk_bf16_f32 v177, v178, v179
M v[128:131],a[132:135],v[68:71]
v_exp_f32 v184, v184
N v[136:139],a[132:135],v[84:87],v[196:199]
v_exp_f32 v185, v185
M v[136:139],a[128:131],v[80:83]
v_exp_f32 v186, v186
N v[144:147],a[128:131],v[96:99],v[200:203]
ds_read_b128 a[156:159], v35 offset:61440
v_cvt_pk_bf16_f32 v178, v180, v181
M v[144:147],a[132:135],v[100:103]
v_exp_f32 v187, v187
N v[152:155],a[132:135],v[116:119],v[204:207]
buffer_load_dword v56, v55, s[32:35], s78 offen
v_cvt_pk_bf16_f32 v179, v182, v183
M v[152:155],a[128:131],v[112:115]
s_waitcnt vmcnt(20)
s_barrier
s_waitcnt lgkmcnt(4)
M v[152:155],a[140:143],v[124:127]
s_add_u32 s78, s78, 2048
T a[128:129],v24,0
T a[130:131],v24,4096
M v[152:155],a[136:139],v[120:123]
v_exp_f32 v188, v188
M v[144:147],a[136:139],v[104:107]
v_exp_f32 v189, v189
M v[144:147],a[140:143],v[108:111]
v_exp_f32 v190, v190
M v[136:139],a[140:143],v[92:95]
T a[132:133],v25,0
T a[134:135],v25,4096
M v[136:139],a[136:139],v[88:91]
L_pad28:
s_cbranch_execz L_pb0
v_exp_f32 v191, v191
M v[128:131],a[136:139],v[72:75]
v_cvt_pk_bf16_f32 v184, v184, v185
v_cvt_pk_bf16_f32 v185, v186, v187
M v[128:131],a[140:143],v[76:79]
s_waitcnt lgkmcnt(6)
v_cvt_pk_bf16_f32 v186, v188, v189
v_cvt_pk_bf16_f32 v187, v190, v191
N v[132:135],a[144:147],v[64:67],v[192:195]
T a[136:137],v26,0
T a[138:139],v26,4096
M v[132:135],a[148:151],v[68:71]
N v[140:143],a[148:151],v[84:87],v[196:199]
M v[140:143],a[144:147],v[80:83]
N v[148:151],a[144:147],v[96:99],v[200:203]
T a[140:141],v27,0
T a[142:143],v27,4096
M v[148:151],a[148:151],v[100:103]
N v[156:159],a[148:151],v[116:119],v[204:207]
M v[156:159],a[144:147],v[112:115]
s_waitcnt lgkmcnt(8)
M v[156:159],a[156:159],v[124:127]
T a[144:145],v28,0
T a[146:147],v28,4096
M v[156:159],a[152:155],v[120:123]
M v[148:151],a[152:155],v[104:107]
M v[148:151],a[156:159],v[108:111]
M v[140:143],a[156:159],v[92:95]
T a[148:149],v29,0
T a[150:151],v29,4096
M v[140:143],a[152:155],v[88:91]
M v[132:135],a[152:155],v[72:75]
M v[132:135],a[156:159],v[76:79]
s_barrier
s_waitcnt lgkmcnt(8)
M a[0:3],a[128:131],v[160:163]
T a[152:153],v30,0
T a[154:155],v30,4096
M a[4:7],a[128:131],v[168:171]
v_exp_f32 v128, v128
M a[8:11],a[128:131],v[176:179]
v_exp_f32 v129, v129
M a[12:15],a[128:131],v[184:187]
v_exp_f32 v130, v130
M a[28:31],a[132:135],v[184:187]
T a[156:157],v31,0
T a[158:159],v31,4096
M a[24:27],a[132:135],v[176:179]
s_add_u32 m0, s59, 32768
v_exp_f32 v131, v131
M a[20:23],a[132:135],v[168:171]
buffer_load_dwordx4 v11, s[24:27], s61 offen offset:0 lds
v_cvt_pk_bf16_f32 v128, v128, v129
M a[16:19],a[132:135],v[160:163]
s_waitcnt lgkmcnt(8)
v_exp_f32 v132, v132
M a[32:35],a[136:139],v[160:163]
ds_read_b128 a[128:131], v36 offset:8192
v_cvt_pk_bf16_f32 v129, v130, v131
M a[36:39],a[136:139],v[168:171]
v_exp_f32 v133, v133
M a[40:43],a[136:139],v[176:179]
v_exp_f32 v134, v134
M a[44:47],a[136:139],v[184:187]
v_exp_f32 v135, v135
M a[60:63],a[140:143],v[184:187]
ds_read_b128 a[132:135], v37 offset:8192
v_cvt_pk_bf16_f32 v130, v132, v133
M a[56:59],a[140:143],v[176:179]
v_exp_f32 v136, v136
M a[52:55],a[140:143],v[168:171]
buffer_load_dwordx4 v12, s[24:27], s61 offen offset:1024 lds
v_cvt_pk_bf16_f32 v131, v134, v135
M a[48:51],a[140:143],v[160:163]
s_waitcnt lgkmcnt(6)
v_exp_f32 v137, v137
M a[64:67],a[144:147],v[160:163]
ds_read_b128 a[136:139], v38 offset:8192
v_cvt_pk_bf16_f32 v136, v136, v137
M a[68:71],a[144:147],v[168:171]
v_exp_f32 v138, v138
M a[72:75],a[144:147],v[176:179]
v_exp_f32 v139, v139
M a[76:79],a[144:147],v[184:187]
v_exp_f32 v140, v140
M a[92:95],a[148:151],v[184:187]
ds_read_b128 a[140:143], v39 offset:8192
v_cvt_pk_bf16_f32 v137, v138, v139
M a[88:91],a[148:151],v[176:179]
s_add_u32 m0, s59, 40960
v_exp_f32 v141, v141
M a[84:87],a[148:151],v[168:171]
buffer_load_dwordx4 v9, s[20:23], s61 offen offset:0 lds
v_cvt_pk_bf16_f32 v138, v140, v141
M a[80:83],a[148:151],v[160:163]
s_waitcnt lgkmcnt(4)
v_exp_f32 v142, v142
M a[96:99],a[152:155],v[160:163]
ds_read_b128 a[144:147], v36 offset:12288
M a[100:103],a[152:155],v[168:171]
v_exp_f32 v143, v143
M a[104:107],a[152:155],v[176:179]
v_exp_f32 v144, v144
M a[108:111],a[152:155],v[184:187]
v_exp_f32 v145, v145
M a[124:127],a[156:159],v[184:187]
ds_read_b128 a[148:151], v37 offset:12288
v_cvt_pk_bf16_f32 v139, v142, v143
M a[120:123],a[156:159],v[176:179]
v_exp_f32 v146, v146
M a[116:119],a[156:159],v[168:171]
buffer_load_dwordx4 v10, s[20:23], s61 offen offset:1024 lds
v_cvt_pk_bf16_f32 v144, v144, v145
M a[112:115],a[156:159],v[160:163]
v_exp_f32 v147, v147
M v[208:211],v[240:243],v[160:163]
s_add_u32 s61, s61, 8192
v_exp_f32 v148, v148
M v[212:215],v[240:243],v[168:171]
v_exp_f32 v149, v149
M v[216:219],v[240:243],v[176:179]
v_exp_f32 v150, v150
M v[220:223],v[240:243],v[184:187]
s_waitcnt lgkmcnt(4)
v_exp_f32 v151, v151
N v[160:163],a[128:131],v[64:67],v[192:195]
ds_read_b128 a[152:155], v38 offset:12288
v_cvt_pk_bf16_f32 v145, v146, v147
M v[160:163],a[132:135],v[68:71]
v_exp_f32 v152, v152
N v[168:171],a[132:135],v[84:87],v[196:199]
v_exp_f32 v153, v153
M v[168:171],a[128:131],v[80:83]
v_exp_f32 v154, v154
N v[176:179],a[128:131],v[96:99],v[200:203]
ds_read_b128 a[156:159], v39 offset:12288
v_cvt_pk_bf16_f32 v146, v148, v149
M v[176:179],a[132:135],v[100:103]
s_add_u32 m0, s59, 49152
v_exp_f32 v155, v155
N v[184:187],a[132:135],v[116:119],v[204:207]
buffer_load_dwordx4 v11, s[24:27], s61 offen offset:0 lds
v_cvt_pk_bf16_f32 v147, v150, v151
M v[184:187],a[128:131],v[112:115]
s_waitcnt lgkmcnt(4)
v_exp_f32 v156, v156
M v[184:187],a[140:143],v[124:127]
T a[128:129],v24,16384
T a[130:131],v24,20480
M v[184:187],a[136:139],v[120:123]
v_exp_f32 v157, v157
M v[176:179],a[136:139],v[104:107]
v_exp_f32 v158, v158
M v[176:179],a[140:143],v[108:111]
v_exp_f32 v159, v159
M v[168:171],a[140:143],v[92:95]
T a[132:133],v25,16384
T a[134:135],v25,20480
M v[168:171],a[136:139],v[88:91]
v_cvt_pk_bf16_f32 v152, v152, v153
v_cvt_pk_bf16_f32 v153, v154, v155
M v[160:163],a[136:139],v[72:75]
buffer_load_dwordx4 v12, s[24:27], s61 offen offset:1024 lds
v_cvt_pk_bf16_f32 v154, v156, v157
M v[160:163],a[140:143],v[76:79]
v_cvt_pk_bf16_f32 v155, v158, v159
s_waitcnt lgkmcnt(6)
N v[164:167],a[144:147],v[64:67],v[192:195]
T a[136:137],v26,16384
T a[138:139],v26,20480
M v[164:167],a[148:151],v[68:71]
N v[172:175],a[148:151],v[84:87],v[196:199]
M v[172:175],a[144:147],v[80:83]
N v[180:183],a[144:147],v[96:99],v[200:203]
T a[140:141],v27,16384
T a[142:143],v27,20480
M v[180:183],a[148:151],v[100:103]
s_add_u32 m0, s59, 57344
N v[188:191],a[148:151],v[116:119],v[204:207]
buffer_load_dwordx4 v9, s[20:23], s61 offen offset:0 lds
M v[188:191],a[144:147],v[112:115]
s_waitcnt lgkmcnt(8)
M v[188:191],a[156:159],v[124:127]
T a[144:145],v28,16384
T a[146:147],v28,20480
M v[188:191],a[152:155],v[120:123]
M v[180:183],a[152:155],v[104:107]
M v[180:183],a[156:159],v[108:111]
M v[172:175],a[156:159],v[92:95]
T a[148:149],v29,16384
T a[150:151],v29,20480
M v[172:175],a[152:155],v[88:91]
M v[164:167],a[152:155],v[72:75]
buffer_load_dwordx4 v10, s[20:23], s61 offen offset:1024 lds
s_add_u32 s61, s61, 8192
M v[164:167],a[156:159],v[76:79]
s_waitcnt lgkmcnt(8)
M a[0:3],a[128:131],v[128:131]
T a[152:153],v30,16384
T a[154:155],v30,20480
M a[4:7],a[128:131],v[136:139]
v_exp_f32 v160, v160
M a[8:11],a[128:131],v[144:147]
v_exp_f32 v161, v161
M a[12:15],a[128:131],v[152:155]
v_exp_f32 v162, v162
M a[28:31],a[132:135],v[152:155]
T a[156:157],v31,16384
T a[158:159],v31,20480
M a[24:27],a[132:135],v[144:147]
v_exp_f32 v163, v163
M a[20:23],a[132:135],v[136:139]
buffer_load_dword v56, v55, s[28:31], s79 offen
v_cvt_pk_bf16_f32 v160, v160, v161
M a[16:19],a[132:135],v[128:131]
s_waitcnt lgkmcnt(8)
v_exp_f32 v164, v164
M a[32:35],a[136:139],v[128:131]
s_add_u32 s79, s79, 2048
ds_read_b128 a[128:131], v36 offset:24576
v_cvt_pk_bf16_f32 v161, v162, v163
M a[36:39],a[136:139],v[136:139]
v_exp_f32 v165, v165
M a[40:43],a[136:139],v[144:147]
v_exp_f32 v166, v166
M a[44:47],a[136:139],v[152:155]
v_exp_f32 v167, v167
M a[60:63],a[140:143],v[152:155]
ds_read_b128 a[132:135], v37 offset:24576
v_cvt_pk_bf16_f32 v162, v164, v165
M a[56:59],a[140:143],v[144:147]
v_exp_f32 v168, v168
M a[52:55],a[140:143],v[136:139]
v_exp_f32 v169, v169
M a[48:51],a[140:143],v[128:131]
s_waitcnt lgkmcnt(6)
v_exp_f32 v170, v170
M a[64:67],a[144:147],v[128:131]
ds_read_b128 a[136:139], v38 offset:24576
v_cvt_pk_bf16_f32 v163, v166, v167
M a[68:71],a[144:147],v[136:139]
v_exp_f32 v171, v171
M a[72:75],a[144:147],v[144:147]
v_exp_f32 v172, v172
M a[76:79],a[144:147],v[152:155]
v_exp_f32 v173, v173
M a[92:95],a[148:151],v[152:155]
ds_read_b128 a[140:143], v39 offset:24576
v_cvt_pk_bf16_f32 v168, v168, v169
M a[88:91],a[148:151],v[144:147]
v_exp_f32 v174, v174
M a[84:87],a[148:151],v[136:139]
v_exp_f32 v175, v175
M a[80:83],a[148:151],v[128:131]
s_waitcnt lgkmcnt(4)
v_exp_f32 v176, v176
M a[96:99],a[152:155],v[128:131]
ds_read_b128 a[144:147], v36 offset:28672
v_cvt_pk_bf16_f32 v169, v170, v171
M a[100:103],a[152:155],v[136:139]
v_exp_f32 v177, v177
M a[104:107],a[152:155],v[144:147]
v_exp_f32 v178, v178
M a[108:111],a[152:155],v[152:155]
v_exp_f32 v179, v179
M a[124:127],a[156:159],v[152:155]
ds_read_b128 a[148:151], v37 offset:28672
v_cvt_pk_bf16_f32 v170, v172, v173
M a[120:123],a[156:159],v[144:147]
v_exp_f32 v180, v180
M a[116:119],a[156:159],v[136:139]
v_exp_f32 v181, v181
M a[112:115],a[156:159],v[128:131]
v_exp_f32 v182, v182
M v[208:211],v[240:243],v[128:131]
v_exp_f32 v183, v183
M v[212:215],v[240:243],v[136:139]
v_exp_f32 v184, v184
M v[216:219],v[240:243],v[144:147]
v_exp_f32 v185, v185
M v[220:223],v[240:243],v[152:155]
s_waitcnt lgkmcnt(4)
v_exp_f32 v186, v186
N v[128:131],a[128:131],v[64:67],v[192:195]
ds_read_b128 a[152:155], v38 offset:28672
v_cvt_pk_bf16_f32 v171, v174, v175
M v[128:131],a[132:135],v[68:71]
v_exp_f32 v187, v187
N v[136:139],a[132:135],v[84:87],v[196:199]
v_exp_f32 v188, v188
M v[136:139],a[128:131],v[80:83]
v_exp_f32 v189, v189
N v[144:147],a[128:131],v[96:99],v[200:203]
ds_read_b128 a[156:159], v39 offset:28672
v_cvt_pk_bf16_f32 v176, v176, v177
M v[144:147],a[132:135],v[100:103]
v_exp_f32 v190, v190
N v[152:155],a[132:135],v[116:119],v[204:207]
buffer_load_dword v56, v55, s[28:31], s79 offen
v_cvt_pk_bf16_f32 v177, v178, v179
M v[152:155],a[128:131],v[112:115]
s_waitcnt vmcnt(22)
s_barrier
s_waitcnt lgkmcnt(4)
M v[152:155],a[140:143],v[124:127]
s_add_u32 s79, s79, 2048
T a[128:129],v24,32768
T a[130:131],v24,36864
M v[152:155],a[136:139],v[120:123]
v_exp_f32 v191, v191
M v[144:147],a[136:139],v[104:107]
v_cvt_pk_bf16_f32 v178, v180, v181
v_cvt_pk_bf16_f32 v179, v182, v183
M v[144:147],a[140:143],v[108:111]
v_cvt_pk_bf16_f32 v184, v184, v185
v_cvt_pk_bf16_f32 v185, v186, v187
M v[136:139],a[140:143],v[92:95]
T a[132:133],v25,32768
T a[134:135],v25,36864
M v[136:139],a[136:139],v[88:91]
v_cvt_pk_bf16_f32 v186, v188, v189
v_cvt_pk_bf16_f32 v187, v190, v191
M v[128:131],a[136:139],v[72:75]
M v[128:131],a[140:143],v[76:79]
s_waitcnt lgkmcnt(6)
N v[132:135],a[144:147],v[64:67],v[192:195]
T a[136:137],v26,32768
T a[138:139],v26,36864
M v[132:135],a[148:151],v[68:71]
N v[140:143],a[148:151],v[84:87],v[196:199]
M v[140:143],a[144:147],v[80:83]
N v[148:151],a[144:147],v[96:99],v[200:203]
T a[140:141],v27,32768
T a[142:143],v27,36864
M v[148:151],a[148:151],v[100:103]
N v[156:159],a[148:151],v[116:119],v[204:207]
M v[156:159],a[144:147],v[112:115]
s_waitcnt lgkmcnt(8)
M v[156:159],a[156:159],v[124:127]
T a[144:145],v28,32768
T a[146:147],v28,36864
M v[156:159],a[152:155],v[120:123]
M v[148:151],a[152:155],v[104:107]
M v[148:151],a[156:159],v[108:111]
M v[140:143],a[156:159],v[92:95]
T a[148:149],v29,32768
T a[150:151],v29,36864
M v[140:143],a[152:155],v[88:91]
M v[132:135],a[152:155],v[72:75]
M v[132:135],a[156:159],v[76:79]
s_barrier
s_waitcnt lgkmcnt(8)
M a[0:3],a[128:131],v[160:163]
T a[152:153],v30,32768
T a[154:155],v30,36864
M a[4:7],a[128:131],v[168:171]
v_exp_f32 v128, v128
M a[8:11],a[128:131],v[176:179]
s_add_u32 m0, s59, 65536
v_exp_f32 v129, v129
M a[12:15],a[128:131],v[184:187]
buffer_load_dwordx4 v11, s[24:27], s61 offen offset:0 lds
v_cvt_pk_bf16_f32 v128, v128, v129
M a[28:31],a[132:135],v[184:187]
T a[156:157],v31,32768
T a[158:159],v31,36864
M a[24:27],a[132:135],v[176:179]
v_exp_f32 v130, v130
M a[20:23],a[132:135],v[168:171]
buffer_load_dwordx4 v12, s[24:27], s61 offen offset:1024 lds
M a[16:19],a[132:135],v[160:163]
s_waitcnt lgkmcnt(8)
v_exp_f32 v131, v131
M a[32:35],a[136:139],v[160:163]
ds_read_b128 a[128:131], v36 offset:40960
v_cvt_pk_bf16_f32 v129, v130, v131
M a[36:39],a[136:139],v[168:171]
v_exp_f32 v132, v132
M a[40:43],a[136:139],v[176:179]
s_add_u32 m0, s59, 73728
v_exp_f32 v133, v133
M a[44:47],a[136:139],v[184:187]
buffer_load_dwordx4 v9, s[20:23], s61 offen offset:0 lds
v_cvt_pk_bf16_f32 v130, v132, v133
M a[60:63],a[140:143],v[184:187]
ds_read_b128 a[132:135], v37 offset:40960
M a[56:59],a[140:143],v[176:179]
v_exp_f32 v134, v134
M a[52:55],a[140:143],v[168:171]
buffer_load_dwordx4 v10, s[20:23], s61 offen offset:1024 lds
s_add_u32 s61, s61, 8192
M a[48:51],a[140:143],v[160:163]
s_waitcnt lgkmcnt(6)
v_exp_f32 v135, v135
M a[64:67],a[144:147],v[160:163]
ds_read_b128 a[136:139], v38 offset:40960
v_cvt_pk_bf16_f32 v131, v134, v135
M a[68:71],a[144:147],v[168:171]
v_exp_f32 v136, v136
M a[72:75],a[144:147],v[176:179]
s_add_u32 m0, s59, 81920
v_exp_f32 v137, v137
M a[76:79],a[144:147],v[184:187]
buffer_load_dwordx4 v11, s[24:27], s61 offen offset:0 lds
v_cvt_pk_bf16_f32 v136, v136, v137
M a[92:95],a[148:151],v[184:187]
ds_read_b128 a[140:143], v39 offset:40960
M a[88:91],a[148:151],v[176:179]
v_exp_f32 v138, v138
M a[84:87],a[148:151],v[168:171]
buffer_load_dwordx4 v12, s[24:27], s61 offen offset:1024 lds
M a[80:83],a[148:151],v[160:163]
s_waitcnt lgkmcnt(4)
v_exp_f32 v139, v139
M a[96:99],a[152:155],v[160:163]
ds_read_b128 a[144:147], v36 offset:45056
v_cvt_pk_bf16_f32 v137, v138, v139
M a[100:103],a[152:155],v[168:171]
v_exp_f32 v140, v140
M a[104:107],a[152:155],v[176:179]
s_add_u32 m0, s59, 90112
v_exp_f32 v141, v141
M a[108:111],a[152:155],v[184:187]
buffer_load_dwordx4 v9, s[20:23], s61 offen offset:0 lds
v_cvt_pk_bf16_f32 v138, v140, v141
M a[124:127],a[156:159],v[184:187]
ds_read_b128 a[148:151], v37 offset:45056
M a[120:123],a[156:159],v[176:179]
v_exp_f32 v142, v142
M a[116:119],a[156:159],v[168:171]
buffer_load_dwordx4 v10, s[20:23], s61 offen offset:1024 lds
s_add_u32 s61, s61, 8192
M a[112:115],a[156:159],v[160:163]
v_exp_f32 v143, v143
M v[208:211],v[240:243],v[160:163]
v_exp_f32 v144, v144
M v[212:215],v[240:243],v[168:171]
v_exp_f32 v145, v145
M v[216:219],v[240:243],v[176:179]
v_exp_f32 v146, v146
M v[220:223],v[240:243],v[184:187]
s_waitcnt lgkmcnt(4)
v_exp_f32 v147, v147
N v[160:163],a[128:131],v[64:67],v[192:195]
ds_read_b128 a[152:155], v38 offset:45056
v_cvt_pk_bf16_f32 v139, v142, v143
M v[160:163],a[132:135],v[68:71]
v_exp_f32 v148, v148
N v[168:171],a[132:135],v[84:87],v[196:199]
v_exp_f32 v149, v149
M v[168:171],a[128:131],v[80:83]
v_exp_f32 v150, v150
N v[176:179],a[128:131],v[96:99],v[200:203]
ds_read_b128 a[156:159], v39 offset:45056
v_cvt_pk_bf16_f32 v144, v144, v145
M v[176:179],a[132:135],v[100:103]
s_add_u32 m0, s19, 131072
v_exp_f32 v151, v151
N v[184:187],a[132:135],v[116:119],v[204:207]
buffer_load_dwordx4 v1, s[28:31], s62 offen offset:0 lds
v_cvt_pk_bf16_f32 v145, v146, v147
M v[184:187],a[128:131],v[112:115]
s_waitcnt lgkmcnt(4)
v_exp_f32 v152, v152
M v[184:187],a[140:143],v[124:127]
T a[128:129],v24,49152
T a[130:131],v24,53248
M v[184:187],a[136:139],v[120:123]
v_exp_f32 v153, v153
M v[176:179],a[136:139],v[104:107]
v_exp_f32 v154, v154
M v[176:179],a[140:143],v[108:111]
v_exp_f32 v155, v155
M v[168:171],a[140:143],v[92:95]
T a[132:133],v25,49152
T a[134:135],v25,53248
M v[168:171],a[136:139],v[88:91]
v_exp_f32 v156, v156
M v[160:163],a[136:139],v[72:75]
buffer_load_dwordx4 v2, s[28:31], s62 offen offset:1024 lds
v_cvt_pk_bf16_f32 v146, v148, v149
M v[160:163],a[140:143],v[76:79]
s_waitcnt lgkmcnt(6)
v_exp_f32 v157, v157
N v[164:167],a[144:147],v[64:67],v[192:195]
T a[136:137],v26,49152
T a[138:139],v26,53248
M v[164:167],a[148:151],v[68:71]
v_exp_f32 v158, v158
N v[172:175],a[148:151],v[84:87],v[196:199]
v_exp_f32 v159, v159
M v[172:175],a[144:147],v[80:83]
v_cvt_pk_bf16_f32 v147, v150, v151
v_cvt_pk_bf16_f32 v152, v152, v153
N v[180:183],a[144:147],v[96:99],v[200:203]
T a[140:141],v27,49152
T a[142:143],v27,53248
M v[180:183],a[148:151],v[100:103]
v_cvt_pk_bf16_f32 v153, v154, v155
v_cvt_pk_bf16_f32 v154, v156, v157
N v[188:191],a[148:151],v[116:119],v[204:207]
buffer_load_dwordx4 v3, s[28:31], s62 offen offset:2048 lds
v_cvt_pk_bf16_f32 v155, v158, v159
M v[188:191],a[144:147],v[112:115]
s_waitcnt lgkmcnt(8)
M v[188:191],a[156:159],v[124:127]
T a[144:145],v28,49152
T a[146:147],v28,53248
M v[188:191],a[152:155],v[120:123]
M v[180:183],a[152:155],v[104:107]
M v[180:183],a[156:159],v[108:111]
M v[172:175],a[156:159],v[92:95]
T a[148:149],v29,49152
T a[150:151],v29,53248
M v[172:175],a[152:155],v[88:91]
M v[164:167],a[152:155],v[72:75]
buffer_load_dwordx4 v4, s[28:31], s62 offen offset:3072 lds
M v[164:167],a[156:159],v[76:79]
s_waitcnt lgkmcnt(8)
M a[0:3],a[128:131],v[128:131]
T a[152:153],v30,49152
T a[154:155],v30,53248
M a[4:7],a[128:131],v[136:139]
v_exp_f32 v160, v160
M a[8:11],a[128:131],v[144:147]
v_exp_f32 v161, v161
M a[12:15],a[128:131],v[152:155]
v_exp_f32 v162, v162
M a[28:31],a[132:135],v[152:155]
T a[156:157],v31,49152
T a[158:159],v31,53248
M a[24:27],a[132:135],v[144:147]
s_add_u32 m0, s19, 135168
v_exp_f32 v163, v163
M a[20:23],a[132:135],v[136:139]
buffer_load_dwordx4 v5, s[28:31], s62 offen offset:0 lds
v_cvt_pk_bf16_f32 v160, v160, v161
M a[16:19],a[132:135],v[128:131]
s_waitcnt lgkmcnt(8)
v_exp_f32 v164, v164
M a[32:35],a[136:139],v[128:131]
ds_read_b128 a[128:131], v36 offset:57344
v_cvt_pk_bf16_f32 v161, v162, v163
M a[36:39],a[136:139],v[136:139]
v_exp_f32 v165, v165
M a[40:43],a[136:139],v[144:147]
v_exp_f32 v166, v166
M a[44:47],a[136:139],v[152:155]
v_exp_f32 v167, v167
M a[60:63],a[140:143],v[152:155]
ds_read_b128 a[132:135], v37 offset:57344
v_cvt_pk_bf16_f32 v162, v164, v165
M a[56:59],a[140:143],v[144:147]
v_exp_f32 v168, v168
M a[52:55],a[140:143],v[136:139]
buffer_load_dwordx4 v6, s[28:31], s62 offen offset:1024 lds
v_cvt_pk_bf16_f32 v163, v166, v167
M a[48:51],a[140:143],v[128:131]
s_waitcnt lgkmcnt(6)
v_exp_f32 v169, v169
M a[64:67],a[144:147],v[128:131]
ds_read_b128 a[136:139], v38 offset:57344
v_cvt_pk_bf16_f32 v168, v168, v169
M a[68:71],a[144:147],v[136:139]
v_exp_f32 v170, v170
M a[72:75],a[144:147],v[144:147]
v_exp_f32 v171, v171
M a[76:79],a[144:147],v[152:155]
v_exp_f32 v172, v172
M a[92:95],a[148:151],v[152:155]
ds_read_b128 a[140:143], v39 offset:57344
v_cvt_pk_bf16_f32 v169, v170, v171
M a[88:91],a[148:151],v[144:147]
v_exp_f32 v173, v173
M a[84:87],a[148:151],v[136:139]
buffer_load_dwordx4 v7, s[28:31], s62 offen offset:2048 lds
v_cvt_pk_bf16_f32 v170, v172, v173
M a[80:83],a[148:151],v[128:131]
s_waitcnt lgkmcnt(4)
v_exp_f32 v174, v174
M a[96:99],a[152:155],v[128:131]
ds_read_b128 a[144:147], v36 offset:61440
M a[100:103],a[152:155],v[136:139]
L_pad29:
s_cbranch_execz L_pb0
v_exp_f32 v175, v175
M a[104:107],a[152:155],v[144:147]
v_exp_f32 v176, v176
M a[108:111],a[152:155],v[152:155]
v_exp_f32 v177, v177
M a[124:127],a[156:159],v[152:155]
ds_read_b128 a[148:151], v37 offset:61440
v_cvt_pk_bf16_f32 v171, v174, v175
M a[120:123],a[156:159],v[144:147]
v_exp_f32 v178, v178
M a[116:119],a[156:159],v[136:139]
s_cmp_eq_u32 s56, 0
buffer_load_dwordx4 v8, s[28:31], s62 offen offset:3072 lds
s_cselect_b32 s62, 7, 0
M a[112:115],a[156:159],v[128:131]
v_exp_f32 v179, v179
M v[208:211],v[240:243],v[128:131]
s_lshl_b32 s62, s62, 18
v_exp_f32 v180, v180
M v[212:215],v[240:243],v[136:139]
s_add_u32 s62, s62, s69
v_exp_f32 v181, v181
M v[216:219],v[240:243],v[144:147]
v_exp_f32 v182, v182
M v[220:223],v[240:243],v[152:155]
s_waitcnt lgkmcnt(4)
v_exp_f32 v183, v183
N v[128:131],a[128:131],v[64:67],v[192:195]
ds_read_b128 a[152:155], v38 offset:61440
v_cvt_pk_bf16_f32 v176, v176, v177
M v[128:131],a[132:135],v[68:71]
v_exp_f32 v184, v184
N v[136:139],a[132:135],v[84:87],v[196:199]
v_exp_f32 v185, v185
M v[136:139],a[128:131],v[80:83]
v_exp_f32 v186, v186
N v[144:147],a[128:131],v[96:99],v[200:203]
ds_read_b128 a[156:159], v39 offset:61440
v_cvt_pk_bf16_f32 v177, v178, v179
M v[144:147],a[132:135],v[100:103]
v_exp_f32 v187, v187
N v[152:155],a[132:135],v[116:119],v[204:207]
buffer_load_dword v56, v55, s[28:31], s79 offen
v_cvt_pk_bf16_f32 v178, v180, v181
M v[152:155],a[128:131],v[112:115]
s_waitcnt vmcnt(31)
s_barrier
s_waitcnt lgkmcnt(4)
M v[152:155],a[140:143],v[124:127]
s_add_u32 s79, s79, 2048
T a[128:129],v16,0
T a[130:131],v16,4096
M v[152:155],a[136:139],v[120:123]
v_exp_f32 v188, v188
M v[144:147],a[136:139],v[104:107]
v_exp_f32 v189, v189
M v[144:147],a[140:143],v[108:111]
v_exp_f32 v190, v190
M v[136:139],a[140:143],v[92:95]
T a[132:133],v17,0
T a[134:135],v17,4096
M v[136:139],a[136:139],v[88:91]
v_exp_f32 v191, v191
M v[128:131],a[136:139],v[72:75]
buffer_load_dword v56, v55, s[28:31], s79 offen
v_cvt_pk_bf16_f32 v179, v182, v183
M v[128:131],a[140:143],v[76:79]
s_waitcnt lgkmcnt(6)
v_cvt_pk_bf16_f32 v184, v184, v185
v_cvt_pk_bf16_f32 v185, v186, v187
N v[132:135],a[144:147],v[64:67],v[192:195]
s_add_u32 s79, s79, 2048
T a[136:137],v18,0
T a[138:139],v18,4096
M v[132:135],a[148:151],v[68:71]
v_cvt_pk_bf16_f32 v186, v188, v189
v_cvt_pk_bf16_f32 v187, v190, v191
N v[140:143],a[148:151],v[84:87],v[196:199]
M v[140:143],a[144:147],v[80:83]
N v[148:151],a[144:147],v[96:99],v[200:203]
T a[140:141],v19,0
T a[142:143],v19,4096
M v[148:151],a[148:151],v[100:103]
N v[156:159],a[148:151],v[116:119],v[204:207]
M v[156:159],a[144:147],v[112:115]
s_waitcnt lgkmcnt(8)
M v[156:159],a[156:159],v[124:127]
T a[144:145],v20,0
T a[146:147],v20,4096
M v[156:159],a[152:155],v[120:123]
M v[148:151],a[152:155],v[104:107]
M v[148:151],a[156:159],v[108:111]
M v[140:143],a[156:159],v[92:95]
T a[148:149],v21,0
T a[150:151],v21,4096
M v[140:143],a[152:155],v[88:91]
M v[132:135],a[152:155],v[72:75]
M v[132:135],a[156:159],v[76:79]
s_barrier
s_waitcnt lgkmcnt(8)
M a[0:3],a[128:131],v[160:163]
T a[152:153],v22,0
T a[154:155],v22,4096
M a[4:7],a[128:131],v[168:171]
v_exp_f32 v128, v128
M a[8:11],a[128:131],v[176:179]
v_exp_f32 v129, v129
M a[12:15],a[128:131],v[184:187]
v_exp_f32 v130, v130
M a[28:31],a[132:135],v[184:187]
T a[156:157],v23,0
T a[158:159],v23,4096
M a[24:27],a[132:135],v[176:179]
s_add_u32 m0, s59, 98304
v_exp_f32 v131, v131
M a[20:23],a[132:135],v[168:171]
buffer_load_dwordx4 v11, s[24:27], s61 offen offset:0 lds
v_cvt_pk_bf16_f32 v128, v128, v129
M a[16:19],a[132:135],v[160:163]
s_waitcnt lgkmcnt(8)
v_exp_f32 v132, v132
M a[32:35],a[136:139],v[160:163]
ds_read_b128 a[128:131], v32 offset:8192
v_cvt_pk_bf16_f32 v129, v130, v131
M a[36:39],a[136:139],v[168:171]
v_exp_f32 v133, v133
M a[40:43],a[136:139],v[176:179]
v_exp_f32 v134, v134
M a[44:47],a[136:139],v[184:187]
v_exp_f32 v135, v135
M a[60:63],a[140:143],v[184:187]
ds_read_b128 a[132:135], v33 offset:8192
v_cvt_pk_bf16_f32 v130, v132, v133
M a[56:59],a[140:143],v[176:179]
v_exp_f32 v136, v136
M a[52:55],a[140:143],v[168:171]
buffer_load_dwordx4 v12, s[24:27], s61 offen offset:1024 lds
v_cvt_pk_bf16_f32 v131, v134, v135
M a[48:51],a[140:143],v[160:163]
s_waitcnt lgkmcnt(6)
v_exp_f32 v137, v137
M a[64:67],a[144:147],v[160:163]
ds_read_b128 a[136:139], v34 offset:8192
v_cvt_pk_bf16_f32 v136, v136, v137
M a[68:71],a[144:147],v[168:171]
v_exp_f32 v138, v138
M a[72:75],a[144:147],v[176:179]
v_exp_f32 v139, v139
M a[76:79],a[144:147],v[184:187]
v_exp_f32 v140, v140
M a[92:95],a[148:151],v[184:187]
ds_read_b128 a[140:143], v35 offset:8192
v_cvt_pk_bf16_f32 v137, v138, v139
M a[88:91],a[148:151],v[176:179]
s_add_u32 m0, s59, 106496
v_exp_f32 v141, v141
M a[84:87],a[148:151],v[168:171]
buffer_load_dwordx4 v9, s[20:23], s61 offen offset:0 lds
v_cvt_pk_bf16_f32 v138, v140, v141
M a[80:83],a[148:151],v[160:163]
s_waitcnt lgkmcnt(4)
v_exp_f32 v142, v142
M a[96:99],a[152:155],v[160:163]
ds_read_b128 a[144:147], v32 offset:12288
M a[100:103],a[152:155],v[168:171]
v_exp_f32 v143, v143
M a[104:107],a[152:155],v[176:179]
v_exp_f32 v144, v144
M a[108:111],a[152:155],v[184:187]
v_exp_f32 v145, v145
M a[124:127],a[156:159],v[184:187]
ds_read_b128 a[148:151], v33 offset:12288
v_cvt_pk_bf16_f32 v139, v142, v143
M a[120:123],a[156:159],v[176:179]
v_exp_f32 v146, v146
M a[116:119],a[156:159],v[168:171]
buffer_load_dwordx4 v10, s[20:23], s61 offen offset:1024 lds
v_cvt_pk_bf16_f32 v144, v144, v145
M a[112:115],a[156:159],v[160:163]
v_exp_f32 v147, v147
M v[208:211],v[240:243],v[160:163]
s_add_u32 s61, s61, 8192
v_exp_f32 v148, v148
M v[212:215],v[240:243],v[168:171]
v_exp_f32 v149, v149
M v[216:219],v[240:243],v[176:179]
v_exp_f32 v150, v150
M v[220:223],v[240:243],v[184:187]
s_waitcnt lgkmcnt(4)
v_exp_f32 v151, v151
N v[160:163],a[128:131],v[64:67],v[192:195]
ds_read_b128 a[152:155], v34 offset:12288
v_cvt_pk_bf16_f32 v145, v146, v147
M v[160:163],a[132:135],v[68:71]
v_exp_f32 v152, v152
N v[168:171],a[132:135],v[84:87],v[196:199]
v_exp_f32 v153, v153
M v[168:171],a[128:131],v[80:83]
v_exp_f32 v154, v154
N v[176:179],a[128:131],v[96:99],v[200:203]
ds_read_b128 a[156:159], v35 offset:12288
v_cvt_pk_bf16_f32 v146, v148, v149
M v[176:179],a[132:135],v[100:103]
s_add_u32 m0, s59, 114688
v_exp_f32 v155, v155
N v[184:187],a[132:135],v[116:119],v[204:207]
buffer_load_dwordx4 v11, s[24:27], s61 offen offset:0 lds
v_cvt_pk_bf16_f32 v147, v150, v151
M v[184:187],a[128:131],v[112:115]
s_waitcnt lgkmcnt(4)
v_exp_f32 v156, v156
M v[184:187],a[140:143],v[124:127]
T a[128:129],v16,16384
T a[130:131],v16,20480
M v[184:187],a[136:139],v[120:123]
v_exp_f32 v157, v157
M v[176:179],a[136:139],v[104:107]
v_exp_f32 v158, v158
M v[176:179],a[140:143],v[108:111]
v_exp_f32 v159, v159
M v[168:171],a[140:143],v[92:95]
T a[132:133],v17,16384
T a[134:135],v17,20480
M v[168:171],a[136:139],v[88:91]
v_cvt_pk_bf16_f32 v152, v152, v153
v_cvt_pk_bf16_f32 v153, v154, v155
M v[160:163],a[136:139],v[72:75]
buffer_load_dwordx4 v12, s[24:27], s61 offen offset:1024 lds
v_cvt_pk_bf16_f32 v154, v156, v157
M v[160:163],a[140:143],v[76:79]
s_add_u32 s61, s61, 8192
v_cvt_pk_bf16_f32 v155, v158, v159
s_waitcnt lgkmcnt(6)
N v[164:167],a[144:147],v[64:67],v[192:195]
T a[136:137],v18,16384
T a[138:139],v18,20480
M v[164:167],a[148:151],v[68:71]
N v[172:175],a[148:151],v[84:87],v[196:199]
M v[172:175],a[144:147],v[80:83]
N v[180:183],a[144:147],v[96:99],v[200:203]
T a[140:141],v19,16384
T a[142:143],v19,20480
M v[180:183],a[148:151],v[100:103]
s_add_u32 m0, s59, 122880
N v[188:191],a[148:151],v[116:119],v[204:207]
buffer_load_dwordx4 v11, s[24:27], s61 offen offset:0 lds
M v[188:191],a[144:147],v[112:115]
s_waitcnt lgkmcnt(8)
M v[188:191],a[156:159],v[124:127]
T a[144:145],v20,16384
T a[146:147],v20,20480
M v[188:191],a[152:155],v[120:123]
M v[180:183],a[152:155],v[104:107]
M v[180:183],a[156:159],v[108:111]
M v[172:175],a[156:159],v[92:95]
T a[148:149],v21,16384
T a[150:151],v21,20480
M v[172:175],a[152:155],v[88:91]
M v[164:167],a[152:155],v[72:75]
buffer_load_dwordx4 v12, s[24:27], s61 offen offset:1024 lds
M v[164:167],a[156:159],v[76:79]
s_waitcnt lgkmcnt(8)
M a[0:3],a[128:131],v[128:131]
T a[152:153],v22,16384
T a[154:155],v22,20480
M a[4:7],a[128:131],v[136:139]
v_exp_f32 v160, v160
M a[8:11],a[128:131],v[144:147]
v_exp_f32 v161, v161
M a[12:15],a[128:131],v[152:155]
v_exp_f32 v162, v162
M a[28:31],a[132:135],v[152:155]
T a[156:157],v23,16384
T a[158:159],v23,20480
M a[24:27],a[132:135],v[144:147]
v_exp_f32 v163, v163
M a[20:23],a[132:135],v[136:139]
v_exp_f32 v164, v164
M a[16:19],a[132:135],v[128:131]
s_waitcnt lgkmcnt(8)
v_exp_f32 v165, v165
M a[32:35],a[136:139],v[128:131]
ds_read_b128 a[128:131], v32 offset:24576
v_cvt_pk_bf16_f32 v160, v160, v161
M a[36:39],a[136:139],v[136:139]
v_exp_f32 v166, v166
M a[40:43],a[136:139],v[144:147]
v_exp_f32 v167, v167
M a[44:47],a[136:139],v[152:155]
v_exp_f32 v168, v168
M a[60:63],a[140:143],v[152:155]
ds_read_b128 a[132:135], v33 offset:24576
v_cvt_pk_bf16_f32 v161, v162, v163
M a[56:59],a[140:143],v[144:147]
v_exp_f32 v169, v169
M a[52:55],a[140:143],v[136:139]
v_exp_f32 v170, v170
M a[48:51],a[140:143],v[128:131]
s_waitcnt lgkmcnt(6)
v_exp_f32 v171, v171
M a[64:67],a[144:147],v[128:131]
ds_read_b128 a[136:139], v34 offset:24576
v_cvt_pk_bf16_f32 v162, v164, v165
M a[68:71],a[144:147],v[136:139]
v_exp_f32 v172, v172
M a[72:75],a[144:147],v[144:147]
v_exp_f32 v173, v173
M a[76:79],a[144:147],v[152:155]
v_exp_f32 v174, v174
M a[92:95],a[148:151],v[152:155]
ds_read_b128 a[140:143], v35 offset:24576
v_cvt_pk_bf16_f32 v163, v166, v167
M a[88:91],a[148:151],v[144:147]
v_exp_f32 v175, v175
M a[84:87],a[148:151],v[136:139]
v_exp_f32 v176, v176
M a[80:83],a[148:151],v[128:131]
s_waitcnt lgkmcnt(4)
v_exp_f32 v177, v177
M a[96:99],a[152:155],v[128:131]
ds_read_b128 a[144:147], v32 offset:28672
v_cvt_pk_bf16_f32 v168, v168, v169
M a[100:103],a[152:155],v[136:139]
v_exp_f32 v178, v178
M a[104:107],a[152:155],v[144:147]
v_exp_f32 v179, v179
M a[108:111],a[152:155],v[152:155]
v_exp_f32 v180, v180
M a[124:127],a[156:159],v[152:155]
ds_read_b128 a[148:151], v33 offset:28672
v_cvt_pk_bf16_f32 v169, v170, v171
M a[120:123],a[156:159],v[144:147]
v_exp_f32 v181, v181
M a[116:119],a[156:159],v[136:139]
v_exp_f32 v182, v182
M a[112:115],a[156:159],v[128:131]
v_exp_f32 v183, v183
M v[208:211],v[240:243],v[128:131]
v_exp_f32 v184, v184
M v[212:215],v[240:243],v[136:139]
v_exp_f32 v185, v185
M v[216:219],v[240:243],v[144:147]
v_exp_f32 v186, v186
M v[220:223],v[240:243],v[152:155]
s_waitcnt lgkmcnt(4)
v_exp_f32 v187, v187
N v[128:131],a[128:131],v[64:67],v[192:195]
ds_read_b128 a[152:155], v34 offset:28672
v_cvt_pk_bf16_f32 v170, v172, v173
M v[128:131],a[132:135],v[68:71]
v_exp_f32 v188, v188
N v[136:139],a[132:135],v[84:87],v[196:199]
v_exp_f32 v189, v189
M v[136:139],a[128:131],v[80:83]
v_exp_f32 v190, v190
N v[144:147],a[128:131],v[96:99],v[200:203]
ds_read_b128 a[156:159], v35 offset:28672
v_cvt_pk_bf16_f32 v171, v174, v175
M v[144:147],a[132:135],v[100:103]
v_exp_f32 v191, v191
N v[152:155],a[132:135],v[116:119],v[204:207]
v_cvt_pk_bf16_f32 v176, v176, v177
v_cvt_pk_bf16_f32 v177, v178, v179
M v[152:155],a[128:131],v[112:115]
s_waitcnt vmcnt(28)
s_barrier
s_waitcnt lgkmcnt(4)
M v[152:155],a[140:143],v[124:127]
T a[128:129],v16,32768
T a[130:131],v16,36864
M v[152:155],a[136:139],v[120:123]
v_cvt_pk_bf16_f32 v178, v180, v181
v_cvt_pk_bf16_f32 v179, v182, v183
M v[144:147],a[136:139],v[104:107]
v_cvt_pk_bf16_f32 v184, v184, v185
v_cvt_pk_bf16_f32 v185, v186, v187
M v[144:147],a[140:143],v[108:111]
v_cvt_pk_bf16_f32 v186, v188, v189
v_cvt_pk_bf16_f32 v187, v190, v191
M v[136:139],a[140:143],v[92:95]
T a[132:133],v17,32768
T a[134:135],v17,36864
M v[136:139],a[136:139],v[88:91]
M v[128:131],a[136:139],v[72:75]
M v[128:131],a[140:143],v[76:79]
s_waitcnt lgkmcnt(6)
N v[132:135],a[144:147],v[64:67],v[192:195]
T a[136:137],v18,32768
T a[138:139],v18,36864
M v[132:135],a[148:151],v[68:71]
N v[140:143],a[148:151],v[84:87],v[196:199]
M v[140:143],a[144:147],v[80:83]
N v[148:151],a[144:147],v[96:99],v[200:203]
T a[140:141],v19,32768
T a[142:143],v19,36864
M v[148:151],a[148:151],v[100:103]
N v[156:159],a[148:151],v[116:119],v[204:207]
M v[156:159],a[144:147],v[112:115]
s_waitcnt lgkmcnt(8)
M v[156:159],a[156:159],v[124:127]
T a[144:145],v20,32768
T a[146:147],v20,36864
M v[156:159],a[152:155],v[120:123]
M v[148:151],a[152:155],v[104:107]
M v[148:151],a[156:159],v[108:111]
M v[140:143],a[156:159],v[92:95]
T a[148:149],v21,32768
T a[150:151],v21,36864
M v[140:143],a[152:155],v[88:91]
M v[132:135],a[152:155],v[72:75]
M v[132:135],a[156:159],v[76:79]
s_barrier
s_waitcnt lgkmcnt(8)
M a[0:3],a[128:131],v[160:163]
T a[152:153],v22,32768
T a[154:155],v22,36864
M a[4:7],a[128:131],v[168:171]
v_exp_f32 v128, v128
M a[8:11],a[128:131],v[176:179]
v_exp_f32 v129, v129
M a[12:15],a[128:131],v[184:187]
v_exp_f32 v130, v130
M a[28:31],a[132:135],v[184:187]
T a[156:157],v23,32768
T a[158:159],v23,36864
M a[24:27],a[132:135],v[176:179]
s_add_u32 m0, s60, 0
v_exp_f32 v131, v131
M a[20:23],a[132:135],v[168:171]
buffer_load_dwordx4 v1, s[28:31], s62 offen offset:0 lds
v_cvt_pk_bf16_f32 v128, v128, v129
M a[16:19],a[132:135],v[160:163]
s_waitcnt lgkmcnt(8)
v_exp_f32 v132, v132
M a[32:35],a[136:139],v[160:163]
ds_read_b128 a[128:131], v32 offset:40960
v_cvt_pk_bf16_f32 v129, v130, v131
M a[36:39],a[136:139],v[168:171]
v_exp_f32 v133, v133
M a[40:43],a[136:139],v[176:179]
v_exp_f32 v134, v134
M a[44:47],a[136:139],v[184:187]
v_exp_f32 v135, v135
M a[60:63],a[140:143],v[184:187]
ds_read_b128 a[132:135], v33 offset:40960
v_cvt_pk_bf16_f32 v130, v132, v133
M a[56:59],a[140:143],v[176:179]
v_exp_f32 v136, v136
M a[52:55],a[140:143],v[168:171]
buffer_load_dwordx4 v2, s[28:31], s62 offen offset:1024 lds
v_cvt_pk_bf16_f32 v131, v134, v135
M a[48:51],a[140:143],v[160:163]
s_waitcnt lgkmcnt(6)
v_exp_f32 v137, v137
M a[64:67],a[144:147],v[160:163]
ds_read_b128 a[136:139], v34 offset:40960
v_cvt_pk_bf16_f32 v136, v136, v137
M a[68:71],a[144:147],v[168:171]
v_exp_f32 v138, v138
M a[72:75],a[144:147],v[176:179]
v_exp_f32 v139, v139
M a[76:79],a[144:147],v[184:187]
v_exp_f32 v140, v140
M a[92:95],a[148:151],v[184:187]
ds_read_b128 a[140:143], v35 offset:40960
v_cvt_pk_bf16_f32 v137, v138, v139
M a[88:91],a[148:151],v[176:179]
v_exp_f32 v141, v141
M a[84:87],a[148:151],v[168:171]
buffer_load_dwordx4 v3, s[28:31], s62 offen offset:2048 lds
v_cvt_pk_bf16_f32 v138, v140, v141
M a[80:83],a[148:151],v[160:163]
s_waitcnt lgkmcnt(4)
v_exp_f32 v142, v142
M a[96:99],a[152:155],v[160:163]
ds_read_b128 a[144:147], v32 offset:45056
M a[100:103],a[152:155],v[168:171]
v_exp_f32 v143, v143
M a[104:107],a[152:155],v[176:179]
v_exp_f32 v144, v144
M a[108:111],a[152:155],v[184:187]
v_exp_f32 v145, v145
M a[124:127],a[156:159],v[184:187]
ds_read_b128 a[148:151], v33 offset:45056
v_cvt_pk_bf16_f32 v139, v142, v143
M a[120:123],a[156:159],v[176:179]
v_exp_f32 v146, v146
M a[116:119],a[156:159],v[168:171]
buffer_load_dwordx4 v4, s[28:31], s62 offen offset:3072 lds
v_cvt_pk_bf16_f32 v144, v144, v145
M a[112:115],a[156:159],v[160:163]
v_exp_f32 v147, v147
M v[208:211],v[240:243],v[160:163]
v_exp_f32 v148, v148
M v[212:215],v[240:243],v[168:171]
v_exp_f32 v149, v149
M v[216:219],v[240:243],v[176:179]
v_exp_f32 v150, v150
M v[220:223],v[240:243],v[184:187]
s_waitcnt lgkmcnt(4)
v_exp_f32 v151, v151
N v[160:163],a[128:131],v[64:67],v[192:195]
ds_read_b128 a[152:155], v34 offset:45056
v_cvt_pk_bf16_f32 v145, v146, v147
M v[160:163],a[132:135],v[68:71]
v_exp_f32 v152, v152
N v[168:171],a[132:135],v[84:87],v[196:199]
v_exp_f32 v153, v153
M v[168:171],a[128:131],v[80:83]
v_exp_f32 v154, v154
N v[176:179],a[128:131],v[96:99],v[200:203]
ds_read_b128 a[156:159], v35 offset:45056
v_cvt_pk_bf16_f32 v146, v148, v149
M v[176:179],a[132:135],v[100:103]
s_add_u32 m0, s60, 4096
v_exp_f32 v155, v155
N v[184:187],a[132:135],v[116:119],v[204:207]
buffer_load_dwordx4 v5, s[28:31], s62 offen offset:0 lds
v_cvt_pk_bf16_f32 v147, v150, v151
M v[184:187],a[128:131],v[112:115]
s_waitcnt lgkmcnt(4)
v_exp_f32 v156, v156
M v[184:187],a[140:143],v[124:127]
T a[128:129],v16,49152
T a[130:131],v16,53248
M v[184:187],a[136:139],v[120:123]
v_exp_f32 v157, v157
M v[176:179],a[136:139],v[104:107]
v_exp_f32 v158, v158
M v[176:179],a[140:143],v[108:111]
v_exp_f32 v159, v159
M v[168:171],a[140:143],v[92:95]
T a[132:133],v17,49152
T a[134:135],v17,53248
M v[168:171],a[136:139],v[88:91]
v_cvt_pk_bf16_f32 v152, v152, v153
v_cvt_pk_bf16_f32 v153, v154, v155
M v[160:163],a[136:139],v[72:75]
buffer_load_dwordx4 v6, s[28:31], s62 offen offset:1024 lds
v_cvt_pk_bf16_f32 v154, v156, v157
M v[160:163],a[140:143],v[76:79]
v_cvt_pk_bf16_f32 v155, v158, v159
s_waitcnt lgkmcnt(6)
N v[164:167],a[144:147],v[64:67],v[192:195]
T a[136:137],v18,49152
T a[138:139],v18,53248
M v[164:167],a[148:151],v[68:71]
N v[172:175],a[148:151],v[84:87],v[196:199]
M v[172:175],a[144:147],v[80:83]
N v[180:183],a[144:147],v[96:99],v[200:203]
T a[140:141],v19,49152
T a[142:143],v19,53248
M v[180:183],a[148:151],v[100:103]
N v[188:191],a[148:151],v[116:119],v[204:207]
buffer_load_dwordx4 v7, s[28:31], s62 offen offset:2048 lds
M v[188:191],a[144:147],v[112:115]
s_waitcnt lgkmcnt(8)
M v[188:191],a[156:159],v[124:127]
T a[144:145],v20,49152
T a[146:147],v20,53248
M v[188:191],a[152:155],v[120:123]
M v[180:183],a[152:155],v[104:107]
M v[180:183],a[156:159],v[108:111]
M v[172:175],a[156:159],v[92:95]
T a[148:149],v21,49152
T a[150:151],v21,53248
M v[172:175],a[152:155],v[88:91]
M v[164:167],a[152:155],v[72:75]
s_cmp_eq_u32 s56, 1
buffer_load_dwordx4 v8, s[28:31], s62 offen offset:3072 lds
s_cselect_b32 s62, 7, 1
M v[164:167],a[156:159],v[76:79]
s_lshl_b32 s62, s62, 18
s_add_u32 s62, s62, s69
s_waitcnt lgkmcnt(8)
M a[0:3],a[128:131],v[128:131]
T a[152:153],v22,49152
T a[154:155],v22,53248
M a[4:7],a[128:131],v[136:139]
v_exp_f32 v160, v160
M a[8:11],a[128:131],v[144:147]
v_exp_f32 v161, v161
M a[12:15],a[128:131],v[152:155]
v_exp_f32 v162, v162
M a[28:31],a[132:135],v[152:155]
T a[156:157],v23,49152
T a[158:159],v23,53248
M a[24:27],a[132:135],v[144:147]
v_exp_f32 v163, v163
M a[20:23],a[132:135],v[136:139]
buffer_load_dwordx4 v[224:227], v57, s[36:39], s44 offen
v_cvt_pk_bf16_f32 v160, v160, v161
M a[16:19],a[132:135],v[128:131]
s_waitcnt lgkmcnt(8)
v_exp_f32 v164, v164
M a[32:35],a[136:139],v[128:131]
ds_read_b128 a[128:131], v32 offset:57344
v_cvt_pk_bf16_f32 v161, v162, v163
M a[36:39],a[136:139],v[136:139]
L_pad30:
s_cbranch_execz L_pad34
v_exp_f32 v165, v165
M a[40:43],a[136:139],v[144:147]
v_exp_f32 v166, v166
M a[44:47],a[136:139],v[152:155]
v_exp_f32 v167, v167
M a[60:63],a[140:143],v[152:155]
ds_read_b128 a[132:135], v33 offset:57344
v_cvt_pk_bf16_f32 v162, v164, v165
M a[56:59],a[140:143],v[144:147]
v_exp_f32 v168, v168
M a[52:55],a[140:143],v[136:139]
v_exp_f32 v169, v169
M a[48:51],a[140:143],v[128:131]
s_waitcnt lgkmcnt(6)
v_exp_f32 v170, v170
M a[64:67],a[144:147],v[128:131]
ds_read_b128 a[136:139], v34 offset:57344
v_cvt_pk_bf16_f32 v163, v166, v167
M a[68:71],a[144:147],v[136:139]
v_exp_f32 v171, v171
M a[72:75],a[144:147],v[144:147]
v_exp_f32 v172, v172
M a[76:79],a[144:147],v[152:155]
v_exp_f32 v173, v173
M a[92:95],a[148:151],v[152:155]
ds_read_b128 a[140:143], v35 offset:57344
v_cvt_pk_bf16_f32 v168, v168, v169
M a[88:91],a[148:151],v[144:147]
v_exp_f32 v174, v174
M a[84:87],a[148:151],v[136:139]
v_exp_f32 v175, v175
M a[80:83],a[148:151],v[128:131]
s_waitcnt lgkmcnt(4)
v_exp_f32 v176, v176
M a[96:99],a[152:155],v[128:131]
ds_read_b128 a[144:147], v32 offset:61440
v_cvt_pk_bf16_f32 v169, v170, v171
M a[100:103],a[152:155],v[136:139]
v_exp_f32 v177, v177
M a[104:107],a[152:155],v[144:147]
v_exp_f32 v178, v178
M a[108:111],a[152:155],v[152:155]
v_exp_f32 v179, v179
M a[124:127],a[156:159],v[152:155]
ds_read_b128 a[148:151], v33 offset:61440
v_cvt_pk_bf16_f32 v170, v172, v173
M a[120:123],a[156:159],v[144:147]
v_exp_f32 v180, v180
M a[116:119],a[156:159],v[136:139]
v_exp_f32 v181, v181
M a[112:115],a[156:159],v[128:131]
v_exp_f32 v182, v182
M v[208:211],v[240:243],v[128:131]
v_exp_f32 v183, v183
M v[212:215],v[240:243],v[136:139]
v_exp_f32 v184, v184
M v[216:219],v[240:243],v[144:147]
v_exp_f32 v185, v185
M v[220:223],v[240:243],v[152:155]
s_waitcnt lgkmcnt(4)
v_exp_f32 v186, v186
N v[128:131],a[128:131],v[64:67],v[192:195]
ds_read_b128 a[152:155], v34 offset:61440
v_cvt_pk_bf16_f32 v171, v174, v175
M v[128:131],a[132:135],v[68:71]
v_exp_f32 v187, v187
N v[136:139],a[132:135],v[84:87],v[196:199]
v_exp_f32 v188, v188
M v[136:139],a[128:131],v[80:83]
v_exp_f32 v189, v189
N v[144:147],a[128:131],v[96:99],v[200:203]
ds_read_b128 a[156:159], v35 offset:61440
v_cvt_pk_bf16_f32 v176, v176, v177
M v[144:147],a[132:135],v[100:103]
v_exp_f32 v190, v190
N v[152:155],a[132:135],v[116:119],v[204:207]
buffer_load_dwordx4 v[228:231], v57, s[36:39], s45 offen
v_cvt_pk_bf16_f32 v177, v178, v179
M v[152:155],a[128:131],v[112:115]
s_waitcnt vmcnt(28)
s_barrier
s_waitcnt lgkmcnt(4)
M v[152:155],a[140:143],v[124:127]
T a[128:129],v24,0
T a[130:131],v24,4096
M v[152:155],a[136:139],v[120:123]
v_exp_f32 v191, v191
M v[144:147],a[136:139],v[104:107]
v_add_u32 v16, 131072, v16
v_add_u32 v17, 131072, v17
M v[144:147],a[140:143],v[108:111]
v_add_u32 v18, 131072, v18
v_add_u32 v19, 131072, v19
M v[136:139],a[140:143],v[92:95]
T a[132:133],v25,0
T a[134:135],v25,4096
M v[136:139],a[136:139],v[88:91]
v_add_u32 v20, 131072, v20
v_add_u32 v21, 131072, v21
M v[128:131],a[136:139],v[72:75]
v_add_u32 v22, 131072, v22
v_add_u32 v23, 131072, v23
M v[128:131],a[140:143],v[76:79]
s_waitcnt lgkmcnt(6)
v_cvt_pk_bf16_f32 v178, v180, v181
v_cvt_pk_bf16_f32 v179, v182, v183
N v[132:135],a[144:147],v[64:67],v[192:195]
T a[136:137],v26,0
T a[138:139],v26,4096
M v[132:135],a[148:151],v[68:71]
v_cvt_pk_bf16_f32 v184, v184, v185
v_cvt_pk_bf16_f32 v185, v186, v187
N v[140:143],a[148:151],v[84:87],v[196:199]
v_cvt_pk_bf16_f32 v186, v188, v189
v_cvt_pk_bf16_f32 v187, v190, v191
M v[140:143],a[144:147],v[80:83]
N v[148:151],a[144:147],v[96:99],v[200:203]
T a[140:141],v27,0
T a[142:143],v27,4096
M v[148:151],a[148:151],v[100:103]
N v[156:159],a[148:151],v[116:119],v[204:207]
M v[156:159],a[144:147],v[112:115]
s_waitcnt lgkmcnt(8)
M v[156:159],a[156:159],v[124:127]
T a[144:145],v28,0
T a[146:147],v28,4096
M v[156:159],a[152:155],v[120:123]
M v[148:151],a[152:155],v[104:107]
M v[148:151],a[156:159],v[108:111]
M v[140:143],a[156:159],v[92:95]
T a[148:149],v29,0
T a[150:151],v29,4096
M v[140:143],a[152:155],v[88:91]
M v[132:135],a[152:155],v[72:75]
M v[132:135],a[156:159],v[76:79]
s_barrier
s_waitcnt lgkmcnt(8)
M a[0:3],a[128:131],v[160:163]
T a[152:153],v30,0
T a[154:155],v30,4096
M a[4:7],a[128:131],v[168:171]
v_exp_f32 v128, v128
M a[8:11],a[128:131],v[176:179]
v_exp_f32 v129, v129
M a[12:15],a[128:131],v[184:187]
v_exp_f32 v130, v130
M a[28:31],a[132:135],v[184:187]
T a[156:157],v31,0
T a[158:159],v31,4096
M a[24:27],a[132:135],v[176:179]
s_add_u32 m0, s60, 32768
v_exp_f32 v131, v131
M a[20:23],a[132:135],v[168:171]
buffer_load_dwordx4 v1, s[28:31], s62 offen offset:0 lds
v_cvt_pk_bf16_f32 v128, v128, v129
M a[16:19],a[132:135],v[160:163]
s_waitcnt lgkmcnt(8)
v_exp_f32 v132, v132
M a[32:35],a[136:139],v[160:163]
ds_read_b128 a[128:131], v36 offset:8192
v_cvt_pk_bf16_f32 v129, v130, v131
M a[36:39],a[136:139],v[168:171]
v_exp_f32 v133, v133
M a[40:43],a[136:139],v[176:179]
v_exp_f32 v134, v134
M a[44:47],a[136:139],v[184:187]
v_exp_f32 v135, v135
M a[60:63],a[140:143],v[184:187]
ds_read_b128 a[132:135], v37 offset:8192
v_cvt_pk_bf16_f32 v130, v132, v133
M a[56:59],a[140:143],v[176:179]
v_exp_f32 v136, v136
M a[52:55],a[140:143],v[168:171]
buffer_load_dwordx4 v2, s[28:31], s62 offen offset:1024 lds
v_cvt_pk_bf16_f32 v131, v134, v135
M a[48:51],a[140:143],v[160:163]
s_waitcnt lgkmcnt(6)
v_exp_f32 v137, v137
M a[64:67],a[144:147],v[160:163]
ds_read_b128 a[136:139], v38 offset:8192
v_cvt_pk_bf16_f32 v136, v136, v137
M a[68:71],a[144:147],v[168:171]
v_exp_f32 v138, v138
M a[72:75],a[144:147],v[176:179]
v_exp_f32 v139, v139
M a[76:79],a[144:147],v[184:187]
v_exp_f32 v140, v140
M a[92:95],a[148:151],v[184:187]
ds_read_b128 a[140:143], v39 offset:8192
v_cvt_pk_bf16_f32 v137, v138, v139
M a[88:91],a[148:151],v[176:179]
v_exp_f32 v141, v141
M a[84:87],a[148:151],v[168:171]
buffer_load_dwordx4 v3, s[28:31], s62 offen offset:2048 lds
v_cvt_pk_bf16_f32 v138, v140, v141
M a[80:83],a[148:151],v[160:163]
s_waitcnt lgkmcnt(4)
v_exp_f32 v142, v142
M a[96:99],a[152:155],v[160:163]
ds_read_b128 a[144:147], v36 offset:12288
M a[100:103],a[152:155],v[168:171]
v_exp_f32 v143, v143
M a[104:107],a[152:155],v[176:179]
v_exp_f32 v144, v144
M a[108:111],a[152:155],v[184:187]
v_exp_f32 v145, v145
M a[124:127],a[156:159],v[184:187]
ds_read_b128 a[148:151], v37 offset:12288
v_cvt_pk_bf16_f32 v139, v142, v143
M a[120:123],a[156:159],v[176:179]
v_exp_f32 v146, v146
M a[116:119],a[156:159],v[168:171]
buffer_load_dwordx4 v4, s[28:31], s62 offen offset:3072 lds
v_cvt_pk_bf16_f32 v144, v144, v145
M a[112:115],a[156:159],v[160:163]
v_exp_f32 v147, v147
M v[208:211],v[240:243],v[160:163]
v_exp_f32 v148, v148
M v[212:215],v[240:243],v[168:171]
v_exp_f32 v149, v149
M v[216:219],v[240:243],v[176:179]
v_exp_f32 v150, v150
M v[220:223],v[240:243],v[184:187]
s_waitcnt lgkmcnt(4)
v_exp_f32 v151, v151
N v[160:163],a[128:131],v[64:67],v[192:195]
ds_read_b128 a[152:155], v38 offset:12288
v_cvt_pk_bf16_f32 v145, v146, v147
M v[160:163],a[132:135],v[68:71]
v_exp_f32 v152, v152
N v[168:171],a[132:135],v[84:87],v[196:199]
v_exp_f32 v153, v153
M v[168:171],a[128:131],v[80:83]
v_exp_f32 v154, v154
N v[176:179],a[128:131],v[96:99],v[200:203]
ds_read_b128 a[156:159], v39 offset:12288
v_cvt_pk_bf16_f32 v146, v148, v149
M v[176:179],a[132:135],v[100:103]
s_add_u32 m0, s60, 36864
v_exp_f32 v155, v155
N v[184:187],a[132:135],v[116:119],v[204:207]
buffer_load_dwordx4 v5, s[28:31], s62 offen offset:0 lds
v_cvt_pk_bf16_f32 v147, v150, v151
M v[184:187],a[128:131],v[112:115]
s_waitcnt lgkmcnt(4)
v_exp_f32 v156, v156
M v[184:187],a[140:143],v[124:127]
T a[128:129],v24,16384
T a[130:131],v24,20480
M v[184:187],a[136:139],v[120:123]
v_exp_f32 v157, v157
M v[176:179],a[136:139],v[104:107]
v_exp_f32 v158, v158
M v[176:179],a[140:143],v[108:111]
v_exp_f32 v159, v159
M v[168:171],a[140:143],v[92:95]
T a[132:133],v25,16384
T a[134:135],v25,20480
M v[168:171],a[136:139],v[88:91]
v_cvt_pk_bf16_f32 v152, v152, v153
v_cvt_pk_bf16_f32 v153, v154, v155
M v[160:163],a[136:139],v[72:75]
buffer_load_dwordx4 v6, s[28:31], s62 offen offset:1024 lds
v_cvt_pk_bf16_f32 v154, v156, v157
M v[160:163],a[140:143],v[76:79]
v_cvt_pk_bf16_f32 v155, v158, v159
s_waitcnt lgkmcnt(6)
N v[164:167],a[144:147],v[64:67],v[192:195]
T a[136:137],v26,16384
T a[138:139],v26,20480
M v[164:167],a[148:151],v[68:71]
N v[172:175],a[148:151],v[84:87],v[196:199]
M v[172:175],a[144:147],v[80:83]
N v[180:183],a[144:147],v[96:99],v[200:203]
T a[140:141],v27,16384
T a[142:143],v27,20480
M v[180:183],a[148:151],v[100:103]
N v[188:191],a[148:151],v[116:119],v[204:207]
buffer_load_dwordx4 v7, s[28:31], s62 offen offset:2048 lds
M v[188:191],a[144:147],v[112:115]
s_waitcnt lgkmcnt(8)
M v[188:191],a[156:159],v[124:127]
T a[144:145],v28,16384
T a[146:147],v28,20480
M v[188:191],a[152:155],v[120:123]
M v[180:183],a[152:155],v[104:107]
M v[180:183],a[156:159],v[108:111]
M v[172:175],a[156:159],v[92:95]
T a[148:149],v29,16384
T a[150:151],v29,20480
M v[172:175],a[152:155],v[88:91]
M v[164:167],a[152:155],v[72:75]
s_cmp_eq_u32 s56, 2
buffer_load_dwordx4 v8, s[28:31], s62 offen offset:3072 lds
s_cselect_b32 s62, 7, 2
M v[164:167],a[156:159],v[76:79]
s_lshl_b32 s62, s62, 18
s_add_u32 s62, s62, s69
s_waitcnt lgkmcnt(8)
M a[0:3],a[128:131],v[128:131]
T a[152:153],v30,16384
T a[154:155],v30,20480
M a[4:7],a[128:131],v[136:139]
v_exp_f32 v160, v160
M a[8:11],a[128:131],v[144:147]
v_exp_f32 v161, v161
M a[12:15],a[128:131],v[152:155]
v_exp_f32 v162, v162
M a[28:31],a[132:135],v[152:155]
T a[156:157],v31,16384
T a[158:159],v31,20480
M a[24:27],a[132:135],v[144:147]
v_exp_f32 v163, v163
M a[20:23],a[132:135],v[136:139]
buffer_load_dwordx4 v[232:235], v57, s[36:39], s46 offen
v_cvt_pk_bf16_f32 v160, v160, v161
M a[16:19],a[132:135],v[128:131]
s_waitcnt lgkmcnt(8)
v_exp_f32 v164, v164
M a[32:35],a[136:139],v[128:131]
ds_read_b128 a[128:131], v36 offset:24576
v_cvt_pk_bf16_f32 v161, v162, v163
M a[36:39],a[136:139],v[136:139]
v_exp_f32 v165, v165
M a[40:43],a[136:139],v[144:147]
v_exp_f32 v166, v166
M a[44:47],a[136:139],v[152:155]
v_exp_f32 v167, v167
M a[60:63],a[140:143],v[152:155]
ds_read_b128 a[132:135], v37 offset:24576
v_cvt_pk_bf16_f32 v162, v164, v165
M a[56:59],a[140:143],v[144:147]
v_exp_f32 v168, v168
M a[52:55],a[140:143],v[136:139]
v_exp_f32 v169, v169
M a[48:51],a[140:143],v[128:131]
s_waitcnt lgkmcnt(6)
v_exp_f32 v170, v170
M a[64:67],a[144:147],v[128:131]
ds_read_b128 a[136:139], v38 offset:24576
v_cvt_pk_bf16_f32 v163, v166, v167
M a[68:71],a[144:147],v[136:139]
v_exp_f32 v171, v171
M a[72:75],a[144:147],v[144:147]
v_exp_f32 v172, v172
M a[76:79],a[144:147],v[152:155]
v_exp_f32 v173, v173
M a[92:95],a[148:151],v[152:155]
ds_read_b128 a[140:143], v39 offset:24576
v_cvt_pk_bf16_f32 v168, v168, v169
M a[88:91],a[148:151],v[144:147]
v_exp_f32 v174, v174
M a[84:87],a[148:151],v[136:139]
v_exp_f32 v175, v175
M a[80:83],a[148:151],v[128:131]
s_waitcnt lgkmcnt(4)
v_exp_f32 v176, v176
M a[96:99],a[152:155],v[128:131]
ds_read_b128 a[144:147], v36 offset:28672
v_cvt_pk_bf16_f32 v169, v170, v171
M a[100:103],a[152:155],v[136:139]
v_exp_f32 v177, v177
M a[104:107],a[152:155],v[144:147]
v_exp_f32 v178, v178
M a[108:111],a[152:155],v[152:155]
v_exp_f32 v179, v179
M a[124:127],a[156:159],v[152:155]
ds_read_b128 a[148:151], v37 offset:28672
v_cvt_pk_bf16_f32 v170, v172, v173
M a[120:123],a[156:159],v[144:147]
v_exp_f32 v180, v180
M a[116:119],a[156:159],v[136:139]
v_exp_f32 v181, v181
M a[112:115],a[156:159],v[128:131]
v_exp_f32 v182, v182
M v[208:211],v[240:243],v[128:131]
v_exp_f32 v183, v183
M v[212:215],v[240:243],v[136:139]
v_exp_f32 v184, v184
M v[216:219],v[240:243],v[144:147]
v_exp_f32 v185, v185
M v[220:223],v[240:243],v[152:155]
s_waitcnt lgkmcnt(4)
v_exp_f32 v186, v186
N v[128:131],a[128:131],v[64:67],v[192:195]
ds_read_b128 a[152:155], v38 offset:28672
v_cvt_pk_bf16_f32 v171, v174, v175
M v[128:131],a[132:135],v[68:71]
v_exp_f32 v187, v187
N v[136:139],a[132:135],v[84:87],v[196:199]
v_exp_f32 v188, v188
M v[136:139],a[128:131],v[80:83]
v_exp_f32 v189, v189
N v[144:147],a[128:131],v[96:99],v[200:203]
ds_read_b128 a[156:159], v39 offset:28672
v_cvt_pk_bf16_f32 v176, v176, v177
M v[144:147],a[132:135],v[100:103]
v_exp_f32 v190, v190
N v[152:155],a[132:135],v[116:119],v[204:207]
buffer_load_dwordx4 v[236:239], v57, s[36:39], s47 offen
v_cvt_pk_bf16_f32 v177, v178, v179
M v[152:155],a[128:131],v[112:115]
s_waitcnt vmcnt(20)
s_barrier
s_waitcnt lgkmcnt(4)
M v[152:155],a[140:143],v[124:127]
T a[128:129],v24,32768
T a[130:131],v24,36864
M v[152:155],a[136:139],v[120:123]
v_exp_f32 v191, v191
M v[144:147],a[136:139],v[104:107]
v_cvt_pk_bf16_f32 v178, v180, v181
v_cvt_pk_bf16_f32 v179, v182, v183
M v[144:147],a[140:143],v[108:111]
v_cvt_pk_bf16_f32 v184, v184, v185
v_cvt_pk_bf16_f32 v185, v186, v187
M v[136:139],a[140:143],v[92:95]
T a[132:133],v25,32768
T a[134:135],v25,36864
M v[136:139],a[136:139],v[88:91]
v_cvt_pk_bf16_f32 v186, v188, v189
v_cvt_pk_bf16_f32 v187, v190, v191
M v[128:131],a[136:139],v[72:75]
M v[128:131],a[140:143],v[76:79]
s_waitcnt lgkmcnt(6)
N v[132:135],a[144:147],v[64:67],v[192:195]
T a[136:137],v26,32768
T a[138:139],v26,36864
M v[132:135],a[148:151],v[68:71]
N v[140:143],a[148:151],v[84:87],v[196:199]
M v[140:143],a[144:147],v[80:83]
N v[148:151],a[144:147],v[96:99],v[200:203]
T a[140:141],v27,32768
T a[142:143],v27,36864
M v[148:151],a[148:151],v[100:103]
N v[156:159],a[148:151],v[116:119],v[204:207]
M v[156:159],a[144:147],v[112:115]
s_waitcnt lgkmcnt(8)
M v[156:159],a[156:159],v[124:127]
T a[144:145],v28,32768
T a[146:147],v28,36864
M v[156:159],a[152:155],v[120:123]
M v[148:151],a[152:155],v[104:107]
M v[148:151],a[156:159],v[108:111]
M v[140:143],a[156:159],v[92:95]
T a[148:149],v29,32768
T a[150:151],v29,36864
M v[140:143],a[152:155],v[88:91]
M v[132:135],a[152:155],v[72:75]
M v[132:135],a[156:159],v[76:79]
s_barrier
s_waitcnt lgkmcnt(8)
M a[0:3],a[128:131],v[160:163]
T a[152:153],v30,32768
T a[154:155],v30,36864
M a[4:7],a[128:131],v[168:171]
v_exp_f32 v128, v128
M a[8:11],a[128:131],v[176:179]
v_exp_f32 v129, v129
M a[12:15],a[128:131],v[184:187]
v_exp_f32 v130, v130
M a[28:31],a[132:135],v[184:187]
T a[156:157],v31,32768
T a[158:159],v31,36864
M a[24:27],a[132:135],v[176:179]
s_add_u32 m0, s60, 65536
v_exp_f32 v131, v131
M a[20:23],a[132:135],v[168:171]
buffer_load_dwordx4 v1, s[28:31], s62 offen offset:0 lds
v_cvt_pk_bf16_f32 v128, v128, v129
M a[16:19],a[132:135],v[160:163]
s_waitcnt lgkmcnt(8)
v_exp_f32 v132, v132
M a[32:35],a[136:139],v[160:163]
ds_read_b128 a[128:131], v36 offset:40960
v_cvt_pk_bf16_f32 v129, v130, v131
M a[36:39],a[136:139],v[168:171]
v_exp_f32 v133, v133
M a[40:43],a[136:139],v[176:179]
v_exp_f32 v134, v134
M a[44:47],a[136:139],v[184:187]
v_exp_f32 v135, v135
M a[60:63],a[140:143],v[184:187]
ds_read_b128 a[132:135], v37 offset:40960
v_cvt_pk_bf16_f32 v130, v132, v133
M a[56:59],a[140:143],v[176:179]
v_exp_f32 v136, v136
M a[52:55],a[140:143],v[168:171]
buffer_load_dwordx4 v2, s[28:31], s62 offen offset:1024 lds
v_cvt_pk_bf16_f32 v131, v134, v135
M a[48:51],a[140:143],v[160:163]
s_waitcnt lgkmcnt(6)
v_exp_f32 v137, v137
M a[64:67],a[144:147],v[160:163]
ds_read_b128 a[136:139], v38 offset:40960
v_cvt_pk_bf16_f32 v136, v136, v137
M a[68:71],a[144:147],v[168:171]
v_exp_f32 v138, v138
M a[72:75],a[144:147],v[176:179]
v_exp_f32 v139, v139
M a[76:79],a[144:147],v[184:187]
v_exp_f32 v140, v140
M a[92:95],a[148:151],v[184:187]
ds_read_b128 a[140:143], v39 offset:40960
v_cvt_pk_bf16_f32 v137, v138, v139
M a[88:91],a[148:151],v[176:179]
v_exp_f32 v141, v141
M a[84:87],a[148:151],v[168:171]
buffer_load_dwordx4 v3, s[28:31], s62 offen offset:2048 lds
v_cvt_pk_bf16_f32 v138, v140, v141
M a[80:83],a[148:151],v[160:163]
s_waitcnt lgkmcnt(4)
v_exp_f32 v142, v142
M a[96:99],a[152:155],v[160:163]
ds_read_b128 a[144:147], v36 offset:45056
M a[100:103],a[152:155],v[168:171]
v_exp_f32 v143, v143
M a[104:107],a[152:155],v[176:179]
v_exp_f32 v144, v144
M a[108:111],a[152:155],v[184:187]
v_exp_f32 v145, v145
M a[124:127],a[156:159],v[184:187]
ds_read_b128 a[148:151], v37 offset:45056
v_cvt_pk_bf16_f32 v139, v142, v143
M a[120:123],a[156:159],v[176:179]
v_exp_f32 v146, v146
M a[116:119],a[156:159],v[168:171]
buffer_load_dwordx4 v4, s[28:31], s62 offen offset:3072 lds
v_cvt_pk_bf16_f32 v144, v144, v145
M a[112:115],a[156:159],v[160:163]
v_exp_f32 v147, v147
M v[208:211],v[240:243],v[160:163]
v_exp_f32 v148, v148
M v[212:215],v[240:243],v[168:171]
v_exp_f32 v149, v149
M v[216:219],v[240:243],v[176:179]
v_exp_f32 v150, v150
M v[220:223],v[240:243],v[184:187]
s_waitcnt lgkmcnt(4)
v_exp_f32 v151, v151
N v[160:163],a[128:131],v[64:67],v[192:195]
ds_read_b128 a[152:155], v38 offset:45056
v_cvt_pk_bf16_f32 v145, v146, v147
M v[160:163],a[132:135],v[68:71]
v_exp_f32 v152, v152
N v[168:171],a[132:135],v[84:87],v[196:199]
v_exp_f32 v153, v153
M v[168:171],a[128:131],v[80:83]
v_exp_f32 v154, v154
N v[176:179],a[128:131],v[96:99],v[200:203]
ds_read_b128 a[156:159], v39 offset:45056
v_cvt_pk_bf16_f32 v146, v148, v149
M v[176:179],a[132:135],v[100:103]
s_add_u32 m0, s60, 69632
v_exp_f32 v155, v155
N v[184:187],a[132:135],v[116:119],v[204:207]
buffer_load_dwordx4 v5, s[28:31], s62 offen offset:0 lds
v_cvt_pk_bf16_f32 v147, v150, v151
M v[184:187],a[128:131],v[112:115]
s_waitcnt lgkmcnt(4)
v_exp_f32 v156, v156
M v[184:187],a[140:143],v[124:127]
T a[128:129],v24,49152
T a[130:131],v24,53248
M v[184:187],a[136:139],v[120:123]
v_exp_f32 v157, v157
M v[176:179],a[136:139],v[104:107]
v_exp_f32 v158, v158
M v[176:179],a[140:143],v[108:111]
v_exp_f32 v159, v159
M v[168:171],a[140:143],v[92:95]
T a[132:133],v25,49152
T a[134:135],v25,53248
M v[168:171],a[136:139],v[88:91]
v_cvt_pk_bf16_f32 v152, v152, v153
v_cvt_pk_bf16_f32 v153, v154, v155
M v[160:163],a[136:139],v[72:75]
buffer_load_dwordx4 v6, s[28:31], s62 offen offset:1024 lds
v_cvt_pk_bf16_f32 v154, v156, v157
M v[160:163],a[140:143],v[76:79]
v_cvt_pk_bf16_f32 v155, v158, v159
s_waitcnt lgkmcnt(6)
N v[164:167],a[144:147],v[64:67],v[192:195]
T a[136:137],v26,49152
T a[138:139],v26,53248
M v[164:167],a[148:151],v[68:71]
L_pad31:
s_cbranch_execz L_pad35
v_exp_f32 v168, v168
N v[172:175],a[148:151],v[84:87],v[196:199]
v_exp_f32 v160, v160
M v[172:175],a[144:147],v[80:83]
v_exp_f32 v161, v161
N v[180:183],a[144:147],v[96:99],v[200:203]
T a[140:141],v27,49152
T a[142:143],v27,53248
M v[180:183],a[148:151],v[100:103]
v_exp_f32 v162, v162
N v[188:191],a[148:151],v[116:119],v[204:207]
buffer_load_dwordx4 v7, s[28:31], s62 offen offset:2048 lds
v_cvt_pk_bf16_f32 v160, v160, v161
M v[188:191],a[144:147],v[112:115]
s_waitcnt lgkmcnt(8)
v_exp_f32 v163, v163
M v[188:191],a[156:159],v[124:127]
T a[144:145],v28,49152
T a[146:147],v28,53248
M v[188:191],a[152:155],v[120:123]
v_exp_f32 v169, v169
M v[180:183],a[152:155],v[104:107]
v_exp_f32 v170, v170
M v[180:183],a[156:159],v[108:111]
v_exp_f32 v171, v171
M v[172:175],a[156:159],v[92:95]
T a[148:149],v29,49152
T a[150:151],v29,53248
M v[172:175],a[152:155],v[88:91]
v_exp_f32 v176, v176
M v[164:167],a[152:155],v[72:75]
s_cmp_eq_u32 s56, 3
buffer_load_dwordx4 v8, s[28:31], s62 offen offset:3072 lds
s_cselect_b32 s62, 7, 3
M v[164:167],a[156:159],v[76:79]
s_waitcnt lgkmcnt(8)
v_exp_f32 v177, v177
M a[0:3],a[128:131],v[128:131]
s_lshl_b32 s62, s62, 18
T a[152:153],v30,49152
T a[154:155],v30,53248
M a[4:7],a[128:131],v[136:139]
s_add_u32 s62, s62, s69
v_exp_f32 v178, v178
M a[8:11],a[128:131],v[144:147]
v_exp_f32 v179, v179
M a[12:15],a[128:131],v[152:155]
v_exp_f32 v184, v184
M a[28:31],a[132:135],v[152:155]
T a[156:157],v31,49152
T a[158:159],v31,53248
M a[24:27],a[132:135],v[144:147]
v_exp_f32 v185, v185
M a[20:23],a[132:135],v[136:139]
v_exp_f32 v186, v186
M a[16:19],a[132:135],v[128:131]
s_waitcnt lgkmcnt(8)
v_exp_f32 v187, v187
M a[32:35],a[136:139],v[128:131]
T a[128:129],v30,57344
T a[130:131],v30,61440
M a[36:39],a[136:139],v[136:139]
v_exp_f32 v164, v164
M a[40:43],a[136:139],v[144:147]
v_exp_f32 v165, v165
M a[44:47],a[136:139],v[152:155]
v_exp_f32 v166, v166
M a[60:63],a[140:143],v[152:155]
T a[132:133],v31,57344
T a[134:135],v31,61440
M a[56:59],a[140:143],v[144:147]
v_exp_f32 v167, v167
M a[52:55],a[140:143],v[136:139]
v_exp_f32 v172, v172
M a[48:51],a[140:143],v[128:131]
s_waitcnt lgkmcnt(8)
v_exp_f32 v173, v173
M a[64:67],a[144:147],v[128:131]
T a[136:137],v24,57344
T a[138:139],v24,61440
M a[68:71],a[144:147],v[136:139]
v_exp_f32 v174, v174
M a[72:75],a[144:147],v[144:147]
v_exp_f32 v175, v175
M a[76:79],a[144:147],v[152:155]
v_exp_f32 v180, v180
M a[92:95],a[148:151],v[152:155]
T a[140:141],v25,57344
T a[142:143],v25,61440
M a[88:91],a[148:151],v[144:147]
v_exp_f32 v181, v181
M a[84:87],a[148:151],v[136:139]
v_exp_f32 v182, v182
M a[80:83],a[148:151],v[128:131]
s_waitcnt lgkmcnt(8)
v_exp_f32 v183, v183
M a[96:99],a[152:155],v[128:131]
T a[144:145],v26,57344
T a[146:147],v26,61440
M a[100:103],a[152:155],v[136:139]
v_exp_f32 v188, v188
M a[104:107],a[152:155],v[144:147]
v_exp_f32 v189, v189
M a[108:111],a[152:155],v[152:155]
v_exp_f32 v190, v190
M a[124:127],a[156:159],v[152:155]
T a[148:149],v27,57344
T a[150:151],v27,61440
M a[120:123],a[156:159],v[144:147]
v_exp_f32 v191, v191
M a[116:119],a[156:159],v[136:139]
v_cvt_pk_bf16_f32 v161, v162, v163
v_cvt_pk_bf16_f32 v168, v168, v169
M a[112:115],a[156:159],v[128:131]
v_cvt_pk_bf16_f32 v169, v170, v171
v_cvt_pk_bf16_f32 v176, v176, v177
M v[208:211],v[240:243],v[128:131]
v_cvt_pk_bf16_f32 v177, v178, v179
v_cvt_pk_bf16_f32 v184, v184, v185
M v[212:215],v[240:243],v[136:139]
v_cvt_pk_bf16_f32 v185, v186, v187
v_cvt_pk_bf16_f32 v162, v164, v165
M v[216:219],v[240:243],v[144:147]
v_cvt_pk_bf16_f32 v163, v166, v167
v_cvt_pk_bf16_f32 v170, v172, v173
M v[220:223],v[240:243],v[152:155]
v_cvt_pk_bf16_f32 v171, v174, v175
v_cvt_pk_bf16_f32 v178, v180, v181
v_cvt_pk_bf16_f32 v179, v182, v183
v_cvt_pk_bf16_f32 v186, v188, v189
v_cvt_pk_bf16_f32 v187, v190, v191
M v[208:211],v[240:243],v[160:163]
M v[212:215],v[240:243],v[168:171]
M v[216:219],v[240:243],v[176:179]
M v[220:223],v[240:243],v[184:187]
s_waitcnt lgkmcnt(8)
M a[96:99],a[128:131],v[160:163]
s_mov_b32 s70, 0x4e800000
T a[152:153],v28,57344
T a[154:155],v28,61440
M a[100:103],a[128:131],v[168:171]
v_rcp_f32 v9, v208
M a[104:107],a[128:131],v[176:179]
v_rcp_f32 v10, v212
M a[108:111],a[128:131],v[184:187]
v_rcp_f32 v11, v216
M a[124:127],a[132:135],v[184:187]
T a[156:157],v29,57344
T a[158:159],v29,61440
M a[120:123],a[132:135],v[176:179]
v_rcp_f32 v12, v220
M a[116:119],a[132:135],v[168:171]
v_add_f32 v40, v208, v212
v_add_f32 v41, v216, v220
M a[112:115],a[132:135],v[160:163]
v_add_f32 v40, v40, v41
v_cmp_nge_f32 vcc, s70, v40
v_mov_b32 v32, v244
v_mov_b32 v33, v245
v_mov_b32 v34, v250
v_mov_b32 v35, v251
s_cbranch_vccnz L_slow
L_norm:
s_waitcnt vmcnt(38)
s_barrier
s_waitcnt lgkmcnt(8)
M a[0:3],a[136:139],v[160:163]
T a[128:129],v16,24576
T a[130:131],v16,28672
M a[4:7],a[136:139],v[168:171]
v_accvgpr_read_b32 v40, a96
v_accvgpr_read_b32 v41, a97
M a[8:11],a[136:139],v[176:179]
v_accvgpr_read_b32 v42, a98
v_accvgpr_read_b32 v43, a99
M a[12:15],a[136:139],v[184:187]
v_accvgpr_read_b32 v44, a112
v_accvgpr_read_b32 v45, a113
M a[28:31],a[140:143],v[184:187]
T a[132:133],v17,24576
T a[134:135],v17,28672
M a[24:27],a[140:143],v[176:179]
v_accvgpr_read_b32 v46, a114
v_accvgpr_read_b32 v47, a115
M a[20:23],a[140:143],v[168:171]
v_accvgpr_read_b32 v48, a100
v_accvgpr_read_b32 v49, a101
M a[16:19],a[140:143],v[160:163]
v_accvgpr_read_b32 v50, a102
v_accvgpr_read_b32 v51, a103
v_accvgpr_read_b32 v52, a116
v_accvgpr_read_b32 v53, a117
v_accvgpr_read_b32 v54, a118
v_accvgpr_read_b32 v55, a119
v_pk_mul_f32 v[40:41], v[40:41], v[8:9] op_sel:[0,1] op_sel_hi:[1,1]
v_pk_mul_f32 v[42:43], v[42:43], v[8:9] op_sel:[0,1] op_sel_hi:[1,1]
v_pk_mul_f32 v[44:45], v[44:45], v[8:9] op_sel:[0,1] op_sel_hi:[1,1]
v_pk_mul_f32 v[46:47], v[46:47], v[8:9] op_sel:[0,1] op_sel_hi:[1,1]
v_pk_mul_f32 v[48:49], v[48:49], v[10:11] op_sel:[0,0] op_sel_hi:[1,0]
v_pk_mul_f32 v[50:51], v[50:51], v[10:11] op_sel:[0,0] op_sel_hi:[1,0]
v_pk_mul_f32 v[52:53], v[52:53], v[10:11] op_sel:[0,0] op_sel_hi:[1,0]
v_pk_mul_f32 v[54:55], v[54:55], v[10:11] op_sel:[0,0] op_sel_hi:[1,0]
s_waitcnt lgkmcnt(8)
M a[32:35],a[144:147],v[160:163]
T a[136:137],v18,24576
T a[138:139],v18,28672
M a[36:39],a[144:147],v[168:171]
v_cvt_pk_bf16_f32 v192, v40, v41
v_cvt_pk_bf16_f32 v193, v42, v43
M a[40:43],a[144:147],v[176:179]
v_cvt_pk_bf16_f32 v194, v44, v45
v_cvt_pk_bf16_f32 v195, v46, v47
M a[44:47],a[144:147],v[184:187]
buffer_store_dwordx4 v[192:195], v58, s[12:15], s11 offen offset:0 sc1
v_cvt_pk_bf16_f32 v196, v48, v49
M a[60:63],a[148:151],v[184:187]
T a[140:141],v19,24576
T a[142:143],v19,28672
M a[56:59],a[148:151],v[176:179]
v_cvt_pk_bf16_f32 v197, v50, v51
v_cvt_pk_bf16_f32 v198, v52, v53
M a[52:55],a[148:151],v[168:171]
v_cvt_pk_bf16_f32 v199, v54, v55
buffer_store_dwordx4 v[196:199], v58, s[12:15], s11 offen offset:1024 sc1
M a[48:51],a[148:151],v[160:163]
s_waitcnt lgkmcnt(8)
v_accvgpr_read_b32 v40, a104
v_accvgpr_read_b32 v41, a105
M a[64:67],a[152:155],v[160:163]
T a[144:145],v20,24576
T a[146:147],v20,28672
M a[68:71],a[152:155],v[168:171]
v_accvgpr_read_b32 v42, a106
v_accvgpr_read_b32 v43, a107
M a[72:75],a[152:155],v[176:179]
v_accvgpr_read_b32 v44, a120
v_accvgpr_read_b32 v45, a121
M a[76:79],a[152:155],v[184:187]
v_accvgpr_read_b32 v46, a122
v_accvgpr_read_b32 v47, a123
M a[92:95],a[156:159],v[184:187]
T a[148:149],v21,24576
T a[150:151],v21,28672
M a[88:91],a[156:159],v[176:179]
v_accvgpr_read_b32 v48, a108
v_accvgpr_read_b32 v49, a109
M a[84:87],a[156:159],v[168:171]
v_accvgpr_read_b32 v50, a110
v_accvgpr_read_b32 v51, a111
M a[80:83],a[156:159],v[160:163]
v_accvgpr_read_b32 v52, a124
v_accvgpr_read_b32 v53, a125
v_accvgpr_read_b32 v54, a126
v_accvgpr_read_b32 v55, a127
v_pk_mul_f32 v[40:41], v[40:41], v[10:11] op_sel:[0,1] op_sel_hi:[1,1]
v_pk_mul_f32 v[42:43], v[42:43], v[10:11] op_sel:[0,1] op_sel_hi:[1,1]
v_pk_mul_f32 v[44:45], v[44:45], v[10:11] op_sel:[0,1] op_sel_hi:[1,1]
v_pk_mul_f32 v[46:47], v[46:47], v[10:11] op_sel:[0,1] op_sel_hi:[1,1]
v_pk_mul_f32 v[48:49], v[48:49], v[12:13] op_sel:[0,0] op_sel_hi:[1,0]
v_pk_mul_f32 v[50:51], v[50:51], v[12:13] op_sel:[0,0] op_sel_hi:[1,0]
v_pk_mul_f32 v[52:53], v[52:53], v[12:13] op_sel:[0,0] op_sel_hi:[1,0]
v_pk_mul_f32 v[54:55], v[54:55], v[12:13] op_sel:[0,0] op_sel_hi:[1,0]
s_mov_b64 exec, 0
s_cmp_eq_u32 s52, 0
s_cbranch_scc1 L_pad38
s_cmp_eq_u32 s52, 1
s_cbranch_scc1 L_pad39
s_cmp_eq_u32 s52, 2
s_cbranch_scc1 L_pad40
s_branch L_pad41
L_pb2:
s_mov_b64 exec, -1
s_barrier
v_cvt_pk_bf16_f32 v200, v40, v41
v_cvt_pk_bf16_f32 v201, v42, v43
v_cvt_pk_bf16_f32 v202, v44, v45
v_cvt_pk_bf16_f32 v203, v46, v47
buffer_store_dwordx4 v[200:203], v59, s[12:15], s11 offen offset:0 sc1
v_cvt_pk_bf16_f32 v204, v48, v49
v_cvt_pk_bf16_f32 v205, v50, v51
v_cvt_pk_bf16_f32 v206, v52, v53
v_cvt_pk_bf16_f32 v207, v54, v55
buffer_store_dwordx4 v[204:207], v59, s[12:15], s11 offen offset:1024 sc1
v_rcp_f32 v40, v32
v_rcp_f32 v41, v33
v_rcp_f32 v42, v34
v_rcp_f32 v43, v35
v_mul_f32 v36, 0xc0135761, v40
v_mul_f32 v64, v40, v40
v_mul_f32 v37, 0xc0135761, v41
v_mul_f32 v65, v41, v41
v_mul_f32 v38, 0xc0135761, v42
v_mul_f32 v66, v42, v42
v_mul_f32 v39, 0xc0135761, v43
v_mul_f32 v67, v43, v43
v_mul_f32 v64, v64, v36
v_mul_f32 v65, v65, v37
v_mul_f32 v66, v66, v38
v_mul_f32 v67, v67, v39
v_mul_f32 v64, 0x3d372713, v64
v_mul_f32 v65, 0x3d372713, v65
v_mul_f32 v66, 0x3d372713, v66
v_mul_f32 v67, 0x3d372713, v67
s_waitcnt vmcnt(12)
v_accvgpr_read_b32 v40, a0
v_accvgpr_read_b32 v41, a1
v_accvgpr_read_b32 v42, a2
v_accvgpr_read_b32 v43, a3
v_accvgpr_read_b32 v44, a16
v_accvgpr_read_b32 v45, a17
v_accvgpr_read_b32 v46, a18
v_accvgpr_read_b32 v47, a19
v_pk_mul_f32 v[40:41], v[40:41], v[8:9] op_sel:[0,1] op_sel_hi:[1,1]
v_pk_mul_f32 v[42:43], v[42:43], v[8:9] op_sel:[0,1] op_sel_hi:[1,1]
v_pk_mul_f32 v[44:45], v[44:45], v[8:9] op_sel:[0,1] op_sel_hi:[1,1]
v_pk_mul_f32 v[46:47], v[46:47], v[8:9] op_sel:[0,1] op_sel_hi:[1,1]
v_cvt_pk_bf16_f32 v208, v40, v41
v_cvt_pk_bf16_f32 v209, v42, v43
v_cvt_pk_bf16_f32 v210, v44, v45
v_cvt_pk_bf16_f32 v211, v46, v47
buffer_store_dwordx4 v[208:211], v58, s[12:15], s8 offen offset:0 sc1
v_permlane16_swap_b32 v224, v226
v_permlane16_swap_b32 v225, v227
v_permlane16_swap_b32 v228, v230
v_permlane16_swap_b32 v229, v231
v_permlane16_swap_b32 v232, v234
v_permlane16_swap_b32 v233, v235
v_permlane16_swap_b32 v236, v238
v_permlane16_swap_b32 v237, v239
v_accvgpr_read_b32 v48, a4
v_accvgpr_read_b32 v49, a5
v_accvgpr_read_b32 v50, a6
v_accvgpr_read_b32 v51, a7
v_accvgpr_read_b32 v52, a20
v_accvgpr_read_b32 v53, a21
v_accvgpr_read_b32 v54, a22
v_accvgpr_read_b32 v55, a23
v_pk_mul_f32 v[48:49], v[48:49], v[10:11] op_sel:[0,0] op_sel_hi:[1,0]
v_pk_mul_f32 v[50:51], v[50:51], v[10:11] op_sel:[0,0] op_sel_hi:[1,0]
v_pk_mul_f32 v[52:53], v[52:53], v[10:11] op_sel:[0,0] op_sel_hi:[1,0]
v_pk_mul_f32 v[54:55], v[54:55], v[10:11] op_sel:[0,0] op_sel_hi:[1,0]
v_cvt_pk_bf16_f32 v212, v48, v49
v_cvt_pk_bf16_f32 v213, v50, v51
v_cvt_pk_bf16_f32 v214, v52, v53
v_cvt_pk_bf16_f32 v215, v54, v55
buffer_store_dwordx4 v[212:215], v58, s[12:15], s8 offen offset:1024 sc1
v_permlane32_swap_b32 v224, v226
v_permlane32_swap_b32 v225, v227
v_permlane32_swap_b32 v228, v230
v_permlane32_swap_b32 v229, v231
v_permlane32_swap_b32 v232, v234
v_permlane32_swap_b32 v233, v235
v_permlane32_swap_b32 v236, v238
v_permlane32_swap_b32 v237, v239
v_accvgpr_read_b32 v40, a8
v_accvgpr_read_b32 v41, a9
v_accvgpr_read_b32 v42, a10
v_accvgpr_read_b32 v43, a11
v_accvgpr_read_b32 v44, a24
v_accvgpr_read_b32 v45, a25
v_accvgpr_read_b32 v46, a26
v_accvgpr_read_b32 v47, a27
v_pk_mul_f32 v[40:41], v[40:41], v[10:11] op_sel:[0,1] op_sel_hi:[1,1]
v_pk_mul_f32 v[42:43], v[42:43], v[10:11] op_sel:[0,1] op_sel_hi:[1,1]
v_pk_mul_f32 v[44:45], v[44:45], v[10:11] op_sel:[0,1] op_sel_hi:[1,1]
v_pk_mul_f32 v[46:47], v[46:47], v[10:11] op_sel:[0,1] op_sel_hi:[1,1]
v_cvt_pk_bf16_f32 v216, v40, v41
v_cvt_pk_bf16_f32 v217, v42, v43
v_cvt_pk_bf16_f32 v218, v44, v45
v_cvt_pk_bf16_f32 v219, v46, v47
buffer_store_dwordx4 v[216:219], v59, s[12:15], s8 offen offset:0 sc1
v_accvgpr_write_b32 a112, v224
v_accvgpr_write_b32 a113, v225
v_accvgpr_write_b32 a114, v226
v_accvgpr_write_b32 a115, v227
v_accvgpr_write_b32 a116, v228
v_accvgpr_write_b32 a117, v229
v_accvgpr_write_b32 a118, v230
v_accvgpr_write_b32 a119, v231
v_accvgpr_read_b32 v48, a12
v_accvgpr_read_b32 v49, a13
v_accvgpr_read_b32 v50, a14
v_accvgpr_read_b32 v51, a15
v_accvgpr_read_b32 v52, a28
v_accvgpr_read_b32 v53, a29
v_accvgpr_read_b32 v54, a30
v_accvgpr_read_b32 v55, a31
v_pk_mul_f32 v[48:49], v[48:49], v[12:13] op_sel:[0,0] op_sel_hi:[1,0]
v_pk_mul_f32 v[50:51], v[50:51], v[12:13] op_sel:[0,0] op_sel_hi:[1,0]
v_pk_mul_f32 v[52:53], v[52:53], v[12:13] op_sel:[0,0] op_sel_hi:[1,0]
v_pk_mul_f32 v[54:55], v[54:55], v[12:13] op_sel:[0,0] op_sel_hi:[1,0]
v_cvt_pk_bf16_f32 v220, v48, v49
v_cvt_pk_bf16_f32 v221, v50, v51
v_cvt_pk_bf16_f32 v222, v52, v53
v_cvt_pk_bf16_f32 v223, v54, v55
buffer_store_dwordx4 v[220:223], v59, s[12:15], s8 offen offset:1024 sc1
v_accvgpr_write_b32 a120, v232
v_accvgpr_write_b32 a121, v233
v_accvgpr_write_b32 a122, v234
v_accvgpr_write_b32 a123, v235
v_accvgpr_write_b32 a124, v236
v_accvgpr_write_b32 a125, v237
v_accvgpr_write_b32 a126, v238
v_accvgpr_write_b32 a127, v239
v_accvgpr_read_b32 v40, a32
v_accvgpr_read_b32 v41, a33
v_accvgpr_read_b32 v42, a34
v_accvgpr_read_b32 v43, a35
v_accvgpr_read_b32 v44, a48
v_accvgpr_read_b32 v45, a49
v_accvgpr_read_b32 v46, a50
v_accvgpr_read_b32 v47, a51
v_pk_mul_f32 v[40:41], v[40:41], v[8:9] op_sel:[0,1] op_sel_hi:[1,1]
v_pk_mul_f32 v[42:43], v[42:43], v[8:9] op_sel:[0,1] op_sel_hi:[1,1]
v_pk_mul_f32 v[44:45], v[44:45], v[8:9] op_sel:[0,1] op_sel_hi:[1,1]
v_pk_mul_f32 v[46:47], v[46:47], v[8:9] op_sel:[0,1] op_sel_hi:[1,1]
v_cvt_pk_bf16_f32 v224, v40, v41
v_cvt_pk_bf16_f32 v225, v42, v43
v_cvt_pk_bf16_f32 v226, v44, v45
v_cvt_pk_bf16_f32 v227, v46, v47
buffer_store_dwordx4 v[224:227], v58, s[12:15], s9 offen offset:0 sc1
v_accvgpr_read_b32 v80, a192
v_accvgpr_read_b32 v81, a193
v_accvgpr_read_b32 v82, a194
v_accvgpr_read_b32 v83, a195
v_accvgpr_read_b32 v84, a196
v_accvgpr_read_b32 v85, a197
v_accvgpr_read_b32 v48, a36
v_accvgpr_read_b32 v49, a37
v_accvgpr_read_b32 v50, a38
v_accvgpr_read_b32 v51, a39
v_accvgpr_read_b32 v52, a52
v_accvgpr_read_b32 v53, a53
v_accvgpr_read_b32 v54, a54
v_accvgpr_read_b32 v55, a55
v_pk_mul_f32 v[48:49], v[48:49], v[10:11] op_sel:[0,0] op_sel_hi:[1,0]
v_pk_mul_f32 v[50:51], v[50:51], v[10:11] op_sel:[0,0] op_sel_hi:[1,0]
v_pk_mul_f32 v[52:53], v[52:53], v[10:11] op_sel:[0,0] op_sel_hi:[1,0]
v_pk_mul_f32 v[54:55], v[54:55], v[10:11] op_sel:[0,0] op_sel_hi:[1,0]
v_cvt_pk_bf16_f32 v228, v48, v49
v_cvt_pk_bf16_f32 v229, v50, v51
v_cvt_pk_bf16_f32 v230, v52, v53
v_cvt_pk_bf16_f32 v231, v54, v55
buffer_store_dwordx4 v[228:231], v58, s[12:15], s9 offen offset:1024 sc1
v_accvgpr_read_b32 v86, a198
v_accvgpr_read_b32 v87, a199
v_pk_mul_f32 v[72:73], v[80:81], v[80:81]
v_pk_mul_f32 v[74:75], v[82:83], v[82:83]
v_pk_mul_f32 v[76:77], v[84:85], v[84:85]
v_pk_mul_f32 v[78:79], v[86:87], v[86:87]
v_accvgpr_read_b32 v40, a40
v_accvgpr_read_b32 v41, a41
v_accvgpr_read_b32 v42, a42
v_accvgpr_read_b32 v43, a43
v_accvgpr_read_b32 v44, a56
v_accvgpr_read_b32 v45, a57
v_accvgpr_read_b32 v46, a58
v_accvgpr_read_b32 v47, a59
v_pk_mul_f32 v[40:41], v[40:41], v[10:11] op_sel:[0,1] op_sel_hi:[1,1]
v_pk_mul_f32 v[42:43], v[42:43], v[10:11] op_sel:[0,1] op_sel_hi:[1,1]
v_pk_mul_f32 v[44:45], v[44:45], v[10:11] op_sel:[0,1] op_sel_hi:[1,1]
v_pk_mul_f32 v[46:47], v[46:47], v[10:11] op_sel:[0,1] op_sel_hi:[1,1]
v_cvt_pk_bf16_f32 v232, v40, v41
v_cvt_pk_bf16_f32 v233, v42, v43
v_cvt_pk_bf16_f32 v234, v44, v45
v_cvt_pk_bf16_f32 v235, v46, v47
buffer_store_dwordx4 v[232:235], v59, s[12:15], s9 offen offset:0 sc1
v_pk_fma_f32 v[72:73], v[72:73], v[66:67], v[38:39] op_sel:[0,0,0] op_sel_hi:[1,0,0]
v_pk_fma_f32 v[74:75], v[74:75], v[66:67], v[38:39] op_sel:[0,0,0] op_sel_hi:[1,0,0]
v_pk_fma_f32 v[76:77], v[76:77], v[66:67], v[38:39] op_sel:[0,0,0] op_sel_hi:[1,0,0]
v_pk_fma_f32 v[78:79], v[78:79], v[66:67], v[38:39] op_sel:[0,0,0] op_sel_hi:[1,0,0]
v_pk_mul_f32 v[72:73], v[72:73], v[80:81]
v_pk_mul_f32 v[74:75], v[74:75], v[82:83]
v_accvgpr_read_b32 v48, a44
v_accvgpr_read_b32 v49, a45
v_accvgpr_read_b32 v50, a46
v_accvgpr_read_b32 v51, a47
v_accvgpr_read_b32 v52, a60
v_accvgpr_read_b32 v53, a61
v_accvgpr_read_b32 v54, a62
v_accvgpr_read_b32 v55, a63
v_pk_mul_f32 v[48:49], v[48:49], v[12:13] op_sel:[0,0] op_sel_hi:[1,0]
v_pk_mul_f32 v[50:51], v[50:51], v[12:13] op_sel:[0,0] op_sel_hi:[1,0]
v_pk_mul_f32 v[52:53], v[52:53], v[12:13] op_sel:[0,0] op_sel_hi:[1,0]
v_pk_mul_f32 v[54:55], v[54:55], v[12:13] op_sel:[0,0] op_sel_hi:[1,0]
v_cvt_pk_bf16_f32 v236, v48, v49
v_cvt_pk_bf16_f32 v237, v50, v51
v_cvt_pk_bf16_f32 v238, v52, v53
v_cvt_pk_bf16_f32 v239, v54, v55
buffer_store_dwordx4 v[236:239], v59, s[12:15], s9 offen offset:1024 sc1
v_pk_mul_f32 v[76:77], v[76:77], v[84:85]
v_pk_mul_f32 v[78:79], v[78:79], v[86:87]
v_exp_f32 v72, v72
v_exp_f32 v73, v73
v_exp_f32 v74, v74
v_exp_f32 v75, v75
v_accvgpr_read_b32 v40, a64
v_accvgpr_read_b32 v41, a65
v_accvgpr_read_b32 v42, a66
v_accvgpr_read_b32 v43, a67
v_accvgpr_read_b32 v44, a80
v_accvgpr_read_b32 v45, a81
v_accvgpr_read_b32 v46, a82
v_accvgpr_read_b32 v47, a83
v_pk_mul_f32 v[40:41], v[40:41], v[8:9] op_sel:[0,1] op_sel_hi:[1,1]
v_pk_mul_f32 v[42:43], v[42:43], v[8:9] op_sel:[0,1] op_sel_hi:[1,1]
v_pk_mul_f32 v[44:45], v[44:45], v[8:9] op_sel:[0,1] op_sel_hi:[1,1]
v_pk_mul_f32 v[46:47], v[46:47], v[8:9] op_sel:[0,1] op_sel_hi:[1,1]
v_cvt_pk_bf16_f32 v240, v40, v41
v_cvt_pk_bf16_f32 v241, v42, v43
v_cvt_pk_bf16_f32 v242, v44, v45
v_cvt_pk_bf16_f32 v243, v46, v47
buffer_store_dwordx4 v[240:243], v58, s[12:15], s10 offen offset:0 sc1
v_exp_f32 v76, v76
v_exp_f32 v77, v77
v_exp_f32 v78, v78
v_exp_f32 v79, v79
v_pk_fma_f32 v[72:73], v[72:73], v[34:35], v[34:35] op_sel:[0,0,0] op_sel_hi:[1,0,0]
v_pk_fma_f32 v[74:75], v[74:75], v[34:35], v[34:35] op_sel:[0,0,0] op_sel_hi:[1,0,0]
v_accvgpr_read_b32 v48, a68
v_accvgpr_read_b32 v49, a69
v_accvgpr_read_b32 v50, a70
v_accvgpr_read_b32 v51, a71
v_accvgpr_read_b32 v52, a84
v_accvgpr_read_b32 v53, a85
v_accvgpr_read_b32 v54, a86
v_accvgpr_read_b32 v55, a87
v_pk_mul_f32 v[48:49], v[48:49], v[10:11] op_sel:[0,0] op_sel_hi:[1,0]
v_pk_mul_f32 v[50:51], v[50:51], v[10:11] op_sel:[0,0] op_sel_hi:[1,0]
v_pk_mul_f32 v[52:53], v[52:53], v[10:11] op_sel:[0,0] op_sel_hi:[1,0]
v_pk_mul_f32 v[54:55], v[54:55], v[10:11] op_sel:[0,0] op_sel_hi:[1,0]
v_cvt_pk_bf16_f32 v244, v48, v49
v_cvt_pk_bf16_f32 v245, v50, v51
v_cvt_pk_bf16_f32 v246, v52, v53
v_cvt_pk_bf16_f32 v247, v54, v55
buffer_store_dwordx4 v[244:247], v58, s[12:15], s10 offen offset:1024 sc1
v_pk_fma_f32 v[76:77], v[76:77], v[34:35], v[34:35] op_sel:[0,0,0] op_sel_hi:[1,0,0]
v_pk_fma_f32 v[78:79], v[78:79], v[34:35], v[34:35] op_sel:[0,0,0] op_sel_hi:[1,0,0]
v_rcp_f32 v72, v72
v_rcp_f32 v73, v73
v_rcp_f32 v74, v74
v_rcp_f32 v75, v75
v_accvgpr_read_b32 v40, a72
v_accvgpr_read_b32 v41, a73
v_accvgpr_read_b32 v42, a74
v_accvgpr_read_b32 v43, a75
v_accvgpr_read_b32 v44, a88
v_accvgpr_read_b32 v45, a89
v_accvgpr_read_b32 v46, a90
v_accvgpr_read_b32 v47, a91
v_pk_mul_f32 v[40:41], v[40:41], v[10:11] op_sel:[0,1] op_sel_hi:[1,1]
v_pk_mul_f32 v[42:43], v[42:43], v[10:11] op_sel:[0,1] op_sel_hi:[1,1]
v_pk_mul_f32 v[44:45], v[44:45], v[10:11] op_sel:[0,1] op_sel_hi:[1,1]
v_pk_mul_f32 v[46:47], v[46:47], v[10:11] op_sel:[0,1] op_sel_hi:[1,1]
v_cvt_pk_bf16_f32 v248, v40, v41
v_cvt_pk_bf16_f32 v249, v42, v43
v_cvt_pk_bf16_f32 v250, v44, v45
v_cvt_pk_bf16_f32 v251, v46, v47
buffer_store_dwordx4 v[248:251], v59, s[12:15], s10 offen offset:0 sc1
v_rcp_f32 v76, v76
v_rcp_f32 v77, v77
v_rcp_f32 v78, v78
v_rcp_f32 v79, v79
v_pk_mul_f32 v[80:81], v[72:73], v[80:81]
v_pk_mul_f32 v[82:83], v[74:75], v[82:83]
v_accvgpr_read_b32 v48, a76
v_accvgpr_read_b32 v49, a77
v_accvgpr_read_b32 v50, a78
v_accvgpr_read_b32 v51, a79
v_accvgpr_read_b32 v52, a92
L_pad32:
s_cbranch_execz L_pad36
v_accvgpr_read_b32 v53, a93
v_accvgpr_read_b32 v54, a94
v_accvgpr_read_b32 v55, a95
v_pk_mul_f32 v[48:49], v[48:49], v[12:13] op_sel:[0,0] op_sel_hi:[1,0]
v_pk_mul_f32 v[50:51], v[50:51], v[12:13] op_sel:[0,0] op_sel_hi:[1,0]
v_pk_mul_f32 v[52:53], v[52:53], v[12:13] op_sel:[0,0] op_sel_hi:[1,0]
v_pk_mul_f32 v[54:55], v[54:55], v[12:13] op_sel:[0,0] op_sel_hi:[1,0]
v_cvt_pk_bf16_f32 v252, v48, v49
v_cvt_pk_bf16_f32 v253, v50, v51
v_cvt_pk_bf16_f32 v254, v52, v53
v_cvt_pk_bf16_f32 v255, v54, v55
buffer_store_dwordx4 v[252:255], v59, s[12:15], s10 offen offset:1024 sc1
v_pk_mul_f32 v[84:85], v[76:77], v[84:85]
v_pk_mul_f32 v[86:87], v[78:79], v[86:87]
v_cvt_pk_bf16_f32 v96, v80, v81
v_cvt_pk_bf16_f32 v97, v82, v83
v_cvt_pk_bf16_f32 v98, v84, v85
v_cvt_pk_bf16_f32 v99, v86, v87
buffer_store_dwordx4 v[96:99], v59, s[12:15], s57 offen offset:0 sc1
v_accvgpr_read_b32 v80, a200
v_accvgpr_read_b32 v81, a201
v_accvgpr_read_b32 v82, a202
v_accvgpr_read_b32 v83, a203
v_accvgpr_read_b32 v84, a204
v_accvgpr_read_b32 v85, a205
v_accvgpr_read_b32 v86, a206
v_accvgpr_read_b32 v87, a207
v_pk_mul_f32 v[72:73], v[80:81], v[80:81]
v_pk_mul_f32 v[74:75], v[82:83], v[82:83]
v_pk_mul_f32 v[76:77], v[84:85], v[84:85]
v_pk_mul_f32 v[78:79], v[86:87], v[86:87]
v_pk_fma_f32 v[72:73], v[72:73], v[66:67], v[38:39] op_sel:[0,1,1] op_sel_hi:[1,1,1]
v_pk_fma_f32 v[74:75], v[74:75], v[66:67], v[38:39] op_sel:[0,1,1] op_sel_hi:[1,1,1]
v_pk_fma_f32 v[76:77], v[76:77], v[66:67], v[38:39] op_sel:[0,1,1] op_sel_hi:[1,1,1]
v_pk_fma_f32 v[78:79], v[78:79], v[66:67], v[38:39] op_sel:[0,1,1] op_sel_hi:[1,1,1]
v_pk_mul_f32 v[72:73], v[72:73], v[80:81]
v_pk_mul_f32 v[74:75], v[74:75], v[82:83]
v_pk_mul_f32 v[76:77], v[76:77], v[84:85]
v_pk_mul_f32 v[78:79], v[78:79], v[86:87]
v_exp_f32 v72, v72
v_exp_f32 v73, v73
v_exp_f32 v74, v74
v_exp_f32 v75, v75
v_exp_f32 v76, v76
v_exp_f32 v77, v77
v_exp_f32 v78, v78
v_exp_f32 v79, v79
v_pk_fma_f32 v[72:73], v[72:73], v[34:35], v[34:35] op_sel:[0,1,1] op_sel_hi:[1,1,1]
v_pk_fma_f32 v[74:75], v[74:75], v[34:35], v[34:35] op_sel:[0,1,1] op_sel_hi:[1,1,1]
v_pk_fma_f32 v[76:77], v[76:77], v[34:35], v[34:35] op_sel:[0,1,1] op_sel_hi:[1,1,1]
v_pk_fma_f32 v[78:79], v[78:79], v[34:35], v[34:35] op_sel:[0,1,1] op_sel_hi:[1,1,1]
v_rcp_f32 v72, v72
v_rcp_f32 v73, v73
v_rcp_f32 v74, v74
v_rcp_f32 v75, v75
v_rcp_f32 v76, v76
v_rcp_f32 v77, v77
v_rcp_f32 v78, v78
v_rcp_f32 v79, v79
v_pk_mul_f32 v[80:81], v[72:73], v[80:81]
v_pk_mul_f32 v[82:83], v[74:75], v[82:83]
v_pk_mul_f32 v[84:85], v[76:77], v[84:85]
v_pk_mul_f32 v[86:87], v[78:79], v[86:87]
v_cvt_pk_bf16_f32 v100, v80, v81
v_cvt_pk_bf16_f32 v101, v82, v83
v_cvt_pk_bf16_f32 v102, v84, v85
v_cvt_pk_bf16_f32 v103, v86, v87
v_accvgpr_read_b32 v80, a208
v_accvgpr_read_b32 v81, a209
v_accvgpr_read_b32 v82, a210
v_accvgpr_read_b32 v83, a211
v_accvgpr_read_b32 v84, a212
v_accvgpr_read_b32 v85, a213
v_accvgpr_read_b32 v86, a214
v_accvgpr_read_b32 v87, a215
v_pk_mul_f32 v[72:73], v[80:81], v[80:81]
v_pk_mul_f32 v[74:75], v[82:83], v[82:83]
v_pk_mul_f32 v[76:77], v[84:85], v[84:85]
v_pk_mul_f32 v[78:79], v[86:87], v[86:87]
v_pk_fma_f32 v[72:73], v[72:73], v[64:65], v[36:37] op_sel:[0,0,0] op_sel_hi:[1,0,0]
v_pk_fma_f32 v[74:75], v[74:75], v[64:65], v[36:37] op_sel:[0,0,0] op_sel_hi:[1,0,0]
v_pk_fma_f32 v[76:77], v[76:77], v[64:65], v[36:37] op_sel:[0,0,0] op_sel_hi:[1,0,0]
buffer_store_dwordx4 v[100:103], v59, s[12:15], s57 offen offset:1024 sc1
v_pk_fma_f32 v[78:79], v[78:79], v[64:65], v[36:37] op_sel:[0,0,0] op_sel_hi:[1,0,0]
v_pk_mul_f32 v[72:73], v[72:73], v[80:81]
v_pk_mul_f32 v[74:75], v[74:75], v[82:83]
v_pk_mul_f32 v[76:77], v[76:77], v[84:85]
v_pk_mul_f32 v[78:79], v[78:79], v[86:87]
v_exp_f32 v72, v72
v_exp_f32 v73, v73
v_exp_f32 v74, v74
v_exp_f32 v75, v75
v_exp_f32 v76, v76
v_exp_f32 v77, v77
v_exp_f32 v78, v78
v_exp_f32 v79, v79
v_pk_fma_f32 v[72:73], v[72:73], v[32:33], v[32:33] op_sel:[0,0,0] op_sel_hi:[1,0,0]
v_pk_fma_f32 v[74:75], v[74:75], v[32:33], v[32:33] op_sel:[0,0,0] op_sel_hi:[1,0,0]
v_pk_fma_f32 v[76:77], v[76:77], v[32:33], v[32:33] op_sel:[0,0,0] op_sel_hi:[1,0,0]
v_pk_fma_f32 v[78:79], v[78:79], v[32:33], v[32:33] op_sel:[0,0,0] op_sel_hi:[1,0,0]
v_rcp_f32 v72, v72
v_rcp_f32 v73, v73
v_rcp_f32 v74, v74
v_rcp_f32 v75, v75
v_rcp_f32 v76, v76
v_rcp_f32 v77, v77
v_rcp_f32 v78, v78
v_rcp_f32 v79, v79
v_pk_mul_f32 v[80:81], v[72:73], v[80:81]
v_pk_mul_f32 v[82:83], v[74:75], v[82:83]
v_pk_mul_f32 v[84:85], v[76:77], v[84:85]
v_pk_mul_f32 v[86:87], v[78:79], v[86:87]
v_cvt_pk_bf16_f32 v104, v80, v81
v_cvt_pk_bf16_f32 v105, v82, v83
v_cvt_pk_bf16_f32 v106, v84, v85
v_cvt_pk_bf16_f32 v107, v86, v87
v_accvgpr_read_b32 v80, a216
v_accvgpr_read_b32 v81, a217
v_accvgpr_read_b32 v82, a218
v_accvgpr_read_b32 v83, a219
v_accvgpr_read_b32 v84, a220
v_accvgpr_read_b32 v85, a221
v_accvgpr_read_b32 v86, a222
v_accvgpr_read_b32 v87, a223
v_pk_mul_f32 v[72:73], v[80:81], v[80:81]
v_pk_mul_f32 v[74:75], v[82:83], v[82:83]
v_pk_mul_f32 v[76:77], v[84:85], v[84:85]
v_pk_mul_f32 v[78:79], v[86:87], v[86:87]
v_pk_fma_f32 v[72:73], v[72:73], v[64:65], v[36:37] op_sel:[0,1,1] op_sel_hi:[1,1,1]
s_add_u32 s57, s57, 4096
buffer_store_dwordx4 v[104:107], v58, s[12:15], s57 offen offset:0 sc1
v_pk_fma_f32 v[74:75], v[74:75], v[64:65], v[36:37] op_sel:[0,1,1] op_sel_hi:[1,1,1]
v_pk_fma_f32 v[76:77], v[76:77], v[64:65], v[36:37] op_sel:[0,1,1] op_sel_hi:[1,1,1]
v_pk_fma_f32 v[78:79], v[78:79], v[64:65], v[36:37] op_sel:[0,1,1] op_sel_hi:[1,1,1]
v_pk_mul_f32 v[72:73], v[72:73], v[80:81]
v_pk_mul_f32 v[74:75], v[74:75], v[82:83]
v_pk_mul_f32 v[76:77], v[76:77], v[84:85]
v_pk_mul_f32 v[78:79], v[78:79], v[86:87]
v_exp_f32 v72, v72
v_exp_f32 v73, v73
v_exp_f32 v74, v74
v_exp_f32 v75, v75
v_exp_f32 v76, v76
v_exp_f32 v77, v77
v_exp_f32 v78, v78
v_exp_f32 v79, v79
v_pk_fma_f32 v[72:73], v[72:73], v[32:33], v[32:33] op_sel:[0,1,1] op_sel_hi:[1,1,1]
v_pk_fma_f32 v[74:75], v[74:75], v[32:33], v[32:33] op_sel:[0,1,1] op_sel_hi:[1,1,1]
v_pk_fma_f32 v[76:77], v[76:77], v[32:33], v[32:33] op_sel:[0,1,1] op_sel_hi:[1,1,1]
v_pk_fma_f32 v[78:79], v[78:79], v[32:33], v[32:33] op_sel:[0,1,1] op_sel_hi:[1,1,1]
v_rcp_f32 v72, v72
v_rcp_f32 v73, v73
v_rcp_f32 v74, v74
v_rcp_f32 v75, v75
v_rcp_f32 v76, v76
v_rcp_f32 v77, v77
v_rcp_f32 v78, v78
v_rcp_f32 v79, v79
v_pk_mul_f32 v[80:81], v[72:73], v[80:81]
v_pk_mul_f32 v[82:83], v[74:75], v[82:83]
v_pk_mul_f32 v[84:85], v[76:77], v[84:85]
v_pk_mul_f32 v[86:87], v[78:79], v[86:87]
v_cvt_pk_bf16_f32 v108, v80, v81
v_cvt_pk_bf16_f32 v109, v82, v83
v_cvt_pk_bf16_f32 v110, v84, v85
v_cvt_pk_bf16_f32 v111, v86, v87
v_accvgpr_read_b32 v80, a224
v_accvgpr_read_b32 v81, a225
v_accvgpr_read_b32 v82, a226
v_accvgpr_read_b32 v83, a227
v_accvgpr_read_b32 v84, a228
v_accvgpr_read_b32 v85, a229
v_accvgpr_read_b32 v86, a230
v_accvgpr_read_b32 v87, a231
v_pk_mul_f32 v[72:73], v[80:81], v[80:81]
v_pk_mul_f32 v[74:75], v[82:83], v[82:83]
v_pk_mul_f32 v[76:77], v[84:85], v[84:85]
v_pk_mul_f32 v[78:79], v[86:87], v[86:87]
buffer_store_dwordx4 v[108:111], v58, s[12:15], s57 offen offset:1024 sc1
v_pk_fma_f32 v[72:73], v[72:73], v[66:67], v[38:39] op_sel:[0,0,0] op_sel_hi:[1,0,0]
v_pk_fma_f32 v[74:75], v[74:75], v[66:67], v[38:39] op_sel:[0,0,0] op_sel_hi:[1,0,0]
v_pk_fma_f32 v[76:77], v[76:77], v[66:67], v[38:39] op_sel:[0,0,0] op_sel_hi:[1,0,0]
v_pk_fma_f32 v[78:79], v[78:79], v[66:67], v[38:39] op_sel:[0,0,0] op_sel_hi:[1,0,0]
v_pk_mul_f32 v[72:73], v[72:73], v[80:81]
v_pk_mul_f32 v[74:75], v[74:75], v[82:83]
v_pk_mul_f32 v[76:77], v[76:77], v[84:85]
v_pk_mul_f32 v[78:79], v[78:79], v[86:87]
v_exp_f32 v72, v72
v_exp_f32 v73, v73
v_exp_f32 v74, v74
v_exp_f32 v75, v75
v_exp_f32 v76, v76
v_exp_f32 v77, v77
v_exp_f32 v78, v78
v_exp_f32 v79, v79
v_pk_fma_f32 v[72:73], v[72:73], v[34:35], v[34:35] op_sel:[0,0,0] op_sel_hi:[1,0,0]
v_pk_fma_f32 v[74:75], v[74:75], v[34:35], v[34:35] op_sel:[0,0,0] op_sel_hi:[1,0,0]
v_pk_fma_f32 v[76:77], v[76:77], v[34:35], v[34:35] op_sel:[0,0,0] op_sel_hi:[1,0,0]
v_pk_fma_f32 v[78:79], v[78:79], v[34:35], v[34:35] op_sel:[0,0,0] op_sel_hi:[1,0,0]
v_rcp_f32 v72, v72
v_rcp_f32 v73, v73
v_rcp_f32 v74, v74
v_rcp_f32 v75, v75
v_rcp_f32 v76, v76
v_rcp_f32 v77, v77
v_rcp_f32 v78, v78
v_rcp_f32 v79, v79
v_pk_mul_f32 v[80:81], v[72:73], v[80:81]
v_pk_mul_f32 v[82:83], v[74:75], v[82:83]
v_pk_mul_f32 v[84:85], v[76:77], v[84:85]
v_pk_mul_f32 v[86:87], v[78:79], v[86:87]
v_cvt_pk_bf16_f32 v112, v80, v81
v_cvt_pk_bf16_f32 v113, v82, v83
v_cvt_pk_bf16_f32 v114, v84, v85
v_cvt_pk_bf16_f32 v115, v86, v87
v_accvgpr_write_b32 a208, v112
v_accvgpr_write_b32 a209, v113
v_accvgpr_write_b32 a210, v114
v_accvgpr_write_b32 a211, v115
v_accvgpr_read_b32 v80, a232
v_accvgpr_read_b32 v81, a233
v_accvgpr_read_b32 v82, a234
v_accvgpr_read_b32 v83, a235
v_accvgpr_read_b32 v84, a236
v_accvgpr_read_b32 v85, a237
v_accvgpr_read_b32 v86, a238
v_accvgpr_read_b32 v87, a239
v_pk_mul_f32 v[72:73], v[80:81], v[80:81]
v_pk_mul_f32 v[74:75], v[82:83], v[82:83]
v_pk_mul_f32 v[76:77], v[84:85], v[84:85]
v_pk_mul_f32 v[78:79], v[86:87], v[86:87]
v_pk_fma_f32 v[72:73], v[72:73], v[66:67], v[38:39] op_sel:[0,1,1] op_sel_hi:[1,1,1]
v_pk_fma_f32 v[74:75], v[74:75], v[66:67], v[38:39] op_sel:[0,1,1] op_sel_hi:[1,1,1]
v_pk_fma_f32 v[76:77], v[76:77], v[66:67], v[38:39] op_sel:[0,1,1] op_sel_hi:[1,1,1]
v_pk_fma_f32 v[78:79], v[78:79], v[66:67], v[38:39] op_sel:[0,1,1] op_sel_hi:[1,1,1]
v_pk_mul_f32 v[72:73], v[72:73], v[80:81]
v_pk_mul_f32 v[74:75], v[74:75], v[82:83]
v_pk_mul_f32 v[76:77], v[76:77], v[84:85]
s_waitcnt vmcnt(4)
s_barrier
s_add_u32 s74, s64, 3
v_mov_b32 v61, s74
buffer_store_dword v61, v60, s[12:15], s65 offen sc1
v_pk_mul_f32 v[78:79], v[78:79], v[86:87]
v_exp_f32 v72, v72
v_exp_f32 v73, v73
v_exp_f32 v74, v74
v_exp_f32 v75, v75
v_exp_f32 v76, v76
v_exp_f32 v77, v77
v_exp_f32 v78, v78
v_exp_f32 v79, v79
v_pk_fma_f32 v[72:73], v[72:73], v[34:35], v[34:35] op_sel:[0,1,1] op_sel_hi:[1,1,1]
v_pk_fma_f32 v[74:75], v[74:75], v[34:35], v[34:35] op_sel:[0,1,1] op_sel_hi:[1,1,1]
v_pk_fma_f32 v[76:77], v[76:77], v[34:35], v[34:35] op_sel:[0,1,1] op_sel_hi:[1,1,1]
v_pk_fma_f32 v[78:79], v[78:79], v[34:35], v[34:35] op_sel:[0,1,1] op_sel_hi:[1,1,1]
v_rcp_f32 v72, v72
v_rcp_f32 v73, v73
v_rcp_f32 v74, v74
v_rcp_f32 v75, v75
v_rcp_f32 v76, v76
v_rcp_f32 v77, v77
v_rcp_f32 v78, v78
v_rcp_f32 v79, v79
v_pk_mul_f32 v[80:81], v[72:73], v[80:81]
v_pk_mul_f32 v[82:83], v[74:75], v[82:83]
v_pk_mul_f32 v[84:85], v[76:77], v[84:85]
v_pk_mul_f32 v[86:87], v[78:79], v[86:87]
v_cvt_pk_bf16_f32 v116, v80, v81
v_cvt_pk_bf16_f32 v117, v82, v83
v_cvt_pk_bf16_f32 v118, v84, v85
v_cvt_pk_bf16_f32 v119, v86, v87
v_accvgpr_write_b32 a212, v116
v_accvgpr_write_b32 a213, v117
v_accvgpr_write_b32 a214, v118
v_accvgpr_write_b32 a215, v119
v_accvgpr_read_b32 v80, a240
v_accvgpr_read_b32 v81, a241
v_accvgpr_read_b32 v82, a242
v_accvgpr_read_b32 v83, a243
v_accvgpr_read_b32 v84, a244
v_accvgpr_read_b32 v85, a245
v_accvgpr_read_b32 v86, a246
v_accvgpr_read_b32 v87, a247
v_pk_mul_f32 v[72:73], v[80:81], v[80:81]
v_pk_mul_f32 v[74:75], v[82:83], v[82:83]
v_pk_mul_f32 v[76:77], v[84:85], v[84:85]
v_pk_mul_f32 v[78:79], v[86:87], v[86:87]
v_pk_fma_f32 v[72:73], v[72:73], v[64:65], v[36:37] op_sel:[0,0,0] op_sel_hi:[1,0,0]
v_pk_fma_f32 v[74:75], v[74:75], v[64:65], v[36:37] op_sel:[0,0,0] op_sel_hi:[1,0,0]
v_pk_fma_f32 v[76:77], v[76:77], v[64:65], v[36:37] op_sel:[0,0,0] op_sel_hi:[1,0,0]
v_pk_fma_f32 v[78:79], v[78:79], v[64:65], v[36:37] op_sel:[0,0,0] op_sel_hi:[1,0,0]
v_pk_mul_f32 v[72:73], v[72:73], v[80:81]
v_pk_mul_f32 v[74:75], v[74:75], v[82:83]
v_pk_mul_f32 v[76:77], v[76:77], v[84:85]
v_pk_mul_f32 v[78:79], v[78:79], v[86:87]
v_exp_f32 v72, v72
v_exp_f32 v73, v73
v_exp_f32 v74, v74
v_exp_f32 v75, v75
v_exp_f32 v76, v76
v_exp_f32 v77, v77
v_exp_f32 v78, v78
v_exp_f32 v79, v79
v_pk_fma_f32 v[72:73], v[72:73], v[32:33], v[32:33] op_sel:[0,0,0] op_sel_hi:[1,0,0]
v_pk_fma_f32 v[74:75], v[74:75], v[32:33], v[32:33] op_sel:[0,0,0] op_sel_hi:[1,0,0]
v_pk_fma_f32 v[76:77], v[76:77], v[32:33], v[32:33] op_sel:[0,0,0] op_sel_hi:[1,0,0]
v_pk_fma_f32 v[78:79], v[78:79], v[32:33], v[32:33] op_sel:[0,0,0] op_sel_hi:[1,0,0]
v_rcp_f32 v72, v72
v_rcp_f32 v73, v73
v_rcp_f32 v74, v74
v_rcp_f32 v75, v75
v_rcp_f32 v76, v76
v_rcp_f32 v77, v77
v_rcp_f32 v78, v78
v_rcp_f32 v79, v79
v_pk_mul_f32 v[80:81], v[72:73], v[80:81]
v_pk_mul_f32 v[82:83], v[74:75], v[82:83]
v_pk_mul_f32 v[84:85], v[76:77], v[84:85]
v_pk_mul_f32 v[86:87], v[78:79], v[86:87]
v_cvt_pk_bf16_f32 v88, v80, v81
v_cvt_pk_bf16_f32 v89, v82, v83
v_cvt_pk_bf16_f32 v90, v84, v85
v_cvt_pk_bf16_f32 v91, v86, v87
v_accvgpr_write_b32 a216, v88
v_accvgpr_write_b32 a217, v89
v_accvgpr_write_b32 a218, v90
v_accvgpr_write_b32 a219, v91
v_mov_b32 v9, v64
v_mov_b32 v10, v65
v_mov_b32 v11, v66
v_mov_b32 v12, v67
s_waitcnt lgkmcnt(8)
N v[64:67],a[128:131],v[192:195],0
T a[152:153],v22,24576
v_accvgpr_read_b32 v48, a248
N v[68:71],a[128:131],v[196:199],0
s_add_u32 m0, s60, 98304
T a[154:155],v22,28672
v_accvgpr_read_b32 v49, a249
N v[72:75],a[128:131],v[200:203],0
buffer_load_dwordx4 v1, s[28:31], s62 offen offset:0 lds
v_accvgpr_read_b32 v50, a250
N v[76:79],a[128:131],v[204:207],0
v_accvgpr_read_b32 v51, a251
v_accvgpr_read_b32 v52, a252
N v[80:83],a[132:135],v[192:195],0
T a[156:157],v23,24576
v_accvgpr_read_b32 v53, a253
N v[84:87],a[132:135],v[196:199],0
T a[158:159],v23,28672
v_accvgpr_read_b32 v54, a254
N v[88:91],a[132:135],v[200:203],0
buffer_load_dwordx4 v2, s[28:31], s62 offen offset:1024 lds
v_accvgpr_read_b32 v55, a255
N v[92:95],a[132:135],v[204:207],0
s_waitcnt lgkmcnt(8)
v_mul_f32 v40, v48, v48
v_mul_f32 v41, v49, v49
N v[96:99],a[136:139],v[192:195],0
T a[128:129],v16,0
v_mul_f32 v42, v50, v50
N v[100:103],a[136:139],v[196:199],0
T a[130:131],v16,4096
v_mul_f32 v43, v51, v51
N v[104:107],a[136:139],v[200:203],0
buffer_load_dwordx4 v3, s[28:31], s62 offen offset:2048 lds
v_mul_f32 v44, v52, v52
N v[108:111],a[136:139],v[204:207],0
v_mul_f32 v45, v53, v53
v_mul_f32 v46, v54, v54
N v[112:115],a[140:143],v[192:195],0
T a[132:133],v17,0
v_mul_f32 v47, v55, v55
N v[116:119],a[140:143],v[196:199],0
T a[134:135],v17,4096
v_fma_f32 v40, v40, v10, v37
N v[120:123],a[140:143],v[200:203],0
buffer_load_dwordx4 v4, s[28:31], s62 offen offset:3072 lds
v_fma_f32 v41, v41, v10, v37
N v[124:127],a[140:143],v[204:207],0
s_waitcnt lgkmcnt(8)
v_fma_f32 v42, v42, v10, v37
v_fma_f32 v43, v43, v10, v37
N v[128:131],a[144:147],v[192:195],0
T a[136:137],v18,0
v_fma_f32 v44, v44, v10, v37
N v[132:135],a[144:147],v[196:199],0
T a[138:139],v18,4096
v_fma_f32 v45, v45, v10, v37
N v[136:139],a[144:147],v[200:203],0
v_fma_f32 v46, v46, v10, v37
v_fma_f32 v47, v47, v10, v37
N v[140:143],a[144:147],v[204:207],0
v_mul_f32 v40, v40, v48
v_mul_f32 v41, v41, v49
N v[144:147],a[148:151],v[192:195],0
T a[140:141],v19,0
v_mul_f32 v42, v42, v50
N v[148:151],a[148:151],v[196:199],0
s_add_u32 m0, s60, 102400
T a[142:143],v19,4096
v_mul_f32 v43, v43, v51
N v[152:155],a[148:151],v[200:203],0
buffer_load_dwordx4 v5, s[28:31], s62 offen offset:0 lds
v_mul_f32 v44, v44, v52
N v[156:159],a[148:151],v[204:207],0
s_waitcnt lgkmcnt(8)
v_exp_f32 v40, v40
N v[160:163],a[152:155],v[192:195],0
T a[144:145],v20,0
v_mul_f32 v45, v45, v53
N v[164:167],a[152:155],v[196:199],0
T a[146:147],v20,4096
v_mul_f32 v46, v46, v54
N v[168:171],a[152:155],v[200:203],0
buffer_load_dwordx4 v6, s[28:31], s62 offen offset:1024 lds
v_mul_f32 v47, v47, v55
N v[172:175],a[152:155],v[204:207],0
v_exp_f32 v41, v41
N v[176:179],a[156:159],v[192:195],0
T a[148:149],v21,0
v_fma_f32 v40, v40, v33, v33
N v[180:183],a[156:159],v[196:199],0
T a[150:151],v21,4096
v_fma_f32 v41, v41, v33, v33
N v[184:187],a[156:159],v[200:203],0
buffer_load_dwordx4 v7, s[28:31], s62 offen offset:2048 lds
N v[188:191],a[156:159],v[204:207],0
s_waitcnt lgkmcnt(8)
v_exp_f32 v42, v42
M v[64:67],a[128:131],v[208:211]
T a[152:153],v22,0
v_fma_f32 v42, v42, v33, v33
M v[68:71],a[128:131],v[212:215]
T a[154:155],v22,4096
M v[72:75],a[128:131],v[216:219]
buffer_load_dword v62, v14, s[12:15], s6 offen sc1
M v[76:79],a[128:131],v[220:223]
v_exp_f32 v43, v43
M v[80:83],a[132:135],v[208:211]
T a[156:157],v23,0
v_fma_f32 v43, v43, v33, v33
M v[84:87],a[132:135],v[212:215]
T a[158:159],v23,4096
M v[88:91],a[132:135],v[216:219]
s_cmp_eq_u32 s56, 4
buffer_load_dwordx4 v8, s[28:31], s62 offen offset:3072 lds
s_cselect_b32 s62, 7, 4
M v[92:95],a[132:135],v[220:223]
s_lshl_b32 s62, s62, 18
s_add_u32 s62, s62, s69
s_waitcnt lgkmcnt(8)
M v[96:99],a[136:139],v[208:211]
T a[128:129],v16,8192
M v[100:103],a[136:139],v[212:215]
T a[130:131],v16,12288
M v[104:107],a[136:139],v[216:219]
v_exp_f32 v44, v44
M v[108:111],a[136:139],v[220:223]
v_exp_f32 v45, v45
M v[112:115],a[140:143],v[208:211]
T a[132:133],v17,8192
v_fma_f32 v44, v44, v33, v33
M v[116:119],a[140:143],v[212:215]
T a[134:135],v17,12288
v_fma_f32 v45, v45, v33, v33
M v[120:123],a[140:143],v[216:219]
v_exp_f32 v46, v46
M v[124:127],a[140:143],v[220:223]
s_waitcnt lgkmcnt(8)
v_exp_f32 v47, v47
M v[128:131],a[144:147],v[208:211]
T a[136:137],v18,8192
v_fma_f32 v46, v46, v33, v33
M v[132:135],a[144:147],v[212:215]
T a[138:139],v18,12288
v_fma_f32 v47, v47, v33, v33
M v[136:139],a[144:147],v[216:219]
v_rcp_f32 v40, v40
M v[140:143],a[144:147],v[220:223]
v_rcp_f32 v41, v41
M v[144:147],a[148:151],v[208:211]
T a[140:141],v19,8192
v_mul_f32 v48, v40, v48
M v[148:151],a[148:151],v[212:215]
T a[142:143],v19,12288
v_mul_f32 v49, v41, v49
M v[152:155],a[148:151],v[216:219]
v_rcp_f32 v42, v42
M v[156:159],a[148:151],v[220:223]
s_waitcnt lgkmcnt(8)
v_rcp_f32 v43, v43
M v[160:163],a[152:155],v[208:211]
T a[144:145],v20,8192
v_mul_f32 v50, v42, v50
M v[164:167],a[152:155],v[212:215]
T a[146:147],v20,12288
v_mul_f32 v51, v43, v51
M v[168:171],a[152:155],v[216:219]
v_rcp_f32 v44, v44
M v[172:175],a[152:155],v[220:223]
v_rcp_f32 v45, v45
M v[176:179],a[156:159],v[208:211]
T a[148:149],v21,8192
v_mul_f32 v52, v44, v52
M v[180:183],a[156:159],v[212:215]
T a[150:151],v21,12288
v_mul_f32 v53, v45, v53
M v[184:187],a[156:159],v[216:219]
v_rcp_f32 v46, v46
M v[188:191],a[156:159],v[220:223]
s_waitcnt lgkmcnt(8)
v_rcp_f32 v47, v47
M v[64:67],a[128:131],v[224:227]
T a[152:153],v22,8192
v_subrev_u32 v24, 65536, v24
M v[68:71],a[128:131],v[228:231]
T a[154:155],v22,12288
v_subrev_u32 v25, 65536, v25
M v[72:75],a[128:131],v[232:235]
v_subrev_u32 v26, 65536, v26
v_subrev_u32 v27, 65536, v27
M v[76:79],a[128:131],v[236:239]
v_subrev_u32 v28, 65536, v28
v_subrev_u32 v29, 65536, v29
M v[80:83],a[132:135],v[224:227]
T a[156:157],v23,8192
v_subrev_u32 v30, 65536, v30
M v[84:87],a[132:135],v[228:231]
T a[158:159],v23,12288
v_subrev_u32 v31, 65536, v31
M v[88:91],a[132:135],v[232:235]
s_waitcnt vmcnt(1)
v_subrev_u32 v62, s74, v62
v_cmp_le_u32 vcc, 13, v62
M v[92:95],a[132:135],v[236:239]
s_cbranch_vccnz SPIN_o
BACK_o:
s_xor_b32 s6, s6, 1024
buffer_load_dwordx4 a[96:99], v58, s[12:15], s63 offen offset:0 sc1
s_waitcnt lgkmcnt(8)
M v[96:99],a[136:139],v[224:227]
T a[128:129],v16,16384
v_mul_f32 v54, v46, v54
M v[100:103],a[136:139],v[228:231]
T a[130:131],v16,20480
v_mul_f32 v55, v47, v55
M v[104:107],a[136:139],v[232:235]
buffer_load_dwordx4 a[100:103], v58, s[12:15], s63 offen offset:1024 sc1
v_cvt_pk_bf16_f32 v48, v48, v49
M v[108:111],a[136:139],v[236:239]
v_cvt_pk_bf16_f32 v49, v50, v51
v_cvt_pk_bf16_f32 v50, v52, v53
buffer_load_dwordx4 a[104:107], v59, s[12:15], s63 offen offset:0 sc1
M v[112:115],a[140:143],v[224:227]
T a[132:133],v17,16384
v_cvt_pk_bf16_f32 v51, v54, v55
M v[116:119],a[140:143],v[228:231]
T a[134:135],v17,20480
v_accvgpr_write_b32 a220, v48
M v[120:123],a[140:143],v[232:235]
buffer_load_dwordx4 a[108:111], v59, s[12:15], s63 offen offset:1024 sc1
s_add_u32 s63, s63, 4096
M v[124:127],a[140:143],v[236:239]
s_waitcnt lgkmcnt(8)
v_accvgpr_write_b32 a221, v49
v_accvgpr_write_b32 a222, v50
buffer_load_dwordx4 a[0:3], v58, s[12:15], s63 offen offset:0 sc1
M v[128:131],a[144:147],v[224:227]
T a[136:137],v18,16384
v_accvgpr_write_b32 a223, v51
M v[132:135],a[144:147],v[228:231]
T a[138:139],v18,20480
v_accvgpr_read_b32 v48, a160
M v[136:139],a[144:147],v[232:235]
buffer_load_dwordx4 a[4:7], v58, s[12:15], s63 offen offset:1024 sc1
v_accvgpr_read_b32 v49, a161
M v[140:143],a[144:147],v[236:239]
v_accvgpr_read_b32 v50, a162
v_accvgpr_read_b32 v51, a163
buffer_load_dwordx4 a[8:11], v59, s[12:15], s63 offen offset:0 sc1
M v[144:147],a[148:151],v[224:227]
T a[140:141],v19,16384
v_accvgpr_read_b32 v52, a164
M v[148:151],a[148:151],v[228:231]
T a[142:143],v19,20480
v_accvgpr_read_b32 v53, a165
M v[152:155],a[148:151],v[232:235]
buffer_load_dwordx4 a[12:15], v59, s[12:15], s63 offen offset:1024 sc1
s_add_u32 s63, s63, 4096
M v[156:159],a[148:151],v[236:239]
s_waitcnt lgkmcnt(8)
v_accvgpr_read_b32 v54, a166
v_accvgpr_read_b32 v55, a167
M v[160:163],a[152:155],v[224:227]
L_pad33:
s_cbranch_execz L_pad37
T a[144:145],v20,16384
v_mul_f32 v40, v48, v48
M v[164:167],a[152:155],v[228:231]
T a[146:147],v20,20480
v_mul_f32 v41, v49, v49
M v[168:171],a[152:155],v[232:235]
v_mul_f32 v42, v50, v50
v_mul_f32 v43, v51, v51
M v[172:175],a[152:155],v[236:239]
v_mul_f32 v44, v52, v52
v_mul_f32 v45, v53, v53
M v[176:179],a[156:159],v[224:227]
T a[148:149],v21,16384
v_mul_f32 v46, v54, v54
M v[180:183],a[156:159],v[228:231]
T a[150:151],v21,20480
v_mul_f32 v47, v55, v55
M v[184:187],a[156:159],v[232:235]
buffer_load_dwordx4 a[16:19], v58, s[12:15], s63 offen offset:0 sc1
v_fma_f32 v40, v40, v11, v38
M v[188:191],a[156:159],v[236:239]
s_waitcnt lgkmcnt(8)
v_fma_f32 v41, v41, v11, v38
v_fma_f32 v42, v42, v11, v38
M v[64:67],a[128:131],v[240:243]
T a[152:153],v22,16384
v_fma_f32 v43, v43, v11, v38
M v[68:71],a[128:131],v[244:247]
T a[154:155],v22,20480
v_fma_f32 v44, v44, v11, v38
M v[72:75],a[128:131],v[248:251]
buffer_load_dwordx4 a[20:23], v58, s[12:15], s63 offen offset:1024 sc1
v_fma_f32 v45, v45, v11, v38
M v[76:79],a[128:131],v[252:255]
v_fma_f32 v46, v46, v11, v38
v_fma_f32 v47, v47, v11, v38
M v[80:83],a[132:135],v[240:243]
T a[156:157],v23,16384
v_mul_f32 v40, v40, v48
M v[84:87],a[132:135],v[244:247]
T a[158:159],v23,20480
v_mul_f32 v41, v41, v49
M v[88:91],a[132:135],v[248:251]
buffer_load_dwordx4 a[24:27], v59, s[12:15], s63 offen offset:0 sc1
v_mul_f32 v42, v42, v50
M v[92:95],a[132:135],v[252:255]
s_waitcnt vmcnt(61)
s_barrier
s_waitcnt lgkmcnt(8)
M v[96:99],a[136:139],v[240:243]
T a[128:129],v24,0
v_subrev_u32 v16, 65536, v16
M v[100:103],a[136:139],v[244:247]
T a[130:131],v24,4096
v_subrev_u32 v17, 65536, v17
M v[104:107],a[136:139],v[248:251]
buffer_load_dwordx4 a[28:31], v59, s[12:15], s63 offen offset:1024 sc1
v_subrev_u32 v18, 65536, v18
M v[108:111],a[136:139],v[252:255]
s_add_u32 s63, s63, 4096
v_subrev_u32 v19, 65536, v19
v_subrev_u32 v20, 65536, v20
M v[112:115],a[140:143],v[240:243]
T a[132:133],v24,8192
v_subrev_u32 v21, 65536, v21
M v[116:119],a[140:143],v[244:247]
T a[134:135],v24,12288
v_subrev_u32 v22, 65536, v22
M v[120:123],a[140:143],v[248:251]
buffer_load_dwordx4 a[32:35], v58, s[12:15], s63 offen offset:0 sc1
v_subrev_u32 v23, 65536, v23
M v[124:127],a[140:143],v[252:255]
s_waitcnt lgkmcnt(8)
v_exp_f32 v40, v40
M v[128:131],a[144:147],v[240:243]
T a[136:137],v25,0
v_mul_f32 v43, v43, v51
M v[132:135],a[144:147],v[244:247]
T a[138:139],v25,4096
v_mul_f32 v44, v44, v52
M v[136:139],a[144:147],v[248:251]
buffer_load_dwordx4 a[36:39], v58, s[12:15], s63 offen offset:1024 sc1
v_mul_f32 v45, v45, v53
M v[140:143],a[144:147],v[252:255]
v_exp_f32 v41, v41
M v[144:147],a[148:151],v[240:243]
T a[140:141],v25,8192
v_mul_f32 v46, v46, v54
M v[148:151],a[148:151],v[244:247]
T a[142:143],v25,12288
v_mul_f32 v47, v47, v55
M v[152:155],a[148:151],v[248:251]
buffer_load_dwordx4 a[40:43], v59, s[12:15], s63 offen offset:0 sc1
v_fma_f32 v40, v40, v34, v34
M v[156:159],a[148:151],v[252:255]
s_waitcnt lgkmcnt(8)
v_exp_f32 v42, v42
M v[160:163],a[152:155],v[240:243]
T a[144:145],v26,0
v_fma_f32 v41, v41, v34, v34
M v[164:167],a[152:155],v[244:247]
T a[146:147],v26,4096
v_fma_f32 v42, v42, v34, v34
M v[168:171],a[152:155],v[248:251]
s_cmp_eq_u32 s56, 1
buffer_load_dwordx4 a[44:47], v59, s[12:15], s63 offen offset:1024 sc1
s_cselect_b32 s63, 7, 1
M v[172:175],a[152:155],v[252:255]
s_lshl_b32 s63, s63, 14
s_add_u32 s63, s63, s4
M v[176:179],a[156:159],v[240:243]
T a[148:149],v26,8192
M v[180:183],a[156:159],v[244:247]
T a[150:151],v26,12288
M v[184:187],a[156:159],v[248:251]
buffer_load_dwordx4 a[48:51], v58, s[12:15], s63 offen offset:0 sc1
M v[188:191],a[156:159],v[252:255]
s_barrier
s_waitcnt vmcnt(9)
s_waitcnt lgkmcnt(8)
M v[64:67],a[128:131],a[96:99]
T a[152:153],v27,0
v_accvgpr_read_b32 v225, a112
M v[64:67],a[132:135],a[0:3]
T a[154:155],v27,4096
v_accvgpr_read_b32 v227, a113
M v[68:71],a[132:135],a[4:7]
buffer_load_dwordx4 a[52:55], v58, s[12:15], s63 offen offset:1024 sc1
v_accvgpr_read_b32 v229, a114
M v[68:71],a[128:131],a[100:103]
v_accvgpr_read_b32 v231, a115
v_accvgpr_read_b32 v233, a116
M v[72:75],a[128:131],a[104:107]
T a[156:157],v27,8192
v_accvgpr_read_b32 v235, a117
M v[72:75],a[132:135],a[8:11]
T a[158:159],v27,12288
v_accvgpr_read_b32 v237, a118
M v[76:79],a[132:135],a[12:15]
buffer_load_dwordx4 a[56:59], v59, s[12:15], s63 offen offset:0 sc1
v_accvgpr_read_b32 v239, a119
M v[76:79],a[128:131],a[108:111]
s_waitcnt lgkmcnt(8)
v_accvgpr_read_b32 v241, a120
v_accvgpr_read_b32 v243, a121
M v[92:95],a[140:143],a[12:15]
T a[128:129],v28,0
v_accvgpr_read_b32 v245, a122
M v[92:95],a[136:139],a[108:111]
T a[130:131],v28,4096
v_accvgpr_read_b32 v247, a123
M v[88:91],a[136:139],a[104:107]
v_accvgpr_read_b32 v249, a124
v_accvgpr_read_b32 v251, a125
M v[88:91],a[140:143],a[8:11]
v_accvgpr_read_b32 v253, a126
v_accvgpr_read_b32 v255, a127
M v[84:87],a[140:143],a[4:7]
T a[132:133],v28,8192
v_lshlrev_b32 v224, 16, v225
M v[84:87],a[136:139],a[100:103]
T a[134:135],v28,12288
v_and_b32 v225, 0xffff0000, v225
M v[80:83],a[136:139],a[96:99]
buffer_load_dwordx4 a[60:63], v59, s[12:15], s63 offen offset:1024 sc1
v_lshlrev_b32 v226, 16, v227
M v[80:83],a[140:143],a[0:3]
s_waitcnt lgkmcnt(8)
v_and_b32 v227, 0xffff0000, v227
v_lshlrev_b32 v228, 16, v229
M v[96:99],a[144:147],a[96:99]
s_add_u32 s63, s63, 4096
T a[136:137],v29,0
v_and_b32 v229, 0xffff0000, v229
M v[96:99],a[148:151],a[0:3]
T a[138:139],v29,4096
v_lshlrev_b32 v230, 16, v231
M v[100:103],a[148:151],a[4:7]
buffer_load_dwordx4 a[64:67], v58, s[12:15], s63 offen offset:0 sc1
v_and_b32 v231, 0xffff0000, v231
M v[100:103],a[144:147],a[100:103]
v_lshlrev_b32 v232, 16, v233
v_and_b32 v233, 0xffff0000, v233
M v[104:107],a[144:147],a[104:107]
T a[140:141],v29,8192
v_lshlrev_b32 v234, 16, v235
M v[104:107],a[148:151],a[8:11]
T a[142:143],v29,12288
v_and_b32 v235, 0xffff0000, v235
M v[108:111],a[148:151],a[12:15]
buffer_load_dwordx4 a[68:71], v58, s[12:15], s63 offen offset:1024 sc1
v_lshlrev_b32 v236, 16, v237
M v[108:111],a[144:147],a[108:111]
s_waitcnt lgkmcnt(8)
v_and_b32 v237, 0xffff0000, v237
v_lshlrev_b32 v238, 16, v239
M v[124:127],a[156:159],a[12:15]
T a[144:145],v30,0
v_and_b32 v239, 0xffff0000, v239
M v[124:127],a[152:155],a[108:111]
T a[146:147],v30,4096
v_lshlrev_b32 v240, 16, v241
M v[120:123],a[152:155],a[104:107]
buffer_load_dwordx4 a[72:75], v59, s[12:15], s63 offen offset:0 sc1
v_and_b32 v241, 0xffff0000, v241
M v[120:123],a[156:159],a[8:11]
v_lshlrev_b32 v242, 16, v243
v_and_b32 v243, 0xffff0000, v243
M v[116:119],a[156:159],a[4:7]
T a[148:149],v30,8192
v_lshlrev_b32 v244, 16, v245
M v[116:119],a[152:155],a[100:103]
T a[150:151],v30,12288
v_and_b32 v245, 0xffff0000, v245
M v[112:115],a[152:155],a[96:99]
buffer_load_dwordx4 a[76:79], v59, s[12:15], s63 offen offset:1024 sc1
v_lshlrev_b32 v246, 16, v247
M v[112:115],a[156:159],a[0:3]
s_waitcnt lgkmcnt(8)
v_and_b32 v247, 0xffff0000, v247
v_lshlrev_b32 v248, 16, v249
M v[128:131],a[128:131],a[96:99]
s_add_u32 s63, s63, 4096
T a[152:153],v31,0
v_and_b32 v249, 0xffff0000, v249
M v[128:131],a[132:135],a[0:3]
T a[154:155],v31,4096
v_lshlrev_b32 v250, 16, v251
M v[132:135],a[132:135],a[4:7]
v_and_b32 v251, 0xffff0000, v251
v_lshlrev_b32 v252, 16, v253
M v[132:135],a[128:131],a[100:103]
v_and_b32 v253, 0xffff0000, v253
v_lshlrev_b32 v254, 16, v255
M v[136:139],a[128:131],a[104:107]
T a[156:157],v31,8192
v_and_b32 v255, 0xffff0000, v255
M v[136:139],a[132:135],a[8:11]
T a[158:159],v31,12288
M v[140:143],a[132:135],a[12:15]
buffer_load_dwordx4 a[80:83], v58, s[12:15], s63 offen offset:0 sc1
M v[140:143],a[128:131],a[108:111]
s_waitcnt lgkmcnt(8)
v_exp_f32 v43, v43
M v[156:159],a[140:143],a[12:15]
T a[128:129],v24,16384
v_fma_f32 v43, v43, v34, v34
M v[156:159],a[136:139],a[108:111]
T a[130:131],v24,20480
M v[152:155],a[136:139],a[104:107]
buffer_load_dwordx4 a[84:87], v58, s[12:15], s63 offen offset:1024 sc1
M v[152:155],a[140:143],a[8:11]
v_exp_f32 v44, v44
M v[148:151],a[140:143],a[4:7]
T a[132:133],v24,24576
v_fma_f32 v44, v44, v34, v34
M v[148:151],a[136:139],a[100:103]
T a[134:135],v24,28672
M v[144:147],a[136:139],a[96:99]
buffer_load_dwordx4 a[88:91], v59, s[12:15], s63 offen offset:0 sc1
M v[144:147],a[140:143],a[0:3]
s_waitcnt lgkmcnt(8)
v_exp_f32 v45, v45
M v[160:163],a[144:147],a[96:99]
T a[136:137],v25,16384
v_fma_f32 v45, v45, v34, v34
M v[160:163],a[148:151],a[0:3]
T a[138:139],v25,20480
M v[164:167],a[148:151],a[4:7]
buffer_load_dwordx4 a[92:95], v59, s[12:15], s63 offen offset:1024 sc1
s_add_u32 s63, s63, 4096
M v[164:167],a[144:147],a[100:103]
v_exp_f32 v46, v46
M v[168:171],a[144:147],a[104:107]
T a[140:141],v25,24576
v_fma_f32 v46, v46, v34, v34
M v[168:171],a[148:151],a[8:11]
T a[142:143],v25,28672
M v[172:175],a[148:151],a[12:15]
buffer_load_dwordx4 a[240:243], v58, s[12:15], s63 offen offset:0 sc1
M v[172:175],a[144:147],a[108:111]
s_waitcnt lgkmcnt(8)
v_exp_f32 v47, v47
M v[188:191],a[156:159],a[12:15]
T a[144:145],v26,16384
v_fma_f32 v47, v47, v34, v34
M v[188:191],a[152:155],a[108:111]
T a[146:147],v26,20480
M v[184:187],a[152:155],a[104:107]
v_rcp_f32 v40, v40
M v[184:187],a[156:159],a[8:11]
v_rcp_f32 v41, v41
M v[180:183],a[156:159],a[4:7]
T a[148:149],v26,24576
v_mul_f32 v48, v40, v48
M v[180:183],a[152:155],a[100:103]
T a[150:151],v26,28672
v_mul_f32 v49, v41, v49
M v[176:179],a[152:155],a[96:99]
buffer_load_dwordx4 a[244:247], v58, s[12:15], s63 offen offset:1024 sc1
v_cvt_pk_bf16_f32 v48, v48, v49
M v[176:179],a[156:159],a[0:3]
s_waitcnt vmcnt(14)
v_accvgpr_write_b32 a224, v48
s_waitcnt lgkmcnt(8)
M v[64:67],a[128:131],a[16:19]
T a[152:153],v27,16384
v_accvgpr_read_b32 v48, a168
M v[64:67],a[132:135],a[32:35]
T a[154:155],v27,20480
v_mul_f32 v40, v48, v48
M v[68:71],a[132:135],a[36:39]
buffer_load_dwordx4 a[248:251], v59, s[12:15], s63 offen offset:0 sc1
v_fma_f32 v40, v40, v12, v39
M v[68:71],a[128:131],a[20:23]
v_rcp_f32 v42, v42
M v[72:75],a[128:131],a[24:27]
T a[156:157],v27,24576
v_mul_f32 v50, v42, v50
M v[72:75],a[132:135],a[40:43]
T a[158:159],v27,28672
v_mul_f32 v40, v40, v48
M v[76:79],a[132:135],a[44:47]
s_cmp_eq_u32 s56, 2
buffer_load_dwordx4 a[252:255], v59, s[12:15], s63 offen offset:1024 sc1
s_cselect_b32 s63, 7, 2
M v[76:79],a[128:131],a[28:31]
s_lshl_b32 s63, s63, 14
s_add_u32 s63, s63, s4
s_waitcnt lgkmcnt(8)
M v[92:95],a[140:143],a[44:47]
T a[128:129],v28,16384
M v[92:95],a[136:139],a[28:31]
T a[130:131],v28,20480
M v[88:91],a[136:139],a[24:27]
buffer_load_dwordx4 v[192:195], v58, s[12:15], s63 offen offset:0 sc1
M v[88:91],a[140:143],a[40:43]
v_rcp_f32 v43, v43
M v[84:87],a[140:143],a[36:39]
T a[132:133],v28,24576
v_mul_f32 v51, v43, v51
M v[84:87],a[136:139],a[20:23]
T a[134:135],v28,28672
v_cvt_pk_bf16_f32 v49, v50, v51
M v[80:83],a[136:139],a[16:19]
buffer_load_dwordx4 v[196:199], v58, s[12:15], s63 offen offset:1024 sc1
v_accvgpr_write_b32 a225, v49
M v[80:83],a[140:143],a[32:35]
s_waitcnt lgkmcnt(8)
v_rcp_f32 v44, v44
M v[96:99],a[144:147],a[16:19]
T a[136:137],v29,16384
v_mul_f32 v52, v44, v52
M v[96:99],a[148:151],a[32:35]
T a[138:139],v29,20480
v_accvgpr_read_b32 v49, a169
M v[100:103],a[148:151],a[36:39]
v_rcp_f32 v45, v45
M v[100:103],a[144:147],a[20:23]
v_rcp_f32 v46, v46
M v[104:107],a[144:147],a[24:27]
T a[140:141],v29,24576
v_mul_f32 v53, v45, v53
M v[104:107],a[148:151],a[40:43]
T a[142:143],v29,28672
v_mul_f32 v54, v46, v54
M v[108:111],a[148:151],a[44:47]
buffer_load_dwordx4 v[200:203], v59, s[12:15], s63 offen offset:0 sc1
v_cvt_pk_bf16_f32 v50, v52, v53
M v[108:111],a[144:147],a[28:31]
s_waitcnt lgkmcnt(8)
v_rcp_f32 v47, v47
M v[124:127],a[156:159],a[44:47]
T a[144:145],v30,16384
v_mul_f32 v55, v47, v55
M v[124:127],a[152:155],a[28:31]
T a[146:147],v30,20480
v_cvt_pk_bf16_f32 v51, v54, v55
M v[120:123],a[152:155],a[24:27]
buffer_load_dwordx4 v[204:207], v59, s[12:15], s63 offen offset:1024 sc1
s_add_u32 s63, s63, 4096
M v[120:123],a[156:159],a[40:43]
v_exp_f32 v40, v40
M v[116:119],a[156:159],a[36:39]
T a[148:149],v30,24576
v_accvgpr_write_b32 a226, v50
M v[116:119],a[152:155],a[20:23]
T a[150:151],v30,28672
v_accvgpr_write_b32 a227, v51
M v[112:115],a[152:155],a[16:19]
buffer_load_dwordx4 v[208:211], v58, s[12:15], s63 offen offset:0 sc1
v_accvgpr_read_b32 v50, a170
M v[112:115],a[156:159],a[32:35]
s_waitcnt lgkmcnt(8)
v_accvgpr_read_b32 v51, a171
v_accvgpr_read_b32 v52, a172
M v[128:131],a[128:131],a[16:19]
T a[152:153],v31,16384
v_accvgpr_read_b32 v53, a173
M v[128:131],a[132:135],a[32:35]
T a[154:155],v31,20480
v_accvgpr_read_b32 v54, a174
M v[132:135],a[132:135],a[36:39]
buffer_load_dwordx4 v[212:215], v58, s[12:15], s63 offen offset:1024 sc1
v_accvgpr_read_b32 v55, a175
M v[132:135],a[128:131],a[20:23]
v_mul_f32 v41, v49, v49
v_mul_f32 v42, v50, v50
M v[136:139],a[128:131],a[24:27]
T a[156:157],v31,24576
v_mul_f32 v43, v51, v51
M v[136:139],a[132:135],a[40:43]
T a[158:159],v31,28672
v_mul_f32 v44, v52, v52
M v[140:143],a[132:135],a[44:47]
buffer_load_dwordx4 v[216:219], v59, s[12:15], s63 offen offset:0 sc1
v_mul_f32 v45, v53, v53
M v[140:143],a[128:131],a[28:31]
s_waitcnt vmcnt(63)
s_barrier
s_waitcnt lgkmcnt(8)
M v[156:159],a[140:143],a[44:47]
T a[128:129],v24,32768
v_mul_f32 v46, v54, v54
M v[156:159],a[136:139],a[28:31]
T a[130:131],v24,36864
v_mul_f32 v47, v55, v55
M v[152:155],a[136:139],a[24:27]
v_fma_f32 v41, v41, v12, v39
v_fma_f32 v42, v42, v12, v39
M v[152:155],a[140:143],a[40:43]
v_fma_f32 v43, v43, v12, v39
v_fma_f32 v44, v44, v12, v39
M v[148:151],a[140:143],a[36:39]
T a[132:133],v24,40960
v_fma_f32 v45, v45, v12, v39
M v[148:151],a[136:139],a[20:23]
T a[134:135],v24,45056
v_fma_f32 v46, v46, v12, v39
M v[144:147],a[136:139],a[16:19]
buffer_load_dwordx4 v[220:223], v59, s[12:15], s63 offen offset:1024 sc1
s_add_u32 s63, s63, 4096
M v[144:147],a[140:143],a[32:35]
s_waitcnt lgkmcnt(8)
v_fma_f32 v47, v47, v12, v39
v_mul_f32 v41, v41, v49
M v[160:163],a[144:147],a[16:19]
T a[136:137],v25,32768
v_mul_f32 v42, v42, v50
M v[160:163],a[148:151],a[32:35]
T a[138:139],v25,36864
v_mul_f32 v43, v43, v51
M v[164:167],a[148:151],a[36:39]
buffer_load_dwordx4 a[192:195], v58, s[12:15], s63 offen offset:0 sc1
v_mul_f32 v44, v44, v52
M v[164:167],a[144:147],a[20:23]
v_exp_f32 v41, v41
M v[168:171],a[144:147],a[24:27]
T a[140:141],v25,40960
v_mul_f32 v45, v45, v53
M v[168:171],a[148:151],a[40:43]
T a[142:143],v25,45056
v_mul_f32 v46, v46, v54
M v[172:175],a[148:151],a[44:47]
buffer_load_dwordx4 a[196:199], v58, s[12:15], s63 offen offset:1024 sc1
v_mul_f32 v47, v47, v55
M v[172:175],a[144:147],a[28:31]
s_waitcnt lgkmcnt(8)
v_exp_f32 v42, v42
M v[188:191],a[156:159],a[44:47]
T a[144:145],v26,32768
v_fma_f32 v40, v40, v35, v35
M v[188:191],a[152:155],a[28:31]
T a[146:147],v26,36864
v_fma_f32 v41, v41, v35, v35
M v[184:187],a[152:155],a[24:27]
buffer_load_dwordx4 a[200:203], v59, s[12:15], s63 offen offset:0 sc1
v_fma_f32 v42, v42, v35, v35
M v[184:187],a[156:159],a[40:43]
v_exp_f32 v43, v43
M v[180:183],a[156:159],a[36:39]
T a[148:149],v26,40960
v_fma_f32 v43, v43, v35, v35
M v[180:183],a[152:155],a[20:23]
T a[150:151],v26,45056
M v[176:179],a[152:155],a[16:19]
buffer_load_dwordx4 a[204:207], v59, s[12:15], s63 offen offset:1024 sc1
s_add_u32 s63, s63, 4096
M v[176:179],a[156:159],a[32:35]
s_barrier
s_waitcnt vmcnt(20)
s_waitcnt lgkmcnt(8)
M v[64:67],a[128:131],a[48:51]
T a[152:153],v27,32768
M v[64:67],a[132:135],a[64:67]
T a[154:155],v27,36864
M v[68:71],a[132:135],a[68:71]
v_exp_f32 v44, v44
M v[68:71],a[128:131],a[52:55]
v_exp_f32 v45, v45
M v[72:75],a[128:131],a[56:59]
T a[156:157],v27,40960
v_fma_f32 v44, v44, v35, v35
M v[72:75],a[132:135],a[72:75]
T a[158:159],v27,45056
v_fma_f32 v45, v45, v35, v35
M v[76:79],a[132:135],a[76:79]
buffer_load_dwordx4 a[112:115], v58, s[12:15], s63 offen offset:0 sc1
M v[76:79],a[128:131],a[60:63]
s_waitcnt lgkmcnt(8)
v_exp_f32 v46, v46
M v[92:95],a[140:143],a[76:79]
T a[128:129],v28,32768
v_fma_f32 v46, v46, v35, v35
M v[92:95],a[136:139],a[60:63]
T a[130:131],v28,36864
M v[88:91],a[136:139],a[56:59]
buffer_load_dwordx4 a[116:119], v58, s[12:15], s63 offen offset:1024 sc1
M v[88:91],a[140:143],a[72:75]
v_exp_f32 v47, v47
M v[84:87],a[140:143],a[68:71]
T a[132:133],v28,40960
v_fma_f32 v47, v47, v35, v35
M v[84:87],a[136:139],a[52:55]
T a[134:135],v28,45056
M v[80:83],a[136:139],a[48:51]
buffer_load_dwordx4 a[120:123], v59, s[12:15], s63 offen offset:0 sc1
M v[80:83],a[140:143],a[64:67]
s_waitcnt lgkmcnt(8)
v_rcp_f32 v40, v40
M v[96:99],a[144:147],a[48:51]
T a[136:137],v29,32768
v_mul_f32 v48, v40, v48
M v[96:99],a[148:151],a[64:67]
T a[138:139],v29,36864
M v[100:103],a[148:151],a[68:71]
s_cmp_eq_u32 s56, 3
buffer_load_dwordx4 a[124:127], v59, s[12:15], s63 offen offset:1024 sc1
s_cselect_b32 s63, 7, 3
M v[100:103],a[144:147],a[52:55]
s_lshl_b32 s63, s63, 14
s_add_u32 s63, s63, s4
M v[104:107],a[144:147],a[56:59]
T a[140:141],v29,40960
M v[104:107],a[148:151],a[72:75]
T a[142:143],v29,45056
M v[108:111],a[148:151],a[76:79]
buffer_load_dwordx4 a[96:99], v58, s[12:15], s63 offen offset:0 sc1
M v[108:111],a[144:147],a[60:63]
s_waitcnt lgkmcnt(8)
v_rcp_f32 v41, v41
M v[124:127],a[156:159],a[76:79]
T a[144:145],v30,32768
v_mul_f32 v49, v41, v49
M v[124:127],a[152:155],a[60:63]
T a[146:147],v30,36864
v_cvt_pk_bf16_f32 v48, v48, v49
M v[120:123],a[152:155],a[56:59]
v_rcp_f32 v42, v42
M v[120:123],a[156:159],a[72:75]
v_rcp_f32 v43, v43
M v[116:119],a[156:159],a[68:71]
T a[148:149],v30,40960
v_mul_f32 v50, v42, v50
M v[116:119],a[152:155],a[52:55]
T a[150:151],v30,45056
v_mul_f32 v51, v43, v51
M v[112:115],a[152:155],a[48:51]
buffer_load_dwordx4 a[100:103], v58, s[12:15], s63 offen offset:1024 sc1
v_cvt_pk_bf16_f32 v49, v50, v51
M v[112:115],a[156:159],a[64:67]
s_waitcnt lgkmcnt(8)
v_rcp_f32 v44, v44
M v[128:131],a[128:131],a[48:51]
T a[152:153],v31,32768
v_mul_f32 v52, v44, v52
M v[128:131],a[132:135],a[64:67]
T a[154:155],v31,36864
v_accvgpr_write_b32 a228, v48
M v[132:135],a[132:135],a[68:71]
buffer_load_dwordx4 a[104:107], v59, s[12:15], s63 offen offset:0 sc1
v_accvgpr_write_b32 a229, v49
M v[132:135],a[128:131],a[52:55]
L_pad34:
s_cbranch_execz L_pb1
v_rcp_f32 v45, v45
M v[136:139],a[128:131],a[56:59]
T a[156:157],v31,40960
v_mul_f32 v53, v45, v53
M v[136:139],a[132:135],a[72:75]
T a[158:159],v31,45056
v_cvt_pk_bf16_f32 v50, v52, v53
M v[140:143],a[132:135],a[76:79]
buffer_load_dwordx4 a[108:111], v59, s[12:15], s63 offen offset:1024 sc1
s_add_u32 s63, s63, 4096
M v[140:143],a[128:131],a[60:63]
s_waitcnt lgkmcnt(8)
v_rcp_f32 v46, v46
M v[156:159],a[140:143],a[76:79]
T a[128:129],v24,49152
v_mul_f32 v54, v46, v54
M v[156:159],a[136:139],a[60:63]
T a[130:131],v24,53248
v_accvgpr_write_b32 a230, v50
M v[152:155],a[136:139],a[56:59]
buffer_load_dwordx4 a[0:3], v58, s[12:15], s63 offen offset:0 sc1
v_accvgpr_read_b32 v48, a176
M v[152:155],a[140:143],a[72:75]
v_rcp_f32 v47, v47
M v[148:151],a[140:143],a[68:71]
T a[132:133],v24,57344
v_mul_f32 v55, v47, v55
M v[148:151],a[136:139],a[52:55]
T a[134:135],v24,61440
v_cvt_pk_bf16_f32 v51, v54, v55
M v[144:147],a[136:139],a[48:51]
buffer_load_dwordx4 a[4:7], v58, s[12:15], s63 offen offset:1024 sc1
v_accvgpr_write_b32 a231, v51
M v[144:147],a[140:143],a[64:67]
s_waitcnt lgkmcnt(8)
v_accvgpr_read_b32 v49, a177
v_accvgpr_read_b32 v50, a178
M v[160:163],a[144:147],a[48:51]
T a[136:137],v25,49152
v_accvgpr_read_b32 v51, a179
M v[160:163],a[148:151],a[64:67]
T a[138:139],v25,53248
v_accvgpr_read_b32 v52, a180
M v[164:167],a[148:151],a[68:71]
v_accvgpr_read_b32 v53, a181
v_accvgpr_read_b32 v54, a182
M v[164:167],a[144:147],a[52:55]
v_accvgpr_read_b32 v55, a183
v_mul_f32 v40, v48, v48
M v[168:171],a[144:147],a[56:59]
T a[140:141],v25,57344
v_mul_f32 v41, v49, v49
M v[168:171],a[148:151],a[72:75]
T a[142:143],v25,61440
v_mul_f32 v42, v50, v50
M v[172:175],a[148:151],a[76:79]
buffer_load_dwordx4 a[8:11], v59, s[12:15], s63 offen offset:0 sc1
v_mul_f32 v43, v51, v51
M v[172:175],a[144:147],a[60:63]
s_waitcnt lgkmcnt(8)
v_mul_f32 v44, v52, v52
v_mul_f32 v45, v53, v53
M v[188:191],a[156:159],a[76:79]
T a[144:145],v26,49152
v_mul_f32 v46, v54, v54
M v[188:191],a[152:155],a[60:63]
T a[146:147],v26,53248
v_mul_f32 v47, v55, v55
M v[184:187],a[152:155],a[56:59]
buffer_load_dwordx4 a[12:15], v59, s[12:15], s63 offen offset:1024 sc1
s_add_u32 s63, s63, 4096
M v[184:187],a[156:159],a[72:75]
v_fma_f32 v40, v40, v9, v36
v_fma_f32 v41, v41, v9, v36
M v[180:183],a[156:159],a[68:71]
T a[148:149],v26,57344
v_fma_f32 v42, v42, v9, v36
M v[180:183],a[152:155],a[52:55]
s_add_u32 m0, s60, 131072
T a[150:151],v26,61440
v_fma_f32 v43, v43, v9, v36
M v[176:179],a[152:155],a[48:51]
buffer_load_dwordx4 v1, s[28:31], s62 offen offset:0 lds
v_fma_f32 v44, v44, v9, v36
M v[176:179],a[156:159],a[64:67]
s_waitcnt vmcnt(25)
v_fma_f32 v45, v45, v9, v36
s_waitcnt lgkmcnt(8)
M v[64:67],a[128:131],a[80:83]
T a[152:153],v27,49152
v_fma_f32 v46, v46, v9, v36
M v[64:67],a[132:135],a[240:243]
T a[154:155],v27,53248
v_fma_f32 v47, v47, v9, v36
M v[68:71],a[132:135],a[244:247]
buffer_load_dwordx4 v2, s[28:31], s62 offen offset:1024 lds
v_mul_f32 v40, v40, v48
M v[68:71],a[128:131],a[84:87]
v_exp_f32 v40, v40
M v[72:75],a[128:131],a[88:91]
T a[156:157],v27,57344
v_mul_f32 v41, v41, v49
M v[72:75],a[132:135],a[248:251]
T a[158:159],v27,61440
v_mul_f32 v42, v42, v50
M v[76:79],a[132:135],a[252:255]
buffer_load_dwordx4 v3, s[28:31], s62 offen offset:2048 lds
v_mul_f32 v43, v43, v51
M v[76:79],a[128:131],a[92:95]
s_waitcnt lgkmcnt(8)
v_exp_f32 v41, v41
M v[92:95],a[140:143],a[252:255]
T a[128:129],v28,49152
v_mul_f32 v44, v44, v52
M v[92:95],a[136:139],a[92:95]
T a[130:131],v28,53248
v_mul_f32 v45, v45, v53
M v[88:91],a[136:139],a[88:91]
v_exp_f32 v42, v42
M v[88:91],a[140:143],a[248:251]
v_exp_f32 v43, v43
M v[84:87],a[140:143],a[244:247]
T a[132:133],v28,57344
v_mul_f32 v46, v46, v54
M v[84:87],a[136:139],a[84:87]
T a[134:135],v28,61440
v_mul_f32 v47, v47, v55
M v[80:83],a[136:139],a[80:83]
buffer_load_dwordx4 v4, s[28:31], s62 offen offset:3072 lds
v_fma_f32 v40, v40, v32, v32
M v[80:83],a[140:143],a[240:243]
s_waitcnt lgkmcnt(8)
v_exp_f32 v44, v44
M v[96:99],a[144:147],a[80:83]
T a[136:137],v29,49152
v_fma_f32 v41, v41, v32, v32
M v[96:99],a[148:151],a[240:243]
s_add_u32 m0, s60, 135168
T a[138:139],v29,53248
v_fma_f32 v42, v42, v32, v32
M v[100:103],a[148:151],a[244:247]
buffer_load_dwordx4 v5, s[28:31], s62 offen offset:0 lds
v_fma_f32 v43, v43, v32, v32
M v[100:103],a[144:147],a[84:87]
v_exp_f32 v45, v45
M v[104:107],a[144:147],a[88:91]
T a[140:141],v29,57344
v_fma_f32 v44, v44, v32, v32
M v[104:107],a[148:151],a[248:251]
T a[142:143],v29,61440
v_fma_f32 v45, v45, v32, v32
M v[108:111],a[148:151],a[252:255]
buffer_load_dwordx4 v6, s[28:31], s62 offen offset:1024 lds
M v[108:111],a[144:147],a[92:95]
s_waitcnt lgkmcnt(8)
v_exp_f32 v46, v46
M v[124:127],a[156:159],a[252:255]
T a[144:145],v30,49152
v_fma_f32 v46, v46, v32, v32
M v[124:127],a[152:155],a[92:95]
T a[146:147],v30,53248
M v[120:123],a[152:155],a[88:91]
buffer_load_dwordx4 v7, s[28:31], s62 offen offset:2048 lds
M v[120:123],a[156:159],a[248:251]
v_exp_f32 v47, v47
M v[116:119],a[156:159],a[244:247]
T a[148:149],v30,57344
v_fma_f32 v47, v47, v32, v32
M v[116:119],a[152:155],a[84:87]
T a[150:151],v30,61440
M v[112:115],a[152:155],a[80:83]
s_cmp_eq_u32 s56, 5
buffer_load_dwordx4 v8, s[28:31], s62 offen offset:3072 lds
s_cselect_b32 s62, 7, 5
M v[112:115],a[156:159],a[240:243]
s_lshl_b32 s62, s62, 18
s_add_u32 s62, s62, s69
s_waitcnt lgkmcnt(8)
M v[128:131],a[128:131],a[80:83]
T a[152:153],v31,49152
M v[128:131],a[132:135],a[240:243]
T a[154:155],v31,53248
M v[132:135],a[132:135],a[244:247]
v_rcp_f32 v40, v40
M v[132:135],a[128:131],a[84:87]
v_rcp_f32 v41, v41
M v[136:139],a[128:131],a[88:91]
T a[156:157],v31,57344
v_mul_f32 v48, v40, v48
M v[136:139],a[132:135],a[248:251]
T a[158:159],v31,61440
v_mul_f32 v49, v41, v49
M v[140:143],a[132:135],a[252:255]
buffer_load_dwordx4 a[160:163], v58, s[12:15], s63 offen offset:0 sc1
v_cvt_pk_bf16_f32 v48, v48, v49
M v[140:143],a[128:131],a[92:95]
s_waitcnt vmcnt(63)
s_barrier
s_waitcnt lgkmcnt(8)
M v[156:159],a[140:143],a[252:255]
T a[128:129],v16,0
v_add_u32 v24, 131072, v24
M v[156:159],a[136:139],a[92:95]
T a[130:131],v16,4096
v_add_u32 v25, 131072, v25
M v[152:155],a[136:139],a[88:91]
buffer_load_dwordx4 a[164:167], v58, s[12:15], s63 offen offset:1024 sc1
v_add_u32 v26, 131072, v26
M v[152:155],a[140:143],a[248:251]
v_add_u32 v27, 131072, v27
v_add_u32 v28, 131072, v28
M v[148:151],a[140:143],a[244:247]
T a[132:133],v16,8192
v_add_u32 v29, 131072, v29
M v[148:151],a[136:139],a[84:87]
T a[134:135],v16,12288
v_add_u32 v30, 131072, v30
M v[144:147],a[136:139],a[80:83]
buffer_load_dwordx4 a[168:171], v59, s[12:15], s63 offen offset:0 sc1
v_add_u32 v31, 131072, v31
M v[144:147],a[140:143],a[240:243]
s_waitcnt lgkmcnt(8)
v_rcp_f32 v42, v42
M v[160:163],a[144:147],a[80:83]
T a[136:137],v17,0
v_mul_f32 v50, v42, v50
M v[160:163],a[148:151],a[240:243]
T a[138:139],v17,4096
v_accvgpr_write_b32 a232, v48
M v[164:167],a[148:151],a[244:247]
buffer_load_dwordx4 a[172:175], v59, s[12:15], s63 offen offset:1024 sc1
s_add_u32 s63, s63, 4096
M v[164:167],a[144:147],a[84:87]
v_rcp_f32 v43, v43
M v[168:171],a[144:147],a[88:91]
T a[140:141],v17,8192
v_mul_f32 v51, v43, v51
M v[168:171],a[148:151],a[248:251]
T a[142:143],v17,12288
v_cvt_pk_bf16_f32 v49, v50, v51
M v[172:175],a[148:151],a[252:255]
buffer_load_dwordx4 a[16:19], v58, s[12:15], s63 offen offset:0 sc1
v_accvgpr_write_b32 a233, v49
M v[172:175],a[144:147],a[92:95]
s_waitcnt lgkmcnt(8)
v_rcp_f32 v44, v44
M v[188:191],a[156:159],a[252:255]
T a[144:145],v18,0
v_mul_f32 v52, v44, v52
M v[188:191],a[152:155],a[92:95]
T a[146:147],v18,4096
v_accvgpr_read_b32 v48, a184
M v[184:187],a[152:155],a[88:91]
v_rcp_f32 v45, v45
M v[184:187],a[156:159],a[248:251]
v_rcp_f32 v46, v46
M v[180:183],a[156:159],a[244:247]
T a[148:149],v18,8192
v_mul_f32 v53, v45, v53
M v[180:183],a[152:155],a[84:87]
T a[150:151],v18,12288
v_mul_f32 v54, v46, v54
M v[176:179],a[152:155],a[80:83]
buffer_load_dwordx4 a[20:23], v58, s[12:15], s63 offen offset:1024 sc1
v_cvt_pk_bf16_f32 v50, v52, v53
M v[176:179],a[156:159],a[240:243]
v_accvgpr_write_b32 a234, v50
s_barrier
s_waitcnt vmcnt(30)
s_waitcnt lgkmcnt(8)
M v[64:67],a[128:131],v[192:195]
T a[152:153],v19,0
v_accvgpr_read_b32 v49, a185
M v[64:67],a[132:135],v[208:211]
T a[154:155],v19,4096
v_accvgpr_read_b32 v50, a186
M v[68:71],a[132:135],v[212:215]
buffer_load_dwordx4 a[24:27], v59, s[12:15], s63 offen offset:0 sc1
v_accvgpr_read_b32 v52, a188
M v[68:71],a[128:131],v[196:199]
v_rcp_f32 v47, v47
M v[72:75],a[128:131],v[200:203]
T a[156:157],v19,8192
v_mul_f32 v55, v47, v55
M v[72:75],a[132:135],v[216:219]
T a[158:159],v19,12288
v_cvt_pk_bf16_f32 v51, v54, v55
M v[76:79],a[132:135],v[220:223]
s_cmp_eq_u32 s56, 4
buffer_load_dwordx4 a[28:31], v59, s[12:15], s63 offen offset:1024 sc1
s_cselect_b32 s63, 7, 4
M v[76:79],a[128:131],v[204:207]
s_lshl_b32 s63, s63, 14
s_add_u32 s63, s63, s4
s_waitcnt lgkmcnt(8)
M v[92:95],a[140:143],v[220:223]
T a[128:129],v20,0
v_accvgpr_write_b32 a235, v51
M v[92:95],a[136:139],v[204:207]
T a[130:131],v20,4096
v_accvgpr_read_b32 v51, a187
M v[88:91],a[136:139],v[200:203]
buffer_load_dwordx4 a[32:35], v58, s[12:15], s63 offen offset:0 sc1
v_accvgpr_read_b32 v53, a189
M v[88:91],a[140:143],v[216:219]
v_accvgpr_read_b32 v54, a190
v_accvgpr_read_b32 v55, a191
M v[84:87],a[140:143],v[212:215]
T a[132:133],v20,8192
v_mul_f32 v40, v48, v48
M v[84:87],a[136:139],v[196:199]
T a[134:135],v20,12288
v_mul_f32 v41, v49, v49
M v[80:83],a[136:139],v[192:195]
buffer_load_dwordx4 a[36:39], v58, s[12:15], s63 offen offset:1024 sc1
v_mul_f32 v42, v50, v50
M v[80:83],a[140:143],v[208:211]
s_waitcnt lgkmcnt(8)
v_mul_f32 v43, v51, v51
v_mul_f32 v44, v52, v52
M v[96:99],a[144:147],v[192:195]
T a[136:137],v21,0
v_mul_f32 v45, v53, v53
M v[96:99],a[148:151],v[208:211]
T a[138:139],v21,4096
v_mul_f32 v46, v54, v54
M v[100:103],a[148:151],v[212:215]
v_mul_f32 v47, v55, v55
v_fma_f32 v40, v40, v10, v37
M v[100:103],a[144:147],v[196:199]
v_fma_f32 v41, v41, v10, v37
v_fma_f32 v42, v42, v10, v37
M v[104:107],a[144:147],v[200:203]
T a[140:141],v21,8192
v_fma_f32 v43, v43, v10, v37
M v[104:107],a[148:151],v[216:219]
T a[142:143],v21,12288
v_fma_f32 v44, v44, v10, v37
M v[108:111],a[148:151],v[220:223]
buffer_load_dwordx4 a[40:43], v59, s[12:15], s63 offen offset:0 sc1
v_fma_f32 v45, v45, v10, v37
M v[108:111],a[144:147],v[204:207]
s_waitcnt lgkmcnt(8)
v_fma_f32 v46, v46, v10, v37
v_fma_f32 v47, v47, v10, v37
M v[124:127],a[156:159],v[220:223]
T a[144:145],v22,0
v_mul_f32 v40, v40, v48
M v[124:127],a[152:155],v[204:207]
T a[146:147],v22,4096
v_mul_f32 v41, v41, v49
M v[120:123],a[152:155],v[200:203]
buffer_load_dwordx4 a[44:47], v59, s[12:15], s63 offen offset:1024 sc1
s_add_u32 s63, s63, 4096
M v[120:123],a[156:159],v[216:219]
v_exp_f32 v40, v40
M v[116:119],a[156:159],v[212:215]
T a[148:149],v22,8192
v_mul_f32 v42, v42, v50
M v[116:119],a[152:155],v[196:199]
T a[150:151],v22,12288
v_mul_f32 v43, v43, v51
M v[112:115],a[152:155],v[192:195]
buffer_load_dwordx4 a[48:51], v58, s[12:15], s63 offen offset:0 sc1
v_mul_f32 v44, v44, v52
M v[112:115],a[156:159],v[208:211]
s_waitcnt lgkmcnt(8)
v_exp_f32 v41, v41
M v[128:131],a[128:131],v[192:195]
T a[152:153],v23,0
v_mul_f32 v45, v45, v53
M v[128:131],a[132:135],v[208:211]
T a[154:155],v23,4096
v_mul_f32 v46, v46, v54
M v[132:135],a[132:135],v[212:215]
buffer_load_dwordx4 a[52:55], v58, s[12:15], s63 offen offset:1024 sc1
v_mul_f32 v47, v47, v55
M v[132:135],a[128:131],v[196:199]
v_exp_f32 v42, v42
M v[136:139],a[128:131],v[200:203]
T a[156:157],v23,8192
v_fma_f32 v40, v40, v33, v33
M v[136:139],a[132:135],v[216:219]
T a[158:159],v23,12288
v_fma_f32 v41, v41, v33, v33
M v[140:143],a[132:135],v[220:223]
buffer_load_dwordx4 a[56:59], v59, s[12:15], s63 offen offset:0 sc1
v_fma_f32 v42, v42, v33, v33
M v[140:143],a[128:131],v[204:207]
s_waitcnt lgkmcnt(8)
v_exp_f32 v43, v43
M v[156:159],a[140:143],v[220:223]
T a[128:129],v16,16384
v_fma_f32 v43, v43, v33, v33
M v[156:159],a[136:139],v[204:207]
T a[130:131],v16,20480
M v[152:155],a[136:139],v[200:203]
v_exp_f32 v44, v44
M v[152:155],a[140:143],v[216:219]
v_exp_f32 v45, v45
M v[148:151],a[140:143],v[212:215]
T a[132:133],v16,24576
v_fma_f32 v44, v44, v33, v33
M v[148:151],a[136:139],v[196:199]
T a[134:135],v16,28672
v_fma_f32 v45, v45, v33, v33
M v[144:147],a[136:139],v[192:195]
buffer_load_dwordx4 a[60:63], v59, s[12:15], s63 offen offset:1024 sc1
s_add_u32 s63, s63, 4096
M v[144:147],a[140:143],v[208:211]
s_waitcnt lgkmcnt(8)
v_exp_f32 v46, v46
M v[160:163],a[144:147],v[192:195]
T a[136:137],v17,16384
v_fma_f32 v46, v46, v33, v33
M v[160:163],a[148:151],v[208:211]
s_add_u32 m0, s60, 0
T a[138:139],v17,20480
M v[164:167],a[148:151],v[212:215]
buffer_load_dwordx4 v1, s[28:31], s62 offen offset:0 lds
M v[164:167],a[144:147],v[196:199]
v_exp_f32 v47, v47
M v[168:171],a[144:147],v[200:203]
T a[140:141],v17,24576
v_fma_f32 v47, v47, v33, v33
M v[168:171],a[148:151],v[216:219]
T a[142:143],v17,28672
M v[172:175],a[148:151],v[220:223]
buffer_load_dwordx4 v2, s[28:31], s62 offen offset:1024 lds
M v[172:175],a[144:147],v[204:207]
s_waitcnt lgkmcnt(8)
v_rcp_f32 v40, v40
M v[188:191],a[156:159],v[220:223]
T a[144:145],v18,16384
v_mul_f32 v48, v40, v48
M v[188:191],a[152:155],v[204:207]
T a[146:147],v18,20480
M v[184:187],a[152:155],v[200:203]
buffer_load_dwordx4 v3, s[28:31], s62 offen offset:2048 lds
M v[184:187],a[156:159],v[216:219]
v_rcp_f32 v41, v41
M v[180:183],a[156:159],v[212:215]
T a[148:149],v18,24576
v_mul_f32 v49, v41, v49
M v[180:183],a[152:155],v[196:199]
T a[150:151],v18,28672
v_cvt_pk_bf16_f32 v48, v48, v49
M v[176:179],a[152:155],v[192:195]
buffer_load_dwordx4 v4, s[28:31], s62 offen offset:3072 lds
v_accvgpr_write_b32 a236, v48
M v[176:179],a[156:159],v[208:211]
s_waitcnt vmcnt(36)
s_waitcnt lgkmcnt(8)
M v[64:67],a[128:131],a[192:195]
T a[152:153],v19,16384
M v[64:67],a[132:135],a[112:115]
T a[154:155],v19,20480
M v[68:71],a[132:135],a[116:119]
v_rcp_f32 v42, v42
M v[68:71],a[128:131],a[196:199]
v_rcp_f32 v43, v43
M v[72:75],a[128:131],a[200:203]
T a[156:157],v19,24576
v_mul_f32 v50, v42, v50
M v[72:75],a[132:135],a[120:123]
s_add_u32 m0, s60, 4096
T a[158:159],v19,28672
v_mul_f32 v51, v43, v51
M v[76:79],a[132:135],a[124:127]
buffer_load_dwordx4 v5, s[28:31], s62 offen offset:0 lds
v_cvt_pk_bf16_f32 v49, v50, v51
M v[76:79],a[128:131],a[204:207]
s_waitcnt lgkmcnt(8)
v_rcp_f32 v44, v44
M v[92:95],a[140:143],a[124:127]
T a[128:129],v20,16384
v_mul_f32 v52, v44, v52
M v[92:95],a[136:139],a[204:207]
T a[130:131],v20,20480
v_accvgpr_write_b32 a237, v49
M v[88:91],a[136:139],a[200:203]
buffer_load_dwordx4 v6, s[28:31], s62 offen offset:1024 lds
M v[88:91],a[140:143],a[120:123]
v_rcp_f32 v45, v45
M v[84:87],a[140:143],a[116:119]
T a[132:133],v20,24576
v_mul_f32 v53, v45, v53
M v[84:87],a[136:139],a[196:199]
T a[134:135],v20,28672
v_cvt_pk_bf16_f32 v50, v52, v53
M v[80:83],a[136:139],a[192:195]
buffer_load_dwordx4 v7, s[28:31], s62 offen offset:2048 lds
v_accvgpr_write_b32 a238, v50
M v[80:83],a[140:143],a[112:115]
s_waitcnt lgkmcnt(8)
v_rcp_f32 v46, v46
M v[96:99],a[144:147],a[192:195]
T a[136:137],v21,16384
v_mul_f32 v54, v46, v54
M v[96:99],a[148:151],a[112:115]
T a[138:139],v21,20480
M v[100:103],a[148:151],a[116:119]
s_cmp_eq_u32 s56, 6
buffer_load_dwordx4 v8, s[28:31], s62 offen offset:3072 lds
s_cselect_b32 s62, 7, 6
M v[100:103],a[144:147],a[196:199]
s_lshl_b32 s62, s62, 18
s_add_u32 s62, s62, s69
M v[104:107],a[144:147],a[200:203]
T a[140:141],v21,24576
M v[104:107],a[148:151],a[120:123]
T a[142:143],v21,28672
M v[108:111],a[148:151],a[124:127]
buffer_load_dwordx4 a[64:67], v58, s[12:15], s63 offen offset:0 sc1
M v[108:111],a[144:147],a[204:207]
s_waitcnt lgkmcnt(8)
v_rcp_f32 v47, v47
M v[124:127],a[156:159],a[124:127]
T a[144:145],v22,16384
v_mul_f32 v55, v47, v55
M v[124:127],a[152:155],a[204:207]
T a[146:147],v22,20480
v_cvt_pk_bf16_f32 v51, v54, v55
M v[120:123],a[152:155],a[200:203]
v_accvgpr_write_b32 a239, v51
M v[120:123],a[156:159],a[120:123]
M v[116:119],a[156:159],a[116:119]
T a[148:149],v22,24576
M v[116:119],a[152:155],a[196:199]
T a[150:151],v22,28672
M v[112:115],a[152:155],a[192:195]
buffer_load_dwordx4 a[68:71], v58, s[12:15], s63 offen offset:1024 sc1
M v[112:115],a[156:159],a[112:115]
s_waitcnt lgkmcnt(8)
M v[128:131],a[128:131],a[192:195]
T a[152:153],v23,16384
M v[128:131],a[132:135],a[112:115]
T a[154:155],v23,20480
M v[132:135],a[132:135],a[116:119]
buffer_load_dwordx4 a[72:75], v59, s[12:15], s63 offen offset:0 sc1
M v[132:135],a[128:131],a[196:199]
M v[136:139],a[128:131],a[200:203]
T a[156:157],v23,24576
M v[136:139],a[132:135],a[120:123]
T a[158:159],v23,28672
M v[140:143],a[132:135],a[124:127]
buffer_load_dwordx4 a[76:79], v59, s[12:15], s63 offen offset:1024 sc1
s_add_u32 s63, s63, 4096
M v[140:143],a[128:131],a[204:207]
s_waitcnt vmcnt(63)
s_barrier
s_waitcnt lgkmcnt(8)
M v[156:159],a[140:143],a[124:127]
T a[128:129],v16,32768
M v[156:159],a[136:139],a[204:207]
T a[130:131],v16,36864
M v[152:155],a[136:139],a[200:203]
buffer_load_dwordx4 a[80:83], v58, s[12:15], s63 offen offset:0 sc1
M v[152:155],a[140:143],a[120:123]
M v[148:151],a[140:143],a[116:119]
T a[132:133],v16,40960
M v[148:151],a[136:139],a[196:199]
T a[134:135],v16,45056
M v[144:147],a[136:139],a[192:195]
buffer_load_dwordx4 a[84:87], v58, s[12:15], s63 offen offset:1024 sc1
M v[144:147],a[140:143],a[112:115]
s_waitcnt lgkmcnt(8)
M v[160:163],a[144:147],a[192:195]
T a[136:137],v17,32768
M v[160:163],a[148:151],a[112:115]
T a[138:139],v17,36864
M v[164:167],a[148:151],a[116:119]
M v[164:167],a[144:147],a[196:199]
L_pad35:
s_cbranch_execz L_pb1
M v[168:171],a[144:147],a[200:203]
T a[140:141],v17,40960
M v[168:171],a[148:151],a[120:123]
T a[142:143],v17,45056
M v[172:175],a[148:151],a[124:127]
buffer_load_dwordx4 a[88:91], v59, s[12:15], s63 offen offset:0 sc1
M v[172:175],a[144:147],a[204:207]
s_waitcnt lgkmcnt(8)
M v[188:191],a[156:159],a[124:127]
T a[144:145],v18,32768
M v[188:191],a[152:155],a[204:207]
T a[146:147],v18,36864
M v[184:187],a[152:155],a[200:203]
s_cmp_eq_u32 s56, 5
buffer_load_dwordx4 a[92:95], v59, s[12:15], s63 offen offset:1024 sc1
s_cselect_b32 s63, 7, 5
M v[184:187],a[156:159],a[120:123]
s_lshl_b32 s63, s63, 14
s_add_u32 s63, s63, s4
M v[180:183],a[156:159],a[116:119]
T a[148:149],v18,40960
M v[180:183],a[152:155],a[196:199]
T a[150:151],v18,45056
M v[176:179],a[152:155],a[192:195]
buffer_load_dwordx4 a[240:243], v58, s[12:15], s63 offen offset:0 sc1
M v[176:179],a[156:159],a[112:115]
s_barrier
s_waitcnt vmcnt(41)
s_waitcnt lgkmcnt(8)
M v[64:67],a[128:131],a[96:99]
T a[152:153],v19,32768
M v[64:67],a[132:135],a[0:3]
T a[154:155],v19,36864
M v[68:71],a[132:135],a[4:7]
buffer_load_dwordx4 a[244:247], v58, s[12:15], s63 offen offset:1024 sc1
M v[68:71],a[128:131],a[100:103]
M v[72:75],a[128:131],a[104:107]
T a[156:157],v19,40960
buffer_store_dwordx4 a[208:211], v59, s[12:15], s57 offen offset:0 sc1
M v[72:75],a[132:135],a[8:11]
T a[158:159],v19,45056
M v[76:79],a[132:135],a[12:15]
M v[76:79],a[128:131],a[108:111]
s_waitcnt lgkmcnt(8)
M v[92:95],a[140:143],a[12:15]
T a[128:129],v20,32768
M v[92:95],a[136:139],a[108:111]
T a[130:131],v20,36864
M v[88:91],a[136:139],a[104:107]
M v[88:91],a[140:143],a[8:11]
M v[84:87],a[140:143],a[4:7]
T a[132:133],v20,40960
buffer_store_dwordx4 a[212:215], v59, s[12:15], s57 offen offset:1024 sc1
M v[84:87],a[136:139],a[100:103]
s_add_u32 s57, s57, 4096
T a[134:135],v20,45056
M v[80:83],a[136:139],a[96:99]
M v[80:83],a[140:143],a[0:3]
s_waitcnt lgkmcnt(8)
M v[96:99],a[144:147],a[96:99]
T a[136:137],v21,32768
M v[96:99],a[148:151],a[0:3]
T a[138:139],v21,36864
M v[100:103],a[148:151],a[4:7]
M v[100:103],a[144:147],a[100:103]
M v[104:107],a[144:147],a[104:107]
T a[140:141],v21,40960
M v[104:107],a[148:151],a[8:11]
T a[142:143],v21,45056
buffer_store_dwordx4 a[216:219], v58, s[12:15], s57 offen offset:0 sc1
M v[108:111],a[148:151],a[12:15]
M v[108:111],a[144:147],a[108:111]
s_waitcnt lgkmcnt(8)
M v[124:127],a[156:159],a[12:15]
T a[144:145],v22,32768
M v[124:127],a[152:155],a[108:111]
T a[146:147],v22,36864
M v[120:123],a[152:155],a[104:107]
M v[120:123],a[156:159],a[8:11]
M v[116:119],a[156:159],a[4:7]
T a[148:149],v22,40960
M v[116:119],a[152:155],a[100:103]
T a[150:151],v22,45056
M v[112:115],a[152:155],a[96:99]
buffer_store_dwordx4 a[220:223], v58, s[12:15], s57 offen offset:1024 sc1
M v[112:115],a[156:159],a[0:3]
s_waitcnt lgkmcnt(8)
M v[128:131],a[128:131],a[96:99]
T a[152:153],v23,32768
M v[128:131],a[132:135],a[0:3]
T a[154:155],v23,36864
M v[132:135],a[132:135],a[4:7]
M v[132:135],a[128:131],a[100:103]
M v[136:139],a[128:131],a[104:107]
T a[156:157],v23,40960
M v[136:139],a[132:135],a[8:11]
T a[158:159],v23,45056
M v[140:143],a[132:135],a[12:15]
M v[140:143],a[128:131],a[108:111]
buffer_store_dwordx4 a[224:227], v59, s[12:15], s57 offen offset:0 sc1
s_waitcnt lgkmcnt(8)
M v[156:159],a[140:143],a[12:15]
T a[128:129],v16,49152
M v[156:159],a[136:139],a[108:111]
T a[130:131],v16,53248
M v[152:155],a[136:139],a[104:107]
M v[152:155],a[140:143],a[8:11]
M v[148:151],a[140:143],a[4:7]
T a[132:133],v16,57344
M v[148:151],a[136:139],a[100:103]
T a[134:135],v16,61440
M v[144:147],a[136:139],a[96:99]
M v[144:147],a[140:143],a[0:3]
s_waitcnt lgkmcnt(8)
M v[160:163],a[144:147],a[96:99]
T a[136:137],v17,49152
buffer_store_dwordx4 a[228:231], v59, s[12:15], s57 offen offset:1024 sc1
M v[160:163],a[148:151],a[0:3]
s_mov_b32 s57, s53
T a[138:139],v17,53248
M v[164:167],a[148:151],a[4:7]
M v[164:167],a[144:147],a[100:103]
M v[168:171],a[144:147],a[104:107]
T a[140:141],v17,57344
M v[168:171],a[148:151],a[8:11]
T a[142:143],v17,61440
M v[172:175],a[148:151],a[12:15]
M v[172:175],a[144:147],a[108:111]
s_waitcnt lgkmcnt(8)
M v[188:191],a[156:159],a[12:15]
T a[144:145],v18,49152
M v[188:191],a[152:155],a[108:111]
T a[146:147],v18,53248
buffer_store_dwordx4 a[232:235], v58, s[12:15], s57 offen offset:0 sc1
M v[184:187],a[152:155],a[104:107]
M v[184:187],a[156:159],a[8:11]
M v[180:183],a[156:159],a[4:7]
T a[148:149],v18,57344
M v[180:183],a[152:155],a[100:103]
T a[150:151],v18,61440
M v[176:179],a[152:155],a[96:99]
M v[176:179],a[156:159],a[0:3]
s_waitcnt vmcnt(33)
s_waitcnt lgkmcnt(8)
M v[64:67],a[128:131],a[160:163]
T a[152:153],v19,49152
M v[64:67],a[132:135],a[16:19]
T a[154:155],v19,53248
M v[68:71],a[132:135],a[20:23]
buffer_store_dwordx4 a[236:239], v58, s[12:15], s57 offen offset:1024 sc1
M v[68:71],a[128:131],a[164:167]
M v[72:75],a[128:131],a[168:171]
T a[156:157],v19,57344
M v[72:75],a[132:135],a[24:27]
T a[158:159],v19,61440
M v[76:79],a[132:135],a[28:31]
M v[76:79],a[128:131],a[172:175]
s_waitcnt lgkmcnt(8)
M v[92:95],a[140:143],a[28:31]
T a[128:129],v20,49152
M v[92:95],a[136:139],a[172:175]
T a[130:131],v20,53248
M v[88:91],a[136:139],a[168:171]
M v[88:91],a[140:143],a[24:27]
M v[84:87],a[140:143],a[20:23]
T a[132:133],v20,57344
M v[84:87],a[136:139],a[164:167]
T a[134:135],v20,61440
M v[80:83],a[136:139],a[160:163]
buffer_load_dwordx4 a[248:251], v59, s[12:15], s63 offen offset:0 sc1
M v[80:83],a[140:143],a[16:19]
s_waitcnt lgkmcnt(8)
M v[96:99],a[144:147],a[160:163]
T a[136:137],v21,49152
M v[96:99],a[148:151],a[16:19]
T a[138:139],v21,53248
M v[100:103],a[148:151],a[20:23]
M v[100:103],a[144:147],a[164:167]
M v[104:107],a[144:147],a[168:171]
T a[140:141],v21,57344
M v[104:107],a[148:151],a[24:27]
T a[142:143],v21,61440
M v[108:111],a[148:151],a[28:31]
buffer_load_dwordx4 a[252:255], v59, s[12:15], s63 offen offset:1024 sc1
s_add_u32 s63, s63, 4096
M v[108:111],a[144:147],a[172:175]
s_waitcnt lgkmcnt(8)
M v[124:127],a[156:159],a[28:31]
T a[144:145],v22,49152
M v[124:127],a[152:155],a[172:175]
T a[146:147],v22,53248
M v[120:123],a[152:155],a[168:171]
buffer_load_dwordx4 a[176:179], v58, s[12:15], s63 offen offset:0 sc1
M v[120:123],a[156:159],a[24:27]
M v[116:119],a[156:159],a[20:23]
T a[148:149],v22,57344
M v[116:119],a[152:155],a[164:167]
T a[150:151],v22,61440
M v[112:115],a[152:155],a[160:163]
buffer_load_dwordx4 a[180:183], v58, s[12:15], s63 offen offset:1024 sc1
M v[112:115],a[156:159],a[16:19]
s_waitcnt lgkmcnt(8)
M v[128:131],a[128:131],a[160:163]
T a[152:153],v23,49152
M v[128:131],a[132:135],a[16:19]
T a[154:155],v23,53248
M v[132:135],a[132:135],a[20:23]
buffer_load_dwordx4 a[184:187], v59, s[12:15], s63 offen offset:0 sc1
M v[132:135],a[128:131],a[164:167]
M v[136:139],a[128:131],a[168:171]
T a[156:157],v23,57344
M v[136:139],a[132:135],a[24:27]
T a[158:159],v23,61440
M v[140:143],a[132:135],a[28:31]
buffer_load_dwordx4 a[188:191], v59, s[12:15], s63 offen offset:1024 sc1
s_add_u32 s63, s63, 4096
M v[140:143],a[128:131],a[172:175]
s_waitcnt vmcnt(48)
s_barrier
s_waitcnt lgkmcnt(8)
M v[156:159],a[140:143],a[28:31]
T a[128:129],v24,0
v_subrev_u32 v16, 65536, v16
M v[156:159],a[136:139],a[172:175]
T a[130:131],v24,4096
v_subrev_u32 v17, 65536, v17
M v[152:155],a[136:139],a[168:171]
v_subrev_u32 v18, 65536, v18
v_subrev_u32 v19, 65536, v19
M v[152:155],a[140:143],a[24:27]
v_subrev_u32 v20, 65536, v20
v_subrev_u32 v21, 65536, v21
M v[148:151],a[140:143],a[20:23]
T a[132:133],v24,8192
v_subrev_u32 v22, 65536, v22
M v[148:151],a[136:139],a[164:167]
s_add_u32 m0, s60, 32768
T a[134:135],v24,12288
v_subrev_u32 v23, 65536, v23
M v[144:147],a[136:139],a[160:163]
buffer_load_dwordx4 v1, s[28:31], s62 offen offset:0 lds
M v[144:147],a[140:143],a[16:19]
s_waitcnt lgkmcnt(8)
M v[160:163],a[144:147],a[160:163]
T a[136:137],v25,0
M v[160:163],a[148:151],a[16:19]
T a[138:139],v25,4096
M v[164:167],a[148:151],a[20:23]
buffer_load_dwordx4 v2, s[28:31], s62 offen offset:1024 lds
M v[164:167],a[144:147],a[164:167]
M v[168:171],a[144:147],a[168:171]
T a[140:141],v25,8192
M v[168:171],a[148:151],a[24:27]
T a[142:143],v25,12288
M v[172:175],a[148:151],a[28:31]
M v[172:175],a[144:147],a[172:175]
s_waitcnt lgkmcnt(8)
M v[188:191],a[156:159],a[28:31]
T a[144:145],v26,0
M v[188:191],a[152:155],a[172:175]
T a[146:147],v26,4096
M v[184:187],a[152:155],a[168:171]
M v[184:187],a[156:159],a[24:27]
M v[180:183],a[156:159],a[20:23]
T a[148:149],v26,8192
M v[180:183],a[152:155],a[164:167]
T a[150:151],v26,12288
M v[176:179],a[152:155],a[160:163]
M v[176:179],a[156:159],a[16:19]
s_barrier
s_waitcnt vmcnt(34)
s_waitcnt lgkmcnt(8)
M v[64:67],a[128:131],a[32:35]
T a[152:153],v27,0
M v[64:67],a[132:135],a[48:51]
T a[154:155],v27,4096
M v[68:71],a[132:135],a[52:55]
M v[68:71],a[128:131],a[36:39]
M v[72:75],a[128:131],a[40:43]
T a[156:157],v27,8192
M v[72:75],a[132:135],a[56:59]
T a[158:159],v27,12288
M v[76:79],a[132:135],a[60:63]
M v[76:79],a[128:131],a[44:47]
s_waitcnt lgkmcnt(8)
M v[92:95],a[140:143],a[60:63]
T a[128:129],v28,0
M v[92:95],a[136:139],a[44:47]
T a[130:131],v28,4096
M v[88:91],a[136:139],a[40:43]
M v[88:91],a[140:143],a[56:59]
M v[84:87],a[140:143],a[52:55]
T a[132:133],v28,8192
M v[84:87],a[136:139],a[36:39]
T a[134:135],v28,12288
M v[80:83],a[136:139],a[32:35]
M v[80:83],a[140:143],a[48:51]
s_waitcnt lgkmcnt(8)
M v[96:99],a[144:147],a[32:35]
T a[136:137],v29,0
M v[96:99],a[148:151],a[48:51]
T a[138:139],v29,4096
M v[100:103],a[148:151],a[52:55]
M v[100:103],a[144:147],a[36:39]
M v[104:107],a[144:147],a[40:43]
T a[140:141],v29,8192
M v[104:107],a[148:151],a[56:59]
T a[142:143],v29,12288
M v[108:111],a[148:151],a[60:63]
M v[108:111],a[144:147],a[44:47]
s_waitcnt lgkmcnt(8)
M v[124:127],a[156:159],a[60:63]
T a[144:145],v30,0
M v[124:127],a[152:155],a[44:47]
T a[146:147],v30,4096
M v[120:123],a[152:155],a[40:43]
M v[120:123],a[156:159],a[56:59]
M v[116:119],a[156:159],a[52:55]
T a[148:149],v30,8192
M v[116:119],a[152:155],a[36:39]
T a[150:151],v30,12288
M v[112:115],a[152:155],a[32:35]
M v[112:115],a[156:159],a[48:51]
s_waitcnt lgkmcnt(8)
M v[128:131],a[128:131],a[32:35]
T a[152:153],v31,0
M v[128:131],a[132:135],a[48:51]
T a[154:155],v31,4096
M v[132:135],a[132:135],a[52:55]
M v[132:135],a[128:131],a[36:39]
M v[136:139],a[128:131],a[40:43]
T a[156:157],v31,8192
M v[136:139],a[132:135],a[56:59]
T a[158:159],v31,12288
M v[140:143],a[132:135],a[60:63]
M v[140:143],a[128:131],a[44:47]
s_waitcnt lgkmcnt(8)
M v[156:159],a[140:143],a[60:63]
T a[128:129],v24,16384
M v[156:159],a[136:139],a[44:47]
T a[130:131],v24,20480
M v[152:155],a[136:139],a[40:43]
buffer_load_dwordx4 v3, s[28:31], s62 offen offset:2048 lds
M v[152:155],a[140:143],a[56:59]
M v[148:151],a[140:143],a[52:55]
T a[132:133],v24,24576
M v[148:151],a[136:139],a[36:39]
T a[134:135],v24,28672
M v[144:147],a[136:139],a[32:35]
buffer_load_dwordx4 v4, s[28:31], s62 offen offset:3072 lds
M v[144:147],a[140:143],a[48:51]
s_waitcnt lgkmcnt(8)
M v[160:163],a[144:147],a[32:35]
T a[136:137],v25,16384
M v[160:163],a[148:151],a[48:51]
T a[138:139],v25,20480
M v[164:167],a[148:151],a[52:55]
M v[164:167],a[144:147],a[36:39]
M v[168:171],a[144:147],a[40:43]
T a[140:141],v25,24576
M v[168:171],a[148:151],a[56:59]
s_add_u32 m0, s60, 36864
T a[142:143],v25,28672
M v[172:175],a[148:151],a[60:63]
buffer_load_dwordx4 v5, s[28:31], s62 offen offset:0 lds
M v[172:175],a[144:147],a[44:47]
s_waitcnt lgkmcnt(8)
M v[188:191],a[156:159],a[60:63]
T a[144:145],v26,16384
M v[188:191],a[152:155],a[44:47]
T a[146:147],v26,20480
M v[184:187],a[152:155],a[40:43]
buffer_load_dwordx4 v6, s[28:31], s62 offen offset:1024 lds
M v[184:187],a[156:159],a[56:59]
M v[180:183],a[156:159],a[52:55]
T a[148:149],v26,24576
M v[180:183],a[152:155],a[36:39]
T a[150:151],v26,28672
M v[176:179],a[152:155],a[32:35]
buffer_load_dwordx4 v7, s[28:31], s62 offen offset:2048 lds
M v[176:179],a[156:159],a[48:51]
s_waitcnt vmcnt(23)
s_waitcnt lgkmcnt(8)
M v[64:67],a[128:131],a[64:67]
T a[152:153],v27,16384
M v[64:67],a[132:135],a[80:83]
s_add_u32 s73, s64, 3
T a[154:155],v27,20480
M v[68:71],a[132:135],a[84:87]
buffer_load_dword v62, v14, s[12:15], s6 offen sc1
M v[68:71],a[128:131],a[68:71]
M v[72:75],a[128:131],a[72:75]
T a[156:157],v27,24576
M v[72:75],a[132:135],a[88:91]
T a[158:159],v27,28672
M v[76:79],a[132:135],a[92:95]
buffer_load_dwordx4 v8, s[28:31], s62 offen offset:3072 lds
s_add_u32 s62, s69, 2097152
M v[76:79],a[128:131],a[76:79]
s_waitcnt lgkmcnt(8)
M v[92:95],a[140:143],a[92:95]
T a[128:129],v28,16384
M v[92:95],a[136:139],a[76:79]
T a[130:131],v28,20480
M v[88:91],a[136:139],a[72:75]
M v[88:91],a[140:143],a[88:91]
M v[84:87],a[140:143],a[84:87]
T a[132:133],v28,24576
M v[84:87],a[136:139],a[68:71]
T a[134:135],v28,28672
M v[80:83],a[136:139],a[64:67]
buffer_load_dwordx4 v[192:195], v58, s[12:15], s63 offen offset:0 sc1
M v[80:83],a[140:143],a[80:83]
s_waitcnt lgkmcnt(8)
M v[96:99],a[144:147],a[64:67]
T a[136:137],v29,16384
M v[96:99],a[148:151],a[80:83]
T a[138:139],v29,20480
M v[100:103],a[148:151],a[84:87]
buffer_load_dwordx4 v[196:199], v58, s[12:15], s63 offen offset:1024 sc1
M v[100:103],a[144:147],a[68:71]
M v[104:107],a[144:147],a[72:75]
T a[140:141],v29,24576
M v[104:107],a[148:151],a[88:91]
T a[142:143],v29,28672
M v[108:111],a[148:151],a[92:95]
buffer_load_dwordx4 v[200:203], v59, s[12:15], s63 offen offset:0 sc1
M v[108:111],a[144:147],a[76:79]
s_waitcnt lgkmcnt(8)
M v[124:127],a[156:159],a[92:95]
T a[144:145],v30,16384
M v[124:127],a[152:155],a[76:79]
T a[146:147],v30,20480
M v[120:123],a[152:155],a[72:75]
buffer_load_dwordx4 v[204:207], v59, s[12:15], s63 offen offset:1024 sc1
s_add_u32 s63, s63, 4096
M v[120:123],a[156:159],a[88:91]
M v[116:119],a[156:159],a[84:87]
T a[148:149],v30,24576
M v[116:119],a[152:155],a[68:71]
T a[150:151],v30,28672
M v[112:115],a[152:155],a[64:67]
buffer_load_dwordx4 v[208:211], v58, s[12:15], s63 offen offset:0 sc1
M v[112:115],a[156:159],a[80:83]
s_waitcnt lgkmcnt(8)
M v[128:131],a[128:131],a[64:67]
T a[152:153],v31,16384
M v[128:131],a[132:135],a[80:83]
T a[154:155],v31,20480
M v[132:135],a[132:135],a[84:87]
buffer_load_dwordx4 v[212:215], v58, s[12:15], s63 offen offset:1024 sc1
M v[132:135],a[128:131],a[68:71]
M v[136:139],a[128:131],a[72:75]
T a[156:157],v31,24576
M v[136:139],a[132:135],a[88:91]
T a[158:159],v31,28672
M v[140:143],a[132:135],a[92:95]
buffer_load_dwordx4 v[216:219], v59, s[12:15], s63 offen offset:0 sc1
M v[140:143],a[128:131],a[76:79]
s_waitcnt vmcnt(22)
s_barrier
s_waitcnt lgkmcnt(8)
M v[156:159],a[140:143],a[92:95]
s_add_u32 s74, s64, 4
T a[128:129],v16,0
v_subrev_u32 v24, 65536, v24
M v[156:159],a[136:139],a[76:79]
T a[130:131],v16,4096
v_subrev_u32 v25, 65536, v25
M v[152:155],a[136:139],a[72:75]
s_cmp_eq_u32 s56, 6
buffer_load_dwordx4 v[220:223], v59, s[12:15], s63 offen offset:1024 sc1
s_cselect_b32 s63, 7, 6
M v[152:155],a[140:143],a[88:91]
s_lshl_b32 s63, s63, 14
v_subrev_u32 v26, 65536, v26
v_subrev_u32 v27, 65536, v27
M v[148:151],a[140:143],a[84:87]
s_add_u32 s63, s63, s4
T a[132:133],v16,8192
v_subrev_u32 v28, 65536, v28
M v[148:151],a[136:139],a[68:71]
T a[134:135],v16,12288
v_subrev_u32 v29, 65536, v29
M v[144:147],a[136:139],a[64:67]
buffer_load_dwordx4 a[192:195], v58, s[12:15], s63 offen offset:0 sc1
v_subrev_u32 v30, 65536, v30
M v[144:147],a[140:143],a[80:83]
s_waitcnt lgkmcnt(8)
v_subrev_u32 v31, 65536, v31
v_mov_b32 v61, s74
M v[160:163],a[144:147],a[64:67]
T a[136:137],v17,0
buffer_store_dword v61, v60, s[12:15], s65 offen sc1
M v[160:163],a[148:151],a[80:83]
T a[138:139],v17,4096
M v[164:167],a[148:151],a[84:87]
buffer_load_dwordx4 a[196:199], v58, s[12:15], s63 offen offset:1024 sc1
M v[164:167],a[144:147],a[68:71]
M v[168:171],a[144:147],a[72:75]
T a[140:141],v17,8192
M v[168:171],a[148:151],a[88:91]
T a[142:143],v17,12288
M v[172:175],a[148:151],a[92:95]
buffer_load_dwordx4 a[200:203], v59, s[12:15], s63 offen offset:0 sc1
M v[172:175],a[144:147],a[76:79]
s_waitcnt lgkmcnt(8)
M v[188:191],a[156:159],a[92:95]
T a[144:145],v18,0
M v[188:191],a[152:155],a[76:79]
T a[146:147],v18,4096
M v[184:187],a[152:155],a[72:75]
M v[184:187],a[156:159],a[88:91]
M v[180:183],a[156:159],a[84:87]
T a[148:149],v18,8192
M v[180:183],a[152:155],a[68:71]
T a[150:151],v18,12288
M v[176:179],a[152:155],a[64:67]
buffer_load_dwordx4 a[204:207], v59, s[12:15], s63 offen offset:1024 sc1
s_add_u32 s63, s63, 4096
M v[176:179],a[156:159],a[80:83]
s_barrier
s_waitcnt vmcnt(22)
s_waitcnt lgkmcnt(8)
M v[64:67],a[128:131],a[240:243]
s_waitcnt vmcnt(14)
T a[152:153],v19,0
v_subrev_u32 v62, s73, v62
M v[64:67],a[132:135],a[176:179]
T a[154:155],v19,4096
v_cmp_le_u32 vcc, 13, v62
M v[68:71],a[132:135],a[180:183]
s_cbranch_vccnz SPIN_n
BACK_n:
buffer_load_dwordx4 a[112:115], v58, s[12:15], s63 offen offset:0 sc1
M v[68:71],a[128:131],a[244:247]
M v[72:75],a[128:131],a[248:251]
T a[156:157],v19,8192
M v[72:75],a[132:135],a[184:187]
T a[158:159],v19,12288
M v[76:79],a[132:135],a[188:191]
buffer_load_dwordx4 a[116:119], v58, s[12:15], s63 offen offset:1024 sc1
M v[76:79],a[128:131],a[252:255]
s_waitcnt lgkmcnt(8)
M v[92:95],a[140:143],a[188:191]
T a[128:129],v20,0
M v[92:95],a[136:139],a[252:255]
T a[130:131],v20,4096
M v[88:91],a[136:139],a[248:251]
buffer_load_dwordx4 a[120:123], v59, s[12:15], s63 offen offset:0 sc1
M v[88:91],a[140:143],a[184:187]
L_pad36:
s_cbranch_execz L_pb1
M v[84:87],a[140:143],a[180:183]
T a[132:133],v20,8192
M v[84:87],a[136:139],a[244:247]
T a[134:135],v20,12288
M v[80:83],a[136:139],a[240:243]
buffer_load_dwordx4 a[124:127], v59, s[12:15], s63 offen offset:1024 sc1
s_add_u32 s63, s63, 4096
M v[80:83],a[140:143],a[176:179]
s_waitcnt lgkmcnt(8)
M v[96:99],a[144:147],a[240:243]
T a[136:137],v21,0
M v[96:99],a[148:151],a[176:179]
T a[138:139],v21,4096
M v[100:103],a[148:151],a[180:183]
M v[100:103],a[144:147],a[244:247]
M v[104:107],a[144:147],a[248:251]
T a[140:141],v21,8192
M v[104:107],a[148:151],a[184:187]
s_add_u32 m0, s60, 65536
T a[142:143],v21,12288
M v[108:111],a[148:151],a[188:191]
buffer_load_dwordx4 v1, s[28:31], s62 offen offset:0 lds
M v[108:111],a[144:147],a[252:255]
s_waitcnt lgkmcnt(8)
M v[124:127],a[156:159],a[188:191]
T a[144:145],v22,0
M v[124:127],a[152:155],a[252:255]
T a[146:147],v22,4096
M v[120:123],a[152:155],a[248:251]
buffer_load_dwordx4 v2, s[28:31], s62 offen offset:1024 lds
M v[120:123],a[156:159],a[184:187]
M v[116:119],a[156:159],a[180:183]
T a[148:149],v22,8192
M v[116:119],a[152:155],a[244:247]
T a[150:151],v22,12288
M v[112:115],a[152:155],a[240:243]
buffer_load_dwordx4 v3, s[28:31], s62 offen offset:2048 lds
M v[112:115],a[156:159],a[176:179]
s_waitcnt lgkmcnt(8)
M v[128:131],a[128:131],a[240:243]
T a[152:153],v23,0
M v[128:131],a[132:135],a[176:179]
T a[154:155],v23,4096
M v[132:135],a[132:135],a[180:183]
buffer_load_dwordx4 v4, s[28:31], s62 offen offset:3072 lds
M v[132:135],a[128:131],a[244:247]
M v[136:139],a[128:131],a[248:251]
T a[156:157],v23,8192
M v[136:139],a[132:135],a[184:187]
s_add_u32 m0, s60, 69632
T a[158:159],v23,12288
M v[140:143],a[132:135],a[188:191]
buffer_load_dwordx4 v5, s[28:31], s62 offen offset:0 lds
M v[140:143],a[128:131],a[252:255]
s_waitcnt lgkmcnt(8)
M v[156:159],a[140:143],a[188:191]
T a[128:129],v16,16384
M v[156:159],a[136:139],a[252:255]
T a[130:131],v16,20480
M v[152:155],a[136:139],a[248:251]
M v[152:155],a[140:143],a[184:187]
M v[148:151],a[140:143],a[180:183]
T a[132:133],v16,24576
M v[148:151],a[136:139],a[244:247]
T a[134:135],v16,28672
M v[144:147],a[136:139],a[240:243]
buffer_load_dwordx4 v6, s[28:31], s62 offen offset:1024 lds
M v[144:147],a[140:143],a[176:179]
s_waitcnt lgkmcnt(8)
M v[160:163],a[144:147],a[240:243]
T a[136:137],v17,16384
M v[160:163],a[148:151],a[176:179]
T a[138:139],v17,20480
M v[164:167],a[148:151],a[180:183]
buffer_load_dwordx4 v7, s[28:31], s62 offen offset:2048 lds
M v[164:167],a[144:147],a[244:247]
M v[168:171],a[144:147],a[248:251]
T a[140:141],v17,24576
M v[168:171],a[148:151],a[184:187]
T a[142:143],v17,28672
M v[172:175],a[148:151],a[188:191]
buffer_load_dwordx4 v8, s[28:31], s62 offen offset:3072 lds
s_add_u32 s62, s62, 262144
M v[172:175],a[144:147],a[252:255]
s_waitcnt lgkmcnt(8)
M v[188:191],a[156:159],a[188:191]
T a[144:145],v18,16384
M v[188:191],a[152:155],a[252:255]
T a[146:147],v18,20480
M v[184:187],a[152:155],a[248:251]
buffer_load_dwordx4 a[208:211], v58, s[12:15], s63 offen offset:0 sc1
M v[184:187],a[156:159],a[184:187]
M v[180:183],a[156:159],a[180:183]
T a[148:149],v18,24576
M v[180:183],a[152:155],a[244:247]
T a[150:151],v18,28672
M v[176:179],a[152:155],a[240:243]
buffer_load_dwordx4 a[212:215], v58, s[12:15], s63 offen offset:1024 sc1
M v[176:179],a[156:159],a[176:179]
s_waitcnt vmcnt(19)
s_waitcnt lgkmcnt(8)
M v[64:67],a[128:131],v[192:195]
T a[152:153],v19,16384
M v[64:67],a[132:135],v[208:211]
T a[154:155],v19,20480
M v[68:71],a[132:135],v[212:215]
M v[68:71],a[128:131],v[196:199]
M v[72:75],a[128:131],v[200:203]
T a[156:157],v19,24576
M v[72:75],a[132:135],v[216:219]
T a[158:159],v19,28672
M v[76:79],a[132:135],v[220:223]
buffer_load_dwordx4 a[216:219], v59, s[12:15], s63 offen offset:0 sc1
M v[76:79],a[128:131],v[204:207]
s_waitcnt lgkmcnt(8)
M v[92:95],a[140:143],v[220:223]
T a[128:129],v20,16384
M v[92:95],a[136:139],v[204:207]
T a[130:131],v20,20480
M v[88:91],a[136:139],v[200:203]
buffer_load_dwordx4 a[220:223], v59, s[12:15], s63 offen offset:1024 sc1
s_add_u32 s63, s63, 4096
M v[88:91],a[140:143],v[216:219]
M v[84:87],a[140:143],v[212:215]
T a[132:133],v20,24576
M v[84:87],a[136:139],v[196:199]
T a[134:135],v20,28672
M v[80:83],a[136:139],v[192:195]
buffer_load_dwordx4 a[96:99], v58, s[12:15], s63 offen offset:0 sc1
M v[80:83],a[140:143],v[208:211]
s_waitcnt lgkmcnt(8)
M v[96:99],a[144:147],v[192:195]
T a[136:137],v21,16384
M v[96:99],a[148:151],v[208:211]
T a[138:139],v21,20480
M v[100:103],a[148:151],v[212:215]
buffer_load_dwordx4 a[100:103], v58, s[12:15], s63 offen offset:1024 sc1
M v[100:103],a[144:147],v[196:199]
M v[104:107],a[144:147],v[200:203]
T a[140:141],v21,24576
M v[104:107],a[148:151],v[216:219]
T a[142:143],v21,28672
M v[108:111],a[148:151],v[220:223]
buffer_load_dwordx4 a[104:107], v59, s[12:15], s63 offen offset:0 sc1
M v[108:111],a[144:147],v[204:207]
s_waitcnt lgkmcnt(8)
M v[124:127],a[156:159],v[220:223]
T a[144:145],v22,16384
M v[124:127],a[152:155],v[204:207]
T a[146:147],v22,20480
M v[120:123],a[152:155],v[200:203]
M v[120:123],a[156:159],v[216:219]
M v[116:119],a[156:159],v[212:215]
T a[148:149],v22,24576
M v[116:119],a[152:155],v[196:199]
T a[150:151],v22,28672
M v[112:115],a[152:155],v[192:195]
buffer_load_dwordx4 a[108:111], v59, s[12:15], s63 offen offset:1024 sc1
s_add_u32 s63, s4, 131072
M v[112:115],a[156:159],v[208:211]
s_waitcnt lgkmcnt(8)
M v[128:131],a[128:131],v[192:195]
T a[152:153],v23,16384
M v[128:131],a[132:135],v[208:211]
T a[154:155],v23,20480
M v[132:135],a[132:135],v[212:215]
buffer_load_dwordx4 a[224:227], v58, s[12:15], s63 offen offset:0 sc1
M v[132:135],a[128:131],v[196:199]
M v[136:139],a[128:131],v[200:203]
T a[156:157],v23,24576
M v[136:139],a[132:135],v[216:219]
T a[158:159],v23,28672
M v[140:143],a[132:135],v[220:223]
buffer_load_dwordx4 a[228:231], v58, s[12:15], s63 offen offset:1024 sc1
M v[140:143],a[128:131],v[204:207]
s_waitcnt vmcnt(35)
s_barrier
s_waitcnt lgkmcnt(8)
M v[156:159],a[140:143],v[220:223]
T a[128:129],v16,32768
M v[156:159],a[136:139],v[204:207]
T a[130:131],v16,36864
M v[152:155],a[136:139],v[200:203]
buffer_load_dwordx4 a[232:235], v59, s[12:15], s63 offen offset:0 sc1
M v[152:155],a[140:143],v[216:219]
M v[148:151],a[140:143],v[212:215]
T a[132:133],v16,40960
M v[148:151],a[136:139],v[196:199]
T a[134:135],v16,45056
M v[144:147],a[136:139],v[192:195]
buffer_load_dwordx4 a[236:239], v59, s[12:15], s63 offen offset:1024 sc1
s_add_u32 s63, s63, 4096
M v[144:147],a[140:143],v[208:211]
s_waitcnt lgkmcnt(8)
M v[160:163],a[144:147],v[192:195]
T a[136:137],v17,32768
M v[160:163],a[148:151],v[208:211]
T a[138:139],v17,36864
M v[164:167],a[148:151],v[212:215]
M v[164:167],a[144:147],v[196:199]
M v[168:171],a[144:147],v[200:203]
T a[140:141],v17,40960
M v[168:171],a[148:151],v[216:219]
T a[142:143],v17,45056
M v[172:175],a[148:151],v[220:223]
buffer_load_dwordx4 a[0:3], v58, s[12:15], s63 offen offset:0 sc1
M v[172:175],a[144:147],v[204:207]
s_waitcnt lgkmcnt(8)
M v[188:191],a[156:159],v[220:223]
T a[144:145],v18,32768
M v[188:191],a[152:155],v[204:207]
T a[146:147],v18,36864
M v[184:187],a[152:155],v[200:203]
buffer_load_dwordx4 a[4:7], v58, s[12:15], s63 offen offset:1024 sc1
M v[184:187],a[156:159],v[216:219]
M v[180:183],a[156:159],v[212:215]
T a[148:149],v18,40960
M v[180:183],a[152:155],v[196:199]
T a[150:151],v18,45056
M v[176:179],a[152:155],v[192:195]
buffer_load_dwordx4 a[8:11], v59, s[12:15], s63 offen offset:0 sc1
M v[176:179],a[156:159],v[208:211]
s_barrier
s_waitcnt vmcnt(23)
s_waitcnt lgkmcnt(8)
M v[64:67],a[128:131],a[192:195]
T a[152:153],v19,32768
M v[64:67],a[132:135],a[112:115]
T a[154:155],v19,36864
M v[68:71],a[132:135],a[116:119]
buffer_load_dwordx4 a[12:15], v59, s[12:15], s63 offen offset:1024 sc1
s_add_u32 s63, s63, 4096
M v[68:71],a[128:131],a[196:199]
M v[72:75],a[128:131],a[200:203]
T a[156:157],v19,40960
M v[72:75],a[132:135],a[120:123]
s_add_u32 m0, s60, 98304
T a[158:159],v19,45056
M v[76:79],a[132:135],a[124:127]
buffer_load_dwordx4 v1, s[28:31], s62 offen offset:0 lds
M v[76:79],a[128:131],a[204:207]
s_waitcnt lgkmcnt(8)
M v[92:95],a[140:143],a[124:127]
T a[128:129],v20,32768
M v[92:95],a[136:139],a[204:207]
T a[130:131],v20,36864
M v[88:91],a[136:139],a[200:203]
M v[88:91],a[140:143],a[120:123]
M v[84:87],a[140:143],a[116:119]
T a[132:133],v20,40960
M v[84:87],a[136:139],a[196:199]
T a[134:135],v20,45056
M v[80:83],a[136:139],a[192:195]
buffer_load_dwordx4 v2, s[28:31], s62 offen offset:1024 lds
M v[80:83],a[140:143],a[112:115]
s_waitcnt lgkmcnt(8)
M v[96:99],a[144:147],a[192:195]
T a[136:137],v21,32768
M v[96:99],a[148:151],a[112:115]
T a[138:139],v21,36864
M v[100:103],a[148:151],a[116:119]
buffer_load_dwordx4 v3, s[28:31], s62 offen offset:2048 lds
M v[100:103],a[144:147],a[196:199]
M v[104:107],a[144:147],a[200:203]
T a[140:141],v21,40960
M v[104:107],a[148:151],a[120:123]
T a[142:143],v21,45056
M v[108:111],a[148:151],a[124:127]
buffer_load_dwordx4 v4, s[28:31], s62 offen offset:3072 lds
M v[108:111],a[144:147],a[204:207]
s_waitcnt lgkmcnt(8)
M v[124:127],a[156:159],a[124:127]
T a[144:145],v22,32768
M v[124:127],a[152:155],a[204:207]
s_add_u32 m0, s60, 102400
T a[146:147],v22,36864
M v[120:123],a[152:155],a[200:203]
buffer_load_dwordx4 v5, s[28:31], s62 offen offset:0 lds
M v[120:123],a[156:159],a[120:123]
M v[116:119],a[156:159],a[116:119]
T a[148:149],v22,40960
M v[116:119],a[152:155],a[196:199]
T a[150:151],v22,45056
M v[112:115],a[152:155],a[192:195]
buffer_load_dwordx4 v6, s[28:31], s62 offen offset:1024 lds
M v[112:115],a[156:159],a[112:115]
s_waitcnt lgkmcnt(8)
M v[128:131],a[128:131],a[192:195]
T a[152:153],v23,32768
M v[128:131],a[132:135],a[112:115]
T a[154:155],v23,36864
M v[132:135],a[132:135],a[116:119]
M v[132:135],a[128:131],a[196:199]
M v[136:139],a[128:131],a[200:203]
T a[156:157],v23,40960
M v[136:139],a[132:135],a[120:123]
T a[158:159],v23,45056
M v[140:143],a[132:135],a[124:127]
buffer_load_dwordx4 v7, s[28:31], s62 offen offset:2048 lds
M v[140:143],a[128:131],a[204:207]
s_waitcnt lgkmcnt(8)
M v[156:159],a[140:143],a[124:127]
T a[128:129],v16,49152
M v[156:159],a[136:139],a[204:207]
T a[130:131],v16,53248
M v[152:155],a[136:139],a[200:203]
buffer_load_dwordx4 v8, s[28:31], s62 offen offset:3072 lds
s_add_u32 s62, s62, 262144
M v[152:155],a[140:143],a[120:123]
M v[148:151],a[140:143],a[116:119]
T a[132:133],v16,57344
M v[148:151],a[136:139],a[196:199]
T a[134:135],v16,61440
M v[144:147],a[136:139],a[192:195]
buffer_load_dwordx4 a[160:163], v58, s[12:15], s63 offen offset:0 sc1
M v[144:147],a[140:143],a[112:115]
s_waitcnt lgkmcnt(8)
M v[160:163],a[144:147],a[192:195]
T a[136:137],v17,49152
M v[160:163],a[148:151],a[112:115]
T a[138:139],v17,53248
M v[164:167],a[148:151],a[116:119]
buffer_load_dwordx4 a[164:167], v58, s[12:15], s63 offen offset:1024 sc1
M v[164:167],a[144:147],a[196:199]
M v[168:171],a[144:147],a[200:203]
T a[140:141],v17,57344
M v[168:171],a[148:151],a[120:123]
T a[142:143],v17,61440
M v[172:175],a[148:151],a[124:127]
buffer_load_dwordx4 a[168:171], v59, s[12:15], s63 offen offset:0 sc1
M v[172:175],a[144:147],a[204:207]
s_waitcnt lgkmcnt(8)
M v[188:191],a[156:159],a[124:127]
T a[144:145],v18,49152
M v[188:191],a[152:155],a[204:207]
T a[146:147],v18,53248
M v[184:187],a[152:155],a[200:203]
M v[184:187],a[156:159],a[120:123]
M v[180:183],a[156:159],a[116:119]
T a[148:149],v18,57344
M v[180:183],a[152:155],a[196:199]
T a[150:151],v18,61440
M v[176:179],a[152:155],a[192:195]
buffer_load_dwordx4 a[172:175], v59, s[12:15], s63 offen offset:1024 sc1
s_add_u32 s63, s63, 4096
M v[176:179],a[156:159],a[112:115]
s_waitcnt vmcnt(20)
s_waitcnt lgkmcnt(8)
M v[64:67],a[128:131],a[208:211]
T a[152:153],v19,49152
M v[64:67],a[132:135],a[96:99]
T a[154:155],v19,53248
M v[68:71],a[132:135],a[100:103]
buffer_load_dwordx4 a[16:19], v58, s[12:15], s63 offen offset:0 sc1
M v[68:71],a[128:131],a[212:215]
M v[72:75],a[128:131],a[216:219]
T a[156:157],v19,57344
M v[72:75],a[132:135],a[104:107]
T a[158:159],v19,61440
M v[76:79],a[132:135],a[108:111]
buffer_load_dwordx4 a[20:23], v58, s[12:15], s63 offen offset:1024 sc1
M v[76:79],a[128:131],a[220:223]
s_waitcnt lgkmcnt(8)
M v[92:95],a[140:143],a[108:111]
T a[128:129],v20,49152
M v[92:95],a[136:139],a[220:223]
T a[130:131],v20,53248
M v[88:91],a[136:139],a[216:219]
buffer_load_dwordx4 a[24:27], v59, s[12:15], s63 offen offset:0 sc1
M v[88:91],a[140:143],a[104:107]
M v[84:87],a[140:143],a[100:103]
T a[132:133],v20,57344
M v[84:87],a[136:139],a[212:215]
T a[134:135],v20,61440
M v[80:83],a[136:139],a[208:211]
buffer_load_dwordx4 a[28:31], v59, s[12:15], s63 offen offset:1024 sc1
s_add_u32 s63, s63, 4096
M v[80:83],a[140:143],a[96:99]
s_waitcnt lgkmcnt(8)
M v[96:99],a[144:147],a[208:211]
T a[136:137],v21,49152
M v[96:99],a[148:151],a[96:99]
T a[138:139],v21,53248
M v[100:103],a[148:151],a[100:103]
M v[100:103],a[144:147],a[212:215]
M v[104:107],a[144:147],a[216:219]
T a[140:141],v21,57344
M v[104:107],a[148:151],a[104:107]
T a[142:143],v21,61440
M v[108:111],a[148:151],a[108:111]
buffer_load_dwordx4 a[32:35], v58, s[12:15], s63 offen offset:0 sc1
M v[108:111],a[144:147],a[220:223]
s_waitcnt lgkmcnt(8)
M v[124:127],a[156:159],a[108:111]
T a[144:145],v22,49152
M v[124:127],a[152:155],a[220:223]
T a[146:147],v22,53248
M v[120:123],a[152:155],a[216:219]
buffer_load_dwordx4 a[36:39], v58, s[12:15], s63 offen offset:1024 sc1
M v[120:123],a[156:159],a[104:107]
M v[116:119],a[156:159],a[100:103]
T a[148:149],v22,57344
M v[116:119],a[152:155],a[212:215]
T a[150:151],v22,61440
M v[112:115],a[152:155],a[208:211]
buffer_load_dwordx4 a[40:43], v59, s[12:15], s63 offen offset:0 sc1
M v[112:115],a[156:159],a[96:99]
s_waitcnt lgkmcnt(8)
M v[128:131],a[128:131],a[208:211]
T a[152:153],v23,49152
M v[128:131],a[132:135],a[96:99]
T a[154:155],v23,53248
M v[132:135],a[132:135],a[100:103]
buffer_load_dwordx4 a[44:47], v59, s[12:15], s63 offen offset:1024 sc1
s_add_u32 s63, s63, 4096
M v[132:135],a[128:131],a[212:215]
M v[136:139],a[128:131],a[216:219]
T a[156:157],v23,57344
M v[136:139],a[132:135],a[104:107]
T a[158:159],v23,61440
M v[140:143],a[132:135],a[108:111]
buffer_load_dwordx4 a[48:51], v58, s[12:15], s63 offen offset:0 sc1
M v[140:143],a[128:131],a[220:223]
s_waitcnt vmcnt(37)
s_barrier
s_waitcnt lgkmcnt(8)
M v[156:159],a[140:143],a[108:111]
T a[128:129],v24,0
v_add_u32 v16, 131072, v16
M v[156:159],a[136:139],a[220:223]
T a[130:131],v24,4096
v_add_u32 v17, 131072, v17
M v[152:155],a[136:139],a[216:219]
v_add_u32 v18, 131072, v18
v_add_u32 v19, 131072, v19
M v[152:155],a[140:143],a[104:107]
v_add_u32 v20, 131072, v20
v_add_u32 v21, 131072, v21
M v[148:151],a[140:143],a[100:103]
T a[132:133],v24,8192
v_add_u32 v22, 131072, v22
M v[148:151],a[136:139],a[212:215]
T a[134:135],v24,12288
v_add_u32 v23, 131072, v23
M v[144:147],a[136:139],a[208:211]
buffer_load_dwordx4 a[52:55], v58, s[12:15], s63 offen offset:1024 sc1
M v[144:147],a[140:143],a[96:99]
s_waitcnt lgkmcnt(8)
M v[160:163],a[144:147],a[208:211]
T a[136:137],v25,0
M v[160:163],a[148:151],a[96:99]
T a[138:139],v25,4096
M v[164:167],a[148:151],a[100:103]
buffer_load_dwordx4 a[56:59], v59, s[12:15], s63 offen offset:0 sc1
M v[164:167],a[144:147],a[212:215]
M v[168:171],a[144:147],a[216:219]
T a[140:141],v25,8192
M v[168:171],a[148:151],a[104:107]
T a[142:143],v25,12288
M v[172:175],a[148:151],a[108:111]
buffer_load_dwordx4 a[60:63], v59, s[12:15], s63 offen offset:1024 sc1
s_add_u32 s63, s63, 4096
M v[172:175],a[144:147],a[220:223]
s_waitcnt lgkmcnt(8)
M v[188:191],a[156:159],a[108:111]
T a[144:145],v26,0
M v[188:191],a[152:155],a[220:223]
s_add_u32 m0, s60, 131072
T a[146:147],v26,4096
M v[184:187],a[152:155],a[216:219]
buffer_load_dwordx4 v1, s[28:31], s62 offen offset:0 lds
M v[184:187],a[156:159],a[104:107]
M v[180:183],a[156:159],a[100:103]
T a[148:149],v26,8192
M v[180:183],a[152:155],a[212:215]
T a[150:151],v26,12288
M v[176:179],a[152:155],a[208:211]
buffer_load_dwordx4 v2, s[28:31], s62 offen offset:1024 lds
M v[176:179],a[156:159],a[96:99]
s_barrier
s_waitcnt vmcnt(26)
s_waitcnt lgkmcnt(8)
M v[64:67],a[128:131],a[224:227]
T a[152:153],v27,0
M v[64:67],a[132:135],a[0:3]
T a[154:155],v27,4096
M v[68:71],a[132:135],a[4:7]
buffer_load_dwordx4 v3, s[28:31], s62 offen offset:2048 lds
M v[68:71],a[128:131],a[228:231]
M v[72:75],a[128:131],a[232:235]
T a[156:157],v27,8192
M v[72:75],a[132:135],a[8:11]
T a[158:159],v27,12288
M v[76:79],a[132:135],a[12:15]
M v[76:79],a[128:131],a[236:239]
s_waitcnt lgkmcnt(8)
M v[92:95],a[140:143],a[12:15]
T a[128:129],v28,0
M v[92:95],a[136:139],a[236:239]
T a[130:131],v28,4096
M v[88:91],a[136:139],a[232:235]
buffer_load_dwordx4 v4, s[28:31], s62 offen offset:3072 lds
M v[88:91],a[140:143],a[8:11]
M v[84:87],a[140:143],a[4:7]
T a[132:133],v28,8192
M v[84:87],a[136:139],a[228:231]
s_add_u32 m0, s60, 135168
T a[134:135],v28,12288
M v[80:83],a[136:139],a[224:227]
buffer_load_dwordx4 v5, s[28:31], s62 offen offset:0 lds
M v[80:83],a[140:143],a[0:3]
s_waitcnt lgkmcnt(8)
M v[96:99],a[144:147],a[224:227]
T a[136:137],v29,0
M v[96:99],a[148:151],a[0:3]
T a[138:139],v29,4096
M v[100:103],a[148:151],a[4:7]
buffer_load_dwordx4 v6, s[28:31], s62 offen offset:1024 lds
M v[100:103],a[144:147],a[228:231]
M v[104:107],a[144:147],a[232:235]
T a[140:141],v29,8192
M v[104:107],a[148:151],a[8:11]
T a[142:143],v29,12288
M v[108:111],a[148:151],a[12:15]
buffer_load_dwordx4 v7, s[28:31], s62 offen offset:2048 lds
M v[108:111],a[144:147],a[236:239]
L_pad37:
s_cbranch_execz L_pb1
s_waitcnt lgkmcnt(8)
M v[124:127],a[156:159],a[12:15]
T a[144:145],v30,0
M v[124:127],a[152:155],a[236:239]
T a[146:147],v30,4096
M v[120:123],a[152:155],a[232:235]
buffer_load_dwordx4 v8, s[28:31], s62 offen offset:3072 lds
s_add_u32 s62, s62, 262144
M v[120:123],a[156:159],a[8:11]
M v[116:119],a[156:159],a[4:7]
T a[148:149],v30,8192
M v[116:119],a[152:155],a[228:231]
T a[150:151],v30,12288
M v[112:115],a[152:155],a[224:227]
buffer_load_dwordx4 a[64:67], v58, s[12:15], s63 offen offset:0 sc1
M v[112:115],a[156:159],a[0:3]
s_waitcnt lgkmcnt(8)
M v[128:131],a[128:131],a[224:227]
T a[152:153],v31,0
M v[128:131],a[132:135],a[0:3]
T a[154:155],v31,4096
M v[132:135],a[132:135],a[4:7]
M v[132:135],a[128:131],a[228:231]
M v[136:139],a[128:131],a[232:235]
T a[156:157],v31,8192
M v[136:139],a[132:135],a[8:11]
T a[158:159],v31,12288
M v[140:143],a[132:135],a[12:15]
buffer_load_dwordx4 a[68:71], v58, s[12:15], s63 offen offset:1024 sc1
M v[140:143],a[128:131],a[236:239]
s_waitcnt lgkmcnt(8)
M v[156:159],a[140:143],a[12:15]
T a[128:129],v24,16384
M v[156:159],a[136:139],a[236:239]
T a[130:131],v24,20480
M v[152:155],a[136:139],a[232:235]
buffer_load_dwordx4 a[72:75], v59, s[12:15], s63 offen offset:0 sc1
M v[152:155],a[140:143],a[8:11]
M v[148:151],a[140:143],a[4:7]
T a[132:133],v24,24576
M v[148:151],a[136:139],a[228:231]
T a[134:135],v24,28672
M v[144:147],a[136:139],a[224:227]
buffer_load_dwordx4 a[76:79], v59, s[12:15], s63 offen offset:1024 sc1
s_add_u32 s63, s63, 4096
M v[144:147],a[140:143],a[0:3]
s_waitcnt lgkmcnt(8)
M v[160:163],a[144:147],a[224:227]
T a[136:137],v25,16384
M v[160:163],a[148:151],a[0:3]
T a[138:139],v25,20480
M v[164:167],a[148:151],a[4:7]
buffer_load_dwordx4 a[80:83], v58, s[12:15], s63 offen offset:0 sc1
M v[164:167],a[144:147],a[228:231]
M v[168:171],a[144:147],a[232:235]
T a[140:141],v25,24576
M v[168:171],a[148:151],a[8:11]
T a[142:143],v25,28672
M v[172:175],a[148:151],a[12:15]
buffer_load_dwordx4 a[84:87], v58, s[12:15], s63 offen offset:1024 sc1
M v[172:175],a[144:147],a[236:239]
s_waitcnt lgkmcnt(8)
M v[188:191],a[156:159],a[12:15]
T a[144:145],v26,16384
M v[188:191],a[152:155],a[236:239]
T a[146:147],v26,20480
M v[184:187],a[152:155],a[232:235]
buffer_load_dwordx4 a[88:91], v59, s[12:15], s63 offen offset:0 sc1
M v[184:187],a[156:159],a[8:11]
M v[180:183],a[156:159],a[4:7]
T a[148:149],v26,24576
M v[180:183],a[152:155],a[228:231]
T a[150:151],v26,28672
M v[176:179],a[152:155],a[224:227]
M v[176:179],a[156:159],a[0:3]
s_waitcnt vmcnt(23)
s_waitcnt lgkmcnt(8)
M v[64:67],a[128:131],a[160:163]
T a[152:153],v27,16384
M v[64:67],a[132:135],a[16:19]
T a[154:155],v27,20480
M v[68:71],a[132:135],a[20:23]
buffer_load_dwordx2 v[44:45], v63, s[48:51], s58 offen offset:0
M v[68:71],a[128:131],a[164:167]
M v[72:75],a[128:131],a[168:171]
T a[156:157],v27,24576
M v[72:75],a[132:135],a[24:27]
T a[158:159],v27,28672
M v[76:79],a[132:135],a[28:31]
buffer_load_dwordx2 v[46:47], v63, s[48:51], s58 offen offset:32
M v[76:79],a[128:131],a[172:175]
s_waitcnt lgkmcnt(8)
M v[92:95],a[140:143],a[28:31]
T a[128:129],v28,16384
M v[92:95],a[136:139],a[172:175]
T a[130:131],v28,20480
M v[88:91],a[136:139],a[168:171]
buffer_load_dwordx4 a[92:95], v59, s[12:15], s63 offen offset:1024 sc1
s_add_u32 s63, s63, 4096
M v[88:91],a[140:143],a[24:27]
M v[84:87],a[140:143],a[20:23]
T a[132:133],v28,24576
M v[84:87],a[136:139],a[164:167]
T a[134:135],v28,28672
M v[80:83],a[136:139],a[160:163]
buffer_load_dwordx4 a[240:243], v58, s[12:15], s63 offen offset:0 sc1
M v[80:83],a[140:143],a[16:19]
s_waitcnt lgkmcnt(8)
M v[96:99],a[144:147],a[160:163]
T a[136:137],v29,16384
M v[96:99],a[148:151],a[16:19]
T a[138:139],v29,20480
M v[100:103],a[148:151],a[20:23]
buffer_load_dwordx4 a[244:247], v58, s[12:15], s63 offen offset:1024 sc1
M v[100:103],a[144:147],a[164:167]
M v[104:107],a[144:147],a[168:171]
T a[140:141],v29,24576
M v[104:107],a[148:151],a[24:27]
T a[142:143],v29,28672
M v[108:111],a[148:151],a[28:31]
buffer_load_dwordx4 a[248:251], v59, s[12:15], s63 offen offset:0 sc1
M v[108:111],a[144:147],a[172:175]
s_waitcnt lgkmcnt(8)
M v[124:127],a[156:159],a[28:31]
T a[144:145],v30,16384
M v[124:127],a[152:155],a[172:175]
T a[146:147],v30,20480
M v[120:123],a[152:155],a[168:171]
M v[120:123],a[156:159],a[24:27]
M v[116:119],a[156:159],a[20:23]
T a[148:149],v30,24576
M v[116:119],a[152:155],a[164:167]
T a[150:151],v30,28672
M v[112:115],a[152:155],a[160:163]
buffer_load_dwordx4 a[252:255], v59, s[12:15], s63 offen offset:1024 sc1
s_add_u32 s63, s63, 4096
M v[112:115],a[156:159],a[16:19]
s_waitcnt lgkmcnt(8)
M v[128:131],a[128:131],a[160:163]
T a[152:153],v31,16384
M v[128:131],a[132:135],a[16:19]
T a[154:155],v31,20480
M v[132:135],a[132:135],a[20:23]
buffer_load_dwordx4 a[176:179], v58, s[12:15], s63 offen offset:0 sc1
M v[132:135],a[128:131],a[164:167]
M v[136:139],a[128:131],a[168:171]
T a[156:157],v31,24576
M v[136:139],a[132:135],a[24:27]
T a[158:159],v31,28672
M v[140:143],a[132:135],a[28:31]
buffer_load_dwordx4 a[180:183], v58, s[12:15], s63 offen offset:1024 sc1
M v[140:143],a[128:131],a[172:175]
s_waitcnt vmcnt(40)
s_barrier
s_waitcnt lgkmcnt(8)
M v[156:159],a[140:143],a[28:31]
T a[128:129],v24,32768
M v[156:159],a[136:139],a[172:175]
T a[130:131],v24,36864
M v[152:155],a[136:139],a[168:171]
buffer_load_dwordx4 a[184:187], v59, s[12:15], s63 offen offset:0 sc1
M v[152:155],a[140:143],a[24:27]
M v[148:151],a[140:143],a[20:23]
T a[132:133],v24,40960
M v[148:151],a[136:139],a[164:167]
T a[134:135],v24,45056
M v[144:147],a[136:139],a[160:163]
buffer_load_dwordx4 a[188:191], v59, s[12:15], s63 offen offset:1024 sc1
s_add_u32 s63, s63, 4096
M v[144:147],a[140:143],a[16:19]
s_waitcnt lgkmcnt(8)
M v[160:163],a[144:147],a[160:163]
T a[136:137],v25,32768
M v[160:163],a[148:151],a[16:19]
s_add_u32 m0, s60, 0
T a[138:139],v25,36864
M v[164:167],a[148:151],a[20:23]
buffer_load_dwordx4 v1, s[28:31], s62 offen offset:0 lds
M v[164:167],a[144:147],a[164:167]
M v[168:171],a[144:147],a[168:171]
T a[140:141],v25,40960
M v[168:171],a[148:151],a[24:27]
T a[142:143],v25,45056
M v[172:175],a[148:151],a[28:31]
M v[172:175],a[144:147],a[172:175]
s_waitcnt lgkmcnt(8)
M v[188:191],a[156:159],a[28:31]
T a[144:145],v26,32768
M v[188:191],a[152:155],a[172:175]
T a[146:147],v26,36864
M v[184:187],a[152:155],a[168:171]
buffer_load_dwordx4 v2, s[28:31], s62 offen offset:1024 lds
M v[184:187],a[156:159],a[24:27]
M v[180:183],a[156:159],a[20:23]
T a[148:149],v26,40960
M v[180:183],a[152:155],a[164:167]
T a[150:151],v26,45056
M v[176:179],a[152:155],a[160:163]
buffer_load_dwordx4 v3, s[28:31], s62 offen offset:2048 lds
M v[176:179],a[156:159],a[16:19]
s_barrier
s_waitcnt vmcnt(29)
s_waitcnt lgkmcnt(8)
M v[64:67],a[128:131],a[32:35]
T a[152:153],v27,32768
M v[64:67],a[132:135],a[48:51]
T a[154:155],v27,36864
M v[68:71],a[132:135],a[52:55]
buffer_load_dwordx4 v4, s[28:31], s62 offen offset:3072 lds
M v[68:71],a[128:131],a[36:39]
M v[72:75],a[128:131],a[40:43]
T a[156:157],v27,40960
M v[72:75],a[132:135],a[56:59]
s_add_u32 m0, s60, 4096
T a[158:159],v27,45056
M v[76:79],a[132:135],a[60:63]
buffer_load_dwordx4 v5, s[28:31], s62 offen offset:0 lds
M v[76:79],a[128:131],a[44:47]
s_waitcnt lgkmcnt(8)
M v[92:95],a[140:143],a[60:63]
T a[128:129],v28,32768
M v[92:95],a[136:139],a[44:47]
T a[130:131],v28,36864
M v[88:91],a[136:139],a[40:43]
buffer_load_dwordx4 v6, s[28:31], s62 offen offset:1024 lds
M v[88:91],a[140:143],a[56:59]
M v[84:87],a[140:143],a[52:55]
T a[132:133],v28,40960
M v[84:87],a[136:139],a[36:39]
T a[134:135],v28,45056
M v[80:83],a[136:139],a[32:35]
buffer_load_dwordx4 v7, s[28:31], s62 offen offset:2048 lds
M v[80:83],a[140:143],a[48:51]
s_waitcnt lgkmcnt(8)
M v[96:99],a[144:147],a[32:35]
T a[136:137],v29,32768
M v[96:99],a[148:151],a[48:51]
T a[138:139],v29,36864
M v[100:103],a[148:151],a[52:55]
M v[100:103],a[144:147],a[36:39]
M v[104:107],a[144:147],a[40:43]
T a[140:141],v29,40960
M v[104:107],a[148:151],a[56:59]
T a[142:143],v29,45056
M v[108:111],a[148:151],a[60:63]
buffer_load_dwordx4 v8, s[28:31], s62 offen offset:3072 lds
s_add_u32 s62, s62, 262144
M v[108:111],a[144:147],a[44:47]
s_waitcnt lgkmcnt(8)
M v[124:127],a[156:159],a[60:63]
T a[144:145],v30,32768
M v[124:127],a[152:155],a[44:47]
T a[146:147],v30,36864
M v[120:123],a[152:155],a[40:43]
buffer_load_dwordx4 v[192:195], v58, s[12:15], s63 offen offset:0 sc1
M v[120:123],a[156:159],a[56:59]
M v[116:119],a[156:159],a[52:55]
T a[148:149],v30,40960
M v[116:119],a[152:155],a[36:39]
T a[150:151],v30,45056
M v[112:115],a[152:155],a[32:35]
buffer_load_dwordx4 v[196:199], v58, s[12:15], s63 offen offset:1024 sc1
M v[112:115],a[156:159],a[48:51]
s_waitcnt lgkmcnt(8)
M v[128:131],a[128:131],a[32:35]
T a[152:153],v31,32768
M v[128:131],a[132:135],a[48:51]
T a[154:155],v31,36864
M v[132:135],a[132:135],a[52:55]
buffer_load_dwordx4 v[200:203], v59, s[12:15], s63 offen offset:0 sc1
M v[132:135],a[128:131],a[36:39]
M v[136:139],a[128:131],a[40:43]
T a[156:157],v31,40960
M v[136:139],a[132:135],a[56:59]
T a[158:159],v31,45056
M v[140:143],a[132:135],a[60:63]
buffer_load_dwordx4 v[204:207], v59, s[12:15], s63 offen offset:1024 sc1
s_add_u32 s63, s63, 4096
M v[140:143],a[128:131],a[44:47]
s_waitcnt lgkmcnt(8)
M v[156:159],a[140:143],a[60:63]
T a[128:129],v24,49152
M v[156:159],a[136:139],a[44:47]
T a[130:131],v24,53248
M v[152:155],a[136:139],a[40:43]
buffer_load_dwordx4 v[208:211], v58, s[12:15], s63 offen offset:0 sc1
M v[152:155],a[140:143],a[56:59]
M v[148:151],a[140:143],a[52:55]
T a[132:133],v24,57344
M v[148:151],a[136:139],a[36:39]
T a[134:135],v24,61440
M v[144:147],a[136:139],a[32:35]
M v[144:147],a[140:143],a[48:51]
s_waitcnt lgkmcnt(8)
M v[160:163],a[144:147],a[32:35]
T a[136:137],v25,49152
M v[160:163],a[148:151],a[48:51]
T a[138:139],v25,53248
M v[164:167],a[148:151],a[52:55]
buffer_load_dwordx4 v[212:215], v58, s[12:15], s63 offen offset:1024 sc1
M v[164:167],a[144:147],a[36:39]
M v[168:171],a[144:147],a[40:43]
T a[140:141],v25,57344
M v[168:171],a[148:151],a[56:59]
T a[142:143],v25,61440
M v[172:175],a[148:151],a[60:63]
buffer_load_dwordx4 v[216:219], v59, s[12:15], s63 offen offset:0 sc1
M v[172:175],a[144:147],a[44:47]
s_waitcnt lgkmcnt(8)
M v[188:191],a[156:159],a[60:63]
T a[144:145],v26,49152
M v[188:191],a[152:155],a[44:47]
T a[146:147],v26,53248
M v[184:187],a[152:155],a[40:43]
buffer_load_dwordx4 v[220:223], v59, s[12:15], s63 offen offset:1024 sc1
s_add_u32 s63, s63, 4096
M v[184:187],a[156:159],a[56:59]
M v[180:183],a[156:159],a[52:55]
T a[148:149],v26,57344
M v[180:183],a[152:155],a[36:39]
T a[150:151],v26,61440
M v[176:179],a[152:155],a[32:35]
buffer_load_dwordx4 a[192:195], v58, s[12:15], s63 offen offset:0 sc1
M v[176:179],a[156:159],a[48:51]
s_waitcnt vmcnt(25)
s_waitcnt lgkmcnt(8)
M v[64:67],a[128:131],a[64:67]
T a[152:153],v27,49152
M v[64:67],a[132:135],a[80:83]
T a[154:155],v27,53248
M v[68:71],a[132:135],a[84:87]
buffer_load_dwordx4 a[196:199], v58, s[12:15], s63 offen offset:1024 sc1
M v[68:71],a[128:131],a[68:71]
M v[72:75],a[128:131],a[72:75]
T a[156:157],v27,57344
M v[72:75],a[132:135],a[88:91]
T a[158:159],v27,61440
M v[76:79],a[132:135],a[92:95]
buffer_load_dwordx4 a[200:203], v59, s[12:15], s63 offen offset:0 sc1
M v[76:79],a[128:131],a[76:79]
s_waitcnt lgkmcnt(8)
M v[92:95],a[140:143],a[92:95]
T a[128:129],v28,49152
M v[92:95],a[136:139],a[76:79]
T a[130:131],v28,53248
M v[88:91],a[136:139],a[72:75]
M v[88:91],a[140:143],a[88:91]
M v[84:87],a[140:143],a[84:87]
T a[132:133],v28,57344
M v[84:87],a[136:139],a[68:71]
T a[134:135],v28,61440
M v[80:83],a[136:139],a[64:67]
buffer_load_dwordx4 a[204:207], v59, s[12:15], s63 offen offset:1024 sc1
s_add_u32 s63, s63, 4096
M v[80:83],a[140:143],a[80:83]
s_waitcnt lgkmcnt(8)
M v[96:99],a[144:147],a[64:67]
T a[136:137],v29,49152
M v[96:99],a[148:151],a[80:83]
T a[138:139],v29,53248
M v[100:103],a[148:151],a[84:87]
buffer_load_dwordx4 a[112:115], v58, s[12:15], s63 offen offset:0 sc1
M v[100:103],a[144:147],a[68:71]
M v[104:107],a[144:147],a[72:75]
T a[140:141],v29,57344
M v[104:107],a[148:151],a[88:91]
T a[142:143],v29,61440
M v[108:111],a[148:151],a[92:95]
buffer_load_dwordx4 a[116:119], v58, s[12:15], s63 offen offset:1024 sc1
M v[108:111],a[144:147],a[76:79]
s_waitcnt lgkmcnt(8)
M v[124:127],a[156:159],a[92:95]
T a[144:145],v30,49152
M v[124:127],a[152:155],a[76:79]
T a[146:147],v30,53248
M v[120:123],a[152:155],a[72:75]
buffer_load_dwordx4 a[120:123], v59, s[12:15], s63 offen offset:0 sc1
M v[120:123],a[156:159],a[88:91]
M v[116:119],a[156:159],a[84:87]
T a[148:149],v30,57344
M v[116:119],a[152:155],a[68:71]
T a[150:151],v30,61440
M v[112:115],a[152:155],a[64:67]
buffer_load_dwordx4 a[124:127], v59, s[12:15], s63 offen offset:1024 sc1
s_add_u32 s63, s63, 4096
M v[112:115],a[156:159],a[80:83]
s_waitcnt lgkmcnt(8)
M v[128:131],a[128:131],a[64:67]
T a[152:153],v31,49152
M v[128:131],a[132:135],a[80:83]
s_add_u32 m0, s60, 32768
T a[154:155],v31,53248
M v[132:135],a[132:135],a[84:87]
buffer_load_dwordx4 v1, s[28:31], s62 offen offset:0 lds
M v[132:135],a[128:131],a[68:71]
M v[136:139],a[128:131],a[72:75]
T a[156:157],v31,57344
M v[136:139],a[132:135],a[88:91]
T a[158:159],v31,61440
M v[140:143],a[132:135],a[92:95]
M v[140:143],a[128:131],a[76:79]
s_waitcnt vmcnt(43)
s_barrier
s_waitcnt lgkmcnt(8)
M v[156:159],a[140:143],a[92:95]
T a[128:129],v16,0
v_subrev_u32 v24, 65536, v24
M v[156:159],a[136:139],a[76:79]
T a[130:131],v16,4096
v_subrev_u32 v25, 65536, v25
M v[152:155],a[136:139],a[72:75]
buffer_load_dwordx4 v2, s[28:31], s62 offen offset:1024 lds
v_subrev_u32 v26, 65536, v26
M v[152:155],a[140:143],a[88:91]
v_subrev_u32 v27, 65536, v27
v_subrev_u32 v28, 65536, v28
M v[148:151],a[140:143],a[84:87]
T a[132:133],v16,8192
v_subrev_u32 v29, 65536, v29
M v[148:151],a[136:139],a[68:71]
T a[134:135],v16,12288
v_subrev_u32 v30, 65536, v30
M v[144:147],a[136:139],a[64:67]
buffer_load_dwordx4 v3, s[28:31], s62 offen offset:2048 lds
v_subrev_u32 v31, 65536, v31
M v[144:147],a[140:143],a[80:83]
s_waitcnt lgkmcnt(8)
M v[160:163],a[144:147],a[64:67]
T a[136:137],v17,0
M v[160:163],a[148:151],a[80:83]
T a[138:139],v17,4096
M v[164:167],a[148:151],a[84:87]
buffer_load_dwordx4 v4, s[28:31], s62 offen offset:3072 lds
M v[164:167],a[144:147],a[68:71]
M v[168:171],a[144:147],a[72:75]
T a[140:141],v17,8192
M v[168:171],a[148:151],a[88:91]
s_add_u32 m0, s60, 36864
T a[142:143],v17,12288
M v[172:175],a[148:151],a[92:95]
buffer_load_dwordx4 v5, s[28:31], s62 offen offset:0 lds
M v[172:175],a[144:147],a[76:79]
s_waitcnt lgkmcnt(8)
M v[188:191],a[156:159],a[92:95]
T a[144:145],v18,0
M v[188:191],a[152:155],a[76:79]
T a[146:147],v18,4096
M v[184:187],a[152:155],a[72:75]
buffer_load_dwordx4 v6, s[28:31], s62 offen offset:1024 lds
M v[184:187],a[156:159],a[88:91]
M v[180:183],a[156:159],a[84:87]
T a[148:149],v18,8192
M v[180:183],a[152:155],a[68:71]
T a[150:151],v18,12288
M v[176:179],a[152:155],a[64:67]
buffer_load_dwordx4 v7, s[28:31], s62 offen offset:2048 lds
M v[176:179],a[156:159],a[80:83]
s_barrier
s_waitcnt vmcnt(31)
s_waitcnt lgkmcnt(8)
M v[64:67],a[128:131],a[240:243]
T a[152:153],v19,0
v_lshlrev_b32 v40, 16, v44
M v[64:67],a[132:135],a[176:179]
s_xor_b32 s70, s55, 2
T a[154:155],v19,4096
v_and_b32 v41, 0xffff0000, v44
M v[68:71],a[132:135],a[180:183]
s_lshl_b32 s70, s70, 10
v_lshlrev_b32 v42, 16, v45
v_and_b32 v43, 0xffff0000, v45
M v[68:71],a[128:131],a[244:247]
s_add_u32 s73, s64, 5
v_lshlrev_b32 v44, 16, v46
v_and_b32 v45, 0xffff0000, v46
M v[72:75],a[128:131],a[248:251]
T a[156:157],v19,8192
v_lshlrev_b32 v46, 16, v47
M v[72:75],a[132:135],a[184:187]
T a[158:159],v19,12288
v_and_b32 v47, 0xffff0000, v47
M v[76:79],a[132:135],a[188:191]
buffer_load_dwordx4 v8, s[28:31], s62 offen offset:3072 lds
v_and_b32 v48, 15, v0
M v[76:79],a[128:131],a[252:255]
s_waitcnt lgkmcnt(8)
v_lshrrev_b32 v49, 1, v63
v_sub_u32 v48, v48, v49
M v[92:95],a[140:143],a[188:191]
s_add_u32 s62, s62, 262144
T a[128:129],v20,0
v_mov_b32 v32, 0
M v[92:95],a[136:139],a[252:255]
T a[130:131],v20,4096
v_mov_b32 v33, 0
M v[88:91],a[136:139],a[248:251]
buffer_load_dwordx4 a[208:211], v58, s[12:15], s63 offen offset:0 sc1
v_mov_b32 v36, 0
M v[88:91],a[140:143],a[184:187]
v_mov_b32 v37, 0
v_mov_b32 v49, 0x3f80
M v[84:87],a[140:143],a[180:183]
T a[132:133],v20,8192
v_mov_b32 v50, 0x3f800000
M v[84:87],a[136:139],a[244:247]
T a[134:135],v20,12288
v_cmp_eq_u32 vcc, 0, v48
M v[80:83],a[136:139],a[240:243]
buffer_load_dwordx4 a[212:215], v58, s[12:15], s63 offen offset:1024 sc1
v_cndmask_b32 v34, 0, v49, vcc
M v[80:83],a[140:143],a[176:179]
s_waitcnt lgkmcnt(8)
v_cmp_eq_u32 vcc, 1, v48
v_mov_b32 v14, s70
M v[96:99],a[144:147],a[240:243]
T a[136:137],v21,0
v_cndmask_b32 v34, v34, v50, vcc
M v[96:99],a[148:151],a[176:179]
T a[138:139],v21,4096
v_cmp_eq_u32 vcc, 2, v48
M v[100:103],a[148:151],a[180:183]
buffer_load_dwordx4 a[216:219], v59, s[12:15], s63 offen offset:0 sc1
v_cndmask_b32 v35, 0, v49, vcc
M v[100:103],a[144:147],a[244:247]
v_cmp_eq_u32 vcc, 3, v48
v_and_b32 v15, 2048, v15
M v[104:107],a[144:147],a[248:251]
T a[140:141],v21,8192
v_cndmask_b32 v35, v35, v50, vcc
M v[104:107],a[148:151],a[184:187]
T a[142:143],v21,12288
v_add_u32 v15, 1024, v15
M v[108:111],a[148:151],a[188:191]
buffer_load_dwordx4 a[220:223], v59, s[12:15], s63 offen offset:1024 sc1
s_add_u32 s63, s63, 4096
M v[108:111],a[144:147],a[252:255]
s_waitcnt lgkmcnt(8)
M v[124:127],a[156:159],a[188:191]
T a[144:145],v22,0
M v[124:127],a[152:155],a[252:255]
T a[146:147],v22,4096
M v[120:123],a[152:155],a[248:251]
buffer_load_dwordx4 a[96:99], v58, s[12:15], s63 offen offset:0 sc1
M v[120:123],a[156:159],a[184:187]
M v[116:119],a[156:159],a[180:183]
T a[148:149],v22,8192
M v[116:119],a[152:155],a[244:247]
T a[150:151],v22,12288
M v[112:115],a[152:155],a[240:243]
L_pad38:
s_cbranch_execz L_pb2
M v[112:115],a[156:159],a[176:179]
s_waitcnt lgkmcnt(8)
M v[128:131],a[128:131],a[240:243]
T a[152:153],v23,0
M v[128:131],a[132:135],a[176:179]
T a[154:155],v23,4096
M v[132:135],a[132:135],a[180:183]
buffer_load_dwordx4 a[100:103], v58, s[12:15], s63 offen offset:1024 sc1
M v[132:135],a[128:131],a[244:247]
M v[136:139],a[128:131],a[248:251]
T a[156:157],v23,8192
M v[136:139],a[132:135],a[184:187]
T a[158:159],v23,12288
M v[140:143],a[132:135],a[188:191]
buffer_load_dwordx4 a[104:107], v59, s[12:15], s63 offen offset:0 sc1
M v[140:143],a[128:131],a[252:255]
s_waitcnt lgkmcnt(8)
M v[156:159],a[140:143],a[188:191]
T a[128:129],v16,16384
M v[156:159],a[136:139],a[252:255]
T a[130:131],v16,20480
M v[152:155],a[136:139],a[248:251]
buffer_load_dwordx4 a[108:111], v59, s[12:15], s63 offen offset:1024 sc1
s_add_u32 s63, s63, 4096
M v[152:155],a[140:143],a[184:187]
M v[148:151],a[140:143],a[180:183]
T a[132:133],v16,24576
M v[148:151],a[136:139],a[244:247]
T a[134:135],v16,28672
M v[144:147],a[136:139],a[240:243]
buffer_load_dwordx4 a[224:227], v58, s[12:15], s63 offen offset:0 sc1
M v[144:147],a[140:143],a[176:179]
s_waitcnt lgkmcnt(8)
M v[160:163],a[144:147],a[240:243]
T a[136:137],v17,16384
M v[160:163],a[148:151],a[176:179]
T a[138:139],v17,20480
M v[164:167],a[148:151],a[180:183]
buffer_load_dwordx4 a[228:231], v58, s[12:15], s63 offen offset:1024 sc1
M v[164:167],a[144:147],a[244:247]
M v[168:171],a[144:147],a[248:251]
T a[140:141],v17,24576
M v[168:171],a[148:151],a[184:187]
T a[142:143],v17,28672
M v[172:175],a[148:151],a[188:191]
buffer_load_dwordx4 a[232:235], v59, s[12:15], s63 offen offset:0 sc1
M v[172:175],a[144:147],a[252:255]
s_waitcnt lgkmcnt(8)
M v[188:191],a[156:159],a[188:191]
T a[144:145],v18,16384
M v[188:191],a[152:155],a[252:255]
T a[146:147],v18,20480
M v[184:187],a[152:155],a[248:251]
M v[184:187],a[156:159],a[184:187]
M v[180:183],a[156:159],a[180:183]
T a[148:149],v18,24576
M v[180:183],a[152:155],a[244:247]
T a[150:151],v18,28672
M v[176:179],a[152:155],a[240:243]
buffer_load_dwordx4 a[236:239], v59, s[12:15], s63 offen offset:1024 sc1
s_add_u32 s63, s63, 4096
M v[176:179],a[156:159],a[176:179]
s_waitcnt vmcnt(28)
s_waitcnt lgkmcnt(8)
M v[64:67],a[128:131],v[192:195]
T a[152:153],v19,16384
M v[64:67],a[132:135],v[208:211]
T a[154:155],v19,20480
M v[68:71],a[132:135],v[212:215]
buffer_load_dwordx4 a[0:3], v58, s[12:15], s63 offen offset:0 sc1
M v[68:71],a[128:131],v[196:199]
M v[72:75],a[128:131],v[200:203]
T a[156:157],v19,24576
M v[72:75],a[132:135],v[216:219]
T a[158:159],v19,28672
M v[76:79],a[132:135],v[220:223]
buffer_load_dwordx4 a[4:7], v58, s[12:15], s63 offen offset:1024 sc1
M v[76:79],a[128:131],v[204:207]
s_waitcnt lgkmcnt(8)
M v[92:95],a[140:143],v[220:223]
T a[128:129],v20,16384
M v[92:95],a[136:139],v[204:207]
T a[130:131],v20,20480
M v[88:91],a[136:139],v[200:203]
buffer_load_dwordx4 a[8:11], v59, s[12:15], s63 offen offset:0 sc1
M v[88:91],a[140:143],v[216:219]
M v[84:87],a[140:143],v[212:215]
T a[132:133],v20,24576
M v[84:87],a[136:139],v[196:199]
T a[134:135],v20,28672
M v[80:83],a[136:139],v[192:195]
buffer_load_dwordx4 a[12:15], v59, s[12:15], s63 offen offset:1024 sc1
s_add_u32 s63, s63, 4096
M v[80:83],a[140:143],v[208:211]
s_waitcnt lgkmcnt(8)
M v[96:99],a[144:147],v[192:195]
T a[136:137],v21,16384
M v[96:99],a[148:151],v[208:211]
s_add_u32 m0, s60, 65536
T a[138:139],v21,20480
M v[100:103],a[148:151],v[212:215]
buffer_load_dwordx4 v1, s[28:31], s62 offen offset:0 lds
M v[100:103],a[144:147],v[196:199]
M v[104:107],a[144:147],v[200:203]
T a[140:141],v21,24576
M v[104:107],a[148:151],v[216:219]
T a[142:143],v21,28672
M v[108:111],a[148:151],v[220:223]
M v[108:111],a[144:147],v[204:207]
s_waitcnt lgkmcnt(8)
M v[124:127],a[156:159],v[220:223]
T a[144:145],v22,16384
M v[124:127],a[152:155],v[204:207]
T a[146:147],v22,20480
M v[120:123],a[152:155],v[200:203]
buffer_load_dwordx4 v2, s[28:31], s62 offen offset:1024 lds
M v[120:123],a[156:159],v[216:219]
M v[116:119],a[156:159],v[212:215]
T a[148:149],v22,24576
M v[116:119],a[152:155],v[196:199]
T a[150:151],v22,28672
M v[112:115],a[152:155],v[192:195]
buffer_load_dwordx4 v3, s[28:31], s62 offen offset:2048 lds
M v[112:115],a[156:159],v[208:211]
s_waitcnt lgkmcnt(8)
M v[128:131],a[128:131],v[192:195]
T a[152:153],v23,16384
M v[128:131],a[132:135],v[208:211]
T a[154:155],v23,20480
M v[132:135],a[132:135],v[212:215]
buffer_load_dwordx4 v4, s[28:31], s62 offen offset:3072 lds
M v[132:135],a[128:131],v[196:199]
M v[136:139],a[128:131],v[200:203]
T a[156:157],v23,24576
M v[136:139],a[132:135],v[216:219]
s_add_u32 m0, s60, 69632
T a[158:159],v23,28672
M v[140:143],a[132:135],v[220:223]
buffer_load_dwordx4 v5, s[28:31], s62 offen offset:0 lds
M v[140:143],a[128:131],v[204:207]
s_waitcnt vmcnt(45)
s_barrier
s_waitcnt lgkmcnt(8)
M v[156:159],a[140:143],v[220:223]
T a[128:129],v24,0
v_subrev_u32 v16, 65536, v16
M v[156:159],a[136:139],v[204:207]
T a[130:131],v24,4096
v_subrev_u32 v17, 65536, v17
M v[152:155],a[136:139],v[200:203]
buffer_load_dwordx4 v6, s[28:31], s62 offen offset:1024 lds
v_subrev_u32 v18, 65536, v18
M v[152:155],a[140:143],v[216:219]
v_subrev_u32 v19, 65536, v19
v_subrev_u32 v20, 65536, v20
M v[148:151],a[140:143],v[212:215]
T a[132:133],v24,8192
v_subrev_u32 v21, 65536, v21
M v[148:151],a[136:139],v[196:199]
T a[134:135],v24,12288
v_subrev_u32 v22, 65536, v22
M v[144:147],a[136:139],v[192:195]
buffer_load_dwordx4 v7, s[28:31], s62 offen offset:2048 lds
v_subrev_u32 v23, 65536, v23
M v[144:147],a[140:143],v[208:211]
s_waitcnt lgkmcnt(8)
M v[160:163],a[144:147],v[192:195]
T a[136:137],v25,0
M v[160:163],a[148:151],v[208:211]
T a[138:139],v25,4096
M v[164:167],a[148:151],v[212:215]
M v[164:167],a[144:147],v[196:199]
M v[168:171],a[144:147],v[200:203]
T a[140:141],v25,8192
M v[168:171],a[148:151],v[216:219]
T a[142:143],v25,12288
M v[172:175],a[148:151],v[220:223]
buffer_load_dwordx4 v8, s[28:31], s62 offen offset:3072 lds
s_add_u32 s62, s62, 262144
M v[172:175],a[144:147],v[204:207]
s_waitcnt lgkmcnt(8)
M v[188:191],a[156:159],v[220:223]
T a[144:145],v26,0
M v[188:191],a[152:155],v[204:207]
T a[146:147],v26,4096
M v[184:187],a[152:155],v[200:203]
buffer_load_dwordx4 a[160:163], v58, s[12:15], s63 offen offset:0 sc1
M v[184:187],a[156:159],v[216:219]
M v[180:183],a[156:159],v[212:215]
T a[148:149],v26,8192
M v[180:183],a[152:155],v[196:199]
T a[150:151],v26,12288
M v[176:179],a[152:155],v[192:195]
buffer_load_dwordx4 a[164:167], v58, s[12:15], s63 offen offset:1024 sc1
M v[176:179],a[156:159],v[208:211]
s_waitcnt vmcnt(34)
s_waitcnt lgkmcnt(8)
M v[64:67],a[128:131],a[192:195]
T a[152:153],v27,0
M v[64:67],a[132:135],a[112:115]
T a[154:155],v27,4096
M v[68:71],a[132:135],a[116:119]
buffer_load_dwordx4 a[168:171], v59, s[12:15], s63 offen offset:0 sc1
M v[68:71],a[128:131],a[196:199]
M v[72:75],a[128:131],a[200:203]
T a[156:157],v27,8192
M v[72:75],a[132:135],a[120:123]
T a[158:159],v27,12288
M v[76:79],a[132:135],a[124:127]
buffer_load_dwordx4 a[172:175], v59, s[12:15], s63 offen offset:1024 sc1
s_add_u32 s63, s63, 4096
M v[76:79],a[128:131],a[204:207]
s_waitcnt lgkmcnt(8)
M v[92:95],a[140:143],a[124:127]
T a[128:129],v28,0
M v[92:95],a[136:139],a[204:207]
T a[130:131],v28,4096
M v[88:91],a[136:139],a[200:203]
buffer_load_dwordx4 a[16:19], v58, s[12:15], s63 offen offset:0 sc1
M v[88:91],a[140:143],a[120:123]
M v[84:87],a[140:143],a[116:119]
T a[132:133],v28,8192
M v[84:87],a[136:139],a[196:199]
T a[134:135],v28,12288
M v[80:83],a[136:139],a[192:195]
M v[80:83],a[140:143],a[112:115]
s_waitcnt lgkmcnt(8)
M v[96:99],a[144:147],a[192:195]
T a[136:137],v29,0
M v[96:99],a[148:151],a[112:115]
T a[138:139],v29,4096
M v[100:103],a[148:151],a[116:119]
buffer_load_dwordx4 a[20:23], v58, s[12:15], s63 offen offset:1024 sc1
M v[100:103],a[144:147],a[196:199]
M v[104:107],a[144:147],a[200:203]
T a[140:141],v29,8192
M v[104:107],a[148:151],a[120:123]
T a[142:143],v29,12288
M v[108:111],a[148:151],a[124:127]
buffer_load_dwordx4 a[24:27], v59, s[12:15], s63 offen offset:0 sc1
M v[108:111],a[144:147],a[204:207]
s_waitcnt lgkmcnt(8)
M v[124:127],a[156:159],a[124:127]
T a[144:145],v30,0
M v[124:127],a[152:155],a[204:207]
T a[146:147],v30,4096
M v[120:123],a[152:155],a[200:203]
buffer_load_dwordx4 a[28:31], v59, s[12:15], s63 offen offset:1024 sc1
s_add_u32 s63, s63, 4096
M v[120:123],a[156:159],a[120:123]
M v[116:119],a[156:159],a[116:119]
T a[148:149],v30,8192
M v[116:119],a[152:155],a[196:199]
T a[150:151],v30,12288
M v[112:115],a[152:155],a[192:195]
buffer_load_dwordx4 a[32:35], v58, s[12:15], s63 offen offset:0 sc1
M v[112:115],a[156:159],a[112:115]
s_waitcnt lgkmcnt(8)
M v[128:131],a[128:131],a[192:195]
T a[152:153],v31,0
M v[128:131],a[132:135],a[112:115]
T a[154:155],v31,4096
M v[132:135],a[132:135],a[116:119]
buffer_load_dwordx4 a[36:39], v58, s[12:15], s63 offen offset:1024 sc1
M v[132:135],a[128:131],a[196:199]
M v[136:139],a[128:131],a[200:203]
T a[156:157],v31,8192
M v[136:139],a[132:135],a[120:123]
T a[158:159],v31,12288
M v[140:143],a[132:135],a[124:127]
buffer_load_dwordx4 a[40:43], v59, s[12:15], s63 offen offset:0 sc1
M v[140:143],a[128:131],a[204:207]
s_waitcnt lgkmcnt(8)
M v[156:159],a[140:143],a[124:127]
T a[128:129],v24,16384
M v[156:159],a[136:139],a[204:207]
T a[130:131],v24,20480
M v[152:155],a[136:139],a[200:203]
M v[152:155],a[140:143],a[120:123]
M v[148:151],a[140:143],a[116:119]
T a[132:133],v24,24576
M v[148:151],a[136:139],a[196:199]
T a[134:135],v24,28672
M v[144:147],a[136:139],a[192:195]
buffer_load_dwordx4 a[44:47], v59, s[12:15], s63 offen offset:1024 sc1
s_add_u32 s63, s63, 4096
M v[144:147],a[140:143],a[112:115]
s_waitcnt lgkmcnt(8)
M v[160:163],a[144:147],a[192:195]
T a[136:137],v25,16384
M v[160:163],a[148:151],a[112:115]
T a[138:139],v25,20480
M v[164:167],a[148:151],a[116:119]
buffer_load_dwordx4 a[48:51], v58, s[12:15], s63 offen offset:0 sc1
M v[164:167],a[144:147],a[196:199]
M v[168:171],a[144:147],a[200:203]
T a[140:141],v25,24576
M v[168:171],a[148:151],a[120:123]
T a[142:143],v25,28672
M v[172:175],a[148:151],a[124:127]
buffer_load_dwordx4 a[52:55], v58, s[12:15], s63 offen offset:1024 sc1
M v[172:175],a[144:147],a[204:207]
s_waitcnt lgkmcnt(8)
M v[188:191],a[156:159],a[124:127]
T a[144:145],v26,16384
M v[188:191],a[152:155],a[204:207]
T a[146:147],v26,20480
M v[184:187],a[152:155],a[200:203]
buffer_load_dwordx4 a[56:59], v59, s[12:15], s63 offen offset:0 sc1
M v[184:187],a[156:159],a[120:123]
M v[180:183],a[156:159],a[116:119]
T a[148:149],v26,24576
M v[180:183],a[152:155],a[196:199]
T a[150:151],v26,28672
M v[176:179],a[152:155],a[192:195]
buffer_load_dwordx4 a[60:63], v59, s[12:15], s63 offen offset:1024 sc1
s_add_u32 s63, s63, 4096
M v[176:179],a[156:159],a[112:115]
s_waitcnt vmcnt(32)
s_waitcnt lgkmcnt(8)
M v[64:67],a[128:131],a[208:211]
T a[152:153],v27,16384
M v[64:67],a[132:135],a[96:99]
s_add_u32 m0, s60, 98304
T a[154:155],v27,20480
M v[68:71],a[132:135],a[100:103]
buffer_load_dwordx4 v1, s[28:31], s62 offen offset:0 lds
M v[68:71],a[128:131],a[212:215]
M v[72:75],a[128:131],a[216:219]
T a[156:157],v27,24576
M v[72:75],a[132:135],a[104:107]
T a[158:159],v27,28672
M v[76:79],a[132:135],a[108:111]
M v[76:79],a[128:131],a[220:223]
s_waitcnt lgkmcnt(8)
M v[92:95],a[140:143],a[108:111]
T a[128:129],v28,16384
M v[92:95],a[136:139],a[220:223]
T a[130:131],v28,20480
M v[88:91],a[136:139],a[216:219]
buffer_load_dwordx4 v2, s[28:31], s62 offen offset:1024 lds
M v[88:91],a[140:143],a[104:107]
M v[84:87],a[140:143],a[100:103]
T a[132:133],v28,24576
M v[84:87],a[136:139],a[212:215]
T a[134:135],v28,28672
M v[80:83],a[136:139],a[208:211]
buffer_load_dwordx4 v3, s[28:31], s62 offen offset:2048 lds
M v[80:83],a[140:143],a[96:99]
s_waitcnt lgkmcnt(8)
M v[96:99],a[144:147],a[208:211]
T a[136:137],v29,16384
M v[96:99],a[148:151],a[96:99]
T a[138:139],v29,20480
M v[100:103],a[148:151],a[100:103]
buffer_load_dwordx4 v4, s[28:31], s62 offen offset:3072 lds
M v[100:103],a[144:147],a[212:215]
M v[104:107],a[144:147],a[216:219]
T a[140:141],v29,24576
M v[104:107],a[148:151],a[104:107]
s_add_u32 m0, s60, 102400
T a[142:143],v29,28672
M v[108:111],a[148:151],a[108:111]
buffer_load_dwordx4 v5, s[28:31], s62 offen offset:0 lds
M v[108:111],a[144:147],a[220:223]
s_waitcnt lgkmcnt(8)
M v[124:127],a[156:159],a[108:111]
T a[144:145],v30,16384
M v[124:127],a[152:155],a[220:223]
T a[146:147],v30,20480
M v[120:123],a[152:155],a[216:219]
buffer_load_dwordx4 v6, s[28:31], s62 offen offset:1024 lds
M v[120:123],a[156:159],a[104:107]
M v[116:119],a[156:159],a[100:103]
T a[148:149],v30,24576
M v[116:119],a[152:155],a[212:215]
T a[150:151],v30,28672
M v[112:115],a[152:155],a[208:211]
buffer_load_dwordx4 v7, s[28:31], s62 offen offset:2048 lds
M v[112:115],a[156:159],a[96:99]
s_waitcnt lgkmcnt(8)
M v[128:131],a[128:131],a[208:211]
T a[152:153],v31,16384
M v[128:131],a[132:135],a[96:99]
T a[154:155],v31,20480
M v[132:135],a[132:135],a[100:103]
M v[132:135],a[128:131],a[212:215]
M v[136:139],a[128:131],a[216:219]
T a[156:157],v31,24576
M v[136:139],a[132:135],a[104:107]
T a[158:159],v31,28672
M v[140:143],a[132:135],a[108:111]
buffer_load_dwordx4 v8, s[28:31], s62 offen offset:3072 lds
s_add_u32 s62, s62, 262144
M v[140:143],a[128:131],a[220:223]
s_waitcnt vmcnt(48)
s_barrier
s_waitcnt lgkmcnt(8)
M v[156:159],a[140:143],a[108:111]
T a[128:129],v24,32768
M v[156:159],a[136:139],a[220:223]
T a[130:131],v24,36864
M v[152:155],a[136:139],a[216:219]
buffer_load_dwordx4 a[64:67], v58, s[12:15], s63 offen offset:0 sc1
M v[152:155],a[140:143],a[104:107]
M v[148:151],a[140:143],a[100:103]
T a[132:133],v24,40960
M v[148:151],a[136:139],a[212:215]
T a[134:135],v24,45056
M v[144:147],a[136:139],a[208:211]
buffer_load_dwordx4 a[68:71], v58, s[12:15], s63 offen offset:1024 sc1
M v[144:147],a[140:143],a[96:99]
s_waitcnt lgkmcnt(8)
M v[160:163],a[144:147],a[208:211]
T a[136:137],v25,32768
M v[160:163],a[148:151],a[96:99]
T a[138:139],v25,36864
M v[164:167],a[148:151],a[100:103]
buffer_load_dwordx4 a[72:75], v59, s[12:15], s63 offen offset:0 sc1
M v[164:167],a[144:147],a[212:215]
M v[168:171],a[144:147],a[216:219]
T a[140:141],v25,40960
M v[168:171],a[148:151],a[104:107]
T a[142:143],v25,45056
M v[172:175],a[148:151],a[108:111]
buffer_load_dwordx4 a[76:79], v59, s[12:15], s63 offen offset:1024 sc1
s_add_u32 s63, s63, 4096
M v[172:175],a[144:147],a[220:223]
s_waitcnt lgkmcnt(8)
M v[188:191],a[156:159],a[108:111]
T a[144:145],v26,32768
M v[188:191],a[152:155],a[220:223]
T a[146:147],v26,36864
M v[184:187],a[152:155],a[216:219]
buffer_load_dwordx4 a[80:83], v58, s[12:15], s63 offen offset:0 sc1
M v[184:187],a[156:159],a[104:107]
M v[180:183],a[156:159],a[100:103]
T a[148:149],v26,40960
M v[180:183],a[152:155],a[212:215]
T a[150:151],v26,45056
M v[176:179],a[152:155],a[208:211]
M v[176:179],a[156:159],a[96:99]
s_barrier
s_waitcnt vmcnt(37)
s_waitcnt lgkmcnt(8)
M v[64:67],a[128:131],a[224:227]
T a[152:153],v27,32768
M v[64:67],a[132:135],a[0:3]
T a[154:155],v27,36864
M v[68:71],a[132:135],a[4:7]
buffer_load_dwordx4 a[84:87], v58, s[12:15], s63 offen offset:1024 sc1
M v[68:71],a[128:131],a[228:231]
M v[72:75],a[128:131],a[232:235]
T a[156:157],v27,40960
M v[72:75],a[132:135],a[8:11]
T a[158:159],v27,45056
M v[76:79],a[132:135],a[12:15]
buffer_load_dwordx4 a[88:91], v59, s[12:15], s63 offen offset:0 sc1
M v[76:79],a[128:131],a[236:239]
s_waitcnt lgkmcnt(8)
M v[92:95],a[140:143],a[12:15]
T a[128:129],v28,32768
M v[92:95],a[136:139],a[236:239]
T a[130:131],v28,36864
M v[88:91],a[136:139],a[232:235]
buffer_load_dwordx4 a[92:95], v59, s[12:15], s63 offen offset:1024 sc1
s_add_u32 s63, s63, 4096
M v[88:91],a[140:143],a[8:11]
M v[84:87],a[140:143],a[4:7]
T a[132:133],v28,40960
M v[84:87],a[136:139],a[228:231]
T a[134:135],v28,45056
M v[80:83],a[136:139],a[224:227]
buffer_load_dwordx4 a[240:243], v58, s[12:15], s63 offen offset:0 sc1
M v[80:83],a[140:143],a[0:3]
s_waitcnt lgkmcnt(8)
M v[96:99],a[144:147],a[224:227]
T a[136:137],v29,32768
M v[96:99],a[148:151],a[0:3]
T a[138:139],v29,36864
M v[100:103],a[148:151],a[4:7]
buffer_load_dwordx4 a[244:247], v58, s[12:15], s63 offen offset:1024 sc1
M v[100:103],a[144:147],a[228:231]
M v[104:107],a[144:147],a[232:235]
T a[140:141],v29,40960
M v[104:107],a[148:151],a[8:11]
T a[142:143],v29,45056
M v[108:111],a[148:151],a[12:15]
buffer_load_dwordx4 a[248:251], v59, s[12:15], s63 offen offset:0 sc1
M v[108:111],a[144:147],a[236:239]
s_waitcnt lgkmcnt(8)
M v[124:127],a[156:159],a[12:15]
T a[144:145],v24,49152
M v[124:127],a[152:155],a[236:239]
T a[146:147],v24,53248
M v[120:123],a[152:155],a[232:235]
M v[120:123],a[156:159],a[8:11]
M v[116:119],a[156:159],a[4:7]
T a[148:149],v24,57344
M v[116:119],a[152:155],a[228:231]
T a[150:151],v24,61440
M v[112:115],a[152:155],a[224:227]
buffer_load_dwordx4 a[252:255], v59, s[12:15], s63 offen offset:1024 sc1
s_add_u32 s63, s63, 4096
M v[112:115],a[156:159],a[0:3]
s_waitcnt lgkmcnt(8)
M v[128:131],a[128:131],a[224:227]
T a[152:153],v25,49152
M v[128:131],a[132:135],a[0:3]
T a[154:155],v25,53248
M v[132:135],a[132:135],a[4:7]
buffer_load_dwordx4 a[176:179], v58, s[12:15], s63 offen offset:0 sc1
M v[132:135],a[128:131],a[228:231]
M v[136:139],a[128:131],a[232:235]
T a[156:157],v25,57344
M v[136:139],a[132:135],a[8:11]
T a[158:159],v25,61440
M v[140:143],a[132:135],a[12:15]
buffer_load_dwordx4 a[180:183], v58, s[12:15], s63 offen offset:1024 sc1
M v[140:143],a[128:131],a[236:239]
s_waitcnt lgkmcnt(8)
M v[156:159],a[140:143],a[12:15]
T a[128:129],v26,49152
M v[156:159],a[136:139],a[236:239]
T a[130:131],v26,53248
M v[152:155],a[136:139],a[232:235]
buffer_load_dwordx4 a[184:187], v59, s[12:15], s63 offen offset:0 sc1
M v[152:155],a[140:143],a[8:11]
M v[148:151],a[140:143],a[4:7]
T a[132:133],v26,57344
M v[148:151],a[136:139],a[228:231]
L_pad39:
s_cbranch_execz L_pb2
T a[134:135],v26,61440
M v[144:147],a[136:139],a[224:227]
buffer_load_dwordx4 a[188:191], v59, s[12:15], s63 offen offset:1024 sc1
s_add_u32 s63, s63, 4096
M v[144:147],a[140:143],a[0:3]
s_waitcnt vmcnt(32)
s_waitcnt lgkmcnt(8)
M v[64:67],a[144:147],a[160:163]
T a[136:137],v27,49152
M v[64:67],a[148:151],a[16:19]
s_add_u32 m0, s60, 0
T a[138:139],v27,53248
M v[68:71],a[148:151],a[20:23]
buffer_load_dwordx4 v1, s[28:31], s62 offen offset:0 lds
M v[68:71],a[144:147],a[164:167]
M v[72:75],a[144:147],a[168:171]
T a[140:141],v27,57344
M v[72:75],a[148:151],a[24:27]
T a[142:143],v27,61440
M v[76:79],a[148:151],a[28:31]
M v[76:79],a[144:147],a[172:175]
s_waitcnt lgkmcnt(8)
M v[92:95],a[156:159],a[28:31]
T a[144:145],v28,49152
M v[92:95],a[152:155],a[172:175]
T a[146:147],v28,53248
M v[88:91],a[152:155],a[168:171]
buffer_load_dwordx4 v2, s[28:31], s62 offen offset:1024 lds
M v[88:91],a[156:159],a[24:27]
M v[84:87],a[156:159],a[20:23]
T a[148:149],v28,57344
M v[84:87],a[152:155],a[164:167]
T a[150:151],v28,61440
M v[80:83],a[152:155],a[160:163]
buffer_load_dwordx4 v3, s[28:31], s62 offen offset:2048 lds
M v[80:83],a[156:159],a[16:19]
s_waitcnt lgkmcnt(8)
M v[96:99],a[128:131],a[160:163]
T a[152:153],v29,49152
M v[96:99],a[132:135],a[16:19]
T a[154:155],v29,53248
M v[100:103],a[132:135],a[20:23]
buffer_load_dwordx4 v4, s[28:31], s62 offen offset:3072 lds
M v[100:103],a[128:131],a[164:167]
M v[104:107],a[128:131],a[168:171]
T a[156:157],v29,57344
M v[104:107],a[132:135],a[24:27]
s_add_u32 m0, s60, 4096
T a[158:159],v29,61440
M v[108:111],a[132:135],a[28:31]
buffer_load_dwordx4 v5, s[28:31], s62 offen offset:0 lds
M v[108:111],a[128:131],a[172:175]
s_waitcnt vmcnt(45)
s_barrier
s_waitcnt lgkmcnt(8)
M v[124:127],a[140:143],a[28:31]
T a[128:129],v16,0
M v[124:127],a[136:139],a[172:175]
T a[130:131],v16,4096
M v[120:123],a[136:139],a[168:171]
buffer_load_dwordx4 v6, s[28:31], s62 offen offset:1024 lds
M v[120:123],a[140:143],a[24:27]
M v[116:119],a[140:143],a[20:23]
T a[132:133],v16,8192
M v[116:119],a[136:139],a[164:167]
T a[134:135],v16,12288
M v[112:115],a[136:139],a[160:163]
buffer_load_dwordx4 v7, s[28:31], s62 offen offset:2048 lds
M v[112:115],a[140:143],a[16:19]
s_waitcnt lgkmcnt(8)
M v[128:131],a[144:147],a[160:163]
T a[136:137],v17,0
M v[128:131],a[148:151],a[16:19]
T a[138:139],v17,4096
M v[132:135],a[148:151],a[20:23]
M v[132:135],a[144:147],a[164:167]
M v[136:139],a[144:147],a[168:171]
T a[140:141],v17,8192
M v[136:139],a[148:151],a[24:27]
T a[142:143],v17,12288
M v[140:143],a[148:151],a[28:31]
buffer_load_dwordx4 v8, s[28:31], s62 offen offset:3072 lds
M v[140:143],a[144:147],a[172:175]
s_waitcnt lgkmcnt(8)
M v[156:159],a[156:159],a[28:31]
T a[144:145],v18,0
M v[156:159],a[152:155],a[172:175]
T a[146:147],v18,4096
M v[152:155],a[152:155],a[168:171]
buffer_load_dwordx4 v[192:195], v58, s[12:15], s63 offen offset:0 sc1
M v[152:155],a[156:159],a[24:27]
M v[148:151],a[156:159],a[20:23]
T a[148:149],v18,8192
M v[148:151],a[152:155],a[164:167]
T a[150:151],v18,12288
M v[144:147],a[152:155],a[160:163]
buffer_load_dwordx4 v[196:199], v58, s[12:15], s63 offen offset:1024 sc1
M v[144:147],a[156:159],a[16:19]
s_waitcnt vmcnt(34)
s_waitcnt lgkmcnt(8)
M v[64:67],a[128:131],a[32:35]
T a[152:153],v19,0
M v[64:67],a[132:135],a[48:51]
T a[154:155],v19,4096
M v[68:71],a[132:135],a[52:55]
buffer_load_dwordx4 v[200:203], v59, s[12:15], s63 offen offset:0 sc1
M v[68:71],a[128:131],a[36:39]
M v[72:75],a[128:131],a[40:43]
T a[156:157],v19,8192
M v[72:75],a[132:135],a[56:59]
T a[158:159],v19,12288
M v[76:79],a[132:135],a[60:63]
buffer_load_dwordx4 v[204:207], v59, s[12:15], s63 offen offset:1024 sc1
s_add_u32 s63, s63, 4096
M v[76:79],a[128:131],a[44:47]
s_waitcnt lgkmcnt(8)
M v[92:95],a[140:143],a[60:63]
T a[128:129],v20,0
M v[92:95],a[136:139],a[44:47]
T a[130:131],v20,4096
M v[88:91],a[136:139],a[40:43]
buffer_load_dwordx4 v[208:211], v58, s[12:15], s63 offen offset:0 sc1
M v[88:91],a[140:143],a[56:59]
M v[84:87],a[140:143],a[52:55]
T a[132:133],v20,8192
M v[84:87],a[136:139],a[36:39]
T a[134:135],v20,12288
M v[80:83],a[136:139],a[32:35]
M v[80:83],a[140:143],a[48:51]
s_waitcnt lgkmcnt(8)
M v[96:99],a[144:147],a[32:35]
T a[136:137],v21,0
M v[96:99],a[148:151],a[48:51]
T a[138:139],v21,4096
M v[100:103],a[148:151],a[52:55]
buffer_load_dwordx4 v[212:215], v58, s[12:15], s63 offen offset:1024 sc1
M v[100:103],a[144:147],a[36:39]
M v[104:107],a[144:147],a[40:43]
T a[140:141],v21,8192
M v[104:107],a[148:151],a[56:59]
T a[142:143],v21,12288
M v[108:111],a[148:151],a[60:63]
buffer_load_dwordx4 v[216:219], v59, s[12:15], s63 offen offset:0 sc1
M v[108:111],a[144:147],a[44:47]
s_waitcnt lgkmcnt(8)
M v[124:127],a[156:159],a[60:63]
T a[144:145],v16,16384
M v[124:127],a[152:155],a[44:47]
T a[146:147],v16,20480
M v[120:123],a[152:155],a[40:43]
buffer_load_dwordx4 v[220:223], v59, s[12:15], s63 offen offset:1024 sc1
s_add_u32 s63, s63, 4096
M v[120:123],a[156:159],a[56:59]
M v[116:119],a[156:159],a[52:55]
T a[148:149],v16,24576
M v[116:119],a[152:155],a[36:39]
T a[150:151],v16,28672
M v[112:115],a[152:155],a[32:35]
buffer_load_dwordx4 a[192:195], v58, s[12:15], s63 offen offset:0 sc1
M v[112:115],a[156:159],a[48:51]
s_waitcnt lgkmcnt(8)
M v[128:131],a[128:131],a[32:35]
T a[152:153],v17,16384
M v[128:131],a[132:135],a[48:51]
T a[154:155],v17,20480
M v[132:135],a[132:135],a[52:55]
buffer_load_dwordx4 a[196:199], v58, s[12:15], s63 offen offset:1024 sc1
M v[132:135],a[128:131],a[36:39]
M v[136:139],a[128:131],a[40:43]
T a[156:157],v17,24576
M v[136:139],a[132:135],a[56:59]
T a[158:159],v17,28672
M v[140:143],a[132:135],a[60:63]
buffer_load_dwordx4 a[200:203], v59, s[12:15], s63 offen offset:0 sc1
M v[140:143],a[128:131],a[44:47]
s_waitcnt lgkmcnt(8)
M v[156:159],a[140:143],a[60:63]
T a[128:129],v18,16384
M v[156:159],a[136:139],a[44:47]
T a[130:131],v18,20480
M v[152:155],a[136:139],a[40:43]
M v[152:155],a[140:143],a[56:59]
M v[148:151],a[140:143],a[52:55]
T a[132:133],v18,24576
M v[148:151],a[136:139],a[36:39]
T a[134:135],v18,28672
M v[144:147],a[136:139],a[32:35]
buffer_load_dwordx4 a[204:207], v59, s[12:15], s63 offen offset:1024 sc1
s_add_u32 s63, s63, 4096
M v[144:147],a[140:143],a[48:51]
s_waitcnt vmcnt(28)
s_waitcnt lgkmcnt(8)
M v[64:67],a[144:147],a[64:67]
T a[136:137],v19,16384
M v[64:67],a[148:151],a[80:83]
T a[138:139],v19,20480
M v[68:71],a[148:151],a[84:87]
buffer_load_dwordx4 a[112:115], v58, s[12:15], s63 offen offset:0 sc1
M v[68:71],a[144:147],a[68:71]
M v[72:75],a[144:147],a[72:75]
T a[140:141],v19,24576
M v[72:75],a[148:151],a[88:91]
T a[142:143],v19,28672
M v[76:79],a[148:151],a[92:95]
buffer_load_dwordx4 a[116:119], v58, s[12:15], s63 offen offset:1024 sc1
M v[76:79],a[144:147],a[76:79]
s_waitcnt lgkmcnt(8)
M v[92:95],a[156:159],a[92:95]
T a[144:145],v20,16384
M v[92:95],a[152:155],a[76:79]
T a[146:147],v20,20480
M v[88:91],a[152:155],a[72:75]
buffer_load_dwordx4 a[120:123], v59, s[12:15], s63 offen offset:0 sc1
M v[88:91],a[156:159],a[88:91]
M v[84:87],a[156:159],a[84:87]
T a[148:149],v20,24576
M v[84:87],a[152:155],a[68:71]
T a[150:151],v20,28672
M v[80:83],a[152:155],a[64:67]
buffer_load_dwordx4 a[124:127], v59, s[12:15], s63 offen offset:1024 sc1
s_add_u32 s63, s63, 4096
M v[80:83],a[156:159],a[80:83]
s_waitcnt lgkmcnt(8)
M v[96:99],a[128:131],a[64:67]
T a[152:153],v21,16384
M v[96:99],a[132:135],a[80:83]
T a[154:155],v21,20480
M v[100:103],a[132:135],a[84:87]
buffer_load_dwordx4 a[208:211], v58, s[12:15], s63 offen offset:0 sc1
M v[100:103],a[128:131],a[68:71]
M v[104:107],a[128:131],a[72:75]
T a[156:157],v21,24576
M v[104:107],a[132:135],a[88:91]
T a[158:159],v21,28672
M v[108:111],a[132:135],a[92:95]
M v[108:111],a[128:131],a[76:79]
s_waitcnt vmcnt(41)
s_barrier
s_waitcnt lgkmcnt(8)
M v[124:127],a[140:143],a[92:95]
T a[128:129],v16,32768
M v[124:127],a[136:139],a[76:79]
T a[130:131],v16,36864
M v[120:123],a[136:139],a[72:75]
buffer_load_dwordx4 a[212:215], v58, s[12:15], s63 offen offset:1024 sc1
M v[120:123],a[140:143],a[88:91]
M v[116:119],a[140:143],a[84:87]
T a[132:133],v16,40960
M v[116:119],a[136:139],a[68:71]
T a[134:135],v16,45056
M v[112:115],a[136:139],a[64:67]
buffer_load_dwordx4 a[216:219], v59, s[12:15], s63 offen offset:0 sc1
M v[112:115],a[140:143],a[80:83]
s_waitcnt lgkmcnt(8)
M v[128:131],a[144:147],a[64:67]
T a[136:137],v17,32768
M v[128:131],a[148:151],a[80:83]
T a[138:139],v17,36864
M v[132:135],a[148:151],a[84:87]
buffer_load_dwordx4 a[220:223], v59, s[12:15], s63 offen offset:1024 sc1
s_add_u32 s63, s63, 4096
M v[132:135],a[144:147],a[68:71]
M v[136:139],a[144:147],a[72:75]
T a[140:141],v17,40960
M v[136:139],a[148:151],a[88:91]
T a[142:143],v17,45056
M v[140:143],a[148:151],a[92:95]
buffer_load_dwordx4 a[96:99], v58, s[12:15], s63 offen offset:0 sc1
M v[140:143],a[144:147],a[76:79]
s_waitcnt lgkmcnt(8)
M v[156:159],a[156:159],a[92:95]
T a[144:145],v16,49152
M v[156:159],a[152:155],a[76:79]
T a[146:147],v16,53248
M v[152:155],a[152:155],a[72:75]
buffer_load_dwordx4 a[100:103], v58, s[12:15], s63 offen offset:1024 sc1
M v[152:155],a[156:159],a[88:91]
M v[148:151],a[156:159],a[84:87]
T a[148:149],v16,57344
M v[148:151],a[152:155],a[68:71]
T a[150:151],v16,61440
M v[144:147],a[152:155],a[64:67]
buffer_load_dwordx4 a[104:107], v59, s[12:15], s63 offen offset:0 sc1
M v[144:147],a[156:159],a[80:83]
s_waitcnt vmcnt(31)
s_waitcnt lgkmcnt(8)
M v[64:67],a[128:131],a[240:243]
T a[152:153],v17,49152
M v[64:67],a[132:135],a[176:179]
T a[154:155],v17,53248
M v[68:71],a[132:135],a[180:183]
M v[68:71],a[128:131],a[244:247]
M v[72:75],a[128:131],a[248:251]
T a[156:157],v17,57344
M v[72:75],a[132:135],a[184:187]
T a[158:159],v17,61440
M v[76:79],a[132:135],a[188:191]
buffer_load_dwordx4 a[108:111], v59, s[12:15], s63 offen offset:1024 sc1
s_add_u32 s63, s63, 4096
M v[76:79],a[128:131],a[252:255]
s_waitcnt lgkmcnt(8)
M v[92:95],a[140:143],a[188:191]
T a[128:129],v20,32768
M v[92:95],a[136:139],a[252:255]
T a[130:131],v20,36864
M v[88:91],a[136:139],a[248:251]
M v[88:91],a[140:143],a[184:187]
M v[84:87],a[140:143],a[180:183]
T a[132:133],v20,40960
M v[84:87],a[136:139],a[244:247]
T a[134:135],v20,45056
M v[80:83],a[136:139],a[240:243]
M v[80:83],a[140:143],a[176:179]
s_waitcnt vmcnt(16)
s_waitcnt lgkmcnt(8)
M v[64:67],a[144:147],v[192:195]
T a[136:137],v21,32768
M v[64:67],a[148:151],v[208:211]
T a[138:139],v21,36864
M v[68:71],a[148:151],v[212:215]
M v[68:71],a[144:147],v[196:199]
M v[72:75],a[144:147],v[200:203]
T a[140:141],v21,40960
M v[72:75],a[148:151],v[216:219]
T a[142:143],v21,45056
M v[76:79],a[148:151],v[220:223]
M v[76:79],a[144:147],v[204:207]
s_waitcnt lgkmcnt(8)
M v[92:95],a[156:159],v[220:223]
T a[144:145],v20,49152
M v[92:95],a[152:155],v[204:207]
T a[146:147],v20,53248
M v[88:91],a[152:155],v[200:203]
M v[88:91],a[156:159],v[216:219]
M v[84:87],a[156:159],v[212:215]
T a[148:149],v20,57344
M v[84:87],a[152:155],v[196:199]
T a[150:151],v20,61440
M v[80:83],a[152:155],v[192:195]
M v[80:83],a[156:159],v[208:211]
s_waitcnt lgkmcnt(8)
M v[128:131],a[128:131],a[240:243]
T a[152:153],v21,49152
v_cvt_pk_bf16_f32 v64, v64, v65
M v[128:131],a[132:135],a[176:179]
T a[154:155],v21,53248
v_cvt_pk_bf16_f32 v65, v66, v67
M v[132:135],a[132:135],a[180:183]
v_cvt_pk_bf16_f32 v66, v80, v81
v_cvt_pk_bf16_f32 v67, v82, v83
M v[132:135],a[128:131],a[244:247]
buffer_store_dwordx4 v[64:67], v13, s[12:15], s66 offen offset:0 sc1
v_cvt_pk_bf16_f32 v68, v68, v69
M v[136:139],a[128:131],a[248:251]
T a[156:157],v21,57344
v_cvt_pk_bf16_f32 v69, v70, v71
M v[136:139],a[132:135],a[184:187]
T a[158:159],v21,61440
v_cvt_pk_bf16_f32 v70, v84, v85
M v[140:143],a[132:135],a[188:191]
v_cvt_pk_bf16_f32 v71, v86, v87
buffer_store_dwordx4 v[68:71], v13, s[12:15], s66 offen offset:1024 sc1
M v[140:143],a[128:131],a[252:255]
s_waitcnt vmcnt(26)
s_barrier
s_waitcnt lgkmcnt(8)
M v[156:159],a[140:143],a[188:191]
T a[128:129],v28,0
v_cvt_pk_bf16_f32 v72, v72, v73
M v[156:159],a[136:139],a[252:255]
T a[130:131],v28,4096
v_cvt_pk_bf16_f32 v73, v74, v75
M v[152:155],a[136:139],a[248:251]
v_cvt_pk_bf16_f32 v74, v88, v89
v_cvt_pk_bf16_f32 v75, v90, v91
M v[152:155],a[140:143],a[184:187]
buffer_store_dwordx4 v[72:75], v13, s[12:15], s66 offen offset:2048 sc1
v_cvt_pk_bf16_f32 v76, v76, v77
M v[148:151],a[140:143],a[180:183]
T a[132:133],v28,8192
v_cvt_pk_bf16_f32 v77, v78, v79
M v[148:151],a[136:139],a[244:247]
T a[134:135],v28,12288
v_cvt_pk_bf16_f32 v78, v92, v93
M v[144:147],a[136:139],a[240:243]
v_cvt_pk_bf16_f32 v79, v94, v95
buffer_store_dwordx4 v[76:79], v13, s[12:15], s66 offen offset:3072 sc1
M v[144:147],a[140:143],a[176:179]
s_waitcnt lgkmcnt(8)
M v[128:131],a[144:147],v[192:195]
T a[136:137],v29,0
M v[128:131],a[148:151],v[208:211]
T a[138:139],v29,4096
M v[132:135],a[148:151],v[212:215]
M v[132:135],a[144:147],v[196:199]
M v[136:139],a[144:147],v[200:203]
T a[140:141],v29,8192
M v[136:139],a[148:151],v[216:219]
T a[142:143],v29,12288
M v[140:143],a[148:151],v[220:223]
M v[140:143],a[144:147],v[204:207]
s_waitcnt lgkmcnt(8)
M v[156:159],a[156:159],v[220:223]
T a[144:145],v28,16384
M v[156:159],a[152:155],v[204:207]
T a[146:147],v28,20480
M v[152:155],a[152:155],v[200:203]
M v[152:155],a[156:159],v[216:219]
M v[148:151],a[156:159],v[212:215]
T a[148:149],v28,24576
M v[148:151],a[152:155],v[196:199]
T a[150:151],v28,28672
M v[144:147],a[152:155],v[192:195]
M v[144:147],a[156:159],v[208:211]
s_waitcnt vmcnt(12)
s_waitcnt lgkmcnt(8)
M v[128:131],a[128:131],a[192:195]
T a[152:153],v29,16384
M v[128:131],a[132:135],a[112:115]
T a[154:155],v29,20480
M v[132:135],a[132:135],a[116:119]
M v[132:135],a[128:131],a[196:199]
M v[136:139],a[128:131],a[200:203]
T a[156:157],v29,24576
M v[136:139],a[132:135],a[120:123]
T a[158:159],v29,28672
M v[140:143],a[132:135],a[124:127]
M v[140:143],a[128:131],a[204:207]
s_waitcnt lgkmcnt(8)
M v[156:159],a[140:143],a[124:127]
T a[128:129],v18,32768
M v[156:159],a[136:139],a[204:207]
T a[130:131],v18,36864
M v[152:155],a[136:139],a[200:203]
M v[152:155],a[140:143],a[120:123]
M v[148:151],a[140:143],a[116:119]
T a[132:133],v18,40960
M v[148:151],a[136:139],a[196:199]
T a[134:135],v18,45056
M v[144:147],a[136:139],a[192:195]
M v[144:147],a[140:143],a[112:115]
s_waitcnt vmcnt(4)
s_waitcnt lgkmcnt(8)
M v[128:131],a[144:147],a[208:211]
T a[136:137],v19,32768
M v[128:131],a[148:151],a[96:99]
T a[138:139],v19,36864
M v[132:135],a[148:151],a[100:103]
M v[132:135],a[144:147],a[212:215]
M v[136:139],a[144:147],a[216:219]
T a[140:141],v19,40960
M v[136:139],a[148:151],a[104:107]
T a[142:143],v19,45056
M v[140:143],a[148:151],a[108:111]
M v[140:143],a[144:147],a[220:223]
s_waitcnt lgkmcnt(8)
M v[156:159],a[156:159],a[108:111]
T a[144:145],v18,49152
M v[156:159],a[152:155],a[220:223]
T a[146:147],v18,53248
M v[152:155],a[152:155],a[216:219]
M v[152:155],a[156:159],a[104:107]
M v[148:151],a[156:159],a[100:103]
T a[148:149],v18,57344
M v[148:151],a[152:155],a[212:215]
T a[150:151],v18,61440
M v[144:147],a[152:155],a[208:211]
M v[144:147],a[156:159],a[96:99]
s_waitcnt lgkmcnt(8)
M v[96:99],a[128:131],a[240:243]
T a[152:153],v19,49152
v_cvt_pk_bf16_f32 v128, v128, v129
M v[96:99],a[132:135],a[176:179]
T a[154:155],v19,53248
v_cvt_pk_bf16_f32 v129, v130, v131
M v[100:103],a[132:135],a[180:183]
v_cvt_pk_bf16_f32 v130, v144, v145
v_cvt_pk_bf16_f32 v131, v146, v147
M v[100:103],a[128:131],a[244:247]
buffer_store_dwordx4 v[128:131], v13, s[12:15], s68 offen offset:0 sc1
v_cvt_pk_bf16_f32 v132, v132, v133
M v[104:107],a[128:131],a[248:251]
T a[156:157],v19,57344
v_cvt_pk_bf16_f32 v133, v134, v135
M v[104:107],a[132:135],a[184:187]
T a[158:159],v19,61440
v_cvt_pk_bf16_f32 v134, v148, v149
M v[108:111],a[132:135],a[188:191]
v_cvt_pk_bf16_f32 v135, v150, v151
buffer_store_dwordx4 v[132:135], v13, s[12:15], s68 offen offset:1024 sc1
M v[108:111],a[128:131],a[252:255]
s_waitcnt lgkmcnt(8)
v_cvt_pk_bf16_f32 v136, v136, v137
v_cvt_pk_bf16_f32 v137, v138, v139
M v[124:127],a[140:143],a[188:191]
T a[128:129],v26,0
v_cvt_pk_bf16_f32 v138, v152, v153
M v[124:127],a[136:139],a[252:255]
T a[130:131],v26,4096
v_cvt_pk_bf16_f32 v139, v154, v155
M v[120:123],a[136:139],a[248:251]
buffer_store_dwordx4 v[136:139], v13, s[12:15], s68 offen offset:2048 sc1
v_cvt_pk_bf16_f32 v140, v140, v141
M v[120:123],a[140:143],a[184:187]
v_cvt_pk_bf16_f32 v141, v142, v143
v_cvt_pk_bf16_f32 v142, v156, v157
M v[116:119],a[140:143],a[180:183]
T a[132:133],v26,8192
v_cvt_pk_bf16_f32 v143, v158, v159
M v[116:119],a[136:139],a[244:247]
T a[134:135],v26,12288
buffer_store_dwordx4 v[140:143], v13, s[12:15], s68 offen offset:3072 sc1
M v[112:115],a[136:139],a[240:243]
M v[112:115],a[140:143],a[176:179]
s_waitcnt lgkmcnt(8)
M v[96:99],a[144:147],v[192:195]
T a[136:137],v27,0
M v[96:99],a[148:151],v[208:211]
T a[138:139],v27,4096
M v[100:103],a[148:151],v[212:215]
M v[100:103],a[144:147],v[196:199]
M v[104:107],a[144:147],v[200:203]
T a[140:141],v27,8192
M v[104:107],a[148:151],v[216:219]
T a[142:143],v27,12288
M v[108:111],a[148:151],v[220:223]
M v[108:111],a[144:147],v[204:207]
s_waitcnt lgkmcnt(8)
M v[124:127],a[156:159],v[220:223]
T a[144:145],v26,16384
M v[124:127],a[152:155],v[204:207]
T a[146:147],v26,20480
M v[120:123],a[152:155],v[200:203]
M v[120:123],a[156:159],v[216:219]
L_pad40:
s_cbranch_execz L_pb2
M v[116:119],a[156:159],v[212:215]
T a[148:149],v26,24576
M v[116:119],a[152:155],v[196:199]
T a[150:151],v26,28672
M v[112:115],a[152:155],v[192:195]
M v[112:115],a[156:159],v[208:211]
s_waitcnt lgkmcnt(8)
M v[96:99],a[128:131],a[192:195]
T a[152:153],v27,16384
M v[96:99],a[132:135],a[112:115]
T a[154:155],v27,20480
M v[100:103],a[132:135],a[116:119]
M v[100:103],a[128:131],a[196:199]
M v[104:107],a[128:131],a[200:203]
T a[156:157],v27,24576
M v[104:107],a[132:135],a[120:123]
T a[158:159],v27,28672
M v[108:111],a[132:135],a[124:127]
M v[108:111],a[128:131],a[204:207]
s_waitcnt lgkmcnt(8)
M v[124:127],a[140:143],a[124:127]
T a[128:129],v30,32768
M v[124:127],a[136:139],a[204:207]
T a[130:131],v30,36864
M v[120:123],a[136:139],a[200:203]
M v[120:123],a[140:143],a[120:123]
M v[116:119],a[140:143],a[116:119]
T a[132:133],v30,40960
M v[116:119],a[136:139],a[196:199]
T a[134:135],v30,45056
M v[112:115],a[136:139],a[192:195]
M v[112:115],a[140:143],a[112:115]
s_waitcnt lgkmcnt(8)
M v[96:99],a[144:147],a[208:211]
T a[136:137],v31,32768
M v[96:99],a[148:151],a[96:99]
T a[138:139],v31,36864
M v[100:103],a[148:151],a[100:103]
M v[100:103],a[144:147],a[212:215]
M v[104:107],a[144:147],a[216:219]
T a[140:141],v31,40960
M v[104:107],a[148:151],a[104:107]
T a[142:143],v31,45056
M v[108:111],a[148:151],a[108:111]
M v[108:111],a[144:147],a[220:223]
s_waitcnt lgkmcnt(8)
M v[124:127],a[156:159],a[108:111]
T a[144:145],v30,49152
M v[124:127],a[152:155],a[220:223]
T a[146:147],v30,53248
M v[120:123],a[152:155],a[216:219]
M v[120:123],a[156:159],a[104:107]
M v[116:119],a[156:159],a[100:103]
T a[148:149],v30,57344
M v[116:119],a[152:155],a[212:215]
T a[150:151],v30,61440
M v[112:115],a[152:155],a[208:211]
M v[112:115],a[156:159],a[96:99]
s_waitcnt lgkmcnt(8)
M v[160:163],a[128:131],a[224:227]
T a[152:153],v31,49152
v_cvt_pk_bf16_f32 v96, v96, v97
M v[160:163],a[132:135],a[0:3]
T a[154:155],v31,53248
v_cvt_pk_bf16_f32 v97, v98, v99
M v[164:167],a[132:135],a[4:7]
v_cvt_pk_bf16_f32 v98, v112, v113
v_cvt_pk_bf16_f32 v99, v114, v115
M v[164:167],a[128:131],a[228:231]
buffer_store_dwordx4 v[96:99], v13, s[12:15], s67 offen offset:0 sc1
v_cvt_pk_bf16_f32 v100, v100, v101
M v[168:171],a[128:131],a[232:235]
T a[156:157],v31,57344
v_cvt_pk_bf16_f32 v101, v102, v103
M v[168:171],a[132:135],a[8:11]
T a[158:159],v31,61440
v_cvt_pk_bf16_f32 v102, v116, v117
M v[172:175],a[132:135],a[12:15]
v_cvt_pk_bf16_f32 v103, v118, v119
buffer_store_dwordx4 v[100:103], v13, s[12:15], s67 offen offset:1024 sc1
M v[172:175],a[128:131],a[236:239]
s_waitcnt lgkmcnt(8)
v_cvt_pk_bf16_f32 v104, v104, v105
v_cvt_pk_bf16_f32 v105, v106, v107
M v[188:191],a[140:143],a[12:15]
T a[128:129],v22,0
v_cvt_pk_bf16_f32 v106, v120, v121
M v[188:191],a[136:139],a[236:239]
T a[130:131],v22,4096
v_cvt_pk_bf16_f32 v107, v122, v123
M v[184:187],a[136:139],a[232:235]
buffer_store_dwordx4 v[104:107], v13, s[12:15], s67 offen offset:2048 sc1
v_cvt_pk_bf16_f32 v108, v108, v109
M v[184:187],a[140:143],a[8:11]
v_cvt_pk_bf16_f32 v109, v110, v111
v_cvt_pk_bf16_f32 v110, v124, v125
M v[180:183],a[140:143],a[4:7]
T a[132:133],v22,8192
v_cvt_pk_bf16_f32 v111, v126, v127
M v[180:183],a[136:139],a[228:231]
T a[134:135],v22,12288
buffer_store_dwordx4 v[108:111], v13, s[12:15], s67 offen offset:3072 sc1
M v[176:179],a[136:139],a[224:227]
M v[176:179],a[140:143],a[0:3]
s_waitcnt lgkmcnt(8)
M v[160:163],a[144:147],a[160:163]
T a[136:137],v23,0
M v[160:163],a[148:151],a[16:19]
T a[138:139],v23,4096
M v[164:167],a[148:151],a[20:23]
M v[164:167],a[144:147],a[164:167]
M v[168:171],a[144:147],a[168:171]
T a[140:141],v23,8192
M v[168:171],a[148:151],a[24:27]
T a[142:143],v23,12288
M v[172:175],a[148:151],a[28:31]
M v[172:175],a[144:147],a[172:175]
s_waitcnt lgkmcnt(8)
M v[188:191],a[156:159],a[28:31]
T a[144:145],v22,16384
M v[188:191],a[152:155],a[172:175]
T a[146:147],v22,20480
M v[184:187],a[152:155],a[168:171]
M v[184:187],a[156:159],a[24:27]
M v[180:183],a[156:159],a[20:23]
T a[148:149],v22,24576
M v[180:183],a[152:155],a[164:167]
T a[150:151],v22,28672
M v[176:179],a[152:155],a[160:163]
M v[176:179],a[156:159],a[16:19]
s_waitcnt lgkmcnt(8)
M v[160:163],a[128:131],a[32:35]
T a[152:153],v23,16384
M v[160:163],a[132:135],a[48:51]
T a[154:155],v23,20480
M v[164:167],a[132:135],a[52:55]
M v[164:167],a[128:131],a[36:39]
M v[168:171],a[128:131],a[40:43]
T a[156:157],v23,24576
M v[168:171],a[132:135],a[56:59]
T a[158:159],v23,28672
M v[172:175],a[132:135],a[60:63]
M v[172:175],a[128:131],a[44:47]
s_waitcnt lgkmcnt(8)
M v[188:191],a[140:143],a[60:63]
T a[128:129],v22,32768
M v[188:191],a[136:139],a[44:47]
T a[130:131],v22,36864
M v[184:187],a[136:139],a[40:43]
M v[184:187],a[140:143],a[56:59]
M v[180:183],a[140:143],a[52:55]
T a[132:133],v22,40960
M v[180:183],a[136:139],a[36:39]
T a[134:135],v22,45056
M v[176:179],a[136:139],a[32:35]
M v[176:179],a[140:143],a[48:51]
s_waitcnt lgkmcnt(8)
M v[160:163],a[144:147],a[64:67]
T a[136:137],v23,32768
M v[160:163],a[148:151],a[80:83]
T a[138:139],v23,36864
M v[164:167],a[148:151],a[84:87]
buffer_load_dword v62, v15, s[12:15], s7 offen sc1
M v[164:167],a[144:147],a[68:71]
M v[168:171],a[144:147],a[72:75]
T a[140:141],v23,40960
M v[168:171],a[148:151],a[88:91]
T a[142:143],v23,45056
M v[172:175],a[148:151],a[92:95]
buffer_load_dword v56, v14, s[12:15], s7 offen sc1
M v[172:175],a[144:147],a[76:79]
s_waitcnt lgkmcnt(8)
M v[188:191],a[156:159],a[92:95]
T a[144:145],v22,49152
M v[188:191],a[152:155],a[76:79]
T a[146:147],v22,53248
M v[184:187],a[152:155],a[72:75]
M v[184:187],a[156:159],a[88:91]
M v[180:183],a[156:159],a[84:87]
T a[148:149],v22,57344
M v[180:183],a[152:155],a[68:71]
T a[150:151],v22,61440
M v[176:179],a[152:155],a[64:67]
M v[176:179],a[156:159],a[80:83]
s_waitcnt lgkmcnt(8)
M v[160:163],a[128:131],a[240:243]
T a[152:153],v23,49152
M v[160:163],a[132:135],a[176:179]
T a[154:155],v23,53248
M v[164:167],a[132:135],a[180:183]
M v[164:167],a[128:131],a[244:247]
M v[168:171],a[128:131],a[248:251]
T a[156:157],v23,57344
M v[168:171],a[132:135],a[184:187]
T a[158:159],v23,61440
M v[172:175],a[132:135],a[188:191]
M v[172:175],a[128:131],a[252:255]
s_waitcnt lgkmcnt(8)
M v[188:191],a[140:143],a[188:191]
T a[128:129],v30,0
M v[188:191],a[136:139],a[252:255]
T a[130:131],v30,4096
M v[184:187],a[136:139],a[248:251]
M v[184:187],a[140:143],a[184:187]
M v[180:183],a[140:143],a[180:183]
s_waitcnt vmcnt(2)
T a[132:133],v30,8192
s_barrier
M v[180:183],a[136:139],a[244:247]
s_add_u32 s74, s64, 5
T a[134:135],v30,12288
v_mov_b32 v61, s74
M v[176:179],a[136:139],a[240:243]
buffer_store_dword v61, v60, s[12:15], s65 offen sc1
s_waitcnt vmcnt(1)
M v[176:179],a[140:143],a[176:179]
s_waitcnt lgkmcnt(8)
v_subrev_u32 v62, s73, v62
v_subrev_u32 v56, s73, v56
M v[160:163],a[144:147],v[192:195]
T a[136:137],v31,0
v_cmp_le_u32 vcc, 11, v62
M v[160:163],a[148:151],v[208:211]
T a[138:139],v31,4096
v_max_u32 v56, v56, v62
M v[164:167],a[148:151],v[212:215]
v_cmp_le_u32 s[78:79], 11, v56
M v[164:167],a[144:147],v[196:199]
s_cbranch_vccnz L_g0
buffer_load_dwordx4 a[224:227], v13, s[12:15], s16 offen offset:0 sc1
L_g0:
M v[168:171],a[144:147],v[200:203]
T a[140:141],v31,8192
M v[168:171],a[148:151],v[216:219]
T a[142:143],v31,12288
M v[172:175],a[148:151],v[220:223]
s_cbranch_vccnz L_g1
buffer_load_dwordx4 a[0:3], v13, s[12:15], s18 offen offset:0 sc1
L_g1:
M v[172:175],a[144:147],v[204:207]
s_cmp_lg_u64 s[78:79], 0
s_cbranch_scc1 L_g2
buffer_load_dwordx4 a[160:163], v13, s[12:15], s17 offen offset:0 sc1
L_g2:
s_waitcnt lgkmcnt(8)
M v[188:191],a[156:159],v[220:223]
T a[144:145],v30,16384
M v[188:191],a[152:155],v[204:207]
T a[146:147],v30,20480
M v[184:187],a[152:155],v[200:203]
s_cbranch_vccnz L_g3
buffer_load_dwordx4 a[228:231], v13, s[12:15], s16 offen offset:1024 sc1
L_g3:
M v[184:187],a[156:159],v[216:219]
s_cbranch_vccnz L_g4
buffer_load_dwordx4 a[4:7], v13, s[12:15], s18 offen offset:1024 sc1
L_g4:
M v[180:183],a[156:159],v[212:215]
T a[148:149],v30,24576
M v[180:183],a[152:155],v[196:199]
T a[150:151],v30,28672
M v[176:179],a[152:155],v[192:195]
s_cmp_lg_u64 s[78:79], 0
s_cbranch_scc1 L_g5
buffer_load_dwordx4 a[164:167], v13, s[12:15], s17 offen offset:1024 sc1
L_g5:
M v[176:179],a[156:159],v[208:211]
s_cbranch_vccnz L_g6
buffer_load_dwordx4 a[232:235], v13, s[12:15], s16 offen offset:2048 sc1
L_g6:
s_waitcnt lgkmcnt(8)
M v[160:163],a[128:131],a[192:195]
T a[152:153],v31,16384
M v[160:163],a[132:135],a[112:115]
T a[154:155],v31,20480
M v[164:167],a[132:135],a[116:119]
s_cbranch_vccnz L_g7
buffer_load_dwordx4 a[8:11], v13, s[12:15], s18 offen offset:2048 sc1
L_g7:
M v[164:167],a[128:131],a[196:199]
s_cmp_lg_u64 s[78:79], 0
s_cbranch_scc1 L_g8
buffer_load_dwordx4 a[168:171], v13, s[12:15], s17 offen offset:2048 sc1
L_g8:
M v[168:171],a[128:131],a[200:203]
T a[156:157],v31,24576
M v[168:171],a[132:135],a[120:123]
T a[158:159],v31,28672
M v[172:175],a[132:135],a[124:127]
s_cbranch_vccnz L_g9
buffer_load_dwordx4 a[236:239], v13, s[12:15], s16 offen offset:3072 sc1
L_g9:
M v[172:175],a[128:131],a[204:207]
s_cbranch_vccnz L_g10
buffer_load_dwordx4 a[12:15], v13, s[12:15], s18 offen offset:3072 sc1
L_g10:
s_waitcnt lgkmcnt(8)
M v[188:191],a[140:143],a[124:127]
M v[188:191],a[136:139],a[204:207]
M v[184:187],a[136:139],a[200:203]
s_cmp_lg_u64 s[78:79], 0
s_cbranch_scc1 L_g11
buffer_load_dwordx4 a[172:175], v13, s[12:15], s17 offen offset:3072 sc1
L_g11:
M v[184:187],a[140:143],a[120:123]
buffer_load_dword v62, v15, s[12:15], s7 offen sc1
buffer_load_dword v56, v14, s[12:15], s7 offen sc1
M v[180:183],a[140:143],a[116:119]
M v[180:183],a[136:139],a[196:199]
M v[176:179],a[136:139],a[192:195]
M v[176:179],a[140:143],a[112:115]
s_waitcnt lgkmcnt(4)
M v[160:163],a[144:147],a[208:211]
M v[160:163],a[148:151],a[96:99]
M v[164:167],a[148:151],a[100:103]
M v[164:167],a[144:147],a[212:215]
M v[168:171],a[144:147],a[216:219]
M v[168:171],a[148:151],a[104:107]
M v[172:175],a[148:151],a[108:111]
M v[172:175],a[144:147],a[220:223]
s_waitcnt lgkmcnt(0)
M v[188:191],a[156:159],a[108:111]
M v[188:191],a[152:155],a[220:223]
M v[184:187],a[152:155],a[216:219]
M v[184:187],a[156:159],a[104:107]
M v[180:183],a[156:159],a[100:103]
M v[180:183],a[152:155],a[212:215]
M v[176:179],a[152:155],a[208:211]
M v[176:179],a[156:159],a[96:99]
s_mov_b32 s70, 0xbfb8aa3b
s_mov_b32 s71, s70
s_mov_b32 s3, 262144
s_cmp_lg_u64 s[78:79], 0
s_cbranch_scc1 L_late
L_all:
s_waitcnt vmcnt(12)
N v[80:83],v[34:37],a[224:227],v[40:43]
N v[112:115],v[32:35],a[224:227],v[44:47]
M v[80:83],v[34:37],a[0:3]
M v[112:115],v[32:35],a[0:3]
s_nop 6
v_pk_mul_f32 v[48:49], v[80:81], s[70:71]
v_pk_mul_f32 v[50:51], v[82:83], s[70:71]
v_pk_mul_f32 v[52:53], v[112:113], s[70:71]
v_pk_mul_f32 v[54:55], v[114:115], s[70:71]
v_exp_f32 v48, v48
v_exp_f32 v49, v49
v_exp_f32 v50, v50
v_exp_f32 v51, v51
v_exp_f32 v52, v52
v_exp_f32 v53, v53
v_exp_f32 v54, v54
v_exp_f32 v55, v55
s_waitcnt vmcnt(11)
M v[160:163],v[34:37],a[160:163]
M v[176:179],v[32:35],a[160:163]
s_waitcnt vmcnt(9)
N v[84:87],v[34:37],a[228:231],v[40:43]
N v[116:119],v[32:35],a[228:231],v[44:47]
M v[84:87],v[34:37],a[4:7]
M v[116:119],v[32:35],a[4:7]
v_pk_add_f32 v[48:49], v[48:49], 1.0 op_sel_hi:[1,0]
v_pk_add_f32 v[50:51], v[50:51], 1.0 op_sel_hi:[1,0]
v_pk_add_f32 v[52:53], v[52:53], 1.0 op_sel_hi:[1,0]
v_pk_add_f32 v[54:55], v[54:55], 1.0 op_sel_hi:[1,0]
v_rcp_f32 v48, v48
v_rcp_f32 v49, v49
v_rcp_f32 v50, v50
v_rcp_f32 v51, v51
v_rcp_f32 v52, v52
v_rcp_f32 v53, v53
v_rcp_f32 v54, v54
v_rcp_f32 v55, v55
v_pk_mul_f32 v[80:81], v[80:81], v[48:49]
v_pk_mul_f32 v[82:83], v[82:83], v[50:51]
v_pk_mul_f32 v[112:113], v[112:113], v[52:53]
v_pk_mul_f32 v[114:115], v[114:115], v[54:55]
v_pk_fma_f32 v[160:161], v[160:161], v[80:81], v[224:225]
v_pk_fma_f32 v[162:163], v[162:163], v[82:83], v[226:227]
v_pk_fma_f32 v[176:177], v[176:177], v[112:113], v[228:229]
v_pk_fma_f32 v[178:179], v[178:179], v[114:115], v[230:231]
v_cvt_pk_bf16_f32 v64, v160, v161
v_cvt_pk_bf16_f32 v65, v162, v163
v_cvt_pk_bf16_f32 v66, v176, v177
v_cvt_pk_bf16_f32 v67, v178, v179
s_nop 0
v_permlane32_swap_b32 v64, v66
v_permlane32_swap_b32 v65, v67
s_nop 0
v_permlane16_swap_b32 v64, v66
v_permlane16_swap_b32 v65, v67
buffer_store_dwordx4 v[64:67], v57, s[40:43], s44 offen
v_pk_mul_f32 v[48:49], v[84:85], s[70:71]
v_pk_mul_f32 v[50:51], v[86:87], s[70:71]
v_pk_mul_f32 v[52:53], v[116:117], s[70:71]
v_pk_mul_f32 v[54:55], v[118:119], s[70:71]
v_exp_f32 v48, v48
v_exp_f32 v49, v49
v_exp_f32 v50, v50
v_exp_f32 v51, v51
v_exp_f32 v52, v52
v_exp_f32 v53, v53
v_exp_f32 v54, v54
v_exp_f32 v55, v55
s_waitcnt vmcnt(9)
M v[164:167],v[34:37],a[164:167]
M v[180:183],v[32:35],a[164:167]
s_waitcnt vmcnt(7)
N v[88:91],v[34:37],a[232:235],v[40:43]
N v[120:123],v[32:35],a[232:235],v[44:47]
M v[88:91],v[34:37],a[8:11]
M v[120:123],v[32:35],a[8:11]
v_pk_add_f32 v[48:49], v[48:49], 1.0 op_sel_hi:[1,0]
v_pk_add_f32 v[50:51], v[50:51], 1.0 op_sel_hi:[1,0]
v_pk_add_f32 v[52:53], v[52:53], 1.0 op_sel_hi:[1,0]
v_pk_add_f32 v[54:55], v[54:55], 1.0 op_sel_hi:[1,0]
v_rcp_f32 v48, v48
v_rcp_f32 v49, v49
v_rcp_f32 v50, v50
v_rcp_f32 v51, v51
v_rcp_f32 v52, v52
v_rcp_f32 v53, v53
v_rcp_f32 v54, v54
v_rcp_f32 v55, v55
v_pk_mul_f32 v[84:85], v[84:85], v[48:49]
v_pk_mul_f32 v[86:87], v[86:87], v[50:51]
v_pk_mul_f32 v[116:117], v[116:117], v[52:53]
v_pk_mul_f32 v[118:119], v[118:119], v[54:55]
v_pk_fma_f32 v[164:165], v[164:165], v[84:85], v[232:233]
v_pk_fma_f32 v[166:167], v[166:167], v[86:87], v[234:235]
v_pk_fma_f32 v[180:181], v[180:181], v[116:117], v[236:237]
v_pk_fma_f32 v[182:183], v[182:183], v[118:119], v[238:239]
v_cvt_pk_bf16_f32 v68, v164, v165
v_cvt_pk_bf16_f32 v69, v166, v167
v_cvt_pk_bf16_f32 v70, v180, v181
v_cvt_pk_bf16_f32 v71, v182, v183
s_nop 0
v_permlane32_swap_b32 v68, v70
v_permlane32_swap_b32 v69, v71
s_nop 0
v_permlane16_swap_b32 v68, v70
v_permlane16_swap_b32 v69, v71
buffer_store_dwordx4 v[68:71], v57, s[40:43], s45 offen
v_pk_mul_f32 v[48:49], v[88:89], s[70:71]
v_pk_mul_f32 v[50:51], v[90:91], s[70:71]
v_pk_mul_f32 v[52:53], v[120:121], s[70:71]
v_pk_mul_f32 v[54:55], v[122:123], s[70:71]
v_exp_f32 v48, v48
v_exp_f32 v49, v49
v_exp_f32 v50, v50
v_exp_f32 v51, v51
v_exp_f32 v52, v52
v_exp_f32 v53, v53
v_exp_f32 v54, v54
v_exp_f32 v55, v55
s_waitcnt vmcnt(7)
M v[168:171],v[34:37],a[168:171]
M v[184:187],v[32:35],a[168:171]
s_waitcnt vmcnt(5)
N v[92:95],v[34:37],a[236:239],v[40:43]
N v[124:127],v[32:35],a[236:239],v[44:47]
M v[92:95],v[34:37],a[12:15]
M v[124:127],v[32:35],a[12:15]
v_pk_add_f32 v[48:49], v[48:49], 1.0 op_sel_hi:[1,0]
v_pk_add_f32 v[50:51], v[50:51], 1.0 op_sel_hi:[1,0]
v_pk_add_f32 v[52:53], v[52:53], 1.0 op_sel_hi:[1,0]
v_pk_add_f32 v[54:55], v[54:55], 1.0 op_sel_hi:[1,0]
v_rcp_f32 v48, v48
v_rcp_f32 v49, v49
v_rcp_f32 v50, v50
v_rcp_f32 v51, v51
v_rcp_f32 v52, v52
v_rcp_f32 v53, v53
v_rcp_f32 v54, v54
v_rcp_f32 v55, v55
v_pk_mul_f32 v[88:89], v[88:89], v[48:49]
v_pk_mul_f32 v[90:91], v[90:91], v[50:51]
v_pk_mul_f32 v[120:121], v[120:121], v[52:53]
v_pk_mul_f32 v[122:123], v[122:123], v[54:55]
v_pk_fma_f32 v[168:169], v[168:169], v[88:89], v[240:241]
v_pk_fma_f32 v[170:171], v[170:171], v[90:91], v[242:243]
v_pk_fma_f32 v[184:185], v[184:185], v[120:121], v[244:245]
v_pk_fma_f32 v[186:187], v[186:187], v[122:123], v[246:247]
v_cvt_pk_bf16_f32 v72, v168, v169
v_cvt_pk_bf16_f32 v73, v170, v171
v_cvt_pk_bf16_f32 v74, v184, v185
v_cvt_pk_bf16_f32 v75, v186, v187
s_nop 0
v_permlane32_swap_b32 v72, v74
v_permlane32_swap_b32 v73, v75
s_nop 0
v_permlane16_swap_b32 v72, v74
v_permlane16_swap_b32 v73, v75
buffer_store_dwordx4 v[72:75], v57, s[40:43], s46 offen
v_pk_mul_f32 v[48:49], v[92:93], s[70:71]
v_pk_mul_f32 v[50:51], v[94:95], s[70:71]
v_pk_mul_f32 v[52:53], v[124:125], s[70:71]
v_pk_mul_f32 v[54:55], v[126:127], s[70:71]
v_exp_f32 v48, v48
v_exp_f32 v49, v49
v_exp_f32 v50, v50
v_exp_f32 v51, v51
v_exp_f32 v52, v52
v_exp_f32 v53, v53
v_exp_f32 v54, v54
v_exp_f32 v55, v55
s_waitcnt vmcnt(5)
M v[172:175],v[34:37],a[172:175]
M v[188:191],v[32:35],a[172:175]
v_pk_add_f32 v[48:49], v[48:49], 1.0 op_sel_hi:[1,0]
v_pk_add_f32 v[50:51], v[50:51], 1.0 op_sel_hi:[1,0]
v_pk_add_f32 v[52:53], v[52:53], 1.0 op_sel_hi:[1,0]
v_pk_add_f32 v[54:55], v[54:55], 1.0 op_sel_hi:[1,0]
v_rcp_f32 v48, v48
v_rcp_f32 v49, v49
v_rcp_f32 v50, v50
v_rcp_f32 v51, v51
v_rcp_f32 v52, v52
v_rcp_f32 v53, v53
v_rcp_f32 v54, v54
v_rcp_f32 v55, v55
v_pk_mul_f32 v[92:93], v[92:93], v[48:49]
v_pk_mul_f32 v[94:95], v[94:95], v[50:51]
v_pk_mul_f32 v[124:125], v[124:125], v[52:53]
v_pk_mul_f32 v[126:127], v[126:127], v[54:55]
v_pk_fma_f32 v[172:173], v[172:173], v[92:93], v[248:249]
v_pk_fma_f32 v[174:175], v[174:175], v[94:95], v[250:251]
v_pk_fma_f32 v[188:189], v[188:189], v[124:125], v[252:253]
v_pk_fma_f32 v[190:191], v[190:191], v[126:127], v[254:255]
v_cvt_pk_bf16_f32 v76, v172, v173
v_cvt_pk_bf16_f32 v77, v174, v175
v_cvt_pk_bf16_f32 v78, v188, v189
v_cvt_pk_bf16_f32 v79, v190, v191
s_nop 0
v_permlane32_swap_b32 v76, v78
v_permlane32_swap_b32 v77, v79
s_nop 0
v_permlane16_swap_b32 v76, v78
v_permlane16_swap_b32 v77, v79
buffer_store_dwordx4 v[76:79], v57, s[40:43], s47 offen
L_fin:
L_end:
s_endpgm
L_late:
s_cbranch_vccz L_late2
L_spf:
buffer_load_dword v60, v15, s[12:15], s7 offen sc1
buffer_load_dword v61, v14, s[12:15], s7 offen sc1
s_waitcnt vmcnt(2)
v_subrev_u32 v62, s73, v62
v_cmp_le_u32 vcc, 11, v62
v_mov_b32 v48, v56
s_cbranch_vccz L_fok
buffer_load_dword v62, v15, s[12:15], s7 offen sc1
buffer_load_dword v56, v14, s[12:15], s7 offen sc1
s_waitcnt vmcnt(2)
v_subrev_u32 v60, s73, v60
v_cmp_le_u32 vcc, 11, v60
v_mov_b32 v48, v61
s_cbranch_vccz L_fok
s_sub_u32 s3, s3, 1
s_cmp_gt_i32 s3, 0
s_cbranch_scc1 L_spf
L_fok:
v_subrev_u32 v48, s73, v48
v_cmp_le_u32 vcc, 11, v48
s_cbranch_vccnz L_fonly
buffer_load_dwordx4 a[224:227], v13, s[12:15], s16 offen offset:0 sc1
buffer_load_dwordx4 a[0:3], v13, s[12:15], s18 offen offset:0 sc1
buffer_load_dwordx4 a[160:163], v13, s[12:15], s17 offen offset:0 sc1
buffer_load_dwordx4 a[228:231], v13, s[12:15], s16 offen offset:1024 sc1
buffer_load_dwordx4 a[4:7], v13, s[12:15], s18 offen offset:1024 sc1
buffer_load_dwordx4 a[164:167], v13, s[12:15], s17 offen offset:1024 sc1
buffer_load_dwordx4 a[232:235], v13, s[12:15], s16 offen offset:2048 sc1
buffer_load_dwordx4 a[8:11], v13, s[12:15], s18 offen offset:2048 sc1
buffer_load_dwordx4 a[168:171], v13, s[12:15], s17 offen offset:2048 sc1
buffer_load_dwordx4 a[236:239], v13, s[12:15], s16 offen offset:3072 sc1
buffer_load_dwordx4 a[12:15], v13, s[12:15], s18 offen offset:3072 sc1
buffer_load_dwordx4 a[172:175], v13, s[12:15], s17 offen offset:3072 sc1
buffer_load_dword v62, v15, s[12:15], s7 offen sc1
buffer_load_dword v56, v14, s[12:15], s7 offen sc1
s_branch L_all
L_fonly:
buffer_load_dwordx4 a[224:227], v13, s[12:15], s16 offen offset:0 sc1
buffer_load_dwordx4 a[0:3], v13, s[12:15], s18 offen offset:0 sc1
buffer_load_dwordx4 a[228:231], v13, s[12:15], s16 offen offset:1024 sc1
buffer_load_dwordx4 a[4:7], v13, s[12:15], s18 offen offset:1024 sc1
buffer_load_dwordx4 a[232:235], v13, s[12:15], s16 offen offset:2048 sc1
buffer_load_dwordx4 a[8:11], v13, s[12:15], s18 offen offset:2048 sc1
buffer_load_dwordx4 a[236:239], v13, s[12:15], s16 offen offset:3072 sc1
buffer_load_dwordx4 a[12:15], v13, s[12:15], s18 offen offset:3072 sc1
buffer_load_dword v62, v15, s[12:15], s7 offen sc1
buffer_load_dword v56, v14, s[12:15], s7 offen sc1
L_late2:
buffer_load_dword v61, v14, s[12:15], s7 offen sc1
s_waitcnt vmcnt(9)
N v[80:83],v[34:37],a[224:227],v[40:43]
N v[112:115],v[32:35],a[224:227],v[44:47]
M v[80:83],v[34:37],a[0:3]
M v[112:115],v[32:35],a[0:3]
s_nop 6
v_pk_mul_f32 v[48:49], v[80:81], s[70:71]
v_pk_mul_f32 v[50:51], v[82:83], s[70:71]
v_pk_mul_f32 v[52:53], v[112:113], s[70:71]
v_pk_mul_f32 v[54:55], v[114:115], s[70:71]
v_exp_f32 v48, v48
v_exp_f32 v49, v49
v_exp_f32 v50, v50
v_exp_f32 v51, v51
v_exp_f32 v52, v52
v_exp_f32 v53, v53
v_exp_f32 v54, v54
v_exp_f32 v55, v55
s_waitcnt vmcnt(7)
N v[84:87],v[34:37],a[228:231],v[40:43]
N v[116:119],v[32:35],a[228:231],v[44:47]
M v[84:87],v[34:37],a[4:7]
M v[116:119],v[32:35],a[4:7]
v_pk_add_f32 v[48:49], v[48:49], 1.0 op_sel_hi:[1,0]
L_pad41:
s_cbranch_execz L_pb2
v_pk_add_f32 v[50:51], v[50:51], 1.0 op_sel_hi:[1,0]
v_pk_add_f32 v[52:53], v[52:53], 1.0 op_sel_hi:[1,0]
v_pk_add_f32 v[54:55], v[54:55], 1.0 op_sel_hi:[1,0]
v_rcp_f32 v48, v48
v_rcp_f32 v49, v49
v_rcp_f32 v50, v50
v_rcp_f32 v51, v51
v_rcp_f32 v52, v52
v_rcp_f32 v53, v53
v_rcp_f32 v54, v54
v_rcp_f32 v55, v55
v_pk_mul_f32 v[80:81], v[80:81], v[48:49]
v_pk_mul_f32 v[82:83], v[82:83], v[50:51]
v_pk_mul_f32 v[112:113], v[112:113], v[52:53]
v_pk_mul_f32 v[114:115], v[114:115], v[54:55]
v_pk_mul_f32 v[48:49], v[84:85], s[70:71]
v_pk_mul_f32 v[50:51], v[86:87], s[70:71]
v_pk_mul_f32 v[52:53], v[116:117], s[70:71]
v_pk_mul_f32 v[54:55], v[118:119], s[70:71]
v_exp_f32 v48, v48
v_exp_f32 v49, v49
v_exp_f32 v50, v50
v_exp_f32 v51, v51
v_exp_f32 v52, v52
v_exp_f32 v53, v53
v_exp_f32 v54, v54
v_exp_f32 v55, v55
v_pk_add_f32 v[48:49], v[48:49], 1.0 op_sel_hi:[1,0]
v_pk_add_f32 v[50:51], v[50:51], 1.0 op_sel_hi:[1,0]
v_pk_add_f32 v[52:53], v[52:53], 1.0 op_sel_hi:[1,0]
v_pk_add_f32 v[54:55], v[54:55], 1.0 op_sel_hi:[1,0]
v_rcp_f32 v48, v48
v_rcp_f32 v49, v49
v_rcp_f32 v50, v50
v_rcp_f32 v51, v51
v_rcp_f32 v52, v52
v_rcp_f32 v53, v53
v_rcp_f32 v54, v54
v_rcp_f32 v55, v55
v_pk_mul_f32 v[84:85], v[84:85], v[48:49]
v_pk_mul_f32 v[86:87], v[86:87], v[50:51]
v_pk_mul_f32 v[116:117], v[116:117], v[52:53]
v_pk_mul_f32 v[118:119], v[118:119], v[54:55]
s_waitcnt vmcnt(1)
N v[88:91],v[34:37],a[232:235],v[40:43]
N v[120:123],v[32:35],a[232:235],v[44:47]
M v[88:91],v[34:37],a[8:11]
M v[120:123],v[32:35],a[8:11]
N v[92:95],v[34:37],a[236:239],v[40:43]
N v[124:127],v[32:35],a[236:239],v[44:47]
M v[92:95],v[34:37],a[12:15]
M v[124:127],v[32:35],a[12:15]
v_subrev_u32 v56, s73, v56
v_cmp_le_u32 vcc, 11, v56
s_cbranch_vccnz L_no
buffer_load_dwordx4 a[160:163], v13, s[12:15], s17 offen offset:0 sc1
buffer_load_dwordx4 a[164:167], v13, s[12:15], s17 offen offset:1024 sc1
buffer_load_dwordx4 a[168:171], v13, s[12:15], s17 offen offset:2048 sc1
buffer_load_dwordx4 a[172:175], v13, s[12:15], s17 offen offset:3072 sc1
s_branch L_yes
L_no:
buffer_load_dword v56, v14, s[12:15], s7 offen sc1
L_yes:
v_pk_mul_f32 v[48:49], v[88:89], s[70:71]
v_pk_mul_f32 v[50:51], v[90:91], s[70:71]
v_pk_mul_f32 v[52:53], v[120:121], s[70:71]
v_pk_mul_f32 v[54:55], v[122:123], s[70:71]
v_exp_f32 v48, v48
v_exp_f32 v49, v49
v_exp_f32 v50, v50
v_exp_f32 v51, v51
v_exp_f32 v52, v52
v_exp_f32 v53, v53
v_exp_f32 v54, v54
v_exp_f32 v55, v55
v_pk_add_f32 v[48:49], v[48:49], 1.0 op_sel_hi:[1,0]
v_pk_add_f32 v[50:51], v[50:51], 1.0 op_sel_hi:[1,0]
v_pk_add_f32 v[52:53], v[52:53], 1.0 op_sel_hi:[1,0]
v_pk_add_f32 v[54:55], v[54:55], 1.0 op_sel_hi:[1,0]
v_rcp_f32 v48, v48
v_rcp_f32 v49, v49
v_rcp_f32 v50, v50
v_rcp_f32 v51, v51
v_rcp_f32 v52, v52
v_rcp_f32 v53, v53
v_rcp_f32 v54, v54
v_rcp_f32 v55, v55
v_pk_mul_f32 v[88:89], v[88:89], v[48:49]
v_pk_mul_f32 v[90:91], v[90:91], v[50:51]
v_pk_mul_f32 v[120:121], v[120:121], v[52:53]
v_pk_mul_f32 v[122:123], v[122:123], v[54:55]
v_pk_mul_f32 v[48:49], v[92:93], s[70:71]
v_pk_mul_f32 v[50:51], v[94:95], s[70:71]
v_pk_mul_f32 v[52:53], v[124:125], s[70:71]
v_pk_mul_f32 v[54:55], v[126:127], s[70:71]
v_exp_f32 v48, v48
v_exp_f32 v49, v49
v_exp_f32 v50, v50
v_exp_f32 v51, v51
v_exp_f32 v52, v52
v_exp_f32 v53, v53
v_exp_f32 v54, v54
v_exp_f32 v55, v55
v_pk_add_f32 v[48:49], v[48:49], 1.0 op_sel_hi:[1,0]
v_pk_add_f32 v[50:51], v[50:51], 1.0 op_sel_hi:[1,0]
v_pk_add_f32 v[52:53], v[52:53], 1.0 op_sel_hi:[1,0]
v_pk_add_f32 v[54:55], v[54:55], 1.0 op_sel_hi:[1,0]
v_rcp_f32 v48, v48
v_rcp_f32 v49, v49
v_rcp_f32 v50, v50
v_rcp_f32 v51, v51
v_rcp_f32 v52, v52
v_rcp_f32 v53, v53
v_rcp_f32 v54, v54
v_rcp_f32 v55, v55
v_pk_mul_f32 v[92:93], v[92:93], v[48:49]
v_pk_mul_f32 v[94:95], v[94:95], v[50:51]
v_pk_mul_f32 v[124:125], v[124:125], v[52:53]
v_pk_mul_f32 v[126:127], v[126:127], v[54:55]
L_sx:
s_cbranch_vccz L_got2
L_spyb:
s_waitcnt vmcnt(1)
v_subrev_u32 v61, s73, v61
v_cmp_le_u32 vcc, 11, v61
s_cbranch_vccz L_got
buffer_load_dword v61, v14, s[12:15], s7 offen sc1
L_spya:
s_waitcnt vmcnt(1)
v_subrev_u32 v56, s73, v56
v_cmp_le_u32 vcc, 11, v56
s_cbranch_vccz L_got
buffer_load_dword v56, v14, s[12:15], s7 offen sc1
s_sub_u32 s3, s3, 1
s_cmp_gt_i32 s3, 0
s_cbranch_scc1 L_spyb
L_got:
buffer_load_dwordx4 a[160:163], v13, s[12:15], s17 offen offset:0 sc1
buffer_load_dwordx4 a[164:167], v13, s[12:15], s17 offen offset:1024 sc1
buffer_load_dwordx4 a[168:171], v13, s[12:15], s17 offen offset:2048 sc1
buffer_load_dwordx4 a[172:175], v13, s[12:15], s17 offen offset:3072 sc1
L_got2:
s_waitcnt vmcnt(3)
M v[160:163],v[34:37],a[160:163]
M v[176:179],v[32:35],a[160:163]
s_waitcnt vmcnt(2)
M v[164:167],v[34:37],a[164:167]
M v[180:183],v[32:35],a[164:167]
s_nop 3
v_pk_fma_f32 v[160:161], v[160:161], v[80:81], v[224:225]
v_pk_fma_f32 v[162:163], v[162:163], v[82:83], v[226:227]
v_pk_fma_f32 v[176:177], v[176:177], v[112:113], v[228:229]
v_pk_fma_f32 v[178:179], v[178:179], v[114:115], v[230:231]
v_cvt_pk_bf16_f32 v64, v160, v161
v_cvt_pk_bf16_f32 v65, v162, v163
v_cvt_pk_bf16_f32 v66, v176, v177
v_cvt_pk_bf16_f32 v67, v178, v179
s_nop 0
v_permlane32_swap_b32 v64, v66
v_permlane32_swap_b32 v65, v67
s_nop 0
v_permlane16_swap_b32 v64, v66
v_permlane16_swap_b32 v65, v67
buffer_store_dwordx4 v[64:67], v57, s[40:43], s44 offen
s_waitcnt vmcnt(2)
M v[168:171],v[34:37],a[168:171]
M v[184:187],v[32:35],a[168:171]
v_pk_fma_f32 v[164:165], v[164:165], v[84:85], v[232:233]
v_pk_fma_f32 v[166:167], v[166:167], v[86:87], v[234:235]
v_pk_fma_f32 v[180:181], v[180:181], v[116:117], v[236:237]
v_pk_fma_f32 v[182:183], v[182:183], v[118:119], v[238:239]
v_cvt_pk_bf16_f32 v68, v164, v165
v_cvt_pk_bf16_f32 v69, v166, v167
v_cvt_pk_bf16_f32 v70, v180, v181
v_cvt_pk_bf16_f32 v71, v182, v183
s_nop 0
v_permlane32_swap_b32 v68, v70
v_permlane32_swap_b32 v69, v71
s_nop 0
v_permlane16_swap_b32 v68, v70
v_permlane16_swap_b32 v69, v71
buffer_store_dwordx4 v[68:71], v57, s[40:43], s45 offen
s_waitcnt vmcnt(2)
M v[172:175],v[34:37],a[172:175]
M v[188:191],v[32:35],a[172:175]
v_pk_fma_f32 v[168:169], v[168:169], v[88:89], v[240:241]
v_pk_fma_f32 v[170:171], v[170:171], v[90:91], v[242:243]
v_pk_fma_f32 v[184:185], v[184:185], v[120:121], v[244:245]
v_pk_fma_f32 v[186:187], v[186:187], v[122:123], v[246:247]
v_cvt_pk_bf16_f32 v72, v168, v169
v_cvt_pk_bf16_f32 v73, v170, v171
v_cvt_pk_bf16_f32 v74, v184, v185
v_cvt_pk_bf16_f32 v75, v186, v187
s_nop 0
v_permlane32_swap_b32 v72, v74
v_permlane32_swap_b32 v73, v75
s_nop 0
v_permlane16_swap_b32 v72, v74
v_permlane16_swap_b32 v73, v75
buffer_store_dwordx4 v[72:75], v57, s[40:43], s46 offen
v_pk_fma_f32 v[172:173], v[172:173], v[92:93], v[248:249]
v_pk_fma_f32 v[174:175], v[174:175], v[94:95], v[250:251]
v_pk_fma_f32 v[188:189], v[188:189], v[124:125], v[252:253]
v_pk_fma_f32 v[190:191], v[190:191], v[126:127], v[254:255]
v_cvt_pk_bf16_f32 v76, v172, v173
v_cvt_pk_bf16_f32 v77, v174, v175
v_cvt_pk_bf16_f32 v78, v188, v189
v_cvt_pk_bf16_f32 v79, v190, v191
s_nop 0
v_permlane32_swap_b32 v76, v78
v_permlane32_swap_b32 v77, v79
s_nop 0
v_permlane16_swap_b32 v76, v78
v_permlane16_swap_b32 v77, v79
buffer_store_dwordx4 v[76:79], v57, s[40:43], s47 offen
s_endpgm
L_slow:
s_nop 7
s_lshl_b32 s70, s55, 19
s_add_u32 s70, s70, 393216
v_and_b32 v40, 15, v0
v_lshlrev_b32 v41, 8, v40
v_lshl_add_u32 v41, v63, 1, v41
v_lshlrev_b32 v42, 7, v63
v_lshl_add_u32 v42, v40, 1, v42
v_mov_b32 v192, 0xff800000
v_mov_b32 v196, 0xff800000
v_mov_b32 v200, 0xff800000
v_mov_b32 v204, 0xff800000
s_mov_b32 s71, 0
L_slow1:
s_lshl_b32 s72, s71, 13
s_add_u32 s72, s72, s70
s_add_u32 s73, s72, 4096
buffer_load_dwordx4 v[160:163], v41, s[20:23], s72 offen offset:0
buffer_load_dwordx4 v[164:167], v41, s[20:23], s72 offen offset:64
buffer_load_dwordx4 v[168:171], v41, s[20:23], s72 offen offset:128
buffer_load_dwordx4 v[172:175], v41, s[20:23], s72 offen offset:192
buffer_load_dwordx4 v[176:179], v41, s[20:23], s73 offen offset:0
buffer_load_dwordx4 v[180:183], v41, s[20:23], s73 offen offset:64
buffer_load_dwordx4 v[184:187], v41, s[20:23], s73 offen offset:128
buffer_load_dwordx4 v[188:191], v41, s[20:23], s73 offen offset:192
s_waitcnt vmcnt(0)
N v[128:131],v[160:163],v[64:67],0
N v[136:139],v[160:163],v[80:83],0
N v[144:147],v[160:163],v[96:99],0
N v[152:155],v[160:163],v[112:115],0
M v[128:131],v[164:167],v[68:71]
M v[136:139],v[164:167],v[84:87]
M v[144:147],v[164:167],v[100:103]
M v[152:155],v[164:167],v[116:119]
M v[128:131],v[168:171],v[72:75]
M v[136:139],v[168:171],v[88:91]
M v[144:147],v[168:171],v[104:107]
M v[152:155],v[168:171],v[120:123]
M v[128:131],v[172:175],v[76:79]
M v[136:139],v[172:175],v[92:95]
M v[144:147],v[172:175],v[108:111]
M v[152:155],v[172:175],v[124:127]
N v[132:135],v[176:179],v[64:67],0
N v[140:143],v[176:179],v[80:83],0
N v[148:151],v[176:179],v[96:99],0
N v[156:159],v[176:179],v[112:115],0
M v[132:135],v[180:183],v[68:71]
M v[140:143],v[180:183],v[84:87]
M v[148:151],v[180:183],v[100:103]
M v[156:159],v[180:183],v[116:119]
M v[132:135],v[184:187],v[72:75]
M v[140:143],v[184:187],v[88:91]
M v[148:151],v[184:187],v[104:107]
M v[156:159],v[184:187],v[120:123]
M v[132:135],v[188:191],v[76:79]
M v[140:143],v[188:191],v[92:95]
M v[148:151],v[188:191],v[108:111]
M v[156:159],v[188:191],v[124:127]
v_max3_f32 v192, v192, v128, v129
v_max3_f32 v192, v192, v130, v131
s_nop 2
v_max3_f32 v192, v192, v132, v133
v_max3_f32 v192, v192, v134, v135
v_max3_f32 v196, v196, v136, v137
v_max3_f32 v196, v196, v138, v139
v_max3_f32 v196, v196, v140, v141
v_max3_f32 v196, v196, v142, v143
v_max3_f32 v200, v200, v144, v145
v_max3_f32 v200, v200, v146, v147
v_max3_f32 v200, v200, v148, v149
v_max3_f32 v200, v200, v150, v151
v_max3_f32 v204, v204, v152, v153
v_max3_f32 v204, v204, v154, v155
v_max3_f32 v204, v204, v156, v157
v_max3_f32 v204, v204, v158, v159
s_add_u32 s71, s71, 1
s_cmp_lt_u32 s71, 16
s_cbranch_scc1 L_slow1
v_mov_b32 v193, v192
s_nop 1
v_permlane32_swap_b32 v192, v193
v_max_f32 v192, v192, v193
v_mov_b32 v193, v192
s_nop 1
v_permlane16_swap_b32 v192, v193
v_max_f32 v192, v192, v193
v_sub_f32 v195, 0, v192
v_sub_f32 v194, 0, v192
v_sub_f32 v193, 0, v192
v_sub_f32 v192, 0, v192
v_mov_b32 v197, v196
s_nop 1
v_permlane32_swap_b32 v196, v197
v_max_f32 v196, v196, v197
v_mov_b32 v197, v196
s_nop 1
v_permlane16_swap_b32 v196, v197
v_max_f32 v196, v196, v197
v_sub_f32 v199, 0, v196
v_sub_f32 v198, 0, v196
v_sub_f32 v197, 0, v196
v_sub_f32 v196, 0, v196
v_mov_b32 v201, v200
s_nop 1
v_permlane32_swap_b32 v200, v201
v_max_f32 v200, v200, v201
v_mov_b32 v201, v200
s_nop 1
v_permlane16_swap_b32 v200, v201
v_max_f32 v200, v200, v201
v_sub_f32 v203, 0, v200
v_sub_f32 v202, 0, v200
v_sub_f32 v201, 0, v200
v_sub_f32 v200, 0, v200
v_mov_b32 v205, v204
s_nop 1
v_permlane32_swap_b32 v204, v205
v_max_f32 v204, v204, v205
v_mov_b32 v205, v204
s_nop 1
v_permlane16_swap_b32 v204, v205
v_max_f32 v204, v204, v205
v_sub_f32 v207, 0, v204
v_sub_f32 v206, 0, v204
v_sub_f32 v205, 0, v204
v_sub_f32 v204, 0, v204
v_accvgpr_write_b32 a0, 0
v_accvgpr_write_b32 a1, 0
v_accvgpr_write_b32 a2, 0
v_accvgpr_write_b32 a3, 0
v_accvgpr_write_b32 a4, 0
v_accvgpr_write_b32 a5, 0
v_accvgpr_write_b32 a6, 0
v_accvgpr_write_b32 a7, 0
v_accvgpr_write_b32 a8, 0
v_accvgpr_write_b32 a9, 0
v_accvgpr_write_b32 a10, 0
v_accvgpr_write_b32 a11, 0
v_accvgpr_write_b32 a12, 0
v_accvgpr_write_b32 a13, 0
v_accvgpr_write_b32 a14, 0
v_accvgpr_write_b32 a15, 0
v_accvgpr_write_b32 a16, 0
v_accvgpr_write_b32 a17, 0
v_accvgpr_write_b32 a18, 0
v_accvgpr_write_b32 a19, 0
v_accvgpr_write_b32 a20, 0
v_accvgpr_write_b32 a21, 0
v_accvgpr_write_b32 a22, 0
v_accvgpr_write_b32 a23, 0
v_accvgpr_write_b32 a24, 0
v_accvgpr_write_b32 a25, 0
v_accvgpr_write_b32 a26, 0
v_accvgpr_write_b32 a27, 0
v_accvgpr_write_b32 a28, 0
v_accvgpr_write_b32 a29, 0
v_accvgpr_write_b32 a30, 0
v_accvgpr_write_b32 a31, 0
v_accvgpr_write_b32 a32, 0
v_accvgpr_write_b32 a33, 0
v_accvgpr_write_b32 a34, 0
v_accvgpr_write_b32 a35, 0
v_accvgpr_write_b32 a36, 0
v_accvgpr_write_b32 a37, 0
v_accvgpr_write_b32 a38, 0
v_accvgpr_write_b32 a39, 0
v_accvgpr_write_b32 a40, 0
v_accvgpr_write_b32 a41, 0
v_accvgpr_write_b32 a42, 0
v_accvgpr_write_b32 a43, 0
v_accvgpr_write_b32 a44, 0
v_accvgpr_write_b32 a45, 0
v_accvgpr_write_b32 a46, 0
v_accvgpr_write_b32 a47, 0
v_accvgpr_write_b32 a48, 0
v_accvgpr_write_b32 a49, 0
v_accvgpr_write_b32 a50, 0
v_accvgpr_write_b32 a51, 0
v_accvgpr_write_b32 a52, 0
v_accvgpr_write_b32 a53, 0
v_accvgpr_write_b32 a54, 0
v_accvgpr_write_b32 a55, 0
v_accvgpr_write_b32 a56, 0
v_accvgpr_write_b32 a57, 0
v_accvgpr_write_b32 a58, 0
v_accvgpr_write_b32 a59, 0
v_accvgpr_write_b32 a60, 0
v_accvgpr_write_b32 a61, 0
v_accvgpr_write_b32 a62, 0
v_accvgpr_write_b32 a63, 0
v_accvgpr_write_b32 a64, 0
v_accvgpr_write_b32 a65, 0
v_accvgpr_write_b32 a66, 0
v_accvgpr_write_b32 a67, 0
v_accvgpr_write_b32 a68, 0
v_accvgpr_write_b32 a69, 0
v_accvgpr_write_b32 a70, 0
v_accvgpr_write_b32 a71, 0
v_accvgpr_write_b32 a72, 0
v_accvgpr_write_b32 a73, 0
v_accvgpr_write_b32 a74, 0
v_accvgpr_write_b32 a75, 0
v_accvgpr_write_b32 a76, 0
v_accvgpr_write_b32 a77, 0
v_accvgpr_write_b32 a78, 0
v_accvgpr_write_b32 a79, 0
v_accvgpr_write_b32 a80, 0
v_accvgpr_write_b32 a81, 0
v_accvgpr_write_b32 a82, 0
v_accvgpr_write_b32 a83, 0
v_accvgpr_write_b32 a84, 0
v_accvgpr_write_b32 a85, 0
v_accvgpr_write_b32 a86, 0
v_accvgpr_write_b32 a87, 0
v_accvgpr_write_b32 a88, 0
v_accvgpr_write_b32 a89, 0
v_accvgpr_write_b32 a90, 0
v_accvgpr_write_b32 a91, 0
v_accvgpr_write_b32 a92, 0
v_accvgpr_write_b32 a93, 0
v_accvgpr_write_b32 a94, 0
v_accvgpr_write_b32 a95, 0
v_accvgpr_write_b32 a96, 0
v_accvgpr_write_b32 a97, 0
v_accvgpr_write_b32 a98, 0
v_accvgpr_write_b32 a99, 0
v_accvgpr_write_b32 a100, 0
v_accvgpr_write_b32 a101, 0
v_accvgpr_write_b32 a102, 0
v_accvgpr_write_b32 a103, 0
v_accvgpr_write_b32 a104, 0
v_accvgpr_write_b32 a105, 0
v_accvgpr_write_b32 a106, 0
v_accvgpr_write_b32 a107, 0
v_accvgpr_write_b32 a108, 0
v_accvgpr_write_b32 a109, 0
v_accvgpr_write_b32 a110, 0
v_accvgpr_write_b32 a111, 0
v_accvgpr_write_b32 a112, 0
v_accvgpr_write_b32 a113, 0
v_accvgpr_write_b32 a114, 0
v_accvgpr_write_b32 a115, 0
v_accvgpr_write_b32 a116, 0
v_accvgpr_write_b32 a117, 0
v_accvgpr_write_b32 a118, 0
v_accvgpr_write_b32 a119, 0
v_accvgpr_write_b32 a120, 0
v_accvgpr_write_b32 a121, 0
v_accvgpr_write_b32 a122, 0
v_accvgpr_write_b32 a123, 0
v_accvgpr_write_b32 a124, 0
v_accvgpr_write_b32 a125, 0
v_accvgpr_write_b32 a126, 0
v_accvgpr_write_b32 a127, 0
v_mov_b32 v208, 0
v_mov_b32 v209, 0
v_mov_b32 v210, 0
v_mov_b32 v211, 0
v_mov_b32 v212, 0
v_mov_b32 v213, 0
v_mov_b32 v214, 0
v_mov_b32 v215, 0
v_mov_b32 v216, 0
v_mov_b32 v217, 0
v_mov_b32 v218, 0
v_mov_b32 v219, 0
v_mov_b32 v220, 0
v_mov_b32 v221, 0
v_mov_b32 v222, 0
v_mov_b32 v223, 0
s_mov_b32 s71, 0
L_slow2:
s_lshl_b32 s72, s71, 13
s_add_u32 s72, s72, s70
s_add_u32 s73, s72, 4096
buffer_load_dwordx4 v[160:163], v41, s[20:23], s72 offen offset:0
buffer_load_dwordx4 v[164:167], v41, s[20:23], s72 offen offset:64
buffer_load_dwordx4 v[168:171], v41, s[20:23], s72 offen offset:128
buffer_load_dwordx4 v[172:175], v41, s[20:23], s72 offen offset:192
buffer_load_dwordx4 v[176:179], v41, s[20:23], s73 offen offset:0
buffer_load_dwordx4 v[180:183], v41, s[20:23], s73 offen offset:64
buffer_load_dwordx4 v[184:187], v41, s[20:23], s73 offen offset:128
buffer_load_dwordx4 v[188:191], v41, s[20:23], s73 offen offset:192
s_waitcnt vmcnt(0)
N v[128:131],v[160:163],v[64:67],v[192:195]
N v[136:139],v[160:163],v[80:83],v[196:199]
N v[144:147],v[160:163],v[96:99],v[200:203]
N v[152:155],v[160:163],v[112:115],v[204:207]
M v[128:131],v[164:167],v[68:71]
M v[136:139],v[164:167],v[84:87]
M v[144:147],v[164:167],v[100:103]
M v[152:155],v[164:167],v[116:119]
M v[128:131],v[168:171],v[72:75]
M v[136:139],v[168:171],v[88:91]
M v[144:147],v[168:171],v[104:107]
M v[152:155],v[168:171],v[120:123]
M v[128:131],v[172:175],v[76:79]
M v[136:139],v[172:175],v[92:95]
M v[144:147],v[172:175],v[108:111]
M v[152:155],v[172:175],v[124:127]
N v[132:135],v[176:179],v[64:67],v[192:195]
N v[140:143],v[176:179],v[80:83],v[196:199]
N v[148:151],v[176:179],v[96:99],v[200:203]
N v[156:159],v[176:179],v[112:115],v[204:207]
M v[132:135],v[180:183],v[68:71]
M v[140:143],v[180:183],v[84:87]
M v[148:151],v[180:183],v[100:103]
M v[156:159],v[180:183],v[116:119]
M v[132:135],v[184:187],v[72:75]
M v[140:143],v[184:187],v[88:91]
M v[148:151],v[184:187],v[104:107]
M v[156:159],v[184:187],v[120:123]
M v[132:135],v[188:191],v[76:79]
M v[140:143],v[188:191],v[92:95]
M v[148:151],v[188:191],v[108:111]
M v[156:159],v[188:191],v[124:127]
v_exp_f32 v128, v128
v_exp_f32 v129, v129
v_exp_f32 v130, v130
v_exp_f32 v131, v131
s_nop 0
v_exp_f32 v132, v132
v_exp_f32 v133, v133
v_exp_f32 v134, v134
v_exp_f32 v135, v135
v_cvt_pk_bf16_f32 v128, v128, v129
v_cvt_pk_bf16_f32 v129, v130, v131
v_cvt_pk_bf16_f32 v130, v132, v133
v_cvt_pk_bf16_f32 v131, v134, v135
v_exp_f32 v136, v136
v_exp_f32 v137, v137
v_exp_f32 v138, v138
v_exp_f32 v139, v139
v_exp_f32 v140, v140
v_exp_f32 v141, v141
v_exp_f32 v142, v142
v_exp_f32 v143, v143
v_cvt_pk_bf16_f32 v136, v136, v137
v_cvt_pk_bf16_f32 v137, v138, v139
v_cvt_pk_bf16_f32 v138, v140, v141
v_cvt_pk_bf16_f32 v139, v142, v143
v_exp_f32 v144, v144
v_exp_f32 v145, v145
v_exp_f32 v146, v146
v_exp_f32 v147, v147
v_exp_f32 v148, v148
v_exp_f32 v149, v149
v_exp_f32 v150, v150
v_exp_f32 v151, v151
v_cvt_pk_bf16_f32 v144, v144, v145
v_cvt_pk_bf16_f32 v145, v146, v147
v_cvt_pk_bf16_f32 v146, v148, v149
v_cvt_pk_bf16_f32 v147, v150, v151
v_exp_f32 v152, v152
v_exp_f32 v153, v153
v_exp_f32 v154, v154
v_exp_f32 v155, v155
v_exp_f32 v156, v156
v_exp_f32 v157, v157
v_exp_f32 v158, v158
v_exp_f32 v159, v159
v_cvt_pk_bf16_f32 v152, v152, v153
v_cvt_pk_bf16_f32 v153, v154, v155
v_cvt_pk_bf16_f32 v154, v156, v157
v_cvt_pk_bf16_f32 v155, v158, v159
s_lshl_b32 s3, s55, 1
s_add_u32 s3, s3, 2
s_and_b32 s3, s3, 7
s_lshl_b32 s3, s3, 5
v_add_u32 v43, s3, v42
buffer_load_ushort v44, v43, s[24:27], s72 offen offset:0
buffer_load_ushort v45, v43, s[24:27], s72 offen offset:256
buffer_load_ushort v46, v43, s[24:27], s72 offen offset:512
buffer_load_ushort v47, v43, s[24:27], s72 offen offset:768
buffer_load_ushort v48, v43, s[24:27], s73 offen offset:0
buffer_load_ushort v49, v43, s[24:27], s73 offen offset:256
buffer_load_ushort v50, v43, s[24:27], s73 offen offset:512
buffer_load_ushort v51, v43, s[24:27], s73 offen offset:768
s_waitcnt vmcnt(0)
v_lshl_or_b32 v160, v45, 16, v44
v_lshl_or_b32 v161, v47, 16, v46
v_lshl_or_b32 v162, v49, 16, v48
v_lshl_or_b32 v163, v51, 16, v50
s_lshl_b32 s3, s55, 1
s_add_u32 s3, s3, 3
s_and_b32 s3, s3, 7
s_lshl_b32 s3, s3, 5
v_add_u32 v43, s3, v42
buffer_load_ushort v44, v43, s[24:27], s72 offen offset:0
buffer_load_ushort v45, v43, s[24:27], s72 offen offset:256
buffer_load_ushort v46, v43, s[24:27], s72 offen offset:512
buffer_load_ushort v47, v43, s[24:27], s72 offen offset:768
buffer_load_ushort v48, v43, s[24:27], s73 offen offset:0
buffer_load_ushort v49, v43, s[24:27], s73 offen offset:256
buffer_load_ushort v50, v43, s[24:27], s73 offen offset:512
buffer_load_ushort v51, v43, s[24:27], s73 offen offset:768
s_waitcnt vmcnt(0)
v_lshl_or_b32 v164, v45, 16, v44
v_lshl_or_b32 v165, v47, 16, v46
v_lshl_or_b32 v166, v49, 16, v48
v_lshl_or_b32 v167, v51, 16, v50
s_lshl_b32 s3, s55, 1
s_add_u32 s3, s3, 4
s_and_b32 s3, s3, 7
s_lshl_b32 s3, s3, 5
v_add_u32 v43, s3, v42
buffer_load_ushort v44, v43, s[24:27], s72 offen offset:0
buffer_load_ushort v45, v43, s[24:27], s72 offen offset:256
buffer_load_ushort v46, v43, s[24:27], s72 offen offset:512
buffer_load_ushort v47, v43, s[24:27], s72 offen offset:768
buffer_load_ushort v48, v43, s[24:27], s73 offen offset:0
buffer_load_ushort v49, v43, s[24:27], s73 offen offset:256
buffer_load_ushort v50, v43, s[24:27], s73 offen offset:512
buffer_load_ushort v51, v43, s[24:27], s73 offen offset:768
s_waitcnt vmcnt(0)
v_lshl_or_b32 v168, v45, 16, v44
v_lshl_or_b32 v169, v47, 16, v46
v_lshl_or_b32 v170, v49, 16, v48
v_lshl_or_b32 v171, v51, 16, v50
s_lshl_b32 s3, s55, 1
s_add_u32 s3, s3, 5
s_and_b32 s3, s3, 7
s_lshl_b32 s3, s3, 5
v_add_u32 v43, s3, v42
buffer_load_ushort v44, v43, s[24:27], s72 offen offset:0
buffer_load_ushort v45, v43, s[24:27], s72 offen offset:256
buffer_load_ushort v46, v43, s[24:27], s72 offen offset:512
buffer_load_ushort v47, v43, s[24:27], s72 offen offset:768
buffer_load_ushort v48, v43, s[24:27], s73 offen offset:0
buffer_load_ushort v49, v43, s[24:27], s73 offen offset:256
buffer_load_ushort v50, v43, s[24:27], s73 offen offset:512
buffer_load_ushort v51, v43, s[24:27], s73 offen offset:768
s_waitcnt vmcnt(0)
v_lshl_or_b32 v172, v45, 16, v44
v_lshl_or_b32 v173, v47, 16, v46
v_lshl_or_b32 v174, v49, 16, v48
v_lshl_or_b32 v175, v51, 16, v50
s_lshl_b32 s3, s55, 1
s_add_u32 s3, s3, 6
s_and_b32 s3, s3, 7
s_lshl_b32 s3, s3, 5
v_add_u32 v43, s3, v42
buffer_load_ushort v44, v43, s[24:27], s72 offen offset:0
buffer_load_ushort v45, v43, s[24:27], s72 offen offset:256
buffer_load_ushort v46, v43, s[24:27], s72 offen offset:512
buffer_load_ushort v47, v43, s[24:27], s72 offen offset:768
buffer_load_ushort v48, v43, s[24:27], s73 offen offset:0
buffer_load_ushort v49, v43, s[24:27], s73 offen offset:256
buffer_load_ushort v50, v43, s[24:27], s73 offen offset:512
buffer_load_ushort v51, v43, s[24:27], s73 offen offset:768
s_waitcnt vmcnt(0)
v_lshl_or_b32 v176, v45, 16, v44
v_lshl_or_b32 v177, v47, 16, v46
v_lshl_or_b32 v178, v49, 16, v48
v_lshl_or_b32 v179, v51, 16, v50
s_lshl_b32 s3, s55, 1
s_add_u32 s3, s3, 7
s_and_b32 s3, s3, 7
s_lshl_b32 s3, s3, 5
v_add_u32 v43, s3, v42
buffer_load_ushort v44, v43, s[24:27], s72 offen offset:0
buffer_load_ushort v45, v43, s[24:27], s72 offen offset:256
buffer_load_ushort v46, v43, s[24:27], s72 offen offset:512
buffer_load_ushort v47, v43, s[24:27], s72 offen offset:768
buffer_load_ushort v48, v43, s[24:27], s73 offen offset:0
buffer_load_ushort v49, v43, s[24:27], s73 offen offset:256
buffer_load_ushort v50, v43, s[24:27], s73 offen offset:512
buffer_load_ushort v51, v43, s[24:27], s73 offen offset:768
s_waitcnt vmcnt(0)
v_lshl_or_b32 v180, v45, 16, v44
v_lshl_or_b32 v181, v47, 16, v46
v_lshl_or_b32 v182, v49, 16, v48
v_lshl_or_b32 v183, v51, 16, v50
s_lshl_b32 s3, s55, 1
s_add_u32 s3, s3, 8
s_and_b32 s3, s3, 7
s_lshl_b32 s3, s3, 5
v_add_u32 v43, s3, v42
buffer_load_ushort v44, v43, s[24:27], s72 offen offset:0
buffer_load_ushort v45, v43, s[24:27], s72 offen offset:256
buffer_load_ushort v46, v43, s[24:27], s72 offen offset:512
buffer_load_ushort v47, v43, s[24:27], s72 offen offset:768
buffer_load_ushort v48, v43, s[24:27], s73 offen offset:0
buffer_load_ushort v49, v43, s[24:27], s73 offen offset:256
buffer_load_ushort v50, v43, s[24:27], s73 offen offset:512
buffer_load_ushort v51, v43, s[24:27], s73 offen offset:768
s_waitcnt vmcnt(0)
v_lshl_or_b32 v184, v45, 16, v44
v_lshl_or_b32 v185, v47, 16, v46
v_lshl_or_b32 v186, v49, 16, v48
v_lshl_or_b32 v187, v51, 16, v50
s_lshl_b32 s3, s55, 1
s_add_u32 s3, s3, 9
s_and_b32 s3, s3, 7
s_lshl_b32 s3, s3, 5
v_add_u32 v43, s3, v42
buffer_load_ushort v44, v43, s[24:27], s72 offen offset:0
buffer_load_ushort v45, v43, s[24:27], s72 offen offset:256
buffer_load_ushort v46, v43, s[24:27], s72 offen offset:512
buffer_load_ushort v47, v43, s[24:27], s72 offen offset:768
buffer_load_ushort v48, v43, s[24:27], s73 offen offset:0
buffer_load_ushort v49, v43, s[24:27], s73 offen offset:256
buffer_load_ushort v50, v43, s[24:27], s73 offen offset:512
buffer_load_ushort v51, v43, s[24:27], s73 offen offset:768
s_waitcnt vmcnt(0)
v_lshl_or_b32 v188, v45, 16, v44
v_lshl_or_b32 v189, v47, 16, v46
v_lshl_or_b32 v190, v49, 16, v48
v_lshl_or_b32 v191, v51, 16, v50
M a[0:3],v[160:163],v[128:131]
M a[4:7],v[160:163],v[136:139]
M a[8:11],v[160:163],v[144:147]
M a[12:15],v[160:163],v[152:155]
M a[16:19],v[164:167],v[128:131]
M a[20:23],v[164:167],v[136:139]
M a[24:27],v[164:167],v[144:147]
M a[28:31],v[164:167],v[152:155]
M a[32:35],v[168:171],v[128:131]
M a[36:39],v[168:171],v[136:139]
M a[40:43],v[168:171],v[144:147]
M a[44:47],v[168:171],v[152:155]
M a[48:51],v[172:175],v[128:131]
M a[52:55],v[172:175],v[136:139]
M a[56:59],v[172:175],v[144:147]
M a[60:63],v[172:175],v[152:155]
M a[64:67],v[176:179],v[128:131]
M a[68:71],v[176:179],v[136:139]
M a[72:75],v[176:179],v[144:147]
M a[76:79],v[176:179],v[152:155]
M a[80:83],v[180:183],v[128:131]
M a[84:87],v[180:183],v[136:139]
M a[88:91],v[180:183],v[144:147]
M a[92:95],v[180:183],v[152:155]
M a[96:99],v[184:187],v[128:131]
M a[100:103],v[184:187],v[136:139]
M a[104:107],v[184:187],v[144:147]
M a[108:111],v[184:187],v[152:155]
M a[112:115],v[188:191],v[128:131]
M a[116:119],v[188:191],v[136:139]
M a[120:123],v[188:191],v[144:147]
M a[124:127],v[188:191],v[152:155]
M v[208:211],v[240:243],v[128:131]
M v[212:215],v[240:243],v[136:139]
M v[216:219],v[240:243],v[144:147]
M v[220:223],v[240:243],v[152:155]
s_nop 7
s_add_u32 s71, s71, 1
s_cmp_lt_u32 s71, 16
s_cbranch_scc1 L_slow2
v_rcp_f32 v9, v208
v_mov_b32 v160, 0
v_mov_b32 v161, 0
v_mov_b32 v162, 0
v_mov_b32 v163, 0
v_rcp_f32 v10, v212
v_mov_b32 v168, 0
v_mov_b32 v169, 0
v_mov_b32 v170, 0
v_mov_b32 v171, 0
v_rcp_f32 v11, v216
v_mov_b32 v176, 0
v_mov_b32 v177, 0
v_mov_b32 v178, 0
v_mov_b32 v179, 0
v_rcp_f32 v12, v220
v_mov_b32 v184, 0
v_mov_b32 v185, 0
v_mov_b32 v186, 0
v_mov_b32 v187, 0
s_nop 1
s_branch L_norm
L_spins:
SPIN_xc:
s_mov_b32 s3, 262144
SPINL_xc:
buffer_load_dword v62, v14, s[12:15], s71 offen sc1
s_waitcnt vmcnt(0)
v_subrev_u32 v62, s74, v62
v_cmp_le_u32 vcc, 15, v62
s_cbranch_vccz BACK_xc
s_sub_u32 s3, s3, 1
s_cmp_lg_u32 s3, 0
s_cbranch_scc1 SPINL_xc
s_branch BACK_xc
SPIN_o:
s_mov_b32 s3, 262144
SPINL_o:
buffer_load_dword v62, v14, s[12:15], s6 offen sc1
s_waitcnt vmcnt(0)
v_subrev_u32 v62, s74, v62
v_cmp_le_u32 vcc, 13, v62
s_cbranch_vccz BACK_o
s_sub_u32 s3, s3, 1
s_cmp_lg_u32 s3, 0
s_cbranch_scc1 SPINL_o
s_branch BACK_o
SPIN_n:
s_mov_b32 s3, 262144
SPINL_n:
buffer_load_dword v62, v14, s[12:15], s6 offen sc1
s_waitcnt vmcnt(0)
v_subrev_u32 v62, s73, v62
v_cmp_le_u32 vcc, 13, v62
s_cbranch_vccz BACK_n
s_sub_u32 s3, s3, 1
s_cmp_lg_u32 s3, 0
s_cbranch_scc1 SPINL_n
s_branch BACK_n
SPIN_nonce:
s_mov_b32 s3, 262144
SPINL_nonce:
buffer_load_dword v122, v123, s[44:47], 0 offen sc1
s_waitcnt vmcnt(0)
v_cmp_eq_u32 vcc, 0, v122
s_cbranch_vccz BACK_nonce
s_sub_u32 s3, s3, 1
s_cmp_lg_u32 s3, 0
s_cbranch_scc1 SPINL_nonce
s_branch BACK_nonce
L_lead2:
v_readfirstlane_b32 s74, v122
L_lead:
s_add_u32 s74, s74, 16
s_cmp_eq_u32 s74, 0
s_cbranch_scc1 L_lead
v_subrev_u32 v123, s74, v122
v_cmp_gt_u32 vcc, 16, v123
s_cbranch_vccnz L_lead
v_mov_b32 v122, s74
v_mov_b32 v123, 0
s_lshl_b32 s74, s53, 5
buffer_store_dword v122, v123, s[44:47], s74 offen sc1
s_branch L_lead3
L_code_end:
.section .rodata,"a"
.p2align 6
.amdhsa_kernel recurrent_scan__sliding_block_cached__dense_activation_gelu__prompt_kernel
  .amdhsa_next_free_vgpr 512
  .amdhsa_next_free_sgpr 102
  .amdhsa_accum_offset 256
  .amdhsa_group_segment_fixed_size 0
  .amdhsa_kernarg_size 104
  .amdhsa_user_sgpr_count 2
  .amdhsa_user_sgpr_kernarg_segment_ptr 1
  .amdhsa_system_sgpr_workgroup_id_x 1
.end_amdhsa_kernel
```
